```python
import torch

def _softmax(x, axis=-1):
    return torch.softmax(x, dim=axis)

def _gelu(x):
    return torch.nn.functional.gelu(x, approximate='tanh')

def _silu(x):
    return torch.nn.functional.silu(x)

def _sigmoid(x):
    return torch.sigmoid(x)

def _layernorm(x, axis=-1, eps=1e-05):
    m = x.mean(dim=axis, keepdim=True)
    v = x.var(dim=axis, keepdim=True, unbiased=False)
    return (x - m) / torch.sqrt(v + eps)

def _scatter_add(tgt, idx, src, axis=0):
    return tgt.clone().index_add_(axis, idx, src)

def _segment_sum(src, seg, n):
    out = torch.zeros((n,) + src.shape[1:], dtype=src.dtype)
    return out.index_add_(0, seg, src)

def _pad(x, pw):
    flat = tuple((v for pair in reversed(pw) for v in pair))
    return torch.nn.functional.pad(x, flat)
kernel_name = 'adaLN_cond__ssm_conv_h3__mixer_gmlp__prompt'

def setup_inputs():

    _w = lambda a: (lambda t: t.to(torch.bfloat16) if t.is_floating_point() else t)(torch.as_tensor(a))

    def _A_setup():
        B, S, D = (1, 2048, 640)
        ks = 4
        return {'q': _w((lambda *s: torch.randn(*s, dtype=torch.bfloat16) * 0.05)(B, S, D)), 'k': _w((lambda *s: torch.randn(*s, dtype=torch.bfloat16) * 1.6)(B, S, D)), 'v': _w((lambda *s: torch.randn(*s, dtype=torch.bfloat16) * 1.6)(B, S, D)), 'shift_k': _w((lambda *s: torch.randn(*s, dtype=torch.bfloat16) * 1.6)(D, ks) * 0.5), 'ssm_k': _w((lambda *s: torch.randn(*s, dtype=torch.bfloat16) * 1.6)(D, S) * (1.0 / S ** 0.5)), 'ssm_D': _w((lambda *s: torch.randn(*s, dtype=torch.bfloat16) * 1.6)(D))}
    _A_in = _A_setup()

    def _B_setup():
        B, S, D, F = (1, 2048, 640, 1728)
        Fh = F // 2
        return {'x': _w((lambda *s: torch.randn(*s, dtype=torch.bfloat16) * 0.05)(B, S, D)), 'w_in': _w((lambda *s: torch.randn(*s, dtype=torch.bfloat16) * 0.8)(D, 2 * Fh)), 'w_sp': _w(0.01 * (lambda *s: torch.randn(*s, dtype=torch.bfloat16) * 0.8)(S, S)), 'b_sp': _w(1.0 + 0.01 * (lambda *s: torch.randn(*s, dtype=torch.bfloat16) * 0.1)(S)), 'w_out': _w((lambda *s: torch.randn(*s, dtype=torch.bfloat16) * 0.1)(Fh, D))}
    _B_in = _B_setup()
    return {'A_q': _A_in['q'], 'A_k': _A_in['k'], 'A_v': _A_in['v'], 'A_shift_k': _A_in['shift_k'], 'A_ssm_k': _A_in['ssm_k'], 'A_ssm_D': _A_in['ssm_D'], 'B_x': _B_in['x'], 'B_w_in': _B_in['w_in'], 'B_w_sp': _B_in['w_sp'], 'B_b_sp': _B_in['b_sp'], 'B_w_out': _B_in['w_out'], 'c': _w((lambda *s: torch.randn(*s, dtype=torch.bfloat16) * 0.1)(1, 640) * 8.0), 'w_mod': _w((lambda *s: torch.randn(*s, dtype=torch.bfloat16) * 0.1)(640, 6 * 640) * 640 ** (-0.5) * 8.0)}

def reference(A_q, A_k, A_v, A_shift_k, A_ssm_k, A_ssm_D, B_x, B_w_in, B_w_sp, B_b_sp, B_w_out, c, w_mod):

    def _A_ref(q, k, v, shift_k, ssm_k, ssm_D):
        B, S, D = q.shape
        ks = shift_k.shape[-1]
        k_pad = _pad(k, ((0, 0), (ks - 1, 0), (0, 0)))
        k_shift = torch.zeros_like(k)
        for t in range(ks):
            k_shift = k_shift + k_pad[:, t:t + S, :] * shift_k[:, ks - 1 - t][None, None, :]
        kv = k_shift * v
        L = 2 * S
        kv_pad = _pad(kv, ((0, 0), (0, S), (0, 0)))
        kf_pad = _pad(ssm_k, ((0, 0), (0, S)))
        kv_f = (lambda x, axes=(-2, -1): torch.fft.rfft2(x.float(), dim=axes))(kv_pad[:, None, :, :], axes=(1, 2))
        kf_f = (lambda x, axes=(-2, -1): torch.fft.rfft2(x.float(), dim=axes))(kf_pad[:, None, :], axes=(1, 2))
        kf_f = (lambda x, *d: x.permute(*d))(kf_f, 1, 2, 0)
        y_f = kv_f * kf_f[None, :, :, :]
        y = (lambda x, s, axes=(-2, -1): torch.fft.irfft2(x, s=s, dim=axes).to(torch.bfloat16))(y_f, (1, L), axes=(1, 2))[:, 0, :S, :]
        y = y + kv * ssm_D[None, None, :]
        return q * y

    def _B_ref(x, w_in, w_sp, b_sp, w_out):
        B, S, D = x.shape
        F = w_in.shape[-1]
        Fh = F // 2
        z = _gelu(torch.einsum('bsd,df->bsf', x, w_in))
        z1 = z[..., :Fh].clone()
        z2 = _layernorm(z[..., Fh:], axis=-1)
        g = torch.einsum('ts,bsf->btf', w_sp, z2) + b_sp[None, :, None]
        return torch.einsum('bsf,fd->bsd', z1 * g, w_out)
    x = A_q
    mod = (_silu(c) @ w_mod).reshape(c.shape[0], 6, 1, -1)
    sa, ca, ga, sb, cb, gb = (mod[:, 0].clone(), mod[:, 1].clone(), mod[:, 2].clone(), mod[:, 3].clone(), mod[:, 4].clone(), mod[:, 5].clone())
    h = _layernorm(x, axis=-1) * (1 + ca) + sa
    x = x + ga * _A_ref(h, A_k, A_v, A_shift_k, A_ssm_k, A_ssm_D)
    h = _layernorm(x, axis=-1) * (1 + cb) + sb
    x = x + gb * _B_ref(h, B_w_in, B_w_sp, B_b_sp, B_w_out)
    return x
```

```asm
; @launch kernel=k0_kernel grid=(256,1,1) block=(256,1,1) lds=33152
; @launch kernel=k1_kernel grid=(248,1,1) block=(256,1,1) lds=150528
; @launch kernel=k2_kernel grid=(256,1,1) block=(256,1,1) lds=86528
; @launch kernel=k3_kernel grid=(256,1,1) block=(256,1,1) lds=131072
; @launch kernel=k4_kernel grid=(256,1,1) block=(256,1,1) lds=143360
.amdgcn_target "amdgcn-amd-amdhsa--gfx950"
.text
.globl k0_kernel
.p2align 8
.type k0_kernel,@function
k0_kernel:
    s_cmp_ge_u32 s2, 256
    s_cbranch_scc1 L_k0_end_1
    s_load_dwordx2 s[4:5], s[0:1], 120
    s_mov_b32 s6, 33554432
    s_mov_b32 s7, 0x20000
    s_mov_b32 s3, 0xffff0000
    s_cmp_ge_u32 s2, 160
    s_cbranch_scc1 L_k0_gemv_2
    s_load_dwordx2 s[8:9], s[0:1], 8
    s_mov_b32 s10, 2621440
    s_mov_b32 s11, 0x20000
    s_load_dwordx2 s[12:13], s[0:1], 16
    s_mov_b32 s14, 2621440
    s_mov_b32 s15, 0x20000
    s_load_dwordx2 s[16:17], s[0:1], 0
    s_mov_b32 s18, 2621440
    s_mov_b32 s19, 0x20000
    s_load_dwordx2 s[20:21], s[0:1], 24
    s_mov_b32 s22, 5120
    s_mov_b32 s23, 0x20000
    s_lshr_b32 s24, s2, 4
    s_and_b32 s25, s2, 15
    v_and_b32 v1, 7, v0
    v_lshrrev_b32 v2, 3, v0
    s_mul_i32 s26, s25, 163840
    s_lshl_b32 s27, s24, 7
    s_add_u32 s26, s26, s27
    v_mul_u32_u24 v3, 5120, v2
    v_lshl_add_u32 v3, v1, 4, v3
    v_add_u32 v3, s26, v3
    v_subrev_u32 v4, 3840, v3
    s_lshl_b32 s27, s24, 9
    v_lshl_add_u32 v5, v1, 6, s27
    s_waitcnt lgkmcnt(0)
    buffer_load_dwordx4 v[68:71], v5, s[20:23], 0 offen offset:0
    buffer_load_dwordx4 v[72:75], v5, s[20:23], 0 offen offset:16
    buffer_load_dwordx4 v[76:79], v5, s[20:23], 0 offen offset:32
    buffer_load_dwordx4 v[80:83], v5, s[20:23], 0 offen offset:48
    buffer_load_dwordx4 v[20:23], v3, s[8:11], 0 offen offset:0
    buffer_load_dwordx4 v[24:27], v3, s[8:11], 0 offen offset:1280
    buffer_load_dwordx4 v[28:31], v3, s[8:11], 0 offen offset:2560
    buffer_load_dwordx4 v[32:35], v3, s[8:11], 0 offen offset:3840
    buffer_load_dwordx4 v[36:39], v3, s[12:15], 0 offen offset:0
    buffer_load_dwordx4 v[40:43], v3, s[12:15], 0 offen offset:1280
    buffer_load_dwordx4 v[44:47], v3, s[12:15], 0 offen offset:2560
    buffer_load_dwordx4 v[48:51], v3, s[12:15], 0 offen offset:3840
    buffer_load_dwordx4 v[8:11], v4, s[8:11], 0 offen offset:0
    buffer_load_dwordx4 v[12:15], v4, s[8:11], 0 offen offset:1280
    buffer_load_dwordx4 v[16:19], v4, s[8:11], 0 offen offset:2560
    buffer_load_dwordx4 v[52:55], v3, s[16:19], 0 offen offset:0
    buffer_load_dwordx4 v[56:59], v3, s[16:19], 0 offen offset:1280
    buffer_load_dwordx4 v[60:63], v3, s[16:19], 0 offen offset:2560
    buffer_load_dwordx4 v[64:67], v3, s[16:19], 0 offen offset:3840
    v_mul_u32_u24 v84, 2064, v1
    v_bfe_u32 v6, v2, 1, 1
    v_lshl_add_u32 v84, v6, 7, v84
    v_lshrrev_b32 v6, 2, v2
    v_lshl_add_u32 v84, v6, 4, v84
    v_and_b32 v6, 1, v2
    v_xor_b32 v6, 1, v6
    v_lshl_add_u32 v84, v6, 3, v84
    v_mul_u32_u24 v85, 2080, v1
    v_lshrrev_b32 v6, 3, v2
    v_lshl_add_u32 v85, v6, 8, v85
    v_and_b32 v6, 7, v2
    v_lshl_add_u32 v85, v6, 4, v85
    v_add_u32 v85, 16512, v85
    v_lshrrev_b32 v6, 7, v0
    v_mul_u32_u24 v86, 2064, v6
    v_and_b32 v6, 127, v0
    v_lshl_add_u32 v86, v6, 4, v86
    v_lshrrev_b32 v6, 3, v0
    v_lshlrev_b32 v87, 11, v6
    v_lshl_add_u32 v87, v1, 4, v87
    v_lshrrev_b32 v6, 6, v0
    v_mul_u32_u24 v88, 1040, v6
    v_lshlrev_b32 v89, 14, v6
    v_and_b32 v6, 63, v0
    v_lshl_add_u32 v88, v6, 4, v88
    v_lshl_add_u32 v89, v6, 4, v89
    s_lshl_b32 s26, s24, 18
    s_lshl_b32 s27, s25, 7
    s_add_u32 s28, s26, s27
    s_add_u32 s28, s28, 1048576
    s_lshl_b32 s27, s25, 10
    s_add_u32 s32, s26, s27
    s_add_u32 s32, s32, 3670016
    s_add_u32 s29, s28, 65536
    s_add_u32 s33, s32, 65536
    s_add_u32 s30, s28, 131072
    s_add_u32 s34, s32, 131072
    s_add_u32 s31, s28, 196608
    s_add_u32 s35, s32, 196608
    s_waitcnt vmcnt(18)
    v_lshlrev_b32 v90, 16, v68
    v_and_b32 v92, s3, v68
    v_lshlrev_b32 v94, 16, v69
    v_and_b32 v96, s3, v69
    v_lshlrev_b32 v91, 16, v70
    v_and_b32 v93, s3, v70
    v_lshlrev_b32 v95, 16, v71
    v_and_b32 v97, s3, v71
    s_waitcnt vmcnt(14)
    v_lshlrev_b32 v104, 16, v20
    v_and_b32 v105, s3, v20
    s_waitcnt vmcnt(13)
    v_lshlrev_b32 v106, 16, v24
    v_and_b32 v107, s3, v24
    s_waitcnt vmcnt(12)
    v_lshlrev_b32 v108, 16, v28
    v_and_b32 v109, s3, v28
    s_waitcnt vmcnt(11)
    v_lshlrev_b32 v110, 16, v32
    v_and_b32 v111, s3, v32
    s_waitcnt vmcnt(6)
    v_lshlrev_b32 v98, 16, v8
    v_and_b32 v99, s3, v8
    s_waitcnt vmcnt(5)
    v_lshlrev_b32 v100, 16, v12
    v_and_b32 v101, s3, v12
    s_waitcnt vmcnt(4)
    v_lshlrev_b32 v102, 16, v16
    v_and_b32 v103, s3, v16
    v_lshlrev_b32 v112, 16, v36
    v_and_b32 v113, s3, v36
    v_lshlrev_b32 v114, 16, v40
    v_and_b32 v115, s3, v40
    v_lshlrev_b32 v116, 16, v44
    v_and_b32 v117, s3, v44
    v_lshlrev_b32 v118, 16, v48
    v_and_b32 v119, s3, v48
    v_pk_mul_f32 v[120:121], v[98:99], v[96:97]
    v_pk_mul_f32 v[122:123], v[100:101], v[96:97]
    v_pk_mul_f32 v[124:125], v[102:103], v[96:97]
    v_pk_mul_f32 v[126:127], v[104:105], v[96:97]
    v_pk_fma_f32 v[120:121], v[100:101], v[94:95], v[120:121]
    v_pk_fma_f32 v[122:123], v[102:103], v[94:95], v[122:123]
    v_pk_fma_f32 v[124:125], v[104:105], v[94:95], v[124:125]
    v_pk_fma_f32 v[126:127], v[106:107], v[94:95], v[126:127]
    v_pk_fma_f32 v[120:121], v[102:103], v[92:93], v[120:121]
    v_pk_fma_f32 v[122:123], v[104:105], v[92:93], v[122:123]
    v_pk_fma_f32 v[124:125], v[106:107], v[92:93], v[124:125]
    v_pk_fma_f32 v[126:127], v[108:109], v[92:93], v[126:127]
    v_pk_fma_f32 v[120:121], v[104:105], v[90:91], v[120:121]
    v_pk_fma_f32 v[122:123], v[106:107], v[90:91], v[122:123]
    v_pk_fma_f32 v[124:125], v[108:109], v[90:91], v[124:125]
    v_pk_fma_f32 v[126:127], v[110:111], v[90:91], v[126:127]
    v_pk_mul_f32 v[120:121], v[120:121], v[112:113]
    v_pk_mul_f32 v[122:123], v[122:123], v[114:115]
    v_pk_mul_f32 v[124:125], v[124:125], v[116:117]
    v_pk_mul_f32 v[126:127], v[126:127], v[118:119]
    v_cvt_pk_bf16_f32 v128, v126, v124
    v_cvt_pk_bf16_f32 v129, v122, v120
    ds_write_b64 v84, v[128:129] offset:0
    v_cvt_pk_bf16_f32 v130, v127, v125
    v_cvt_pk_bf16_f32 v131, v123, v121
    ds_write_b64 v84, v[130:131] offset:256
    v_lshlrev_b32 v90, 16, v72
    v_and_b32 v92, s3, v72
    v_lshlrev_b32 v94, 16, v73
    v_and_b32 v96, s3, v73
    v_lshlrev_b32 v91, 16, v74
    v_and_b32 v93, s3, v74
    v_lshlrev_b32 v95, 16, v75
    v_and_b32 v97, s3, v75
    v_lshlrev_b32 v104, 16, v21
    v_and_b32 v105, s3, v21
    v_lshlrev_b32 v106, 16, v25
    v_and_b32 v107, s3, v25
    v_lshlrev_b32 v108, 16, v29
    v_and_b32 v109, s3, v29
    v_lshlrev_b32 v110, 16, v33
    v_and_b32 v111, s3, v33
    v_lshlrev_b32 v98, 16, v9
    v_and_b32 v99, s3, v9
    v_lshlrev_b32 v100, 16, v13
    v_and_b32 v101, s3, v13
    v_lshlrev_b32 v102, 16, v17
    v_and_b32 v103, s3, v17
    v_lshlrev_b32 v112, 16, v37
    v_and_b32 v113, s3, v37
    v_lshlrev_b32 v114, 16, v41
    v_and_b32 v115, s3, v41
    v_lshlrev_b32 v116, 16, v45
    v_and_b32 v117, s3, v45
    v_lshlrev_b32 v118, 16, v49
    v_and_b32 v119, s3, v49
    v_pk_mul_f32 v[120:121], v[98:99], v[96:97]
    v_pk_mul_f32 v[122:123], v[100:101], v[96:97]
    v_pk_mul_f32 v[124:125], v[102:103], v[96:97]
    v_pk_mul_f32 v[126:127], v[104:105], v[96:97]
    v_pk_fma_f32 v[120:121], v[100:101], v[94:95], v[120:121]
    v_pk_fma_f32 v[122:123], v[102:103], v[94:95], v[122:123]
    v_pk_fma_f32 v[124:125], v[104:105], v[94:95], v[124:125]
    v_pk_fma_f32 v[126:127], v[106:107], v[94:95], v[126:127]
    v_pk_fma_f32 v[120:121], v[102:103], v[92:93], v[120:121]
    v_pk_fma_f32 v[122:123], v[104:105], v[92:93], v[122:123]
    v_pk_fma_f32 v[124:125], v[106:107], v[92:93], v[124:125]
    v_pk_fma_f32 v[126:127], v[108:109], v[92:93], v[126:127]
    v_pk_fma_f32 v[120:121], v[104:105], v[90:91], v[120:121]
    v_pk_fma_f32 v[122:123], v[106:107], v[90:91], v[122:123]
    v_pk_fma_f32 v[124:125], v[108:109], v[90:91], v[124:125]
    v_pk_fma_f32 v[126:127], v[110:111], v[90:91], v[126:127]
    v_pk_mul_f32 v[120:121], v[120:121], v[112:113]
    v_pk_mul_f32 v[122:123], v[122:123], v[114:115]
    v_pk_mul_f32 v[124:125], v[124:125], v[116:117]
    v_pk_mul_f32 v[126:127], v[126:127], v[118:119]
    v_cvt_pk_bf16_f32 v128, v126, v124
    v_cvt_pk_bf16_f32 v129, v122, v120
    ds_write_b64 v84, v[128:129] offset:512
    v_cvt_pk_bf16_f32 v130, v127, v125
    v_cvt_pk_bf16_f32 v131, v123, v121
    ds_write_b64 v84, v[130:131] offset:768
    v_lshlrev_b32 v90, 16, v76
    v_and_b32 v92, s3, v76
    v_lshlrev_b32 v94, 16, v77
    v_and_b32 v96, s3, v77
    v_lshlrev_b32 v91, 16, v78
    v_and_b32 v93, s3, v78
    v_lshlrev_b32 v95, 16, v79
    v_and_b32 v97, s3, v79
    v_lshlrev_b32 v104, 16, v22
    v_and_b32 v105, s3, v22
    v_lshlrev_b32 v106, 16, v26
    v_and_b32 v107, s3, v26
    v_lshlrev_b32 v108, 16, v30
    v_and_b32 v109, s3, v30
    v_lshlrev_b32 v110, 16, v34
    v_and_b32 v111, s3, v34
    v_lshlrev_b32 v98, 16, v10
    v_and_b32 v99, s3, v10
    v_lshlrev_b32 v100, 16, v14
    v_and_b32 v101, s3, v14
    v_lshlrev_b32 v102, 16, v18
    v_and_b32 v103, s3, v18
    v_lshlrev_b32 v112, 16, v38
    v_and_b32 v113, s3, v38
    v_lshlrev_b32 v114, 16, v42
    v_and_b32 v115, s3, v42
    v_lshlrev_b32 v116, 16, v46
    v_and_b32 v117, s3, v46
    v_lshlrev_b32 v118, 16, v50
    v_and_b32 v119, s3, v50
    v_pk_mul_f32 v[120:121], v[98:99], v[96:97]
    v_pk_mul_f32 v[122:123], v[100:101], v[96:97]
    v_pk_mul_f32 v[124:125], v[102:103], v[96:97]
    v_pk_mul_f32 v[126:127], v[104:105], v[96:97]
    v_pk_fma_f32 v[120:121], v[100:101], v[94:95], v[120:121]
    v_pk_fma_f32 v[122:123], v[102:103], v[94:95], v[122:123]
    v_pk_fma_f32 v[124:125], v[104:105], v[94:95], v[124:125]
    v_pk_fma_f32 v[126:127], v[106:107], v[94:95], v[126:127]
    v_pk_fma_f32 v[120:121], v[102:103], v[92:93], v[120:121]
    v_pk_fma_f32 v[122:123], v[104:105], v[92:93], v[122:123]
    v_pk_fma_f32 v[124:125], v[106:107], v[92:93], v[124:125]
    v_pk_fma_f32 v[126:127], v[108:109], v[92:93], v[126:127]
    v_pk_fma_f32 v[120:121], v[104:105], v[90:91], v[120:121]
    v_pk_fma_f32 v[122:123], v[106:107], v[90:91], v[122:123]
    v_pk_fma_f32 v[124:125], v[108:109], v[90:91], v[124:125]
    v_pk_fma_f32 v[126:127], v[110:111], v[90:91], v[126:127]
    v_pk_mul_f32 v[120:121], v[120:121], v[112:113]
    v_pk_mul_f32 v[122:123], v[122:123], v[114:115]
    v_pk_mul_f32 v[124:125], v[124:125], v[116:117]
    v_pk_mul_f32 v[126:127], v[126:127], v[118:119]
    v_cvt_pk_bf16_f32 v128, v126, v124
    v_cvt_pk_bf16_f32 v129, v122, v120
    ds_write_b64 v84, v[128:129] offset:1024
    v_cvt_pk_bf16_f32 v130, v127, v125
    v_cvt_pk_bf16_f32 v131, v123, v121
    ds_write_b64 v84, v[130:131] offset:1280
    v_lshlrev_b32 v90, 16, v80
    v_and_b32 v92, s3, v80
    v_lshlrev_b32 v94, 16, v81
    v_and_b32 v96, s3, v81
    v_lshlrev_b32 v91, 16, v82
    v_and_b32 v93, s3, v82
    v_lshlrev_b32 v95, 16, v83
    v_and_b32 v97, s3, v83
    v_lshlrev_b32 v104, 16, v23
    v_and_b32 v105, s3, v23
    v_lshlrev_b32 v106, 16, v27
    v_and_b32 v107, s3, v27
    v_lshlrev_b32 v108, 16, v31
    v_and_b32 v109, s3, v31
    v_lshlrev_b32 v110, 16, v35
    v_and_b32 v111, s3, v35
    v_lshlrev_b32 v98, 16, v11
    v_and_b32 v99, s3, v11
    v_lshlrev_b32 v100, 16, v15
    v_and_b32 v101, s3, v15
    v_lshlrev_b32 v102, 16, v19
    v_and_b32 v103, s3, v19
    v_lshlrev_b32 v112, 16, v39
    v_and_b32 v113, s3, v39
    v_lshlrev_b32 v114, 16, v43
    v_and_b32 v115, s3, v43
    v_lshlrev_b32 v116, 16, v47
    v_and_b32 v117, s3, v47
    v_lshlrev_b32 v118, 16, v51
    v_and_b32 v119, s3, v51
    v_pk_mul_f32 v[120:121], v[98:99], v[96:97]
    v_pk_mul_f32 v[122:123], v[100:101], v[96:97]
    v_pk_mul_f32 v[124:125], v[102:103], v[96:97]
    v_pk_mul_f32 v[126:127], v[104:105], v[96:97]
    v_pk_fma_f32 v[120:121], v[100:101], v[94:95], v[120:121]
    v_pk_fma_f32 v[122:123], v[102:103], v[94:95], v[122:123]
    v_pk_fma_f32 v[124:125], v[104:105], v[94:95], v[124:125]
    v_pk_fma_f32 v[126:127], v[106:107], v[94:95], v[126:127]
    v_pk_fma_f32 v[120:121], v[102:103], v[92:93], v[120:121]
    v_pk_fma_f32 v[122:123], v[104:105], v[92:93], v[122:123]
    v_pk_fma_f32 v[124:125], v[106:107], v[92:93], v[124:125]
    v_pk_fma_f32 v[126:127], v[108:109], v[92:93], v[126:127]
    v_pk_fma_f32 v[120:121], v[104:105], v[90:91], v[120:121]
    v_pk_fma_f32 v[122:123], v[106:107], v[90:91], v[122:123]
    v_pk_fma_f32 v[124:125], v[108:109], v[90:91], v[124:125]
    v_pk_fma_f32 v[126:127], v[110:111], v[90:91], v[126:127]
    v_pk_mul_f32 v[120:121], v[120:121], v[112:113]
    v_pk_mul_f32 v[122:123], v[122:123], v[114:115]
    v_pk_mul_f32 v[124:125], v[124:125], v[116:117]
    v_pk_mul_f32 v[126:127], v[126:127], v[118:119]
    v_cvt_pk_bf16_f32 v128, v126, v124
    v_cvt_pk_bf16_f32 v129, v122, v120
    ds_write_b64 v84, v[128:129] offset:1536
    v_cvt_pk_bf16_f32 v130, v127, v125
    v_cvt_pk_bf16_f32 v131, v123, v121
    ds_write_b64 v84, v[130:131] offset:1792
    s_waitcnt vmcnt(1)
    ds_write2_b64 v85, v[52:53], v[60:61] offset0:0 offset1:1
    s_waitcnt vmcnt(0)
    ds_write2_b64 v85, v[56:57], v[64:65] offset0:16 offset1:17
    ds_write2_b64 v85, v[54:55], v[62:63] offset0:130 offset1:131
    ds_write2_b64 v85, v[58:59], v[66:67] offset0:146 offset1:147
    s_waitcnt lgkmcnt(0)
    s_barrier
    ds_read_b128 v[8:11], v86 offset:0
    ds_read_b128 v[12:15], v86 offset:4128
    ds_read_b128 v[16:19], v86 offset:8256
    ds_read_b128 v[20:23], v86 offset:12384
    ds_read_b128 v[36:39], v88 offset:16512
    ds_read_b128 v[40:43], v88 offset:20672
    ds_read_b128 v[44:47], v88 offset:24832
    ds_read_b128 v[48:51], v88 offset:28992
    s_waitcnt lgkmcnt(7)
    buffer_store_dwordx4 v[8:11], v87, s[4:7], s28 offen
    s_waitcnt lgkmcnt(6)
    buffer_store_dwordx4 v[12:15], v87, s[4:7], s29 offen
    s_waitcnt lgkmcnt(5)
    buffer_store_dwordx4 v[16:19], v87, s[4:7], s30 offen
    s_waitcnt lgkmcnt(4)
    buffer_store_dwordx4 v[20:23], v87, s[4:7], s31 offen
    s_waitcnt lgkmcnt(3)
    buffer_store_dwordx4 v[36:39], v89, s[4:7], s32 offen
    s_waitcnt lgkmcnt(2)
    buffer_store_dwordx4 v[40:43], v89, s[4:7], s33 offen
    s_waitcnt lgkmcnt(1)
    buffer_store_dwordx4 v[44:47], v89, s[4:7], s34 offen
    s_waitcnt lgkmcnt(0)
    buffer_store_dwordx4 v[48:51], v89, s[4:7], s35 offen
    s_branch L_k0_fin_5
L_k0_gemv_2:
    s_cmp_ge_u32 s2, 220
    s_cbranch_scc1 L_k0_stats_3
    s_load_dwordx2 s[8:9], s[0:1], 96
    s_mov_b32 s10, 4915200
    s_mov_b32 s11, 0x20000
    s_load_dwordx2 s[12:13], s[0:1], 88
    s_mov_b32 s14, 1280
    s_mov_b32 s15, 0x20000
    s_sub_u32 s16, s2, 160
    v_and_b32 v1, 7, v0
    v_lshrrev_b32 v2, 3, v0
    v_mul_u32_u24 v4, 40, v2
    v_mul_u32_u24 v3, 153600, v2
    v_lshl_add_u32 v3, v1, 4, v3
    s_lshl_b32 s17, s16, 7
    s_waitcnt lgkmcnt(0)
    buffer_load_dwordx4 v[6:9], v4, s[12:15], 0 offen
    buffer_load_dwordx4 v[10:13], v4, s[12:15], 0 offen offset:16
    buffer_load_dwordx2 v[14:15], v4, s[12:15], 0 offen offset:32
    buffer_load_dwordx4 v[16:19], v3, s[8:11], s17 offen
    s_add_u32 s17, s17, 7680
    buffer_load_dwordx4 v[20:23], v3, s[8:11], s17 offen
    s_add_u32 s17, s17, 7680
    buffer_load_dwordx4 v[24:27], v3, s[8:11], s17 offen
    s_add_u32 s17, s17, 7680
    buffer_load_dwordx4 v[28:31], v3, s[8:11], s17 offen
    s_add_u32 s17, s17, 7680
    buffer_load_dwordx4 v[32:35], v3, s[8:11], s17 offen
    s_add_u32 s17, s17, 7680
    buffer_load_dwordx4 v[36:39], v3, s[8:11], s17 offen
    s_add_u32 s17, s17, 7680
    buffer_load_dwordx4 v[40:43], v3, s[8:11], s17 offen
    s_add_u32 s17, s17, 7680
    buffer_load_dwordx4 v[44:47], v3, s[8:11], s17 offen
    s_add_u32 s17, s17, 7680
    buffer_load_dwordx4 v[48:51], v3, s[8:11], s17 offen
    s_add_u32 s17, s17, 7680
    buffer_load_dwordx4 v[52:55], v3, s[8:11], s17 offen
    s_add_u32 s17, s17, 7680
    buffer_load_dwordx4 v[56:59], v3, s[8:11], s17 offen
    s_add_u32 s17, s17, 7680
    buffer_load_dwordx4 v[60:63], v3, s[8:11], s17 offen
    s_add_u32 s17, s17, 7680
    buffer_load_dwordx4 v[64:67], v3, s[8:11], s17 offen
    s_add_u32 s17, s17, 7680
    buffer_load_dwordx4 v[68:71], v3, s[8:11], s17 offen
    s_add_u32 s17, s17, 7680
    buffer_load_dwordx4 v[72:75], v3, s[8:11], s17 offen
    s_add_u32 s17, s17, 7680
    buffer_load_dwordx4 v[76:79], v3, s[8:11], s17 offen
    s_add_u32 s17, s17, 7680
    buffer_load_dwordx4 v[80:83], v3, s[8:11], s17 offen
    s_add_u32 s17, s17, 7680
    buffer_load_dwordx4 v[84:87], v3, s[8:11], s17 offen
    s_add_u32 s17, s17, 7680
    buffer_load_dwordx4 v[88:91], v3, s[8:11], s17 offen
    s_add_u32 s17, s17, 7680
    buffer_load_dwordx4 v[92:95], v3, s[8:11], s17 offen
    s_mov_b32 s18, 0xbfb8aa3b
    s_waitcnt vmcnt(22)
    v_lshlrev_b32 v124, 16, v6
    v_and_b32 v125, s3, v6
    v_mul_f32 v126, s18, v124
    v_mul_f32 v127, s18, v125
    v_exp_f32 v126, v126
    v_exp_f32 v127, v127
    v_add_f32 v126, 1.0, v126
    v_add_f32 v127, 1.0, v127
    v_rcp_f32 v126, v126
    v_rcp_f32 v127, v127
    v_mul_f32 v124, v124, v126
    v_mul_f32 v125, v125, v127
    v_cvt_pk_bf16_f32 v124, v124, v125
    v_lshlrev_b32 v96, 16, v124
    v_and_b32 v97, s3, v124
    v_lshlrev_b32 v124, 16, v7
    v_and_b32 v125, s3, v7
    v_mul_f32 v126, s18, v124
    v_mul_f32 v127, s18, v125
    v_exp_f32 v126, v126
    v_exp_f32 v127, v127
    v_add_f32 v126, 1.0, v126
    v_add_f32 v127, 1.0, v127
    v_rcp_f32 v126, v126
    v_rcp_f32 v127, v127
    v_mul_f32 v124, v124, v126
    v_mul_f32 v125, v125, v127
    v_cvt_pk_bf16_f32 v124, v124, v125
    v_lshlrev_b32 v98, 16, v124
    v_and_b32 v99, s3, v124
    v_lshlrev_b32 v124, 16, v8
    v_and_b32 v125, s3, v8
    v_mul_f32 v126, s18, v124
    v_mul_f32 v127, s18, v125
    v_exp_f32 v126, v126
    v_exp_f32 v127, v127
    v_add_f32 v126, 1.0, v126
    v_add_f32 v127, 1.0, v127
    v_rcp_f32 v126, v126
    v_rcp_f32 v127, v127
    v_mul_f32 v124, v124, v126
    v_mul_f32 v125, v125, v127
    v_cvt_pk_bf16_f32 v124, v124, v125
    v_lshlrev_b32 v100, 16, v124
    v_and_b32 v101, s3, v124
    v_lshlrev_b32 v124, 16, v9
    v_and_b32 v125, s3, v9
    v_mul_f32 v126, s18, v124
    v_mul_f32 v127, s18, v125
    v_exp_f32 v126, v126
    v_exp_f32 v127, v127
    v_add_f32 v126, 1.0, v126
    v_add_f32 v127, 1.0, v127
    v_rcp_f32 v126, v126
    v_rcp_f32 v127, v127
    v_mul_f32 v124, v124, v126
    v_mul_f32 v125, v125, v127
    v_cvt_pk_bf16_f32 v124, v124, v125
    v_lshlrev_b32 v102, 16, v124
    v_and_b32 v103, s3, v124
    s_waitcnt vmcnt(21)
    v_lshlrev_b32 v124, 16, v10
    v_and_b32 v125, s3, v10
    v_mul_f32 v126, s18, v124
    v_mul_f32 v127, s18, v125
    v_exp_f32 v126, v126
    v_exp_f32 v127, v127
    v_add_f32 v126, 1.0, v126
    v_add_f32 v127, 1.0, v127
    v_rcp_f32 v126, v126
    v_rcp_f32 v127, v127
    v_mul_f32 v124, v124, v126
    v_mul_f32 v125, v125, v127
    v_cvt_pk_bf16_f32 v124, v124, v125
    v_lshlrev_b32 v104, 16, v124
    v_and_b32 v105, s3, v124
    v_lshlrev_b32 v124, 16, v11
    v_and_b32 v125, s3, v11
    v_mul_f32 v126, s18, v124
    v_mul_f32 v127, s18, v125
    v_exp_f32 v126, v126
    v_exp_f32 v127, v127
    v_add_f32 v126, 1.0, v126
    v_add_f32 v127, 1.0, v127
    v_rcp_f32 v126, v126
    v_rcp_f32 v127, v127
    v_mul_f32 v124, v124, v126
    v_mul_f32 v125, v125, v127
    v_cvt_pk_bf16_f32 v124, v124, v125
    v_lshlrev_b32 v106, 16, v124
    v_and_b32 v107, s3, v124
    v_lshlrev_b32 v124, 16, v12
    v_and_b32 v125, s3, v12
    v_mul_f32 v126, s18, v124
    v_mul_f32 v127, s18, v125
    v_exp_f32 v126, v126
    v_exp_f32 v127, v127
    v_add_f32 v126, 1.0, v126
    v_add_f32 v127, 1.0, v127
    v_rcp_f32 v126, v126
    v_rcp_f32 v127, v127
    v_mul_f32 v124, v124, v126
    v_mul_f32 v125, v125, v127
    v_cvt_pk_bf16_f32 v124, v124, v125
    v_lshlrev_b32 v108, 16, v124
    v_and_b32 v109, s3, v124
    v_lshlrev_b32 v124, 16, v13
    v_and_b32 v125, s3, v13
    v_mul_f32 v126, s18, v124
    v_mul_f32 v127, s18, v125
    v_exp_f32 v126, v126
    v_exp_f32 v127, v127
    v_add_f32 v126, 1.0, v126
    v_add_f32 v127, 1.0, v127
    v_rcp_f32 v126, v126
    v_rcp_f32 v127, v127
    v_mul_f32 v124, v124, v126
    v_mul_f32 v125, v125, v127
    v_cvt_pk_bf16_f32 v124, v124, v125
    v_lshlrev_b32 v110, 16, v124
    v_and_b32 v111, s3, v124
    s_waitcnt vmcnt(20)
    v_lshlrev_b32 v124, 16, v14
    v_and_b32 v125, s3, v14
    v_mul_f32 v126, s18, v124
    v_mul_f32 v127, s18, v125
    v_exp_f32 v126, v126
    v_exp_f32 v127, v127
    v_add_f32 v126, 1.0, v126
    v_add_f32 v127, 1.0, v127
    v_rcp_f32 v126, v126
    v_rcp_f32 v127, v127
    v_mul_f32 v124, v124, v126
    v_mul_f32 v125, v125, v127
    v_cvt_pk_bf16_f32 v124, v124, v125
    v_lshlrev_b32 v112, 16, v124
    v_and_b32 v113, s3, v124
    v_lshlrev_b32 v124, 16, v15
    v_and_b32 v125, s3, v15
    v_mul_f32 v126, s18, v124
    v_mul_f32 v127, s18, v125
    v_exp_f32 v126, v126
    v_exp_f32 v127, v127
    v_add_f32 v126, 1.0, v126
    v_add_f32 v127, 1.0, v127
    v_rcp_f32 v126, v126
    v_rcp_f32 v127, v127
    v_mul_f32 v124, v124, v126
    v_mul_f32 v125, v125, v127
    v_cvt_pk_bf16_f32 v124, v124, v125
    v_lshlrev_b32 v114, 16, v124
    v_and_b32 v115, s3, v124
    s_waitcnt vmcnt(19)
    v_lshlrev_b32 v124, 16, v16
    v_and_b32 v125, s3, v16
    v_lshlrev_b32 v126, 16, v17
    v_and_b32 v127, s3, v17
    v_lshlrev_b32 v128, 16, v18
    v_and_b32 v129, s3, v18
    v_lshlrev_b32 v130, 16, v19
    v_and_b32 v131, s3, v19
    v_pk_mul_f32 v[116:117], v[124:125], v[96:97] op_sel:[0,0] op_sel_hi:[1,0]
    v_pk_mul_f32 v[118:119], v[126:127], v[96:97] op_sel:[0,0] op_sel_hi:[1,0]
    v_pk_mul_f32 v[120:121], v[128:129], v[96:97] op_sel:[0,0] op_sel_hi:[1,0]
    v_pk_mul_f32 v[122:123], v[130:131], v[96:97] op_sel:[0,0] op_sel_hi:[1,0]
    s_waitcnt vmcnt(18)
    v_lshlrev_b32 v124, 16, v20
    v_and_b32 v125, s3, v20
    v_lshlrev_b32 v126, 16, v21
    v_and_b32 v127, s3, v21
    v_lshlrev_b32 v128, 16, v22
    v_and_b32 v129, s3, v22
    v_lshlrev_b32 v130, 16, v23
    v_and_b32 v131, s3, v23
    v_pk_fma_f32 v[116:117], v[124:125], v[96:97], v[116:117] op_sel:[0,1,0] op_sel_hi:[1,1,1]
    v_pk_fma_f32 v[118:119], v[126:127], v[96:97], v[118:119] op_sel:[0,1,0] op_sel_hi:[1,1,1]
    v_pk_fma_f32 v[120:121], v[128:129], v[96:97], v[120:121] op_sel:[0,1,0] op_sel_hi:[1,1,1]
    v_pk_fma_f32 v[122:123], v[130:131], v[96:97], v[122:123] op_sel:[0,1,0] op_sel_hi:[1,1,1]
    s_waitcnt vmcnt(17)
    v_lshlrev_b32 v124, 16, v24
    v_and_b32 v125, s3, v24
    v_lshlrev_b32 v126, 16, v25
    v_and_b32 v127, s3, v25
    v_lshlrev_b32 v128, 16, v26
    v_and_b32 v129, s3, v26
    v_lshlrev_b32 v130, 16, v27
    v_and_b32 v131, s3, v27
    v_pk_fma_f32 v[116:117], v[124:125], v[98:99], v[116:117] op_sel:[0,0,0] op_sel_hi:[1,0,1]
    v_pk_fma_f32 v[118:119], v[126:127], v[98:99], v[118:119] op_sel:[0,0,0] op_sel_hi:[1,0,1]
    v_pk_fma_f32 v[120:121], v[128:129], v[98:99], v[120:121] op_sel:[0,0,0] op_sel_hi:[1,0,1]
    v_pk_fma_f32 v[122:123], v[130:131], v[98:99], v[122:123] op_sel:[0,0,0] op_sel_hi:[1,0,1]
    s_waitcnt vmcnt(16)
    v_lshlrev_b32 v124, 16, v28
    v_and_b32 v125, s3, v28
    v_lshlrev_b32 v126, 16, v29
    v_and_b32 v127, s3, v29
    v_lshlrev_b32 v128, 16, v30
    v_and_b32 v129, s3, v30
    v_lshlrev_b32 v130, 16, v31
    v_and_b32 v131, s3, v31
    v_pk_fma_f32 v[116:117], v[124:125], v[98:99], v[116:117] op_sel:[0,1,0] op_sel_hi:[1,1,1]
    v_pk_fma_f32 v[118:119], v[126:127], v[98:99], v[118:119] op_sel:[0,1,0] op_sel_hi:[1,1,1]
    v_pk_fma_f32 v[120:121], v[128:129], v[98:99], v[120:121] op_sel:[0,1,0] op_sel_hi:[1,1,1]
    v_pk_fma_f32 v[122:123], v[130:131], v[98:99], v[122:123] op_sel:[0,1,0] op_sel_hi:[1,1,1]
    s_waitcnt vmcnt(15)
    v_lshlrev_b32 v124, 16, v32
    v_and_b32 v125, s3, v32
    v_lshlrev_b32 v126, 16, v33
    v_and_b32 v127, s3, v33
    v_lshlrev_b32 v128, 16, v34
    v_and_b32 v129, s3, v34
    v_lshlrev_b32 v130, 16, v35
    v_and_b32 v131, s3, v35
    v_pk_fma_f32 v[116:117], v[124:125], v[100:101], v[116:117] op_sel:[0,0,0] op_sel_hi:[1,0,1]
    v_pk_fma_f32 v[118:119], v[126:127], v[100:101], v[118:119] op_sel:[0,0,0] op_sel_hi:[1,0,1]
    v_pk_fma_f32 v[120:121], v[128:129], v[100:101], v[120:121] op_sel:[0,0,0] op_sel_hi:[1,0,1]
    v_pk_fma_f32 v[122:123], v[130:131], v[100:101], v[122:123] op_sel:[0,0,0] op_sel_hi:[1,0,1]
    s_waitcnt vmcnt(14)
    v_lshlrev_b32 v124, 16, v36
    v_and_b32 v125, s3, v36
    v_lshlrev_b32 v126, 16, v37
    v_and_b32 v127, s3, v37
    v_lshlrev_b32 v128, 16, v38
    v_and_b32 v129, s3, v38
    v_lshlrev_b32 v130, 16, v39
    v_and_b32 v131, s3, v39
    v_pk_fma_f32 v[116:117], v[124:125], v[100:101], v[116:117] op_sel:[0,1,0] op_sel_hi:[1,1,1]
    v_pk_fma_f32 v[118:119], v[126:127], v[100:101], v[118:119] op_sel:[0,1,0] op_sel_hi:[1,1,1]
    v_pk_fma_f32 v[120:121], v[128:129], v[100:101], v[120:121] op_sel:[0,1,0] op_sel_hi:[1,1,1]
    v_pk_fma_f32 v[122:123], v[130:131], v[100:101], v[122:123] op_sel:[0,1,0] op_sel_hi:[1,1,1]
    s_waitcnt vmcnt(13)
    v_lshlrev_b32 v124, 16, v40
    v_and_b32 v125, s3, v40
    v_lshlrev_b32 v126, 16, v41
    v_and_b32 v127, s3, v41
    v_lshlrev_b32 v128, 16, v42
    v_and_b32 v129, s3, v42
    v_lshlrev_b32 v130, 16, v43
    v_and_b32 v131, s3, v43
    v_pk_fma_f32 v[116:117], v[124:125], v[102:103], v[116:117] op_sel:[0,0,0] op_sel_hi:[1,0,1]
    v_pk_fma_f32 v[118:119], v[126:127], v[102:103], v[118:119] op_sel:[0,0,0] op_sel_hi:[1,0,1]
    v_pk_fma_f32 v[120:121], v[128:129], v[102:103], v[120:121] op_sel:[0,0,0] op_sel_hi:[1,0,1]
    v_pk_fma_f32 v[122:123], v[130:131], v[102:103], v[122:123] op_sel:[0,0,0] op_sel_hi:[1,0,1]
    s_waitcnt vmcnt(12)
    v_lshlrev_b32 v124, 16, v44
    v_and_b32 v125, s3, v44
    v_lshlrev_b32 v126, 16, v45
    v_and_b32 v127, s3, v45
    v_lshlrev_b32 v128, 16, v46
    v_and_b32 v129, s3, v46
    v_lshlrev_b32 v130, 16, v47
    v_and_b32 v131, s3, v47
    v_pk_fma_f32 v[116:117], v[124:125], v[102:103], v[116:117] op_sel:[0,1,0] op_sel_hi:[1,1,1]
    v_pk_fma_f32 v[118:119], v[126:127], v[102:103], v[118:119] op_sel:[0,1,0] op_sel_hi:[1,1,1]
    v_pk_fma_f32 v[120:121], v[128:129], v[102:103], v[120:121] op_sel:[0,1,0] op_sel_hi:[1,1,1]
    v_pk_fma_f32 v[122:123], v[130:131], v[102:103], v[122:123] op_sel:[0,1,0] op_sel_hi:[1,1,1]
    s_waitcnt vmcnt(11)
    v_lshlrev_b32 v124, 16, v48
    v_and_b32 v125, s3, v48
    v_lshlrev_b32 v126, 16, v49
    v_and_b32 v127, s3, v49
    v_lshlrev_b32 v128, 16, v50
    v_and_b32 v129, s3, v50
    v_lshlrev_b32 v130, 16, v51
    v_and_b32 v131, s3, v51
    v_pk_fma_f32 v[116:117], v[124:125], v[104:105], v[116:117] op_sel:[0,0,0] op_sel_hi:[1,0,1]
    v_pk_fma_f32 v[118:119], v[126:127], v[104:105], v[118:119] op_sel:[0,0,0] op_sel_hi:[1,0,1]
    v_pk_fma_f32 v[120:121], v[128:129], v[104:105], v[120:121] op_sel:[0,0,0] op_sel_hi:[1,0,1]
    v_pk_fma_f32 v[122:123], v[130:131], v[104:105], v[122:123] op_sel:[0,0,0] op_sel_hi:[1,0,1]
    s_waitcnt vmcnt(10)
    v_lshlrev_b32 v124, 16, v52
    v_and_b32 v125, s3, v52
    v_lshlrev_b32 v126, 16, v53
    v_and_b32 v127, s3, v53
    v_lshlrev_b32 v128, 16, v54
    v_and_b32 v129, s3, v54
    v_lshlrev_b32 v130, 16, v55
    v_and_b32 v131, s3, v55
    v_pk_fma_f32 v[116:117], v[124:125], v[104:105], v[116:117] op_sel:[0,1,0] op_sel_hi:[1,1,1]
    v_pk_fma_f32 v[118:119], v[126:127], v[104:105], v[118:119] op_sel:[0,1,0] op_sel_hi:[1,1,1]
    v_pk_fma_f32 v[120:121], v[128:129], v[104:105], v[120:121] op_sel:[0,1,0] op_sel_hi:[1,1,1]
    v_pk_fma_f32 v[122:123], v[130:131], v[104:105], v[122:123] op_sel:[0,1,0] op_sel_hi:[1,1,1]
    s_waitcnt vmcnt(9)
    v_lshlrev_b32 v124, 16, v56
    v_and_b32 v125, s3, v56
    v_lshlrev_b32 v126, 16, v57
    v_and_b32 v127, s3, v57
    v_lshlrev_b32 v128, 16, v58
    v_and_b32 v129, s3, v58
    v_lshlrev_b32 v130, 16, v59
    v_and_b32 v131, s3, v59
    v_pk_fma_f32 v[116:117], v[124:125], v[106:107], v[116:117] op_sel:[0,0,0] op_sel_hi:[1,0,1]
    v_pk_fma_f32 v[118:119], v[126:127], v[106:107], v[118:119] op_sel:[0,0,0] op_sel_hi:[1,0,1]
    v_pk_fma_f32 v[120:121], v[128:129], v[106:107], v[120:121] op_sel:[0,0,0] op_sel_hi:[1,0,1]
    v_pk_fma_f32 v[122:123], v[130:131], v[106:107], v[122:123] op_sel:[0,0,0] op_sel_hi:[1,0,1]
    s_waitcnt vmcnt(8)
    v_lshlrev_b32 v124, 16, v60
    v_and_b32 v125, s3, v60
    v_lshlrev_b32 v126, 16, v61
    v_and_b32 v127, s3, v61
    v_lshlrev_b32 v128, 16, v62
    v_and_b32 v129, s3, v62
    v_lshlrev_b32 v130, 16, v63
    v_and_b32 v131, s3, v63
    v_pk_fma_f32 v[116:117], v[124:125], v[106:107], v[116:117] op_sel:[0,1,0] op_sel_hi:[1,1,1]
    v_pk_fma_f32 v[118:119], v[126:127], v[106:107], v[118:119] op_sel:[0,1,0] op_sel_hi:[1,1,1]
    v_pk_fma_f32 v[120:121], v[128:129], v[106:107], v[120:121] op_sel:[0,1,0] op_sel_hi:[1,1,1]
    v_pk_fma_f32 v[122:123], v[130:131], v[106:107], v[122:123] op_sel:[0,1,0] op_sel_hi:[1,1,1]
    s_waitcnt vmcnt(7)
    v_lshlrev_b32 v124, 16, v64
    v_and_b32 v125, s3, v64
    v_lshlrev_b32 v126, 16, v65
    v_and_b32 v127, s3, v65
    v_lshlrev_b32 v128, 16, v66
    v_and_b32 v129, s3, v66
    v_lshlrev_b32 v130, 16, v67
    v_and_b32 v131, s3, v67
    v_pk_fma_f32 v[116:117], v[124:125], v[108:109], v[116:117] op_sel:[0,0,0] op_sel_hi:[1,0,1]
    v_pk_fma_f32 v[118:119], v[126:127], v[108:109], v[118:119] op_sel:[0,0,0] op_sel_hi:[1,0,1]
    v_pk_fma_f32 v[120:121], v[128:129], v[108:109], v[120:121] op_sel:[0,0,0] op_sel_hi:[1,0,1]
    v_pk_fma_f32 v[122:123], v[130:131], v[108:109], v[122:123] op_sel:[0,0,0] op_sel_hi:[1,0,1]
    s_waitcnt vmcnt(6)
    v_lshlrev_b32 v124, 16, v68
    v_and_b32 v125, s3, v68
    v_lshlrev_b32 v126, 16, v69
    v_and_b32 v127, s3, v69
    v_lshlrev_b32 v128, 16, v70
    v_and_b32 v129, s3, v70
    v_lshlrev_b32 v130, 16, v71
    v_and_b32 v131, s3, v71
    v_pk_fma_f32 v[116:117], v[124:125], v[108:109], v[116:117] op_sel:[0,1,0] op_sel_hi:[1,1,1]
    v_pk_fma_f32 v[118:119], v[126:127], v[108:109], v[118:119] op_sel:[0,1,0] op_sel_hi:[1,1,1]
    v_pk_fma_f32 v[120:121], v[128:129], v[108:109], v[120:121] op_sel:[0,1,0] op_sel_hi:[1,1,1]
    v_pk_fma_f32 v[122:123], v[130:131], v[108:109], v[122:123] op_sel:[0,1,0] op_sel_hi:[1,1,1]
    s_waitcnt vmcnt(5)
    v_lshlrev_b32 v124, 16, v72
    v_and_b32 v125, s3, v72
    v_lshlrev_b32 v126, 16, v73
    v_and_b32 v127, s3, v73
    v_lshlrev_b32 v128, 16, v74
    v_and_b32 v129, s3, v74
    v_lshlrev_b32 v130, 16, v75
    v_and_b32 v131, s3, v75
    v_pk_fma_f32 v[116:117], v[124:125], v[110:111], v[116:117] op_sel:[0,0,0] op_sel_hi:[1,0,1]
    v_pk_fma_f32 v[118:119], v[126:127], v[110:111], v[118:119] op_sel:[0,0,0] op_sel_hi:[1,0,1]
    v_pk_fma_f32 v[120:121], v[128:129], v[110:111], v[120:121] op_sel:[0,0,0] op_sel_hi:[1,0,1]
    v_pk_fma_f32 v[122:123], v[130:131], v[110:111], v[122:123] op_sel:[0,0,0] op_sel_hi:[1,0,1]
    s_waitcnt vmcnt(4)
    v_lshlrev_b32 v124, 16, v76
    v_and_b32 v125, s3, v76
    v_lshlrev_b32 v126, 16, v77
    v_and_b32 v127, s3, v77
    v_lshlrev_b32 v128, 16, v78
    v_and_b32 v129, s3, v78
    v_lshlrev_b32 v130, 16, v79
    v_and_b32 v131, s3, v79
    v_pk_fma_f32 v[116:117], v[124:125], v[110:111], v[116:117] op_sel:[0,1,0] op_sel_hi:[1,1,1]
    v_pk_fma_f32 v[118:119], v[126:127], v[110:111], v[118:119] op_sel:[0,1,0] op_sel_hi:[1,1,1]
    v_pk_fma_f32 v[120:121], v[128:129], v[110:111], v[120:121] op_sel:[0,1,0] op_sel_hi:[1,1,1]
    v_pk_fma_f32 v[122:123], v[130:131], v[110:111], v[122:123] op_sel:[0,1,0] op_sel_hi:[1,1,1]
    s_waitcnt vmcnt(3)
    v_lshlrev_b32 v124, 16, v80
    v_and_b32 v125, s3, v80
    v_lshlrev_b32 v126, 16, v81
    v_and_b32 v127, s3, v81
    v_lshlrev_b32 v128, 16, v82
    v_and_b32 v129, s3, v82
    v_lshlrev_b32 v130, 16, v83
    v_and_b32 v131, s3, v83
    v_pk_fma_f32 v[116:117], v[124:125], v[112:113], v[116:117] op_sel:[0,0,0] op_sel_hi:[1,0,1]
    v_pk_fma_f32 v[118:119], v[126:127], v[112:113], v[118:119] op_sel:[0,0,0] op_sel_hi:[1,0,1]
    v_pk_fma_f32 v[120:121], v[128:129], v[112:113], v[120:121] op_sel:[0,0,0] op_sel_hi:[1,0,1]
    v_pk_fma_f32 v[122:123], v[130:131], v[112:113], v[122:123] op_sel:[0,0,0] op_sel_hi:[1,0,1]
    s_waitcnt vmcnt(2)
    v_lshlrev_b32 v124, 16, v84
    v_and_b32 v125, s3, v84
    v_lshlrev_b32 v126, 16, v85
    v_and_b32 v127, s3, v85
    v_lshlrev_b32 v128, 16, v86
    v_and_b32 v129, s3, v86
    v_lshlrev_b32 v130, 16, v87
    v_and_b32 v131, s3, v87
    v_pk_fma_f32 v[116:117], v[124:125], v[112:113], v[116:117] op_sel:[0,1,0] op_sel_hi:[1,1,1]
    v_pk_fma_f32 v[118:119], v[126:127], v[112:113], v[118:119] op_sel:[0,1,0] op_sel_hi:[1,1,1]
    v_pk_fma_f32 v[120:121], v[128:129], v[112:113], v[120:121] op_sel:[0,1,0] op_sel_hi:[1,1,1]
    v_pk_fma_f32 v[122:123], v[130:131], v[112:113], v[122:123] op_sel:[0,1,0] op_sel_hi:[1,1,1]
    s_waitcnt vmcnt(1)
    v_lshlrev_b32 v124, 16, v88
    v_and_b32 v125, s3, v88
    v_lshlrev_b32 v126, 16, v89
    v_and_b32 v127, s3, v89
    v_lshlrev_b32 v128, 16, v90
    v_and_b32 v129, s3, v90
    v_lshlrev_b32 v130, 16, v91
    v_and_b32 v131, s3, v91
    v_pk_fma_f32 v[116:117], v[124:125], v[114:115], v[116:117] op_sel:[0,0,0] op_sel_hi:[1,0,1]
    v_pk_fma_f32 v[118:119], v[126:127], v[114:115], v[118:119] op_sel:[0,0,0] op_sel_hi:[1,0,1]
    v_pk_fma_f32 v[120:121], v[128:129], v[114:115], v[120:121] op_sel:[0,0,0] op_sel_hi:[1,0,1]
    v_pk_fma_f32 v[122:123], v[130:131], v[114:115], v[122:123] op_sel:[0,0,0] op_sel_hi:[1,0,1]
    s_waitcnt vmcnt(0)
    v_lshlrev_b32 v124, 16, v92
    v_and_b32 v125, s3, v92
    v_lshlrev_b32 v126, 16, v93
    v_and_b32 v127, s3, v93
    v_lshlrev_b32 v128, 16, v94
    v_and_b32 v129, s3, v94
    v_lshlrev_b32 v130, 16, v95
    v_and_b32 v131, s3, v95
    v_pk_fma_f32 v[116:117], v[124:125], v[114:115], v[116:117] op_sel:[0,1,0] op_sel_hi:[1,1,1]
    v_pk_fma_f32 v[118:119], v[126:127], v[114:115], v[118:119] op_sel:[0,1,0] op_sel_hi:[1,1,1]
    v_pk_fma_f32 v[120:121], v[128:129], v[114:115], v[120:121] op_sel:[0,1,0] op_sel_hi:[1,1,1]
    v_pk_fma_f32 v[122:123], v[130:131], v[114:115], v[122:123] op_sel:[0,1,0] op_sel_hi:[1,1,1]
    v_lshlrev_b32 v5, 5, v0
    ds_write_b128 v5, v[116:119]
    ds_write_b128 v5, v[120:123] offset:16
    s_waitcnt lgkmcnt(0)
    s_barrier
    v_lshrrev_b32 v5, 6, v0
    s_nop 0
    v_readfirstlane_b32 s17, v5
    s_nop 0
    s_cmp_lg_u32 s17, 0
    s_cbranch_scc1 L_k0_gemv_done_6
    v_lshlrev_b32 v5, 2, v0
    ds_read2st64_b32 v[16:17], v5 offset0:0 offset1:1
    ds_read2st64_b32 v[20:21], v5 offset0:2 offset1:3
    ds_read2st64_b32 v[24:25], v5 offset0:4 offset1:5
    ds_read2st64_b32 v[28:29], v5 offset0:6 offset1:7
    ds_read2st64_b32 v[32:33], v5 offset0:8 offset1:9
    ds_read2st64_b32 v[36:37], v5 offset0:10 offset1:11
    ds_read2st64_b32 v[40:41], v5 offset0:12 offset1:13
    ds_read2st64_b32 v[44:45], v5 offset0:14 offset1:15
    ds_read2st64_b32 v[48:49], v5 offset0:16 offset1:17
    ds_read2st64_b32 v[52:53], v5 offset0:18 offset1:19
    ds_read2st64_b32 v[56:57], v5 offset0:20 offset1:21
    ds_read2st64_b32 v[60:61], v5 offset0:22 offset1:23
    ds_read2st64_b32 v[64:65], v5 offset0:24 offset1:25
    ds_read2st64_b32 v[68:69], v5 offset0:26 offset1:27
    ds_read2st64_b32 v[72:73], v5 offset0:28 offset1:29
    ds_read2st64_b32 v[76:77], v5 offset0:30 offset1:31
    s_waitcnt lgkmcnt(14)
    v_pk_add_f32 v[16:17], v[16:17], v[20:21]
    s_waitcnt lgkmcnt(13)
    v_pk_add_f32 v[16:17], v[16:17], v[24:25]
    s_waitcnt lgkmcnt(12)
    v_pk_add_f32 v[16:17], v[16:17], v[28:29]
    s_waitcnt lgkmcnt(11)
    v_pk_add_f32 v[16:17], v[16:17], v[32:33]
    s_waitcnt lgkmcnt(10)
    v_pk_add_f32 v[16:17], v[16:17], v[36:37]
    s_waitcnt lgkmcnt(9)
    v_pk_add_f32 v[16:17], v[16:17], v[40:41]
    s_waitcnt lgkmcnt(8)
    v_pk_add_f32 v[16:17], v[16:17], v[44:45]
    s_waitcnt lgkmcnt(7)
    v_pk_add_f32 v[16:17], v[16:17], v[48:49]
    s_waitcnt lgkmcnt(6)
    v_pk_add_f32 v[16:17], v[16:17], v[52:53]
    s_waitcnt lgkmcnt(5)
    v_pk_add_f32 v[16:17], v[16:17], v[56:57]
    s_waitcnt lgkmcnt(4)
    v_pk_add_f32 v[16:17], v[16:17], v[60:61]
    s_waitcnt lgkmcnt(3)
    v_pk_add_f32 v[16:17], v[16:17], v[64:65]
    s_waitcnt lgkmcnt(2)
    v_pk_add_f32 v[16:17], v[16:17], v[68:69]
    s_waitcnt lgkmcnt(1)
    v_pk_add_f32 v[16:17], v[16:17], v[72:73]
    s_waitcnt lgkmcnt(0)
    v_pk_add_f32 v[16:17], v[16:17], v[76:77]
    v_add_f32 v124, v16, v17
    v_cvt_pk_bf16_f32 v124, v124, v124
    v_lshlrev_b32 v124, 16, v124
    s_cmp_ge_u32 s16, 30
    s_cselect_b32 s17, 30, 0
    s_sub_u32 s17, s16, s17
    s_sub_u32 s17, s17, 10
    s_cmp_lt_u32 s17, 10
    s_cselect_b32 s17, 1.0, 0
    v_add_f32 v124, s17, v124
    v_cvt_pk_bf16_f32 v124, v124, v124
    v_lshlrev_b32 v124, 16, v124
    s_lshl_b32 s17, s16, 8
    buffer_store_dword v124, v5, s[4:7], s17 offen offset:0
L_k0_gemv_done_6:
    s_branch L_k0_fin_5
L_k0_stats_3:
    s_cmp_ge_u32 s2, 252
    s_cbranch_scc1 L_k0_gran_4
    s_load_dwordx2 s[8:9], s[0:1], 0
    s_mov_b32 s10, 2621440
    s_mov_b32 s11, 0x20000
    s_sub_u32 s16, s2, 220
    s_mul_i32 s17, s16, 81920
    s_add_u32 s18, s17, 5120
    s_add_u32 s19, s17, 10240
    s_add_u32 s20, s17, 15360
    s_mov_b32 s22, 0x3f803f80
    v_lshrrev_b32 v2, 6, v0
    v_bfe_u32 v4, v0, 4, 2
    v_lshl_add_u32 v1, v2, 4, v4
    v_mul_u32_u24 v1, 1280, v1
    v_and_b32 v3, 15, v0
    v_lshl_add_u32 v1, v3, 4, v1
    s_waitcnt lgkmcnt(0)
    buffer_load_dwordx4 v[6:9], v1, s[8:11], s17 offen offset:0
    buffer_load_dwordx4 v[10:13], v1, s[8:11], s17 offen offset:256
    buffer_load_dwordx4 v[14:17], v1, s[8:11], s17 offen offset:512
    buffer_load_dwordx4 v[18:21], v1, s[8:11], s17 offen offset:768
    buffer_load_dwordx4 v[22:25], v1, s[8:11], s17 offen offset:1024
    buffer_load_dwordx4 v[26:29], v1, s[8:11], s18 offen offset:0
    buffer_load_dwordx4 v[30:33], v1, s[8:11], s18 offen offset:256
    buffer_load_dwordx4 v[34:37], v1, s[8:11], s18 offen offset:512
    buffer_load_dwordx4 v[38:41], v1, s[8:11], s18 offen offset:768
    buffer_load_dwordx4 v[42:45], v1, s[8:11], s18 offen offset:1024
    buffer_load_dwordx4 v[46:49], v1, s[8:11], s19 offen offset:0
    buffer_load_dwordx4 v[50:53], v1, s[8:11], s19 offen offset:256
    buffer_load_dwordx4 v[54:57], v1, s[8:11], s19 offen offset:512
    buffer_load_dwordx4 v[58:61], v1, s[8:11], s19 offen offset:768
    buffer_load_dwordx4 v[62:65], v1, s[8:11], s19 offen offset:1024
    buffer_load_dwordx4 v[66:69], v1, s[8:11], s20 offen offset:0
    buffer_load_dwordx4 v[70:73], v1, s[8:11], s20 offen offset:256
    buffer_load_dwordx4 v[74:77], v1, s[8:11], s20 offen offset:512
    buffer_load_dwordx4 v[78:81], v1, s[8:11], s20 offen offset:768
    buffer_load_dwordx4 v[82:85], v1, s[8:11], s20 offen offset:1024
    v_cmp_eq_u32 vcc, 0, v3
    v_lshrrev_b32 v3, 1, v2
    v_lshlrev_b32 v3, 8, v3
    v_and_b32 v2, 1, v2
    v_lshl_add_u32 v3, v2, 6, v3
    v_and_b32 v2, 1, v4
    v_lshl_add_u32 v3, v2, 7, v3
    v_lshrrev_b32 v2, 1, v4
    v_lshl_add_u32 v3, v2, 2, v3
    s_lshl_b32 s17, s16, 9
    s_add_u32 s17, s17, 16384
    v_mov_b32 v86, 0
    v_mov_b32 v90, 0
    v_mov_b32 v87, 0
    v_mov_b32 v91, 0
    v_mov_b32 v88, 0
    v_mov_b32 v92, 0
    v_mov_b32 v89, 0
    v_mov_b32 v93, 0
    s_waitcnt vmcnt(19)
    v_dot2c_f32_bf16 v86, s22, v6
    v_dot2c_f32_bf16 v90, v6, v6
    v_dot2c_f32_bf16 v86, s22, v7
    v_dot2c_f32_bf16 v90, v7, v7
    v_dot2c_f32_bf16 v86, s22, v8
    v_dot2c_f32_bf16 v90, v8, v8
    v_dot2c_f32_bf16 v86, s22, v9
    v_dot2c_f32_bf16 v90, v9, v9
    s_waitcnt vmcnt(18)
    v_dot2c_f32_bf16 v86, s22, v10
    v_dot2c_f32_bf16 v90, v10, v10
    v_dot2c_f32_bf16 v86, s22, v11
    v_dot2c_f32_bf16 v90, v11, v11
    v_dot2c_f32_bf16 v86, s22, v12
    v_dot2c_f32_bf16 v90, v12, v12
    v_dot2c_f32_bf16 v86, s22, v13
    v_dot2c_f32_bf16 v90, v13, v13
    s_waitcnt vmcnt(17)
    v_dot2c_f32_bf16 v86, s22, v14
    v_dot2c_f32_bf16 v90, v14, v14
    v_dot2c_f32_bf16 v86, s22, v15
    v_dot2c_f32_bf16 v90, v15, v15
    v_dot2c_f32_bf16 v86, s22, v16
    v_dot2c_f32_bf16 v90, v16, v16
    v_dot2c_f32_bf16 v86, s22, v17
    v_dot2c_f32_bf16 v90, v17, v17
    s_waitcnt vmcnt(16)
    v_dot2c_f32_bf16 v86, s22, v18
    v_dot2c_f32_bf16 v90, v18, v18
    v_dot2c_f32_bf16 v86, s22, v19
    v_dot2c_f32_bf16 v90, v19, v19
    v_dot2c_f32_bf16 v86, s22, v20
    v_dot2c_f32_bf16 v90, v20, v20
    v_dot2c_f32_bf16 v86, s22, v21
    v_dot2c_f32_bf16 v90, v21, v21
    s_waitcnt vmcnt(15)
    v_dot2c_f32_bf16 v86, s22, v22
    v_dot2c_f32_bf16 v90, v22, v22
    v_dot2c_f32_bf16 v86, s22, v23
    v_dot2c_f32_bf16 v90, v23, v23
    v_dot2c_f32_bf16 v86, s22, v24
    v_dot2c_f32_bf16 v90, v24, v24
    v_dot2c_f32_bf16 v86, s22, v25
    v_dot2c_f32_bf16 v90, v25, v25
    s_waitcnt vmcnt(14)
    v_dot2c_f32_bf16 v87, s22, v26
    v_dot2c_f32_bf16 v91, v26, v26
    v_dot2c_f32_bf16 v87, s22, v27
    v_dot2c_f32_bf16 v91, v27, v27
    v_dot2c_f32_bf16 v87, s22, v28
    v_dot2c_f32_bf16 v91, v28, v28
    v_dot2c_f32_bf16 v87, s22, v29
    v_dot2c_f32_bf16 v91, v29, v29
    s_waitcnt vmcnt(13)
    v_dot2c_f32_bf16 v87, s22, v30
    v_dot2c_f32_bf16 v91, v30, v30
    v_dot2c_f32_bf16 v87, s22, v31
    v_dot2c_f32_bf16 v91, v31, v31
    v_dot2c_f32_bf16 v87, s22, v32
    v_dot2c_f32_bf16 v91, v32, v32
    v_dot2c_f32_bf16 v87, s22, v33
    v_dot2c_f32_bf16 v91, v33, v33
    s_waitcnt vmcnt(12)
    v_dot2c_f32_bf16 v87, s22, v34
    v_dot2c_f32_bf16 v91, v34, v34
    v_dot2c_f32_bf16 v87, s22, v35
    v_dot2c_f32_bf16 v91, v35, v35
    v_dot2c_f32_bf16 v87, s22, v36
    v_dot2c_f32_bf16 v91, v36, v36
    v_dot2c_f32_bf16 v87, s22, v37
    v_dot2c_f32_bf16 v91, v37, v37
    s_waitcnt vmcnt(11)
    v_dot2c_f32_bf16 v87, s22, v38
    v_dot2c_f32_bf16 v91, v38, v38
    v_dot2c_f32_bf16 v87, s22, v39
    v_dot2c_f32_bf16 v91, v39, v39
    v_dot2c_f32_bf16 v87, s22, v40
    v_dot2c_f32_bf16 v91, v40, v40
    v_dot2c_f32_bf16 v87, s22, v41
    v_dot2c_f32_bf16 v91, v41, v41
    s_waitcnt vmcnt(10)
    v_dot2c_f32_bf16 v87, s22, v42
    v_dot2c_f32_bf16 v91, v42, v42
    v_dot2c_f32_bf16 v87, s22, v43
    v_dot2c_f32_bf16 v91, v43, v43
    v_dot2c_f32_bf16 v87, s22, v44
    v_dot2c_f32_bf16 v91, v44, v44
    v_dot2c_f32_bf16 v87, s22, v45
    v_dot2c_f32_bf16 v91, v45, v45
    s_waitcnt vmcnt(9)
    v_dot2c_f32_bf16 v88, s22, v46
    v_dot2c_f32_bf16 v92, v46, v46
    v_dot2c_f32_bf16 v88, s22, v47
    v_dot2c_f32_bf16 v92, v47, v47
    v_dot2c_f32_bf16 v88, s22, v48
    v_dot2c_f32_bf16 v92, v48, v48
    v_dot2c_f32_bf16 v88, s22, v49
    v_dot2c_f32_bf16 v92, v49, v49
    s_waitcnt vmcnt(8)
    v_dot2c_f32_bf16 v88, s22, v50
    v_dot2c_f32_bf16 v92, v50, v50
    v_dot2c_f32_bf16 v88, s22, v51
    v_dot2c_f32_bf16 v92, v51, v51
    v_dot2c_f32_bf16 v88, s22, v52
    v_dot2c_f32_bf16 v92, v52, v52
    v_dot2c_f32_bf16 v88, s22, v53
    v_dot2c_f32_bf16 v92, v53, v53
    s_waitcnt vmcnt(7)
    v_dot2c_f32_bf16 v88, s22, v54
    v_dot2c_f32_bf16 v92, v54, v54
    v_dot2c_f32_bf16 v88, s22, v55
    v_dot2c_f32_bf16 v92, v55, v55
    v_dot2c_f32_bf16 v88, s22, v56
    v_dot2c_f32_bf16 v92, v56, v56
    v_dot2c_f32_bf16 v88, s22, v57
    v_dot2c_f32_bf16 v92, v57, v57
    s_waitcnt vmcnt(6)
    v_dot2c_f32_bf16 v88, s22, v58
    v_dot2c_f32_bf16 v92, v58, v58
    v_dot2c_f32_bf16 v88, s22, v59
    v_dot2c_f32_bf16 v92, v59, v59
    v_dot2c_f32_bf16 v88, s22, v60
    v_dot2c_f32_bf16 v92, v60, v60
    v_dot2c_f32_bf16 v88, s22, v61
    v_dot2c_f32_bf16 v92, v61, v61
    s_waitcnt vmcnt(5)
    v_dot2c_f32_bf16 v88, s22, v62
    v_dot2c_f32_bf16 v92, v62, v62
    v_dot2c_f32_bf16 v88, s22, v63
    v_dot2c_f32_bf16 v92, v63, v63
    v_dot2c_f32_bf16 v88, s22, v64
    v_dot2c_f32_bf16 v92, v64, v64
    v_dot2c_f32_bf16 v88, s22, v65
    v_dot2c_f32_bf16 v92, v65, v65
    s_waitcnt vmcnt(4)
    v_dot2c_f32_bf16 v89, s22, v66
    v_dot2c_f32_bf16 v93, v66, v66
    v_dot2c_f32_bf16 v89, s22, v67
    v_dot2c_f32_bf16 v93, v67, v67
    v_dot2c_f32_bf16 v89, s22, v68
    v_dot2c_f32_bf16 v93, v68, v68
    v_dot2c_f32_bf16 v89, s22, v69
    v_dot2c_f32_bf16 v93, v69, v69
    s_waitcnt vmcnt(3)
    v_dot2c_f32_bf16 v89, s22, v70
    v_dot2c_f32_bf16 v93, v70, v70
    v_dot2c_f32_bf16 v89, s22, v71
    v_dot2c_f32_bf16 v93, v71, v71
    v_dot2c_f32_bf16 v89, s22, v72
    v_dot2c_f32_bf16 v93, v72, v72
    v_dot2c_f32_bf16 v89, s22, v73
    v_dot2c_f32_bf16 v93, v73, v73
    s_waitcnt vmcnt(2)
    v_dot2c_f32_bf16 v89, s22, v74
    v_dot2c_f32_bf16 v93, v74, v74
    v_dot2c_f32_bf16 v89, s22, v75
    v_dot2c_f32_bf16 v93, v75, v75
    v_dot2c_f32_bf16 v89, s22, v76
    v_dot2c_f32_bf16 v93, v76, v76
    v_dot2c_f32_bf16 v89, s22, v77
    v_dot2c_f32_bf16 v93, v77, v77
    s_waitcnt vmcnt(1)
    v_dot2c_f32_bf16 v89, s22, v78
    v_dot2c_f32_bf16 v93, v78, v78
    v_dot2c_f32_bf16 v89, s22, v79
    v_dot2c_f32_bf16 v93, v79, v79
    v_dot2c_f32_bf16 v89, s22, v80
    v_dot2c_f32_bf16 v93, v80, v80
    v_dot2c_f32_bf16 v89, s22, v81
    v_dot2c_f32_bf16 v93, v81, v81
    s_waitcnt vmcnt(0)
    v_dot2c_f32_bf16 v89, s22, v82
    v_dot2c_f32_bf16 v93, v82, v82
    v_dot2c_f32_bf16 v89, s22, v83
    v_dot2c_f32_bf16 v93, v83, v83
    v_dot2c_f32_bf16 v89, s22, v84
    v_dot2c_f32_bf16 v93, v84, v84
    v_dot2c_f32_bf16 v89, s22, v85
    v_dot2c_f32_bf16 v93, v85, v85
    v_add_f32_dpp v86, v86, v86 row_ror:8 row_mask:0xf bank_mask:0xf
    v_add_f32_dpp v90, v90, v90 row_ror:8 row_mask:0xf bank_mask:0xf
    v_add_f32_dpp v87, v87, v87 row_ror:8 row_mask:0xf bank_mask:0xf
    v_add_f32_dpp v91, v91, v91 row_ror:8 row_mask:0xf bank_mask:0xf
    v_add_f32_dpp v88, v88, v88 row_ror:8 row_mask:0xf bank_mask:0xf
    v_add_f32_dpp v92, v92, v92 row_ror:8 row_mask:0xf bank_mask:0xf
    v_add_f32_dpp v89, v89, v89 row_ror:8 row_mask:0xf bank_mask:0xf
    v_add_f32_dpp v93, v93, v93 row_ror:8 row_mask:0xf bank_mask:0xf
    v_add_f32_dpp v86, v86, v86 row_ror:4 row_mask:0xf bank_mask:0xf
    v_add_f32_dpp v90, v90, v90 row_ror:4 row_mask:0xf bank_mask:0xf
    v_add_f32_dpp v87, v87, v87 row_ror:4 row_mask:0xf bank_mask:0xf
    v_add_f32_dpp v91, v91, v91 row_ror:4 row_mask:0xf bank_mask:0xf
    v_add_f32_dpp v88, v88, v88 row_ror:4 row_mask:0xf bank_mask:0xf
    v_add_f32_dpp v92, v92, v92 row_ror:4 row_mask:0xf bank_mask:0xf
    v_add_f32_dpp v89, v89, v89 row_ror:4 row_mask:0xf bank_mask:0xf
    v_add_f32_dpp v93, v93, v93 row_ror:4 row_mask:0xf bank_mask:0xf
    v_add_f32_dpp v86, v86, v86 row_ror:2 row_mask:0xf bank_mask:0xf
    v_add_f32_dpp v90, v90, v90 row_ror:2 row_mask:0xf bank_mask:0xf
    v_add_f32_dpp v87, v87, v87 row_ror:2 row_mask:0xf bank_mask:0xf
    v_add_f32_dpp v91, v91, v91 row_ror:2 row_mask:0xf bank_mask:0xf
    v_add_f32_dpp v88, v88, v88 row_ror:2 row_mask:0xf bank_mask:0xf
    v_add_f32_dpp v92, v92, v92 row_ror:2 row_mask:0xf bank_mask:0xf
    v_add_f32_dpp v89, v89, v89 row_ror:2 row_mask:0xf bank_mask:0xf
    v_add_f32_dpp v93, v93, v93 row_ror:2 row_mask:0xf bank_mask:0xf
    v_add_f32_dpp v86, v86, v86 row_ror:1 row_mask:0xf bank_mask:0xf
    v_add_f32_dpp v90, v90, v90 row_ror:1 row_mask:0xf bank_mask:0xf
    v_add_f32_dpp v87, v87, v87 row_ror:1 row_mask:0xf bank_mask:0xf
    v_add_f32_dpp v91, v91, v91 row_ror:1 row_mask:0xf bank_mask:0xf
    v_add_f32_dpp v88, v88, v88 row_ror:1 row_mask:0xf bank_mask:0xf
    v_add_f32_dpp v92, v92, v92 row_ror:1 row_mask:0xf bank_mask:0xf
    v_add_f32_dpp v89, v89, v89 row_ror:1 row_mask:0xf bank_mask:0xf
    v_add_f32_dpp v93, v93, v93 row_ror:1 row_mask:0xf bank_mask:0xf
    v_mul_f32 v86, 0x3acccccd, v86
    v_mul_f32 v90, 0x3acccccd, v90
    v_mul_f32 v87, 0x3acccccd, v87
    v_mul_f32 v91, 0x3acccccd, v91
    v_mul_f32 v88, 0x3acccccd, v88
    v_mul_f32 v92, 0x3acccccd, v92
    v_mul_f32 v89, 0x3acccccd, v89
    v_mul_f32 v93, 0x3acccccd, v93
    v_fma_f32 v90, -v86, v86, v90
    v_max_f32 v90, 0, v90
    v_add_f32 v90, 0x3727c5ac, v90
    v_rsq_f32 v90, v90
    v_fma_f32 v91, -v87, v87, v91
    v_max_f32 v91, 0, v91
    v_add_f32 v91, 0x3727c5ac, v91
    v_rsq_f32 v91, v91
    v_fma_f32 v92, -v88, v88, v92
    v_max_f32 v92, 0, v92
    v_add_f32 v92, 0x3727c5ac, v92
    v_rsq_f32 v92, v92
    v_fma_f32 v93, -v89, v89, v93
    v_max_f32 v93, 0, v93
    v_add_f32 v93, 0x3727c5ac, v93
    v_rsq_f32 v93, v93
    v_mul_f32 v94, -v86, v90
    v_mul_f32 v95, -v87, v91
    v_mul_f32 v96, -v88, v92
    v_mul_f32 v97, -v89, v93
    s_and_b64 exec, exec, vcc
    buffer_store_dword v90, v3, s[4:7], s17 offen offset:0
    buffer_store_dword v94, v3, s[4:7], s17 offen offset:8
    buffer_store_dword v91, v3, s[4:7], s17 offen offset:16
    buffer_store_dword v95, v3, s[4:7], s17 offen offset:24
    buffer_store_dword v92, v3, s[4:7], s17 offen offset:32
    buffer_store_dword v96, v3, s[4:7], s17 offen offset:40
    buffer_store_dword v93, v3, s[4:7], s17 offen offset:48
    buffer_store_dword v97, v3, s[4:7], s17 offen offset:56
    s_branch L_k0_fin_5
L_k0_gran_4:
    s_sub_u32 s16, s2, 252
    s_lshl_b32 s16, s16, 15
    s_add_u32 s16, s16, 65536
    v_lshlrev_b32 v1, 4, v0
    v_mov_b32 v2, -1
    v_mov_b32 v3, -1
    v_mov_b32 v4, -1
    v_mov_b32 v5, -1
    s_waitcnt lgkmcnt(0)
    buffer_store_dwordx4 v[2:5], v1, s[4:7], s16 offen
    s_add_u32 s16, s16, 4096
    buffer_store_dwordx4 v[2:5], v1, s[4:7], s16 offen
    s_add_u32 s16, s16, 4096
    buffer_store_dwordx4 v[2:5], v1, s[4:7], s16 offen
    s_add_u32 s16, s16, 4096
    buffer_store_dwordx4 v[2:5], v1, s[4:7], s16 offen
    s_add_u32 s16, s16, 4096
    buffer_store_dwordx4 v[2:5], v1, s[4:7], s16 offen
    s_add_u32 s16, s16, 4096
    buffer_store_dwordx4 v[2:5], v1, s[4:7], s16 offen
    s_add_u32 s16, s16, 4096
    buffer_store_dwordx4 v[2:5], v1, s[4:7], s16 offen
    s_add_u32 s16, s16, 4096
    buffer_store_dwordx4 v[2:5], v1, s[4:7], s16 offen
L_k0_fin_5:
L_k0_end_1:
    s_endpgm
.globl k1_kernel
.p2align 8
.type k1_kernel,@function
k1_kernel:
    s_cmp_ge_u32 s2, 248
    s_cbranch_scc1 L_k1_end_1
    s_load_dwordx2 s[4:5], s[0:1], 120
    s_mov_b32 s6, 33554432
    s_mov_b32 s7, 0x20000
    s_mov_b32 s3, 0xffff0000
    s_cmp_ge_u32 s2, 160
    s_cbranch_scc1 L_k1_win_3
    s_load_dwordx2 s[8:9], s[0:1], 32
    s_mov_b32 s10, 2621440
    s_mov_b32 s11, 0x20000
    s_load_dwordx2 s[12:13], s[0:1], 40
    s_mov_b32 s14, 1280
    s_mov_b32 s15, 0x20000
    v_lshrrev_b32 v2, 6, v0
    s_nop 0
    v_readfirstlane_b32 s16, v2
    v_and_b32 v1, 63, v0
    s_lshl_b32 s17, s2, 2
    s_add_u32 s17, s17, s16
    s_mul_i32 s18, s16, 33024
    s_mul_i32 s19, s16, 4608
    s_add_u32 s19, s19, 132096
    s_lshl_b32 s20, s17, 12
    v_lshl_add_u32 v4, v1, 4, s20
    v_subrev_u32 v5, 16, v4
    v_cmp_eq_u32 vcc, 0, v1
    v_mov_b32 v2, 2147483648
    s_nop 0
    v_cndmask_b32 v5, v5, v2, vcc
    s_waitcnt lgkmcnt(0)
    buffer_load_dwordx4 v[6:9], v5, s[8:11], 0 offen
    buffer_load_dwordx4 v[10:13], v4, s[8:11], 0 offen offset:0
    buffer_load_dwordx4 v[14:17], v4, s[8:11], 0 offen offset:1008
    buffer_load_dwordx4 v[18:21], v4, s[8:11], 0 offen offset:1024
    buffer_load_dwordx4 v[22:25], v4, s[8:11], 0 offen offset:2032
    buffer_load_dwordx4 v[26:29], v4, s[8:11], 0 offen offset:2048
    buffer_load_dwordx4 v[30:33], v4, s[8:11], 0 offen offset:3056
    buffer_load_dwordx4 v[34:37], v4, s[8:11], 0 offen offset:3072
    s_lshl_b32 s21, s17, 1
    buffer_load_ushort v38, off, s[12:15], s21
    s_mov_b32 s21, 1048576
    s_add_u32 m0, s19, 256
    s_nop 0
    buffer_load_dwordx4 v4, s[4:7], s21 offen offset:0 lds
    buffer_load_dwordx4 v4, s[4:7], s21 offen offset:1024 lds
    s_add_u32 m0, s19, 512
    s_nop 0
    buffer_load_dwordx4 v4, s[4:7], s21 offen offset:2048 lds
    buffer_load_dwordx4 v4, s[4:7], s21 offen offset:3072 lds
    v_lshlrev_b32 v39, 4, v0
    s_lshl_b32 s21, s2, 14
    s_add_u32 s24, s21, 3670016
    s_add_u32 s28, s21, 6291456
    s_mov_b32 s32, 16384
    s_add_u32 s25, s21, 3674112
    s_add_u32 s29, s21, 6295552
    s_mov_b32 s33, 20480
    s_add_u32 s26, s21, 3678208
    s_add_u32 s30, s21, 6299648
    s_mov_b32 s34, 24576
    s_add_u32 s27, s21, 3682304
    s_add_u32 s31, s21, 6303744
    s_mov_b32 s35, 28672
    buffer_load_dwordx4 v[40:43], v39, s[4:7], s24 offen
    buffer_load_dwordx4 v[56:59], v39, s[4:7], s32 offen
    buffer_load_dwordx4 v[44:47], v39, s[4:7], s25 offen
    buffer_load_dwordx4 v[60:63], v39, s[4:7], s33 offen
    buffer_load_dwordx4 v[48:51], v39, s[4:7], s26 offen
    buffer_load_dwordx4 v[64:67], v39, s[4:7], s34 offen
    buffer_load_dwordx4 v[52:55], v39, s[4:7], s27 offen
    buffer_load_dwordx4 v[68:71], v39, s[4:7], s35 offen
    s_lshl_b32 s21, s2, 4
    s_add_u32 s22, s21, 5120
    buffer_load_dwordx4 v[72:75], off, s[4:7], s21 offset:0
    buffer_load_dwordx4 v[76:79], off, s[4:7], s21 offset:2560
    buffer_load_dwordx4 v[80:83], off, s[4:7], s22
    v_mov_b32 v84, 0
    v_mov_b32 v85, 0
    v_mov_b32 v86, 0
    v_mov_b32 v87, 0
    v_lshrrev_b32 v2, 4, v1
    v_mul_u32_u24 v2, 2304, v2
    v_and_b32 v3, 15, v1
    v_lshl_add_u32 v2, v3, 4, v2
    v_add_u32 v2, s19, v2
    v_and_b32 v3, 7, v1
    v_mul_u32_u24 v3, 4128, v3
    v_add_u32 v3, s18, v3
    v_cmp_lt_u32 vcc, 31, v1
    s_nop 1
    v_cndmask_b32 v2, v2, v3, vcc
    ds_write_b128 v2, v[84:87]
    v_lshrrev_b32 v88, 4, v1
    v_bfe_u32 v2, v1, 3, 1
    v_bfe_u32 v3, v1, 2, 1
    v_xor_b32 v3, v2, v3
    v_and_b32 v89, 3, v1
    v_lshl_add_u32 v89, v89, 1, v2
    v_mul_u32_u24 v91, 4128, v89
    v_lshl_add_u32 v91, v3, 4, v91
    v_lshl_add_u32 v89, v3, 3, v89
    v_and_b32 v2, 1, v88
    v_lshrrev_b32 v3, 1, v88
    v_lshl_add_u32 v90, v2, 1, v3
    v_mul_u32_u24 v92, 2304, v3
    v_and_b32 v3, 15, v1
    v_add_u32 v2, v2, v3
    v_lshl_add_u32 v92, v2, 4, v92
    s_add_u32 s21, s19, 240
    v_add_u32 v92, s21, v92
    v_sub_u32 v2, 3, v90
    v_lshl_add_u32 v91, v2, 4, v91
    v_add_u32 v91, s18, v91
    v_bfe_u32 v2, v1, 5, 1
    v_bfe_u32 v3, v1, 4, 1
    v_xor_b32 v3, v2, v3
    v_lshl_add_u32 v93, v2, 2, v3
    v_and_b32 v2, 1, v1
    v_lshl_add_u32 v93, v2, 1, v93
    v_bfe_u32 v2, v1, 1, 1
    v_and_b32 v3, 4, v1
    v_or_b32 v2, v2, v3
    v_xor_b32 v93, v2, v93
    v_bfe_u32 v2, v1, 1, 3
    v_lshl_add_u32 v93, v2, 3, v93
    v_lshl_add_u32 v93, v93, 4, s18
    v_lshl_add_u32 v94, v1, 4, s18
    s_waitcnt vmcnt(22)
    ds_write_b128 v94, v[8:11] offset:12400
    ds_write_b128 v94, v[10:13] offset:28912
    v_alignbit_b32 v96, v7, v6, 16
    v_alignbit_b32 v97, v8, v7, 16
    v_alignbit_b32 v98, v9, v8, 16
    v_alignbit_b32 v99, v10, v9, 16
    v_alignbit_b32 v100, v11, v10, 16
    v_alignbit_b32 v101, v12, v11, 16
    ds_write_b128 v94, v[96:99] offset:16
    ds_write_b128 v94, v[98:101] offset:16528
    v_mov_b32 v108, v7
    v_mov_b32 v109, v8
    v_mov_b32 v110, v9
    v_mov_b32 v111, v10
    v_mov_b32 v112, v11
    v_mov_b32 v113, v12
    ds_write_b128 v94, v[108:111] offset:4144
    ds_write_b128 v94, v[110:113] offset:20656
    v_alignbit_b32 v102, v8, v7, 16
    v_alignbit_b32 v103, v9, v8, 16
    v_alignbit_b32 v104, v10, v9, 16
    v_alignbit_b32 v105, v11, v10, 16
    v_alignbit_b32 v106, v12, v11, 16
    v_alignbit_b32 v107, v13, v12, 16
    ds_write_b128 v94, v[102:105] offset:8272
    ds_write_b128 v94, v[104:107] offset:24784
    s_waitcnt vmcnt(20)
    ds_write_b128 v94, v[16:19] offset:13424
    ds_write_b128 v94, v[18:21] offset:29936
    v_alignbit_b32 v96, v15, v14, 16
    v_alignbit_b32 v97, v16, v15, 16
    v_alignbit_b32 v98, v17, v16, 16
    v_alignbit_b32 v99, v18, v17, 16
    v_alignbit_b32 v100, v19, v18, 16
    v_alignbit_b32 v101, v20, v19, 16
    ds_write_b128 v94, v[96:99] offset:1040
    ds_write_b128 v94, v[98:101] offset:17552
    v_mov_b32 v108, v15
    v_mov_b32 v109, v16
    v_mov_b32 v110, v17
    v_mov_b32 v111, v18
    v_mov_b32 v112, v19
    v_mov_b32 v113, v20
    ds_write_b128 v94, v[108:111] offset:5168
    ds_write_b128 v94, v[110:113] offset:21680
    v_alignbit_b32 v102, v16, v15, 16
    v_alignbit_b32 v103, v17, v16, 16
    v_alignbit_b32 v104, v18, v17, 16
    v_alignbit_b32 v105, v19, v18, 16
    v_alignbit_b32 v106, v20, v19, 16
    v_alignbit_b32 v107, v21, v20, 16
    ds_write_b128 v94, v[102:105] offset:9296
    ds_write_b128 v94, v[104:107] offset:25808
    s_waitcnt vmcnt(18)
    ds_write_b128 v94, v[24:27] offset:14448
    ds_write_b128 v94, v[26:29] offset:30960
    v_alignbit_b32 v96, v23, v22, 16
    v_alignbit_b32 v97, v24, v23, 16
    v_alignbit_b32 v98, v25, v24, 16
    v_alignbit_b32 v99, v26, v25, 16
    v_alignbit_b32 v100, v27, v26, 16
    v_alignbit_b32 v101, v28, v27, 16
    ds_write_b128 v94, v[96:99] offset:2064
    ds_write_b128 v94, v[98:101] offset:18576
    v_mov_b32 v108, v23
    v_mov_b32 v109, v24
    v_mov_b32 v110, v25
    v_mov_b32 v111, v26
    v_mov_b32 v112, v27
    v_mov_b32 v113, v28
    ds_write_b128 v94, v[108:111] offset:6192
    ds_write_b128 v94, v[110:113] offset:22704
    v_alignbit_b32 v102, v24, v23, 16
    v_alignbit_b32 v103, v25, v24, 16
    v_alignbit_b32 v104, v26, v25, 16
    v_alignbit_b32 v105, v27, v26, 16
    v_alignbit_b32 v106, v28, v27, 16
    v_alignbit_b32 v107, v29, v28, 16
    ds_write_b128 v94, v[102:105] offset:10320
    ds_write_b128 v94, v[104:107] offset:26832
    s_waitcnt vmcnt(16)
    ds_write_b128 v94, v[32:35] offset:15472
    ds_write_b128 v94, v[34:37] offset:31984
    v_alignbit_b32 v96, v31, v30, 16
    v_alignbit_b32 v97, v32, v31, 16
    v_alignbit_b32 v98, v33, v32, 16
    v_alignbit_b32 v99, v34, v33, 16
    v_alignbit_b32 v100, v35, v34, 16
    v_alignbit_b32 v101, v36, v35, 16
    ds_write_b128 v94, v[96:99] offset:3088
    ds_write_b128 v94, v[98:101] offset:19600
    v_mov_b32 v108, v31
    v_mov_b32 v109, v32
    v_mov_b32 v110, v33
    v_mov_b32 v111, v34
    v_mov_b32 v112, v35
    v_mov_b32 v113, v36
    ds_write_b128 v94, v[108:111] offset:7216
    ds_write_b128 v94, v[110:113] offset:23728
    v_alignbit_b32 v102, v32, v31, 16
    v_alignbit_b32 v103, v33, v32, 16
    v_alignbit_b32 v104, v34, v33, 16
    v_alignbit_b32 v105, v35, v34, 16
    v_alignbit_b32 v106, v36, v35, 16
    v_alignbit_b32 v107, v37, v36, 16
    ds_write_b128 v94, v[102:105] offset:11344
    ds_write_b128 v94, v[104:107] offset:27856
    v_lshlrev_b32 v2, 3, v90
    v_sub_u32 v2, v2, v89
    v_subrev_u32 v2, 9, v2
    v_and_b32 v3, 1, v2
    v_lshlrev_b32 v3, 4, v3
    s_waitcnt vmcnt(15)
    v_lshlrev_b32 v38, v3, v38
    v_ashrrev_i32 v2, 1, v2
    v_cmp_eq_u32 vcc, 0, v2
    s_nop 1
    v_cndmask_b32 v116, 0, v38, vcc
    v_cmp_eq_u32 vcc, 1, v2
    s_nop 1
    v_cndmask_b32 v117, 0, v38, vcc
    v_cmp_eq_u32 vcc, 2, v2
    s_nop 1
    v_cndmask_b32 v118, 0, v38, vcc
    v_cmp_eq_u32 vcc, 3, v2
    s_nop 1
    v_cndmask_b32 v119, 0, v38, vcc
    s_waitcnt vmcnt(11)
    ds_read_b128 v[152:155], v92 offset:0
    ds_read_b128 v[156:159], v92 offset:256
    ds_read_b128 v[160:163], v92 offset:512
    ds_read_b128 v[164:167], v92 offset:768
    ds_read_b128 v[168:171], v92 offset:1024
    ds_read_b128 v[172:175], v92 offset:1280
    ds_read_b128 v[176:179], v92 offset:1536
    ds_read_b128 v[180:183], v92 offset:1792
    ds_read_b128 v[148:151], v91 offset:3584
    ds_read_b128 v[144:147], v91 offset:3072
    ds_read_b128 v[140:143], v91 offset:2560
    ds_read_b128 v[136:139], v91 offset:2048
    ds_read_b128 v[132:135], v91 offset:1536
    ds_read_b128 v[128:131], v91 offset:1024
    ds_read_b128 v[124:127], v91 offset:512
    ds_read_b128 v[120:123], v91 offset:0
    s_waitcnt lgkmcnt(15)
    v_mfma_f32_16x16x32_bf16 v[184:187], v[116:119], v[152:155], 0
    s_waitcnt lgkmcnt(14)
    v_mfma_f32_16x16x32_bf16 v[188:191], v[116:119], v[156:159], 0
    s_waitcnt lgkmcnt(13)
    v_mfma_f32_16x16x32_bf16 v[192:195], v[116:119], v[160:163], 0
    s_waitcnt lgkmcnt(12)
    v_mfma_f32_16x16x32_bf16 v[196:199], v[116:119], v[164:167], 0
    s_waitcnt lgkmcnt(11)
    v_mfma_f32_16x16x32_bf16 v[200:203], v[116:119], v[168:171], 0
    s_waitcnt lgkmcnt(10)
    v_mfma_f32_16x16x32_bf16 v[204:207], v[116:119], v[172:175], 0
    s_waitcnt lgkmcnt(9)
    v_mfma_f32_16x16x32_bf16 v[208:211], v[116:119], v[176:179], 0
    s_waitcnt lgkmcnt(8)
    v_mfma_f32_16x16x32_bf16 v[212:215], v[116:119], v[180:183], 0
    s_mov_b32 s20, 8
L_k1_conv_5:
    v_add_u32 v91, 64, v91
    v_subrev_u32 v92, 32, v92
    s_waitcnt lgkmcnt(7)
    v_mfma_f32_16x16x32_bf16 v[212:215], v[148:151], v[152:155], v[212:215]
    ds_read_b128 v[148:151], v91 offset:3584
    s_waitcnt lgkmcnt(7)
    v_mfma_f32_16x16x32_bf16 v[208:211], v[144:147], v[152:155], v[208:211]
    v_mfma_f32_16x16x32_bf16 v[212:215], v[144:147], v[156:159], v[212:215]
    ds_read_b128 v[144:147], v91 offset:3072
    s_waitcnt lgkmcnt(7)
    v_mfma_f32_16x16x32_bf16 v[204:207], v[140:143], v[152:155], v[204:207]
    v_mfma_f32_16x16x32_bf16 v[208:211], v[140:143], v[156:159], v[208:211]
    v_mfma_f32_16x16x32_bf16 v[212:215], v[140:143], v[160:163], v[212:215]
    ds_read_b128 v[140:143], v91 offset:2560
    s_waitcnt lgkmcnt(7)
    v_mfma_f32_16x16x32_bf16 v[200:203], v[136:139], v[152:155], v[200:203]
    v_mfma_f32_16x16x32_bf16 v[204:207], v[136:139], v[156:159], v[204:207]
    v_mfma_f32_16x16x32_bf16 v[208:211], v[136:139], v[160:163], v[208:211]
    v_mfma_f32_16x16x32_bf16 v[212:215], v[136:139], v[164:167], v[212:215]
    ds_read_b128 v[136:139], v91 offset:2048
    s_waitcnt lgkmcnt(7)
    v_mfma_f32_16x16x32_bf16 v[196:199], v[132:135], v[152:155], v[196:199]
    v_mfma_f32_16x16x32_bf16 v[200:203], v[132:135], v[156:159], v[200:203]
    v_mfma_f32_16x16x32_bf16 v[204:207], v[132:135], v[160:163], v[204:207]
    v_mfma_f32_16x16x32_bf16 v[208:211], v[132:135], v[164:167], v[208:211]
    v_mfma_f32_16x16x32_bf16 v[212:215], v[132:135], v[168:171], v[212:215]
    ds_read_b128 v[132:135], v91 offset:1536
    s_waitcnt lgkmcnt(7)
    v_mfma_f32_16x16x32_bf16 v[192:195], v[128:131], v[152:155], v[192:195]
    v_mfma_f32_16x16x32_bf16 v[196:199], v[128:131], v[156:159], v[196:199]
    v_mfma_f32_16x16x32_bf16 v[200:203], v[128:131], v[160:163], v[200:203]
    v_mfma_f32_16x16x32_bf16 v[204:207], v[128:131], v[164:167], v[204:207]
    v_mfma_f32_16x16x32_bf16 v[208:211], v[128:131], v[168:171], v[208:211]
    v_mfma_f32_16x16x32_bf16 v[212:215], v[128:131], v[172:175], v[212:215]
    ds_read_b128 v[128:131], v91 offset:1024
    s_waitcnt lgkmcnt(7)
    v_mfma_f32_16x16x32_bf16 v[188:191], v[124:127], v[152:155], v[188:191]
    v_mfma_f32_16x16x32_bf16 v[192:195], v[124:127], v[156:159], v[192:195]
    v_mfma_f32_16x16x32_bf16 v[196:199], v[124:127], v[160:163], v[196:199]
    v_mfma_f32_16x16x32_bf16 v[200:203], v[124:127], v[164:167], v[200:203]
    v_mfma_f32_16x16x32_bf16 v[204:207], v[124:127], v[168:171], v[204:207]
    v_mfma_f32_16x16x32_bf16 v[208:211], v[124:127], v[172:175], v[208:211]
    v_mfma_f32_16x16x32_bf16 v[212:215], v[124:127], v[176:179], v[212:215]
    ds_read_b128 v[124:127], v91 offset:512
    s_waitcnt lgkmcnt(7)
    v_mfma_f32_16x16x32_bf16 v[184:187], v[120:123], v[152:155], v[184:187]
    ds_read_b128 v[152:155], v92 offset:0
    v_mfma_f32_16x16x32_bf16 v[188:191], v[120:123], v[156:159], v[188:191]
    ds_read_b128 v[156:159], v92 offset:256
    v_mfma_f32_16x16x32_bf16 v[192:195], v[120:123], v[160:163], v[192:195]
    ds_read_b128 v[160:163], v92 offset:512
    v_mfma_f32_16x16x32_bf16 v[196:199], v[120:123], v[164:167], v[196:199]
    ds_read_b128 v[164:167], v92 offset:768
    v_mfma_f32_16x16x32_bf16 v[200:203], v[120:123], v[168:171], v[200:203]
    ds_read_b128 v[168:171], v92 offset:1024
    v_mfma_f32_16x16x32_bf16 v[204:207], v[120:123], v[172:175], v[204:207]
    ds_read_b128 v[172:175], v92 offset:1280
    v_mfma_f32_16x16x32_bf16 v[208:211], v[120:123], v[176:179], v[208:211]
    ds_read_b128 v[176:179], v92 offset:1536
    v_mfma_f32_16x16x32_bf16 v[212:215], v[120:123], v[180:183], v[212:215]
    ds_read_b128 v[180:183], v92 offset:1792
    ds_read_b128 v[120:123], v91 offset:0
    s_sub_u32 s20, s20, 1
    s_cmp_lg_u32 s20, 0
    s_cbranch_scc1 L_k1_conv_5
    ds_write_b128 v93, v[184:187] offset:0
    ds_write_b128 v93, v[188:191] offset:1024
    ds_write_b128 v93, v[192:195] offset:2048
    ds_write_b128 v93, v[196:199] offset:3072
    ds_write_b128 v93, v[200:203] offset:4096
    ds_write_b128 v93, v[204:207] offset:5120
    ds_write_b128 v93, v[208:211] offset:6144
    ds_write_b128 v93, v[212:215] offset:7168
    v_bfe_u32 v2, v0, 4, 1
    v_bfe_u32 v3, v0, 5, 1
    v_lshl_add_u32 v2, v3, 2, v2
    v_lshlrev_b32 v2, 1, v2
    v_xor_b32 v2, v0, v2
    v_lshlrev_b32 v216, 3, v2
    v_add_u32 v217, 66048, v216
    s_waitcnt vmcnt(0)
    v_mul_f32 v218, v80, v76
    v_mul_f32 v219, v80, v72
    v_mul_f32 v220, v81, v77
    v_mul_f32 v221, v81, v73
    v_mul_f32 v222, v82, v78
    v_mul_f32 v223, v82, v74
    v_mul_f32 v224, v83, v79
    v_mul_f32 v225, v83, v75
    s_waitcnt lgkmcnt(0)
    s_barrier
    ds_read_b64 v[120:121], v216 offset:0
    ds_read_b64 v[122:123], v216 offset:33024
    ds_read_b64 v[124:125], v217 offset:0
    ds_read_b64 v[126:127], v217 offset:33024
    ds_read_b64 v[128:129], v216 offset:2048
    ds_read_b64 v[130:131], v216 offset:35072
    ds_read_b64 v[132:133], v217 offset:2048
    ds_read_b64 v[134:135], v217 offset:35072
    ds_read_b64 v[136:137], v216 offset:4096
    ds_read_b64 v[138:139], v216 offset:37120
    ds_read_b64 v[140:141], v217 offset:4096
    ds_read_b64 v[142:143], v217 offset:37120
    ds_read_b64 v[144:145], v216 offset:6144
    ds_read_b64 v[146:147], v216 offset:39168
    ds_read_b64 v[148:149], v217 offset:6144
    ds_read_b64 v[150:151], v217 offset:39168
    v_lshlrev_b32 v152, 16, v40
    v_and_b32 v154, s3, v40
    v_lshlrev_b32 v156, 16, v41
    v_and_b32 v158, s3, v41
    v_lshlrev_b32 v153, 16, v42
    v_and_b32 v155, s3, v42
    v_lshlrev_b32 v157, 16, v43
    v_and_b32 v159, s3, v43
    v_pk_fma_f32 v[160:161], v[152:153], v[56:57], v[58:59]
    v_pk_fma_f32 v[162:163], v[154:155], v[56:57], v[58:59]
    v_pk_fma_f32 v[164:165], v[156:157], v[56:57], v[58:59]
    v_pk_fma_f32 v[166:167], v[158:159], v[56:57], v[58:59]
    v_pk_fma_f32 v[160:161], v[160:161], v[218:219], v[218:219] op_sel:[0,0,1] op_sel_hi:[1,0,1]
    v_pk_fma_f32 v[162:163], v[162:163], v[220:221], v[220:221] op_sel:[0,0,1] op_sel_hi:[1,0,1]
    v_pk_fma_f32 v[164:165], v[164:165], v[222:223], v[222:223] op_sel:[0,0,1] op_sel_hi:[1,0,1]
    v_pk_fma_f32 v[166:167], v[166:167], v[224:225], v[224:225] op_sel:[0,0,1] op_sel_hi:[1,0,1]
    s_waitcnt lgkmcnt(15)
    v_pk_fma_f32 v[160:161], v[160:161], v[120:121], v[152:153]
    s_waitcnt lgkmcnt(14)
    v_pk_fma_f32 v[162:163], v[162:163], v[122:123], v[154:155]
    s_waitcnt lgkmcnt(13)
    v_pk_fma_f32 v[164:165], v[164:165], v[124:125], v[156:157]
    s_waitcnt lgkmcnt(12)
    v_pk_fma_f32 v[166:167], v[166:167], v[126:127], v[158:159]
    v_cvt_pk_bf16_f32 v40, v160, v162
    v_cvt_pk_bf16_f32 v41, v164, v166
    v_cvt_pk_bf16_f32 v42, v161, v163
    v_cvt_pk_bf16_f32 v43, v165, v167
    buffer_store_dwordx4 v[40:43], v39, s[4:7], s28 offen
    v_lshlrev_b32 v152, 16, v44
    v_and_b32 v154, s3, v44
    v_lshlrev_b32 v156, 16, v45
    v_and_b32 v158, s3, v45
    v_lshlrev_b32 v153, 16, v46
    v_and_b32 v155, s3, v46
    v_lshlrev_b32 v157, 16, v47
    v_and_b32 v159, s3, v47
    v_pk_fma_f32 v[160:161], v[152:153], v[60:61], v[62:63]
    v_pk_fma_f32 v[162:163], v[154:155], v[60:61], v[62:63]
    v_pk_fma_f32 v[164:165], v[156:157], v[60:61], v[62:63]
    v_pk_fma_f32 v[166:167], v[158:159], v[60:61], v[62:63]
    v_pk_fma_f32 v[160:161], v[160:161], v[218:219], v[218:219] op_sel:[0,0,1] op_sel_hi:[1,0,1]
    v_pk_fma_f32 v[162:163], v[162:163], v[220:221], v[220:221] op_sel:[0,0,1] op_sel_hi:[1,0,1]
    v_pk_fma_f32 v[164:165], v[164:165], v[222:223], v[222:223] op_sel:[0,0,1] op_sel_hi:[1,0,1]
    v_pk_fma_f32 v[166:167], v[166:167], v[224:225], v[224:225] op_sel:[0,0,1] op_sel_hi:[1,0,1]
    s_waitcnt lgkmcnt(11)
    v_pk_fma_f32 v[160:161], v[160:161], v[128:129], v[152:153]
    s_waitcnt lgkmcnt(10)
    v_pk_fma_f32 v[162:163], v[162:163], v[130:131], v[154:155]
    s_waitcnt lgkmcnt(9)
    v_pk_fma_f32 v[164:165], v[164:165], v[132:133], v[156:157]
    s_waitcnt lgkmcnt(8)
    v_pk_fma_f32 v[166:167], v[166:167], v[134:135], v[158:159]
    v_cvt_pk_bf16_f32 v44, v160, v162
    v_cvt_pk_bf16_f32 v45, v164, v166
    v_cvt_pk_bf16_f32 v46, v161, v163
    v_cvt_pk_bf16_f32 v47, v165, v167
    buffer_store_dwordx4 v[44:47], v39, s[4:7], s29 offen
    v_lshlrev_b32 v152, 16, v48
    v_and_b32 v154, s3, v48
    v_lshlrev_b32 v156, 16, v49
    v_and_b32 v158, s3, v49
    v_lshlrev_b32 v153, 16, v50
    v_and_b32 v155, s3, v50
    v_lshlrev_b32 v157, 16, v51
    v_and_b32 v159, s3, v51
    v_pk_fma_f32 v[160:161], v[152:153], v[64:65], v[66:67]
    v_pk_fma_f32 v[162:163], v[154:155], v[64:65], v[66:67]
    v_pk_fma_f32 v[164:165], v[156:157], v[64:65], v[66:67]
    v_pk_fma_f32 v[166:167], v[158:159], v[64:65], v[66:67]
    v_pk_fma_f32 v[160:161], v[160:161], v[218:219], v[218:219] op_sel:[0,0,1] op_sel_hi:[1,0,1]
    v_pk_fma_f32 v[162:163], v[162:163], v[220:221], v[220:221] op_sel:[0,0,1] op_sel_hi:[1,0,1]
    v_pk_fma_f32 v[164:165], v[164:165], v[222:223], v[222:223] op_sel:[0,0,1] op_sel_hi:[1,0,1]
    v_pk_fma_f32 v[166:167], v[166:167], v[224:225], v[224:225] op_sel:[0,0,1] op_sel_hi:[1,0,1]
    s_waitcnt lgkmcnt(7)
    v_pk_fma_f32 v[160:161], v[160:161], v[136:137], v[152:153]
    s_waitcnt lgkmcnt(6)
    v_pk_fma_f32 v[162:163], v[162:163], v[138:139], v[154:155]
    s_waitcnt lgkmcnt(5)
    v_pk_fma_f32 v[164:165], v[164:165], v[140:141], v[156:157]
    s_waitcnt lgkmcnt(4)
    v_pk_fma_f32 v[166:167], v[166:167], v[142:143], v[158:159]
    v_cvt_pk_bf16_f32 v48, v160, v162
    v_cvt_pk_bf16_f32 v49, v164, v166
    v_cvt_pk_bf16_f32 v50, v161, v163
    v_cvt_pk_bf16_f32 v51, v165, v167
    buffer_store_dwordx4 v[48:51], v39, s[4:7], s30 offen
    v_lshlrev_b32 v152, 16, v52
    v_and_b32 v154, s3, v52
    v_lshlrev_b32 v156, 16, v53
    v_and_b32 v158, s3, v53
    v_lshlrev_b32 v153, 16, v54
    v_and_b32 v155, s3, v54
    v_lshlrev_b32 v157, 16, v55
    v_and_b32 v159, s3, v55
    v_pk_fma_f32 v[160:161], v[152:153], v[68:69], v[70:71]
    v_pk_fma_f32 v[162:163], v[154:155], v[68:69], v[70:71]
    v_pk_fma_f32 v[164:165], v[156:157], v[68:69], v[70:71]
    v_pk_fma_f32 v[166:167], v[158:159], v[68:69], v[70:71]
    v_pk_fma_f32 v[160:161], v[160:161], v[218:219], v[218:219] op_sel:[0,0,1] op_sel_hi:[1,0,1]
    v_pk_fma_f32 v[162:163], v[162:163], v[220:221], v[220:221] op_sel:[0,0,1] op_sel_hi:[1,0,1]
    v_pk_fma_f32 v[164:165], v[164:165], v[222:223], v[222:223] op_sel:[0,0,1] op_sel_hi:[1,0,1]
    v_pk_fma_f32 v[166:167], v[166:167], v[224:225], v[224:225] op_sel:[0,0,1] op_sel_hi:[1,0,1]
    s_waitcnt lgkmcnt(3)
    v_pk_fma_f32 v[160:161], v[160:161], v[144:145], v[152:153]
    s_waitcnt lgkmcnt(2)
    v_pk_fma_f32 v[162:163], v[162:163], v[146:147], v[154:155]
    s_waitcnt lgkmcnt(1)
    v_pk_fma_f32 v[164:165], v[164:165], v[148:149], v[156:157]
    s_waitcnt lgkmcnt(0)
    v_pk_fma_f32 v[166:167], v[166:167], v[150:151], v[158:159]
    v_cvt_pk_bf16_f32 v52, v160, v162
    v_cvt_pk_bf16_f32 v53, v164, v166
    v_cvt_pk_bf16_f32 v54, v161, v163
    v_cvt_pk_bf16_f32 v55, v165, v167
    buffer_store_dwordx4 v[52:55], v39, s[4:7], s31 offen
    s_branch L_k1_fin_2
L_k1_win_3:
    s_cmp_ge_u32 s2, 224
    s_cbranch_scc1 L_k1_wout_4
    s_load_dwordx2 s[8:9], s[0:1], 56
    s_mov_b32 s10, 2211840
    s_mov_b32 s11, 0x20000
    v_lshrrev_b32 v4, 6, v0
    s_nop 0
    v_readfirstlane_b32 s13, v4
    s_sub_u32 s12, s2, 160
    s_and_b32 s14, s12, 3
    s_lshr_b32 s15, s12, 2
    s_mov_b32 s22, 0x3f803f80
    v_and_b32 v1, 63, v0
    v_and_b32 v2, 15, v0
    v_lshrrev_b32 v3, 4, v1
    s_lshr_b32 s16, s15, 1
    s_mul_i32 s16, s16, 216
    s_and_b32 s17, s15, 1
    s_mul_i32 s17, s17, 1728
    s_add_u32 s16, s16, s17
    s_lshl_b32 s17, s14, 6
    s_add_u32 s16, s16, s17
    s_mul_i32 s17, s13, 552960
    s_add_u32 s16, s16, s17
    v_mul_u32_u24 v5, 27648, v3
    v_lshl_add_u32 v5, v2, 2, v5
    s_cmp_eq_u32 s14, 3
    s_cselect_b32 s17, 6, 16
    v_cmp_gt_u32 vcc, s17, v2
    v_mov_b32 v4, 2147483648
    s_nop 0
    v_cndmask_b32 v5, v4, v5, vcc
    s_waitcnt lgkmcnt(0)
    buffer_load_dword v10, v5, s[8:11], s16 offen
    s_add_u32 s16, s16, 3456
    buffer_load_dword v11, v5, s[8:11], s16 offen
    s_add_u32 s16, s16, 3456
    buffer_load_dword v12, v5, s[8:11], s16 offen
    s_add_u32 s16, s16, 3456
    buffer_load_dword v13, v5, s[8:11], s16 offen
    s_add_u32 s16, s16, 3456
    buffer_load_dword v14, v5, s[8:11], s16 offen
    s_add_u32 s16, s16, 3456
    buffer_load_dword v15, v5, s[8:11], s16 offen
    s_add_u32 s16, s16, 3456
    buffer_load_dword v16, v5, s[8:11], s16 offen
    s_add_u32 s16, s16, 3456
    buffer_load_dword v17, v5, s[8:11], s16 offen
    s_add_u32 s16, s16, 86400
    buffer_load_dword v18, v5, s[8:11], s16 offen
    s_add_u32 s16, s16, 3456
    buffer_load_dword v19, v5, s[8:11], s16 offen
    s_add_u32 s16, s16, 3456
    buffer_load_dword v20, v5, s[8:11], s16 offen
    s_add_u32 s16, s16, 3456
    buffer_load_dword v21, v5, s[8:11], s16 offen
    s_add_u32 s16, s16, 3456
    buffer_load_dword v22, v5, s[8:11], s16 offen
    s_add_u32 s16, s16, 3456
    buffer_load_dword v23, v5, s[8:11], s16 offen
    s_add_u32 s16, s16, 3456
    buffer_load_dword v24, v5, s[8:11], s16 offen
    s_add_u32 s16, s16, 3456
    buffer_load_dword v25, v5, s[8:11], s16 offen
    s_add_u32 s16, s16, 86400
    buffer_load_dword v26, v5, s[8:11], s16 offen
    s_add_u32 s16, s16, 3456
    buffer_load_dword v27, v5, s[8:11], s16 offen
    s_add_u32 s16, s16, 3456
    buffer_load_dword v28, v5, s[8:11], s16 offen
    s_add_u32 s16, s16, 3456
    buffer_load_dword v29, v5, s[8:11], s16 offen
    s_add_u32 s16, s16, 3456
    buffer_load_dword v30, v5, s[8:11], s16 offen
    s_add_u32 s16, s16, 3456
    buffer_load_dword v31, v5, s[8:11], s16 offen
    s_add_u32 s16, s16, 3456
    buffer_load_dword v32, v5, s[8:11], s16 offen
    s_add_u32 s16, s16, 3456
    buffer_load_dword v33, v5, s[8:11], s16 offen
    s_add_u32 s16, s16, 86400
    buffer_load_dword v34, v5, s[8:11], s16 offen
    s_add_u32 s16, s16, 3456
    buffer_load_dword v35, v5, s[8:11], s16 offen
    s_add_u32 s16, s16, 3456
    buffer_load_dword v36, v5, s[8:11], s16 offen
    s_add_u32 s16, s16, 3456
    buffer_load_dword v37, v5, s[8:11], s16 offen
    s_add_u32 s16, s16, 3456
    buffer_load_dword v38, v5, s[8:11], s16 offen
    s_add_u32 s16, s16, 3456
    buffer_load_dword v39, v5, s[8:11], s16 offen
    s_add_u32 s16, s16, 3456
    buffer_load_dword v40, v5, s[8:11], s16 offen
    s_add_u32 s16, s16, 3456
    buffer_load_dword v41, v5, s[8:11], s16 offen
    s_add_u32 s16, s16, 86400
    buffer_load_dword v42, v5, s[8:11], s16 offen
    s_add_u32 s16, s16, 3456
    buffer_load_dword v43, v5, s[8:11], s16 offen
    s_add_u32 s16, s16, 3456
    buffer_load_dword v44, v5, s[8:11], s16 offen
    s_add_u32 s16, s16, 3456
    buffer_load_dword v45, v5, s[8:11], s16 offen
    s_add_u32 s16, s16, 3456
    buffer_load_dword v46, v5, s[8:11], s16 offen
    s_add_u32 s16, s16, 3456
    buffer_load_dword v47, v5, s[8:11], s16 offen
    s_add_u32 s16, s16, 3456
    buffer_load_dword v48, v5, s[8:11], s16 offen
    s_add_u32 s16, s16, 3456
    buffer_load_dword v49, v5, s[8:11], s16 offen
    s_add_u32 s16, s16, 86400
    v_lshlrev_b32 v6, 5, v3
    s_mul_i32 s17, s13, 640
    s_add_u32 s18, s17, 10240
    s_add_u32 s17, s17, 7680
    buffer_load_dwordx4 v[50:53], v6, s[4:7], s18 offen offset:0
    buffer_load_dwordx4 v[90:93], v6, s[4:7], s17 offen offset:0
    buffer_load_dwordx4 v[54:57], v6, s[4:7], s18 offen offset:16
    buffer_load_dwordx4 v[94:97], v6, s[4:7], s17 offen offset:16
    buffer_load_dwordx4 v[58:61], v6, s[4:7], s18 offen offset:128
    buffer_load_dwordx4 v[98:101], v6, s[4:7], s17 offen offset:128
    buffer_load_dwordx4 v[62:65], v6, s[4:7], s18 offen offset:144
    buffer_load_dwordx4 v[102:105], v6, s[4:7], s17 offen offset:144
    buffer_load_dwordx4 v[66:69], v6, s[4:7], s18 offen offset:256
    buffer_load_dwordx4 v[106:109], v6, s[4:7], s17 offen offset:256
    buffer_load_dwordx4 v[70:73], v6, s[4:7], s18 offen offset:272
    buffer_load_dwordx4 v[110:113], v6, s[4:7], s17 offen offset:272
    buffer_load_dwordx4 v[74:77], v6, s[4:7], s18 offen offset:384
    buffer_load_dwordx4 v[114:117], v6, s[4:7], s17 offen offset:384
    buffer_load_dwordx4 v[78:81], v6, s[4:7], s18 offen offset:400
    buffer_load_dwordx4 v[118:121], v6, s[4:7], s17 offen offset:400
    buffer_load_dwordx4 v[82:85], v6, s[4:7], s18 offen offset:512
    buffer_load_dwordx4 v[122:125], v6, s[4:7], s17 offen offset:512
    buffer_load_dwordx4 v[86:89], v6, s[4:7], s18 offen offset:528
    buffer_load_dwordx4 v[126:129], v6, s[4:7], s17 offen offset:528
    v_lshlrev_b32 v7, 4, v1
    v_add_u32 v8, 20480, v7
    s_cmp_lg_u32 s14, 3
    s_cbranch_scc1 L_k1_full_6
    v_lshl_add_u32 v7, v2, 4, v7
    v_cmp_gt_u32 vcc, 8, v2
    s_nop 1
    v_cndmask_b32 v7, v4, v7, vcc
    v_add_u32 v8, 16, v7
L_k1_full_6:
    s_mul_i32 s16, s15, 143360
    s_mul_i32 s17, s14, 40960
    s_add_u32 s16, s16, s17
    s_mul_i32 s17, s13, 5120
    s_add_u32 s16, s16, s17
    s_add_u32 s16, s16, 8912896
    v_mov_b32 v132, 0
    v_mov_b32 v133, 0
    v_mov_b32 v134, 0
    v_mov_b32 v135, 0
    s_waitcnt vmcnt(59)
    v_lshlrev_b32 v136, 16, v10
    v_and_b32 v144, s3, v10
    s_waitcnt vmcnt(58)
    v_lshlrev_b32 v137, 16, v11
    v_and_b32 v145, s3, v11
    s_waitcnt vmcnt(57)
    v_lshlrev_b32 v138, 16, v12
    v_and_b32 v146, s3, v12
    s_waitcnt vmcnt(56)
    v_lshlrev_b32 v139, 16, v13
    v_and_b32 v147, s3, v13
    s_waitcnt vmcnt(55)
    v_lshlrev_b32 v140, 16, v14
    v_and_b32 v148, s3, v14
    s_waitcnt vmcnt(54)
    v_lshlrev_b32 v141, 16, v15
    v_and_b32 v149, s3, v15
    s_waitcnt vmcnt(53)
    v_lshlrev_b32 v142, 16, v16
    v_and_b32 v150, s3, v16
    s_waitcnt vmcnt(52)
    v_lshlrev_b32 v143, 16, v17
    v_and_b32 v151, s3, v17
    s_waitcnt vmcnt(18)
    v_fmac_f32 v134, v90, v136
    v_fmac_f32 v135, v90, v144
    v_fmac_f32 v134, v91, v137
    v_fmac_f32 v135, v91, v145
    v_fmac_f32 v134, v92, v138
    v_fmac_f32 v135, v92, v146
    v_fmac_f32 v134, v93, v139
    v_fmac_f32 v135, v93, v147
    s_waitcnt vmcnt(16)
    v_fmac_f32 v134, v94, v140
    v_fmac_f32 v135, v94, v148
    v_fmac_f32 v134, v95, v141
    v_fmac_f32 v135, v95, v149
    v_fmac_f32 v134, v96, v142
    v_fmac_f32 v135, v96, v150
    v_fmac_f32 v134, v97, v143
    v_fmac_f32 v135, v97, v151
    v_pk_mul_f32 v[136:137], v[136:137], v[50:51]
    v_pk_mul_f32 v[144:145], v[144:145], v[50:51]
    v_pk_mul_f32 v[138:139], v[138:139], v[52:53]
    v_pk_mul_f32 v[146:147], v[146:147], v[52:53]
    v_pk_mul_f32 v[140:141], v[140:141], v[54:55]
    v_pk_mul_f32 v[148:149], v[148:149], v[54:55]
    v_pk_mul_f32 v[142:143], v[142:143], v[56:57]
    v_pk_mul_f32 v[150:151], v[150:151], v[56:57]
    v_cvt_pk_bf16_f32 v152, v136, v137
    v_cvt_pk_bf16_f32 v160, v144, v145
    v_cvt_pk_bf16_f32 v153, v138, v139
    v_cvt_pk_bf16_f32 v161, v146, v147
    v_cvt_pk_bf16_f32 v154, v140, v141
    v_cvt_pk_bf16_f32 v162, v148, v149
    v_cvt_pk_bf16_f32 v155, v142, v143
    v_cvt_pk_bf16_f32 v163, v150, v151
    buffer_store_dwordx4 v[152:155], v7, s[4:7], s16 offen
    buffer_store_dwordx4 v[160:163], v8, s[4:7], s16 offen
    s_add_u32 s16, s16, 1024
    v_dot2c_f32_bf16 v132, s22, v152
    v_dot2c_f32_bf16 v133, s22, v160
    v_dot2c_f32_bf16 v132, s22, v153
    v_dot2c_f32_bf16 v133, s22, v161
    v_dot2c_f32_bf16 v132, s22, v154
    v_dot2c_f32_bf16 v133, s22, v162
    v_dot2c_f32_bf16 v132, s22, v155
    v_dot2c_f32_bf16 v133, s22, v163
    v_lshlrev_b32 v136, 16, v18
    v_and_b32 v144, s3, v18
    v_lshlrev_b32 v137, 16, v19
    v_and_b32 v145, s3, v19
    v_lshlrev_b32 v138, 16, v20
    v_and_b32 v146, s3, v20
    v_lshlrev_b32 v139, 16, v21
    v_and_b32 v147, s3, v21
    v_lshlrev_b32 v140, 16, v22
    v_and_b32 v148, s3, v22
    v_lshlrev_b32 v141, 16, v23
    v_and_b32 v149, s3, v23
    v_lshlrev_b32 v142, 16, v24
    v_and_b32 v150, s3, v24
    v_lshlrev_b32 v143, 16, v25
    v_and_b32 v151, s3, v25
    s_waitcnt vmcnt(16)
    v_fmac_f32 v134, v98, v136
    v_fmac_f32 v135, v98, v144
    v_fmac_f32 v134, v99, v137
    v_fmac_f32 v135, v99, v145
    v_fmac_f32 v134, v100, v138
    v_fmac_f32 v135, v100, v146
    v_fmac_f32 v134, v101, v139
    v_fmac_f32 v135, v101, v147
    s_waitcnt vmcnt(14)
    v_fmac_f32 v134, v102, v140
    v_fmac_f32 v135, v102, v148
    v_fmac_f32 v134, v103, v141
    v_fmac_f32 v135, v103, v149
    v_fmac_f32 v134, v104, v142
    v_fmac_f32 v135, v104, v150
    v_fmac_f32 v134, v105, v143
    v_fmac_f32 v135, v105, v151
    v_pk_mul_f32 v[136:137], v[136:137], v[58:59]
    v_pk_mul_f32 v[144:145], v[144:145], v[58:59]
    v_pk_mul_f32 v[138:139], v[138:139], v[60:61]
    v_pk_mul_f32 v[146:147], v[146:147], v[60:61]
    v_pk_mul_f32 v[140:141], v[140:141], v[62:63]
    v_pk_mul_f32 v[148:149], v[148:149], v[62:63]
    v_pk_mul_f32 v[142:143], v[142:143], v[64:65]
    v_pk_mul_f32 v[150:151], v[150:151], v[64:65]
    v_cvt_pk_bf16_f32 v156, v136, v137
    v_cvt_pk_bf16_f32 v164, v144, v145
    v_cvt_pk_bf16_f32 v157, v138, v139
    v_cvt_pk_bf16_f32 v165, v146, v147
    v_cvt_pk_bf16_f32 v158, v140, v141
    v_cvt_pk_bf16_f32 v166, v148, v149
    v_cvt_pk_bf16_f32 v159, v142, v143
    v_cvt_pk_bf16_f32 v167, v150, v151
    buffer_store_dwordx4 v[156:159], v7, s[4:7], s16 offen
    buffer_store_dwordx4 v[164:167], v8, s[4:7], s16 offen
    s_add_u32 s16, s16, 1024
    v_dot2c_f32_bf16 v132, s22, v156
    v_dot2c_f32_bf16 v133, s22, v164
    v_dot2c_f32_bf16 v132, s22, v157
    v_dot2c_f32_bf16 v133, s22, v165
    v_dot2c_f32_bf16 v132, s22, v158
    v_dot2c_f32_bf16 v133, s22, v166
    v_dot2c_f32_bf16 v132, s22, v159
    v_dot2c_f32_bf16 v133, s22, v167
    v_lshlrev_b32 v136, 16, v26
    v_and_b32 v144, s3, v26
    v_lshlrev_b32 v137, 16, v27
    v_and_b32 v145, s3, v27
    v_lshlrev_b32 v138, 16, v28
    v_and_b32 v146, s3, v28
    v_lshlrev_b32 v139, 16, v29
    v_and_b32 v147, s3, v29
    v_lshlrev_b32 v140, 16, v30
    v_and_b32 v148, s3, v30
    v_lshlrev_b32 v141, 16, v31
    v_and_b32 v149, s3, v31
    v_lshlrev_b32 v142, 16, v32
    v_and_b32 v150, s3, v32
    v_lshlrev_b32 v143, 16, v33
    v_and_b32 v151, s3, v33
    s_waitcnt vmcnt(14)
    v_fmac_f32 v134, v106, v136
    v_fmac_f32 v135, v106, v144
    v_fmac_f32 v134, v107, v137
    v_fmac_f32 v135, v107, v145
    v_fmac_f32 v134, v108, v138
    v_fmac_f32 v135, v108, v146
    v_fmac_f32 v134, v109, v139
    v_fmac_f32 v135, v109, v147
    s_waitcnt vmcnt(12)
    v_fmac_f32 v134, v110, v140
    v_fmac_f32 v135, v110, v148
    v_fmac_f32 v134, v111, v141
    v_fmac_f32 v135, v111, v149
    v_fmac_f32 v134, v112, v142
    v_fmac_f32 v135, v112, v150
    v_fmac_f32 v134, v113, v143
    v_fmac_f32 v135, v113, v151
    v_pk_mul_f32 v[136:137], v[136:137], v[66:67]
    v_pk_mul_f32 v[144:145], v[144:145], v[66:67]
    v_pk_mul_f32 v[138:139], v[138:139], v[68:69]
    v_pk_mul_f32 v[146:147], v[146:147], v[68:69]
    v_pk_mul_f32 v[140:141], v[140:141], v[70:71]
    v_pk_mul_f32 v[148:149], v[148:149], v[70:71]
    v_pk_mul_f32 v[142:143], v[142:143], v[72:73]
    v_pk_mul_f32 v[150:151], v[150:151], v[72:73]
    v_cvt_pk_bf16_f32 v152, v136, v137
    v_cvt_pk_bf16_f32 v160, v144, v145
    v_cvt_pk_bf16_f32 v153, v138, v139
    v_cvt_pk_bf16_f32 v161, v146, v147
    v_cvt_pk_bf16_f32 v154, v140, v141
    v_cvt_pk_bf16_f32 v162, v148, v149
    v_cvt_pk_bf16_f32 v155, v142, v143
    v_cvt_pk_bf16_f32 v163, v150, v151
    buffer_store_dwordx4 v[152:155], v7, s[4:7], s16 offen
    buffer_store_dwordx4 v[160:163], v8, s[4:7], s16 offen
    s_add_u32 s16, s16, 1024
    v_dot2c_f32_bf16 v132, s22, v152
    v_dot2c_f32_bf16 v133, s22, v160
    v_dot2c_f32_bf16 v132, s22, v153
    v_dot2c_f32_bf16 v133, s22, v161
    v_dot2c_f32_bf16 v132, s22, v154
    v_dot2c_f32_bf16 v133, s22, v162
    v_dot2c_f32_bf16 v132, s22, v155
    v_dot2c_f32_bf16 v133, s22, v163
    v_lshlrev_b32 v136, 16, v34
    v_and_b32 v144, s3, v34
    v_lshlrev_b32 v137, 16, v35
    v_and_b32 v145, s3, v35
    v_lshlrev_b32 v138, 16, v36
    v_and_b32 v146, s3, v36
    v_lshlrev_b32 v139, 16, v37
    v_and_b32 v147, s3, v37
    v_lshlrev_b32 v140, 16, v38
    v_and_b32 v148, s3, v38
    v_lshlrev_b32 v141, 16, v39
    v_and_b32 v149, s3, v39
    v_lshlrev_b32 v142, 16, v40
    v_and_b32 v150, s3, v40
    v_lshlrev_b32 v143, 16, v41
    v_and_b32 v151, s3, v41
    s_waitcnt vmcnt(12)
    v_fmac_f32 v134, v114, v136
    v_fmac_f32 v135, v114, v144
    v_fmac_f32 v134, v115, v137
    v_fmac_f32 v135, v115, v145
    v_fmac_f32 v134, v116, v138
    v_fmac_f32 v135, v116, v146
    v_fmac_f32 v134, v117, v139
    v_fmac_f32 v135, v117, v147
    s_waitcnt vmcnt(10)
    v_fmac_f32 v134, v118, v140
    v_fmac_f32 v135, v118, v148
    v_fmac_f32 v134, v119, v141
    v_fmac_f32 v135, v119, v149
    v_fmac_f32 v134, v120, v142
    v_fmac_f32 v135, v120, v150
    v_fmac_f32 v134, v121, v143
    v_fmac_f32 v135, v121, v151
    v_pk_mul_f32 v[136:137], v[136:137], v[74:75]
    v_pk_mul_f32 v[144:145], v[144:145], v[74:75]
    v_pk_mul_f32 v[138:139], v[138:139], v[76:77]
    v_pk_mul_f32 v[146:147], v[146:147], v[76:77]
    v_pk_mul_f32 v[140:141], v[140:141], v[78:79]
    v_pk_mul_f32 v[148:149], v[148:149], v[78:79]
    v_pk_mul_f32 v[142:143], v[142:143], v[80:81]
    v_pk_mul_f32 v[150:151], v[150:151], v[80:81]
    v_cvt_pk_bf16_f32 v156, v136, v137
    v_cvt_pk_bf16_f32 v164, v144, v145
    v_cvt_pk_bf16_f32 v157, v138, v139
    v_cvt_pk_bf16_f32 v165, v146, v147
    v_cvt_pk_bf16_f32 v158, v140, v141
    v_cvt_pk_bf16_f32 v166, v148, v149
    v_cvt_pk_bf16_f32 v159, v142, v143
    v_cvt_pk_bf16_f32 v167, v150, v151
    buffer_store_dwordx4 v[156:159], v7, s[4:7], s16 offen
    buffer_store_dwordx4 v[164:167], v8, s[4:7], s16 offen
    s_add_u32 s16, s16, 1024
    v_dot2c_f32_bf16 v132, s22, v156
    v_dot2c_f32_bf16 v133, s22, v164
    v_dot2c_f32_bf16 v132, s22, v157
    v_dot2c_f32_bf16 v133, s22, v165
    v_dot2c_f32_bf16 v132, s22, v158
    v_dot2c_f32_bf16 v133, s22, v166
    v_dot2c_f32_bf16 v132, s22, v159
    v_dot2c_f32_bf16 v133, s22, v167
    v_lshlrev_b32 v136, 16, v42
    v_and_b32 v144, s3, v42
    v_lshlrev_b32 v137, 16, v43
    v_and_b32 v145, s3, v43
    v_lshlrev_b32 v138, 16, v44
    v_and_b32 v146, s3, v44
    v_lshlrev_b32 v139, 16, v45
    v_and_b32 v147, s3, v45
    v_lshlrev_b32 v140, 16, v46
    v_and_b32 v148, s3, v46
    v_lshlrev_b32 v141, 16, v47
    v_and_b32 v149, s3, v47
    v_lshlrev_b32 v142, 16, v48
    v_and_b32 v150, s3, v48
    v_lshlrev_b32 v143, 16, v49
    v_and_b32 v151, s3, v49
    s_waitcnt vmcnt(10)
    v_fmac_f32 v134, v122, v136
    v_fmac_f32 v135, v122, v144
    v_fmac_f32 v134, v123, v137
    v_fmac_f32 v135, v123, v145
    v_fmac_f32 v134, v124, v138
    v_fmac_f32 v135, v124, v146
    v_fmac_f32 v134, v125, v139
    v_fmac_f32 v135, v125, v147
    s_waitcnt vmcnt(8)
    v_fmac_f32 v134, v126, v140
    v_fmac_f32 v135, v126, v148
    v_fmac_f32 v134, v127, v141
    v_fmac_f32 v135, v127, v149
    v_fmac_f32 v134, v128, v142
    v_fmac_f32 v135, v128, v150
    v_fmac_f32 v134, v129, v143
    v_fmac_f32 v135, v129, v151
    v_pk_mul_f32 v[136:137], v[136:137], v[82:83]
    v_pk_mul_f32 v[144:145], v[144:145], v[82:83]
    v_pk_mul_f32 v[138:139], v[138:139], v[84:85]
    v_pk_mul_f32 v[146:147], v[146:147], v[84:85]
    v_pk_mul_f32 v[140:141], v[140:141], v[86:87]
    v_pk_mul_f32 v[148:149], v[148:149], v[86:87]
    v_pk_mul_f32 v[142:143], v[142:143], v[88:89]
    v_pk_mul_f32 v[150:151], v[150:151], v[88:89]
    v_cvt_pk_bf16_f32 v152, v136, v137
    v_cvt_pk_bf16_f32 v160, v144, v145
    v_cvt_pk_bf16_f32 v153, v138, v139
    v_cvt_pk_bf16_f32 v161, v146, v147
    v_cvt_pk_bf16_f32 v154, v140, v141
    v_cvt_pk_bf16_f32 v162, v148, v149
    v_cvt_pk_bf16_f32 v155, v142, v143
    v_cvt_pk_bf16_f32 v163, v150, v151
    buffer_store_dwordx4 v[152:155], v7, s[4:7], s16 offen
    buffer_store_dwordx4 v[160:163], v8, s[4:7], s16 offen
    s_add_u32 s16, s16, 1024
    v_dot2c_f32_bf16 v132, s22, v152
    v_dot2c_f32_bf16 v133, s22, v160
    v_dot2c_f32_bf16 v132, s22, v153
    v_dot2c_f32_bf16 v133, s22, v161
    v_dot2c_f32_bf16 v132, s22, v154
    v_dot2c_f32_bf16 v133, s22, v162
    v_dot2c_f32_bf16 v132, s22, v155
    v_dot2c_f32_bf16 v133, s22, v163
    v_lshlrev_b32 v4, 4, v0
    s_nop 1
    ds_write_b128 v4, v[132:135]
    s_waitcnt lgkmcnt(0)
    s_barrier
    s_cmp_lg_u32 s13, 0
    s_cbranch_scc1 L_k1_win_done_7
    v_lshlrev_b32 v4, 2, v3
    v_lshl_add_u32 v4, v2, 4, v4
    ds_read2st64_b32 v[50:51], v4 offset0:0 offset1:1
    ds_read2st64_b32 v[52:53], v4 offset0:2 offset1:3
    ds_read2st64_b32 v[54:55], v4 offset0:4 offset1:5
    ds_read2st64_b32 v[56:57], v4 offset0:6 offset1:7
    ds_read2st64_b32 v[58:59], v4 offset0:8 offset1:9
    ds_read2st64_b32 v[60:61], v4 offset0:10 offset1:11
    ds_read2st64_b32 v[62:63], v4 offset0:12 offset1:13
    ds_read2st64_b32 v[64:65], v4 offset0:14 offset1:15
    s_waitcnt lgkmcnt(6)
    v_pk_add_f32 v[50:51], v[50:51], v[52:53]
    s_waitcnt lgkmcnt(5)
    v_pk_add_f32 v[50:51], v[50:51], v[54:55]
    s_waitcnt lgkmcnt(4)
    v_pk_add_f32 v[50:51], v[50:51], v[56:57]
    s_waitcnt lgkmcnt(3)
    v_pk_add_f32 v[50:51], v[50:51], v[58:59]
    s_waitcnt lgkmcnt(2)
    v_pk_add_f32 v[50:51], v[50:51], v[60:61]
    s_waitcnt lgkmcnt(1)
    v_pk_add_f32 v[50:51], v[50:51], v[62:63]
    s_waitcnt lgkmcnt(0)
    v_pk_add_f32 v[50:51], v[50:51], v[64:65]
    v_add_f32 v136, v50, v51
    v_and_b32 v4, 1, v3
    s_cmp_eq_u32 s14, 3
    s_cselect_b32 s16, 0, 4
    s_cselect_b32 s17, 1, 0
    v_lshlrev_b32 v4, s16, v4
    v_lshlrev_b32 v2, s17, v2
    v_add_u32 v4, v4, v2
    v_lshrrev_b32 v3, 1, v3
    v_lshl_add_u32 v4, v3, 7, v4
    v_lshlrev_b32 v4, 2, v4
    s_lshl_b32 s16, s15, 10
    s_lshl_b32 s17, s14, 7
    s_add_u32 s16, s16, s17
    s_add_u32 s16, s16, 32768
    buffer_store_dword v136, v4, s[4:7], s16 offen
L_k1_win_done_7:
    s_branch L_k1_fin_2
L_k1_wout_4:
    s_load_dwordx2 s[8:9], s[0:1], 80
    s_mov_b32 s10, 1105920
    s_mov_b32 s11, 0x20000
    v_lshrrev_b32 v4, 6, v0
    s_nop 0
    v_readfirstlane_b32 s13, v4
    s_sub_u32 s12, s2, 224
    s_lshr_b32 s14, s12, 3
    s_and_b32 s15, s12, 7
    s_mov_b32 s22, 0x05040100
    s_mov_b32 s23, 0x07060302
    v_and_b32 v1, 63, v0
    v_and_b32 v2, 15, v0
    v_lshrrev_b32 v3, 4, v1
    s_mul_i32 s16, s15, 160
    s_lshl_b32 s17, s14, 6
    s_add_u32 s16, s16, s17
    s_mul_i32 s17, s13, 276480
    s_add_u32 s16, s16, s17
    v_mul_u32_u24 v5, 10240, v3
    v_lshl_add_u32 v5, v2, 2, v5
    v_mul_u32_u24 v6, 5120, v3
    v_lshl_add_u32 v6, v2, 2, v6
    v_mov_b32 v4, 2147483648
    v_cmp_gt_u32 vcc, 3, v3
    s_nop 1
    v_cndmask_b32 v6, v4, v6, vcc
    v_lshlrev_b32 v7, 4, v1
    v_add_u32 v8, 1024, v7
    s_cmp_lg_u32 s14, 2
    s_cbranch_scc1 L_k1_full_8
    v_lshl_add_u32 v7, v2, 4, v7
    v_cmp_gt_u32 vcc, 8, v2
    s_nop 1
    v_cndmask_b32 v7, v4, v7, vcc
    v_cndmask_b32 v5, v4, v5, vcc
    v_cndmask_b32 v6, v4, v6, vcc
    v_add_u32 v8, 16, v7
L_k1_full_8:
    s_add_u32 s24, s16, 0
    s_waitcnt lgkmcnt(0)
    buffer_load_dword v10, v5, s[8:11], s24 offen offset:0
    buffer_load_dword v11, v5, s[8:11], s24 offen offset:1280
    buffer_load_dword v12, v5, s[8:11], s24 offen offset:2560
    buffer_load_dword v13, v5, s[8:11], s24 offen offset:3840
    s_add_u32 s24, s16, 5120
    buffer_load_dword v14, v5, s[8:11], s24 offen offset:0
    buffer_load_dword v15, v5, s[8:11], s24 offen offset:1280
    buffer_load_dword v16, v5, s[8:11], s24 offen offset:2560
    buffer_load_dword v17, v5, s[8:11], s24 offen offset:3840
    s_add_u32 s24, s16, 40960
    buffer_load_dword v18, v5, s[8:11], s24 offen offset:0
    buffer_load_dword v19, v5, s[8:11], s24 offen offset:1280
    buffer_load_dword v20, v5, s[8:11], s24 offen offset:2560
    buffer_load_dword v21, v5, s[8:11], s24 offen offset:3840
    s_add_u32 s24, s16, 46080
    buffer_load_dword v22, v5, s[8:11], s24 offen offset:0
    buffer_load_dword v23, v5, s[8:11], s24 offen offset:1280
    buffer_load_dword v24, v5, s[8:11], s24 offen offset:2560
    buffer_load_dword v25, v5, s[8:11], s24 offen offset:3840
    s_add_u32 s24, s16, 81920
    buffer_load_dword v26, v5, s[8:11], s24 offen offset:0
    buffer_load_dword v27, v5, s[8:11], s24 offen offset:1280
    buffer_load_dword v28, v5, s[8:11], s24 offen offset:2560
    buffer_load_dword v29, v5, s[8:11], s24 offen offset:3840
    s_add_u32 s24, s16, 87040
    buffer_load_dword v30, v5, s[8:11], s24 offen offset:0
    buffer_load_dword v31, v5, s[8:11], s24 offen offset:1280
    buffer_load_dword v32, v5, s[8:11], s24 offen offset:2560
    buffer_load_dword v33, v5, s[8:11], s24 offen offset:3840
    s_add_u32 s24, s16, 138240
    buffer_load_dword v34, v5, s[8:11], s24 offen offset:0
    buffer_load_dword v35, v5, s[8:11], s24 offen offset:1280
    buffer_load_dword v36, v5, s[8:11], s24 offen offset:2560
    buffer_load_dword v37, v5, s[8:11], s24 offen offset:3840
    s_add_u32 s24, s16, 143360
    buffer_load_dword v38, v5, s[8:11], s24 offen offset:0
    buffer_load_dword v39, v5, s[8:11], s24 offen offset:1280
    buffer_load_dword v40, v5, s[8:11], s24 offen offset:2560
    buffer_load_dword v41, v5, s[8:11], s24 offen offset:3840
    s_add_u32 s24, s16, 179200
    buffer_load_dword v42, v5, s[8:11], s24 offen offset:0
    buffer_load_dword v43, v5, s[8:11], s24 offen offset:1280
    buffer_load_dword v44, v5, s[8:11], s24 offen offset:2560
    buffer_load_dword v45, v5, s[8:11], s24 offen offset:3840
    s_add_u32 s24, s16, 184320
    buffer_load_dword v46, v5, s[8:11], s24 offen offset:0
    buffer_load_dword v47, v5, s[8:11], s24 offen offset:1280
    buffer_load_dword v48, v5, s[8:11], s24 offen offset:2560
    buffer_load_dword v49, v5, s[8:11], s24 offen offset:3840
    s_add_u32 s24, s16, 220160
    buffer_load_dword v50, v5, s[8:11], s24 offen offset:0
    buffer_load_dword v51, v5, s[8:11], s24 offen offset:1280
    buffer_load_dword v52, v5, s[8:11], s24 offen offset:2560
    buffer_load_dword v53, v5, s[8:11], s24 offen offset:3840
    s_add_u32 s24, s16, 225280
    buffer_load_dword v54, v5, s[8:11], s24 offen offset:0
    buffer_load_dword v55, v5, s[8:11], s24 offen offset:1280
    buffer_load_dword v56, v5, s[8:11], s24 offen offset:2560
    buffer_load_dword v57, v5, s[8:11], s24 offen offset:3840
    s_add_u32 s24, s16, 122880
    buffer_load_dword v58, v6, s[8:11], s24 offen offset:0
    buffer_load_dword v59, v6, s[8:11], s24 offen offset:1280
    buffer_load_dword v60, v6, s[8:11], s24 offen offset:2560
    buffer_load_dword v61, v6, s[8:11], s24 offen offset:3840
    s_add_u32 s24, s16, 261120
    buffer_load_dword v62, v6, s[8:11], s24 offen offset:0
    buffer_load_dword v63, v6, s[8:11], s24 offen offset:1280
    buffer_load_dword v64, v6, s[8:11], s24 offen offset:2560
    buffer_load_dword v65, v6, s[8:11], s24 offen offset:3840
    s_mul_i32 s16, s15, 143360
    s_lshl_b32 s17, s14, 11
    s_add_u32 s16, s16, s17
    s_add_u32 s16, s16, 11206656
    s_mul_i32 s17, s13, 5120
    s_add_u32 s18, s16, s17
    s_add_u32 s18, s18, 122880
    s_mul_i32 s17, s13, 30720
    s_add_u32 s16, s16, s17
    s_waitcnt vmcnt(54)
    v_perm_b32 v66, v11, v10, s22
    v_perm_b32 v74, v11, v10, s23
    s_waitcnt vmcnt(52)
    v_perm_b32 v67, v13, v12, s22
    v_perm_b32 v75, v13, v12, s23
    s_waitcnt vmcnt(50)
    v_perm_b32 v68, v15, v14, s22
    v_perm_b32 v76, v15, v14, s23
    s_waitcnt vmcnt(48)
    v_perm_b32 v69, v17, v16, s22
    v_perm_b32 v77, v17, v16, s23
    buffer_store_dwordx4 v[66:69], v7, s[4:7], s16 offen
    buffer_store_dwordx4 v[74:77], v8, s[4:7], s16 offen
    s_add_u32 s16, s16, 5120
    s_waitcnt vmcnt(48)
    v_perm_b32 v70, v19, v18, s22
    v_perm_b32 v78, v19, v18, s23
    s_waitcnt vmcnt(46)
    v_perm_b32 v71, v21, v20, s22
    v_perm_b32 v79, v21, v20, s23
    s_waitcnt vmcnt(44)
    v_perm_b32 v72, v23, v22, s22
    v_perm_b32 v80, v23, v22, s23
    s_waitcnt vmcnt(42)
    v_perm_b32 v73, v25, v24, s22
    v_perm_b32 v81, v25, v24, s23
    buffer_store_dwordx4 v[70:73], v7, s[4:7], s16 offen
    buffer_store_dwordx4 v[78:81], v8, s[4:7], s16 offen
    s_add_u32 s16, s16, 5120
    s_waitcnt vmcnt(42)
    v_perm_b32 v66, v27, v26, s22
    v_perm_b32 v74, v27, v26, s23
    s_waitcnt vmcnt(40)
    v_perm_b32 v67, v29, v28, s22
    v_perm_b32 v75, v29, v28, s23
    s_waitcnt vmcnt(38)
    v_perm_b32 v68, v31, v30, s22
    v_perm_b32 v76, v31, v30, s23
    s_waitcnt vmcnt(36)
    v_perm_b32 v69, v33, v32, s22
    v_perm_b32 v77, v33, v32, s23
    buffer_store_dwordx4 v[66:69], v7, s[4:7], s16 offen
    buffer_store_dwordx4 v[74:77], v8, s[4:7], s16 offen
    s_add_u32 s16, s16, 5120
    s_waitcnt vmcnt(36)
    v_perm_b32 v70, v35, v34, s22
    v_perm_b32 v78, v35, v34, s23
    s_waitcnt vmcnt(34)
    v_perm_b32 v71, v37, v36, s22
    v_perm_b32 v79, v37, v36, s23
    s_waitcnt vmcnt(32)
    v_perm_b32 v72, v39, v38, s22
    v_perm_b32 v80, v39, v38, s23
    s_waitcnt vmcnt(30)
    v_perm_b32 v73, v41, v40, s22
    v_perm_b32 v81, v41, v40, s23
    buffer_store_dwordx4 v[70:73], v7, s[4:7], s16 offen
    buffer_store_dwordx4 v[78:81], v8, s[4:7], s16 offen
    s_add_u32 s16, s16, 5120
    s_waitcnt vmcnt(30)
    v_perm_b32 v66, v43, v42, s22
    v_perm_b32 v74, v43, v42, s23
    s_waitcnt vmcnt(28)
    v_perm_b32 v67, v45, v44, s22
    v_perm_b32 v75, v45, v44, s23
    s_waitcnt vmcnt(26)
    v_perm_b32 v68, v47, v46, s22
    v_perm_b32 v76, v47, v46, s23
    s_waitcnt vmcnt(24)
    v_perm_b32 v69, v49, v48, s22
    v_perm_b32 v77, v49, v48, s23
    buffer_store_dwordx4 v[66:69], v7, s[4:7], s16 offen
    buffer_store_dwordx4 v[74:77], v8, s[4:7], s16 offen
    s_add_u32 s16, s16, 5120
    s_waitcnt vmcnt(24)
    v_perm_b32 v70, v51, v50, s22
    v_perm_b32 v78, v51, v50, s23
    s_waitcnt vmcnt(22)
    v_perm_b32 v71, v53, v52, s22
    v_perm_b32 v79, v53, v52, s23
    s_waitcnt vmcnt(20)
    v_perm_b32 v72, v55, v54, s22
    v_perm_b32 v80, v55, v54, s23
    s_waitcnt vmcnt(18)
    v_perm_b32 v73, v57, v56, s22
    v_perm_b32 v81, v57, v56, s23
    buffer_store_dwordx4 v[70:73], v7, s[4:7], s16 offen
    buffer_store_dwordx4 v[78:81], v8, s[4:7], s16 offen
    s_waitcnt vmcnt(18)
    v_perm_b32 v66, v59, v58, s22
    v_perm_b32 v74, v59, v58, s23
    s_waitcnt vmcnt(16)
    v_perm_b32 v67, v61, v60, s22
    v_perm_b32 v75, v61, v60, s23
    s_waitcnt vmcnt(14)
    v_perm_b32 v68, v63, v62, s22
    v_perm_b32 v76, v63, v62, s23
    s_waitcnt vmcnt(12)
    v_perm_b32 v69, v65, v64, s22
    v_perm_b32 v77, v65, v64, s23
    buffer_store_dwordx4 v[66:69], v7, s[4:7], s18 offen
    buffer_store_dwordx4 v[74:77], v8, s[4:7], s18 offen
L_k1_fin_2:
L_k1_end_1:
    s_endpgm
.globl k2_kernel
.p2align 8
.type k2_kernel,@function
k2_kernel:
    s_cmp_ge_u32 s2, 256
    s_cbranch_scc1 L_k2_end_1
    s_load_dwordx2 s[4:5], s[0:1], 120
    s_mov_b32 s6, 33554432
    s_mov_b32 s7, 0x20000
    v_lshrrev_b32 v4, 6, v0
    s_nop 0
    v_readfirstlane_b32 s8, v4
    s_lshr_b32 s11, s2, 5
    s_and_b32 s9, s2, 6
    s_lshl_b32 s9, s9, 2
    s_add_u32 s9, s9, s11
    s_bfe_u32 s11, s2, 0x20003
    s_and_b32 s10, s2, 1
    s_lshl_b32 s10, s10, 2
    s_add_u32 s10, s10, s11
    v_and_b32 v1, 63, v0
    v_bfe_u32 v4, v0, 3, 2
    v_bfe_u32 v5, v0, 5, 1
    v_lshl_add_u32 v4, v4, 1, v5
    v_lshlrev_b32 v6, 14, v4
    v_and_b32 v4, 7, v0
    v_lshl_add_u32 v6, v4, 4, v6
    s_lshl_b32 s16, s9, 9
    s_lshl_b32 s11, s8, 7
    s_add_u32 s16, s16, s11
    s_add_u32 s16, s16, 6291456
    s_mul_i32 s17, s8, 20480
    s_mov_b32 m0, s17
    s_waitcnt lgkmcnt(0)
    buffer_load_dwordx4 v6, s[4:7], s16 offen lds
    s_add_u32 m0, m0, 1024
    s_add_u32 s16, s16, 131072
    buffer_load_dwordx4 v6, s[4:7], s16 offen lds
    s_add_u32 m0, m0, 1024
    s_add_u32 s16, s16, 131072
    buffer_load_dwordx4 v6, s[4:7], s16 offen lds
    s_add_u32 m0, m0, 1024
    s_add_u32 s16, s16, 131072
    buffer_load_dwordx4 v6, s[4:7], s16 offen lds
    s_add_u32 m0, m0, 1024
    s_add_u32 s16, s16, 131072
    buffer_load_dwordx4 v6, s[4:7], s16 offen lds
    s_add_u32 m0, m0, 1024
    s_add_u32 s16, s16, 131072
    buffer_load_dwordx4 v6, s[4:7], s16 offen lds
    s_add_u32 m0, m0, 1024
    s_add_u32 s16, s16, 131072
    buffer_load_dwordx4 v6, s[4:7], s16 offen lds
    s_add_u32 m0, m0, 1024
    s_add_u32 s16, s16, 131072
    buffer_load_dwordx4 v6, s[4:7], s16 offen lds
    s_add_u32 m0, m0, 1024
    s_add_u32 s16, s16, 131072
    buffer_load_dwordx4 v6, s[4:7], s16 offen lds
    s_add_u32 m0, m0, 1024
    s_add_u32 s16, s16, 131072
    buffer_load_dwordx4 v6, s[4:7], s16 offen lds
    s_add_u32 m0, m0, 1024
    s_add_u32 s16, s16, 131072
    buffer_load_dwordx4 v6, s[4:7], s16 offen lds
    s_add_u32 m0, m0, 1024
    s_add_u32 s16, s16, 131072
    buffer_load_dwordx4 v6, s[4:7], s16 offen lds
    s_add_u32 m0, m0, 1024
    s_add_u32 s16, s16, 131072
    buffer_load_dwordx4 v6, s[4:7], s16 offen lds
    s_add_u32 m0, m0, 1024
    s_add_u32 s16, s16, 131072
    buffer_load_dwordx4 v6, s[4:7], s16 offen lds
    s_add_u32 m0, m0, 1024
    s_add_u32 s16, s16, 131072
    buffer_load_dwordx4 v6, s[4:7], s16 offen lds
    s_add_u32 m0, m0, 1024
    s_add_u32 s16, s16, 131072
    buffer_load_dwordx4 v6, s[4:7], s16 offen lds
    s_add_u32 m0, m0, 1024
    s_add_u32 s16, s16, 131072
    buffer_load_dwordx4 v6, s[4:7], s16 offen lds
    s_add_u32 m0, m0, 1024
    s_add_u32 s16, s16, 131072
    buffer_load_dwordx4 v6, s[4:7], s16 offen lds
    s_add_u32 m0, m0, 1024
    s_add_u32 s16, s16, 131072
    buffer_load_dwordx4 v6, s[4:7], s16 offen lds
    s_add_u32 m0, m0, 1024
    s_add_u32 s16, s16, 131072
    buffer_load_dwordx4 v6, s[4:7], s16 offen lds
    v_lshlrev_b32 v7, 4, v1
    s_cmp_eq_u32 s8, 3
    s_cselect_b32 s12, 2147483648, 0
    s_or_b32 s11, s12, 20480
    v_add_u32 v8, s11, v7
    s_mul_i32 s20, s10, 286720
    s_mul_i32 s11, s8, 40960
    s_add_u32 s20, s20, s11
    s_add_u32 s20, s20, 9056256
    s_add_u32 s21, s20, 4096
    s_add_u32 s22, s20, 8192
    s_add_u32 s23, s20, 12288
    s_add_u32 s24, s20, 16384
    buffer_load_dwordx4 a[0:3], v7, s[4:7], s20 offen offset:0
    buffer_load_dwordx4 a[4:7], v8, s[4:7], s20 offen offset:0
    buffer_load_dwordx4 a[8:11], v7, s[4:7], s20 offen offset:1024
    buffer_load_dwordx4 a[12:15], v8, s[4:7], s20 offen offset:1024
    buffer_load_dwordx4 a[16:19], v7, s[4:7], s20 offen offset:2048
    buffer_load_dwordx4 a[20:23], v8, s[4:7], s20 offen offset:2048
    buffer_load_dwordx4 a[24:27], v7, s[4:7], s20 offen offset:3072
    buffer_load_dwordx4 a[28:31], v8, s[4:7], s20 offen offset:3072
    buffer_load_dwordx4 a[32:35], v7, s[4:7], s21 offen offset:0
    buffer_load_dwordx4 a[36:39], v8, s[4:7], s21 offen offset:0
    buffer_load_dwordx4 a[40:43], v7, s[4:7], s21 offen offset:1024
    buffer_load_dwordx4 a[44:47], v8, s[4:7], s21 offen offset:1024
    buffer_load_dwordx4 a[48:51], v7, s[4:7], s21 offen offset:2048
    buffer_load_dwordx4 a[52:55], v8, s[4:7], s21 offen offset:2048
    buffer_load_dwordx4 a[56:59], v7, s[4:7], s21 offen offset:3072
    buffer_load_dwordx4 a[60:63], v8, s[4:7], s21 offen offset:3072
    buffer_load_dwordx4 a[64:67], v7, s[4:7], s22 offen offset:0
    buffer_load_dwordx4 a[68:71], v8, s[4:7], s22 offen offset:0
    buffer_load_dwordx4 a[72:75], v7, s[4:7], s22 offen offset:1024
    buffer_load_dwordx4 a[76:79], v8, s[4:7], s22 offen offset:1024
    buffer_load_dwordx4 a[80:83], v7, s[4:7], s22 offen offset:2048
    buffer_load_dwordx4 a[84:87], v8, s[4:7], s22 offen offset:2048
    buffer_load_dwordx4 a[88:91], v7, s[4:7], s22 offen offset:3072
    buffer_load_dwordx4 a[92:95], v8, s[4:7], s22 offen offset:3072
    buffer_load_dwordx4 a[96:99], v7, s[4:7], s23 offen offset:0
    buffer_load_dwordx4 a[100:103], v8, s[4:7], s23 offen offset:0
    buffer_load_dwordx4 a[104:107], v7, s[4:7], s23 offen offset:1024
    buffer_load_dwordx4 a[108:111], v8, s[4:7], s23 offen offset:1024
    buffer_load_dwordx4 a[112:115], v7, s[4:7], s23 offen offset:2048
    buffer_load_dwordx4 a[116:119], v8, s[4:7], s23 offen offset:2048
    buffer_load_dwordx4 a[120:123], v7, s[4:7], s23 offen offset:3072
    buffer_load_dwordx4 a[124:127], v8, s[4:7], s23 offen offset:3072
    buffer_load_dwordx4 a[128:131], v7, s[4:7], s24 offen offset:0
    buffer_load_dwordx4 a[132:135], v8, s[4:7], s24 offen offset:0
    buffer_load_dwordx4 a[136:139], v7, s[4:7], s24 offen offset:1024
    buffer_load_dwordx4 a[140:143], v8, s[4:7], s24 offen offset:1024
    buffer_load_dwordx4 a[144:147], v7, s[4:7], s24 offen offset:2048
    buffer_load_dwordx4 a[148:151], v8, s[4:7], s24 offen offset:2048
    buffer_load_dwordx4 a[152:155], v7, s[4:7], s24 offen offset:3072
    buffer_load_dwordx4 a[156:159], v8, s[4:7], s24 offen offset:3072
    s_sub_u32 s20, s20, 143360
    s_sub_u32 s21, s21, 143360
    s_sub_u32 s22, s22, 143360
    s_sub_u32 s23, s23, 143360
    s_sub_u32 s24, s24, 143360
    v_and_b32 v2, 15, v0
    v_lshrrev_b32 v3, 4, v1
    v_lshlrev_b32 v9, 3, v1
    v_add_u32 v10, 40960, v9
    s_mov_b32 s26, 0xbdd2d3e8
    s_mov_b32 s27, 0xc0135761
    s_mov_b32 s28, 1.0
    s_mov_b32 s29, 1.0
    v_add_u32 v120, s17, v9
    v_mov_b32 v108, 0x3f803f80
    v_mov_b32 v109, 0x3f803f80
    v_mov_b32 v110, 0x3f803f80
    v_mov_b32 v111, 0x3f803f80
    s_waitcnt vmcnt(59)
    ds_read_b64 v[12:13], v120 offset:0
    ds_read_b64 v[14:15], v120 offset:512
    s_waitcnt vmcnt(58)
    ds_read_b64 v[16:17], v120 offset:1024
    ds_read_b64 v[18:19], v120 offset:1536
    s_waitcnt lgkmcnt(2)
    v_mfma_f32_16x16x32_bf16 v[112:115], v[12:15], v[12:15], 0
    v_mfma_f32_16x16x32_bf16 v[116:119], v[108:111], v[12:15], 0
    s_waitcnt vmcnt(57)
    ds_read_b64 v[20:21], v120 offset:2048
    ds_read_b64 v[22:23], v120 offset:2560
    s_waitcnt lgkmcnt(2)
    v_mfma_f32_16x16x32_bf16 v[112:115], v[16:19], v[16:19], v[112:115]
    v_mfma_f32_16x16x32_bf16 v[116:119], v[108:111], v[16:19], v[116:119]
    s_waitcnt vmcnt(56)
    ds_read_b64 v[24:25], v120 offset:3072
    ds_read_b64 v[26:27], v120 offset:3584
    s_waitcnt lgkmcnt(2)
    v_mfma_f32_16x16x32_bf16 v[112:115], v[20:23], v[20:23], v[112:115]
    v_mfma_f32_16x16x32_bf16 v[116:119], v[108:111], v[20:23], v[116:119]
    s_waitcnt vmcnt(55)
    ds_read_b64 v[28:29], v120 offset:4096
    ds_read_b64 v[30:31], v120 offset:4608
    s_waitcnt lgkmcnt(2)
    v_mfma_f32_16x16x32_bf16 v[112:115], v[24:27], v[24:27], v[112:115]
    v_mfma_f32_16x16x32_bf16 v[116:119], v[108:111], v[24:27], v[116:119]
    s_waitcnt vmcnt(54)
    ds_read_b64 v[32:33], v120 offset:5120
    ds_read_b64 v[34:35], v120 offset:5632
    s_waitcnt lgkmcnt(2)
    v_mfma_f32_16x16x32_bf16 v[112:115], v[28:31], v[28:31], v[112:115]
    v_mfma_f32_16x16x32_bf16 v[116:119], v[108:111], v[28:31], v[116:119]
    s_waitcnt vmcnt(53)
    ds_read_b64 v[36:37], v120 offset:6144
    ds_read_b64 v[38:39], v120 offset:6656
    s_waitcnt lgkmcnt(2)
    v_mfma_f32_16x16x32_bf16 v[112:115], v[32:35], v[32:35], v[112:115]
    v_mfma_f32_16x16x32_bf16 v[116:119], v[108:111], v[32:35], v[116:119]
    s_waitcnt vmcnt(52)
    ds_read_b64 v[40:41], v120 offset:7168
    ds_read_b64 v[42:43], v120 offset:7680
    s_waitcnt lgkmcnt(2)
    v_mfma_f32_16x16x32_bf16 v[112:115], v[36:39], v[36:39], v[112:115]
    v_mfma_f32_16x16x32_bf16 v[116:119], v[108:111], v[36:39], v[116:119]
    s_waitcnt vmcnt(51)
    ds_read_b64 v[12:13], v120 offset:8192
    ds_read_b64 v[14:15], v120 offset:8704
    s_waitcnt lgkmcnt(2)
    v_mfma_f32_16x16x32_bf16 v[112:115], v[40:43], v[40:43], v[112:115]
    v_mfma_f32_16x16x32_bf16 v[116:119], v[108:111], v[40:43], v[116:119]
    s_waitcnt vmcnt(50)
    ds_read_b64 v[16:17], v120 offset:9216
    ds_read_b64 v[18:19], v120 offset:9728
    s_waitcnt lgkmcnt(2)
    v_mfma_f32_16x16x32_bf16 v[112:115], v[12:15], v[12:15], v[112:115]
    v_mfma_f32_16x16x32_bf16 v[116:119], v[108:111], v[12:15], v[116:119]
    s_waitcnt vmcnt(49)
    ds_read_b64 v[20:21], v120 offset:10240
    ds_read_b64 v[22:23], v120 offset:10752
    s_waitcnt lgkmcnt(2)
    v_mfma_f32_16x16x32_bf16 v[112:115], v[16:19], v[16:19], v[112:115]
    v_mfma_f32_16x16x32_bf16 v[116:119], v[108:111], v[16:19], v[116:119]
    s_waitcnt vmcnt(48)
    ds_read_b64 v[24:25], v120 offset:11264
    ds_read_b64 v[26:27], v120 offset:11776
    s_waitcnt lgkmcnt(2)
    v_mfma_f32_16x16x32_bf16 v[112:115], v[20:23], v[20:23], v[112:115]
    v_mfma_f32_16x16x32_bf16 v[116:119], v[108:111], v[20:23], v[116:119]
    s_waitcnt vmcnt(47)
    ds_read_b64 v[28:29], v120 offset:12288
    ds_read_b64 v[30:31], v120 offset:12800
    s_waitcnt lgkmcnt(2)
    v_mfma_f32_16x16x32_bf16 v[112:115], v[24:27], v[24:27], v[112:115]
    v_mfma_f32_16x16x32_bf16 v[116:119], v[108:111], v[24:27], v[116:119]
    s_waitcnt vmcnt(46)
    ds_read_b64 v[32:33], v120 offset:13312
    ds_read_b64 v[34:35], v120 offset:13824
    s_waitcnt lgkmcnt(2)
    v_mfma_f32_16x16x32_bf16 v[112:115], v[28:31], v[28:31], v[112:115]
    v_mfma_f32_16x16x32_bf16 v[116:119], v[108:111], v[28:31], v[116:119]
    s_waitcnt vmcnt(45)
    ds_read_b64 v[36:37], v120 offset:14336
    ds_read_b64 v[38:39], v120 offset:14848
    s_waitcnt lgkmcnt(2)
    v_mfma_f32_16x16x32_bf16 v[112:115], v[32:35], v[32:35], v[112:115]
    v_mfma_f32_16x16x32_bf16 v[116:119], v[108:111], v[32:35], v[116:119]
    s_waitcnt vmcnt(44)
    ds_read_b64 v[40:41], v120 offset:15360
    ds_read_b64 v[42:43], v120 offset:15872
    s_waitcnt lgkmcnt(2)
    v_mfma_f32_16x16x32_bf16 v[112:115], v[36:39], v[36:39], v[112:115]
    v_mfma_f32_16x16x32_bf16 v[116:119], v[108:111], v[36:39], v[116:119]
    s_waitcnt vmcnt(43)
    ds_read_b64 v[12:13], v120 offset:16384
    ds_read_b64 v[14:15], v120 offset:16896
    s_waitcnt lgkmcnt(2)
    v_mfma_f32_16x16x32_bf16 v[112:115], v[40:43], v[40:43], v[112:115]
    v_mfma_f32_16x16x32_bf16 v[116:119], v[108:111], v[40:43], v[116:119]
    s_waitcnt vmcnt(42)
    ds_read_b64 v[16:17], v120 offset:17408
    ds_read_b64 v[18:19], v120 offset:17920
    s_waitcnt lgkmcnt(2)
    v_mfma_f32_16x16x32_bf16 v[112:115], v[12:15], v[12:15], v[112:115]
    v_mfma_f32_16x16x32_bf16 v[116:119], v[108:111], v[12:15], v[116:119]
    s_waitcnt vmcnt(41)
    ds_read_b64 v[20:21], v120 offset:18432
    ds_read_b64 v[22:23], v120 offset:18944
    s_waitcnt lgkmcnt(2)
    v_mfma_f32_16x16x32_bf16 v[112:115], v[16:19], v[16:19], v[112:115]
    v_mfma_f32_16x16x32_bf16 v[116:119], v[108:111], v[16:19], v[116:119]
    s_waitcnt vmcnt(40)
    ds_read_b64 v[24:25], v120 offset:19456
    ds_read_b64 v[26:27], v120 offset:19968
    s_waitcnt lgkmcnt(2)
    v_mfma_f32_16x16x32_bf16 v[112:115], v[20:23], v[20:23], v[112:115]
    v_mfma_f32_16x16x32_bf16 v[116:119], v[108:111], v[20:23], v[116:119]
    s_waitcnt lgkmcnt(0)
    v_mfma_f32_16x16x32_bf16 v[112:115], v[24:27], v[24:27], v[112:115]
    v_mfma_f32_16x16x32_bf16 v[116:119], v[108:111], v[24:27], v[116:119]
    s_lshl_b32 s11, s10, 11
    s_lshl_b32 s13, s8, 7
    s_add_u32 s11, s11, s13
    s_add_u32 s11, s11, 32768
    v_lshlrev_b32 v4, 2, v2
    v_lshlrev_b32 v5, 4, v3
    buffer_load_dword v122, v4, s[4:7], s11 offen offset:1024
    buffer_load_dword v123, v4, s[4:7], s11 offen offset:1536
    buffer_load_dwordx4 v[126:129], v5, s[4:7], s11 offen offset:0
    buffer_load_dwordx4 v[134:137], v5, s[4:7], s11 offen offset:512
    buffer_load_dword v124, v4, s[4:7], s11 offen offset:1088
    buffer_load_dword v125, v4, s[4:7], s11 offen offset:1600
    buffer_load_dwordx4 v[130:133], v5, s[4:7], s11 offen offset:64
    buffer_load_dwordx4 v[138:141], v5, s[4:7], s11 offen offset:576
    v_and_b32 v4, 3, v0
    v_cmp_eq_u32 vcc, 1, v4
    s_nop 1
    v_cndmask_b32 v112, v112, v113, vcc
    v_cmp_eq_u32 vcc, 2, v4
    s_nop 1
    v_cndmask_b32 v112, v112, v114, vcc
    v_cmp_eq_u32 vcc, 3, v4
    s_nop 1
    v_cndmask_b32 v112, v112, v115, vcc
    v_mul_f32 v116, 0xbacccccd, v116
    v_mul_f32 v112, 0x3acccccd, v112
    v_fma_f32 v112, -v116, v116, v112
    v_max_f32 v112, 0, v112
    v_add_f32 v112, 0x3727c5ac, v112
    v_rsq_f32 v112, v112
    v_lshrrev_b32 v4, 2, v2
    v_cmp_eq_u32 vcc, v4, v3
    s_lshl_b32 s11, s8, 6
    s_add_u32 s11, s11, 81920
    v_lshl_add_u32 v4, v2, 2, s11
    s_mov_b64 exec, vcc
    ds_write2st64_b32 v4, v112, v116 offset0:0 offset1:1
    s_mov_b64 exec, -1
    s_waitcnt lgkmcnt(0)
    s_barrier
    ds_read_b64 v[12:13], v9 offset:0
    ds_read_b64 v[14:15], v9 offset:512
    ds_read_b64 v[16:17], v9 offset:20480
    ds_read_b64 v[18:19], v9 offset:20992
    ds_read_b64 v[20:21], v10 offset:0
    ds_read_b64 v[22:23], v10 offset:512
    ds_read_b64 v[24:25], v10 offset:20480
    ds_read_b64 v[26:27], v10 offset:20992
    s_waitcnt vmcnt(47) lgkmcnt(6)
    v_mfma_f32_16x16x32_bf16 v[44:47], v[12:15], a[0:3], 0
    s_waitcnt vmcnt(46)
    v_mfma_f32_16x16x32_bf16 v[60:63], v[12:15], a[4:7], 0
    ds_read_b64 v[28:29], v9 offset:1024
    ds_read_b64 v[30:31], v9 offset:1536
    s_waitcnt lgkmcnt(6)
    v_mfma_f32_16x16x32_bf16 v[48:51], v[16:19], a[0:3], 0
    v_mfma_f32_16x16x32_bf16 v[64:67], v[16:19], a[4:7], 0
    ds_read_b64 v[32:33], v9 offset:21504
    ds_read_b64 v[34:35], v9 offset:22016
    s_waitcnt lgkmcnt(6)
    v_mfma_f32_16x16x32_bf16 v[52:55], v[20:23], a[0:3], 0
    v_mfma_f32_16x16x32_bf16 v[68:71], v[20:23], a[4:7], 0
    ds_read_b64 v[36:37], v10 offset:1024
    ds_read_b64 v[38:39], v10 offset:1536
    s_waitcnt lgkmcnt(6)
    v_mfma_f32_16x16x32_bf16 v[56:59], v[24:27], a[0:3], 0
    v_mfma_f32_16x16x32_bf16 v[72:75], v[24:27], a[4:7], 0
    ds_read_b64 v[40:41], v10 offset:21504
    ds_read_b64 v[42:43], v10 offset:22016
    buffer_load_dwordx4 a[0:3], v7, s[4:7], s20 offen offset:0
    buffer_load_dwordx4 a[4:7], v8, s[4:7], s20 offen offset:0
    s_waitcnt vmcnt(47) lgkmcnt(6)
    v_mfma_f32_16x16x32_bf16 v[44:47], v[28:31], a[8:11], v[44:47]
    s_waitcnt vmcnt(46)
    v_mfma_f32_16x16x32_bf16 v[60:63], v[28:31], a[12:15], v[60:63]
    ds_read_b64 v[12:13], v9 offset:2048
    ds_read_b64 v[14:15], v9 offset:2560
    s_waitcnt lgkmcnt(6)
    v_mfma_f32_16x16x32_bf16 v[48:51], v[32:35], a[8:11], v[48:51]
    v_mfma_f32_16x16x32_bf16 v[64:67], v[32:35], a[12:15], v[64:67]
    ds_read_b64 v[16:17], v9 offset:22528
    ds_read_b64 v[18:19], v9 offset:23040
    s_waitcnt lgkmcnt(6)
    v_mfma_f32_16x16x32_bf16 v[52:55], v[36:39], a[8:11], v[52:55]
    v_mfma_f32_16x16x32_bf16 v[68:71], v[36:39], a[12:15], v[68:71]
    ds_read_b64 v[20:21], v10 offset:2048
    ds_read_b64 v[22:23], v10 offset:2560
    s_waitcnt lgkmcnt(6)
    v_mfma_f32_16x16x32_bf16 v[56:59], v[40:43], a[8:11], v[56:59]
    v_mfma_f32_16x16x32_bf16 v[72:75], v[40:43], a[12:15], v[72:75]
    ds_read_b64 v[24:25], v10 offset:22528
    ds_read_b64 v[26:27], v10 offset:23040
    buffer_load_dwordx4 a[8:11], v7, s[4:7], s20 offen offset:1024
    buffer_load_dwordx4 a[12:15], v8, s[4:7], s20 offen offset:1024
    s_waitcnt vmcnt(47) lgkmcnt(6)
    v_mfma_f32_16x16x32_bf16 v[44:47], v[12:15], a[16:19], v[44:47]
    s_waitcnt vmcnt(46)
    v_mfma_f32_16x16x32_bf16 v[60:63], v[12:15], a[20:23], v[60:63]
    ds_read_b64 v[28:29], v9 offset:3072
    ds_read_b64 v[30:31], v9 offset:3584
    s_waitcnt lgkmcnt(6)
    v_mfma_f32_16x16x32_bf16 v[48:51], v[16:19], a[16:19], v[48:51]
    v_mfma_f32_16x16x32_bf16 v[64:67], v[16:19], a[20:23], v[64:67]
    ds_read_b64 v[32:33], v9 offset:23552
    ds_read_b64 v[34:35], v9 offset:24064
    s_waitcnt lgkmcnt(6)
    v_mfma_f32_16x16x32_bf16 v[52:55], v[20:23], a[16:19], v[52:55]
    v_mfma_f32_16x16x32_bf16 v[68:71], v[20:23], a[20:23], v[68:71]
    ds_read_b64 v[36:37], v10 offset:3072
    ds_read_b64 v[38:39], v10 offset:3584
    s_waitcnt lgkmcnt(6)
    v_mfma_f32_16x16x32_bf16 v[56:59], v[24:27], a[16:19], v[56:59]
    v_mfma_f32_16x16x32_bf16 v[72:75], v[24:27], a[20:23], v[72:75]
    ds_read_b64 v[40:41], v10 offset:23552
    ds_read_b64 v[42:43], v10 offset:24064
    buffer_load_dwordx4 a[16:19], v7, s[4:7], s20 offen offset:2048
    buffer_load_dwordx4 a[20:23], v8, s[4:7], s20 offen offset:2048
    s_waitcnt vmcnt(47) lgkmcnt(6)
    v_mfma_f32_16x16x32_bf16 v[44:47], v[28:31], a[24:27], v[44:47]
    s_waitcnt vmcnt(46)
    v_mfma_f32_16x16x32_bf16 v[60:63], v[28:31], a[28:31], v[60:63]
    ds_read_b64 v[12:13], v9 offset:4096
    ds_read_b64 v[14:15], v9 offset:4608
    s_waitcnt lgkmcnt(6)
    v_mfma_f32_16x16x32_bf16 v[48:51], v[32:35], a[24:27], v[48:51]
    v_mfma_f32_16x16x32_bf16 v[64:67], v[32:35], a[28:31], v[64:67]
    ds_read_b64 v[16:17], v9 offset:24576
    ds_read_b64 v[18:19], v9 offset:25088
    s_waitcnt lgkmcnt(6)
    v_mfma_f32_16x16x32_bf16 v[52:55], v[36:39], a[24:27], v[52:55]
    v_mfma_f32_16x16x32_bf16 v[68:71], v[36:39], a[28:31], v[68:71]
    ds_read_b64 v[20:21], v10 offset:4096
    ds_read_b64 v[22:23], v10 offset:4608
    s_waitcnt lgkmcnt(6)
    v_mfma_f32_16x16x32_bf16 v[56:59], v[40:43], a[24:27], v[56:59]
    v_mfma_f32_16x16x32_bf16 v[72:75], v[40:43], a[28:31], v[72:75]
    ds_read_b64 v[24:25], v10 offset:24576
    ds_read_b64 v[26:27], v10 offset:25088
    buffer_load_dwordx4 a[24:27], v7, s[4:7], s20 offen offset:3072
    buffer_load_dwordx4 a[28:31], v8, s[4:7], s20 offen offset:3072
    s_waitcnt vmcnt(47) lgkmcnt(6)
    v_mfma_f32_16x16x32_bf16 v[44:47], v[12:15], a[32:35], v[44:47]
    s_waitcnt vmcnt(46)
    v_mfma_f32_16x16x32_bf16 v[60:63], v[12:15], a[36:39], v[60:63]
    ds_read_b64 v[28:29], v9 offset:5120
    ds_read_b64 v[30:31], v9 offset:5632
    s_waitcnt lgkmcnt(6)
    v_mfma_f32_16x16x32_bf16 v[48:51], v[16:19], a[32:35], v[48:51]
    v_mfma_f32_16x16x32_bf16 v[64:67], v[16:19], a[36:39], v[64:67]
    ds_read_b64 v[32:33], v9 offset:25600
    ds_read_b64 v[34:35], v9 offset:26112
    s_waitcnt lgkmcnt(6)
    v_mfma_f32_16x16x32_bf16 v[52:55], v[20:23], a[32:35], v[52:55]
    v_mfma_f32_16x16x32_bf16 v[68:71], v[20:23], a[36:39], v[68:71]
    ds_read_b64 v[36:37], v10 offset:5120
    ds_read_b64 v[38:39], v10 offset:5632
    s_waitcnt lgkmcnt(6)
    v_mfma_f32_16x16x32_bf16 v[56:59], v[24:27], a[32:35], v[56:59]
    v_mfma_f32_16x16x32_bf16 v[72:75], v[24:27], a[36:39], v[72:75]
    ds_read_b64 v[40:41], v10 offset:25600
    ds_read_b64 v[42:43], v10 offset:26112
    buffer_load_dwordx4 a[32:35], v7, s[4:7], s21 offen offset:0
    buffer_load_dwordx4 a[36:39], v8, s[4:7], s21 offen offset:0
    s_waitcnt vmcnt(47) lgkmcnt(6)
    v_mfma_f32_16x16x32_bf16 v[44:47], v[28:31], a[40:43], v[44:47]
    s_waitcnt vmcnt(46)
    v_mfma_f32_16x16x32_bf16 v[60:63], v[28:31], a[44:47], v[60:63]
    ds_read_b64 v[12:13], v9 offset:6144
    ds_read_b64 v[14:15], v9 offset:6656
    s_waitcnt lgkmcnt(6)
    v_mfma_f32_16x16x32_bf16 v[48:51], v[32:35], a[40:43], v[48:51]
    v_mfma_f32_16x16x32_bf16 v[64:67], v[32:35], a[44:47], v[64:67]
    ds_read_b64 v[16:17], v9 offset:26624
    ds_read_b64 v[18:19], v9 offset:27136
    s_waitcnt lgkmcnt(6)
    v_mfma_f32_16x16x32_bf16 v[52:55], v[36:39], a[40:43], v[52:55]
    v_mfma_f32_16x16x32_bf16 v[68:71], v[36:39], a[44:47], v[68:71]
    ds_read_b64 v[20:21], v10 offset:6144
    ds_read_b64 v[22:23], v10 offset:6656
    s_waitcnt lgkmcnt(6)
    v_mfma_f32_16x16x32_bf16 v[56:59], v[40:43], a[40:43], v[56:59]
    v_mfma_f32_16x16x32_bf16 v[72:75], v[40:43], a[44:47], v[72:75]
    ds_read_b64 v[24:25], v10 offset:26624
    ds_read_b64 v[26:27], v10 offset:27136
    buffer_load_dwordx4 a[40:43], v7, s[4:7], s21 offen offset:1024
    buffer_load_dwordx4 a[44:47], v8, s[4:7], s21 offen offset:1024
    s_waitcnt vmcnt(47) lgkmcnt(6)
    v_mfma_f32_16x16x32_bf16 v[44:47], v[12:15], a[48:51], v[44:47]
    s_waitcnt vmcnt(46)
    v_mfma_f32_16x16x32_bf16 v[60:63], v[12:15], a[52:55], v[60:63]
    ds_read_b64 v[28:29], v9 offset:7168
    ds_read_b64 v[30:31], v9 offset:7680
    s_waitcnt lgkmcnt(6)
    v_mfma_f32_16x16x32_bf16 v[48:51], v[16:19], a[48:51], v[48:51]
    v_mfma_f32_16x16x32_bf16 v[64:67], v[16:19], a[52:55], v[64:67]
    ds_read_b64 v[32:33], v9 offset:27648
    ds_read_b64 v[34:35], v9 offset:28160
    s_waitcnt lgkmcnt(6)
    v_mfma_f32_16x16x32_bf16 v[52:55], v[20:23], a[48:51], v[52:55]
    v_mfma_f32_16x16x32_bf16 v[68:71], v[20:23], a[52:55], v[68:71]
    ds_read_b64 v[36:37], v10 offset:7168
    ds_read_b64 v[38:39], v10 offset:7680
    s_waitcnt lgkmcnt(6)
    v_mfma_f32_16x16x32_bf16 v[56:59], v[24:27], a[48:51], v[56:59]
    v_mfma_f32_16x16x32_bf16 v[72:75], v[24:27], a[52:55], v[72:75]
    ds_read_b64 v[40:41], v10 offset:27648
    ds_read_b64 v[42:43], v10 offset:28160
    buffer_load_dwordx4 a[48:51], v7, s[4:7], s21 offen offset:2048
    buffer_load_dwordx4 a[52:55], v8, s[4:7], s21 offen offset:2048
    s_waitcnt vmcnt(47) lgkmcnt(6)
    v_mfma_f32_16x16x32_bf16 v[44:47], v[28:31], a[56:59], v[44:47]
    s_waitcnt vmcnt(46)
    v_mfma_f32_16x16x32_bf16 v[60:63], v[28:31], a[60:63], v[60:63]
    ds_read_b64 v[12:13], v9 offset:8192
    ds_read_b64 v[14:15], v9 offset:8704
    s_waitcnt lgkmcnt(6)
    v_mfma_f32_16x16x32_bf16 v[48:51], v[32:35], a[56:59], v[48:51]
    v_mfma_f32_16x16x32_bf16 v[64:67], v[32:35], a[60:63], v[64:67]
    ds_read_b64 v[16:17], v9 offset:28672
    ds_read_b64 v[18:19], v9 offset:29184
    s_waitcnt lgkmcnt(6)
    v_mfma_f32_16x16x32_bf16 v[52:55], v[36:39], a[56:59], v[52:55]
    v_mfma_f32_16x16x32_bf16 v[68:71], v[36:39], a[60:63], v[68:71]
    ds_read_b64 v[20:21], v10 offset:8192
    ds_read_b64 v[22:23], v10 offset:8704
    s_waitcnt lgkmcnt(6)
    v_mfma_f32_16x16x32_bf16 v[56:59], v[40:43], a[56:59], v[56:59]
    v_mfma_f32_16x16x32_bf16 v[72:75], v[40:43], a[60:63], v[72:75]
    ds_read_b64 v[24:25], v10 offset:28672
    ds_read_b64 v[26:27], v10 offset:29184
    buffer_load_dwordx4 a[56:59], v7, s[4:7], s21 offen offset:3072
    buffer_load_dwordx4 a[60:63], v8, s[4:7], s21 offen offset:3072
    s_waitcnt vmcnt(47) lgkmcnt(6)
    v_mfma_f32_16x16x32_bf16 v[44:47], v[12:15], a[64:67], v[44:47]
    s_waitcnt vmcnt(46)
    v_mfma_f32_16x16x32_bf16 v[60:63], v[12:15], a[68:71], v[60:63]
    ds_read_b64 v[28:29], v9 offset:9216
    ds_read_b64 v[30:31], v9 offset:9728
    s_waitcnt lgkmcnt(6)
    v_mfma_f32_16x16x32_bf16 v[48:51], v[16:19], a[64:67], v[48:51]
    v_mfma_f32_16x16x32_bf16 v[64:67], v[16:19], a[68:71], v[64:67]
    ds_read_b64 v[32:33], v9 offset:29696
    ds_read_b64 v[34:35], v9 offset:30208
    s_waitcnt lgkmcnt(6)
    v_mfma_f32_16x16x32_bf16 v[52:55], v[20:23], a[64:67], v[52:55]
    v_mfma_f32_16x16x32_bf16 v[68:71], v[20:23], a[68:71], v[68:71]
    ds_read_b64 v[36:37], v10 offset:9216
    ds_read_b64 v[38:39], v10 offset:9728
    s_waitcnt lgkmcnt(6)
    v_mfma_f32_16x16x32_bf16 v[56:59], v[24:27], a[64:67], v[56:59]
    v_mfma_f32_16x16x32_bf16 v[72:75], v[24:27], a[68:71], v[72:75]
    ds_read_b64 v[40:41], v10 offset:29696
    ds_read_b64 v[42:43], v10 offset:30208
    buffer_load_dwordx4 a[64:67], v7, s[4:7], s22 offen offset:0
    buffer_load_dwordx4 a[68:71], v8, s[4:7], s22 offen offset:0
    s_waitcnt vmcnt(47) lgkmcnt(6)
    v_mfma_f32_16x16x32_bf16 v[44:47], v[28:31], a[72:75], v[44:47]
    s_waitcnt vmcnt(46)
    v_mfma_f32_16x16x32_bf16 v[60:63], v[28:31], a[76:79], v[60:63]
    ds_read_b64 v[12:13], v9 offset:10240
    ds_read_b64 v[14:15], v9 offset:10752
    s_waitcnt lgkmcnt(6)
    v_mfma_f32_16x16x32_bf16 v[48:51], v[32:35], a[72:75], v[48:51]
    v_mfma_f32_16x16x32_bf16 v[64:67], v[32:35], a[76:79], v[64:67]
    ds_read_b64 v[16:17], v9 offset:30720
    ds_read_b64 v[18:19], v9 offset:31232
    s_waitcnt lgkmcnt(6)
    v_mfma_f32_16x16x32_bf16 v[52:55], v[36:39], a[72:75], v[52:55]
    v_mfma_f32_16x16x32_bf16 v[68:71], v[36:39], a[76:79], v[68:71]
    ds_read_b64 v[20:21], v10 offset:10240
    ds_read_b64 v[22:23], v10 offset:10752
    s_waitcnt lgkmcnt(6)
    v_mfma_f32_16x16x32_bf16 v[56:59], v[40:43], a[72:75], v[56:59]
    v_mfma_f32_16x16x32_bf16 v[72:75], v[40:43], a[76:79], v[72:75]
    ds_read_b64 v[24:25], v10 offset:30720
    ds_read_b64 v[26:27], v10 offset:31232
    buffer_load_dwordx4 a[72:75], v7, s[4:7], s22 offen offset:1024
    buffer_load_dwordx4 a[76:79], v8, s[4:7], s22 offen offset:1024
    s_waitcnt vmcnt(47) lgkmcnt(6)
    v_mfma_f32_16x16x32_bf16 v[44:47], v[12:15], a[80:83], v[44:47]
    s_waitcnt vmcnt(46)
    v_mfma_f32_16x16x32_bf16 v[60:63], v[12:15], a[84:87], v[60:63]
    ds_read_b64 v[28:29], v9 offset:11264
    ds_read_b64 v[30:31], v9 offset:11776
    s_waitcnt lgkmcnt(6)
    v_mfma_f32_16x16x32_bf16 v[48:51], v[16:19], a[80:83], v[48:51]
    v_mfma_f32_16x16x32_bf16 v[64:67], v[16:19], a[84:87], v[64:67]
    ds_read_b64 v[32:33], v9 offset:31744
    ds_read_b64 v[34:35], v9 offset:32256
    s_waitcnt lgkmcnt(6)
    v_mfma_f32_16x16x32_bf16 v[52:55], v[20:23], a[80:83], v[52:55]
    v_mfma_f32_16x16x32_bf16 v[68:71], v[20:23], a[84:87], v[68:71]
    ds_read_b64 v[36:37], v10 offset:11264
    ds_read_b64 v[38:39], v10 offset:11776
    s_waitcnt lgkmcnt(6)
    v_mfma_f32_16x16x32_bf16 v[56:59], v[24:27], a[80:83], v[56:59]
    v_mfma_f32_16x16x32_bf16 v[72:75], v[24:27], a[84:87], v[72:75]
    ds_read_b64 v[40:41], v10 offset:31744
    ds_read_b64 v[42:43], v10 offset:32256
    buffer_load_dwordx4 a[80:83], v7, s[4:7], s22 offen offset:2048
    buffer_load_dwordx4 a[84:87], v8, s[4:7], s22 offen offset:2048
    s_waitcnt vmcnt(47) lgkmcnt(6)
    v_mfma_f32_16x16x32_bf16 v[44:47], v[28:31], a[88:91], v[44:47]
    s_waitcnt vmcnt(46)
    v_mfma_f32_16x16x32_bf16 v[60:63], v[28:31], a[92:95], v[60:63]
    ds_read_b64 v[12:13], v9 offset:12288
    ds_read_b64 v[14:15], v9 offset:12800
    s_waitcnt lgkmcnt(6)
    v_mfma_f32_16x16x32_bf16 v[48:51], v[32:35], a[88:91], v[48:51]
    v_mfma_f32_16x16x32_bf16 v[64:67], v[32:35], a[92:95], v[64:67]
    ds_read_b64 v[16:17], v9 offset:32768
    ds_read_b64 v[18:19], v9 offset:33280
    s_waitcnt lgkmcnt(6)
    v_mfma_f32_16x16x32_bf16 v[52:55], v[36:39], a[88:91], v[52:55]
    v_mfma_f32_16x16x32_bf16 v[68:71], v[36:39], a[92:95], v[68:71]
    ds_read_b64 v[20:21], v10 offset:12288
    ds_read_b64 v[22:23], v10 offset:12800
    s_waitcnt lgkmcnt(6)
    v_mfma_f32_16x16x32_bf16 v[56:59], v[40:43], a[88:91], v[56:59]
    v_mfma_f32_16x16x32_bf16 v[72:75], v[40:43], a[92:95], v[72:75]
    ds_read_b64 v[24:25], v10 offset:32768
    ds_read_b64 v[26:27], v10 offset:33280
    buffer_load_dwordx4 a[88:91], v7, s[4:7], s22 offen offset:3072
    buffer_load_dwordx4 a[92:95], v8, s[4:7], s22 offen offset:3072
    s_waitcnt vmcnt(47) lgkmcnt(6)
    v_mfma_f32_16x16x32_bf16 v[44:47], v[12:15], a[96:99], v[44:47]
    s_waitcnt vmcnt(46)
    v_mfma_f32_16x16x32_bf16 v[60:63], v[12:15], a[100:103], v[60:63]
    ds_read_b64 v[28:29], v9 offset:13312
    ds_read_b64 v[30:31], v9 offset:13824
    s_waitcnt lgkmcnt(6)
    v_mfma_f32_16x16x32_bf16 v[48:51], v[16:19], a[96:99], v[48:51]
    v_mfma_f32_16x16x32_bf16 v[64:67], v[16:19], a[100:103], v[64:67]
    ds_read_b64 v[32:33], v9 offset:33792
    ds_read_b64 v[34:35], v9 offset:34304
    s_waitcnt lgkmcnt(6)
    v_mfma_f32_16x16x32_bf16 v[52:55], v[20:23], a[96:99], v[52:55]
    v_mfma_f32_16x16x32_bf16 v[68:71], v[20:23], a[100:103], v[68:71]
    ds_read_b64 v[36:37], v10 offset:13312
    ds_read_b64 v[38:39], v10 offset:13824
    s_waitcnt lgkmcnt(6)
    v_mfma_f32_16x16x32_bf16 v[56:59], v[24:27], a[96:99], v[56:59]
    v_mfma_f32_16x16x32_bf16 v[72:75], v[24:27], a[100:103], v[72:75]
    ds_read_b64 v[40:41], v10 offset:33792
    ds_read_b64 v[42:43], v10 offset:34304
    buffer_load_dwordx4 a[96:99], v7, s[4:7], s23 offen offset:0
    buffer_load_dwordx4 a[100:103], v8, s[4:7], s23 offen offset:0
    s_waitcnt vmcnt(47) lgkmcnt(6)
    v_mfma_f32_16x16x32_bf16 v[44:47], v[28:31], a[104:107], v[44:47]
    s_waitcnt vmcnt(46)
    v_mfma_f32_16x16x32_bf16 v[60:63], v[28:31], a[108:111], v[60:63]
    ds_read_b64 v[12:13], v9 offset:14336
    ds_read_b64 v[14:15], v9 offset:14848
    s_waitcnt lgkmcnt(6)
    v_mfma_f32_16x16x32_bf16 v[48:51], v[32:35], a[104:107], v[48:51]
    v_mfma_f32_16x16x32_bf16 v[64:67], v[32:35], a[108:111], v[64:67]
    ds_read_b64 v[16:17], v9 offset:34816
    ds_read_b64 v[18:19], v9 offset:35328
    s_waitcnt lgkmcnt(6)
    v_mfma_f32_16x16x32_bf16 v[52:55], v[36:39], a[104:107], v[52:55]
    v_mfma_f32_16x16x32_bf16 v[68:71], v[36:39], a[108:111], v[68:71]
    ds_read_b64 v[20:21], v10 offset:14336
    ds_read_b64 v[22:23], v10 offset:14848
    s_waitcnt lgkmcnt(6)
    v_mfma_f32_16x16x32_bf16 v[56:59], v[40:43], a[104:107], v[56:59]
    v_mfma_f32_16x16x32_bf16 v[72:75], v[40:43], a[108:111], v[72:75]
    ds_read_b64 v[24:25], v10 offset:34816
    ds_read_b64 v[26:27], v10 offset:35328
    buffer_load_dwordx4 a[104:107], v7, s[4:7], s23 offen offset:1024
    buffer_load_dwordx4 a[108:111], v8, s[4:7], s23 offen offset:1024
    s_waitcnt vmcnt(47) lgkmcnt(6)
    v_mfma_f32_16x16x32_bf16 v[44:47], v[12:15], a[112:115], v[44:47]
    s_waitcnt vmcnt(46)
    v_mfma_f32_16x16x32_bf16 v[60:63], v[12:15], a[116:119], v[60:63]
    ds_read_b64 v[28:29], v9 offset:15360
    ds_read_b64 v[30:31], v9 offset:15872
    s_waitcnt lgkmcnt(6)
    v_mfma_f32_16x16x32_bf16 v[48:51], v[16:19], a[112:115], v[48:51]
    v_mfma_f32_16x16x32_bf16 v[64:67], v[16:19], a[116:119], v[64:67]
    ds_read_b64 v[32:33], v9 offset:35840
    ds_read_b64 v[34:35], v9 offset:36352
    s_waitcnt lgkmcnt(6)
    v_mfma_f32_16x16x32_bf16 v[52:55], v[20:23], a[112:115], v[52:55]
    v_mfma_f32_16x16x32_bf16 v[68:71], v[20:23], a[116:119], v[68:71]
    ds_read_b64 v[36:37], v10 offset:15360
    ds_read_b64 v[38:39], v10 offset:15872
    s_waitcnt lgkmcnt(6)
    v_mfma_f32_16x16x32_bf16 v[56:59], v[24:27], a[112:115], v[56:59]
    v_mfma_f32_16x16x32_bf16 v[72:75], v[24:27], a[116:119], v[72:75]
    ds_read_b64 v[40:41], v10 offset:35840
    ds_read_b64 v[42:43], v10 offset:36352
    buffer_load_dwordx4 a[112:115], v7, s[4:7], s23 offen offset:2048
    buffer_load_dwordx4 a[116:119], v8, s[4:7], s23 offen offset:2048
    s_waitcnt vmcnt(47) lgkmcnt(6)
    v_mfma_f32_16x16x32_bf16 v[44:47], v[28:31], a[120:123], v[44:47]
    s_waitcnt vmcnt(46)
    v_mfma_f32_16x16x32_bf16 v[60:63], v[28:31], a[124:127], v[60:63]
    ds_read_b64 v[12:13], v9 offset:16384
    ds_read_b64 v[14:15], v9 offset:16896
    s_waitcnt lgkmcnt(6)
    v_mfma_f32_16x16x32_bf16 v[48:51], v[32:35], a[120:123], v[48:51]
    v_mfma_f32_16x16x32_bf16 v[64:67], v[32:35], a[124:127], v[64:67]
    ds_read_b64 v[16:17], v9 offset:36864
    ds_read_b64 v[18:19], v9 offset:37376
    s_waitcnt lgkmcnt(6)
    v_mfma_f32_16x16x32_bf16 v[52:55], v[36:39], a[120:123], v[52:55]
    v_mfma_f32_16x16x32_bf16 v[68:71], v[36:39], a[124:127], v[68:71]
    ds_read_b64 v[20:21], v10 offset:16384
    ds_read_b64 v[22:23], v10 offset:16896
    s_waitcnt lgkmcnt(6)
    v_mfma_f32_16x16x32_bf16 v[56:59], v[40:43], a[120:123], v[56:59]
    v_mfma_f32_16x16x32_bf16 v[72:75], v[40:43], a[124:127], v[72:75]
    ds_read_b64 v[24:25], v10 offset:36864
    ds_read_b64 v[26:27], v10 offset:37376
    buffer_load_dwordx4 a[120:123], v7, s[4:7], s23 offen offset:3072
    buffer_load_dwordx4 a[124:127], v8, s[4:7], s23 offen offset:3072
    s_waitcnt vmcnt(47) lgkmcnt(6)
    v_mfma_f32_16x16x32_bf16 v[44:47], v[12:15], a[128:131], v[44:47]
    s_waitcnt vmcnt(46)
    v_mfma_f32_16x16x32_bf16 v[60:63], v[12:15], a[132:135], v[60:63]
    ds_read_b64 v[28:29], v9 offset:17408
    ds_read_b64 v[30:31], v9 offset:17920
    s_waitcnt lgkmcnt(6)
    v_mfma_f32_16x16x32_bf16 v[48:51], v[16:19], a[128:131], v[48:51]
    v_mfma_f32_16x16x32_bf16 v[64:67], v[16:19], a[132:135], v[64:67]
    ds_read_b64 v[32:33], v9 offset:37888
    ds_read_b64 v[34:35], v9 offset:38400
    s_waitcnt lgkmcnt(6)
    v_mfma_f32_16x16x32_bf16 v[52:55], v[20:23], a[128:131], v[52:55]
    v_mfma_f32_16x16x32_bf16 v[68:71], v[20:23], a[132:135], v[68:71]
    ds_read_b64 v[36:37], v10 offset:17408
    ds_read_b64 v[38:39], v10 offset:17920
    s_waitcnt lgkmcnt(6)
    v_mfma_f32_16x16x32_bf16 v[56:59], v[24:27], a[128:131], v[56:59]
    v_mfma_f32_16x16x32_bf16 v[72:75], v[24:27], a[132:135], v[72:75]
    ds_read_b64 v[40:41], v10 offset:37888
    ds_read_b64 v[42:43], v10 offset:38400
    buffer_load_dwordx4 a[128:131], v7, s[4:7], s24 offen offset:0
    buffer_load_dwordx4 a[132:135], v8, s[4:7], s24 offen offset:0
    s_waitcnt vmcnt(47) lgkmcnt(6)
    v_mfma_f32_16x16x32_bf16 v[44:47], v[28:31], a[136:139], v[44:47]
    s_waitcnt vmcnt(46)
    v_mfma_f32_16x16x32_bf16 v[60:63], v[28:31], a[140:143], v[60:63]
    ds_read_b64 v[12:13], v9 offset:18432
    ds_read_b64 v[14:15], v9 offset:18944
    s_waitcnt lgkmcnt(6)
    v_mfma_f32_16x16x32_bf16 v[48:51], v[32:35], a[136:139], v[48:51]
    v_mfma_f32_16x16x32_bf16 v[64:67], v[32:35], a[140:143], v[64:67]
    ds_read_b64 v[16:17], v9 offset:38912
    ds_read_b64 v[18:19], v9 offset:39424
    s_waitcnt lgkmcnt(6)
    v_mfma_f32_16x16x32_bf16 v[52:55], v[36:39], a[136:139], v[52:55]
    v_mfma_f32_16x16x32_bf16 v[68:71], v[36:39], a[140:143], v[68:71]
    ds_read_b64 v[20:21], v10 offset:18432
    ds_read_b64 v[22:23], v10 offset:18944
    s_waitcnt lgkmcnt(6)
    v_mfma_f32_16x16x32_bf16 v[56:59], v[40:43], a[136:139], v[56:59]
    v_mfma_f32_16x16x32_bf16 v[72:75], v[40:43], a[140:143], v[72:75]
    ds_read_b64 v[24:25], v10 offset:38912
    ds_read_b64 v[26:27], v10 offset:39424
    buffer_load_dwordx4 a[136:139], v7, s[4:7], s24 offen offset:1024
    buffer_load_dwordx4 a[140:143], v8, s[4:7], s24 offen offset:1024
    s_waitcnt vmcnt(47) lgkmcnt(6)
    v_mfma_f32_16x16x32_bf16 v[44:47], v[12:15], a[144:147], v[44:47]
    s_waitcnt vmcnt(46)
    v_mfma_f32_16x16x32_bf16 v[60:63], v[12:15], a[148:151], v[60:63]
    ds_read_b64 v[28:29], v9 offset:19456
    ds_read_b64 v[30:31], v9 offset:19968
    s_waitcnt lgkmcnt(6)
    v_mfma_f32_16x16x32_bf16 v[48:51], v[16:19], a[144:147], v[48:51]
    v_mfma_f32_16x16x32_bf16 v[64:67], v[16:19], a[148:151], v[64:67]
    ds_read_b64 v[32:33], v9 offset:39936
    ds_read_b64 v[34:35], v9 offset:40448
    s_waitcnt lgkmcnt(6)
    v_mfma_f32_16x16x32_bf16 v[52:55], v[20:23], a[144:147], v[52:55]
    v_mfma_f32_16x16x32_bf16 v[68:71], v[20:23], a[148:151], v[68:71]
    ds_read_b64 v[36:37], v10 offset:19456
    ds_read_b64 v[38:39], v10 offset:19968
    s_waitcnt lgkmcnt(6)
    v_mfma_f32_16x16x32_bf16 v[56:59], v[24:27], a[144:147], v[56:59]
    v_mfma_f32_16x16x32_bf16 v[72:75], v[24:27], a[148:151], v[72:75]
    ds_read_b64 v[40:41], v10 offset:39936
    ds_read_b64 v[42:43], v10 offset:40448
    buffer_load_dwordx4 a[144:147], v7, s[4:7], s24 offen offset:2048
    buffer_load_dwordx4 a[148:151], v8, s[4:7], s24 offen offset:2048
    s_waitcnt vmcnt(47) lgkmcnt(6)
    v_mfma_f32_16x16x32_bf16 v[44:47], v[28:31], a[152:155], v[44:47]
    s_waitcnt vmcnt(46)
    v_mfma_f32_16x16x32_bf16 v[60:63], v[28:31], a[156:159], v[60:63]
    s_waitcnt lgkmcnt(4)
    v_mfma_f32_16x16x32_bf16 v[48:51], v[32:35], a[152:155], v[48:51]
    v_mfma_f32_16x16x32_bf16 v[64:67], v[32:35], a[156:159], v[64:67]
    s_waitcnt lgkmcnt(2)
    v_mfma_f32_16x16x32_bf16 v[52:55], v[36:39], a[152:155], v[52:55]
    v_mfma_f32_16x16x32_bf16 v[68:71], v[36:39], a[156:159], v[68:71]
    s_waitcnt lgkmcnt(0)
    v_mfma_f32_16x16x32_bf16 v[56:59], v[40:43], a[152:155], v[56:59]
    v_mfma_f32_16x16x32_bf16 v[72:75], v[40:43], a[156:159], v[72:75]
    buffer_load_dwordx4 a[152:155], v7, s[4:7], s24 offen offset:3072
    buffer_load_dwordx4 a[156:159], v8, s[4:7], s24 offen offset:3072
    v_lshlrev_b32 v208, 4, v3
    v_add_u32 v4, 81920, v208
    ds_read_b128 v[160:163], v4 offset:256
    ds_read_b128 v[144:147], v4 offset:0
    ds_read_b128 v[164:167], v4 offset:320
    ds_read_b128 v[148:151], v4 offset:64
    ds_read_b128 v[168:171], v4 offset:384
    ds_read_b128 v[152:155], v4 offset:128
    ds_read_b128 v[172:175], v4 offset:448
    ds_read_b128 v[156:159], v4 offset:192
    s_waitcnt vmcnt(46) lgkmcnt(7)
    v_pk_fma_f32 v[44:45], v[160:161], v[122:123], v[44:45] op_sel:[0,0,0] op_sel_hi:[1,0,1]
    v_pk_fma_f32 v[46:47], v[162:163], v[122:123], v[46:47] op_sel:[0,0,0] op_sel_hi:[1,0,1]
    s_waitcnt vmcnt(42)
    v_pk_fma_f32 v[60:61], v[160:161], v[124:125], v[60:61] op_sel:[0,0,0] op_sel_hi:[1,0,1]
    v_pk_fma_f32 v[62:63], v[162:163], v[124:125], v[62:63] op_sel:[0,0,0] op_sel_hi:[1,0,1]
    s_waitcnt lgkmcnt(6)
    v_pk_fma_f32 v[44:45], v[44:45], v[144:145], v[122:123] op_sel:[0,0,1] op_sel_hi:[1,1,1]
    v_pk_fma_f32 v[46:47], v[46:47], v[146:147], v[122:123] op_sel:[0,0,1] op_sel_hi:[1,1,1]
    v_pk_fma_f32 v[60:61], v[60:61], v[144:145], v[124:125] op_sel:[0,0,1] op_sel_hi:[1,1,1]
    v_pk_fma_f32 v[62:63], v[62:63], v[146:147], v[124:125] op_sel:[0,0,1] op_sel_hi:[1,1,1]
    v_pk_mul_f32 v[176:177], v[44:45], v[44:45]
    v_pk_mul_f32 v[178:179], v[46:47], v[46:47]
    v_pk_mul_f32 v[180:181], v[60:61], v[60:61]
    v_pk_mul_f32 v[182:183], v[62:63], v[62:63]
    v_pk_fma_f32 v[176:177], v[176:177], s[26:27], s[26:27] op_sel:[0,0,1] op_sel_hi:[1,0,1]
    v_pk_fma_f32 v[178:179], v[178:179], s[26:27], s[26:27] op_sel:[0,0,1] op_sel_hi:[1,0,1]
    v_pk_fma_f32 v[180:181], v[180:181], s[26:27], s[26:27] op_sel:[0,0,1] op_sel_hi:[1,0,1]
    v_pk_fma_f32 v[182:183], v[182:183], s[26:27], s[26:27] op_sel:[0,0,1] op_sel_hi:[1,0,1]
    v_pk_mul_f32 v[176:177], v[176:177], v[44:45]
    v_pk_mul_f32 v[178:179], v[178:179], v[46:47]
    v_pk_mul_f32 v[180:181], v[180:181], v[60:61]
    v_pk_mul_f32 v[182:183], v[182:183], v[62:63]
    v_exp_f32 v176, v176
    v_exp_f32 v177, v177
    v_exp_f32 v178, v178
    v_exp_f32 v179, v179
    v_exp_f32 v180, v180
    v_exp_f32 v181, v181
    v_exp_f32 v182, v182
    v_exp_f32 v183, v183
    v_pk_add_f32 v[176:177], v[176:177], s[28:29]
    v_pk_add_f32 v[178:179], v[178:179], s[28:29]
    v_pk_add_f32 v[180:181], v[180:181], s[28:29]
    v_pk_add_f32 v[182:183], v[182:183], s[28:29]
    v_rcp_f32 v176, v176
    v_rcp_f32 v177, v177
    v_rcp_f32 v178, v178
    v_rcp_f32 v179, v179
    v_rcp_f32 v180, v180
    v_rcp_f32 v181, v181
    v_rcp_f32 v182, v182
    v_rcp_f32 v183, v183
    v_pk_mul_f32 v[44:45], v[44:45], v[176:177]
    v_pk_mul_f32 v[46:47], v[46:47], v[178:179]
    v_pk_mul_f32 v[60:61], v[60:61], v[180:181]
    v_pk_mul_f32 v[62:63], v[62:63], v[182:183]
    s_waitcnt lgkmcnt(5)
    v_pk_fma_f32 v[48:49], v[164:165], v[122:123], v[48:49] op_sel:[0,0,0] op_sel_hi:[1,0,1]
    v_pk_fma_f32 v[50:51], v[166:167], v[122:123], v[50:51] op_sel:[0,0,0] op_sel_hi:[1,0,1]
    v_pk_fma_f32 v[64:65], v[164:165], v[124:125], v[64:65] op_sel:[0,0,0] op_sel_hi:[1,0,1]
    v_pk_fma_f32 v[66:67], v[166:167], v[124:125], v[66:67] op_sel:[0,0,0] op_sel_hi:[1,0,1]
    s_waitcnt lgkmcnt(4)
    v_pk_fma_f32 v[48:49], v[48:49], v[148:149], v[122:123] op_sel:[0,0,1] op_sel_hi:[1,1,1]
    v_pk_fma_f32 v[50:51], v[50:51], v[150:151], v[122:123] op_sel:[0,0,1] op_sel_hi:[1,1,1]
    v_pk_fma_f32 v[64:65], v[64:65], v[148:149], v[124:125] op_sel:[0,0,1] op_sel_hi:[1,1,1]
    v_pk_fma_f32 v[66:67], v[66:67], v[150:151], v[124:125] op_sel:[0,0,1] op_sel_hi:[1,1,1]
    v_pk_mul_f32 v[176:177], v[48:49], v[48:49]
    v_pk_mul_f32 v[178:179], v[50:51], v[50:51]
    v_pk_mul_f32 v[180:181], v[64:65], v[64:65]
    v_pk_mul_f32 v[182:183], v[66:67], v[66:67]
    v_pk_fma_f32 v[176:177], v[176:177], s[26:27], s[26:27] op_sel:[0,0,1] op_sel_hi:[1,0,1]
    v_pk_fma_f32 v[178:179], v[178:179], s[26:27], s[26:27] op_sel:[0,0,1] op_sel_hi:[1,0,1]
    v_pk_fma_f32 v[180:181], v[180:181], s[26:27], s[26:27] op_sel:[0,0,1] op_sel_hi:[1,0,1]
    v_pk_fma_f32 v[182:183], v[182:183], s[26:27], s[26:27] op_sel:[0,0,1] op_sel_hi:[1,0,1]
    v_pk_mul_f32 v[176:177], v[176:177], v[48:49]
    v_pk_mul_f32 v[178:179], v[178:179], v[50:51]
    v_pk_mul_f32 v[180:181], v[180:181], v[64:65]
    v_pk_mul_f32 v[182:183], v[182:183], v[66:67]
    v_exp_f32 v176, v176
    v_exp_f32 v177, v177
    v_exp_f32 v178, v178
    v_exp_f32 v179, v179
    v_exp_f32 v180, v180
    v_exp_f32 v181, v181
    v_exp_f32 v182, v182
    v_exp_f32 v183, v183
    v_pk_add_f32 v[176:177], v[176:177], s[28:29]
    v_pk_add_f32 v[178:179], v[178:179], s[28:29]
    v_pk_add_f32 v[180:181], v[180:181], s[28:29]
    v_pk_add_f32 v[182:183], v[182:183], s[28:29]
    v_rcp_f32 v176, v176
    v_rcp_f32 v177, v177
    v_rcp_f32 v178, v178
    v_rcp_f32 v179, v179
    v_rcp_f32 v180, v180
    v_rcp_f32 v181, v181
    v_rcp_f32 v182, v182
    v_rcp_f32 v183, v183
    v_pk_mul_f32 v[48:49], v[48:49], v[176:177]
    v_pk_mul_f32 v[50:51], v[50:51], v[178:179]
    v_pk_mul_f32 v[64:65], v[64:65], v[180:181]
    v_pk_mul_f32 v[66:67], v[66:67], v[182:183]
    s_waitcnt lgkmcnt(3)
    v_pk_fma_f32 v[52:53], v[168:169], v[122:123], v[52:53] op_sel:[0,0,0] op_sel_hi:[1,0,1]
    v_pk_fma_f32 v[54:55], v[170:171], v[122:123], v[54:55] op_sel:[0,0,0] op_sel_hi:[1,0,1]
    v_pk_fma_f32 v[68:69], v[168:169], v[124:125], v[68:69] op_sel:[0,0,0] op_sel_hi:[1,0,1]
    v_pk_fma_f32 v[70:71], v[170:171], v[124:125], v[70:71] op_sel:[0,0,0] op_sel_hi:[1,0,1]
    s_waitcnt lgkmcnt(2)
    v_pk_fma_f32 v[52:53], v[52:53], v[152:153], v[122:123] op_sel:[0,0,1] op_sel_hi:[1,1,1]
    v_pk_fma_f32 v[54:55], v[54:55], v[154:155], v[122:123] op_sel:[0,0,1] op_sel_hi:[1,1,1]
    v_pk_fma_f32 v[68:69], v[68:69], v[152:153], v[124:125] op_sel:[0,0,1] op_sel_hi:[1,1,1]
    v_pk_fma_f32 v[70:71], v[70:71], v[154:155], v[124:125] op_sel:[0,0,1] op_sel_hi:[1,1,1]
    v_pk_mul_f32 v[176:177], v[52:53], v[52:53]
    v_pk_mul_f32 v[178:179], v[54:55], v[54:55]
    v_pk_mul_f32 v[180:181], v[68:69], v[68:69]
    v_pk_mul_f32 v[182:183], v[70:71], v[70:71]
    v_pk_fma_f32 v[176:177], v[176:177], s[26:27], s[26:27] op_sel:[0,0,1] op_sel_hi:[1,0,1]
    v_pk_fma_f32 v[178:179], v[178:179], s[26:27], s[26:27] op_sel:[0,0,1] op_sel_hi:[1,0,1]
    v_pk_fma_f32 v[180:181], v[180:181], s[26:27], s[26:27] op_sel:[0,0,1] op_sel_hi:[1,0,1]
    v_pk_fma_f32 v[182:183], v[182:183], s[26:27], s[26:27] op_sel:[0,0,1] op_sel_hi:[1,0,1]
    v_pk_mul_f32 v[176:177], v[176:177], v[52:53]
    v_pk_mul_f32 v[178:179], v[178:179], v[54:55]
    v_pk_mul_f32 v[180:181], v[180:181], v[68:69]
    v_pk_mul_f32 v[182:183], v[182:183], v[70:71]
    v_exp_f32 v176, v176
    v_exp_f32 v177, v177
    v_exp_f32 v178, v178
    v_exp_f32 v179, v179
    v_exp_f32 v180, v180
    v_exp_f32 v181, v181
    v_exp_f32 v182, v182
    v_exp_f32 v183, v183
    v_pk_add_f32 v[176:177], v[176:177], s[28:29]
    v_pk_add_f32 v[178:179], v[178:179], s[28:29]
    v_pk_add_f32 v[180:181], v[180:181], s[28:29]
    v_pk_add_f32 v[182:183], v[182:183], s[28:29]
    v_rcp_f32 v176, v176
    v_rcp_f32 v177, v177
    v_rcp_f32 v178, v178
    v_rcp_f32 v179, v179
    v_rcp_f32 v180, v180
    v_rcp_f32 v181, v181
    v_rcp_f32 v182, v182
    v_rcp_f32 v183, v183
    v_pk_mul_f32 v[52:53], v[52:53], v[176:177]
    v_pk_mul_f32 v[54:55], v[54:55], v[178:179]
    v_pk_mul_f32 v[68:69], v[68:69], v[180:181]
    v_pk_mul_f32 v[70:71], v[70:71], v[182:183]
    s_waitcnt lgkmcnt(1)
    v_pk_fma_f32 v[56:57], v[172:173], v[122:123], v[56:57] op_sel:[0,0,0] op_sel_hi:[1,0,1]
    v_pk_fma_f32 v[58:59], v[174:175], v[122:123], v[58:59] op_sel:[0,0,0] op_sel_hi:[1,0,1]
    v_pk_fma_f32 v[72:73], v[172:173], v[124:125], v[72:73] op_sel:[0,0,0] op_sel_hi:[1,0,1]
    v_pk_fma_f32 v[74:75], v[174:175], v[124:125], v[74:75] op_sel:[0,0,0] op_sel_hi:[1,0,1]
    s_waitcnt lgkmcnt(0)
    v_pk_fma_f32 v[56:57], v[56:57], v[156:157], v[122:123] op_sel:[0,0,1] op_sel_hi:[1,1,1]
    v_pk_fma_f32 v[58:59], v[58:59], v[158:159], v[122:123] op_sel:[0,0,1] op_sel_hi:[1,1,1]
    v_pk_fma_f32 v[72:73], v[72:73], v[156:157], v[124:125] op_sel:[0,0,1] op_sel_hi:[1,1,1]
    v_pk_fma_f32 v[74:75], v[74:75], v[158:159], v[124:125] op_sel:[0,0,1] op_sel_hi:[1,1,1]
    v_pk_mul_f32 v[176:177], v[56:57], v[56:57]
    v_pk_mul_f32 v[178:179], v[58:59], v[58:59]
    v_pk_mul_f32 v[180:181], v[72:73], v[72:73]
    v_pk_mul_f32 v[182:183], v[74:75], v[74:75]
    v_pk_fma_f32 v[176:177], v[176:177], s[26:27], s[26:27] op_sel:[0,0,1] op_sel_hi:[1,0,1]
    v_pk_fma_f32 v[178:179], v[178:179], s[26:27], s[26:27] op_sel:[0,0,1] op_sel_hi:[1,0,1]
    v_pk_fma_f32 v[180:181], v[180:181], s[26:27], s[26:27] op_sel:[0,0,1] op_sel_hi:[1,0,1]
    v_pk_fma_f32 v[182:183], v[182:183], s[26:27], s[26:27] op_sel:[0,0,1] op_sel_hi:[1,0,1]
    v_pk_mul_f32 v[176:177], v[176:177], v[56:57]
    v_pk_mul_f32 v[178:179], v[178:179], v[58:59]
    v_pk_mul_f32 v[180:181], v[180:181], v[72:73]
    v_pk_mul_f32 v[182:183], v[182:183], v[74:75]
    v_exp_f32 v176, v176
    v_exp_f32 v177, v177
    v_exp_f32 v178, v178
    v_exp_f32 v179, v179
    v_exp_f32 v180, v180
    v_exp_f32 v181, v181
    v_exp_f32 v182, v182
    v_exp_f32 v183, v183
    v_pk_add_f32 v[176:177], v[176:177], s[28:29]
    v_pk_add_f32 v[178:179], v[178:179], s[28:29]
    v_pk_add_f32 v[180:181], v[180:181], s[28:29]
    v_pk_add_f32 v[182:183], v[182:183], s[28:29]
    v_rcp_f32 v176, v176
    v_rcp_f32 v177, v177
    v_rcp_f32 v178, v178
    v_rcp_f32 v179, v179
    v_rcp_f32 v180, v180
    v_rcp_f32 v181, v181
    v_rcp_f32 v182, v182
    v_rcp_f32 v183, v183
    v_pk_mul_f32 v[56:57], v[56:57], v[176:177]
    v_pk_mul_f32 v[58:59], v[58:59], v[178:179]
    v_pk_mul_f32 v[72:73], v[72:73], v[180:181]
    v_pk_mul_f32 v[74:75], v[74:75], v[182:183]
    v_pk_add_f32 v[144:145], v[44:45], v[60:61]
    v_pk_mul_f32 v[160:161], v[44:45], v[44:45]
    v_pk_add_f32 v[146:147], v[46:47], v[62:63]
    v_pk_mul_f32 v[162:163], v[46:47], v[46:47]
    v_pk_fma_f32 v[160:161], v[60:61], v[60:61], v[160:161]
    v_pk_fma_f32 v[162:163], v[62:63], v[62:63], v[162:163]
    v_pk_add_f32 v[148:149], v[48:49], v[64:65]
    v_pk_mul_f32 v[164:165], v[48:49], v[48:49]
    v_pk_add_f32 v[150:151], v[50:51], v[66:67]
    v_pk_mul_f32 v[166:167], v[50:51], v[50:51]
    v_pk_fma_f32 v[164:165], v[64:65], v[64:65], v[164:165]
    v_pk_fma_f32 v[166:167], v[66:67], v[66:67], v[166:167]
    v_pk_add_f32 v[152:153], v[52:53], v[68:69]
    v_pk_mul_f32 v[168:169], v[52:53], v[52:53]
    v_pk_add_f32 v[154:155], v[54:55], v[70:71]
    v_pk_mul_f32 v[170:171], v[54:55], v[54:55]
    v_pk_fma_f32 v[168:169], v[68:69], v[68:69], v[168:169]
    v_pk_fma_f32 v[170:171], v[70:71], v[70:71], v[170:171]
    v_pk_add_f32 v[156:157], v[56:57], v[72:73]
    v_pk_mul_f32 v[172:173], v[56:57], v[56:57]
    v_pk_add_f32 v[158:159], v[58:59], v[74:75]
    v_pk_mul_f32 v[174:175], v[58:59], v[58:59]
    v_pk_fma_f32 v[172:173], v[72:73], v[72:73], v[172:173]
    v_pk_fma_f32 v[174:175], v[74:75], v[74:75], v[174:175]
    v_add_f32_dpp v144, v144, v144 row_ror:8 row_mask:0xf bank_mask:3
    v_add_f32_dpp v145, v145, v145 row_ror:8 row_mask:0xf bank_mask:3
    v_add_f32_dpp v146, v146, v146 row_ror:8 row_mask:0xf bank_mask:3
    v_add_f32_dpp v147, v147, v147 row_ror:8 row_mask:0xf bank_mask:3
    v_add_f32_dpp v148, v148, v148 row_ror:8 row_mask:0xf bank_mask:3
    v_add_f32_dpp v149, v149, v149 row_ror:8 row_mask:0xf bank_mask:3
    v_add_f32_dpp v150, v150, v150 row_ror:8 row_mask:0xf bank_mask:3
    v_add_f32_dpp v151, v151, v151 row_ror:8 row_mask:0xf bank_mask:3
    v_add_f32_dpp v152, v152, v152 row_ror:8 row_mask:0xf bank_mask:3
    v_add_f32_dpp v153, v153, v153 row_ror:8 row_mask:0xf bank_mask:3
    v_add_f32_dpp v154, v154, v154 row_ror:8 row_mask:0xf bank_mask:3
    v_add_f32_dpp v155, v155, v155 row_ror:8 row_mask:0xf bank_mask:3
    v_add_f32_dpp v156, v156, v156 row_ror:8 row_mask:0xf bank_mask:3
    v_add_f32_dpp v157, v157, v157 row_ror:8 row_mask:0xf bank_mask:3
    v_add_f32_dpp v158, v158, v158 row_ror:8 row_mask:0xf bank_mask:3
    v_add_f32_dpp v159, v159, v159 row_ror:8 row_mask:0xf bank_mask:3
    v_add_f32_dpp v144, v160, v160 row_ror:8 row_mask:0xf bank_mask:12
    v_add_f32_dpp v145, v161, v161 row_ror:8 row_mask:0xf bank_mask:12
    v_add_f32_dpp v146, v162, v162 row_ror:8 row_mask:0xf bank_mask:12
    v_add_f32_dpp v147, v163, v163 row_ror:8 row_mask:0xf bank_mask:12
    v_add_f32_dpp v148, v164, v164 row_ror:8 row_mask:0xf bank_mask:12
    v_add_f32_dpp v149, v165, v165 row_ror:8 row_mask:0xf bank_mask:12
    v_add_f32_dpp v150, v166, v166 row_ror:8 row_mask:0xf bank_mask:12
    v_add_f32_dpp v151, v167, v167 row_ror:8 row_mask:0xf bank_mask:12
    v_add_f32_dpp v152, v168, v168 row_ror:8 row_mask:0xf bank_mask:12
    v_add_f32_dpp v153, v169, v169 row_ror:8 row_mask:0xf bank_mask:12
    v_add_f32_dpp v154, v170, v170 row_ror:8 row_mask:0xf bank_mask:12
    v_add_f32_dpp v155, v171, v171 row_ror:8 row_mask:0xf bank_mask:12
    v_add_f32_dpp v156, v172, v172 row_ror:8 row_mask:0xf bank_mask:12
    v_add_f32_dpp v157, v173, v173 row_ror:8 row_mask:0xf bank_mask:12
    v_add_f32_dpp v158, v174, v174 row_ror:8 row_mask:0xf bank_mask:12
    v_add_f32_dpp v159, v175, v175 row_ror:8 row_mask:0xf bank_mask:12
    v_add_f32_dpp v144, v144, v144 row_half_mirror row_mask:0xf bank_mask:5
    v_add_f32_dpp v145, v145, v145 row_half_mirror row_mask:0xf bank_mask:5
    v_add_f32_dpp v146, v146, v146 row_half_mirror row_mask:0xf bank_mask:5
    v_add_f32_dpp v147, v147, v147 row_half_mirror row_mask:0xf bank_mask:5
    v_add_f32_dpp v148, v148, v148 row_half_mirror row_mask:0xf bank_mask:5
    v_add_f32_dpp v149, v149, v149 row_half_mirror row_mask:0xf bank_mask:5
    v_add_f32_dpp v150, v150, v150 row_half_mirror row_mask:0xf bank_mask:5
    v_add_f32_dpp v151, v151, v151 row_half_mirror row_mask:0xf bank_mask:5
    v_add_f32_dpp v144, v152, v152 row_half_mirror row_mask:0xf bank_mask:10
    v_add_f32_dpp v145, v153, v153 row_half_mirror row_mask:0xf bank_mask:10
    v_add_f32_dpp v146, v154, v154 row_half_mirror row_mask:0xf bank_mask:10
    v_add_f32_dpp v147, v155, v155 row_half_mirror row_mask:0xf bank_mask:10
    v_add_f32_dpp v148, v156, v156 row_half_mirror row_mask:0xf bank_mask:10
    v_add_f32_dpp v149, v157, v157 row_half_mirror row_mask:0xf bank_mask:10
    v_add_f32_dpp v150, v158, v158 row_half_mirror row_mask:0xf bank_mask:10
    v_add_f32_dpp v151, v159, v159 row_half_mirror row_mask:0xf bank_mask:10
    v_add_f32_dpp v144, v144, v144 quad_perm:[1,0,3,2] row_mask:0xf bank_mask:0xf
    v_add_f32_dpp v145, v145, v145 quad_perm:[1,0,3,2] row_mask:0xf bank_mask:0xf
    v_add_f32_dpp v146, v146, v146 quad_perm:[1,0,3,2] row_mask:0xf bank_mask:0xf
    v_add_f32_dpp v147, v147, v147 quad_perm:[1,0,3,2] row_mask:0xf bank_mask:0xf
    v_add_f32_dpp v148, v148, v148 quad_perm:[1,0,3,2] row_mask:0xf bank_mask:0xf
    v_add_f32_dpp v149, v149, v149 quad_perm:[1,0,3,2] row_mask:0xf bank_mask:0xf
    v_add_f32_dpp v150, v150, v150 quad_perm:[1,0,3,2] row_mask:0xf bank_mask:0xf
    v_add_f32_dpp v151, v151, v151 quad_perm:[1,0,3,2] row_mask:0xf bank_mask:0xf
    v_add_f32_dpp v144, v144, v144 quad_perm:[2,3,0,1] row_mask:0xf bank_mask:0xf
    v_add_f32_dpp v145, v145, v145 quad_perm:[2,3,0,1] row_mask:0xf bank_mask:0xf
    v_add_f32_dpp v146, v146, v146 quad_perm:[2,3,0,1] row_mask:0xf bank_mask:0xf
    v_add_f32_dpp v147, v147, v147 quad_perm:[2,3,0,1] row_mask:0xf bank_mask:0xf
    v_add_f32_dpp v148, v148, v148 quad_perm:[2,3,0,1] row_mask:0xf bank_mask:0xf
    v_add_f32_dpp v149, v149, v149 quad_perm:[2,3,0,1] row_mask:0xf bank_mask:0xf
    v_add_f32_dpp v150, v150, v150 quad_perm:[2,3,0,1] row_mask:0xf bank_mask:0xf
    v_add_f32_dpp v151, v151, v151 quad_perm:[2,3,0,1] row_mask:0xf bank_mask:0xf
    v_bfe_u32 v4, v0, 2, 2
    v_lshl_add_u32 v4, v4, 7, v208
    s_lshl_b32 s11, s8, 9
    s_add_u32 s13, s11, 82432
    v_add_u32 v4, s13, v4
    ds_write_b128 v4, v[144:147]
    ds_write_b128 v4, v[148:151] offset:64
    s_lshl_b32 s30, s9, 12
    s_add_u32 s30, s30, 65536
    s_waitcnt lgkmcnt(0)
    s_barrier
    s_cmp_lg_u32 s8, 0
    s_cbranch_scc1 L_k2_nopub_2
    v_lshlrev_b32 v4, 2, v1
    v_add_u32 v4, 82432, v4
    ds_read2st64_b32 v[176:177], v4 offset0:0 offset1:1
    ds_read2st64_b32 v[178:179], v4 offset0:2 offset1:3
    ds_read2st64_b32 v[180:181], v4 offset0:4 offset1:5
    ds_read2st64_b32 v[182:183], v4 offset0:6 offset1:7
    s_lshl_b32 s13, s10, 9
    s_add_u32 s13, s13, s30
    s_waitcnt lgkmcnt(2)
    v_pk_add_f32 v[176:177], v[176:177], v[178:179]
    s_waitcnt lgkmcnt(0)
    v_pk_add_f32 v[180:181], v[180:181], v[182:183]
    v_pk_add_f32 v[176:177], v[176:177], v[180:181]
    v_and_b32 v177, 0x7fffffff, v177
    buffer_store_dwordx2 v[176:177], v9, s[4:7], s13 offen sc1
L_k2_nopub_2:
    ds_read_b64 v[12:13], v9 offset:0
    ds_read_b64 v[14:15], v9 offset:512
    ds_read_b64 v[16:17], v9 offset:20480
    ds_read_b64 v[18:19], v9 offset:20992
    ds_read_b64 v[20:21], v10 offset:0
    ds_read_b64 v[22:23], v10 offset:512
    ds_read_b64 v[24:25], v10 offset:20480
    ds_read_b64 v[26:27], v10 offset:20992
    s_waitcnt vmcnt(39) lgkmcnt(6)
    v_mfma_f32_16x16x32_bf16 v[76:79], a[0:3], v[12:15], 0
    s_waitcnt vmcnt(38)
    v_mfma_f32_16x16x32_bf16 v[92:95], a[4:7], v[12:15], 0
    ds_read_b64 v[28:29], v9 offset:1024
    ds_read_b64 v[30:31], v9 offset:1536
    s_waitcnt lgkmcnt(6)
    v_mfma_f32_16x16x32_bf16 v[80:83], a[0:3], v[16:19], 0
    v_mfma_f32_16x16x32_bf16 v[96:99], a[4:7], v[16:19], 0
    ds_read_b64 v[32:33], v9 offset:21504
    ds_read_b64 v[34:35], v9 offset:22016
    s_waitcnt lgkmcnt(6)
    v_mfma_f32_16x16x32_bf16 v[84:87], a[0:3], v[20:23], 0
    v_mfma_f32_16x16x32_bf16 v[100:103], a[4:7], v[20:23], 0
    ds_read_b64 v[36:37], v10 offset:1024
    ds_read_b64 v[38:39], v10 offset:1536
    s_waitcnt lgkmcnt(6)
    v_mfma_f32_16x16x32_bf16 v[88:91], a[0:3], v[24:27], 0
    v_mfma_f32_16x16x32_bf16 v[104:107], a[4:7], v[24:27], 0
    ds_read_b64 v[40:41], v10 offset:21504
    ds_read_b64 v[42:43], v10 offset:22016
    s_waitcnt vmcnt(37) lgkmcnt(6)
    v_mfma_f32_16x16x32_bf16 v[76:79], a[8:11], v[28:31], v[76:79]
    s_waitcnt vmcnt(36)
    v_mfma_f32_16x16x32_bf16 v[92:95], a[12:15], v[28:31], v[92:95]
    ds_read_b64 v[12:13], v9 offset:2048
    ds_read_b64 v[14:15], v9 offset:2560
    s_waitcnt lgkmcnt(6)
    v_mfma_f32_16x16x32_bf16 v[80:83], a[8:11], v[32:35], v[80:83]
    v_mfma_f32_16x16x32_bf16 v[96:99], a[12:15], v[32:35], v[96:99]
    ds_read_b64 v[16:17], v9 offset:22528
    ds_read_b64 v[18:19], v9 offset:23040
    s_waitcnt lgkmcnt(6)
    v_mfma_f32_16x16x32_bf16 v[84:87], a[8:11], v[36:39], v[84:87]
    v_mfma_f32_16x16x32_bf16 v[100:103], a[12:15], v[36:39], v[100:103]
    ds_read_b64 v[20:21], v10 offset:2048
    ds_read_b64 v[22:23], v10 offset:2560
    s_waitcnt lgkmcnt(6)
    v_mfma_f32_16x16x32_bf16 v[88:91], a[8:11], v[40:43], v[88:91]
    v_mfma_f32_16x16x32_bf16 v[104:107], a[12:15], v[40:43], v[104:107]
    ds_read_b64 v[24:25], v10 offset:22528
    ds_read_b64 v[26:27], v10 offset:23040
    s_waitcnt vmcnt(35) lgkmcnt(6)
    v_mfma_f32_16x16x32_bf16 v[76:79], a[16:19], v[12:15], v[76:79]
    s_waitcnt vmcnt(34)
    v_mfma_f32_16x16x32_bf16 v[92:95], a[20:23], v[12:15], v[92:95]
    ds_read_b64 v[28:29], v9 offset:3072
    ds_read_b64 v[30:31], v9 offset:3584
    s_waitcnt lgkmcnt(6)
    v_mfma_f32_16x16x32_bf16 v[80:83], a[16:19], v[16:19], v[80:83]
    v_mfma_f32_16x16x32_bf16 v[96:99], a[20:23], v[16:19], v[96:99]
    ds_read_b64 v[32:33], v9 offset:23552
    ds_read_b64 v[34:35], v9 offset:24064
    s_waitcnt lgkmcnt(6)
    v_mfma_f32_16x16x32_bf16 v[84:87], a[16:19], v[20:23], v[84:87]
    v_mfma_f32_16x16x32_bf16 v[100:103], a[20:23], v[20:23], v[100:103]
    ds_read_b64 v[36:37], v10 offset:3072
    ds_read_b64 v[38:39], v10 offset:3584
    s_waitcnt lgkmcnt(6)
    v_mfma_f32_16x16x32_bf16 v[88:91], a[16:19], v[24:27], v[88:91]
    v_mfma_f32_16x16x32_bf16 v[104:107], a[20:23], v[24:27], v[104:107]
    ds_read_b64 v[40:41], v10 offset:23552
    ds_read_b64 v[42:43], v10 offset:24064
    s_waitcnt vmcnt(33) lgkmcnt(6)
    v_mfma_f32_16x16x32_bf16 v[76:79], a[24:27], v[28:31], v[76:79]
    s_waitcnt vmcnt(32)
    v_mfma_f32_16x16x32_bf16 v[92:95], a[28:31], v[28:31], v[92:95]
    ds_read_b64 v[12:13], v9 offset:4096
    ds_read_b64 v[14:15], v9 offset:4608
    s_waitcnt lgkmcnt(6)
    v_mfma_f32_16x16x32_bf16 v[80:83], a[24:27], v[32:35], v[80:83]
    v_mfma_f32_16x16x32_bf16 v[96:99], a[28:31], v[32:35], v[96:99]
    ds_read_b64 v[16:17], v9 offset:24576
    ds_read_b64 v[18:19], v9 offset:25088
    s_waitcnt lgkmcnt(6)
    v_mfma_f32_16x16x32_bf16 v[84:87], a[24:27], v[36:39], v[84:87]
    v_mfma_f32_16x16x32_bf16 v[100:103], a[28:31], v[36:39], v[100:103]
    ds_read_b64 v[20:21], v10 offset:4096
    ds_read_b64 v[22:23], v10 offset:4608
    s_waitcnt lgkmcnt(6)
    v_mfma_f32_16x16x32_bf16 v[88:91], a[24:27], v[40:43], v[88:91]
    v_mfma_f32_16x16x32_bf16 v[104:107], a[28:31], v[40:43], v[104:107]
    ds_read_b64 v[24:25], v10 offset:24576
    ds_read_b64 v[26:27], v10 offset:25088
    s_waitcnt vmcnt(31) lgkmcnt(6)
    v_mfma_f32_16x16x32_bf16 v[76:79], a[32:35], v[12:15], v[76:79]
    s_waitcnt vmcnt(30)
    v_mfma_f32_16x16x32_bf16 v[92:95], a[36:39], v[12:15], v[92:95]
    ds_read_b64 v[28:29], v9 offset:5120
    ds_read_b64 v[30:31], v9 offset:5632
    s_waitcnt lgkmcnt(6)
    v_mfma_f32_16x16x32_bf16 v[80:83], a[32:35], v[16:19], v[80:83]
    v_mfma_f32_16x16x32_bf16 v[96:99], a[36:39], v[16:19], v[96:99]
    ds_read_b64 v[32:33], v9 offset:25600
    ds_read_b64 v[34:35], v9 offset:26112
    s_waitcnt lgkmcnt(6)
    v_mfma_f32_16x16x32_bf16 v[84:87], a[32:35], v[20:23], v[84:87]
    v_mfma_f32_16x16x32_bf16 v[100:103], a[36:39], v[20:23], v[100:103]
    ds_read_b64 v[36:37], v10 offset:5120
    ds_read_b64 v[38:39], v10 offset:5632
    s_waitcnt lgkmcnt(6)
    v_mfma_f32_16x16x32_bf16 v[88:91], a[32:35], v[24:27], v[88:91]
    v_mfma_f32_16x16x32_bf16 v[104:107], a[36:39], v[24:27], v[104:107]
    ds_read_b64 v[40:41], v10 offset:25600
    ds_read_b64 v[42:43], v10 offset:26112
    s_waitcnt vmcnt(29) lgkmcnt(6)
    v_mfma_f32_16x16x32_bf16 v[76:79], a[40:43], v[28:31], v[76:79]
    s_waitcnt vmcnt(28)
    v_mfma_f32_16x16x32_bf16 v[92:95], a[44:47], v[28:31], v[92:95]
    ds_read_b64 v[12:13], v9 offset:6144
    ds_read_b64 v[14:15], v9 offset:6656
    s_waitcnt lgkmcnt(6)
    v_mfma_f32_16x16x32_bf16 v[80:83], a[40:43], v[32:35], v[80:83]
    v_mfma_f32_16x16x32_bf16 v[96:99], a[44:47], v[32:35], v[96:99]
    ds_read_b64 v[16:17], v9 offset:26624
    ds_read_b64 v[18:19], v9 offset:27136
    s_waitcnt lgkmcnt(6)
    v_mfma_f32_16x16x32_bf16 v[84:87], a[40:43], v[36:39], v[84:87]
    v_mfma_f32_16x16x32_bf16 v[100:103], a[44:47], v[36:39], v[100:103]
    ds_read_b64 v[20:21], v10 offset:6144
    ds_read_b64 v[22:23], v10 offset:6656
    s_waitcnt lgkmcnt(6)
    v_mfma_f32_16x16x32_bf16 v[88:91], a[40:43], v[40:43], v[88:91]
    v_mfma_f32_16x16x32_bf16 v[104:107], a[44:47], v[40:43], v[104:107]
    ds_read_b64 v[24:25], v10 offset:26624
    ds_read_b64 v[26:27], v10 offset:27136
    s_waitcnt vmcnt(27) lgkmcnt(6)
    v_mfma_f32_16x16x32_bf16 v[76:79], a[48:51], v[12:15], v[76:79]
    s_waitcnt vmcnt(26)
    v_mfma_f32_16x16x32_bf16 v[92:95], a[52:55], v[12:15], v[92:95]
    ds_read_b64 v[28:29], v9 offset:7168
    ds_read_b64 v[30:31], v9 offset:7680
    s_waitcnt lgkmcnt(6)
    v_mfma_f32_16x16x32_bf16 v[80:83], a[48:51], v[16:19], v[80:83]
    v_mfma_f32_16x16x32_bf16 v[96:99], a[52:55], v[16:19], v[96:99]
    ds_read_b64 v[32:33], v9 offset:27648
    ds_read_b64 v[34:35], v9 offset:28160
    s_waitcnt lgkmcnt(6)
    v_mfma_f32_16x16x32_bf16 v[84:87], a[48:51], v[20:23], v[84:87]
    v_mfma_f32_16x16x32_bf16 v[100:103], a[52:55], v[20:23], v[100:103]
    ds_read_b64 v[36:37], v10 offset:7168
    ds_read_b64 v[38:39], v10 offset:7680
    s_waitcnt lgkmcnt(6)
    v_mfma_f32_16x16x32_bf16 v[88:91], a[48:51], v[24:27], v[88:91]
    v_mfma_f32_16x16x32_bf16 v[104:107], a[52:55], v[24:27], v[104:107]
    ds_read_b64 v[40:41], v10 offset:27648
    ds_read_b64 v[42:43], v10 offset:28160
    s_waitcnt vmcnt(25) lgkmcnt(6)
    v_mfma_f32_16x16x32_bf16 v[76:79], a[56:59], v[28:31], v[76:79]
    s_waitcnt vmcnt(24)
    v_mfma_f32_16x16x32_bf16 v[92:95], a[60:63], v[28:31], v[92:95]
    ds_read_b64 v[12:13], v9 offset:8192
    ds_read_b64 v[14:15], v9 offset:8704
    s_waitcnt lgkmcnt(6)
    v_mfma_f32_16x16x32_bf16 v[80:83], a[56:59], v[32:35], v[80:83]
    v_mfma_f32_16x16x32_bf16 v[96:99], a[60:63], v[32:35], v[96:99]
    ds_read_b64 v[16:17], v9 offset:28672
    ds_read_b64 v[18:19], v9 offset:29184
    s_waitcnt lgkmcnt(6)
    v_mfma_f32_16x16x32_bf16 v[84:87], a[56:59], v[36:39], v[84:87]
    v_mfma_f32_16x16x32_bf16 v[100:103], a[60:63], v[36:39], v[100:103]
    ds_read_b64 v[20:21], v10 offset:8192
    ds_read_b64 v[22:23], v10 offset:8704
    s_waitcnt lgkmcnt(6)
    v_mfma_f32_16x16x32_bf16 v[88:91], a[56:59], v[40:43], v[88:91]
    v_mfma_f32_16x16x32_bf16 v[104:107], a[60:63], v[40:43], v[104:107]
    ds_read_b64 v[24:25], v10 offset:28672
    ds_read_b64 v[26:27], v10 offset:29184
    s_waitcnt vmcnt(23) lgkmcnt(6)
    v_mfma_f32_16x16x32_bf16 v[76:79], a[64:67], v[12:15], v[76:79]
    s_waitcnt vmcnt(22)
    v_mfma_f32_16x16x32_bf16 v[92:95], a[68:71], v[12:15], v[92:95]
    ds_read_b64 v[28:29], v9 offset:9216
    ds_read_b64 v[30:31], v9 offset:9728
    s_waitcnt lgkmcnt(6)
    v_mfma_f32_16x16x32_bf16 v[80:83], a[64:67], v[16:19], v[80:83]
    v_mfma_f32_16x16x32_bf16 v[96:99], a[68:71], v[16:19], v[96:99]
    ds_read_b64 v[32:33], v9 offset:29696
    ds_read_b64 v[34:35], v9 offset:30208
    s_waitcnt lgkmcnt(6)
    v_mfma_f32_16x16x32_bf16 v[84:87], a[64:67], v[20:23], v[84:87]
    v_mfma_f32_16x16x32_bf16 v[100:103], a[68:71], v[20:23], v[100:103]
    ds_read_b64 v[36:37], v10 offset:9216
    ds_read_b64 v[38:39], v10 offset:9728
    s_waitcnt lgkmcnt(6)
    v_mfma_f32_16x16x32_bf16 v[88:91], a[64:67], v[24:27], v[88:91]
    v_mfma_f32_16x16x32_bf16 v[104:107], a[68:71], v[24:27], v[104:107]
    ds_read_b64 v[40:41], v10 offset:29696
    ds_read_b64 v[42:43], v10 offset:30208
    s_waitcnt vmcnt(21) lgkmcnt(6)
    v_mfma_f32_16x16x32_bf16 v[76:79], a[72:75], v[28:31], v[76:79]
    s_waitcnt vmcnt(20)
    v_mfma_f32_16x16x32_bf16 v[92:95], a[76:79], v[28:31], v[92:95]
    ds_read_b64 v[12:13], v9 offset:10240
    ds_read_b64 v[14:15], v9 offset:10752
    s_waitcnt lgkmcnt(6)
    v_mfma_f32_16x16x32_bf16 v[80:83], a[72:75], v[32:35], v[80:83]
    v_mfma_f32_16x16x32_bf16 v[96:99], a[76:79], v[32:35], v[96:99]
    ds_read_b64 v[16:17], v9 offset:30720
    ds_read_b64 v[18:19], v9 offset:31232
    s_waitcnt lgkmcnt(6)
    v_mfma_f32_16x16x32_bf16 v[84:87], a[72:75], v[36:39], v[84:87]
    v_mfma_f32_16x16x32_bf16 v[100:103], a[76:79], v[36:39], v[100:103]
    ds_read_b64 v[20:21], v10 offset:10240
    ds_read_b64 v[22:23], v10 offset:10752
    s_waitcnt lgkmcnt(6)
    v_mfma_f32_16x16x32_bf16 v[88:91], a[72:75], v[40:43], v[88:91]
    v_mfma_f32_16x16x32_bf16 v[104:107], a[76:79], v[40:43], v[104:107]
    ds_read_b64 v[24:25], v10 offset:30720
    ds_read_b64 v[26:27], v10 offset:31232
    s_waitcnt vmcnt(19) lgkmcnt(6)
    v_mfma_f32_16x16x32_bf16 v[76:79], a[80:83], v[12:15], v[76:79]
    s_waitcnt vmcnt(18)
    v_mfma_f32_16x16x32_bf16 v[92:95], a[84:87], v[12:15], v[92:95]
    ds_read_b64 v[28:29], v9 offset:11264
    ds_read_b64 v[30:31], v9 offset:11776
    s_waitcnt lgkmcnt(6)
    v_mfma_f32_16x16x32_bf16 v[80:83], a[80:83], v[16:19], v[80:83]
    v_mfma_f32_16x16x32_bf16 v[96:99], a[84:87], v[16:19], v[96:99]
    ds_read_b64 v[32:33], v9 offset:31744
    ds_read_b64 v[34:35], v9 offset:32256
    s_waitcnt lgkmcnt(6)
    v_mfma_f32_16x16x32_bf16 v[84:87], a[80:83], v[20:23], v[84:87]
    v_mfma_f32_16x16x32_bf16 v[100:103], a[84:87], v[20:23], v[100:103]
    ds_read_b64 v[36:37], v10 offset:11264
    ds_read_b64 v[38:39], v10 offset:11776
    s_waitcnt lgkmcnt(6)
    v_mfma_f32_16x16x32_bf16 v[88:91], a[80:83], v[24:27], v[88:91]
    v_mfma_f32_16x16x32_bf16 v[104:107], a[84:87], v[24:27], v[104:107]
    ds_read_b64 v[40:41], v10 offset:31744
    ds_read_b64 v[42:43], v10 offset:32256
    s_waitcnt vmcnt(17) lgkmcnt(6)
    v_mfma_f32_16x16x32_bf16 v[76:79], a[88:91], v[28:31], v[76:79]
    s_waitcnt vmcnt(16)
    v_mfma_f32_16x16x32_bf16 v[92:95], a[92:95], v[28:31], v[92:95]
    ds_read_b64 v[12:13], v9 offset:12288
    ds_read_b64 v[14:15], v9 offset:12800
    s_waitcnt lgkmcnt(6)
    v_mfma_f32_16x16x32_bf16 v[80:83], a[88:91], v[32:35], v[80:83]
    v_mfma_f32_16x16x32_bf16 v[96:99], a[92:95], v[32:35], v[96:99]
    ds_read_b64 v[16:17], v9 offset:32768
    ds_read_b64 v[18:19], v9 offset:33280
    s_waitcnt lgkmcnt(6)
    v_mfma_f32_16x16x32_bf16 v[84:87], a[88:91], v[36:39], v[84:87]
    v_mfma_f32_16x16x32_bf16 v[100:103], a[92:95], v[36:39], v[100:103]
    ds_read_b64 v[20:21], v10 offset:12288
    ds_read_b64 v[22:23], v10 offset:12800
    s_waitcnt lgkmcnt(6)
    v_mfma_f32_16x16x32_bf16 v[88:91], a[88:91], v[40:43], v[88:91]
    v_mfma_f32_16x16x32_bf16 v[104:107], a[92:95], v[40:43], v[104:107]
    ds_read_b64 v[24:25], v10 offset:32768
    ds_read_b64 v[26:27], v10 offset:33280
    s_waitcnt vmcnt(15) lgkmcnt(6)
    v_mfma_f32_16x16x32_bf16 v[76:79], a[96:99], v[12:15], v[76:79]
    s_waitcnt vmcnt(14)
    v_mfma_f32_16x16x32_bf16 v[92:95], a[100:103], v[12:15], v[92:95]
    ds_read_b64 v[28:29], v9 offset:13312
    ds_read_b64 v[30:31], v9 offset:13824
    s_waitcnt lgkmcnt(6)
    v_mfma_f32_16x16x32_bf16 v[80:83], a[96:99], v[16:19], v[80:83]
    v_mfma_f32_16x16x32_bf16 v[96:99], a[100:103], v[16:19], v[96:99]
    ds_read_b64 v[32:33], v9 offset:33792
    ds_read_b64 v[34:35], v9 offset:34304
    s_waitcnt lgkmcnt(6)
    v_mfma_f32_16x16x32_bf16 v[84:87], a[96:99], v[20:23], v[84:87]
    v_mfma_f32_16x16x32_bf16 v[100:103], a[100:103], v[20:23], v[100:103]
    ds_read_b64 v[36:37], v10 offset:13312
    ds_read_b64 v[38:39], v10 offset:13824
    s_waitcnt lgkmcnt(6)
    v_mfma_f32_16x16x32_bf16 v[88:91], a[96:99], v[24:27], v[88:91]
    v_mfma_f32_16x16x32_bf16 v[104:107], a[100:103], v[24:27], v[104:107]
    ds_read_b64 v[40:41], v10 offset:33792
    ds_read_b64 v[42:43], v10 offset:34304
    s_waitcnt vmcnt(13) lgkmcnt(6)
    v_mfma_f32_16x16x32_bf16 v[76:79], a[104:107], v[28:31], v[76:79]
    s_waitcnt vmcnt(12)
    v_mfma_f32_16x16x32_bf16 v[92:95], a[108:111], v[28:31], v[92:95]
    ds_read_b64 v[12:13], v9 offset:14336
    ds_read_b64 v[14:15], v9 offset:14848
    s_waitcnt lgkmcnt(6)
    v_mfma_f32_16x16x32_bf16 v[80:83], a[104:107], v[32:35], v[80:83]
    v_mfma_f32_16x16x32_bf16 v[96:99], a[108:111], v[32:35], v[96:99]
    ds_read_b64 v[16:17], v9 offset:34816
    ds_read_b64 v[18:19], v9 offset:35328
    s_waitcnt lgkmcnt(6)
    v_mfma_f32_16x16x32_bf16 v[84:87], a[104:107], v[36:39], v[84:87]
    v_mfma_f32_16x16x32_bf16 v[100:103], a[108:111], v[36:39], v[100:103]
    ds_read_b64 v[20:21], v10 offset:14336
    ds_read_b64 v[22:23], v10 offset:14848
    s_waitcnt lgkmcnt(6)
    v_mfma_f32_16x16x32_bf16 v[88:91], a[104:107], v[40:43], v[88:91]
    v_mfma_f32_16x16x32_bf16 v[104:107], a[108:111], v[40:43], v[104:107]
    ds_read_b64 v[24:25], v10 offset:34816
    ds_read_b64 v[26:27], v10 offset:35328
    s_waitcnt vmcnt(11) lgkmcnt(6)
    v_mfma_f32_16x16x32_bf16 v[76:79], a[112:115], v[12:15], v[76:79]
    s_waitcnt vmcnt(10)
    v_mfma_f32_16x16x32_bf16 v[92:95], a[116:119], v[12:15], v[92:95]
    ds_read_b64 v[28:29], v9 offset:15360
    ds_read_b64 v[30:31], v9 offset:15872
    s_waitcnt lgkmcnt(6)
    v_mfma_f32_16x16x32_bf16 v[80:83], a[112:115], v[16:19], v[80:83]
    v_mfma_f32_16x16x32_bf16 v[96:99], a[116:119], v[16:19], v[96:99]
    ds_read_b64 v[32:33], v9 offset:35840
    ds_read_b64 v[34:35], v9 offset:36352
    s_waitcnt lgkmcnt(6)
    v_mfma_f32_16x16x32_bf16 v[84:87], a[112:115], v[20:23], v[84:87]
    v_mfma_f32_16x16x32_bf16 v[100:103], a[116:119], v[20:23], v[100:103]
    ds_read_b64 v[36:37], v10 offset:15360
    ds_read_b64 v[38:39], v10 offset:15872
    s_waitcnt lgkmcnt(6)
    v_mfma_f32_16x16x32_bf16 v[88:91], a[112:115], v[24:27], v[88:91]
    v_mfma_f32_16x16x32_bf16 v[104:107], a[116:119], v[24:27], v[104:107]
    ds_read_b64 v[40:41], v10 offset:35840
    ds_read_b64 v[42:43], v10 offset:36352
    s_waitcnt vmcnt(9) lgkmcnt(6)
    v_mfma_f32_16x16x32_bf16 v[76:79], a[120:123], v[28:31], v[76:79]
    s_waitcnt vmcnt(8)
    v_mfma_f32_16x16x32_bf16 v[92:95], a[124:127], v[28:31], v[92:95]
    ds_read_b64 v[12:13], v9 offset:16384
    ds_read_b64 v[14:15], v9 offset:16896
    s_waitcnt lgkmcnt(6)
    v_mfma_f32_16x16x32_bf16 v[80:83], a[120:123], v[32:35], v[80:83]
    v_mfma_f32_16x16x32_bf16 v[96:99], a[124:127], v[32:35], v[96:99]
    ds_read_b64 v[16:17], v9 offset:36864
    ds_read_b64 v[18:19], v9 offset:37376
    s_waitcnt lgkmcnt(6)
    v_mfma_f32_16x16x32_bf16 v[84:87], a[120:123], v[36:39], v[84:87]
    v_mfma_f32_16x16x32_bf16 v[100:103], a[124:127], v[36:39], v[100:103]
    ds_read_b64 v[20:21], v10 offset:16384
    ds_read_b64 v[22:23], v10 offset:16896
    s_waitcnt lgkmcnt(6)
    v_mfma_f32_16x16x32_bf16 v[88:91], a[120:123], v[40:43], v[88:91]
    v_mfma_f32_16x16x32_bf16 v[104:107], a[124:127], v[40:43], v[104:107]
    ds_read_b64 v[24:25], v10 offset:36864
    ds_read_b64 v[26:27], v10 offset:37376
    s_waitcnt vmcnt(7) lgkmcnt(6)
    v_mfma_f32_16x16x32_bf16 v[76:79], a[128:131], v[12:15], v[76:79]
    s_waitcnt vmcnt(6)
    v_mfma_f32_16x16x32_bf16 v[92:95], a[132:135], v[12:15], v[92:95]
    ds_read_b64 v[28:29], v9 offset:17408
    ds_read_b64 v[30:31], v9 offset:17920
    s_waitcnt lgkmcnt(6)
    v_mfma_f32_16x16x32_bf16 v[80:83], a[128:131], v[16:19], v[80:83]
    v_mfma_f32_16x16x32_bf16 v[96:99], a[132:135], v[16:19], v[96:99]
    ds_read_b64 v[32:33], v9 offset:37888
    ds_read_b64 v[34:35], v9 offset:38400
    s_waitcnt lgkmcnt(6)
    v_mfma_f32_16x16x32_bf16 v[84:87], a[128:131], v[20:23], v[84:87]
    v_mfma_f32_16x16x32_bf16 v[100:103], a[132:135], v[20:23], v[100:103]
    ds_read_b64 v[36:37], v10 offset:17408
    ds_read_b64 v[38:39], v10 offset:17920
    s_waitcnt lgkmcnt(6)
    v_mfma_f32_16x16x32_bf16 v[88:91], a[128:131], v[24:27], v[88:91]
    v_mfma_f32_16x16x32_bf16 v[104:107], a[132:135], v[24:27], v[104:107]
    ds_read_b64 v[40:41], v10 offset:37888
    ds_read_b64 v[42:43], v10 offset:38400
    s_waitcnt vmcnt(5) lgkmcnt(6)
    v_mfma_f32_16x16x32_bf16 v[76:79], a[136:139], v[28:31], v[76:79]
    s_waitcnt vmcnt(4)
    v_mfma_f32_16x16x32_bf16 v[92:95], a[140:143], v[28:31], v[92:95]
    ds_read_b64 v[12:13], v9 offset:18432
    ds_read_b64 v[14:15], v9 offset:18944
    s_waitcnt lgkmcnt(6)
    v_mfma_f32_16x16x32_bf16 v[80:83], a[136:139], v[32:35], v[80:83]
    v_mfma_f32_16x16x32_bf16 v[96:99], a[140:143], v[32:35], v[96:99]
    ds_read_b64 v[16:17], v9 offset:38912
    ds_read_b64 v[18:19], v9 offset:39424
    s_waitcnt lgkmcnt(6)
    v_mfma_f32_16x16x32_bf16 v[84:87], a[136:139], v[36:39], v[84:87]
    v_mfma_f32_16x16x32_bf16 v[100:103], a[140:143], v[36:39], v[100:103]
    ds_read_b64 v[20:21], v10 offset:18432
    ds_read_b64 v[22:23], v10 offset:18944
    s_waitcnt lgkmcnt(6)
    v_mfma_f32_16x16x32_bf16 v[88:91], a[136:139], v[40:43], v[88:91]
    v_mfma_f32_16x16x32_bf16 v[104:107], a[140:143], v[40:43], v[104:107]
    ds_read_b64 v[24:25], v10 offset:38912
    ds_read_b64 v[26:27], v10 offset:39424
    s_waitcnt vmcnt(3) lgkmcnt(6)
    v_mfma_f32_16x16x32_bf16 v[76:79], a[144:147], v[12:15], v[76:79]
    s_waitcnt vmcnt(2)
    v_mfma_f32_16x16x32_bf16 v[92:95], a[148:151], v[12:15], v[92:95]
    ds_read_b64 v[28:29], v9 offset:19456
    ds_read_b64 v[30:31], v9 offset:19968
    s_waitcnt lgkmcnt(6)
    v_mfma_f32_16x16x32_bf16 v[80:83], a[144:147], v[16:19], v[80:83]
    v_mfma_f32_16x16x32_bf16 v[96:99], a[148:151], v[16:19], v[96:99]
    ds_read_b64 v[32:33], v9 offset:39936
    ds_read_b64 v[34:35], v9 offset:40448
    s_waitcnt lgkmcnt(6)
    v_mfma_f32_16x16x32_bf16 v[84:87], a[144:147], v[20:23], v[84:87]
    v_mfma_f32_16x16x32_bf16 v[100:103], a[148:151], v[20:23], v[100:103]
    ds_read_b64 v[36:37], v10 offset:19456
    ds_read_b64 v[38:39], v10 offset:19968
    s_waitcnt lgkmcnt(6)
    v_mfma_f32_16x16x32_bf16 v[88:91], a[144:147], v[24:27], v[88:91]
    v_mfma_f32_16x16x32_bf16 v[104:107], a[148:151], v[24:27], v[104:107]
    ds_read_b64 v[40:41], v10 offset:39936
    ds_read_b64 v[42:43], v10 offset:40448
    s_waitcnt vmcnt(1) lgkmcnt(6)
    v_mfma_f32_16x16x32_bf16 v[76:79], a[152:155], v[28:31], v[76:79]
    s_waitcnt vmcnt(0)
    v_mfma_f32_16x16x32_bf16 v[92:95], a[156:159], v[28:31], v[92:95]
    s_waitcnt lgkmcnt(4)
    v_mfma_f32_16x16x32_bf16 v[80:83], a[152:155], v[32:35], v[80:83]
    v_mfma_f32_16x16x32_bf16 v[96:99], a[156:159], v[32:35], v[96:99]
    s_waitcnt lgkmcnt(2)
    v_mfma_f32_16x16x32_bf16 v[84:87], a[152:155], v[36:39], v[84:87]
    v_mfma_f32_16x16x32_bf16 v[100:103], a[156:159], v[36:39], v[100:103]
    s_waitcnt lgkmcnt(0)
    v_mfma_f32_16x16x32_bf16 v[88:91], a[152:155], v[40:43], v[88:91]
    v_mfma_f32_16x16x32_bf16 v[104:107], a[156:159], v[40:43], v[104:107]
    v_lshlrev_b32 v4, 2, v2
    v_add_u32 v4, 81920, v4
    ds_read2_b32 v[144:145], v4 offset0:0 offset1:64
    ds_read2_b32 v[146:147], v4 offset0:16 offset1:80
    ds_read2_b32 v[148:149], v4 offset0:32 offset1:96
    ds_read2_b32 v[150:151], v4 offset0:48 offset1:112
    s_lshl_b32 s13, s9, 3
    s_add_u32 s13, s13, s10
    s_lshl_b32 s13, s13, 14
    s_lshl_b32 s14, s8, 10
    s_add_u32 s13, s13, s14
    s_add_u32 s13, s13, 16252928
    s_waitcnt lgkmcnt(3)
    v_pk_fma_f32 v[76:77], v[126:127], v[144:145], v[76:77] op_sel:[0,1,0] op_sel_hi:[1,1,1]
    v_pk_fma_f32 v[78:79], v[128:129], v[144:145], v[78:79] op_sel:[0,1,0] op_sel_hi:[1,1,1]
    v_pk_fma_f32 v[92:93], v[130:131], v[144:145], v[92:93] op_sel:[0,1,0] op_sel_hi:[1,1,1]
    v_pk_fma_f32 v[94:95], v[132:133], v[144:145], v[94:95] op_sel:[0,1,0] op_sel_hi:[1,1,1]
    v_pk_fma_f32 v[76:77], v[76:77], v[144:145], v[134:135] op_sel:[0,0,0] op_sel_hi:[1,0,1]
    v_pk_fma_f32 v[78:79], v[78:79], v[144:145], v[136:137] op_sel:[0,0,0] op_sel_hi:[1,0,1]
    v_pk_fma_f32 v[92:93], v[92:93], v[144:145], v[138:139] op_sel:[0,0,0] op_sel_hi:[1,0,1]
    v_pk_fma_f32 v[94:95], v[94:95], v[144:145], v[140:141] op_sel:[0,0,0] op_sel_hi:[1,0,1]
    v_pk_mul_f32 v[176:177], v[76:77], v[76:77]
    v_pk_mul_f32 v[178:179], v[78:79], v[78:79]
    v_pk_mul_f32 v[180:181], v[92:93], v[92:93]
    v_pk_mul_f32 v[182:183], v[94:95], v[94:95]
    v_pk_fma_f32 v[176:177], v[176:177], s[26:27], s[26:27] op_sel:[0,0,1] op_sel_hi:[1,0,1]
    v_pk_fma_f32 v[178:179], v[178:179], s[26:27], s[26:27] op_sel:[0,0,1] op_sel_hi:[1,0,1]
    v_pk_fma_f32 v[180:181], v[180:181], s[26:27], s[26:27] op_sel:[0,0,1] op_sel_hi:[1,0,1]
    v_pk_fma_f32 v[182:183], v[182:183], s[26:27], s[26:27] op_sel:[0,0,1] op_sel_hi:[1,0,1]
    v_pk_mul_f32 v[176:177], v[176:177], v[76:77]
    v_pk_mul_f32 v[178:179], v[178:179], v[78:79]
    v_pk_mul_f32 v[180:181], v[180:181], v[92:93]
    v_pk_mul_f32 v[182:183], v[182:183], v[94:95]
    v_exp_f32 v176, v176
    v_exp_f32 v177, v177
    v_exp_f32 v178, v178
    v_exp_f32 v179, v179
    v_exp_f32 v180, v180
    v_exp_f32 v181, v181
    v_exp_f32 v182, v182
    v_exp_f32 v183, v183
    v_pk_add_f32 v[176:177], v[176:177], s[28:29]
    v_pk_add_f32 v[178:179], v[178:179], s[28:29]
    v_pk_add_f32 v[180:181], v[180:181], s[28:29]
    v_pk_add_f32 v[182:183], v[182:183], s[28:29]
    v_rcp_f32 v176, v176
    v_rcp_f32 v177, v177
    v_rcp_f32 v178, v178
    v_rcp_f32 v179, v179
    v_rcp_f32 v180, v180
    v_rcp_f32 v181, v181
    v_rcp_f32 v182, v182
    v_rcp_f32 v183, v183
    v_pk_mul_f32 v[76:77], v[76:77], v[176:177]
    v_pk_mul_f32 v[78:79], v[78:79], v[178:179]
    v_pk_mul_f32 v[92:93], v[92:93], v[180:181]
    v_pk_mul_f32 v[94:95], v[94:95], v[182:183]
    v_cvt_pk_bf16_f32 v160, v76, v92
    v_cvt_pk_bf16_f32 v161, v77, v93
    v_cvt_pk_bf16_f32 v162, v78, v94
    v_cvt_pk_bf16_f32 v163, v79, v95
    buffer_store_dwordx4 v[160:163], v7, s[4:7], s13 offen
    s_add_u32 s13, s13, 4096
    s_waitcnt lgkmcnt(2)
    v_pk_fma_f32 v[80:81], v[126:127], v[146:147], v[80:81] op_sel:[0,1,0] op_sel_hi:[1,1,1]
    v_pk_fma_f32 v[82:83], v[128:129], v[146:147], v[82:83] op_sel:[0,1,0] op_sel_hi:[1,1,1]
    v_pk_fma_f32 v[96:97], v[130:131], v[146:147], v[96:97] op_sel:[0,1,0] op_sel_hi:[1,1,1]
    v_pk_fma_f32 v[98:99], v[132:133], v[146:147], v[98:99] op_sel:[0,1,0] op_sel_hi:[1,1,1]
    v_pk_fma_f32 v[80:81], v[80:81], v[146:147], v[134:135] op_sel:[0,0,0] op_sel_hi:[1,0,1]
    v_pk_fma_f32 v[82:83], v[82:83], v[146:147], v[136:137] op_sel:[0,0,0] op_sel_hi:[1,0,1]
    v_pk_fma_f32 v[96:97], v[96:97], v[146:147], v[138:139] op_sel:[0,0,0] op_sel_hi:[1,0,1]
    v_pk_fma_f32 v[98:99], v[98:99], v[146:147], v[140:141] op_sel:[0,0,0] op_sel_hi:[1,0,1]
    v_pk_mul_f32 v[176:177], v[80:81], v[80:81]
    v_pk_mul_f32 v[178:179], v[82:83], v[82:83]
    v_pk_mul_f32 v[180:181], v[96:97], v[96:97]
    v_pk_mul_f32 v[182:183], v[98:99], v[98:99]
    v_pk_fma_f32 v[176:177], v[176:177], s[26:27], s[26:27] op_sel:[0,0,1] op_sel_hi:[1,0,1]
    v_pk_fma_f32 v[178:179], v[178:179], s[26:27], s[26:27] op_sel:[0,0,1] op_sel_hi:[1,0,1]
    v_pk_fma_f32 v[180:181], v[180:181], s[26:27], s[26:27] op_sel:[0,0,1] op_sel_hi:[1,0,1]
    v_pk_fma_f32 v[182:183], v[182:183], s[26:27], s[26:27] op_sel:[0,0,1] op_sel_hi:[1,0,1]
    v_pk_mul_f32 v[176:177], v[176:177], v[80:81]
    v_pk_mul_f32 v[178:179], v[178:179], v[82:83]
    v_pk_mul_f32 v[180:181], v[180:181], v[96:97]
    v_pk_mul_f32 v[182:183], v[182:183], v[98:99]
    v_exp_f32 v176, v176
    v_exp_f32 v177, v177
    v_exp_f32 v178, v178
    v_exp_f32 v179, v179
    v_exp_f32 v180, v180
    v_exp_f32 v181, v181
    v_exp_f32 v182, v182
    v_exp_f32 v183, v183
    v_pk_add_f32 v[176:177], v[176:177], s[28:29]
    v_pk_add_f32 v[178:179], v[178:179], s[28:29]
    v_pk_add_f32 v[180:181], v[180:181], s[28:29]
    v_pk_add_f32 v[182:183], v[182:183], s[28:29]
    v_rcp_f32 v176, v176
    v_rcp_f32 v177, v177
    v_rcp_f32 v178, v178
    v_rcp_f32 v179, v179
    v_rcp_f32 v180, v180
    v_rcp_f32 v181, v181
    v_rcp_f32 v182, v182
    v_rcp_f32 v183, v183
    v_pk_mul_f32 v[80:81], v[80:81], v[176:177]
    v_pk_mul_f32 v[82:83], v[82:83], v[178:179]
    v_pk_mul_f32 v[96:97], v[96:97], v[180:181]
    v_pk_mul_f32 v[98:99], v[98:99], v[182:183]
    v_cvt_pk_bf16_f32 v164, v80, v96
    v_cvt_pk_bf16_f32 v165, v81, v97
    v_cvt_pk_bf16_f32 v166, v82, v98
    v_cvt_pk_bf16_f32 v167, v83, v99
    buffer_store_dwordx4 v[164:167], v7, s[4:7], s13 offen
    s_add_u32 s13, s13, 4096
    s_waitcnt lgkmcnt(1)
    v_pk_fma_f32 v[84:85], v[126:127], v[148:149], v[84:85] op_sel:[0,1,0] op_sel_hi:[1,1,1]
    v_pk_fma_f32 v[86:87], v[128:129], v[148:149], v[86:87] op_sel:[0,1,0] op_sel_hi:[1,1,1]
    v_pk_fma_f32 v[100:101], v[130:131], v[148:149], v[100:101] op_sel:[0,1,0] op_sel_hi:[1,1,1]
    v_pk_fma_f32 v[102:103], v[132:133], v[148:149], v[102:103] op_sel:[0,1,0] op_sel_hi:[1,1,1]
    v_pk_fma_f32 v[84:85], v[84:85], v[148:149], v[134:135] op_sel:[0,0,0] op_sel_hi:[1,0,1]
    v_pk_fma_f32 v[86:87], v[86:87], v[148:149], v[136:137] op_sel:[0,0,0] op_sel_hi:[1,0,1]
    v_pk_fma_f32 v[100:101], v[100:101], v[148:149], v[138:139] op_sel:[0,0,0] op_sel_hi:[1,0,1]
    v_pk_fma_f32 v[102:103], v[102:103], v[148:149], v[140:141] op_sel:[0,0,0] op_sel_hi:[1,0,1]
    v_pk_mul_f32 v[176:177], v[84:85], v[84:85]
    v_pk_mul_f32 v[178:179], v[86:87], v[86:87]
    v_pk_mul_f32 v[180:181], v[100:101], v[100:101]
    v_pk_mul_f32 v[182:183], v[102:103], v[102:103]
    v_pk_fma_f32 v[176:177], v[176:177], s[26:27], s[26:27] op_sel:[0,0,1] op_sel_hi:[1,0,1]
    v_pk_fma_f32 v[178:179], v[178:179], s[26:27], s[26:27] op_sel:[0,0,1] op_sel_hi:[1,0,1]
    v_pk_fma_f32 v[180:181], v[180:181], s[26:27], s[26:27] op_sel:[0,0,1] op_sel_hi:[1,0,1]
    v_pk_fma_f32 v[182:183], v[182:183], s[26:27], s[26:27] op_sel:[0,0,1] op_sel_hi:[1,0,1]
    v_pk_mul_f32 v[176:177], v[176:177], v[84:85]
    v_pk_mul_f32 v[178:179], v[178:179], v[86:87]
    v_pk_mul_f32 v[180:181], v[180:181], v[100:101]
    v_pk_mul_f32 v[182:183], v[182:183], v[102:103]
    v_exp_f32 v176, v176
    v_exp_f32 v177, v177
    v_exp_f32 v178, v178
    v_exp_f32 v179, v179
    v_exp_f32 v180, v180
    v_exp_f32 v181, v181
    v_exp_f32 v182, v182
    v_exp_f32 v183, v183
    v_pk_add_f32 v[176:177], v[176:177], s[28:29]
    v_pk_add_f32 v[178:179], v[178:179], s[28:29]
    v_pk_add_f32 v[180:181], v[180:181], s[28:29]
    v_pk_add_f32 v[182:183], v[182:183], s[28:29]
    v_rcp_f32 v176, v176
    v_rcp_f32 v177, v177
    v_rcp_f32 v178, v178
    v_rcp_f32 v179, v179
    v_rcp_f32 v180, v180
    v_rcp_f32 v181, v181
    v_rcp_f32 v182, v182
    v_rcp_f32 v183, v183
    v_pk_mul_f32 v[84:85], v[84:85], v[176:177]
    v_pk_mul_f32 v[86:87], v[86:87], v[178:179]
    v_pk_mul_f32 v[100:101], v[100:101], v[180:181]
    v_pk_mul_f32 v[102:103], v[102:103], v[182:183]
    v_cvt_pk_bf16_f32 v168, v84, v100
    v_cvt_pk_bf16_f32 v169, v85, v101
    v_cvt_pk_bf16_f32 v170, v86, v102
    v_cvt_pk_bf16_f32 v171, v87, v103
    buffer_store_dwordx4 v[168:171], v7, s[4:7], s13 offen
    s_add_u32 s13, s13, 4096
    s_waitcnt lgkmcnt(0)
    v_pk_fma_f32 v[88:89], v[126:127], v[150:151], v[88:89] op_sel:[0,1,0] op_sel_hi:[1,1,1]
    v_pk_fma_f32 v[90:91], v[128:129], v[150:151], v[90:91] op_sel:[0,1,0] op_sel_hi:[1,1,1]
    v_pk_fma_f32 v[104:105], v[130:131], v[150:151], v[104:105] op_sel:[0,1,0] op_sel_hi:[1,1,1]
    v_pk_fma_f32 v[106:107], v[132:133], v[150:151], v[106:107] op_sel:[0,1,0] op_sel_hi:[1,1,1]
    v_pk_fma_f32 v[88:89], v[88:89], v[150:151], v[134:135] op_sel:[0,0,0] op_sel_hi:[1,0,1]
    v_pk_fma_f32 v[90:91], v[90:91], v[150:151], v[136:137] op_sel:[0,0,0] op_sel_hi:[1,0,1]
    v_pk_fma_f32 v[104:105], v[104:105], v[150:151], v[138:139] op_sel:[0,0,0] op_sel_hi:[1,0,1]
    v_pk_fma_f32 v[106:107], v[106:107], v[150:151], v[140:141] op_sel:[0,0,0] op_sel_hi:[1,0,1]
    v_pk_mul_f32 v[176:177], v[88:89], v[88:89]
    v_pk_mul_f32 v[178:179], v[90:91], v[90:91]
    v_pk_mul_f32 v[180:181], v[104:105], v[104:105]
    v_pk_mul_f32 v[182:183], v[106:107], v[106:107]
    v_pk_fma_f32 v[176:177], v[176:177], s[26:27], s[26:27] op_sel:[0,0,1] op_sel_hi:[1,0,1]
    v_pk_fma_f32 v[178:179], v[178:179], s[26:27], s[26:27] op_sel:[0,0,1] op_sel_hi:[1,0,1]
    v_pk_fma_f32 v[180:181], v[180:181], s[26:27], s[26:27] op_sel:[0,0,1] op_sel_hi:[1,0,1]
    v_pk_fma_f32 v[182:183], v[182:183], s[26:27], s[26:27] op_sel:[0,0,1] op_sel_hi:[1,0,1]
    v_pk_mul_f32 v[176:177], v[176:177], v[88:89]
    v_pk_mul_f32 v[178:179], v[178:179], v[90:91]
    v_pk_mul_f32 v[180:181], v[180:181], v[104:105]
    v_pk_mul_f32 v[182:183], v[182:183], v[106:107]
    v_exp_f32 v176, v176
    v_exp_f32 v177, v177
    v_exp_f32 v178, v178
    v_exp_f32 v179, v179
    v_exp_f32 v180, v180
    v_exp_f32 v181, v181
    v_exp_f32 v182, v182
    v_exp_f32 v183, v183
    v_pk_add_f32 v[176:177], v[176:177], s[28:29]
    v_pk_add_f32 v[178:179], v[178:179], s[28:29]
    v_pk_add_f32 v[180:181], v[180:181], s[28:29]
    v_pk_add_f32 v[182:183], v[182:183], s[28:29]
    v_rcp_f32 v176, v176
    v_rcp_f32 v177, v177
    v_rcp_f32 v178, v178
    v_rcp_f32 v179, v179
    v_rcp_f32 v180, v180
    v_rcp_f32 v181, v181
    v_rcp_f32 v182, v182
    v_rcp_f32 v183, v183
    v_pk_mul_f32 v[88:89], v[88:89], v[176:177]
    v_pk_mul_f32 v[90:91], v[90:91], v[178:179]
    v_pk_mul_f32 v[104:105], v[104:105], v[180:181]
    v_pk_mul_f32 v[106:107], v[106:107], v[182:183]
    v_cvt_pk_bf16_f32 v172, v88, v104
    v_cvt_pk_bf16_f32 v173, v89, v105
    v_cvt_pk_bf16_f32 v174, v90, v106
    v_cvt_pk_bf16_f32 v175, v91, v107
    buffer_store_dwordx4 v[172:175], v7, s[4:7], s13 offen
    s_mov_b32 s13, 65536
L_k2_poll_3:
    buffer_load_dwordx2 v[176:177], v9, s[4:7], s30 offen offset:0 sc1
    buffer_load_dwordx2 v[178:179], v9, s[4:7], s30 offen offset:512 sc1
    buffer_load_dwordx2 v[180:181], v9, s[4:7], s30 offen offset:1024 sc1
    buffer_load_dwordx2 v[182:183], v9, s[4:7], s30 offen offset:1536 sc1
    buffer_load_dwordx2 v[184:185], v9, s[4:7], s30 offen offset:2048 sc1
    buffer_load_dwordx2 v[186:187], v9, s[4:7], s30 offen offset:2560 sc1
    buffer_load_dwordx2 v[188:189], v9, s[4:7], s30 offen offset:3072 sc1
    buffer_load_dwordx2 v[190:191], v9, s[4:7], s30 offen offset:3584 sc1
    s_waitcnt vmcnt(5)
    v_max3_u32 v4, v177, v179, v181
    s_waitcnt vmcnt(3)
    v_max3_u32 v4, v4, v183, v185
    s_waitcnt vmcnt(1)
    v_max3_u32 v4, v4, v187, v189
    s_waitcnt vmcnt(0)
    v_max_u32 v4, v4, v191
    v_cmp_eq_u32 vcc, -1, v4
    s_nop 0
    s_cbranch_vccz L_k2_got_4
    s_sub_u32 s13, s13, 1
    s_cmp_lg_u32 s13, 0
    s_cbranch_scc1 L_k2_poll_3
L_k2_got_4:
    v_pk_add_f32 v[176:177], v[176:177], v[178:179]
    v_pk_add_f32 v[180:181], v[180:181], v[182:183]
    v_pk_add_f32 v[184:185], v[184:185], v[186:187]
    v_pk_add_f32 v[188:189], v[188:189], v[190:191]
    v_pk_add_f32 v[176:177], v[176:177], v[180:181]
    v_pk_add_f32 v[184:185], v[184:185], v[188:189]
    v_pk_add_f32 v[176:177], v[176:177], v[184:185]
    v_mul_f32 v176, 0xba97b426, v176
    v_mul_f32 v177, 0x3a97b426, v177
    v_fma_f32 v177, -v176, v176, v177
    v_max_f32 v177, 0, v177
    v_add_f32 v177, 0x3727c5ac, v177
    v_rsq_f32 v177, v177
    s_add_u32 s13, s11, 84480
    v_lshl_add_u32 v4, v1, 2, s13
    v_mul_f32 v176, v176, v177
    ds_write2st64_b32 v4, v177, v176 offset0:0 offset1:1
    v_add_u32 v4, s13, v208
    ds_read_b128 v[144:147], v4 offset:0
    ds_read_b128 v[160:163], v4 offset:256
    ds_read_b128 v[148:151], v4 offset:64
    ds_read_b128 v[164:167], v4 offset:320
    ds_read_b128 v[152:155], v4 offset:128
    ds_read_b128 v[168:171], v4 offset:384
    ds_read_b128 v[156:159], v4 offset:192
    ds_read_b128 v[172:175], v4 offset:448
    s_mul_i32 s13, s10, 458752
    s_lshl_b32 s14, s8, 17
    s_add_u32 s13, s13, s14
    s_lshl_b32 s14, s9, 11
    s_add_u32 s13, s13, s14
    s_add_u32 s13, s13, 12582912
    v_add_u32 v8, 45056, v8
    s_waitcnt lgkmcnt(6)
    v_pk_fma_f32 v[44:45], v[44:45], v[144:145], v[160:161]
    v_pk_fma_f32 v[46:47], v[46:47], v[146:147], v[162:163]
    s_waitcnt lgkmcnt(4)
    v_pk_fma_f32 v[48:49], v[48:49], v[148:149], v[164:165]
    v_pk_fma_f32 v[50:51], v[50:51], v[150:151], v[166:167]
    v_cvt_pk_bf16_f32 v176, v44, v48
    v_cvt_pk_bf16_f32 v177, v45, v49
    v_cvt_pk_bf16_f32 v178, v46, v50
    v_cvt_pk_bf16_f32 v179, v47, v51
    buffer_store_dwordx4 v[176:179], v7, s[4:7], s13 offen offset:0
    v_pk_fma_f32 v[60:61], v[60:61], v[144:145], v[160:161]
    v_pk_fma_f32 v[62:63], v[62:63], v[146:147], v[162:163]
    v_pk_fma_f32 v[64:65], v[64:65], v[148:149], v[164:165]
    v_pk_fma_f32 v[66:67], v[66:67], v[150:151], v[166:167]
    v_cvt_pk_bf16_f32 v180, v60, v64
    v_cvt_pk_bf16_f32 v181, v61, v65
    v_cvt_pk_bf16_f32 v182, v62, v66
    v_cvt_pk_bf16_f32 v183, v63, v67
    buffer_store_dwordx4 v[180:183], v8, s[4:7], s13 offen offset:0
    s_waitcnt lgkmcnt(2)
    v_pk_fma_f32 v[52:53], v[52:53], v[152:153], v[168:169]
    v_pk_fma_f32 v[54:55], v[54:55], v[154:155], v[170:171]
    s_waitcnt lgkmcnt(0)
    v_pk_fma_f32 v[56:57], v[56:57], v[156:157], v[172:173]
    v_pk_fma_f32 v[58:59], v[58:59], v[158:159], v[174:175]
    v_cvt_pk_bf16_f32 v184, v52, v56
    v_cvt_pk_bf16_f32 v185, v53, v57
    v_cvt_pk_bf16_f32 v186, v54, v58
    v_cvt_pk_bf16_f32 v187, v55, v59
    buffer_store_dwordx4 v[184:187], v7, s[4:7], s13 offen offset:1024
    v_pk_fma_f32 v[68:69], v[68:69], v[152:153], v[168:169]
    v_pk_fma_f32 v[70:71], v[70:71], v[154:155], v[170:171]
    v_pk_fma_f32 v[72:73], v[72:73], v[156:157], v[172:173]
    v_pk_fma_f32 v[74:75], v[74:75], v[158:159], v[174:175]
    v_cvt_pk_bf16_f32 v188, v68, v72
    v_cvt_pk_bf16_f32 v189, v69, v73
    v_cvt_pk_bf16_f32 v190, v70, v74
    v_cvt_pk_bf16_f32 v191, v71, v75
    buffer_store_dwordx4 v[188:191], v8, s[4:7], s13 offen offset:1024
L_k2_end_1:
    s_endpgm
.globl k3_kernel
.p2align 8
.type k3_kernel,@function
k3_kernel:
    s_cmp_ge_u32 s2, 256
    s_cbranch_scc1 L_k3_end_1
    s_load_dwordx2 s[4:5], s[0:1], 120
    s_mov_b32 s6, 33554432
    s_mov_b32 s7, 0x20000
    s_load_dwordx2 s[8:9], s[0:1], 64
    s_mov_b32 s10, 8388608
    s_mov_b32 s11, 0x20000
    s_load_dwordx2 s[12:13], s[0:1], 72
    s_mov_b32 s14, 4096
    s_mov_b32 s15, 0x20000
    v_lshrrev_b32 v2, 6, v0
    s_nop 0
    v_readfirstlane_b32 s16, v2
    s_lshr_b32 s19, s2, 5
    s_and_b32 s17, s2, 6
    s_lshl_b32 s17, s17, 2
    s_add_u32 s17, s17, s19
    s_bfe_u32 s19, s2, 0x20003
    s_and_b32 s18, s2, 1
    s_lshl_b32 s18, s18, 2
    s_add_u32 s18, s18, s19
    s_mov_b32 s3, 0xffff0000
    v_and_b32 v1, 63, v0
    v_lshrrev_b32 v2, 3, v1
    v_lshlrev_b32 v4, 13, v2
    v_lshrrev_b32 v2, 4, v1
    v_and_b32 v3, 7, v0
    v_xor_b32 v2, v2, v3
    v_lshl_add_u32 v4, v2, 4, v4
    v_xor_b32 v5, 64, v4
    v_add_u32 v5, 65536, v5
    s_lshl_b32 s19, s17, 18
    s_lshl_b32 s20, s16, 10
    s_add_u32 s28, s19, s20
    s_add_u32 s29, s28, 4096
    s_add_u32 s30, s28, 131072
    s_add_u32 s31, s28, 135168
    s_lshl_b32 s24, s16, 15
    s_add_u32 m0, s24, 0
    s_waitcnt lgkmcnt(0)
    buffer_load_dwordx4 v4, s[8:11], s28 offen offset:0 lds
    s_add_u32 m0, s24, 1024
    s_nop 0
    buffer_load_dwordx4 v5, s[8:11], s28 offen offset:0 lds
    s_add_u32 m0, s24, 1920
    s_nop 0
    buffer_load_dwordx4 v4, s[8:11], s28 offen offset:128 lds
    s_add_u32 m0, s24, 2944
    s_nop 0
    buffer_load_dwordx4 v5, s[8:11], s28 offen offset:128 lds
    s_add_u32 m0, s24, 3840
    s_nop 0
    buffer_load_dwordx4 v4, s[8:11], s28 offen offset:256 lds
    s_add_u32 m0, s24, 4864
    s_nop 0
    buffer_load_dwordx4 v5, s[8:11], s28 offen offset:256 lds
    s_add_u32 m0, s24, 5760
    s_nop 0
    buffer_load_dwordx4 v4, s[8:11], s28 offen offset:384 lds
    s_add_u32 m0, s24, 6784
    s_nop 0
    buffer_load_dwordx4 v5, s[8:11], s28 offen offset:384 lds
    s_add_u32 m0, s24, 7680
    s_nop 0
    buffer_load_dwordx4 v4, s[8:11], s28 offen offset:512 lds
    s_add_u32 m0, s24, 8704
    s_nop 0
    buffer_load_dwordx4 v5, s[8:11], s28 offen offset:512 lds
    s_add_u32 m0, s24, 9600
    s_nop 0
    buffer_load_dwordx4 v4, s[8:11], s28 offen offset:640 lds
    s_add_u32 m0, s24, 10624
    s_nop 0
    buffer_load_dwordx4 v5, s[8:11], s28 offen offset:640 lds
    s_add_u32 m0, s24, 11520
    s_nop 0
    buffer_load_dwordx4 v4, s[8:11], s28 offen offset:768 lds
    s_add_u32 m0, s24, 12544
    s_nop 0
    buffer_load_dwordx4 v5, s[8:11], s28 offen offset:768 lds
    s_add_u32 m0, s24, 13440
    s_nop 0
    buffer_load_dwordx4 v4, s[8:11], s28 offen offset:896 lds
    s_add_u32 m0, s24, 14464
    s_nop 0
    buffer_load_dwordx4 v5, s[8:11], s28 offen offset:896 lds
    s_add_u32 m0, s24, 16384
    s_nop 0
    buffer_load_dwordx4 v4, s[8:11], s29 offen offset:0 lds
    s_add_u32 m0, s24, 17408
    s_nop 0
    buffer_load_dwordx4 v5, s[8:11], s29 offen offset:0 lds
    s_add_u32 m0, s24, 18304
    s_nop 0
    buffer_load_dwordx4 v4, s[8:11], s29 offen offset:128 lds
    s_add_u32 m0, s24, 19328
    s_nop 0
    buffer_load_dwordx4 v5, s[8:11], s29 offen offset:128 lds
    s_add_u32 m0, s24, 20224
    s_nop 0
    buffer_load_dwordx4 v4, s[8:11], s29 offen offset:256 lds
    s_add_u32 m0, s24, 21248
    s_nop 0
    buffer_load_dwordx4 v5, s[8:11], s29 offen offset:256 lds
    s_add_u32 m0, s24, 22144
    s_nop 0
    buffer_load_dwordx4 v4, s[8:11], s29 offen offset:384 lds
    s_add_u32 m0, s24, 23168
    s_nop 0
    buffer_load_dwordx4 v5, s[8:11], s29 offen offset:384 lds
    s_add_u32 m0, s24, 24064
    s_nop 0
    buffer_load_dwordx4 v4, s[8:11], s29 offen offset:512 lds
    s_add_u32 m0, s24, 25088
    s_nop 0
    buffer_load_dwordx4 v5, s[8:11], s29 offen offset:512 lds
    s_add_u32 m0, s24, 25984
    s_nop 0
    buffer_load_dwordx4 v4, s[8:11], s29 offen offset:640 lds
    s_add_u32 m0, s24, 27008
    s_nop 0
    buffer_load_dwordx4 v5, s[8:11], s29 offen offset:640 lds
    s_add_u32 m0, s24, 27904
    s_nop 0
    buffer_load_dwordx4 v4, s[8:11], s29 offen offset:768 lds
    s_add_u32 m0, s24, 28928
    s_nop 0
    buffer_load_dwordx4 v5, s[8:11], s29 offen offset:768 lds
    s_add_u32 m0, s24, 29824
    s_nop 0
    buffer_load_dwordx4 v4, s[8:11], s29 offen offset:896 lds
    s_add_u32 m0, s24, 30848
    s_nop 0
    buffer_load_dwordx4 v5, s[8:11], s29 offen offset:896 lds
    v_lshlrev_b32 v8, 4, v1
    s_mul_i32 s25, s18, 458752
    s_lshl_b32 s19, s16, 14
    s_add_u32 s25, s25, s19
    s_add_u32 s25, s25, 12582912
    buffer_load_dwordx4 v[12:15], v8, s[4:7], s25 offen offset:0
    buffer_load_dwordx4 v[16:19], v8, s[4:7], s25 offen offset:1024
    buffer_load_dwordx4 v[20:23], v8, s[4:7], s25 offen offset:2048
    buffer_load_dwordx4 v[24:27], v8, s[4:7], s25 offen offset:3072
    s_add_u32 s25, s25, 4096
    buffer_load_dwordx4 v[28:31], v8, s[4:7], s25 offen offset:0
    buffer_load_dwordx4 v[32:35], v8, s[4:7], s25 offen offset:1024
    buffer_load_dwordx4 v[36:39], v8, s[4:7], s25 offen offset:2048
    buffer_load_dwordx4 v[40:43], v8, s[4:7], s25 offen offset:3072
    s_add_u32 s25, s25, 4096
    buffer_load_dwordx4 v[44:47], v8, s[4:7], s25 offen offset:0
    buffer_load_dwordx4 v[48:51], v8, s[4:7], s25 offen offset:1024
    buffer_load_dwordx4 v[52:55], v8, s[4:7], s25 offen offset:2048
    buffer_load_dwordx4 v[56:59], v8, s[4:7], s25 offen offset:3072
    s_add_u32 s25, s25, 4096
    buffer_load_dwordx4 v[60:63], v8, s[4:7], s25 offen offset:0
    buffer_load_dwordx4 v[64:67], v8, s[4:7], s25 offen offset:1024
    buffer_load_dwordx4 v[68:71], v8, s[4:7], s25 offen offset:2048
    buffer_load_dwordx4 v[72:75], v8, s[4:7], s25 offen offset:3072
    s_add_u32 s25, s25, 53248
    buffer_load_dwordx4 v[76:79], v8, s[4:7], s25 offen offset:0
    buffer_load_dwordx4 v[80:83], v8, s[4:7], s25 offen offset:1024
    buffer_load_dwordx4 v[84:87], v8, s[4:7], s25 offen offset:2048
    buffer_load_dwordx4 v[88:91], v8, s[4:7], s25 offen offset:3072
    s_add_u32 s25, s25, 4096
    buffer_load_dwordx4 v[92:95], v8, s[4:7], s25 offen offset:0
    buffer_load_dwordx4 v[96:99], v8, s[4:7], s25 offen offset:1024
    buffer_load_dwordx4 v[100:103], v8, s[4:7], s25 offen offset:2048
    buffer_load_dwordx4 v[104:107], v8, s[4:7], s25 offen offset:3072
    s_add_u32 s25, s25, 4096
    v_and_b32 v2, 15, v0
    v_lshlrev_b32 v6, 7, v2
    v_lshlrev_b32 v11, 2, v2
    v_lshrrev_b32 v2, 1, v2
    v_lshrrev_b32 v3, 4, v1
    v_xor_b32 v2, v2, v3
    v_lshl_add_u32 v6, v2, 4, v6
    v_add_u32 v6, s24, v6
    v_xor_b32 v7, 64, v6
    v_add_u32 v9, s24, v8
    s_lshl_b32 s19, s16, 10
    v_add_u32 v10, s19, v8
    v_add_u32 v140, 65536, v10
    s_waitcnt vmcnt(54)
    ds_read_b128 a[0:3], v6 offset:0
    ds_read_b128 a[4:7], v7 offset:0
    s_waitcnt vmcnt(52)
    ds_read_b128 a[8:11], v6 offset:2048
    ds_read_b128 a[12:15], v7 offset:2048
    s_waitcnt lgkmcnt(2)
    s_add_u32 m0, s24, 0
    s_nop 0
    buffer_load_dwordx4 v4, s[8:11], s30 offen offset:0 lds
    s_add_u32 m0, s24, 1024
    s_nop 0
    buffer_load_dwordx4 v5, s[8:11], s30 offen offset:0 lds
    s_waitcnt vmcnt(52)
    ds_read_b128 a[16:19], v6 offset:4096
    ds_read_b128 a[20:23], v7 offset:4096
    s_waitcnt lgkmcnt(2)
    s_add_u32 m0, s24, 1920
    s_nop 0
    buffer_load_dwordx4 v4, s[8:11], s30 offen offset:128 lds
    s_add_u32 m0, s24, 2944
    s_nop 0
    buffer_load_dwordx4 v5, s[8:11], s30 offen offset:128 lds
    s_waitcnt vmcnt(52)
    ds_read_b128 a[24:27], v6 offset:6144
    ds_read_b128 a[28:31], v7 offset:6144
    s_waitcnt lgkmcnt(2)
    s_add_u32 m0, s24, 3840
    s_nop 0
    buffer_load_dwordx4 v4, s[8:11], s30 offen offset:256 lds
    s_add_u32 m0, s24, 4864
    s_nop 0
    buffer_load_dwordx4 v5, s[8:11], s30 offen offset:256 lds
    s_waitcnt vmcnt(52)
    ds_read_b128 a[32:35], v6 offset:8192
    ds_read_b128 a[36:39], v7 offset:8192
    s_waitcnt lgkmcnt(2)
    s_add_u32 m0, s24, 5760
    s_nop 0
    buffer_load_dwordx4 v4, s[8:11], s30 offen offset:384 lds
    s_add_u32 m0, s24, 6784
    s_nop 0
    buffer_load_dwordx4 v5, s[8:11], s30 offen offset:384 lds
    s_waitcnt vmcnt(52)
    ds_read_b128 a[40:43], v6 offset:10240
    ds_read_b128 a[44:47], v7 offset:10240
    s_waitcnt lgkmcnt(2)
    s_add_u32 m0, s24, 7680
    s_nop 0
    buffer_load_dwordx4 v4, s[8:11], s30 offen offset:512 lds
    s_add_u32 m0, s24, 8704
    s_nop 0
    buffer_load_dwordx4 v5, s[8:11], s30 offen offset:512 lds
    s_waitcnt vmcnt(52)
    ds_read_b128 a[48:51], v6 offset:12288
    ds_read_b128 a[52:55], v7 offset:12288
    s_waitcnt lgkmcnt(2)
    s_add_u32 m0, s24, 9600
    s_nop 0
    buffer_load_dwordx4 v4, s[8:11], s30 offen offset:640 lds
    s_add_u32 m0, s24, 10624
    s_nop 0
    buffer_load_dwordx4 v5, s[8:11], s30 offen offset:640 lds
    s_waitcnt vmcnt(52)
    ds_read_b128 a[56:59], v6 offset:14336
    ds_read_b128 a[60:63], v7 offset:14336
    s_waitcnt lgkmcnt(2)
    s_add_u32 m0, s24, 11520
    s_nop 0
    buffer_load_dwordx4 v4, s[8:11], s30 offen offset:768 lds
    s_add_u32 m0, s24, 12544
    s_nop 0
    buffer_load_dwordx4 v5, s[8:11], s30 offen offset:768 lds
    s_waitcnt vmcnt(52)
    ds_read_b128 a[64:67], v6 offset:16384
    ds_read_b128 a[68:71], v7 offset:16384
    s_waitcnt lgkmcnt(2)
    s_add_u32 m0, s24, 13440
    s_nop 0
    buffer_load_dwordx4 v4, s[8:11], s30 offen offset:896 lds
    s_add_u32 m0, s24, 14464
    s_nop 0
    buffer_load_dwordx4 v5, s[8:11], s30 offen offset:896 lds
    s_waitcnt vmcnt(52)
    ds_read_b128 a[72:75], v6 offset:18432
    ds_read_b128 a[76:79], v7 offset:18432
    s_waitcnt lgkmcnt(2)
    s_add_u32 m0, s24, 16384
    s_nop 0
    buffer_load_dwordx4 v4, s[8:11], s31 offen offset:0 lds
    s_add_u32 m0, s24, 17408
    s_nop 0
    buffer_load_dwordx4 v5, s[8:11], s31 offen offset:0 lds
    s_waitcnt vmcnt(52)
    ds_read_b128 a[80:83], v6 offset:20480
    ds_read_b128 a[84:87], v7 offset:20480
    s_waitcnt lgkmcnt(2)
    s_add_u32 m0, s24, 18304
    s_nop 0
    buffer_load_dwordx4 v4, s[8:11], s31 offen offset:128 lds
    s_add_u32 m0, s24, 19328
    s_nop 0
    buffer_load_dwordx4 v5, s[8:11], s31 offen offset:128 lds
    s_waitcnt vmcnt(52)
    ds_read_b128 a[88:91], v6 offset:22528
    ds_read_b128 a[92:95], v7 offset:22528
    s_waitcnt lgkmcnt(2)
    s_add_u32 m0, s24, 20224
    s_nop 0
    buffer_load_dwordx4 v4, s[8:11], s31 offen offset:256 lds
    s_add_u32 m0, s24, 21248
    s_nop 0
    buffer_load_dwordx4 v5, s[8:11], s31 offen offset:256 lds
    s_waitcnt vmcnt(52)
    ds_read_b128 a[96:99], v6 offset:24576
    ds_read_b128 a[100:103], v7 offset:24576
    s_waitcnt lgkmcnt(2)
    s_add_u32 m0, s24, 22144
    s_nop 0
    buffer_load_dwordx4 v4, s[8:11], s31 offen offset:384 lds
    s_add_u32 m0, s24, 23168
    s_nop 0
    buffer_load_dwordx4 v5, s[8:11], s31 offen offset:384 lds
    s_waitcnt vmcnt(52)
    ds_read_b128 a[104:107], v6 offset:26624
    ds_read_b128 a[108:111], v7 offset:26624
    s_waitcnt lgkmcnt(2)
    s_add_u32 m0, s24, 24064
    s_nop 0
    buffer_load_dwordx4 v4, s[8:11], s31 offen offset:512 lds
    s_add_u32 m0, s24, 25088
    s_nop 0
    buffer_load_dwordx4 v5, s[8:11], s31 offen offset:512 lds
    s_waitcnt vmcnt(52)
    ds_read_b128 a[112:115], v6 offset:28672
    ds_read_b128 a[116:119], v7 offset:28672
    s_waitcnt lgkmcnt(2)
    s_add_u32 m0, s24, 25984
    s_nop 0
    buffer_load_dwordx4 v4, s[8:11], s31 offen offset:640 lds
    s_add_u32 m0, s24, 27008
    s_nop 0
    buffer_load_dwordx4 v5, s[8:11], s31 offen offset:640 lds
    s_waitcnt vmcnt(52)
    ds_read_b128 a[120:123], v6 offset:30720
    ds_read_b128 a[124:127], v7 offset:30720
    s_waitcnt lgkmcnt(2)
    s_add_u32 m0, s24, 27904
    s_nop 0
    buffer_load_dwordx4 v4, s[8:11], s31 offen offset:768 lds
    s_add_u32 m0, s24, 28928
    s_nop 0
    buffer_load_dwordx4 v5, s[8:11], s31 offen offset:768 lds
    s_waitcnt vmcnt(28)
    ds_read_b128 a[128:131], v6 offset:0
    ds_read_b128 a[132:135], v7 offset:0
    s_waitcnt lgkmcnt(2)
    s_add_u32 m0, s24, 29824
    s_nop 0
    buffer_load_dwordx4 v4, s[8:11], s31 offen offset:896 lds
    s_add_u32 m0, s24, 30848
    s_nop 0
    buffer_load_dwordx4 v5, s[8:11], s31 offen offset:896 lds
    buffer_load_dwordx4 v[108:111], v8, s[4:7], s25 offen offset:0
    buffer_load_dwordx4 v[112:115], v8, s[4:7], s25 offen offset:1024
    buffer_load_dwordx4 v[116:119], v8, s[4:7], s25 offen offset:2048
    buffer_load_dwordx4 v[120:123], v8, s[4:7], s25 offen offset:3072
    s_add_u32 s25, s25, 4096
    buffer_load_dwordx4 v[124:127], v8, s[4:7], s25 offen offset:0
    buffer_load_dwordx4 v[128:131], v8, s[4:7], s25 offen offset:1024
    buffer_load_dwordx4 v[132:135], v8, s[4:7], s25 offen offset:2048
    buffer_load_dwordx4 v[136:139], v8, s[4:7], s25 offen offset:3072
    s_add_u32 s25, s25, 53248
    s_lshl_b32 s19, s17, 3
    s_add_u32 s19, s19, s18
    s_lshl_b32 s19, s19, 14
    s_lshl_b32 s20, s16, 12
    s_add_u32 s19, s19, s20
    s_add_u32 s19, s19, 16252928
    buffer_load_dwordx4 v[144:147], v8, s[4:7], s19 offen offset:0
    buffer_load_dwordx4 v[148:151], v8, s[4:7], s19 offen offset:1024
    buffer_load_dwordx4 v[152:155], v8, s[4:7], s19 offen offset:2048
    buffer_load_dwordx4 v[156:159], v8, s[4:7], s19 offen offset:3072
    s_lshl_b32 s19, s17, 7
    s_lshr_b32 s20, s16, 1
    s_lshl_b32 s20, s20, 6
    s_add_u32 s19, s19, s20
    s_and_b32 s20, s16, 1
    s_lshl_b32 s20, s20, 1
    s_add_u32 s19, s19, s20
    buffer_load_ushort v11, v11, s[12:15], s19 offen
    s_waitcnt vmcnt(41)
    ds_read_b128 a[136:139], v6 offset:2048
    ds_read_b128 a[140:143], v7 offset:2048
    s_waitcnt vmcnt(39)
    ds_read_b128 a[144:147], v6 offset:4096
    ds_read_b128 a[148:151], v7 offset:4096
    s_waitcnt vmcnt(37)
    ds_read_b128 a[152:155], v6 offset:6144
    ds_read_b128 a[156:159], v7 offset:6144
    s_waitcnt vmcnt(35)
    ds_read_b128 a[160:163], v6 offset:8192
    ds_read_b128 a[164:167], v7 offset:8192
    s_waitcnt vmcnt(33)
    ds_read_b128 a[168:171], v6 offset:10240
    ds_read_b128 a[172:175], v7 offset:10240
    s_waitcnt vmcnt(31)
    ds_read_b128 a[176:179], v6 offset:12288
    ds_read_b128 a[180:183], v7 offset:12288
    s_waitcnt vmcnt(29)
    ds_read_b128 a[184:187], v6 offset:14336
    ds_read_b128 a[188:191], v7 offset:14336
    s_waitcnt vmcnt(27)
    ds_read_b128 a[192:195], v6 offset:16384
    ds_read_b128 a[196:199], v7 offset:16384
    s_waitcnt vmcnt(25)
    ds_read_b128 a[200:203], v6 offset:18432
    ds_read_b128 a[204:207], v7 offset:18432
    s_waitcnt vmcnt(23)
    ds_read_b128 a[208:211], v6 offset:20480
    ds_read_b128 a[212:215], v7 offset:20480
    s_waitcnt vmcnt(21)
    ds_read_b128 a[216:219], v6 offset:22528
    ds_read_b128 a[220:223], v7 offset:22528
    s_waitcnt vmcnt(19)
    ds_read_b128 a[224:227], v6 offset:24576
    ds_read_b128 a[228:231], v7 offset:24576
    s_waitcnt vmcnt(17)
    ds_read_b128 a[232:235], v6 offset:26624
    ds_read_b128 a[236:239], v7 offset:26624
    s_waitcnt vmcnt(15)
    ds_read_b128 a[240:243], v6 offset:28672
    ds_read_b128 a[244:247], v7 offset:28672
    s_waitcnt vmcnt(13)
    ds_read_b128 a[248:251], v6 offset:30720
    ds_read_b128 a[252:255], v7 offset:30720
    s_lshl_b32 s19, s17, 2
    s_add_u32 s19, s19, s16
    s_mul_i32 s19, s19, 28672
    s_add_u32 s19, s19, 20447232
    s_mul_i32 s26, s18, 3072
    s_add_u32 s26, s26, s19
    s_lshr_b32 s27, s18, 1
    s_lshl_b32 s27, s27, 10
    s_add_u32 s27, s27, s19
    s_and_b32 s20, s18, 1
    s_lshl_b32 s20, s20, 3
    s_add_u32 s27, s27, s20
    s_add_u32 s27, s27, 24576
    v_mfma_f32_16x16x32_bf16 v[160:163], v[12:15], a[0:3], 0
    v_mfma_f32_16x16x32_bf16 v[164:167], v[12:15], a[64:67], 0
    s_waitcnt lgkmcnt(15)
    v_mfma_f32_16x16x32_bf16 v[168:171], v[12:15], a[128:131], 0
    v_mfma_f32_16x16x32_bf16 v[172:175], v[12:15], a[192:195], 0
    buffer_load_dwordx4 v[12:15], v8, s[4:7], s25 offen offset:0
    v_mfma_f32_16x16x32_bf16 v[160:163], v[16:19], a[4:7], v[160:163]
    v_mfma_f32_16x16x32_bf16 v[164:167], v[16:19], a[68:71], v[164:167]
    v_mfma_f32_16x16x32_bf16 v[168:171], v[16:19], a[132:135], v[168:171]
    s_waitcnt lgkmcnt(14)
    v_mfma_f32_16x16x32_bf16 v[172:175], v[16:19], a[196:199], v[172:175]
    buffer_load_dwordx4 v[16:19], v8, s[4:7], s25 offen offset:1024
    v_mfma_f32_16x16x32_bf16 v[160:163], v[20:23], a[8:11], v[160:163]
    v_mfma_f32_16x16x32_bf16 v[164:167], v[20:23], a[72:75], v[164:167]
    v_mfma_f32_16x16x32_bf16 v[168:171], v[20:23], a[136:139], v[168:171]
    s_waitcnt lgkmcnt(13)
    v_mfma_f32_16x16x32_bf16 v[172:175], v[20:23], a[200:203], v[172:175]
    buffer_load_dwordx4 v[20:23], v8, s[4:7], s25 offen offset:2048
    v_mfma_f32_16x16x32_bf16 v[160:163], v[24:27], a[12:15], v[160:163]
    v_mfma_f32_16x16x32_bf16 v[164:167], v[24:27], a[76:79], v[164:167]
    v_mfma_f32_16x16x32_bf16 v[168:171], v[24:27], a[140:143], v[168:171]
    s_waitcnt lgkmcnt(12)
    v_mfma_f32_16x16x32_bf16 v[172:175], v[24:27], a[204:207], v[172:175]
    buffer_load_dwordx4 v[24:27], v8, s[4:7], s25 offen offset:3072
    s_add_u32 s25, s25, 4096
    v_mfma_f32_16x16x32_bf16 v[160:163], v[28:31], a[16:19], v[160:163]
    v_mfma_f32_16x16x32_bf16 v[164:167], v[28:31], a[80:83], v[164:167]
    v_mfma_f32_16x16x32_bf16 v[168:171], v[28:31], a[144:147], v[168:171]
    s_waitcnt lgkmcnt(11)
    v_mfma_f32_16x16x32_bf16 v[172:175], v[28:31], a[208:211], v[172:175]
    buffer_load_dwordx4 v[28:31], v8, s[4:7], s25 offen offset:0
    v_mfma_f32_16x16x32_bf16 v[160:163], v[32:35], a[20:23], v[160:163]
    v_mfma_f32_16x16x32_bf16 v[164:167], v[32:35], a[84:87], v[164:167]
    v_mfma_f32_16x16x32_bf16 v[168:171], v[32:35], a[148:151], v[168:171]
    s_waitcnt lgkmcnt(10)
    v_mfma_f32_16x16x32_bf16 v[172:175], v[32:35], a[212:215], v[172:175]
    buffer_load_dwordx4 v[32:35], v8, s[4:7], s25 offen offset:1024
    v_mfma_f32_16x16x32_bf16 v[160:163], v[36:39], a[24:27], v[160:163]
    v_mfma_f32_16x16x32_bf16 v[164:167], v[36:39], a[88:91], v[164:167]
    v_mfma_f32_16x16x32_bf16 v[168:171], v[36:39], a[152:155], v[168:171]
    s_waitcnt lgkmcnt(9)
    v_mfma_f32_16x16x32_bf16 v[172:175], v[36:39], a[216:219], v[172:175]
    buffer_load_dwordx4 v[36:39], v8, s[4:7], s25 offen offset:2048
    v_mfma_f32_16x16x32_bf16 v[160:163], v[40:43], a[28:31], v[160:163]
    v_mfma_f32_16x16x32_bf16 v[164:167], v[40:43], a[92:95], v[164:167]
    v_mfma_f32_16x16x32_bf16 v[168:171], v[40:43], a[156:159], v[168:171]
    s_waitcnt lgkmcnt(8)
    v_mfma_f32_16x16x32_bf16 v[172:175], v[40:43], a[220:223], v[172:175]
    buffer_load_dwordx4 v[40:43], v8, s[4:7], s25 offen offset:3072
    s_add_u32 s25, s25, 4096
    v_mfma_f32_16x16x32_bf16 v[160:163], v[44:47], a[32:35], v[160:163]
    v_mfma_f32_16x16x32_bf16 v[164:167], v[44:47], a[96:99], v[164:167]
    v_mfma_f32_16x16x32_bf16 v[168:171], v[44:47], a[160:163], v[168:171]
    s_waitcnt lgkmcnt(7)
    v_mfma_f32_16x16x32_bf16 v[172:175], v[44:47], a[224:227], v[172:175]
    buffer_load_dwordx4 v[44:47], v8, s[4:7], s25 offen offset:0
    v_mfma_f32_16x16x32_bf16 v[160:163], v[48:51], a[36:39], v[160:163]
    v_mfma_f32_16x16x32_bf16 v[164:167], v[48:51], a[100:103], v[164:167]
    v_mfma_f32_16x16x32_bf16 v[168:171], v[48:51], a[164:167], v[168:171]
    s_waitcnt lgkmcnt(6)
    v_mfma_f32_16x16x32_bf16 v[172:175], v[48:51], a[228:231], v[172:175]
    buffer_load_dwordx4 v[48:51], v8, s[4:7], s25 offen offset:1024
    v_mfma_f32_16x16x32_bf16 v[160:163], v[52:55], a[40:43], v[160:163]
    v_mfma_f32_16x16x32_bf16 v[164:167], v[52:55], a[104:107], v[164:167]
    v_mfma_f32_16x16x32_bf16 v[168:171], v[52:55], a[168:171], v[168:171]
    s_waitcnt lgkmcnt(5)
    v_mfma_f32_16x16x32_bf16 v[172:175], v[52:55], a[232:235], v[172:175]
    buffer_load_dwordx4 v[52:55], v8, s[4:7], s25 offen offset:2048
    v_mfma_f32_16x16x32_bf16 v[160:163], v[56:59], a[44:47], v[160:163]
    v_mfma_f32_16x16x32_bf16 v[164:167], v[56:59], a[108:111], v[164:167]
    v_mfma_f32_16x16x32_bf16 v[168:171], v[56:59], a[172:175], v[168:171]
    s_waitcnt lgkmcnt(4)
    v_mfma_f32_16x16x32_bf16 v[172:175], v[56:59], a[236:239], v[172:175]
    buffer_load_dwordx4 v[56:59], v8, s[4:7], s25 offen offset:3072
    s_add_u32 s25, s25, 4096
    v_mfma_f32_16x16x32_bf16 v[160:163], v[60:63], a[48:51], v[160:163]
    v_mfma_f32_16x16x32_bf16 v[164:167], v[60:63], a[112:115], v[164:167]
    v_mfma_f32_16x16x32_bf16 v[168:171], v[60:63], a[176:179], v[168:171]
    s_waitcnt lgkmcnt(3)
    v_mfma_f32_16x16x32_bf16 v[172:175], v[60:63], a[240:243], v[172:175]
    buffer_load_dwordx4 v[60:63], v8, s[4:7], s25 offen offset:0
    v_mfma_f32_16x16x32_bf16 v[160:163], v[64:67], a[52:55], v[160:163]
    v_mfma_f32_16x16x32_bf16 v[164:167], v[64:67], a[116:119], v[164:167]
    v_mfma_f32_16x16x32_bf16 v[168:171], v[64:67], a[180:183], v[168:171]
    s_waitcnt lgkmcnt(2)
    v_mfma_f32_16x16x32_bf16 v[172:175], v[64:67], a[244:247], v[172:175]
    buffer_load_dwordx4 v[64:67], v8, s[4:7], s25 offen offset:1024
    v_mfma_f32_16x16x32_bf16 v[160:163], v[68:71], a[56:59], v[160:163]
    v_mfma_f32_16x16x32_bf16 v[164:167], v[68:71], a[120:123], v[164:167]
    v_mfma_f32_16x16x32_bf16 v[168:171], v[68:71], a[184:187], v[168:171]
    s_waitcnt lgkmcnt(1)
    v_mfma_f32_16x16x32_bf16 v[172:175], v[68:71], a[248:251], v[172:175]
    buffer_load_dwordx4 v[68:71], v8, s[4:7], s25 offen offset:2048
    v_mfma_f32_16x16x32_bf16 v[160:163], v[72:75], a[60:63], v[160:163]
    v_mfma_f32_16x16x32_bf16 v[164:167], v[72:75], a[124:127], v[164:167]
    v_mfma_f32_16x16x32_bf16 v[168:171], v[72:75], a[188:191], v[168:171]
    s_waitcnt lgkmcnt(0)
    v_mfma_f32_16x16x32_bf16 v[172:175], v[72:75], a[252:255], v[172:175]
    buffer_load_dwordx4 v[72:75], v8, s[4:7], s25 offen offset:3072
    s_add_u32 s25, s25, 53248
    v_mfma_f32_16x16x32_bf16 v[176:179], v[76:79], a[0:3], 0
    v_mfma_f32_16x16x32_bf16 v[180:183], v[76:79], a[64:67], 0
    v_mfma_f32_16x16x32_bf16 v[184:187], v[76:79], a[128:131], 0
    v_mfma_f32_16x16x32_bf16 v[188:191], v[76:79], a[192:195], 0
    buffer_load_dwordx4 v[76:79], v8, s[4:7], s25 offen offset:0
    v_mfma_f32_16x16x32_bf16 v[176:179], v[80:83], a[4:7], v[176:179]
    v_mfma_f32_16x16x32_bf16 v[180:183], v[80:83], a[68:71], v[180:183]
    v_mfma_f32_16x16x32_bf16 v[184:187], v[80:83], a[132:135], v[184:187]
    v_mfma_f32_16x16x32_bf16 v[188:191], v[80:83], a[196:199], v[188:191]
    buffer_load_dwordx4 v[80:83], v8, s[4:7], s25 offen offset:1024
    ds_write_b128 v9, v[160:163] offset:0
    ds_write_b128 v9, v[164:167] offset:1024
    ds_write_b128 v9, v[168:171] offset:2048
    ds_write_b128 v9, v[172:175] offset:3072
    v_mfma_f32_16x16x32_bf16 v[176:179], v[84:87], a[8:11], v[176:179]
    v_mfma_f32_16x16x32_bf16 v[180:183], v[84:87], a[72:75], v[180:183]
    v_mfma_f32_16x16x32_bf16 v[184:187], v[84:87], a[136:139], v[184:187]
    v_mfma_f32_16x16x32_bf16 v[188:191], v[84:87], a[200:203], v[188:191]
    buffer_load_dwordx4 v[84:87], v8, s[4:7], s25 offen offset:2048
    v_mfma_f32_16x16x32_bf16 v[176:179], v[88:91], a[12:15], v[176:179]
    v_mfma_f32_16x16x32_bf16 v[180:183], v[88:91], a[76:79], v[180:183]
    v_mfma_f32_16x16x32_bf16 v[184:187], v[88:91], a[140:143], v[184:187]
    v_mfma_f32_16x16x32_bf16 v[188:191], v[88:91], a[204:207], v[188:191]
    buffer_load_dwordx4 v[88:91], v8, s[4:7], s25 offen offset:3072
    s_add_u32 s25, s25, 4096
    v_mfma_f32_16x16x32_bf16 v[176:179], v[92:95], a[16:19], v[176:179]
    v_mfma_f32_16x16x32_bf16 v[180:183], v[92:95], a[80:83], v[180:183]
    v_mfma_f32_16x16x32_bf16 v[184:187], v[92:95], a[144:147], v[184:187]
    v_mfma_f32_16x16x32_bf16 v[188:191], v[92:95], a[208:211], v[188:191]
    buffer_load_dwordx4 v[92:95], v8, s[4:7], s25 offen offset:0
    s_waitcnt lgkmcnt(0)
    s_barrier
    ds_read_b128 v[192:195], v10 offset:0
    ds_read_b128 v[196:199], v10 offset:32768
    ds_read_b128 v[200:203], v140 offset:0
    ds_read_b128 v[204:207], v140 offset:32768
    v_mfma_f32_16x16x32_bf16 v[176:179], v[96:99], a[20:23], v[176:179]
    v_mfma_f32_16x16x32_bf16 v[180:183], v[96:99], a[84:87], v[180:183]
    v_mfma_f32_16x16x32_bf16 v[184:187], v[96:99], a[148:151], v[184:187]
    v_mfma_f32_16x16x32_bf16 v[188:191], v[96:99], a[212:215], v[188:191]
    buffer_load_dwordx4 v[96:99], v8, s[4:7], s25 offen offset:1024
    v_mfma_f32_16x16x32_bf16 v[176:179], v[100:103], a[24:27], v[176:179]
    v_mfma_f32_16x16x32_bf16 v[180:183], v[100:103], a[88:91], v[180:183]
    v_mfma_f32_16x16x32_bf16 v[184:187], v[100:103], a[152:155], v[184:187]
    v_mfma_f32_16x16x32_bf16 v[188:191], v[100:103], a[216:219], v[188:191]
    buffer_load_dwordx4 v[100:103], v8, s[4:7], s25 offen offset:2048
    v_mfma_f32_16x16x32_bf16 v[176:179], v[104:107], a[28:31], v[176:179]
    v_mfma_f32_16x16x32_bf16 v[180:183], v[104:107], a[92:95], v[180:183]
    v_mfma_f32_16x16x32_bf16 v[184:187], v[104:107], a[156:159], v[184:187]
    v_mfma_f32_16x16x32_bf16 v[188:191], v[104:107], a[220:223], v[188:191]
    buffer_load_dwordx4 v[104:107], v8, s[4:7], s25 offen offset:3072
    s_add_u32 s25, s25, 4096
    s_waitcnt vmcnt(24)
    v_lshlrev_b32 v11, 16, v11
    s_waitcnt lgkmcnt(2)
    v_add_f32 v192, v192, v196
    v_add_f32 v193, v193, v197
    v_add_f32 v194, v194, v198
    v_add_f32 v195, v195, v199
    s_waitcnt lgkmcnt(0)
    v_add_f32 v200, v200, v204
    v_add_f32 v201, v201, v205
    v_add_f32 v202, v202, v206
    v_add_f32 v203, v203, v207
    v_mfma_f32_16x16x32_bf16 v[176:179], v[108:111], a[32:35], v[176:179]
    v_mfma_f32_16x16x32_bf16 v[180:183], v[108:111], a[96:99], v[180:183]
    v_mfma_f32_16x16x32_bf16 v[184:187], v[108:111], a[160:163], v[184:187]
    v_mfma_f32_16x16x32_bf16 v[188:191], v[108:111], a[224:227], v[188:191]
    buffer_load_dwordx4 v[108:111], v8, s[4:7], s25 offen offset:0
    v_mfma_f32_16x16x32_bf16 v[176:179], v[112:115], a[36:39], v[176:179]
    v_mfma_f32_16x16x32_bf16 v[180:183], v[112:115], a[100:103], v[180:183]
    v_mfma_f32_16x16x32_bf16 v[184:187], v[112:115], a[164:167], v[184:187]
    v_mfma_f32_16x16x32_bf16 v[188:191], v[112:115], a[228:231], v[188:191]
    buffer_load_dwordx4 v[112:115], v8, s[4:7], s25 offen offset:1024
    v_add_f32 v192, v192, v11
    v_add_f32 v193, v193, v11
    v_add_f32 v194, v194, v11
    v_add_f32 v195, v195, v11
    v_add_f32 v192, v192, v200
    v_add_f32 v193, v193, v201
    v_add_f32 v194, v194, v202
    v_add_f32 v195, v195, v203
    v_mfma_f32_16x16x32_bf16 v[176:179], v[116:119], a[40:43], v[176:179]
    v_mfma_f32_16x16x32_bf16 v[180:183], v[116:119], a[104:107], v[180:183]
    v_mfma_f32_16x16x32_bf16 v[184:187], v[116:119], a[168:171], v[184:187]
    v_mfma_f32_16x16x32_bf16 v[188:191], v[116:119], a[232:235], v[188:191]
    buffer_load_dwordx4 v[116:119], v8, s[4:7], s25 offen offset:2048
    v_mfma_f32_16x16x32_bf16 v[176:179], v[120:123], a[44:47], v[176:179]
    v_mfma_f32_16x16x32_bf16 v[180:183], v[120:123], a[108:111], v[180:183]
    v_mfma_f32_16x16x32_bf16 v[184:187], v[120:123], a[172:175], v[184:187]
    v_mfma_f32_16x16x32_bf16 v[188:191], v[120:123], a[236:239], v[188:191]
    buffer_load_dwordx4 v[120:123], v8, s[4:7], s25 offen offset:3072
    s_add_u32 s25, s25, 4096
    v_lshlrev_b32 v216, 16, v144
    v_lshlrev_b32 v217, 16, v145
    v_lshlrev_b32 v218, 16, v146
    v_lshlrev_b32 v219, 16, v147
    v_mul_f32 v208, v192, v216
    v_mul_f32 v209, v193, v217
    v_mul_f32 v210, v194, v218
    v_mul_f32 v211, v195, v219
    v_mfma_f32_16x16x32_bf16 v[176:179], v[124:127], a[48:51], v[176:179]
    v_mfma_f32_16x16x32_bf16 v[180:183], v[124:127], a[112:115], v[180:183]
    v_mfma_f32_16x16x32_bf16 v[184:187], v[124:127], a[176:179], v[184:187]
    v_mfma_f32_16x16x32_bf16 v[188:191], v[124:127], a[240:243], v[188:191]
    buffer_load_dwordx4 v[124:127], v8, s[4:7], s25 offen offset:0
    v_mfma_f32_16x16x32_bf16 v[176:179], v[128:131], a[52:55], v[176:179]
    v_mfma_f32_16x16x32_bf16 v[180:183], v[128:131], a[116:119], v[180:183]
    v_mfma_f32_16x16x32_bf16 v[184:187], v[128:131], a[180:183], v[184:187]
    v_mfma_f32_16x16x32_bf16 v[188:191], v[128:131], a[244:247], v[188:191]
    buffer_load_dwordx4 v[128:131], v8, s[4:7], s25 offen offset:1024
    v_mfma_f32_16x16x32_bf16 v[176:179], v[132:135], a[56:59], v[176:179]
    v_mfma_f32_16x16x32_bf16 v[180:183], v[132:135], a[120:123], v[180:183]
    v_mfma_f32_16x16x32_bf16 v[184:187], v[132:135], a[184:187], v[184:187]
    v_mfma_f32_16x16x32_bf16 v[188:191], v[132:135], a[248:251], v[188:191]
    buffer_load_dwordx4 v[132:135], v8, s[4:7], s25 offen offset:2048
    v_mfma_f32_16x16x32_bf16 v[176:179], v[136:139], a[60:63], v[176:179]
    v_mfma_f32_16x16x32_bf16 v[180:183], v[136:139], a[124:127], v[180:183]
    v_mfma_f32_16x16x32_bf16 v[184:187], v[136:139], a[188:191], v[184:187]
    v_mfma_f32_16x16x32_bf16 v[188:191], v[136:139], a[252:255], v[188:191]
    buffer_load_dwordx4 v[136:139], v8, s[4:7], s25 offen offset:3072
    s_add_u32 s25, s25, 53248
    s_waitcnt vmcnt(31)
    v_mfma_f32_16x16x32_bf16 v[160:163], v[12:15], a[0:3], 0
    v_mfma_f32_16x16x32_bf16 v[164:167], v[12:15], a[64:67], 0
    v_mfma_f32_16x16x32_bf16 v[168:171], v[12:15], a[128:131], 0
    v_mfma_f32_16x16x32_bf16 v[172:175], v[12:15], a[192:195], 0
    buffer_load_dwordx4 v[12:15], v8, s[4:7], s25 offen offset:0
    s_waitcnt vmcnt(31)
    v_mfma_f32_16x16x32_bf16 v[160:163], v[16:19], a[4:7], v[160:163]
    v_mfma_f32_16x16x32_bf16 v[164:167], v[16:19], a[68:71], v[164:167]
    v_mfma_f32_16x16x32_bf16 v[168:171], v[16:19], a[132:135], v[168:171]
    v_mfma_f32_16x16x32_bf16 v[172:175], v[16:19], a[196:199], v[172:175]
    buffer_load_dwordx4 v[16:19], v8, s[4:7], s25 offen offset:1024
    ds_write_b128 v9, v[176:179] offset:4096
    ds_write_b128 v9, v[180:183] offset:5120
    ds_write_b128 v9, v[184:187] offset:6144
    ds_write_b128 v9, v[188:191] offset:7168
    s_waitcnt vmcnt(31)
    v_mfma_f32_16x16x32_bf16 v[160:163], v[20:23], a[8:11], v[160:163]
    v_mfma_f32_16x16x32_bf16 v[164:167], v[20:23], a[72:75], v[164:167]
    v_mfma_f32_16x16x32_bf16 v[168:171], v[20:23], a[136:139], v[168:171]
    v_mfma_f32_16x16x32_bf16 v[172:175], v[20:23], a[200:203], v[172:175]
    buffer_load_dwordx4 v[20:23], v8, s[4:7], s25 offen offset:2048
    s_waitcnt vmcnt(31)
    v_mfma_f32_16x16x32_bf16 v[160:163], v[24:27], a[12:15], v[160:163]
    v_mfma_f32_16x16x32_bf16 v[164:167], v[24:27], a[76:79], v[164:167]
    v_mfma_f32_16x16x32_bf16 v[168:171], v[24:27], a[140:143], v[168:171]
    v_mfma_f32_16x16x32_bf16 v[172:175], v[24:27], a[204:207], v[172:175]
    buffer_load_dwordx4 v[24:27], v8, s[4:7], s25 offen offset:3072
    s_add_u32 s25, s25, 4096
    s_waitcnt vmcnt(31)
    v_mfma_f32_16x16x32_bf16 v[160:163], v[28:31], a[16:19], v[160:163]
    v_mfma_f32_16x16x32_bf16 v[164:167], v[28:31], a[80:83], v[164:167]
    v_mfma_f32_16x16x32_bf16 v[168:171], v[28:31], a[144:147], v[168:171]
    v_mfma_f32_16x16x32_bf16 v[172:175], v[28:31], a[208:211], v[172:175]
    buffer_load_dwordx4 v[28:31], v8, s[4:7], s25 offen offset:0
    s_waitcnt lgkmcnt(0)
    s_barrier
    ds_read_b128 v[192:195], v10 offset:4096
    ds_read_b128 v[196:199], v10 offset:36864
    ds_read_b128 v[200:203], v140 offset:4096
    ds_read_b128 v[204:207], v140 offset:36864
    s_waitcnt vmcnt(31)
    v_mfma_f32_16x16x32_bf16 v[160:163], v[32:35], a[20:23], v[160:163]
    v_mfma_f32_16x16x32_bf16 v[164:167], v[32:35], a[84:87], v[164:167]
    v_mfma_f32_16x16x32_bf16 v[168:171], v[32:35], a[148:151], v[168:171]
    v_mfma_f32_16x16x32_bf16 v[172:175], v[32:35], a[212:215], v[172:175]
    buffer_load_dwordx4 v[32:35], v8, s[4:7], s25 offen offset:1024
    s_waitcnt vmcnt(31)
    v_mfma_f32_16x16x32_bf16 v[160:163], v[36:39], a[24:27], v[160:163]
    v_mfma_f32_16x16x32_bf16 v[164:167], v[36:39], a[88:91], v[164:167]
    v_mfma_f32_16x16x32_bf16 v[168:171], v[36:39], a[152:155], v[168:171]
    v_mfma_f32_16x16x32_bf16 v[172:175], v[36:39], a[216:219], v[172:175]
    buffer_load_dwordx4 v[36:39], v8, s[4:7], s25 offen offset:2048
    s_waitcnt vmcnt(31)
    v_mfma_f32_16x16x32_bf16 v[160:163], v[40:43], a[28:31], v[160:163]
    v_mfma_f32_16x16x32_bf16 v[164:167], v[40:43], a[92:95], v[164:167]
    v_mfma_f32_16x16x32_bf16 v[168:171], v[40:43], a[156:159], v[168:171]
    v_mfma_f32_16x16x32_bf16 v[172:175], v[40:43], a[220:223], v[172:175]
    buffer_load_dwordx4 v[40:43], v8, s[4:7], s25 offen offset:3072
    s_add_u32 s25, s25, 4096
    s_waitcnt lgkmcnt(2)
    v_add_f32 v192, v192, v196
    v_add_f32 v193, v193, v197
    v_add_f32 v194, v194, v198
    v_add_f32 v195, v195, v199
    s_waitcnt lgkmcnt(0)
    v_add_f32 v200, v200, v204
    v_add_f32 v201, v201, v205
    v_add_f32 v202, v202, v206
    v_add_f32 v203, v203, v207
    s_waitcnt vmcnt(31)
    v_mfma_f32_16x16x32_bf16 v[160:163], v[44:47], a[32:35], v[160:163]
    v_mfma_f32_16x16x32_bf16 v[164:167], v[44:47], a[96:99], v[164:167]
    v_mfma_f32_16x16x32_bf16 v[168:171], v[44:47], a[160:163], v[168:171]
    v_mfma_f32_16x16x32_bf16 v[172:175], v[44:47], a[224:227], v[172:175]
    buffer_load_dwordx4 v[44:47], v8, s[4:7], s25 offen offset:0
    s_waitcnt vmcnt(31)
    v_mfma_f32_16x16x32_bf16 v[160:163], v[48:51], a[36:39], v[160:163]
    v_mfma_f32_16x16x32_bf16 v[164:167], v[48:51], a[100:103], v[164:167]
    v_mfma_f32_16x16x32_bf16 v[168:171], v[48:51], a[164:167], v[168:171]
    v_mfma_f32_16x16x32_bf16 v[172:175], v[48:51], a[228:231], v[172:175]
    buffer_load_dwordx4 v[48:51], v8, s[4:7], s25 offen offset:1024
    v_add_f32 v192, v192, v11
    v_add_f32 v193, v193, v11
    v_add_f32 v194, v194, v11
    v_add_f32 v195, v195, v11
    v_add_f32 v192, v192, v200
    v_add_f32 v193, v193, v201
    v_add_f32 v194, v194, v202
    v_add_f32 v195, v195, v203
    s_waitcnt vmcnt(31)
    v_mfma_f32_16x16x32_bf16 v[160:163], v[52:55], a[40:43], v[160:163]
    v_mfma_f32_16x16x32_bf16 v[164:167], v[52:55], a[104:107], v[164:167]
    v_mfma_f32_16x16x32_bf16 v[168:171], v[52:55], a[168:171], v[168:171]
    v_mfma_f32_16x16x32_bf16 v[172:175], v[52:55], a[232:235], v[172:175]
    buffer_load_dwordx4 v[52:55], v8, s[4:7], s25 offen offset:2048
    s_waitcnt vmcnt(31)
    v_mfma_f32_16x16x32_bf16 v[160:163], v[56:59], a[44:47], v[160:163]
    v_mfma_f32_16x16x32_bf16 v[164:167], v[56:59], a[108:111], v[164:167]
    v_mfma_f32_16x16x32_bf16 v[168:171], v[56:59], a[172:175], v[168:171]
    v_mfma_f32_16x16x32_bf16 v[172:175], v[56:59], a[236:239], v[172:175]
    buffer_load_dwordx4 v[56:59], v8, s[4:7], s25 offen offset:3072
    s_add_u32 s25, s25, 4096
    v_and_b32 v216, s3, v144
    v_and_b32 v217, s3, v145
    v_and_b32 v218, s3, v146
    v_and_b32 v219, s3, v147
    v_mul_f32 v212, v192, v216
    v_mul_f32 v213, v193, v217
    v_mul_f32 v214, v194, v218
    v_mul_f32 v215, v195, v219
    s_waitcnt vmcnt(31)
    v_mfma_f32_16x16x32_bf16 v[160:163], v[60:63], a[48:51], v[160:163]
    v_mfma_f32_16x16x32_bf16 v[164:167], v[60:63], a[112:115], v[164:167]
    v_mfma_f32_16x16x32_bf16 v[168:171], v[60:63], a[176:179], v[168:171]
    v_mfma_f32_16x16x32_bf16 v[172:175], v[60:63], a[240:243], v[172:175]
    buffer_load_dwordx4 v[60:63], v8, s[4:7], s25 offen offset:0
    s_waitcnt vmcnt(31)
    v_mfma_f32_16x16x32_bf16 v[160:163], v[64:67], a[52:55], v[160:163]
    v_mfma_f32_16x16x32_bf16 v[164:167], v[64:67], a[116:119], v[164:167]
    v_mfma_f32_16x16x32_bf16 v[168:171], v[64:67], a[180:183], v[168:171]
    v_mfma_f32_16x16x32_bf16 v[172:175], v[64:67], a[244:247], v[172:175]
    buffer_load_dwordx4 v[64:67], v8, s[4:7], s25 offen offset:1024
    v_cvt_pk_bf16_f32 v220, v208, v212
    v_cvt_pk_bf16_f32 v221, v209, v213
    v_cvt_pk_bf16_f32 v222, v210, v214
    v_cvt_pk_bf16_f32 v223, v211, v215
    buffer_store_dwordx4 v[220:223], v8, s[4:7], s26 offen offset:0
    s_waitcnt vmcnt(32)
    v_mfma_f32_16x16x32_bf16 v[160:163], v[68:71], a[56:59], v[160:163]
    v_mfma_f32_16x16x32_bf16 v[164:167], v[68:71], a[120:123], v[164:167]
    v_mfma_f32_16x16x32_bf16 v[168:171], v[68:71], a[184:187], v[168:171]
    v_mfma_f32_16x16x32_bf16 v[172:175], v[68:71], a[248:251], v[172:175]
    buffer_load_dwordx4 v[68:71], v8, s[4:7], s25 offen offset:2048
    s_waitcnt vmcnt(32)
    v_mfma_f32_16x16x32_bf16 v[160:163], v[72:75], a[60:63], v[160:163]
    v_mfma_f32_16x16x32_bf16 v[164:167], v[72:75], a[124:127], v[164:167]
    v_mfma_f32_16x16x32_bf16 v[168:171], v[72:75], a[188:191], v[168:171]
    v_mfma_f32_16x16x32_bf16 v[172:175], v[72:75], a[252:255], v[172:175]
    buffer_load_dwordx4 v[72:75], v8, s[4:7], s25 offen offset:3072
    s_add_u32 s25, s25, 53248
    s_waitcnt vmcnt(32)
    v_mfma_f32_16x16x32_bf16 v[176:179], v[76:79], a[0:3], 0
    v_mfma_f32_16x16x32_bf16 v[180:183], v[76:79], a[64:67], 0
    v_mfma_f32_16x16x32_bf16 v[184:187], v[76:79], a[128:131], 0
    v_mfma_f32_16x16x32_bf16 v[188:191], v[76:79], a[192:195], 0
    buffer_load_dwordx4 v[76:79], v8, s[4:7], s25 offen offset:0
    s_waitcnt vmcnt(32)
    v_mfma_f32_16x16x32_bf16 v[176:179], v[80:83], a[4:7], v[176:179]
    v_mfma_f32_16x16x32_bf16 v[180:183], v[80:83], a[68:71], v[180:183]
    v_mfma_f32_16x16x32_bf16 v[184:187], v[80:83], a[132:135], v[184:187]
    v_mfma_f32_16x16x32_bf16 v[188:191], v[80:83], a[196:199], v[188:191]
    buffer_load_dwordx4 v[80:83], v8, s[4:7], s25 offen offset:1024
    ds_write_b128 v9, v[160:163] offset:0
    ds_write_b128 v9, v[164:167] offset:1024
    ds_write_b128 v9, v[168:171] offset:2048
    ds_write_b128 v9, v[172:175] offset:3072
    s_waitcnt vmcnt(32)
    v_mfma_f32_16x16x32_bf16 v[176:179], v[84:87], a[8:11], v[176:179]
    v_mfma_f32_16x16x32_bf16 v[180:183], v[84:87], a[72:75], v[180:183]
    v_mfma_f32_16x16x32_bf16 v[184:187], v[84:87], a[136:139], v[184:187]
    v_mfma_f32_16x16x32_bf16 v[188:191], v[84:87], a[200:203], v[188:191]
    buffer_load_dwordx4 v[84:87], v8, s[4:7], s25 offen offset:2048
    s_waitcnt vmcnt(32)
    v_mfma_f32_16x16x32_bf16 v[176:179], v[88:91], a[12:15], v[176:179]
    v_mfma_f32_16x16x32_bf16 v[180:183], v[88:91], a[76:79], v[180:183]
    v_mfma_f32_16x16x32_bf16 v[184:187], v[88:91], a[140:143], v[184:187]
    v_mfma_f32_16x16x32_bf16 v[188:191], v[88:91], a[204:207], v[188:191]
    buffer_load_dwordx4 v[88:91], v8, s[4:7], s25 offen offset:3072
    s_add_u32 s25, s25, 4096
    s_waitcnt vmcnt(32)
    v_mfma_f32_16x16x32_bf16 v[176:179], v[92:95], a[16:19], v[176:179]
    v_mfma_f32_16x16x32_bf16 v[180:183], v[92:95], a[80:83], v[180:183]
    v_mfma_f32_16x16x32_bf16 v[184:187], v[92:95], a[144:147], v[184:187]
    v_mfma_f32_16x16x32_bf16 v[188:191], v[92:95], a[208:211], v[188:191]
    buffer_load_dwordx4 v[92:95], v8, s[4:7], s25 offen offset:0
    s_waitcnt lgkmcnt(0)
    s_barrier
    ds_read_b128 v[192:195], v10 offset:0
    ds_read_b128 v[196:199], v10 offset:32768
    ds_read_b128 v[200:203], v140 offset:0
    ds_read_b128 v[204:207], v140 offset:32768
    s_waitcnt vmcnt(32)
    v_mfma_f32_16x16x32_bf16 v[176:179], v[96:99], a[20:23], v[176:179]
    v_mfma_f32_16x16x32_bf16 v[180:183], v[96:99], a[84:87], v[180:183]
    v_mfma_f32_16x16x32_bf16 v[184:187], v[96:99], a[148:151], v[184:187]
    v_mfma_f32_16x16x32_bf16 v[188:191], v[96:99], a[212:215], v[188:191]
    buffer_load_dwordx4 v[96:99], v8, s[4:7], s25 offen offset:1024
    s_waitcnt vmcnt(32)
    v_mfma_f32_16x16x32_bf16 v[176:179], v[100:103], a[24:27], v[176:179]
    v_mfma_f32_16x16x32_bf16 v[180:183], v[100:103], a[88:91], v[180:183]
    v_mfma_f32_16x16x32_bf16 v[184:187], v[100:103], a[152:155], v[184:187]
    v_mfma_f32_16x16x32_bf16 v[188:191], v[100:103], a[216:219], v[188:191]
    buffer_load_dwordx4 v[100:103], v8, s[4:7], s25 offen offset:2048
    s_waitcnt vmcnt(32)
    v_mfma_f32_16x16x32_bf16 v[176:179], v[104:107], a[28:31], v[176:179]
    v_mfma_f32_16x16x32_bf16 v[180:183], v[104:107], a[92:95], v[180:183]
    v_mfma_f32_16x16x32_bf16 v[184:187], v[104:107], a[156:159], v[184:187]
    v_mfma_f32_16x16x32_bf16 v[188:191], v[104:107], a[220:223], v[188:191]
    buffer_load_dwordx4 v[104:107], v8, s[4:7], s25 offen offset:3072
    s_add_u32 s25, s25, 4096
    s_waitcnt lgkmcnt(2)
    v_add_f32 v192, v192, v196
    v_add_f32 v193, v193, v197
    v_add_f32 v194, v194, v198
    v_add_f32 v195, v195, v199
    s_waitcnt lgkmcnt(0)
    v_add_f32 v200, v200, v204
    v_add_f32 v201, v201, v205
    v_add_f32 v202, v202, v206
    v_add_f32 v203, v203, v207
    s_waitcnt vmcnt(32)
    v_mfma_f32_16x16x32_bf16 v[176:179], v[108:111], a[32:35], v[176:179]
    v_mfma_f32_16x16x32_bf16 v[180:183], v[108:111], a[96:99], v[180:183]
    v_mfma_f32_16x16x32_bf16 v[184:187], v[108:111], a[160:163], v[184:187]
    v_mfma_f32_16x16x32_bf16 v[188:191], v[108:111], a[224:227], v[188:191]
    buffer_load_dwordx4 v[108:111], v8, s[4:7], s25 offen offset:0
    s_waitcnt vmcnt(32)
    v_mfma_f32_16x16x32_bf16 v[176:179], v[112:115], a[36:39], v[176:179]
    v_mfma_f32_16x16x32_bf16 v[180:183], v[112:115], a[100:103], v[180:183]
    v_mfma_f32_16x16x32_bf16 v[184:187], v[112:115], a[164:167], v[184:187]
    v_mfma_f32_16x16x32_bf16 v[188:191], v[112:115], a[228:231], v[188:191]
    buffer_load_dwordx4 v[112:115], v8, s[4:7], s25 offen offset:1024
    v_add_f32 v192, v192, v11
    v_add_f32 v193, v193, v11
    v_add_f32 v194, v194, v11
    v_add_f32 v195, v195, v11
    v_add_f32 v192, v192, v200
    v_add_f32 v193, v193, v201
    v_add_f32 v194, v194, v202
    v_add_f32 v195, v195, v203
    s_waitcnt vmcnt(32)
    v_mfma_f32_16x16x32_bf16 v[176:179], v[116:119], a[40:43], v[176:179]
    v_mfma_f32_16x16x32_bf16 v[180:183], v[116:119], a[104:107], v[180:183]
    v_mfma_f32_16x16x32_bf16 v[184:187], v[116:119], a[168:171], v[184:187]
    v_mfma_f32_16x16x32_bf16 v[188:191], v[116:119], a[232:235], v[188:191]
    buffer_load_dwordx4 v[116:119], v8, s[4:7], s25 offen offset:2048
    s_waitcnt vmcnt(32)
    v_mfma_f32_16x16x32_bf16 v[176:179], v[120:123], a[44:47], v[176:179]
    v_mfma_f32_16x16x32_bf16 v[180:183], v[120:123], a[108:111], v[180:183]
    v_mfma_f32_16x16x32_bf16 v[184:187], v[120:123], a[172:175], v[184:187]
    v_mfma_f32_16x16x32_bf16 v[188:191], v[120:123], a[236:239], v[188:191]
    buffer_load_dwordx4 v[120:123], v8, s[4:7], s25 offen offset:3072
    s_add_u32 s25, s25, 4096
    v_lshlrev_b32 v216, 16, v148
    v_lshlrev_b32 v217, 16, v149
    v_lshlrev_b32 v218, 16, v150
    v_lshlrev_b32 v219, 16, v151
    v_mul_f32 v208, v192, v216
    v_mul_f32 v209, v193, v217
    v_mul_f32 v210, v194, v218
    v_mul_f32 v211, v195, v219
    s_waitcnt vmcnt(32)
    v_mfma_f32_16x16x32_bf16 v[176:179], v[124:127], a[48:51], v[176:179]
    v_mfma_f32_16x16x32_bf16 v[180:183], v[124:127], a[112:115], v[180:183]
    v_mfma_f32_16x16x32_bf16 v[184:187], v[124:127], a[176:179], v[184:187]
    v_mfma_f32_16x16x32_bf16 v[188:191], v[124:127], a[240:243], v[188:191]
    buffer_load_dwordx4 v[124:127], v8, s[4:7], s25 offen offset:0
    s_waitcnt vmcnt(32)
    v_mfma_f32_16x16x32_bf16 v[176:179], v[128:131], a[52:55], v[176:179]
    v_mfma_f32_16x16x32_bf16 v[180:183], v[128:131], a[116:119], v[180:183]
    v_mfma_f32_16x16x32_bf16 v[184:187], v[128:131], a[180:183], v[184:187]
    v_mfma_f32_16x16x32_bf16 v[188:191], v[128:131], a[244:247], v[188:191]
    buffer_load_dwordx4 v[128:131], v8, s[4:7], s25 offen offset:1024
    s_waitcnt vmcnt(32)
    v_mfma_f32_16x16x32_bf16 v[176:179], v[132:135], a[56:59], v[176:179]
    v_mfma_f32_16x16x32_bf16 v[180:183], v[132:135], a[120:123], v[180:183]
    v_mfma_f32_16x16x32_bf16 v[184:187], v[132:135], a[184:187], v[184:187]
    v_mfma_f32_16x16x32_bf16 v[188:191], v[132:135], a[248:251], v[188:191]
    buffer_load_dwordx4 v[132:135], v8, s[4:7], s25 offen offset:2048
    s_waitcnt vmcnt(32)
    v_mfma_f32_16x16x32_bf16 v[176:179], v[136:139], a[60:63], v[176:179]
    v_mfma_f32_16x16x32_bf16 v[180:183], v[136:139], a[124:127], v[180:183]
    v_mfma_f32_16x16x32_bf16 v[184:187], v[136:139], a[188:191], v[184:187]
    v_mfma_f32_16x16x32_bf16 v[188:191], v[136:139], a[252:255], v[188:191]
    buffer_load_dwordx4 v[136:139], v8, s[4:7], s25 offen offset:3072
    s_add_u32 s25, s25, 53248
    s_waitcnt vmcnt(32)
    v_mfma_f32_16x16x32_bf16 v[160:163], v[12:15], a[0:3], 0
    v_mfma_f32_16x16x32_bf16 v[164:167], v[12:15], a[64:67], 0
    v_mfma_f32_16x16x32_bf16 v[168:171], v[12:15], a[128:131], 0
    v_mfma_f32_16x16x32_bf16 v[172:175], v[12:15], a[192:195], 0
    buffer_load_dwordx4 v[12:15], v8, s[4:7], s25 offen offset:0
    s_waitcnt vmcnt(32)
    v_mfma_f32_16x16x32_bf16 v[160:163], v[16:19], a[4:7], v[160:163]
    v_mfma_f32_16x16x32_bf16 v[164:167], v[16:19], a[68:71], v[164:167]
    v_mfma_f32_16x16x32_bf16 v[168:171], v[16:19], a[132:135], v[168:171]
    v_mfma_f32_16x16x32_bf16 v[172:175], v[16:19], a[196:199], v[172:175]
    buffer_load_dwordx4 v[16:19], v8, s[4:7], s25 offen offset:1024
    ds_write_b128 v9, v[176:179] offset:4096
    ds_write_b128 v9, v[180:183] offset:5120
    ds_write_b128 v9, v[184:187] offset:6144
    ds_write_b128 v9, v[188:191] offset:7168
    s_waitcnt vmcnt(32)
    v_mfma_f32_16x16x32_bf16 v[160:163], v[20:23], a[8:11], v[160:163]
    v_mfma_f32_16x16x32_bf16 v[164:167], v[20:23], a[72:75], v[164:167]
    v_mfma_f32_16x16x32_bf16 v[168:171], v[20:23], a[136:139], v[168:171]
    v_mfma_f32_16x16x32_bf16 v[172:175], v[20:23], a[200:203], v[172:175]
    buffer_load_dwordx4 v[20:23], v8, s[4:7], s25 offen offset:2048
    s_waitcnt vmcnt(32)
    v_mfma_f32_16x16x32_bf16 v[160:163], v[24:27], a[12:15], v[160:163]
    v_mfma_f32_16x16x32_bf16 v[164:167], v[24:27], a[76:79], v[164:167]
    v_mfma_f32_16x16x32_bf16 v[168:171], v[24:27], a[140:143], v[168:171]
    v_mfma_f32_16x16x32_bf16 v[172:175], v[24:27], a[204:207], v[172:175]
    buffer_load_dwordx4 v[24:27], v8, s[4:7], s25 offen offset:3072
    s_add_u32 s25, s25, 4096
    s_waitcnt vmcnt(32)
    v_mfma_f32_16x16x32_bf16 v[160:163], v[28:31], a[16:19], v[160:163]
    v_mfma_f32_16x16x32_bf16 v[164:167], v[28:31], a[80:83], v[164:167]
    v_mfma_f32_16x16x32_bf16 v[168:171], v[28:31], a[144:147], v[168:171]
    v_mfma_f32_16x16x32_bf16 v[172:175], v[28:31], a[208:211], v[172:175]
    buffer_load_dwordx4 v[28:31], v8, s[4:7], s25 offen offset:0
    s_waitcnt lgkmcnt(0)
    s_barrier
    ds_read_b128 v[192:195], v10 offset:4096
    ds_read_b128 v[196:199], v10 offset:36864
    ds_read_b128 v[200:203], v140 offset:4096
    ds_read_b128 v[204:207], v140 offset:36864
    s_waitcnt vmcnt(32)
    v_mfma_f32_16x16x32_bf16 v[160:163], v[32:35], a[20:23], v[160:163]
    v_mfma_f32_16x16x32_bf16 v[164:167], v[32:35], a[84:87], v[164:167]
    v_mfma_f32_16x16x32_bf16 v[168:171], v[32:35], a[148:151], v[168:171]
    v_mfma_f32_16x16x32_bf16 v[172:175], v[32:35], a[212:215], v[172:175]
    buffer_load_dwordx4 v[32:35], v8, s[4:7], s25 offen offset:1024
    s_waitcnt vmcnt(32)
    v_mfma_f32_16x16x32_bf16 v[160:163], v[36:39], a[24:27], v[160:163]
    v_mfma_f32_16x16x32_bf16 v[164:167], v[36:39], a[88:91], v[164:167]
    v_mfma_f32_16x16x32_bf16 v[168:171], v[36:39], a[152:155], v[168:171]
    v_mfma_f32_16x16x32_bf16 v[172:175], v[36:39], a[216:219], v[172:175]
    buffer_load_dwordx4 v[36:39], v8, s[4:7], s25 offen offset:2048
    s_waitcnt vmcnt(32)
    v_mfma_f32_16x16x32_bf16 v[160:163], v[40:43], a[28:31], v[160:163]
    v_mfma_f32_16x16x32_bf16 v[164:167], v[40:43], a[92:95], v[164:167]
    v_mfma_f32_16x16x32_bf16 v[168:171], v[40:43], a[156:159], v[168:171]
    v_mfma_f32_16x16x32_bf16 v[172:175], v[40:43], a[220:223], v[172:175]
    buffer_load_dwordx4 v[40:43], v8, s[4:7], s25 offen offset:3072
    s_add_u32 s25, s25, 4096
    s_waitcnt lgkmcnt(2)
    v_add_f32 v192, v192, v196
    v_add_f32 v193, v193, v197
    v_add_f32 v194, v194, v198
    v_add_f32 v195, v195, v199
    s_waitcnt lgkmcnt(0)
    v_add_f32 v200, v200, v204
    v_add_f32 v201, v201, v205
    v_add_f32 v202, v202, v206
    v_add_f32 v203, v203, v207
    s_waitcnt vmcnt(32)
    v_mfma_f32_16x16x32_bf16 v[160:163], v[44:47], a[32:35], v[160:163]
    v_mfma_f32_16x16x32_bf16 v[164:167], v[44:47], a[96:99], v[164:167]
    v_mfma_f32_16x16x32_bf16 v[168:171], v[44:47], a[160:163], v[168:171]
    v_mfma_f32_16x16x32_bf16 v[172:175], v[44:47], a[224:227], v[172:175]
    buffer_load_dwordx4 v[44:47], v8, s[4:7], s25 offen offset:0
    s_waitcnt vmcnt(32)
    v_mfma_f32_16x16x32_bf16 v[160:163], v[48:51], a[36:39], v[160:163]
    v_mfma_f32_16x16x32_bf16 v[164:167], v[48:51], a[100:103], v[164:167]
    v_mfma_f32_16x16x32_bf16 v[168:171], v[48:51], a[164:167], v[168:171]
    v_mfma_f32_16x16x32_bf16 v[172:175], v[48:51], a[228:231], v[172:175]
    buffer_load_dwordx4 v[48:51], v8, s[4:7], s25 offen offset:1024
    v_add_f32 v192, v192, v11
    v_add_f32 v193, v193, v11
    v_add_f32 v194, v194, v11
    v_add_f32 v195, v195, v11
    v_add_f32 v192, v192, v200
    v_add_f32 v193, v193, v201
    v_add_f32 v194, v194, v202
    v_add_f32 v195, v195, v203
    s_waitcnt vmcnt(32)
    v_mfma_f32_16x16x32_bf16 v[160:163], v[52:55], a[40:43], v[160:163]
    v_mfma_f32_16x16x32_bf16 v[164:167], v[52:55], a[104:107], v[164:167]
    v_mfma_f32_16x16x32_bf16 v[168:171], v[52:55], a[168:171], v[168:171]
    v_mfma_f32_16x16x32_bf16 v[172:175], v[52:55], a[232:235], v[172:175]
    buffer_load_dwordx4 v[52:55], v8, s[4:7], s25 offen offset:2048
    s_waitcnt vmcnt(32)
    v_mfma_f32_16x16x32_bf16 v[160:163], v[56:59], a[44:47], v[160:163]
    v_mfma_f32_16x16x32_bf16 v[164:167], v[56:59], a[108:111], v[164:167]
    v_mfma_f32_16x16x32_bf16 v[168:171], v[56:59], a[172:175], v[168:171]
    v_mfma_f32_16x16x32_bf16 v[172:175], v[56:59], a[236:239], v[172:175]
    buffer_load_dwordx4 v[56:59], v8, s[4:7], s25 offen offset:3072
    s_add_u32 s25, s25, 4096
    v_and_b32 v216, s3, v148
    v_and_b32 v217, s3, v149
    v_and_b32 v218, s3, v150
    v_and_b32 v219, s3, v151
    v_mul_f32 v212, v192, v216
    v_mul_f32 v213, v193, v217
    v_mul_f32 v214, v194, v218
    v_mul_f32 v215, v195, v219
    s_waitcnt vmcnt(32)
    v_mfma_f32_16x16x32_bf16 v[160:163], v[60:63], a[48:51], v[160:163]
    v_mfma_f32_16x16x32_bf16 v[164:167], v[60:63], a[112:115], v[164:167]
    v_mfma_f32_16x16x32_bf16 v[168:171], v[60:63], a[176:179], v[168:171]
    v_mfma_f32_16x16x32_bf16 v[172:175], v[60:63], a[240:243], v[172:175]
    buffer_load_dwordx4 v[60:63], v8, s[4:7], s25 offen offset:0
    s_waitcnt vmcnt(32)
    v_mfma_f32_16x16x32_bf16 v[160:163], v[64:67], a[52:55], v[160:163]
    v_mfma_f32_16x16x32_bf16 v[164:167], v[64:67], a[116:119], v[164:167]
    v_mfma_f32_16x16x32_bf16 v[168:171], v[64:67], a[180:183], v[168:171]
    v_mfma_f32_16x16x32_bf16 v[172:175], v[64:67], a[244:247], v[172:175]
    buffer_load_dwordx4 v[64:67], v8, s[4:7], s25 offen offset:1024
    v_cvt_pk_bf16_f32 v220, v208, v212
    v_cvt_pk_bf16_f32 v221, v209, v213
    v_cvt_pk_bf16_f32 v222, v210, v214
    v_cvt_pk_bf16_f32 v223, v211, v215
    buffer_store_dwordx4 v[220:223], v8, s[4:7], s26 offen offset:1024
    s_waitcnt vmcnt(32)
    v_mfma_f32_16x16x32_bf16 v[160:163], v[68:71], a[56:59], v[160:163]
    v_mfma_f32_16x16x32_bf16 v[164:167], v[68:71], a[120:123], v[164:167]
    v_mfma_f32_16x16x32_bf16 v[168:171], v[68:71], a[184:187], v[168:171]
    v_mfma_f32_16x16x32_bf16 v[172:175], v[68:71], a[248:251], v[172:175]
    buffer_load_dwordx4 v[68:71], v8, s[4:7], s25 offen offset:2048
    s_waitcnt vmcnt(32)
    v_mfma_f32_16x16x32_bf16 v[160:163], v[72:75], a[60:63], v[160:163]
    v_mfma_f32_16x16x32_bf16 v[164:167], v[72:75], a[124:127], v[164:167]
    v_mfma_f32_16x16x32_bf16 v[168:171], v[72:75], a[188:191], v[168:171]
    v_mfma_f32_16x16x32_bf16 v[172:175], v[72:75], a[252:255], v[172:175]
    buffer_load_dwordx4 v[72:75], v8, s[4:7], s25 offen offset:3072
    s_add_u32 s25, s25, 53248
    s_waitcnt vmcnt(32)
    v_mfma_f32_16x16x32_bf16 v[176:179], v[76:79], a[0:3], 0
    v_mfma_f32_16x16x32_bf16 v[180:183], v[76:79], a[64:67], 0
    v_mfma_f32_16x16x32_bf16 v[184:187], v[76:79], a[128:131], 0
    v_mfma_f32_16x16x32_bf16 v[188:191], v[76:79], a[192:195], 0
    s_waitcnt vmcnt(31)
    v_mfma_f32_16x16x32_bf16 v[176:179], v[80:83], a[4:7], v[176:179]
    v_mfma_f32_16x16x32_bf16 v[180:183], v[80:83], a[68:71], v[180:183]
    v_mfma_f32_16x16x32_bf16 v[184:187], v[80:83], a[132:135], v[184:187]
    v_mfma_f32_16x16x32_bf16 v[188:191], v[80:83], a[196:199], v[188:191]
    ds_write_b128 v9, v[160:163] offset:0
    ds_write_b128 v9, v[164:167] offset:1024
    ds_write_b128 v9, v[168:171] offset:2048
    ds_write_b128 v9, v[172:175] offset:3072
    s_waitcnt vmcnt(30)
    v_mfma_f32_16x16x32_bf16 v[176:179], v[84:87], a[8:11], v[176:179]
    v_mfma_f32_16x16x32_bf16 v[180:183], v[84:87], a[72:75], v[180:183]
    v_mfma_f32_16x16x32_bf16 v[184:187], v[84:87], a[136:139], v[184:187]
    v_mfma_f32_16x16x32_bf16 v[188:191], v[84:87], a[200:203], v[188:191]
    s_waitcnt vmcnt(29)
    v_mfma_f32_16x16x32_bf16 v[176:179], v[88:91], a[12:15], v[176:179]
    v_mfma_f32_16x16x32_bf16 v[180:183], v[88:91], a[76:79], v[180:183]
    v_mfma_f32_16x16x32_bf16 v[184:187], v[88:91], a[140:143], v[184:187]
    v_mfma_f32_16x16x32_bf16 v[188:191], v[88:91], a[204:207], v[188:191]
    s_waitcnt vmcnt(28)
    v_mfma_f32_16x16x32_bf16 v[176:179], v[92:95], a[16:19], v[176:179]
    v_mfma_f32_16x16x32_bf16 v[180:183], v[92:95], a[80:83], v[180:183]
    v_mfma_f32_16x16x32_bf16 v[184:187], v[92:95], a[144:147], v[184:187]
    v_mfma_f32_16x16x32_bf16 v[188:191], v[92:95], a[208:211], v[188:191]
    s_waitcnt lgkmcnt(0)
    s_barrier
    ds_read_b128 v[192:195], v10 offset:0
    ds_read_b128 v[196:199], v10 offset:32768
    ds_read_b128 v[200:203], v140 offset:0
    ds_read_b128 v[204:207], v140 offset:32768
    s_waitcnt vmcnt(27)
    v_mfma_f32_16x16x32_bf16 v[176:179], v[96:99], a[20:23], v[176:179]
    v_mfma_f32_16x16x32_bf16 v[180:183], v[96:99], a[84:87], v[180:183]
    v_mfma_f32_16x16x32_bf16 v[184:187], v[96:99], a[148:151], v[184:187]
    v_mfma_f32_16x16x32_bf16 v[188:191], v[96:99], a[212:215], v[188:191]
    s_waitcnt vmcnt(26)
    v_mfma_f32_16x16x32_bf16 v[176:179], v[100:103], a[24:27], v[176:179]
    v_mfma_f32_16x16x32_bf16 v[180:183], v[100:103], a[88:91], v[180:183]
    v_mfma_f32_16x16x32_bf16 v[184:187], v[100:103], a[152:155], v[184:187]
    v_mfma_f32_16x16x32_bf16 v[188:191], v[100:103], a[216:219], v[188:191]
    s_waitcnt vmcnt(25)
    v_mfma_f32_16x16x32_bf16 v[176:179], v[104:107], a[28:31], v[176:179]
    v_mfma_f32_16x16x32_bf16 v[180:183], v[104:107], a[92:95], v[180:183]
    v_mfma_f32_16x16x32_bf16 v[184:187], v[104:107], a[156:159], v[184:187]
    v_mfma_f32_16x16x32_bf16 v[188:191], v[104:107], a[220:223], v[188:191]
    s_waitcnt lgkmcnt(2)
    v_add_f32 v192, v192, v196
    v_add_f32 v193, v193, v197
    v_add_f32 v194, v194, v198
    v_add_f32 v195, v195, v199
    s_waitcnt lgkmcnt(0)
    v_add_f32 v200, v200, v204
    v_add_f32 v201, v201, v205
    v_add_f32 v202, v202, v206
    v_add_f32 v203, v203, v207
    s_waitcnt vmcnt(24)
    v_mfma_f32_16x16x32_bf16 v[176:179], v[108:111], a[32:35], v[176:179]
    v_mfma_f32_16x16x32_bf16 v[180:183], v[108:111], a[96:99], v[180:183]
    v_mfma_f32_16x16x32_bf16 v[184:187], v[108:111], a[160:163], v[184:187]
    v_mfma_f32_16x16x32_bf16 v[188:191], v[108:111], a[224:227], v[188:191]
    s_waitcnt vmcnt(23)
    v_mfma_f32_16x16x32_bf16 v[176:179], v[112:115], a[36:39], v[176:179]
    v_mfma_f32_16x16x32_bf16 v[180:183], v[112:115], a[100:103], v[180:183]
    v_mfma_f32_16x16x32_bf16 v[184:187], v[112:115], a[164:167], v[184:187]
    v_mfma_f32_16x16x32_bf16 v[188:191], v[112:115], a[228:231], v[188:191]
    v_add_f32 v192, v192, v11
    v_add_f32 v193, v193, v11
    v_add_f32 v194, v194, v11
    v_add_f32 v195, v195, v11
    v_add_f32 v192, v192, v200
    v_add_f32 v193, v193, v201
    v_add_f32 v194, v194, v202
    v_add_f32 v195, v195, v203
    s_waitcnt vmcnt(22)
    v_mfma_f32_16x16x32_bf16 v[176:179], v[116:119], a[40:43], v[176:179]
    v_mfma_f32_16x16x32_bf16 v[180:183], v[116:119], a[104:107], v[180:183]
    v_mfma_f32_16x16x32_bf16 v[184:187], v[116:119], a[168:171], v[184:187]
    v_mfma_f32_16x16x32_bf16 v[188:191], v[116:119], a[232:235], v[188:191]
    s_waitcnt vmcnt(21)
    v_mfma_f32_16x16x32_bf16 v[176:179], v[120:123], a[44:47], v[176:179]
    v_mfma_f32_16x16x32_bf16 v[180:183], v[120:123], a[108:111], v[180:183]
    v_mfma_f32_16x16x32_bf16 v[184:187], v[120:123], a[172:175], v[184:187]
    v_mfma_f32_16x16x32_bf16 v[188:191], v[120:123], a[236:239], v[188:191]
    v_lshlrev_b32 v216, 16, v152
    v_lshlrev_b32 v217, 16, v153
    v_lshlrev_b32 v218, 16, v154
    v_lshlrev_b32 v219, 16, v155
    v_mul_f32 v208, v192, v216
    v_mul_f32 v209, v193, v217
    v_mul_f32 v210, v194, v218
    v_mul_f32 v211, v195, v219
    s_waitcnt vmcnt(20)
    v_mfma_f32_16x16x32_bf16 v[176:179], v[124:127], a[48:51], v[176:179]
    v_mfma_f32_16x16x32_bf16 v[180:183], v[124:127], a[112:115], v[180:183]
    v_mfma_f32_16x16x32_bf16 v[184:187], v[124:127], a[176:179], v[184:187]
    v_mfma_f32_16x16x32_bf16 v[188:191], v[124:127], a[240:243], v[188:191]
    s_waitcnt vmcnt(19)
    v_mfma_f32_16x16x32_bf16 v[176:179], v[128:131], a[52:55], v[176:179]
    v_mfma_f32_16x16x32_bf16 v[180:183], v[128:131], a[116:119], v[180:183]
    v_mfma_f32_16x16x32_bf16 v[184:187], v[128:131], a[180:183], v[184:187]
    v_mfma_f32_16x16x32_bf16 v[188:191], v[128:131], a[244:247], v[188:191]
    s_waitcnt vmcnt(18)
    v_mfma_f32_16x16x32_bf16 v[176:179], v[132:135], a[56:59], v[176:179]
    v_mfma_f32_16x16x32_bf16 v[180:183], v[132:135], a[120:123], v[180:183]
    v_mfma_f32_16x16x32_bf16 v[184:187], v[132:135], a[184:187], v[184:187]
    v_mfma_f32_16x16x32_bf16 v[188:191], v[132:135], a[248:251], v[188:191]
    s_waitcnt vmcnt(17)
    v_mfma_f32_16x16x32_bf16 v[176:179], v[136:139], a[60:63], v[176:179]
    v_mfma_f32_16x16x32_bf16 v[180:183], v[136:139], a[124:127], v[180:183]
    v_mfma_f32_16x16x32_bf16 v[184:187], v[136:139], a[188:191], v[184:187]
    v_mfma_f32_16x16x32_bf16 v[188:191], v[136:139], a[252:255], v[188:191]
    s_waitcnt vmcnt(16)
    v_mfma_f32_16x16x32_bf16 v[160:163], v[12:15], a[0:3], 0
    v_mfma_f32_16x16x32_bf16 v[164:167], v[12:15], a[64:67], 0
    v_mfma_f32_16x16x32_bf16 v[168:171], v[12:15], a[128:131], 0
    v_mfma_f32_16x16x32_bf16 v[172:175], v[12:15], a[192:195], 0
    s_waitcnt vmcnt(15)
    v_mfma_f32_16x16x32_bf16 v[160:163], v[16:19], a[4:7], v[160:163]
    v_mfma_f32_16x16x32_bf16 v[164:167], v[16:19], a[68:71], v[164:167]
    v_mfma_f32_16x16x32_bf16 v[168:171], v[16:19], a[132:135], v[168:171]
    v_mfma_f32_16x16x32_bf16 v[172:175], v[16:19], a[196:199], v[172:175]
    ds_write_b128 v9, v[176:179] offset:4096
    ds_write_b128 v9, v[180:183] offset:5120
    ds_write_b128 v9, v[184:187] offset:6144
    ds_write_b128 v9, v[188:191] offset:7168
    s_waitcnt vmcnt(14)
    v_mfma_f32_16x16x32_bf16 v[160:163], v[20:23], a[8:11], v[160:163]
    v_mfma_f32_16x16x32_bf16 v[164:167], v[20:23], a[72:75], v[164:167]
    v_mfma_f32_16x16x32_bf16 v[168:171], v[20:23], a[136:139], v[168:171]
    v_mfma_f32_16x16x32_bf16 v[172:175], v[20:23], a[200:203], v[172:175]
    s_waitcnt vmcnt(13)
    v_mfma_f32_16x16x32_bf16 v[160:163], v[24:27], a[12:15], v[160:163]
    v_mfma_f32_16x16x32_bf16 v[164:167], v[24:27], a[76:79], v[164:167]
    v_mfma_f32_16x16x32_bf16 v[168:171], v[24:27], a[140:143], v[168:171]
    v_mfma_f32_16x16x32_bf16 v[172:175], v[24:27], a[204:207], v[172:175]
    s_waitcnt vmcnt(12)
    v_mfma_f32_16x16x32_bf16 v[160:163], v[28:31], a[16:19], v[160:163]
    v_mfma_f32_16x16x32_bf16 v[164:167], v[28:31], a[80:83], v[164:167]
    v_mfma_f32_16x16x32_bf16 v[168:171], v[28:31], a[144:147], v[168:171]
    v_mfma_f32_16x16x32_bf16 v[172:175], v[28:31], a[208:211], v[172:175]
    s_waitcnt lgkmcnt(0)
    s_barrier
    ds_read_b128 v[192:195], v10 offset:4096
    ds_read_b128 v[196:199], v10 offset:36864
    ds_read_b128 v[200:203], v140 offset:4096
    ds_read_b128 v[204:207], v140 offset:36864
    s_waitcnt vmcnt(11)
    v_mfma_f32_16x16x32_bf16 v[160:163], v[32:35], a[20:23], v[160:163]
    v_mfma_f32_16x16x32_bf16 v[164:167], v[32:35], a[84:87], v[164:167]
    v_mfma_f32_16x16x32_bf16 v[168:171], v[32:35], a[148:151], v[168:171]
    v_mfma_f32_16x16x32_bf16 v[172:175], v[32:35], a[212:215], v[172:175]
    s_waitcnt vmcnt(10)
    v_mfma_f32_16x16x32_bf16 v[160:163], v[36:39], a[24:27], v[160:163]
    v_mfma_f32_16x16x32_bf16 v[164:167], v[36:39], a[88:91], v[164:167]
    v_mfma_f32_16x16x32_bf16 v[168:171], v[36:39], a[152:155], v[168:171]
    v_mfma_f32_16x16x32_bf16 v[172:175], v[36:39], a[216:219], v[172:175]
    s_waitcnt vmcnt(9)
    v_mfma_f32_16x16x32_bf16 v[160:163], v[40:43], a[28:31], v[160:163]
    v_mfma_f32_16x16x32_bf16 v[164:167], v[40:43], a[92:95], v[164:167]
    v_mfma_f32_16x16x32_bf16 v[168:171], v[40:43], a[156:159], v[168:171]
    v_mfma_f32_16x16x32_bf16 v[172:175], v[40:43], a[220:223], v[172:175]
    s_waitcnt lgkmcnt(2)
    v_add_f32 v192, v192, v196
    v_add_f32 v193, v193, v197
    v_add_f32 v194, v194, v198
    v_add_f32 v195, v195, v199
    s_waitcnt lgkmcnt(0)
    v_add_f32 v200, v200, v204
    v_add_f32 v201, v201, v205
    v_add_f32 v202, v202, v206
    v_add_f32 v203, v203, v207
    s_waitcnt vmcnt(8)
    v_mfma_f32_16x16x32_bf16 v[160:163], v[44:47], a[32:35], v[160:163]
    v_mfma_f32_16x16x32_bf16 v[164:167], v[44:47], a[96:99], v[164:167]
    v_mfma_f32_16x16x32_bf16 v[168:171], v[44:47], a[160:163], v[168:171]
    v_mfma_f32_16x16x32_bf16 v[172:175], v[44:47], a[224:227], v[172:175]
    s_waitcnt vmcnt(7)
    v_mfma_f32_16x16x32_bf16 v[160:163], v[48:51], a[36:39], v[160:163]
    v_mfma_f32_16x16x32_bf16 v[164:167], v[48:51], a[100:103], v[164:167]
    v_mfma_f32_16x16x32_bf16 v[168:171], v[48:51], a[164:167], v[168:171]
    v_mfma_f32_16x16x32_bf16 v[172:175], v[48:51], a[228:231], v[172:175]
    v_add_f32 v192, v192, v11
    v_add_f32 v193, v193, v11
    v_add_f32 v194, v194, v11
    v_add_f32 v195, v195, v11
    v_add_f32 v192, v192, v200
    v_add_f32 v193, v193, v201
    v_add_f32 v194, v194, v202
    v_add_f32 v195, v195, v203
    s_waitcnt vmcnt(6)
    v_mfma_f32_16x16x32_bf16 v[160:163], v[52:55], a[40:43], v[160:163]
    v_mfma_f32_16x16x32_bf16 v[164:167], v[52:55], a[104:107], v[164:167]
    v_mfma_f32_16x16x32_bf16 v[168:171], v[52:55], a[168:171], v[168:171]
    v_mfma_f32_16x16x32_bf16 v[172:175], v[52:55], a[232:235], v[172:175]
    s_waitcnt vmcnt(5)
    v_mfma_f32_16x16x32_bf16 v[160:163], v[56:59], a[44:47], v[160:163]
    v_mfma_f32_16x16x32_bf16 v[164:167], v[56:59], a[108:111], v[164:167]
    v_mfma_f32_16x16x32_bf16 v[168:171], v[56:59], a[172:175], v[168:171]
    v_mfma_f32_16x16x32_bf16 v[172:175], v[56:59], a[236:239], v[172:175]
    v_and_b32 v216, s3, v152
    v_and_b32 v217, s3, v153
    v_and_b32 v218, s3, v154
    v_and_b32 v219, s3, v155
    v_mul_f32 v212, v192, v216
    v_mul_f32 v213, v193, v217
    v_mul_f32 v214, v194, v218
    v_mul_f32 v215, v195, v219
    s_waitcnt vmcnt(4)
    v_mfma_f32_16x16x32_bf16 v[160:163], v[60:63], a[48:51], v[160:163]
    v_mfma_f32_16x16x32_bf16 v[164:167], v[60:63], a[112:115], v[164:167]
    v_mfma_f32_16x16x32_bf16 v[168:171], v[60:63], a[176:179], v[168:171]
    v_mfma_f32_16x16x32_bf16 v[172:175], v[60:63], a[240:243], v[172:175]
    s_waitcnt vmcnt(3)
    v_mfma_f32_16x16x32_bf16 v[160:163], v[64:67], a[52:55], v[160:163]
    v_mfma_f32_16x16x32_bf16 v[164:167], v[64:67], a[116:119], v[164:167]
    v_mfma_f32_16x16x32_bf16 v[168:171], v[64:67], a[180:183], v[168:171]
    v_mfma_f32_16x16x32_bf16 v[172:175], v[64:67], a[244:247], v[172:175]
    v_cvt_pk_bf16_f32 v220, v208, v212
    v_cvt_pk_bf16_f32 v221, v209, v213
    v_cvt_pk_bf16_f32 v222, v210, v214
    v_cvt_pk_bf16_f32 v223, v211, v215
    buffer_store_dwordx4 v[220:223], v8, s[4:7], s26 offen offset:2048
    s_waitcnt vmcnt(2)
    v_mfma_f32_16x16x32_bf16 v[160:163], v[68:71], a[56:59], v[160:163]
    v_mfma_f32_16x16x32_bf16 v[164:167], v[68:71], a[120:123], v[164:167]
    v_mfma_f32_16x16x32_bf16 v[168:171], v[68:71], a[184:187], v[168:171]
    v_mfma_f32_16x16x32_bf16 v[172:175], v[68:71], a[248:251], v[172:175]
    s_waitcnt vmcnt(1)
    v_mfma_f32_16x16x32_bf16 v[160:163], v[72:75], a[60:63], v[160:163]
    v_mfma_f32_16x16x32_bf16 v[164:167], v[72:75], a[124:127], v[164:167]
    v_mfma_f32_16x16x32_bf16 v[168:171], v[72:75], a[188:191], v[168:171]
    v_mfma_f32_16x16x32_bf16 v[172:175], v[72:75], a[252:255], v[172:175]
    s_nop 4
    ds_write_b128 v9, v[160:163] offset:0
    ds_write_b128 v9, v[164:167] offset:1024
    ds_write_b128 v9, v[168:171] offset:2048
    ds_write_b128 v9, v[172:175] offset:3072
    s_waitcnt lgkmcnt(0)
    s_barrier
    ds_read_b128 v[192:195], v10 offset:0
    ds_read_b128 v[196:199], v10 offset:32768
    ds_read_b128 v[200:203], v140 offset:0
    ds_read_b128 v[204:207], v140 offset:32768
    s_waitcnt lgkmcnt(2)
    v_add_f32 v192, v192, v196
    v_add_f32 v193, v193, v197
    v_add_f32 v194, v194, v198
    v_add_f32 v195, v195, v199
    s_waitcnt lgkmcnt(0)
    v_add_f32 v200, v200, v204
    v_add_f32 v201, v201, v205
    v_add_f32 v202, v202, v206
    v_add_f32 v203, v203, v207
    v_add_f32 v192, v192, v11
    v_add_f32 v193, v193, v11
    v_add_f32 v194, v194, v11
    v_add_f32 v195, v195, v11
    v_add_f32 v192, v192, v200
    v_add_f32 v193, v193, v201
    v_add_f32 v194, v194, v202
    v_add_f32 v195, v195, v203
    v_lshlrev_b32 v216, 16, v156
    v_lshlrev_b32 v217, 16, v157
    v_lshlrev_b32 v218, 16, v158
    v_lshlrev_b32 v219, 16, v159
    v_mul_f32 v208, v192, v216
    v_mul_f32 v209, v193, v217
    v_mul_f32 v210, v194, v218
    v_mul_f32 v211, v195, v219
    v_cvt_pk_bf16_f32 v220, v208, v209
    v_cvt_pk_bf16_f32 v221, v210, v211
    buffer_store_dwordx2 v[220:221], v8, s[4:7], s27 offen
L_k3_end_1:
    s_endpgm
.globl k4_kernel
.p2align 8
.type k4_kernel,@function
k4_kernel:
    s_cmp_ge_u32 s2, 256
    s_cbranch_scc1 L_k4_end_1
    s_load_dwordx2 s[4:5], s[0:1], 120
    s_mov_b32 s6, 33554432
    s_mov_b32 s7, 0x20000
    s_load_dwordx2 s[8:9], s[0:1], 104
    s_mov_b32 s10, 2621440
    s_mov_b32 s11, 0x20000
    v_lshrrev_b32 v2, 6, v0
    s_nop 0
    v_readfirstlane_b32 s16, v2
    s_lshr_b32 s19, s2, 5
    s_and_b32 s17, s2, 6
    s_lshl_b32 s17, s17, 2
    s_add_u32 s17, s17, s19
    s_bfe_u32 s19, s2, 0x20003
    s_and_b32 s18, s2, 1
    s_lshl_b32 s18, s18, 2
    s_add_u32 s18, s18, s19
    s_mov_b32 s3, 0xffff0000
    v_and_b32 v1, 63, v0
    v_lshlrev_b32 v4, 4, v1
    s_mul_i32 s19, s16, 5120
    s_mov_b32 m0, s19
    s_mul_i32 s24, s18, 143360
    s_add_u32 s24, s24, s19
    s_add_u32 s24, s24, 11206656
    s_lshl_b32 s25, s17, 2
    s_add_u32 s25, s25, s16
    s_mul_i32 s25, s25, 28672
    s_add_u32 s25, s25, 20447232
    s_waitcnt lgkmcnt(0)
    buffer_load_dwordx4 v4, s[4:7], s24 offen offset:0 lds
    buffer_load_dwordx4 v4, s[4:7], s24 offen offset:1024 lds
    buffer_load_dwordx4 v4, s[4:7], s24 offen offset:2048 lds
    buffer_load_dwordx4 v4, s[4:7], s24 offen offset:3072 lds
    s_add_u32 m0, m0, 4096
    s_add_u32 s24, s24, 4096
    buffer_load_dwordx4 v4, s[4:7], s24 offen lds
    s_add_u32 m0, m0, 16384
    s_add_u32 s24, s24, 16384
    buffer_load_dwordx4 v[8:11], v4, s[4:7], s25 offen offset:0
    buffer_load_dwordx4 v[12:15], v4, s[4:7], s25 offen offset:1024
    buffer_load_dwordx4 v[16:19], v4, s[4:7], s25 offen offset:2048
    buffer_load_dwordx4 v[20:23], v4, s[4:7], s25 offen offset:3072
    s_add_u32 s25, s25, 4096
    buffer_load_dwordx4 v4, s[4:7], s24 offen offset:0 lds
    buffer_load_dwordx4 v4, s[4:7], s24 offen offset:1024 lds
    buffer_load_dwordx4 v4, s[4:7], s24 offen offset:2048 lds
    buffer_load_dwordx4 v4, s[4:7], s24 offen offset:3072 lds
    s_add_u32 m0, m0, 4096
    s_add_u32 s24, s24, 4096
    buffer_load_dwordx4 v4, s[4:7], s24 offen lds
    s_add_u32 m0, m0, 16384
    s_add_u32 s24, s24, 16384
    buffer_load_dwordx4 v[24:27], v4, s[4:7], s25 offen offset:0
    buffer_load_dwordx4 v[28:31], v4, s[4:7], s25 offen offset:1024
    buffer_load_dwordx4 v[32:35], v4, s[4:7], s25 offen offset:2048
    buffer_load_dwordx4 v[36:39], v4, s[4:7], s25 offen offset:3072
    s_add_u32 s25, s25, 4096
    buffer_load_dwordx4 v4, s[4:7], s24 offen offset:0 lds
    buffer_load_dwordx4 v4, s[4:7], s24 offen offset:1024 lds
    buffer_load_dwordx4 v4, s[4:7], s24 offen offset:2048 lds
    buffer_load_dwordx4 v4, s[4:7], s24 offen offset:3072 lds
    s_add_u32 m0, m0, 4096
    s_add_u32 s24, s24, 4096
    buffer_load_dwordx4 v4, s[4:7], s24 offen lds
    s_add_u32 m0, m0, 16384
    s_add_u32 s24, s24, 16384
    buffer_load_dwordx4 v[40:43], v4, s[4:7], s25 offen offset:0
    buffer_load_dwordx4 v[44:47], v4, s[4:7], s25 offen offset:1024
    buffer_load_dwordx4 v[48:51], v4, s[4:7], s25 offen offset:2048
    buffer_load_dwordx4 v[52:55], v4, s[4:7], s25 offen offset:3072
    s_add_u32 s25, s25, 4096
    buffer_load_dwordx4 v4, s[4:7], s24 offen offset:0 lds
    buffer_load_dwordx4 v4, s[4:7], s24 offen offset:1024 lds
    buffer_load_dwordx4 v4, s[4:7], s24 offen offset:2048 lds
    buffer_load_dwordx4 v4, s[4:7], s24 offen offset:3072 lds
    s_add_u32 m0, m0, 4096
    s_add_u32 s24, s24, 4096
    buffer_load_dwordx4 v4, s[4:7], s24 offen lds
    s_add_u32 m0, m0, 16384
    s_add_u32 s24, s24, 16384
    buffer_load_dwordx4 v[56:59], v4, s[4:7], s25 offen offset:0
    buffer_load_dwordx4 v[60:63], v4, s[4:7], s25 offen offset:1024
    buffer_load_dwordx4 v[64:67], v4, s[4:7], s25 offen offset:2048
    buffer_load_dwordx4 v[68:71], v4, s[4:7], s25 offen offset:3072
    s_add_u32 s25, s25, 4096
    buffer_load_dwordx4 v4, s[4:7], s24 offen offset:0 lds
    buffer_load_dwordx4 v4, s[4:7], s24 offen offset:1024 lds
    buffer_load_dwordx4 v4, s[4:7], s24 offen offset:2048 lds
    buffer_load_dwordx4 v4, s[4:7], s24 offen offset:3072 lds
    s_add_u32 m0, m0, 4096
    s_add_u32 s24, s24, 4096
    buffer_load_dwordx4 v4, s[4:7], s24 offen lds
    s_add_u32 m0, m0, 16384
    s_add_u32 s24, s24, 16384
    buffer_load_dwordx4 v[72:75], v4, s[4:7], s25 offen offset:0
    buffer_load_dwordx4 v[76:79], v4, s[4:7], s25 offen offset:1024
    buffer_load_dwordx4 v[80:83], v4, s[4:7], s25 offen offset:2048
    buffer_load_dwordx4 v[84:87], v4, s[4:7], s25 offen offset:3072
    s_add_u32 s25, s25, 4096
    buffer_load_dwordx4 v4, s[4:7], s24 offen offset:0 lds
    buffer_load_dwordx4 v4, s[4:7], s24 offen offset:1024 lds
    buffer_load_dwordx4 v4, s[4:7], s24 offen offset:2048 lds
    buffer_load_dwordx4 v4, s[4:7], s24 offen offset:3072 lds
    s_add_u32 m0, m0, 4096
    s_add_u32 s24, s24, 4096
    buffer_load_dwordx4 v4, s[4:7], s24 offen lds
    s_add_u32 m0, m0, 16384
    s_add_u32 s24, s24, 16384
    buffer_load_dwordx4 v[88:91], v4, s[4:7], s25 offen offset:0
    buffer_load_dwordx4 v[92:95], v4, s[4:7], s25 offen offset:1024
    buffer_load_dwordx4 v[96:99], v4, s[4:7], s25 offen offset:2048
    buffer_load_dwordx4 v[100:103], v4, s[4:7], s25 offen offset:3072
    s_add_u32 s25, s25, 4096
    buffer_load_dwordx4 v4, s[4:7], s24 offen offset:0 lds
    buffer_load_dwordx4 v4, s[4:7], s24 offen offset:1024 lds
    buffer_load_dwordx4 v4, s[4:7], s24 offen offset:2048 lds
    buffer_load_dwordx4 v4, s[4:7], s24 offen offset:3072 lds
    s_add_u32 m0, m0, 4096
    s_add_u32 s24, s24, 4096
    buffer_load_dwordx4 v4, s[4:7], s24 offen lds
    buffer_load_dwordx4 v[104:107], v4, s[4:7], s25 offen offset:0
    buffer_load_dwordx4 v[108:111], v4, s[4:7], s25 offen offset:1024
    buffer_load_dwordx4 v[112:115], v4, s[4:7], s25 offen offset:2048
    buffer_load_dwordx4 v[116:119], v4, s[4:7], s25 offen offset:3072
    v_add_u32 v120, 61440, v4
    v_add_u32 v121, 122880, v4
    s_waitcnt vmcnt(58)
    s_barrier
    ds_read_b128 v[144:147], v4 offset:0
    ds_read_b128 v[148:151], v4 offset:1024
    ds_read_b128 v[152:155], v4 offset:2048
    ds_read_b128 v[156:159], v4 offset:3072
    ds_read_b128 v[160:163], v4 offset:4096
    ds_read_b128 v[164:167], v4 offset:5120
    ds_read_b128 v[168:171], v4 offset:6144
    ds_read_b128 v[172:175], v4 offset:7168
    s_waitcnt vmcnt(57) lgkmcnt(7)
    v_mfma_f32_16x16x32_bf16 v[124:127], v[144:147], v[8:11], 0
    ds_read_b128 v[176:179], v4 offset:8192
    s_waitcnt lgkmcnt(7)
    v_mfma_f32_16x16x32_bf16 v[128:131], v[148:151], v[8:11], 0
    ds_read_b128 v[180:183], v4 offset:9216
    s_waitcnt lgkmcnt(7)
    v_mfma_f32_16x16x32_bf16 v[132:135], v[152:155], v[8:11], 0
    ds_read_b128 v[144:147], v4 offset:10240
    s_waitcnt lgkmcnt(7)
    v_mfma_f32_16x16x32_bf16 v[136:139], v[156:159], v[8:11], 0
    ds_read_b128 v[148:151], v4 offset:11264
    s_waitcnt lgkmcnt(7)
    v_mfma_f32_16x16x32_bf16 v[140:143], v[160:163], v[8:11], 0
    ds_read_b128 v[152:155], v4 offset:12288
    s_waitcnt vmcnt(56) lgkmcnt(7)
    v_mfma_f32_16x16x32_bf16 v[124:127], v[164:167], v[12:15], v[124:127]
    ds_read_b128 v[156:159], v4 offset:13312
    s_waitcnt lgkmcnt(7)
    v_mfma_f32_16x16x32_bf16 v[128:131], v[168:171], v[12:15], v[128:131]
    ds_read_b128 v[160:163], v4 offset:14336
    s_waitcnt lgkmcnt(7)
    v_mfma_f32_16x16x32_bf16 v[132:135], v[172:175], v[12:15], v[132:135]
    ds_read_b128 v[164:167], v4 offset:15360
    s_waitcnt lgkmcnt(7)
    v_mfma_f32_16x16x32_bf16 v[136:139], v[176:179], v[12:15], v[136:139]
    ds_read_b128 v[168:171], v4 offset:16384
    s_waitcnt lgkmcnt(7)
    v_mfma_f32_16x16x32_bf16 v[140:143], v[180:183], v[12:15], v[140:143]
    ds_read_b128 v[172:175], v4 offset:17408
    s_waitcnt vmcnt(55) lgkmcnt(7)
    v_mfma_f32_16x16x32_bf16 v[124:127], v[144:147], v[16:19], v[124:127]
    ds_read_b128 v[176:179], v4 offset:18432
    s_waitcnt lgkmcnt(7)
    v_mfma_f32_16x16x32_bf16 v[128:131], v[148:151], v[16:19], v[128:131]
    ds_read_b128 v[180:183], v4 offset:19456
    s_waitcnt lgkmcnt(7)
    v_mfma_f32_16x16x32_bf16 v[132:135], v[152:155], v[16:19], v[132:135]
    s_waitcnt lgkmcnt(6)
    v_mfma_f32_16x16x32_bf16 v[136:139], v[156:159], v[16:19], v[136:139]
    s_waitcnt lgkmcnt(5)
    v_mfma_f32_16x16x32_bf16 v[140:143], v[160:163], v[16:19], v[140:143]
    s_waitcnt vmcnt(54) lgkmcnt(4)
    v_mfma_f32_16x16x32_bf16 v[124:127], v[164:167], v[20:23], v[124:127]
    s_waitcnt lgkmcnt(3)
    v_mfma_f32_16x16x32_bf16 v[128:131], v[168:171], v[20:23], v[128:131]
    s_waitcnt lgkmcnt(2)
    v_mfma_f32_16x16x32_bf16 v[132:135], v[172:175], v[20:23], v[132:135]
    s_waitcnt lgkmcnt(1)
    v_mfma_f32_16x16x32_bf16 v[136:139], v[176:179], v[20:23], v[136:139]
    s_waitcnt lgkmcnt(0)
    v_mfma_f32_16x16x32_bf16 v[140:143], v[180:183], v[20:23], v[140:143]
    s_waitcnt vmcnt(49)
    s_barrier
    ds_read_b128 v[144:147], v4 offset:20480
    ds_read_b128 v[148:151], v4 offset:21504
    ds_read_b128 v[152:155], v4 offset:22528
    ds_read_b128 v[156:159], v4 offset:23552
    ds_read_b128 v[160:163], v4 offset:24576
    ds_read_b128 v[164:167], v4 offset:25600
    ds_read_b128 v[168:171], v4 offset:26624
    ds_read_b128 v[172:175], v4 offset:27648
    s_waitcnt vmcnt(48) lgkmcnt(7)
    v_mfma_f32_16x16x32_bf16 v[124:127], v[144:147], v[24:27], v[124:127]
    ds_read_b128 v[176:179], v4 offset:28672
    s_waitcnt lgkmcnt(7)
    v_mfma_f32_16x16x32_bf16 v[128:131], v[148:151], v[24:27], v[128:131]
    ds_read_b128 v[180:183], v4 offset:29696
    s_waitcnt lgkmcnt(7)
    v_mfma_f32_16x16x32_bf16 v[132:135], v[152:155], v[24:27], v[132:135]
    ds_read_b128 v[144:147], v4 offset:30720
    s_waitcnt lgkmcnt(7)
    v_mfma_f32_16x16x32_bf16 v[136:139], v[156:159], v[24:27], v[136:139]
    ds_read_b128 v[148:151], v4 offset:31744
    s_waitcnt lgkmcnt(7)
    v_mfma_f32_16x16x32_bf16 v[140:143], v[160:163], v[24:27], v[140:143]
    ds_read_b128 v[152:155], v4 offset:32768
    s_waitcnt vmcnt(47) lgkmcnt(7)
    v_mfma_f32_16x16x32_bf16 v[124:127], v[164:167], v[28:31], v[124:127]
    ds_read_b128 v[156:159], v4 offset:33792
    s_waitcnt lgkmcnt(7)
    v_mfma_f32_16x16x32_bf16 v[128:131], v[168:171], v[28:31], v[128:131]
    ds_read_b128 v[160:163], v4 offset:34816
    s_waitcnt lgkmcnt(7)
    v_mfma_f32_16x16x32_bf16 v[132:135], v[172:175], v[28:31], v[132:135]
    ds_read_b128 v[164:167], v4 offset:35840
    s_waitcnt lgkmcnt(7)
    v_mfma_f32_16x16x32_bf16 v[136:139], v[176:179], v[28:31], v[136:139]
    ds_read_b128 v[168:171], v4 offset:36864
    s_waitcnt lgkmcnt(7)
    v_mfma_f32_16x16x32_bf16 v[140:143], v[180:183], v[28:31], v[140:143]
    ds_read_b128 v[172:175], v4 offset:37888
    s_waitcnt vmcnt(46) lgkmcnt(7)
    v_mfma_f32_16x16x32_bf16 v[124:127], v[144:147], v[32:35], v[124:127]
    ds_read_b128 v[176:179], v4 offset:38912
    s_waitcnt lgkmcnt(7)
    v_mfma_f32_16x16x32_bf16 v[128:131], v[148:151], v[32:35], v[128:131]
    ds_read_b128 v[180:183], v4 offset:39936
    s_waitcnt lgkmcnt(7)
    v_mfma_f32_16x16x32_bf16 v[132:135], v[152:155], v[32:35], v[132:135]
    s_waitcnt lgkmcnt(6)
    v_mfma_f32_16x16x32_bf16 v[136:139], v[156:159], v[32:35], v[136:139]
    s_waitcnt lgkmcnt(5)
    v_mfma_f32_16x16x32_bf16 v[140:143], v[160:163], v[32:35], v[140:143]
    s_waitcnt vmcnt(45) lgkmcnt(4)
    v_mfma_f32_16x16x32_bf16 v[124:127], v[164:167], v[36:39], v[124:127]
    s_waitcnt lgkmcnt(3)
    v_mfma_f32_16x16x32_bf16 v[128:131], v[168:171], v[36:39], v[128:131]
    s_waitcnt lgkmcnt(2)
    v_mfma_f32_16x16x32_bf16 v[132:135], v[172:175], v[36:39], v[132:135]
    s_waitcnt lgkmcnt(1)
    v_mfma_f32_16x16x32_bf16 v[136:139], v[176:179], v[36:39], v[136:139]
    s_waitcnt lgkmcnt(0)
    v_mfma_f32_16x16x32_bf16 v[140:143], v[180:183], v[36:39], v[140:143]
    s_waitcnt vmcnt(40)
    s_barrier
    v_and_b32 v2, 15, v0
    v_lshrrev_b32 v3, 4, v1
    v_lshlrev_b32 v217, 3, v2
    v_lshl_add_u32 v216, v3, 15, v217
    v_lshl_add_u32 v217, v3, 14, v217
    v_lshlrev_b32 v218, 5, v3
    v_mul_u32_u24 v219, 2560, v2
    s_mul_i32 s19, s18, 327680
    s_lshl_b32 s20, s17, 9
    s_add_u32 s19, s19, s20
    s_lshl_b32 s20, s16, 7
    s_add_u32 s19, s19, s20
    s_add_u32 s19, s19, 6291456
    s_add_u32 s20, s19, 0
    buffer_load_dwordx2 v[184:185], v216, s[4:7], s20 offen
    s_add_u32 s20, s19, 16384
    buffer_load_dwordx2 v[186:187], v216, s[4:7], s20 offen
    s_add_u32 s20, s19, 131072
    buffer_load_dwordx2 v[188:189], v216, s[4:7], s20 offen
    s_add_u32 s20, s19, 147456
    buffer_load_dwordx2 v[190:191], v216, s[4:7], s20 offen
    s_add_u32 s20, s19, 262144
    buffer_load_dwordx2 v[192:193], v217, s[4:7], s20 offen
    s_mul_i32 s19, s18, 320
    s_add_u32 s19, s19, 12800
    buffer_load_dwordx4 v[196:199], v218, s[4:7], s19 offen offset:0
    buffer_load_dwordx4 v[200:203], v218, s[4:7], s19 offen offset:16
    buffer_load_dwordx4 v[204:207], v218, s[4:7], s19 offen offset:128
    buffer_load_dwordx4 v[208:211], v218, s[4:7], s19 offen offset:144
    v_lshlrev_b32 v218, 4, v3
    buffer_load_dwordx4 v[212:215], v218, s[4:7], s19 offen offset:256
    ds_read_b128 v[144:147], v4 offset:40960
    ds_read_b128 v[148:151], v4 offset:41984
    ds_read_b128 v[152:155], v4 offset:43008
    ds_read_b128 v[156:159], v4 offset:44032
    ds_read_b128 v[160:163], v4 offset:45056
    ds_read_b128 v[164:167], v4 offset:46080
    ds_read_b128 v[168:171], v4 offset:47104
    ds_read_b128 v[172:175], v4 offset:48128
    s_waitcnt vmcnt(49) lgkmcnt(7)
    v_mfma_f32_16x16x32_bf16 v[124:127], v[144:147], v[40:43], v[124:127]
    ds_read_b128 v[176:179], v4 offset:49152
    s_waitcnt lgkmcnt(7)
    v_mfma_f32_16x16x32_bf16 v[128:131], v[148:151], v[40:43], v[128:131]
    ds_read_b128 v[180:183], v4 offset:50176
    s_waitcnt lgkmcnt(7)
    v_mfma_f32_16x16x32_bf16 v[132:135], v[152:155], v[40:43], v[132:135]
    ds_read_b128 v[144:147], v4 offset:51200
    s_waitcnt lgkmcnt(7)
    v_mfma_f32_16x16x32_bf16 v[136:139], v[156:159], v[40:43], v[136:139]
    ds_read_b128 v[148:151], v4 offset:52224
    s_waitcnt lgkmcnt(7)
    v_mfma_f32_16x16x32_bf16 v[140:143], v[160:163], v[40:43], v[140:143]
    ds_read_b128 v[152:155], v4 offset:53248
    s_waitcnt vmcnt(48) lgkmcnt(7)
    v_mfma_f32_16x16x32_bf16 v[124:127], v[164:167], v[44:47], v[124:127]
    ds_read_b128 v[156:159], v4 offset:54272
    s_waitcnt lgkmcnt(7)
    v_mfma_f32_16x16x32_bf16 v[128:131], v[168:171], v[44:47], v[128:131]
    ds_read_b128 v[160:163], v4 offset:55296
    s_waitcnt lgkmcnt(7)
    v_mfma_f32_16x16x32_bf16 v[132:135], v[172:175], v[44:47], v[132:135]
    ds_read_b128 v[164:167], v4 offset:56320
    s_waitcnt lgkmcnt(7)
    v_mfma_f32_16x16x32_bf16 v[136:139], v[176:179], v[44:47], v[136:139]
    ds_read_b128 v[168:171], v4 offset:57344
    s_waitcnt lgkmcnt(7)
    v_mfma_f32_16x16x32_bf16 v[140:143], v[180:183], v[44:47], v[140:143]
    ds_read_b128 v[172:175], v4 offset:58368
    s_waitcnt vmcnt(47) lgkmcnt(7)
    v_mfma_f32_16x16x32_bf16 v[124:127], v[144:147], v[48:51], v[124:127]
    ds_read_b128 v[176:179], v4 offset:59392
    s_waitcnt lgkmcnt(7)
    v_mfma_f32_16x16x32_bf16 v[128:131], v[148:151], v[48:51], v[128:131]
    ds_read_b128 v[180:183], v4 offset:60416
    s_waitcnt lgkmcnt(7)
    v_mfma_f32_16x16x32_bf16 v[132:135], v[152:155], v[48:51], v[132:135]
    s_waitcnt lgkmcnt(6)
    v_mfma_f32_16x16x32_bf16 v[136:139], v[156:159], v[48:51], v[136:139]
    s_waitcnt lgkmcnt(5)
    v_mfma_f32_16x16x32_bf16 v[140:143], v[160:163], v[48:51], v[140:143]
    s_waitcnt vmcnt(46) lgkmcnt(4)
    v_mfma_f32_16x16x32_bf16 v[124:127], v[164:167], v[52:55], v[124:127]
    s_waitcnt lgkmcnt(3)
    v_mfma_f32_16x16x32_bf16 v[128:131], v[168:171], v[52:55], v[128:131]
    s_waitcnt lgkmcnt(2)
    v_mfma_f32_16x16x32_bf16 v[132:135], v[172:175], v[52:55], v[132:135]
    s_waitcnt lgkmcnt(1)
    v_mfma_f32_16x16x32_bf16 v[136:139], v[176:179], v[52:55], v[136:139]
    s_waitcnt lgkmcnt(0)
    v_mfma_f32_16x16x32_bf16 v[140:143], v[180:183], v[52:55], v[140:143]
    s_waitcnt vmcnt(41)
    s_barrier
    ds_read_b128 v[144:147], v120 offset:0
    ds_read_b128 v[148:151], v120 offset:1024
    ds_read_b128 v[152:155], v120 offset:2048
    ds_read_b128 v[156:159], v120 offset:3072
    ds_read_b128 v[160:163], v120 offset:4096
    ds_read_b128 v[164:167], v120 offset:5120
    ds_read_b128 v[168:171], v120 offset:6144
    ds_read_b128 v[172:175], v120 offset:7168
    s_waitcnt vmcnt(40) lgkmcnt(7)
    v_mfma_f32_16x16x32_bf16 v[124:127], v[144:147], v[56:59], v[124:127]
    ds_read_b128 v[176:179], v120 offset:8192
    s_waitcnt lgkmcnt(7)
    v_mfma_f32_16x16x32_bf16 v[128:131], v[148:151], v[56:59], v[128:131]
    ds_read_b128 v[180:183], v120 offset:9216
    s_waitcnt lgkmcnt(7)
    v_mfma_f32_16x16x32_bf16 v[132:135], v[152:155], v[56:59], v[132:135]
    ds_read_b128 v[144:147], v120 offset:10240
    s_waitcnt lgkmcnt(7)
    v_mfma_f32_16x16x32_bf16 v[136:139], v[156:159], v[56:59], v[136:139]
    ds_read_b128 v[148:151], v120 offset:11264
    s_waitcnt lgkmcnt(7)
    v_mfma_f32_16x16x32_bf16 v[140:143], v[160:163], v[56:59], v[140:143]
    ds_read_b128 v[152:155], v120 offset:12288
    s_waitcnt vmcnt(39) lgkmcnt(7)
    v_mfma_f32_16x16x32_bf16 v[124:127], v[164:167], v[60:63], v[124:127]
    ds_read_b128 v[156:159], v120 offset:13312
    s_waitcnt lgkmcnt(7)
    v_mfma_f32_16x16x32_bf16 v[128:131], v[168:171], v[60:63], v[128:131]
    ds_read_b128 v[160:163], v120 offset:14336
    s_waitcnt lgkmcnt(7)
    v_mfma_f32_16x16x32_bf16 v[132:135], v[172:175], v[60:63], v[132:135]
    ds_read_b128 v[164:167], v120 offset:15360
    s_waitcnt lgkmcnt(7)
    v_mfma_f32_16x16x32_bf16 v[136:139], v[176:179], v[60:63], v[136:139]
    ds_read_b128 v[168:171], v120 offset:16384
    s_waitcnt lgkmcnt(7)
    v_mfma_f32_16x16x32_bf16 v[140:143], v[180:183], v[60:63], v[140:143]
    ds_read_b128 v[172:175], v120 offset:17408
    s_waitcnt vmcnt(38) lgkmcnt(7)
    v_mfma_f32_16x16x32_bf16 v[124:127], v[144:147], v[64:67], v[124:127]
    ds_read_b128 v[176:179], v120 offset:18432
    s_waitcnt lgkmcnt(7)
    v_mfma_f32_16x16x32_bf16 v[128:131], v[148:151], v[64:67], v[128:131]
    ds_read_b128 v[180:183], v120 offset:19456
    s_waitcnt lgkmcnt(7)
    v_mfma_f32_16x16x32_bf16 v[132:135], v[152:155], v[64:67], v[132:135]
    s_waitcnt lgkmcnt(6)
    v_mfma_f32_16x16x32_bf16 v[136:139], v[156:159], v[64:67], v[136:139]
    s_waitcnt lgkmcnt(5)
    v_mfma_f32_16x16x32_bf16 v[140:143], v[160:163], v[64:67], v[140:143]
    s_waitcnt vmcnt(37) lgkmcnt(4)
    v_mfma_f32_16x16x32_bf16 v[124:127], v[164:167], v[68:71], v[124:127]
    s_waitcnt lgkmcnt(3)
    v_mfma_f32_16x16x32_bf16 v[128:131], v[168:171], v[68:71], v[128:131]
    s_waitcnt lgkmcnt(2)
    v_mfma_f32_16x16x32_bf16 v[132:135], v[172:175], v[68:71], v[132:135]
    s_waitcnt lgkmcnt(1)
    v_mfma_f32_16x16x32_bf16 v[136:139], v[176:179], v[68:71], v[136:139]
    s_waitcnt lgkmcnt(0)
    v_mfma_f32_16x16x32_bf16 v[140:143], v[180:183], v[68:71], v[140:143]
    s_waitcnt vmcnt(32)
    s_barrier
    ds_read_b128 v[144:147], v120 offset:20480
    ds_read_b128 v[148:151], v120 offset:21504
    ds_read_b128 v[152:155], v120 offset:22528
    ds_read_b128 v[156:159], v120 offset:23552
    ds_read_b128 v[160:163], v120 offset:24576
    ds_read_b128 v[164:167], v120 offset:25600
    ds_read_b128 v[168:171], v120 offset:26624
    ds_read_b128 v[172:175], v120 offset:27648
    s_waitcnt vmcnt(31) lgkmcnt(7)
    v_mfma_f32_16x16x32_bf16 v[124:127], v[144:147], v[72:75], v[124:127]
    ds_read_b128 v[176:179], v120 offset:28672
    s_waitcnt lgkmcnt(7)
    v_mfma_f32_16x16x32_bf16 v[128:131], v[148:151], v[72:75], v[128:131]
    ds_read_b128 v[180:183], v120 offset:29696
    s_waitcnt lgkmcnt(7)
    v_mfma_f32_16x16x32_bf16 v[132:135], v[152:155], v[72:75], v[132:135]
    ds_read_b128 v[144:147], v120 offset:30720
    s_waitcnt lgkmcnt(7)
    v_mfma_f32_16x16x32_bf16 v[136:139], v[156:159], v[72:75], v[136:139]
    ds_read_b128 v[148:151], v120 offset:31744
    s_waitcnt lgkmcnt(7)
    v_mfma_f32_16x16x32_bf16 v[140:143], v[160:163], v[72:75], v[140:143]
    ds_read_b128 v[152:155], v120 offset:32768
    s_waitcnt vmcnt(30) lgkmcnt(7)
    v_mfma_f32_16x16x32_bf16 v[124:127], v[164:167], v[76:79], v[124:127]
    ds_read_b128 v[156:159], v120 offset:33792
    s_waitcnt lgkmcnt(7)
    v_mfma_f32_16x16x32_bf16 v[128:131], v[168:171], v[76:79], v[128:131]
    ds_read_b128 v[160:163], v120 offset:34816
    s_waitcnt lgkmcnt(7)
    v_mfma_f32_16x16x32_bf16 v[132:135], v[172:175], v[76:79], v[132:135]
    ds_read_b128 v[164:167], v120 offset:35840
    s_waitcnt lgkmcnt(7)
    v_mfma_f32_16x16x32_bf16 v[136:139], v[176:179], v[76:79], v[136:139]
    ds_read_b128 v[168:171], v120 offset:36864
    s_waitcnt lgkmcnt(7)
    v_mfma_f32_16x16x32_bf16 v[140:143], v[180:183], v[76:79], v[140:143]
    ds_read_b128 v[172:175], v120 offset:37888
    s_waitcnt vmcnt(29) lgkmcnt(7)
    v_mfma_f32_16x16x32_bf16 v[124:127], v[144:147], v[80:83], v[124:127]
    ds_read_b128 v[176:179], v120 offset:38912
    s_waitcnt lgkmcnt(7)
    v_mfma_f32_16x16x32_bf16 v[128:131], v[148:151], v[80:83], v[128:131]
    ds_read_b128 v[180:183], v120 offset:39936
    s_waitcnt lgkmcnt(7)
    v_mfma_f32_16x16x32_bf16 v[132:135], v[152:155], v[80:83], v[132:135]
    s_waitcnt lgkmcnt(6)
    v_mfma_f32_16x16x32_bf16 v[136:139], v[156:159], v[80:83], v[136:139]
    s_waitcnt lgkmcnt(5)
    v_mfma_f32_16x16x32_bf16 v[140:143], v[160:163], v[80:83], v[140:143]
    s_waitcnt vmcnt(28) lgkmcnt(4)
    v_mfma_f32_16x16x32_bf16 v[124:127], v[164:167], v[84:87], v[124:127]
    s_waitcnt lgkmcnt(3)
    v_mfma_f32_16x16x32_bf16 v[128:131], v[168:171], v[84:87], v[128:131]
    s_waitcnt lgkmcnt(2)
    v_mfma_f32_16x16x32_bf16 v[132:135], v[172:175], v[84:87], v[132:135]
    s_waitcnt lgkmcnt(1)
    v_mfma_f32_16x16x32_bf16 v[136:139], v[176:179], v[84:87], v[136:139]
    s_waitcnt lgkmcnt(0)
    v_mfma_f32_16x16x32_bf16 v[140:143], v[180:183], v[84:87], v[140:143]
    s_waitcnt vmcnt(23)
    s_barrier
    ds_read_b128 v[144:147], v120 offset:40960
    ds_read_b128 v[148:151], v120 offset:41984
    ds_read_b128 v[152:155], v120 offset:43008
    ds_read_b128 v[156:159], v120 offset:44032
    ds_read_b128 v[160:163], v120 offset:45056
    ds_read_b128 v[164:167], v120 offset:46080
    ds_read_b128 v[168:171], v120 offset:47104
    ds_read_b128 v[172:175], v120 offset:48128
    s_waitcnt vmcnt(22) lgkmcnt(7)
    v_mfma_f32_16x16x32_bf16 v[124:127], v[144:147], v[88:91], v[124:127]
    ds_read_b128 v[176:179], v120 offset:49152
    s_waitcnt lgkmcnt(7)
    v_mfma_f32_16x16x32_bf16 v[128:131], v[148:151], v[88:91], v[128:131]
    ds_read_b128 v[180:183], v120 offset:50176
    s_waitcnt lgkmcnt(7)
    v_mfma_f32_16x16x32_bf16 v[132:135], v[152:155], v[88:91], v[132:135]
    ds_read_b128 v[144:147], v120 offset:51200
    s_waitcnt lgkmcnt(7)
    v_mfma_f32_16x16x32_bf16 v[136:139], v[156:159], v[88:91], v[136:139]
    ds_read_b128 v[148:151], v120 offset:52224
    s_waitcnt lgkmcnt(7)
    v_mfma_f32_16x16x32_bf16 v[140:143], v[160:163], v[88:91], v[140:143]
    ds_read_b128 v[152:155], v120 offset:53248
    s_waitcnt vmcnt(21) lgkmcnt(7)
    v_mfma_f32_16x16x32_bf16 v[124:127], v[164:167], v[92:95], v[124:127]
    ds_read_b128 v[156:159], v120 offset:54272
    s_waitcnt lgkmcnt(7)
    v_mfma_f32_16x16x32_bf16 v[128:131], v[168:171], v[92:95], v[128:131]
    ds_read_b128 v[160:163], v120 offset:55296
    s_waitcnt lgkmcnt(7)
    v_mfma_f32_16x16x32_bf16 v[132:135], v[172:175], v[92:95], v[132:135]
    ds_read_b128 v[164:167], v120 offset:56320
    s_waitcnt lgkmcnt(7)
    v_mfma_f32_16x16x32_bf16 v[136:139], v[176:179], v[92:95], v[136:139]
    ds_read_b128 v[168:171], v120 offset:57344
    s_waitcnt lgkmcnt(7)
    v_mfma_f32_16x16x32_bf16 v[140:143], v[180:183], v[92:95], v[140:143]
    ds_read_b128 v[172:175], v120 offset:58368
    s_waitcnt vmcnt(20) lgkmcnt(7)
    v_mfma_f32_16x16x32_bf16 v[124:127], v[144:147], v[96:99], v[124:127]
    ds_read_b128 v[176:179], v120 offset:59392
    s_waitcnt lgkmcnt(7)
    v_mfma_f32_16x16x32_bf16 v[128:131], v[148:151], v[96:99], v[128:131]
    ds_read_b128 v[180:183], v120 offset:60416
    s_waitcnt lgkmcnt(7)
    v_mfma_f32_16x16x32_bf16 v[132:135], v[152:155], v[96:99], v[132:135]
    s_waitcnt lgkmcnt(6)
    v_mfma_f32_16x16x32_bf16 v[136:139], v[156:159], v[96:99], v[136:139]
    s_waitcnt lgkmcnt(5)
    v_mfma_f32_16x16x32_bf16 v[140:143], v[160:163], v[96:99], v[140:143]
    s_waitcnt vmcnt(19) lgkmcnt(4)
    v_mfma_f32_16x16x32_bf16 v[124:127], v[164:167], v[100:103], v[124:127]
    s_waitcnt lgkmcnt(3)
    v_mfma_f32_16x16x32_bf16 v[128:131], v[168:171], v[100:103], v[128:131]
    s_waitcnt lgkmcnt(2)
    v_mfma_f32_16x16x32_bf16 v[132:135], v[172:175], v[100:103], v[132:135]
    s_waitcnt lgkmcnt(1)
    v_mfma_f32_16x16x32_bf16 v[136:139], v[176:179], v[100:103], v[136:139]
    s_waitcnt lgkmcnt(0)
    v_mfma_f32_16x16x32_bf16 v[140:143], v[180:183], v[100:103], v[140:143]
    s_waitcnt vmcnt(14)
    s_barrier
    ds_read_b128 v[144:147], v121 offset:0
    ds_read_b128 v[148:151], v121 offset:1024
    ds_read_b128 v[152:155], v121 offset:2048
    ds_read_b128 v[156:159], v121 offset:3072
    ds_read_b128 v[160:163], v121 offset:4096
    ds_read_b128 v[164:167], v121 offset:5120
    ds_read_b128 v[168:171], v121 offset:6144
    ds_read_b128 v[172:175], v121 offset:7168
    s_waitcnt vmcnt(13) lgkmcnt(7)
    v_mfma_f32_16x16x32_bf16 v[124:127], v[144:147], v[104:107], v[124:127]
    ds_read_b128 v[176:179], v121 offset:8192
    s_waitcnt lgkmcnt(7)
    v_mfma_f32_16x16x32_bf16 v[128:131], v[148:151], v[104:107], v[128:131]
    ds_read_b128 v[180:183], v121 offset:9216
    s_waitcnt lgkmcnt(7)
    v_mfma_f32_16x16x32_bf16 v[132:135], v[152:155], v[104:107], v[132:135]
    ds_read_b128 v[144:147], v121 offset:10240
    s_waitcnt lgkmcnt(7)
    v_mfma_f32_16x16x32_bf16 v[136:139], v[156:159], v[104:107], v[136:139]
    ds_read_b128 v[148:151], v121 offset:11264
    s_waitcnt lgkmcnt(7)
    v_mfma_f32_16x16x32_bf16 v[140:143], v[160:163], v[104:107], v[140:143]
    ds_read_b128 v[152:155], v121 offset:12288
    s_waitcnt vmcnt(12) lgkmcnt(7)
    v_mfma_f32_16x16x32_bf16 v[124:127], v[164:167], v[108:111], v[124:127]
    ds_read_b128 v[156:159], v121 offset:13312
    s_waitcnt lgkmcnt(7)
    v_mfma_f32_16x16x32_bf16 v[128:131], v[168:171], v[108:111], v[128:131]
    ds_read_b128 v[160:163], v121 offset:14336
    s_waitcnt lgkmcnt(7)
    v_mfma_f32_16x16x32_bf16 v[132:135], v[172:175], v[108:111], v[132:135]
    ds_read_b128 v[164:167], v121 offset:15360
    s_waitcnt lgkmcnt(7)
    v_mfma_f32_16x16x32_bf16 v[136:139], v[176:179], v[108:111], v[136:139]
    ds_read_b128 v[168:171], v121 offset:16384
    s_waitcnt lgkmcnt(7)
    v_mfma_f32_16x16x32_bf16 v[140:143], v[180:183], v[108:111], v[140:143]
    ds_read_b128 v[172:175], v121 offset:17408
    s_waitcnt vmcnt(11) lgkmcnt(7)
    v_mfma_f32_16x16x32_bf16 v[124:127], v[144:147], v[112:115], v[124:127]
    ds_read_b128 v[176:179], v121 offset:18432
    s_waitcnt lgkmcnt(7)
    v_mfma_f32_16x16x32_bf16 v[128:131], v[148:151], v[112:115], v[128:131]
    ds_read_b128 v[180:183], v121 offset:19456
    s_waitcnt lgkmcnt(7)
    v_mfma_f32_16x16x32_bf16 v[132:135], v[152:155], v[112:115], v[132:135]
    s_waitcnt lgkmcnt(6)
    v_mfma_f32_16x16x32_bf16 v[136:139], v[156:159], v[112:115], v[136:139]
    s_waitcnt lgkmcnt(5)
    v_mfma_f32_16x16x32_bf16 v[140:143], v[160:163], v[112:115], v[140:143]
    s_waitcnt vmcnt(10) lgkmcnt(4)
    v_mfma_f32_16x16x32_bf16 v[124:127], v[164:167], v[116:119], v[124:127]
    s_waitcnt lgkmcnt(3)
    v_mfma_f32_16x16x32_bf16 v[128:131], v[168:171], v[116:119], v[128:131]
    s_waitcnt lgkmcnt(2)
    v_mfma_f32_16x16x32_bf16 v[132:135], v[172:175], v[116:119], v[132:135]
    s_waitcnt lgkmcnt(1)
    v_mfma_f32_16x16x32_bf16 v[136:139], v[176:179], v[116:119], v[136:139]
    s_waitcnt lgkmcnt(0)
    v_mfma_f32_16x16x32_bf16 v[140:143], v[180:183], v[116:119], v[140:143]
    s_lshl_b32 s19, s17, 6
    s_lshr_b32 s20, s16, 1
    s_lshl_b32 s20, s20, 5
    s_add_u32 s19, s19, s20
    s_and_b32 s20, s16, 1
    s_add_u32 s19, s19, s20
    s_mul_i32 s19, s19, 1280
    s_mul_i32 s20, s18, 160
    s_add_u32 s19, s19, s20
    v_lshl_add_u32 v2, v3, 3, v219
    v_lshl_add_u32 v219, v3, 4, v219
    s_waitcnt vmcnt(9)
    v_lshlrev_b32 v144, 16, v184
    v_and_b32 v148, s3, v184
    v_lshlrev_b32 v145, 16, v185
    v_and_b32 v149, s3, v185
    s_waitcnt vmcnt(8)
    v_lshlrev_b32 v146, 16, v186
    v_and_b32 v150, s3, v186
    v_lshlrev_b32 v147, 16, v187
    v_and_b32 v151, s3, v187
    s_waitcnt vmcnt(4)
    v_fmac_f32 v144, v196, v124
    v_fmac_f32 v148, v197, v128
    v_fmac_f32 v145, v198, v125
    v_fmac_f32 v149, v199, v129
    s_waitcnt vmcnt(3)
    v_fmac_f32 v146, v200, v126
    v_fmac_f32 v150, v201, v130
    v_fmac_f32 v147, v202, v127
    v_fmac_f32 v151, v203, v131
    v_cvt_pk_bf16_f32 v184, v144, v148
    v_cvt_pk_bf16_f32 v185, v145, v149
    v_cvt_pk_bf16_f32 v186, v146, v150
    v_cvt_pk_bf16_f32 v187, v147, v151
    buffer_store_dwordx4 v[184:187], v219, s[8:11], s19 offen offset:0
    v_lshlrev_b32 v144, 16, v188
    v_and_b32 v148, s3, v188
    v_lshlrev_b32 v145, 16, v189
    v_and_b32 v149, s3, v189
    v_lshlrev_b32 v146, 16, v190
    v_and_b32 v150, s3, v190
    v_lshlrev_b32 v147, 16, v191
    v_and_b32 v151, s3, v191
    s_waitcnt vmcnt(3)
    v_fmac_f32 v144, v204, v132
    v_fmac_f32 v148, v205, v136
    v_fmac_f32 v145, v206, v133
    v_fmac_f32 v149, v207, v137
    s_waitcnt vmcnt(2)
    v_fmac_f32 v146, v208, v134
    v_fmac_f32 v150, v209, v138
    v_fmac_f32 v147, v210, v135
    v_fmac_f32 v151, v211, v139
    v_cvt_pk_bf16_f32 v188, v144, v148
    v_cvt_pk_bf16_f32 v189, v145, v149
    v_cvt_pk_bf16_f32 v190, v146, v150
    v_cvt_pk_bf16_f32 v191, v147, v151
    buffer_store_dwordx4 v[188:191], v219, s[8:11], s19 offen offset:64
    v_lshlrev_b32 v144, 16, v192
    v_and_b32 v145, s3, v192
    v_lshlrev_b32 v146, 16, v193
    v_and_b32 v147, s3, v193
    s_waitcnt vmcnt(2)
    v_fmac_f32 v144, v212, v140
    v_fmac_f32 v145, v213, v141
    v_fmac_f32 v146, v214, v142
    v_fmac_f32 v147, v215, v143
    v_cvt_pk_bf16_f32 v192, v144, v145
    v_cvt_pk_bf16_f32 v193, v146, v147
    buffer_store_dwordx2 v[192:193], v2, s[8:11], s19 offen offset:128
L_k4_end_1:
    s_endpgm
.section .rodata,"a"
.p2align 6
.amdhsa_kernel k0_kernel
  .amdhsa_next_free_vgpr 132
  .amdhsa_next_free_sgpr 36
  .amdhsa_accum_offset 132
  .amdhsa_group_segment_fixed_size 0
  .amdhsa_kernarg_size 128
  .amdhsa_user_sgpr_count 2
  .amdhsa_user_sgpr_kernarg_segment_ptr 1
  .amdhsa_system_sgpr_workgroup_id_x 1
  .amdhsa_float_denorm_mode_32 3
.end_amdhsa_kernel
.p2align 6
.amdhsa_kernel k1_kernel
  .amdhsa_next_free_vgpr 226
  .amdhsa_next_free_sgpr 36
  .amdhsa_accum_offset 228
  .amdhsa_group_segment_fixed_size 0
  .amdhsa_kernarg_size 128
  .amdhsa_user_sgpr_count 2
  .amdhsa_user_sgpr_kernarg_segment_ptr 1
  .amdhsa_system_sgpr_workgroup_id_x 1
  .amdhsa_float_denorm_mode_32 3
.end_amdhsa_kernel
.p2align 6
.amdhsa_kernel k2_kernel
  .amdhsa_next_free_vgpr 372
  .amdhsa_next_free_sgpr 31
  .amdhsa_accum_offset 212
  .amdhsa_group_segment_fixed_size 0
  .amdhsa_kernarg_size 128
  .amdhsa_user_sgpr_count 2
  .amdhsa_user_sgpr_kernarg_segment_ptr 1
  .amdhsa_system_sgpr_workgroup_id_x 1
  .amdhsa_float_denorm_mode_32 3
.end_amdhsa_kernel
.p2align 6
.amdhsa_kernel k3_kernel
  .amdhsa_next_free_vgpr 480
  .amdhsa_next_free_sgpr 32
  .amdhsa_accum_offset 224
  .amdhsa_group_segment_fixed_size 0
  .amdhsa_kernarg_size 128
  .amdhsa_user_sgpr_count 2
  .amdhsa_user_sgpr_kernarg_segment_ptr 1
  .amdhsa_system_sgpr_workgroup_id_x 1
  .amdhsa_float_denorm_mode_32 3
.end_amdhsa_kernel
.p2align 6
.amdhsa_kernel k4_kernel
  .amdhsa_next_free_vgpr 220
  .amdhsa_next_free_sgpr 26
  .amdhsa_accum_offset 220
  .amdhsa_group_segment_fixed_size 0
  .amdhsa_kernarg_size 128
  .amdhsa_user_sgpr_count 2
  .amdhsa_user_sgpr_kernarg_segment_ptr 1
  .amdhsa_system_sgpr_workgroup_id_x 1
  .amdhsa_float_denorm_mode_32 3
.end_amdhsa_kernel
```

```asm
; @launch kernel=ka_kernel grid=(256,1,1) block=(256,1,1) lds=159232
; @launch kernel=kb_kernel grid=(256,1,1) block=(256,1,1) lds=163840
.amdgcn_target "amdgcn-amd-amdhsa--gfx950"
.text
.globl ka_kernel
.p2align 8
.type ka_kernel,@function
ka_kernel:
    s_cmp_ge_u32 s2, 256
    s_cbranch_scc1 L_ka_end_1
    s_load_dwordx2 s[4:5], s[0:1], 120
    s_mov_b32 s6, 33554432
    s_mov_b32 s7, 0x20000
    s_load_dwordx2 s[44:45], s[0:1], 112
    s_mov_b32 s46, 256
    s_mov_b32 s47, 0x20000
    s_mov_b32 s3, 0xffff0000
    s_cmp_ge_u32 s2, 160
    s_cbranch_scc1 L_ka_aux_3
    s_load_dwordx2 s[8:9], s[0:1], 8
    s_mov_b32 s10, 2621440
    s_mov_b32 s11, 0x20000
    s_load_dwordx2 s[12:13], s[0:1], 16
    s_mov_b32 s14, 2621440
    s_mov_b32 s15, 0x20000
    s_load_dwordx2 s[20:21], s[0:1], 24
    s_mov_b32 s22, 5120
    s_mov_b32 s23, 0x20000
    s_load_dwordx2 s[16:17], s[0:1], 0
    s_mov_b32 s18, 2621440
    s_mov_b32 s19, 0x20000
    s_load_dwordx2 s[24:25], s[0:1], 32
    s_mov_b32 s26, 2621440
    s_mov_b32 s27, 0x20000
    s_load_dwordx2 s[28:29], s[0:1], 40
    s_mov_b32 s30, 1280
    s_mov_b32 s31, 0x20000
    s_load_dwordx2 s[32:33], s[0:1], 64
    s_mov_b32 s34, 8388608
    s_mov_b32 s35, 0x20000
    s_load_dwordx2 s[36:37], s[0:1], 80
    s_mov_b32 s38, 1105920
    s_mov_b32 s39, 0x20000
    s_lshr_b32 s52, s2, 4
    s_and_b32 s53, s2, 15
    v_and_b32 v44, 7, v0
    v_lshrrev_b32 v45, 3, v0
    s_mul_i32 s58, s53, 163840
    s_lshl_b32 s59, s52, 7
    s_add_u32 s58, s58, s59
    v_mul_u32_u24 v46, 5120, v45
    v_lshl_add_u32 v46, v44, 4, v46
    v_add_u32 v46, s58, v46
    v_subrev_u32 v47, 3840, v46
    s_lshl_b32 s59, s52, 9
    v_lshl_add_u32 v48, v44, 6, s59
    s_waitcnt lgkmcnt(0)
    buffer_load_dwordx4 v[62:65], v46, s[8:11], 0 offen offset:0
    buffer_load_dwordx4 v[66:69], v46, s[8:11], 0 offen offset:1280
    buffer_load_dwordx4 v[70:73], v46, s[8:11], 0 offen offset:2560
    buffer_load_dwordx4 v[74:77], v46, s[8:11], 0 offen offset:3840
    buffer_load_dwordx4 v[78:81], v46, s[12:15], 0 offen offset:0
    buffer_load_dwordx4 v[82:85], v46, s[12:15], 0 offen offset:1280
    buffer_load_dwordx4 v[86:89], v46, s[12:15], 0 offen offset:2560
    buffer_load_dwordx4 v[90:93], v46, s[12:15], 0 offen offset:3840
    buffer_load_dwordx4 v[94:97], v48, s[20:23], 0 offen offset:0
    buffer_load_dwordx4 v[98:101], v48, s[20:23], 0 offen offset:16
    buffer_load_dwordx4 v[102:105], v48, s[20:23], 0 offen offset:32
    buffer_load_dwordx4 v[106:109], v48, s[20:23], 0 offen offset:48
    buffer_load_dwordx4 v[50:53], v47, s[8:11], 0 offen offset:0
    buffer_load_dwordx4 v[54:57], v47, s[8:11], 0 offen offset:1280
    buffer_load_dwordx4 v[58:61], v47, s[8:11], 0 offen offset:2560
    v_lshrrev_b32 v2, 6, v0
    s_nop 0
    v_readfirstlane_b32 s54, v2
    v_and_b32 v1, 63, v0
    s_lshl_b32 s55, s2, 2
    s_add_u32 s55, s55, s54
    s_lshl_b32 s58, s55, 12
    v_lshl_add_u32 v4, v1, 4, s58
    v_subrev_u32 v49, 16, v4
    v_cmp_eq_u32 vcc, 0, v1
    v_mov_b32 v2, 2147483648
    s_nop 0
    v_cndmask_b32 v49, v49, v2, vcc
    s_lshl_b32 s55, s55, 1
    v_mul_u32_u24 v142, 2064, v44
    v_add_u32 v142, 132096, v142
    v_bfe_u32 v2, v45, 1, 1
    v_lshl_add_u32 v142, v2, 7, v142
    v_lshrrev_b32 v2, 2, v45
    v_lshl_add_u32 v142, v2, 4, v142
    v_and_b32 v2, 1, v45
    v_xor_b32 v2, 1, v2
    v_lshl_add_u32 v142, v2, 3, v142
    s_mul_i32 s58, s54, 2176
    s_add_u32 s58, s58, 150528
    v_mul_u32_u24 v24, 272, v44
    v_and_b32 v2, 7, v45
    v_lshl_add_u32 v24, v2, 4, v24
    v_add_u32 v24, s58, v24
    v_lshrrev_b32 v2, 4, v1
    v_and_b32 v3, 15, v1
    v_mul_u32_u24 v25, 272, v2
    v_lshl_add_u32 v25, v3, 4, v25
    v_add_u32 v25, s58, v25
    v_lshlrev_b32 v26, 15, v2
    v_lshl_add_u32 v26, v3, 4, v26
    v_lshrrev_b32 v2, 7, v0
    v_mul_u32_u24 v143, 2064, v2
    v_and_b32 v2, 127, v0
    v_lshl_add_u32 v143, v2, 4, v143
    v_add_u32 v143, 132096, v143
    v_lshlrev_b32 v144, 11, v45
    v_lshl_add_u32 v144, v44, 4, v144
    s_lshl_b32 s58, s52, 18
    s_lshl_b32 s59, s53, 7
    s_add_u32 s62, s58, s59
    s_add_u32 s62, s62, 1048576
    s_lshl_b32 s59, s53, 10
    s_add_u32 s66, s58, s59
    s_lshl_b32 s59, s54, 8
    s_add_u32 s66, s66, s59
    s_add_u32 s66, s66, 3670016
    s_add_u32 s63, s62, 65536
    s_add_u32 s67, s66, 131072
    s_add_u32 s64, s62, 131072
    s_add_u32 s68, s66, 16384
    s_add_u32 s65, s62, 196608
    s_add_u32 s69, s66, 147456
    s_mul_i32 s56, s54, 33024
    s_mul_i32 s57, s54, 4608
    s_add_u32 s57, s57, 132096
    v_lshrrev_b32 v145, 4, v1
    v_bfe_u32 v2, v1, 3, 1
    v_bfe_u32 v3, v1, 2, 1
    v_xor_b32 v3, v2, v3
    v_and_b32 v146, 3, v1
    v_lshl_add_u32 v146, v146, 1, v2
    v_mul_u32_u24 v6, 4128, v146
    v_lshl_add_u32 v6, v3, 4, v6
    v_lshl_add_u32 v146, v3, 3, v146
    v_and_b32 v2, 1, v145
    v_lshrrev_b32 v3, 1, v145
    v_lshl_add_u32 v147, v2, 1, v3
    v_mul_u32_u24 v7, 2304, v3
    v_and_b32 v3, 15, v1
    v_add_u32 v2, v2, v3
    v_lshl_add_u32 v7, v2, 4, v7
    s_add_u32 s59, s57, 16
    v_add_u32 v7, s59, v7
    v_sub_u32 v2, 3, v147
    v_lshl_add_u32 v6, v2, 4, v6
    v_add_u32 v6, s56, v6
    v_lshlrev_b32 v149, 3, v147
    v_sub_u32 v149, v149, v146
    v_subrev_u32 v149, 9, v149
    v_bfe_u32 v2, v1, 5, 1
    v_bfe_u32 v3, v1, 4, 1
    v_xor_b32 v3, v2, v3
    v_lshl_add_u32 v8, v2, 2, v3
    v_and_b32 v2, 1, v1
    v_lshl_add_u32 v8, v2, 1, v8
    v_bfe_u32 v2, v1, 1, 1
    v_and_b32 v3, 4, v1
    v_or_b32 v2, v2, v3
    v_xor_b32 v8, v2, v8
    v_bfe_u32 v2, v1, 1, 3
    v_lshl_add_u32 v8, v2, 3, v8
    v_lshl_add_u32 v8, v8, 4, s56
    v_lshl_add_u32 v148, v1, 4, s56
    v_lshlrev_b32 v9, 4, v0
    v_mul_u32_u24 v150, 2304, v145
    v_and_b32 v3, 15, v1
    v_lshl_add_u32 v150, v3, 4, v150
    v_add_u32 v150, s57, v150
    s_lshl_b32 s58, s52, 9
    s_add_u32 s58, s58, 229376
    s_and_b32 s59, s2, 3
    s_lshl_b32 s59, s59, 7
    s_add_u32 s59, s59, s58
    v_lshl_add_u32 v10, v3, 3, s59
    s_lshl_b32 s59, s54, 7
    s_add_u32 s58, s58, s59
    s_lshl_b32 s59, s53, 3
    s_add_u32 s61, s58, s59
    v_and_b32 v3, 7, v1
    v_mul_u32_u24 v3, 4128, v3
    v_add_u32 v3, s56, v3
    v_cmp_lt_u32 vcc, 31, v1
    s_nop 1
    v_cndmask_b32 v150, v150, v3, vcc
    s_waitcnt vmcnt(14)
    v_lshlrev_b32 v166, 16, v62
    v_and_b32 v167, s3, v62
    buffer_load_dwordx2 v[12:13], off, s[44:47], 0 sc1
    s_waitcnt vmcnt(14)
    v_lshlrev_b32 v168, 16, v66
    v_and_b32 v169, s3, v66
    s_waitcnt vmcnt(13)
    v_lshlrev_b32 v170, 16, v70
    v_and_b32 v171, s3, v70
    s_waitcnt vmcnt(12)
    v_lshlrev_b32 v172, 16, v74
    v_and_b32 v173, s3, v74
    s_waitcnt vmcnt(11)
    v_lshlrev_b32 v174, 16, v78
    v_and_b32 v175, s3, v78
    buffer_load_dwordx4 v[114:117], v4, s[24:27], 0 offen offset:0
    s_waitcnt vmcnt(11)
    v_lshlrev_b32 v176, 16, v82
    v_and_b32 v177, s3, v82
    s_waitcnt vmcnt(10)
    v_lshlrev_b32 v178, 16, v86
    v_and_b32 v179, s3, v86
    s_waitcnt vmcnt(9)
    v_lshlrev_b32 v180, 16, v90
    v_and_b32 v181, s3, v90
    s_waitcnt vmcnt(8)
    v_lshlrev_b32 v152, 16, v94
    v_and_b32 v154, s3, v94
    buffer_load_dwordx4 v[110:113], v49, s[24:27], 0 offen
    v_lshlrev_b32 v156, 16, v95
    v_and_b32 v158, s3, v95
    v_lshlrev_b32 v153, 16, v96
    v_and_b32 v155, s3, v96
    v_lshlrev_b32 v157, 16, v97
    v_and_b32 v159, s3, v97
    s_waitcnt vmcnt(5)
    v_lshlrev_b32 v160, 16, v50
    v_and_b32 v161, s3, v50
    buffer_load_dwordx4 v[122:125], v4, s[24:27], 0 offen offset:1024
    s_waitcnt vmcnt(5)
    v_lshlrev_b32 v162, 16, v54
    v_and_b32 v163, s3, v54
    s_waitcnt vmcnt(4)
    v_lshlrev_b32 v164, 16, v58
    v_and_b32 v165, s3, v58
    v_pk_mul_f32 v[182:183], v[160:161], v[158:159]
    v_pk_mul_f32 v[184:185], v[162:163], v[158:159]
    v_pk_mul_f32 v[186:187], v[164:165], v[158:159]
    v_pk_mul_f32 v[188:189], v[166:167], v[158:159]
    buffer_load_dwordx4 v[118:121], v4, s[24:27], 0 offen offset:1008
    v_pk_fma_f32 v[182:183], v[162:163], v[156:157], v[182:183]
    v_pk_fma_f32 v[184:185], v[164:165], v[156:157], v[184:185]
    v_pk_fma_f32 v[186:187], v[166:167], v[156:157], v[186:187]
    v_pk_fma_f32 v[188:189], v[168:169], v[156:157], v[188:189]
    v_pk_fma_f32 v[182:183], v[164:165], v[154:155], v[182:183]
    v_pk_fma_f32 v[184:185], v[166:167], v[154:155], v[184:185]
    v_pk_fma_f32 v[186:187], v[168:169], v[154:155], v[186:187]
    v_pk_fma_f32 v[188:189], v[170:171], v[154:155], v[188:189]
    buffer_load_dwordx4 v[130:133], v4, s[24:27], 0 offen offset:2048
    v_pk_fma_f32 v[182:183], v[166:167], v[152:153], v[182:183]
    v_pk_fma_f32 v[184:185], v[168:169], v[152:153], v[184:185]
    v_pk_fma_f32 v[186:187], v[170:171], v[152:153], v[186:187]
    v_pk_fma_f32 v[188:189], v[172:173], v[152:153], v[188:189]
    v_pk_mul_f32 v[182:183], v[182:183], v[174:175]
    v_pk_mul_f32 v[184:185], v[184:185], v[176:177]
    v_pk_mul_f32 v[186:187], v[186:187], v[178:179]
    v_pk_mul_f32 v[188:189], v[188:189], v[180:181]
    buffer_load_dwordx4 v[126:129], v4, s[24:27], 0 offen offset:2032
    v_cvt_pk_bf16_f32 v190, v188, v186
    v_cvt_pk_bf16_f32 v191, v184, v182
    ds_write_b64 v142, v[190:191] offset:0
    v_cvt_pk_bf16_f32 v192, v189, v187
    v_cvt_pk_bf16_f32 v193, v185, v183
    ds_write_b64 v142, v[192:193] offset:256
    v_lshlrev_b32 v166, 16, v63
    v_and_b32 v167, s3, v63
    buffer_load_dwordx4 v[138:141], v4, s[24:27], 0 offen offset:3072
    v_lshlrev_b32 v168, 16, v67
    v_and_b32 v169, s3, v67
    v_lshlrev_b32 v170, 16, v71
    v_and_b32 v171, s3, v71
    v_lshlrev_b32 v172, 16, v75
    v_and_b32 v173, s3, v75
    v_lshlrev_b32 v174, 16, v79
    v_and_b32 v175, s3, v79
    buffer_load_dwordx4 v[134:137], v4, s[24:27], 0 offen offset:3056
    v_lshlrev_b32 v176, 16, v83
    v_and_b32 v177, s3, v83
    v_lshlrev_b32 v178, 16, v87
    v_and_b32 v179, s3, v87
    v_lshlrev_b32 v180, 16, v91
    v_and_b32 v181, s3, v91
    v_lshlrev_b32 v152, 16, v98
    v_and_b32 v154, s3, v98
    buffer_load_ushort v5, off, s[28:31], s55
    v_lshlrev_b32 v156, 16, v99
    v_and_b32 v158, s3, v99
    v_lshlrev_b32 v153, 16, v100
    v_and_b32 v155, s3, v100
    v_lshlrev_b32 v157, 16, v101
    v_and_b32 v159, s3, v101
    v_lshlrev_b32 v160, 16, v51
    v_and_b32 v161, s3, v51
    buffer_load_dwordx4 v[28:31], v46, s[16:19], 0 offen offset:0
    v_lshlrev_b32 v162, 16, v55
    v_and_b32 v163, s3, v55
    v_lshlrev_b32 v164, 16, v59
    v_and_b32 v165, s3, v59
    v_pk_mul_f32 v[182:183], v[160:161], v[158:159]
    v_pk_mul_f32 v[184:185], v[162:163], v[158:159]
    v_pk_mul_f32 v[186:187], v[164:165], v[158:159]
    v_pk_mul_f32 v[188:189], v[166:167], v[158:159]
    buffer_load_dwordx4 v[32:35], v46, s[16:19], 0 offen offset:1280
    v_pk_fma_f32 v[182:183], v[162:163], v[156:157], v[182:183]
    v_pk_fma_f32 v[184:185], v[164:165], v[156:157], v[184:185]
    v_pk_fma_f32 v[186:187], v[166:167], v[156:157], v[186:187]
    v_pk_fma_f32 v[188:189], v[168:169], v[156:157], v[188:189]
    v_pk_fma_f32 v[182:183], v[164:165], v[154:155], v[182:183]
    v_pk_fma_f32 v[184:185], v[166:167], v[154:155], v[184:185]
    v_pk_fma_f32 v[186:187], v[168:169], v[154:155], v[186:187]
    v_pk_fma_f32 v[188:189], v[170:171], v[154:155], v[188:189]
    buffer_load_dwordx4 v[36:39], v46, s[16:19], 0 offen offset:2560
    v_pk_fma_f32 v[182:183], v[166:167], v[152:153], v[182:183]
    v_pk_fma_f32 v[184:185], v[168:169], v[152:153], v[184:185]
    v_pk_fma_f32 v[186:187], v[170:171], v[152:153], v[186:187]
    v_pk_fma_f32 v[188:189], v[172:173], v[152:153], v[188:189]
    v_pk_mul_f32 v[182:183], v[182:183], v[174:175]
    v_pk_mul_f32 v[184:185], v[184:185], v[176:177]
    v_pk_mul_f32 v[186:187], v[186:187], v[178:179]
    v_pk_mul_f32 v[188:189], v[188:189], v[180:181]
    buffer_load_dwordx4 v[40:43], v46, s[16:19], 0 offen offset:3840
    v_cvt_pk_bf16_f32 v190, v188, v186
    v_cvt_pk_bf16_f32 v191, v184, v182
    ds_write_b64 v142, v[190:191] offset:512
    v_cvt_pk_bf16_f32 v192, v189, v187
    v_cvt_pk_bf16_f32 v193, v185, v183
    ds_write_b64 v142, v[192:193] offset:768
    v_lshlrev_b32 v166, 16, v64
    v_and_b32 v167, s3, v64
    v_lshlrev_b32 v168, 16, v68
    v_and_b32 v169, s3, v68
    v_lshlrev_b32 v170, 16, v72
    v_and_b32 v171, s3, v72
    v_lshlrev_b32 v172, 16, v76
    v_and_b32 v173, s3, v76
    v_lshlrev_b32 v174, 16, v80
    v_and_b32 v175, s3, v80
    v_lshlrev_b32 v176, 16, v84
    v_and_b32 v177, s3, v84
    v_lshlrev_b32 v178, 16, v88
    v_and_b32 v179, s3, v88
    v_lshlrev_b32 v180, 16, v92
    v_and_b32 v181, s3, v92
    v_lshlrev_b32 v152, 16, v102
    v_and_b32 v154, s3, v102
    v_lshlrev_b32 v156, 16, v103
    v_and_b32 v158, s3, v103
    v_lshlrev_b32 v153, 16, v104
    v_and_b32 v155, s3, v104
    v_lshlrev_b32 v157, 16, v105
    v_and_b32 v159, s3, v105
    v_lshlrev_b32 v160, 16, v52
    v_and_b32 v161, s3, v52
    v_lshlrev_b32 v162, 16, v56
    v_and_b32 v163, s3, v56
    v_lshlrev_b32 v164, 16, v60
    v_and_b32 v165, s3, v60
    v_pk_mul_f32 v[182:183], v[160:161], v[158:159]
    v_pk_mul_f32 v[184:185], v[162:163], v[158:159]
    v_pk_mul_f32 v[186:187], v[164:165], v[158:159]
    v_pk_mul_f32 v[188:189], v[166:167], v[158:159]
    v_pk_fma_f32 v[182:183], v[162:163], v[156:157], v[182:183]
    v_pk_fma_f32 v[184:185], v[164:165], v[156:157], v[184:185]
    v_pk_fma_f32 v[186:187], v[166:167], v[156:157], v[186:187]
    v_pk_fma_f32 v[188:189], v[168:169], v[156:157], v[188:189]
    v_pk_fma_f32 v[182:183], v[164:165], v[154:155], v[182:183]
    v_pk_fma_f32 v[184:185], v[166:167], v[154:155], v[184:185]
    v_pk_fma_f32 v[186:187], v[168:169], v[154:155], v[186:187]
    v_pk_fma_f32 v[188:189], v[170:171], v[154:155], v[188:189]
    v_pk_fma_f32 v[182:183], v[166:167], v[152:153], v[182:183]
    v_pk_fma_f32 v[184:185], v[168:169], v[152:153], v[184:185]
    v_pk_fma_f32 v[186:187], v[170:171], v[152:153], v[186:187]
    v_pk_fma_f32 v[188:189], v[172:173], v[152:153], v[188:189]
    v_pk_mul_f32 v[182:183], v[182:183], v[174:175]
    v_pk_mul_f32 v[184:185], v[184:185], v[176:177]
    v_pk_mul_f32 v[186:187], v[186:187], v[178:179]
    v_pk_mul_f32 v[188:189], v[188:189], v[180:181]
    v_cvt_pk_bf16_f32 v190, v188, v186
    v_cvt_pk_bf16_f32 v191, v184, v182
    ds_write_b64 v142, v[190:191] offset:1024
    v_cvt_pk_bf16_f32 v192, v189, v187
    v_cvt_pk_bf16_f32 v193, v185, v183
    ds_write_b64 v142, v[192:193] offset:1280
    v_lshlrev_b32 v166, 16, v65
    v_and_b32 v167, s3, v65
    v_lshlrev_b32 v168, 16, v69
    v_and_b32 v169, s3, v69
    v_lshlrev_b32 v170, 16, v73
    v_and_b32 v171, s3, v73
    v_lshlrev_b32 v172, 16, v77
    v_and_b32 v173, s3, v77
    v_lshlrev_b32 v174, 16, v81
    v_and_b32 v175, s3, v81
    v_lshlrev_b32 v176, 16, v85
    v_and_b32 v177, s3, v85
    v_lshlrev_b32 v178, 16, v89
    v_and_b32 v179, s3, v89
    v_lshlrev_b32 v180, 16, v93
    v_and_b32 v181, s3, v93
    v_lshlrev_b32 v152, 16, v106
    v_and_b32 v154, s3, v106
    v_lshlrev_b32 v156, 16, v107
    v_and_b32 v158, s3, v107
    v_lshlrev_b32 v153, 16, v108
    v_and_b32 v155, s3, v108
    v_lshlrev_b32 v157, 16, v109
    v_and_b32 v159, s3, v109
    v_lshlrev_b32 v160, 16, v53
    v_and_b32 v161, s3, v53
    v_lshlrev_b32 v162, 16, v57
    v_and_b32 v163, s3, v57
    v_lshlrev_b32 v164, 16, v61
    v_and_b32 v165, s3, v61
    v_pk_mul_f32 v[182:183], v[160:161], v[158:159]
    v_pk_mul_f32 v[184:185], v[162:163], v[158:159]
    v_pk_mul_f32 v[186:187], v[164:165], v[158:159]
    v_pk_mul_f32 v[188:189], v[166:167], v[158:159]
    v_pk_fma_f32 v[182:183], v[162:163], v[156:157], v[182:183]
    v_pk_fma_f32 v[184:185], v[164:165], v[156:157], v[184:185]
    v_pk_fma_f32 v[186:187], v[166:167], v[156:157], v[186:187]
    v_pk_fma_f32 v[188:189], v[168:169], v[156:157], v[188:189]
    v_pk_fma_f32 v[182:183], v[164:165], v[154:155], v[182:183]
    v_pk_fma_f32 v[184:185], v[166:167], v[154:155], v[184:185]
    v_pk_fma_f32 v[186:187], v[168:169], v[154:155], v[186:187]
    v_pk_fma_f32 v[188:189], v[170:171], v[154:155], v[188:189]
    v_pk_fma_f32 v[182:183], v[166:167], v[152:153], v[182:183]
    v_pk_fma_f32 v[184:185], v[168:169], v[152:153], v[184:185]
    v_pk_fma_f32 v[186:187], v[170:171], v[152:153], v[186:187]
    v_pk_fma_f32 v[188:189], v[172:173], v[152:153], v[188:189]
    v_pk_mul_f32 v[182:183], v[182:183], v[174:175]
    v_pk_mul_f32 v[184:185], v[184:185], v[176:177]
    v_pk_mul_f32 v[186:187], v[186:187], v[178:179]
    v_pk_mul_f32 v[188:189], v[188:189], v[180:181]
    v_cvt_pk_bf16_f32 v190, v188, v186
    v_cvt_pk_bf16_f32 v191, v184, v182
    ds_write_b64 v142, v[190:191] offset:1536
    v_cvt_pk_bf16_f32 v192, v189, v187
    v_cvt_pk_bf16_f32 v193, v185, v183
    ds_write_b64 v142, v[192:193] offset:1792
    s_waitcnt lgkmcnt(0)
    s_barrier
    ds_read_b128 v[50:53], v143 offset:0
    ds_read_b128 v[54:57], v143 offset:4128
    ds_read_b128 v[58:61], v143 offset:8256
    ds_read_b128 v[62:65], v143 offset:12384
    s_waitcnt lgkmcnt(3)
    buffer_store_dwordx4 v[50:53], v144, s[4:7], s62 offen sc1
    s_waitcnt lgkmcnt(2)
    buffer_store_dwordx4 v[54:57], v144, s[4:7], s63 offen sc1
    s_waitcnt lgkmcnt(1)
    buffer_store_dwordx4 v[58:61], v144, s[4:7], s64 offen sc1
    s_waitcnt lgkmcnt(0)
    buffer_store_dwordx4 v[62:65], v144, s[4:7], s65 offen sc1
    s_mov_b32 s49, 65536
L_ka_tagpoll_6:
    s_waitcnt vmcnt(17)
    v_readfirstlane_b32 s48, v12
    s_nop 0
    s_cmp_lg_u32 s48, 0
    s_cbranch_scc1 L_ka_taggot_7
    buffer_load_dwordx2 v[12:13], off, s[44:47], 0 sc1
    s_waitcnt vmcnt(0)
    s_sub_u32 s49, s49, 1
    s_cmp_lg_u32 s49, 0
    s_cbranch_scc1 L_ka_tagpoll_6
L_ka_taggot_7:
    s_waitcnt vmcnt(15)
    ds_write_b128 v148, v[112:115] offset:12400
    v_alignbit_b32 v152, v111, v110, 16
    v_alignbit_b32 v153, v112, v111, 16
    v_alignbit_b32 v154, v113, v112, 16
    v_alignbit_b32 v155, v114, v113, 16
    v_alignbit_b32 v156, v115, v114, 16
    v_alignbit_b32 v157, v116, v115, 16
    ds_write_b128 v148, v[114:117] offset:28912
    ds_write_b128 v148, v[152:155] offset:16
    v_mov_b32 v166, v111
    v_mov_b32 v167, v112
    v_mov_b32 v168, v113
    v_mov_b32 v169, v114
    v_mov_b32 v170, v115
    v_mov_b32 v171, v116
    ds_write_b128 v148, v[154:157] offset:16528
    ds_write_b128 v148, v[166:169] offset:4144
    v_alignbit_b32 v160, v112, v111, 16
    v_alignbit_b32 v161, v113, v112, 16
    v_alignbit_b32 v162, v114, v113, 16
    v_alignbit_b32 v163, v115, v114, 16
    v_alignbit_b32 v164, v116, v115, 16
    v_alignbit_b32 v165, v117, v116, 16
    ds_write_b128 v148, v[168:171] offset:20656
    ds_write_b128 v148, v[160:163] offset:8272
    ds_write_b128 v148, v[162:165] offset:24784
    s_waitcnt vmcnt(13)
    ds_write_b128 v148, v[120:123] offset:13424
    v_alignbit_b32 v152, v119, v118, 16
    v_alignbit_b32 v153, v120, v119, 16
    v_alignbit_b32 v154, v121, v120, 16
    v_alignbit_b32 v155, v122, v121, 16
    v_alignbit_b32 v156, v123, v122, 16
    v_alignbit_b32 v157, v124, v123, 16
    ds_write_b128 v148, v[122:125] offset:29936
    ds_write_b128 v148, v[152:155] offset:1040
    v_mov_b32 v166, v119
    v_mov_b32 v167, v120
    v_mov_b32 v168, v121
    v_mov_b32 v169, v122
    v_mov_b32 v170, v123
    v_mov_b32 v171, v124
    ds_write_b128 v148, v[154:157] offset:17552
    ds_write_b128 v148, v[166:169] offset:5168
    v_alignbit_b32 v160, v120, v119, 16
    v_alignbit_b32 v161, v121, v120, 16
    v_alignbit_b32 v162, v122, v121, 16
    v_alignbit_b32 v163, v123, v122, 16
    v_alignbit_b32 v164, v124, v123, 16
    v_alignbit_b32 v165, v125, v124, 16
    ds_write_b128 v148, v[168:171] offset:21680
    ds_write_b128 v148, v[160:163] offset:9296
    ds_write_b128 v148, v[162:165] offset:25808
    s_waitcnt vmcnt(0)
    s_mov_b64 exec, 1
    buffer_store_dwordx2 v[12:13], off, s[4:7], s61 sc1
    s_mov_b64 exec, -1
    ds_write_b128 v148, v[128:131] offset:14448
    v_alignbit_b32 v152, v127, v126, 16
    v_alignbit_b32 v153, v128, v127, 16
    v_alignbit_b32 v154, v129, v128, 16
    v_alignbit_b32 v155, v130, v129, 16
    v_alignbit_b32 v156, v131, v130, 16
    v_alignbit_b32 v157, v132, v131, 16
    ds_write_b128 v148, v[130:133] offset:30960
    ds_write_b128 v148, v[152:155] offset:2064
    v_mov_b32 v166, v127
    v_mov_b32 v167, v128
    v_mov_b32 v168, v129
    v_mov_b32 v169, v130
    v_mov_b32 v170, v131
    v_mov_b32 v171, v132
    ds_write_b128 v148, v[154:157] offset:18576
    ds_write_b128 v148, v[166:169] offset:6192
    v_alignbit_b32 v160, v128, v127, 16
    v_alignbit_b32 v161, v129, v128, 16
    v_alignbit_b32 v162, v130, v129, 16
    v_alignbit_b32 v163, v131, v130, 16
    v_alignbit_b32 v164, v132, v131, 16
    v_alignbit_b32 v165, v133, v132, 16
    ds_write_b128 v148, v[168:171] offset:22704
    ds_write_b128 v148, v[160:163] offset:10320
    ds_write_b128 v148, v[162:165] offset:26832
    ds_write_b128 v148, v[136:139] offset:15472
    v_alignbit_b32 v152, v135, v134, 16
    v_alignbit_b32 v153, v136, v135, 16
    v_alignbit_b32 v154, v137, v136, 16
    v_alignbit_b32 v155, v138, v137, 16
    v_alignbit_b32 v156, v139, v138, 16
    v_alignbit_b32 v157, v140, v139, 16
    ds_write_b128 v148, v[138:141] offset:31984
    ds_write_b128 v148, v[152:155] offset:3088
    v_mov_b32 v166, v135
    v_mov_b32 v167, v136
    v_mov_b32 v168, v137
    v_mov_b32 v169, v138
    v_mov_b32 v170, v139
    v_mov_b32 v171, v140
    ds_write_b128 v148, v[154:157] offset:19600
    ds_write_b128 v148, v[166:169] offset:7216
    v_alignbit_b32 v160, v136, v135, 16
    v_alignbit_b32 v161, v137, v136, 16
    v_alignbit_b32 v162, v138, v137, 16
    v_alignbit_b32 v163, v139, v138, 16
    v_alignbit_b32 v164, v140, v139, 16
    v_alignbit_b32 v165, v141, v140, 16
    ds_write_b128 v148, v[168:171] offset:23728
    ds_write_b128 v148, v[160:163] offset:11344
    ds_write_b128 v148, v[162:165] offset:27856
    buffer_load_dwordx2 v[14:15], v10, s[4:7], 0 offen sc1
    v_mov_b32 v174, 0
    v_mov_b32 v175, 0
    v_mov_b32 v176, 0
    v_mov_b32 v177, 0
    s_barrier
    ds_write_b128 v150, v[174:177]
    v_and_b32 v3, 1, v149
    v_lshlrev_b32 v3, 4, v3
    v_lshlrev_b32 v5, v3, v5
    v_ashrrev_i32 v149, 1, v149
    v_cmp_eq_u32 vcc, 0, v149
    s_nop 1
    v_cndmask_b32 v20, 0, v5, vcc
    v_cmp_eq_u32 vcc, 1, v149
    s_nop 1
    v_cndmask_b32 v21, 0, v5, vcc
    v_cmp_eq_u32 vcc, 2, v149
    s_nop 1
    v_cndmask_b32 v22, 0, v5, vcc
    v_cmp_eq_u32 vcc, 3, v149
    s_nop 1
    v_cndmask_b32 v23, 0, v5, vcc
    ds_read_b128 v[72:75], v6 offset:3584
    ds_read_b128 v[68:71], v6 offset:3072
    ds_read_b128 v[64:67], v6 offset:2560
    ds_read_b128 v[60:63], v6 offset:2048
    ds_read_b128 v[56:59], v6 offset:1536
    ds_read_b128 v[52:55], v6 offset:1024
    ds_read_b128 v[48:51], v6 offset:512
    ds_read_b128 v[44:47], v6 offset:0
    s_mov_b32 s49, 65536
L_ka_poll_8:
    s_waitcnt vmcnt(0)
    v_cmp_ne_u32 vcc, s48, v15
    s_nop 0
    s_cbranch_vccz L_ka_got_9
    buffer_load_dwordx2 v[14:15], v10, s[4:7], 0 offen sc1
    s_waitcnt vmcnt(0)
    s_sub_u32 s49, s49, 1
    s_cmp_lg_u32 s49, 0
    s_cbranch_scc1 L_ka_poll_8
L_ka_got_9:
    s_mov_b32 s59, 1048576
    s_add_u32 m0, s57, 256
    s_nop 0
    buffer_load_dwordx4 v4, s[4:7], s59 offen offset:0 sc1 lds
    buffer_load_dwordx4 v4, s[4:7], s59 offen offset:1024 sc1 lds
    s_add_u32 m0, s57, 512
    s_nop 0
    buffer_load_dwordx4 v4, s[4:7], s59 offen offset:2048 sc1 lds
    buffer_load_dwordx4 v4, s[4:7], s59 offen offset:3072 sc1 lds
    ds_write2_b64 v24, v[28:29], v[36:37] offset0:0 offset1:1
    ds_write2_b64 v24, v[32:33], v[40:41] offset0:16 offset1:17
    ds_read_b128 v[172:175], v25 offset:0
    ds_read_b128 v[176:179], v25 offset:1088
    ds_write2_b64 v24, v[30:31], v[38:39] offset0:0 offset1:1
    ds_write2_b64 v24, v[34:35], v[42:43] offset0:16 offset1:17
    ds_read_b128 v[180:183], v25 offset:0
    ds_read_b128 v[184:187], v25 offset:1088
    s_waitcnt lgkmcnt(5)
    buffer_store_dwordx4 v[172:175], v26, s[4:7], s66 offen sc1
    s_waitcnt lgkmcnt(4)
    buffer_store_dwordx4 v[176:179], v26, s[4:7], s67 offen sc1
    s_waitcnt lgkmcnt(1)
    buffer_store_dwordx4 v[180:183], v26, s[4:7], s68 offen sc1
    s_waitcnt lgkmcnt(0)
    buffer_store_dwordx4 v[184:187], v26, s[4:7], s69 offen sc1
    s_lshl_b32 s59, s2, 14
    s_add_u32 s66, s59, 3670016
    s_add_u32 s62, s59, 6291456
    s_add_u32 s67, s59, 3674112
    s_add_u32 s63, s59, 6295552
    s_add_u32 s68, s59, 3678208
    s_add_u32 s64, s59, 6299648
    s_add_u32 s69, s59, 3682304
    s_add_u32 s65, s59, 6303744
    s_lshl_b32 s61, s2, 2
    s_add_u32 s61, s61, s54
    s_lshl_b32 s61, s61, 3
    s_add_u32 s61, s61, 241664
    s_lshl_b32 s59, s52, 9
    s_add_u32 s59, s59, 241664
    v_lshl_add_u32 v27, v1, 3, s59
    v_bfe_u32 v2, v1, 2, 3
    v_min_u32 v2, 2, v2
    v_mul_u32_u24 v2, 5120, v2
    v_and_b32 v3, 3, v1
    v_lshl_add_u32 v2, v3, 3, v2
    s_lshl_b32 s59, s2, 5
    s_add_u32 s59, s59, 32768
    v_add_u32 v2, s59, v2
    v_lshlrev_b32 v10, 3, v1
    v_add_u32 v10, 237568, v10
    v_cmp_gt_u32 vcc, 32, v1
    s_nop 1
    v_cndmask_b32 v10, v2, v10, vcc
    v_bfe_u32 v2, v0, 4, 1
    v_bfe_u32 v3, v0, 5, 1
    v_lshl_add_u32 v2, v3, 2, v2
    v_lshlrev_b32 v2, 1, v2
    v_xor_b32 v2, v0, v2
    v_lshlrev_b32 v228, 3, v2
    v_add_u32 v229, 66048, v228
    s_lshr_b32 s58, s2, 3
    s_min_u32 s58, s58, 15
    s_lshl_b32 s58, s58, 17
    s_and_b32 s59, s2, 6
    s_lshl_b32 s59, s59, 20
    s_add_u32 s58, s58, s59
    v_lshlrev_b32 v230, 7, v0
    s_waitcnt vmcnt(4)
    ds_read_b128 v[76:79], v7 offset:224
    ds_read_b128 v[80:83], v7 offset:480
    ds_read_b128 v[84:87], v7 offset:736
    ds_read_b128 v[88:91], v7 offset:992
    ds_read_b128 v[92:95], v7 offset:1248
    ds_read_b128 v[96:99], v7 offset:1504
    ds_read_b128 v[100:103], v7 offset:1760
    ds_read_b128 v[104:107], v7 offset:2016
    s_waitcnt lgkmcnt(7)
    v_mfma_f32_16x16x32_bf16 v[140:143], v[20:23], v[76:79], 0
    s_waitcnt lgkmcnt(6)
    v_mfma_f32_16x16x32_bf16 v[144:147], v[20:23], v[80:83], 0
    s_waitcnt lgkmcnt(5)
    v_mfma_f32_16x16x32_bf16 v[148:151], v[20:23], v[84:87], 0
    s_waitcnt lgkmcnt(4)
    v_mfma_f32_16x16x32_bf16 v[152:155], v[20:23], v[88:91], 0
    s_waitcnt lgkmcnt(3)
    v_mfma_f32_16x16x32_bf16 v[156:159], v[20:23], v[92:95], 0
    s_waitcnt lgkmcnt(2)
    v_mfma_f32_16x16x32_bf16 v[160:163], v[20:23], v[96:99], 0
    s_waitcnt lgkmcnt(1)
    v_mfma_f32_16x16x32_bf16 v[164:167], v[20:23], v[100:103], 0
    s_waitcnt lgkmcnt(0)
    v_mfma_f32_16x16x32_bf16 v[168:171], v[20:23], v[104:107], 0
    v_mfma_f32_16x16x32_bf16 v[168:171], v[72:75], v[76:79], v[168:171]
    ds_read_b128 v[72:75], v6 offset:3648
    s_mul_i32 s76, s2, 52429
    s_lshr_b32 s76, s76, 18
    s_mul_i32 s77, s76, 43691
    s_lshr_b32 s77, s77, 17
    s_mul_i32 s77, s77, 12
    s_lshl_b32 s78, s76, 5
    s_add_u32 s77, s77, s78
    s_lshl_b32 s78, s54, 3
    s_add_u32 s77, s77, s78
    s_mul_i32 s78, s76, 216
    s_lshl_b32 s79, s54, 2
    s_add_u32 s78, s78, s79
    s_sub_u32 s78, s78, 5088
    s_cmp_eq_u32 s54, 3
    s_cselect_b32 s78, 864, s78
    s_cmp_ge_u32 s76, 24
    s_cselect_b32 s70, s78, s77
    s_cselect_b32 s71, 133120, 0
    s_add_u32 s71, s71, 5120
    s_mul_i32 s70, s70, 1280
    s_mul_i32 s77, s76, 5
    s_sub_u32 s77, s2, s77
    s_lshl_b32 s77, s77, 6
    v_add_u32 v196, s77, v1
    v_mfma_f32_16x16x32_bf16 v[164:167], v[68:71], v[76:79], v[164:167]
    v_lshlrev_b32 v197, 2, v196
    buffer_load_dword v200, v197, s[36:39], s70 offen offset:0
    v_mfma_f32_16x16x32_bf16 v[168:171], v[68:71], v[80:83], v[168:171]
    ds_read_b128 v[68:71], v6 offset:3136
    buffer_load_dword v201, v197, s[36:39], s70 offen offset:1280
    v_mfma_f32_16x16x32_bf16 v[160:163], v[64:67], v[76:79], v[160:163]
    buffer_load_dword v202, v197, s[36:39], s70 offen offset:2560
    buffer_load_dword v203, v197, s[36:39], s70 offen offset:3840
    v_mfma_f32_16x16x32_bf16 v[164:167], v[64:67], v[80:83], v[164:167]
    ds_read_b128 v[108:111], v7 offset:192
    s_add_u32 s70, s70, s71
    buffer_load_dword v204, v197, s[36:39], s70 offen offset:0
    v_mfma_f32_16x16x32_bf16 v[168:171], v[64:67], v[84:87], v[168:171]
    ds_read_b128 v[64:67], v6 offset:2624
    buffer_load_dword v205, v197, s[36:39], s70 offen offset:1280
    v_mfma_f32_16x16x32_bf16 v[156:159], v[60:63], v[76:79], v[156:159]
    buffer_load_dword v206, v197, s[36:39], s70 offen offset:2560
    buffer_load_dword v207, v197, s[36:39], s70 offen offset:3840
    v_mfma_f32_16x16x32_bf16 v[160:163], v[60:63], v[80:83], v[160:163]
    v_mfma_f32_16x16x32_bf16 v[164:167], v[60:63], v[84:87], v[164:167]
    ds_read_b128 v[112:115], v7 offset:448
    v_mfma_f32_16x16x32_bf16 v[168:171], v[60:63], v[88:91], v[168:171]
    ds_read_b128 v[60:63], v6 offset:2112
    v_mfma_f32_16x16x32_bf16 v[152:155], v[56:59], v[76:79], v[152:155]
    v_mfma_f32_16x16x32_bf16 v[156:159], v[56:59], v[80:83], v[156:159]
    v_mfma_f32_16x16x32_bf16 v[160:163], v[56:59], v[84:87], v[160:163]
    ds_read_b128 v[116:119], v7 offset:704
    v_mfma_f32_16x16x32_bf16 v[164:167], v[56:59], v[88:91], v[164:167]
    v_mfma_f32_16x16x32_bf16 v[168:171], v[56:59], v[92:95], v[168:171]
    ds_read_b128 v[56:59], v6 offset:1600
    v_mfma_f32_16x16x32_bf16 v[148:151], v[52:55], v[76:79], v[148:151]
    v_mfma_f32_16x16x32_bf16 v[152:155], v[52:55], v[80:83], v[152:155]
    ds_read_b128 v[120:123], v7 offset:960
    v_mfma_f32_16x16x32_bf16 v[156:159], v[52:55], v[84:87], v[156:159]
    v_mfma_f32_16x16x32_bf16 v[160:163], v[52:55], v[88:91], v[160:163]
    v_mfma_f32_16x16x32_bf16 v[164:167], v[52:55], v[92:95], v[164:167]
    ds_read_b128 v[124:127], v7 offset:1216
    v_mfma_f32_16x16x32_bf16 v[168:171], v[52:55], v[96:99], v[168:171]
    ds_read_b128 v[52:55], v6 offset:1088
    v_mfma_f32_16x16x32_bf16 v[144:147], v[48:51], v[76:79], v[144:147]
    v_mfma_f32_16x16x32_bf16 v[148:151], v[48:51], v[80:83], v[148:151]
    v_mfma_f32_16x16x32_bf16 v[152:155], v[48:51], v[84:87], v[152:155]
    ds_read_b128 v[128:131], v7 offset:1472
    v_mfma_f32_16x16x32_bf16 v[156:159], v[48:51], v[88:91], v[156:159]
    v_mfma_f32_16x16x32_bf16 v[160:163], v[48:51], v[92:95], v[160:163]
    v_mfma_f32_16x16x32_bf16 v[164:167], v[48:51], v[96:99], v[164:167]
    ds_read_b128 v[132:135], v7 offset:1728
    v_mfma_f32_16x16x32_bf16 v[168:171], v[48:51], v[100:103], v[168:171]
    ds_read_b128 v[48:51], v6 offset:576
    v_mfma_f32_16x16x32_bf16 v[140:143], v[44:47], v[76:79], v[140:143]
    v_mfma_f32_16x16x32_bf16 v[144:147], v[44:47], v[80:83], v[144:147]
    v_mfma_f32_16x16x32_bf16 v[148:151], v[44:47], v[84:87], v[148:151]
    ds_read_b128 v[136:139], v7 offset:1984
    v_mfma_f32_16x16x32_bf16 v[152:155], v[44:47], v[88:91], v[152:155]
    v_mfma_f32_16x16x32_bf16 v[156:159], v[44:47], v[92:95], v[156:159]
    v_mfma_f32_16x16x32_bf16 v[160:163], v[44:47], v[96:99], v[160:163]
    v_mfma_f32_16x16x32_bf16 v[164:167], v[44:47], v[100:103], v[164:167]
    v_mfma_f32_16x16x32_bf16 v[168:171], v[44:47], v[104:107], v[168:171]
    ds_read_b128 v[44:47], v6 offset:64
    s_waitcnt vmcnt(8)
    s_mov_b64 exec, 1
    buffer_store_dwordx2 v[12:13], off, s[4:7], s61 sc1
    s_mov_b64 exec, -1
    s_waitcnt lgkmcnt(13)
    v_mfma_f32_16x16x32_bf16 v[168:171], v[72:75], v[108:111], v[168:171]
    ds_read_b128 v[72:75], v6 offset:3712
    v_mfma_f32_16x16x32_bf16 v[164:167], v[68:71], v[108:111], v[164:167]
    s_waitcnt lgkmcnt(12)
    v_mfma_f32_16x16x32_bf16 v[168:171], v[68:71], v[112:115], v[168:171]
    ds_read_b128 v[68:71], v6 offset:3200
    v_mfma_f32_16x16x32_bf16 v[160:163], v[64:67], v[108:111], v[160:163]
    v_mfma_f32_16x16x32_bf16 v[164:167], v[64:67], v[112:115], v[164:167]
    ds_read_b128 v[76:79], v7 offset:160
    s_waitcnt lgkmcnt(12)
    v_mfma_f32_16x16x32_bf16 v[168:171], v[64:67], v[116:119], v[168:171]
    ds_read_b128 v[64:67], v6 offset:2688
    v_mfma_f32_16x16x32_bf16 v[156:159], v[60:63], v[108:111], v[156:159]
    v_mfma_f32_16x16x32_bf16 v[160:163], v[60:63], v[112:115], v[160:163]
    v_mfma_f32_16x16x32_bf16 v[164:167], v[60:63], v[116:119], v[164:167]
    ds_read_b128 v[80:83], v7 offset:416
    s_waitcnt lgkmcnt(12)
    v_mfma_f32_16x16x32_bf16 v[168:171], v[60:63], v[120:123], v[168:171]
    ds_read_b128 v[60:63], v6 offset:2176
    v_mfma_f32_16x16x32_bf16 v[152:155], v[56:59], v[108:111], v[152:155]
    v_mfma_f32_16x16x32_bf16 v[156:159], v[56:59], v[112:115], v[156:159]
    v_mfma_f32_16x16x32_bf16 v[160:163], v[56:59], v[116:119], v[160:163]
    ds_read_b128 v[84:87], v7 offset:672
    v_mfma_f32_16x16x32_bf16 v[164:167], v[56:59], v[120:123], v[164:167]
    s_waitcnt lgkmcnt(13)
    v_mfma_f32_16x16x32_bf16 v[168:171], v[56:59], v[124:127], v[168:171]
    ds_read_b128 v[56:59], v6 offset:1664
    s_waitcnt lgkmcnt(13)
    v_mfma_f32_16x16x32_bf16 v[148:151], v[52:55], v[108:111], v[148:151]
    v_mfma_f32_16x16x32_bf16 v[152:155], v[52:55], v[112:115], v[152:155]
    ds_read_b128 v[88:91], v7 offset:928
    v_mfma_f32_16x16x32_bf16 v[156:159], v[52:55], v[116:119], v[156:159]
    v_mfma_f32_16x16x32_bf16 v[160:163], v[52:55], v[120:123], v[160:163]
    v_mfma_f32_16x16x32_bf16 v[164:167], v[52:55], v[124:127], v[164:167]
    ds_read_b128 v[92:95], v7 offset:1184
    s_waitcnt lgkmcnt(14)
    v_mfma_f32_16x16x32_bf16 v[168:171], v[52:55], v[128:131], v[168:171]
    ds_read_b128 v[52:55], v6 offset:1152
    s_waitcnt lgkmcnt(13)
    v_mfma_f32_16x16x32_bf16 v[144:147], v[48:51], v[108:111], v[144:147]
    v_mfma_f32_16x16x32_bf16 v[148:151], v[48:51], v[112:115], v[148:151]
    v_mfma_f32_16x16x32_bf16 v[152:155], v[48:51], v[116:119], v[152:155]
    ds_read_b128 v[96:99], v7 offset:1440
    v_mfma_f32_16x16x32_bf16 v[156:159], v[48:51], v[120:123], v[156:159]
    v_mfma_f32_16x16x32_bf16 v[160:163], v[48:51], v[124:127], v[160:163]
    v_mfma_f32_16x16x32_bf16 v[164:167], v[48:51], v[128:131], v[164:167]
    ds_read_b128 v[100:103], v7 offset:1696
    v_mfma_f32_16x16x32_bf16 v[168:171], v[48:51], v[132:135], v[168:171]
    ds_read_b128 v[48:51], v6 offset:640
    s_waitcnt lgkmcnt(14)
    v_mfma_f32_16x16x32_bf16 v[140:143], v[44:47], v[108:111], v[140:143]
    v_mfma_f32_16x16x32_bf16 v[144:147], v[44:47], v[112:115], v[144:147]
    v_mfma_f32_16x16x32_bf16 v[148:151], v[44:47], v[116:119], v[148:151]
    ds_read_b128 v[104:107], v7 offset:1952
    v_mfma_f32_16x16x32_bf16 v[152:155], v[44:47], v[120:123], v[152:155]
    v_mfma_f32_16x16x32_bf16 v[156:159], v[44:47], v[124:127], v[156:159]
    v_mfma_f32_16x16x32_bf16 v[160:163], v[44:47], v[128:131], v[160:163]
    v_mfma_f32_16x16x32_bf16 v[164:167], v[44:47], v[132:135], v[164:167]
    v_mfma_f32_16x16x32_bf16 v[168:171], v[44:47], v[136:139], v[168:171]
    ds_read_b128 v[44:47], v6 offset:128
    s_waitcnt lgkmcnt(13)
    v_mfma_f32_16x16x32_bf16 v[168:171], v[72:75], v[76:79], v[168:171]
    ds_read_b128 v[72:75], v6 offset:3776
    v_mfma_f32_16x16x32_bf16 v[164:167], v[68:71], v[76:79], v[164:167]
    s_waitcnt lgkmcnt(12)
    v_mfma_f32_16x16x32_bf16 v[168:171], v[68:71], v[80:83], v[168:171]
    ds_read_b128 v[68:71], v6 offset:3264
    v_mfma_f32_16x16x32_bf16 v[160:163], v[64:67], v[76:79], v[160:163]
    v_mfma_f32_16x16x32_bf16 v[164:167], v[64:67], v[80:83], v[164:167]
    ds_read_b128 v[108:111], v7 offset:128
    s_waitcnt lgkmcnt(12)
    v_mfma_f32_16x16x32_bf16 v[168:171], v[64:67], v[84:87], v[168:171]
    ds_read_b128 v[64:67], v6 offset:2752
    v_mfma_f32_16x16x32_bf16 v[156:159], v[60:63], v[76:79], v[156:159]
    v_mfma_f32_16x16x32_bf16 v[160:163], v[60:63], v[80:83], v[160:163]
    v_mfma_f32_16x16x32_bf16 v[164:167], v[60:63], v[84:87], v[164:167]
    ds_read_b128 v[112:115], v7 offset:384
    s_waitcnt lgkmcnt(12)
    v_mfma_f32_16x16x32_bf16 v[168:171], v[60:63], v[88:91], v[168:171]
    ds_read_b128 v[60:63], v6 offset:2240
    v_mfma_f32_16x16x32_bf16 v[152:155], v[56:59], v[76:79], v[152:155]
    v_mfma_f32_16x16x32_bf16 v[156:159], v[56:59], v[80:83], v[156:159]
    v_mfma_f32_16x16x32_bf16 v[160:163], v[56:59], v[84:87], v[160:163]
    ds_read_b128 v[116:119], v7 offset:640
    v_mfma_f32_16x16x32_bf16 v[164:167], v[56:59], v[88:91], v[164:167]
    s_waitcnt lgkmcnt(13)
    v_mfma_f32_16x16x32_bf16 v[168:171], v[56:59], v[92:95], v[168:171]
    ds_read_b128 v[56:59], v6 offset:1728
    s_waitcnt lgkmcnt(13)
    v_mfma_f32_16x16x32_bf16 v[148:151], v[52:55], v[76:79], v[148:151]
    v_mfma_f32_16x16x32_bf16 v[152:155], v[52:55], v[80:83], v[152:155]
    ds_read_b128 v[120:123], v7 offset:896
    v_mfma_f32_16x16x32_bf16 v[156:159], v[52:55], v[84:87], v[156:159]
    v_mfma_f32_16x16x32_bf16 v[160:163], v[52:55], v[88:91], v[160:163]
    v_mfma_f32_16x16x32_bf16 v[164:167], v[52:55], v[92:95], v[164:167]
    ds_read_b128 v[124:127], v7 offset:1152
    s_waitcnt lgkmcnt(14)
    v_mfma_f32_16x16x32_bf16 v[168:171], v[52:55], v[96:99], v[168:171]
    ds_read_b128 v[52:55], v6 offset:1216
    s_waitcnt lgkmcnt(13)
    v_mfma_f32_16x16x32_bf16 v[144:147], v[48:51], v[76:79], v[144:147]
    v_mfma_f32_16x16x32_bf16 v[148:151], v[48:51], v[80:83], v[148:151]
    v_mfma_f32_16x16x32_bf16 v[152:155], v[48:51], v[84:87], v[152:155]
    ds_read_b128 v[128:131], v7 offset:1408
    v_mfma_f32_16x16x32_bf16 v[156:159], v[48:51], v[88:91], v[156:159]
    v_mfma_f32_16x16x32_bf16 v[160:163], v[48:51], v[92:95], v[160:163]
    v_mfma_f32_16x16x32_bf16 v[164:167], v[48:51], v[96:99], v[164:167]
    ds_read_b128 v[132:135], v7 offset:1664
    v_mfma_f32_16x16x32_bf16 v[168:171], v[48:51], v[100:103], v[168:171]
    ds_read_b128 v[48:51], v6 offset:704
    s_waitcnt lgkmcnt(14)
    v_mfma_f32_16x16x32_bf16 v[140:143], v[44:47], v[76:79], v[140:143]
    v_mfma_f32_16x16x32_bf16 v[144:147], v[44:47], v[80:83], v[144:147]
    v_mfma_f32_16x16x32_bf16 v[148:151], v[44:47], v[84:87], v[148:151]
    ds_read_b128 v[136:139], v7 offset:1920
    v_mfma_f32_16x16x32_bf16 v[152:155], v[44:47], v[88:91], v[152:155]
    v_mfma_f32_16x16x32_bf16 v[156:159], v[44:47], v[92:95], v[156:159]
    v_mfma_f32_16x16x32_bf16 v[160:163], v[44:47], v[96:99], v[160:163]
    v_mfma_f32_16x16x32_bf16 v[164:167], v[44:47], v[100:103], v[164:167]
    v_mfma_f32_16x16x32_bf16 v[168:171], v[44:47], v[104:107], v[168:171]
    ds_read_b128 v[44:47], v6 offset:192
    s_waitcnt lgkmcnt(13)
    v_mfma_f32_16x16x32_bf16 v[168:171], v[72:75], v[108:111], v[168:171]
    ds_read_b128 v[72:75], v6 offset:3840
    s_mov_b32 s73, 0x05040100
    s_mov_b32 s74, 0x07060302
    s_mul_i32 s72, s76, 5120
    s_lshl_b32 s77, s54, 8
    s_add_u32 s72, s72, s77
    s_add_u32 s72, s72, 11206656
    s_cmp_ge_u32 s76, 28
    s_cselect_b32 s72, 33554432, s72
    v_mul_u32_u24 v197, 1639, v196
    v_mfma_f32_16x16x32_bf16 v[164:167], v[68:71], v[108:111], v[164:167]
    v_lshrrev_b32 v197, 16, v197
    v_mul_u32_u24 v198, 143360, v197
    s_waitcnt lgkmcnt(12)
    v_mfma_f32_16x16x32_bf16 v[168:171], v[68:71], v[112:115], v[168:171]
    ds_read_b128 v[68:71], v6 offset:3328
    v_mul_u32_u24 v197, 40, v197
    v_mfma_f32_16x16x32_bf16 v[160:163], v[64:67], v[108:111], v[160:163]
    v_sub_u32 v196, v196, v197
    v_lshrrev_b32 v197, 4, v196
    v_mfma_f32_16x16x32_bf16 v[164:167], v[64:67], v[112:115], v[164:167]
    ds_read_b128 v[76:79], v7 offset:96
    v_lshl_add_u32 v198, v197, 11, v198
    s_waitcnt lgkmcnt(12)
    v_mfma_f32_16x16x32_bf16 v[168:171], v[64:67], v[116:119], v[168:171]
    ds_read_b128 v[64:67], v6 offset:2816
    v_cmp_le_u32 vcc, 32, v196
    v_mfma_f32_16x16x32_bf16 v[156:159], v[60:63], v[108:111], v[156:159]
    v_and_b32 v196, 15, v196
    v_mov_b32 v199, 1024
    v_mfma_f32_16x16x32_bf16 v[160:163], v[60:63], v[112:115], v[160:163]
    v_cndmask_b32 v197, 0, v196, vcc
    v_cndmask_b32 v199, v199, 16, vcc
    v_mfma_f32_16x16x32_bf16 v[164:167], v[60:63], v[116:119], v[164:167]
    ds_read_b128 v[80:83], v7 offset:352
    v_add_u32 v196, v196, v197
    s_waitcnt lgkmcnt(12)
    v_mfma_f32_16x16x32_bf16 v[168:171], v[60:63], v[120:123], v[168:171]
    ds_read_b128 v[60:63], v6 offset:2304
    v_lshl_add_u32 v198, v196, 4, v198
    v_mfma_f32_16x16x32_bf16 v[152:155], v[56:59], v[108:111], v[152:155]
    v_add_u32 v199, v198, v199
    s_waitcnt vmcnt(7)
    v_perm_b32 v208, v201, v200, s73
    v_mfma_f32_16x16x32_bf16 v[156:159], v[56:59], v[112:115], v[156:159]
    s_waitcnt vmcnt(5)
    v_perm_b32 v209, v203, v202, s73
    s_waitcnt vmcnt(3)
    v_perm_b32 v210, v205, v204, s73
    v_mfma_f32_16x16x32_bf16 v[160:163], v[56:59], v[116:119], v[160:163]
    ds_read_b128 v[84:87], v7 offset:608
    s_waitcnt vmcnt(1)
    v_perm_b32 v211, v207, v206, s73
    v_mfma_f32_16x16x32_bf16 v[164:167], v[56:59], v[120:123], v[164:167]
    v_perm_b32 v212, v201, v200, s74
    v_perm_b32 v213, v203, v202, s74
    s_waitcnt lgkmcnt(13)
    v_mfma_f32_16x16x32_bf16 v[168:171], v[56:59], v[124:127], v[168:171]
    ds_read_b128 v[56:59], v6 offset:1792
    v_perm_b32 v214, v205, v204, s74
    s_waitcnt lgkmcnt(13)
    v_mfma_f32_16x16x32_bf16 v[148:151], v[52:55], v[108:111], v[148:151]
    v_perm_b32 v215, v207, v206, s74
    buffer_store_dwordx4 v[208:211], v198, s[4:7], s72 offen
    v_mfma_f32_16x16x32_bf16 v[152:155], v[52:55], v[112:115], v[152:155]
    ds_read_b128 v[88:91], v7 offset:864
    buffer_store_dwordx4 v[212:215], v199, s[4:7], s72 offen
    v_mfma_f32_16x16x32_bf16 v[156:159], v[52:55], v[116:119], v[156:159]
    v_mfma_f32_16x16x32_bf16 v[160:163], v[52:55], v[120:123], v[160:163]
    v_mfma_f32_16x16x32_bf16 v[164:167], v[52:55], v[124:127], v[164:167]
    ds_read_b128 v[92:95], v7 offset:1120
    s_waitcnt lgkmcnt(14)
    v_mfma_f32_16x16x32_bf16 v[168:171], v[52:55], v[128:131], v[168:171]
    ds_read_b128 v[52:55], v6 offset:1280
    s_waitcnt lgkmcnt(13)
    v_mfma_f32_16x16x32_bf16 v[144:147], v[48:51], v[108:111], v[144:147]
    v_mfma_f32_16x16x32_bf16 v[148:151], v[48:51], v[112:115], v[148:151]
    v_mfma_f32_16x16x32_bf16 v[152:155], v[48:51], v[116:119], v[152:155]
    ds_read_b128 v[96:99], v7 offset:1376
    v_mfma_f32_16x16x32_bf16 v[156:159], v[48:51], v[120:123], v[156:159]
    v_mfma_f32_16x16x32_bf16 v[160:163], v[48:51], v[124:127], v[160:163]
    v_mfma_f32_16x16x32_bf16 v[164:167], v[48:51], v[128:131], v[164:167]
    ds_read_b128 v[100:103], v7 offset:1632
    v_mfma_f32_16x16x32_bf16 v[168:171], v[48:51], v[132:135], v[168:171]
    ds_read_b128 v[48:51], v6 offset:768
    s_waitcnt lgkmcnt(14)
    v_mfma_f32_16x16x32_bf16 v[140:143], v[44:47], v[108:111], v[140:143]
    v_mfma_f32_16x16x32_bf16 v[144:147], v[44:47], v[112:115], v[144:147]
    v_mfma_f32_16x16x32_bf16 v[148:151], v[44:47], v[116:119], v[148:151]
    ds_read_b128 v[104:107], v7 offset:1888
    v_mfma_f32_16x16x32_bf16 v[152:155], v[44:47], v[120:123], v[152:155]
    v_mfma_f32_16x16x32_bf16 v[156:159], v[44:47], v[124:127], v[156:159]
    v_mfma_f32_16x16x32_bf16 v[160:163], v[44:47], v[128:131], v[160:163]
    v_mfma_f32_16x16x32_bf16 v[164:167], v[44:47], v[132:135], v[164:167]
    v_mfma_f32_16x16x32_bf16 v[168:171], v[44:47], v[136:139], v[168:171]
    ds_read_b128 v[44:47], v6 offset:256
    buffer_load_dwordx2 v[14:15], v10, s[4:7], 0 offen sc1
    buffer_load_dwordx2 v[16:17], v27, s[4:7], 0 offen sc1
    s_waitcnt lgkmcnt(13)
    v_mfma_f32_16x16x32_bf16 v[168:171], v[72:75], v[76:79], v[168:171]
    ds_read_b128 v[72:75], v6 offset:3904
    v_mfma_f32_16x16x32_bf16 v[164:167], v[68:71], v[76:79], v[164:167]
    s_waitcnt lgkmcnt(12)
    v_mfma_f32_16x16x32_bf16 v[168:171], v[68:71], v[80:83], v[168:171]
    ds_read_b128 v[68:71], v6 offset:3392
    v_mfma_f32_16x16x32_bf16 v[160:163], v[64:67], v[76:79], v[160:163]
    v_mfma_f32_16x16x32_bf16 v[164:167], v[64:67], v[80:83], v[164:167]
    ds_read_b128 v[108:111], v7 offset:64
    s_waitcnt lgkmcnt(12)
    v_mfma_f32_16x16x32_bf16 v[168:171], v[64:67], v[84:87], v[168:171]
    ds_read_b128 v[64:67], v6 offset:2880
    v_mfma_f32_16x16x32_bf16 v[156:159], v[60:63], v[76:79], v[156:159]
    v_mfma_f32_16x16x32_bf16 v[160:163], v[60:63], v[80:83], v[160:163]
    v_mfma_f32_16x16x32_bf16 v[164:167], v[60:63], v[84:87], v[164:167]
    ds_read_b128 v[112:115], v7 offset:320
    s_waitcnt lgkmcnt(12)
    v_mfma_f32_16x16x32_bf16 v[168:171], v[60:63], v[88:91], v[168:171]
    ds_read_b128 v[60:63], v6 offset:2368
    v_mfma_f32_16x16x32_bf16 v[152:155], v[56:59], v[76:79], v[152:155]
    v_mfma_f32_16x16x32_bf16 v[156:159], v[56:59], v[80:83], v[156:159]
    v_mfma_f32_16x16x32_bf16 v[160:163], v[56:59], v[84:87], v[160:163]
    ds_read_b128 v[116:119], v7 offset:576
    v_mfma_f32_16x16x32_bf16 v[164:167], v[56:59], v[88:91], v[164:167]
    s_waitcnt lgkmcnt(13)
    v_mfma_f32_16x16x32_bf16 v[168:171], v[56:59], v[92:95], v[168:171]
    ds_read_b128 v[56:59], v6 offset:1856
    s_waitcnt lgkmcnt(13)
    v_mfma_f32_16x16x32_bf16 v[148:151], v[52:55], v[76:79], v[148:151]
    v_mfma_f32_16x16x32_bf16 v[152:155], v[52:55], v[80:83], v[152:155]
    ds_read_b128 v[120:123], v7 offset:832
    v_mfma_f32_16x16x32_bf16 v[156:159], v[52:55], v[84:87], v[156:159]
    v_mfma_f32_16x16x32_bf16 v[160:163], v[52:55], v[88:91], v[160:163]
    v_mfma_f32_16x16x32_bf16 v[164:167], v[52:55], v[92:95], v[164:167]
    ds_read_b128 v[124:127], v7 offset:1088
    s_waitcnt lgkmcnt(14)
    v_mfma_f32_16x16x32_bf16 v[168:171], v[52:55], v[96:99], v[168:171]
    ds_read_b128 v[52:55], v6 offset:1344
    s_waitcnt lgkmcnt(13)
    v_mfma_f32_16x16x32_bf16 v[144:147], v[48:51], v[76:79], v[144:147]
    v_mfma_f32_16x16x32_bf16 v[148:151], v[48:51], v[80:83], v[148:151]
    v_mfma_f32_16x16x32_bf16 v[152:155], v[48:51], v[84:87], v[152:155]
    ds_read_b128 v[128:131], v7 offset:1344
    v_mfma_f32_16x16x32_bf16 v[156:159], v[48:51], v[88:91], v[156:159]
    v_mfma_f32_16x16x32_bf16 v[160:163], v[48:51], v[92:95], v[160:163]
    v_mfma_f32_16x16x32_bf16 v[164:167], v[48:51], v[96:99], v[164:167]
    ds_read_b128 v[132:135], v7 offset:1600
    v_mfma_f32_16x16x32_bf16 v[168:171], v[48:51], v[100:103], v[168:171]
    ds_read_b128 v[48:51], v6 offset:832
    s_waitcnt lgkmcnt(14)
    v_mfma_f32_16x16x32_bf16 v[140:143], v[44:47], v[76:79], v[140:143]
    v_mfma_f32_16x16x32_bf16 v[144:147], v[44:47], v[80:83], v[144:147]
    v_mfma_f32_16x16x32_bf16 v[148:151], v[44:47], v[84:87], v[148:151]
    ds_read_b128 v[136:139], v7 offset:1856
    v_mfma_f32_16x16x32_bf16 v[152:155], v[44:47], v[88:91], v[152:155]
    v_mfma_f32_16x16x32_bf16 v[156:159], v[44:47], v[92:95], v[156:159]
    v_mfma_f32_16x16x32_bf16 v[160:163], v[44:47], v[96:99], v[160:163]
    v_mfma_f32_16x16x32_bf16 v[164:167], v[44:47], v[100:103], v[164:167]
    v_mfma_f32_16x16x32_bf16 v[168:171], v[44:47], v[104:107], v[168:171]
    ds_read_b128 v[44:47], v6 offset:320
    s_mov_b32 s49, 65536
L_ka_poll_10:
    s_waitcnt vmcnt(1)
    v_cmp_ne_u32 vcc, s48, v15
    s_waitcnt vmcnt(0)
    v_cmp_ne_u32 s[50:51], s48, v17
    s_nop 0
    s_or_b64 vcc, vcc, s[50:51]
    s_cbranch_vccz L_ka_got_11
    buffer_load_dwordx2 v[14:15], v10, s[4:7], 0 offen sc1
    buffer_load_dwordx2 v[16:17], v27, s[4:7], 0 offen sc1
    s_waitcnt vmcnt(0)
    s_sub_u32 s49, s49, 1
    s_cmp_lg_u32 s49, 0
    s_cbranch_scc1 L_ka_poll_10
L_ka_got_11:
    s_waitcnt lgkmcnt(13)
    v_mfma_f32_16x16x32_bf16 v[168:171], v[72:75], v[108:111], v[168:171]
    ds_read_b128 v[72:75], v6 offset:3968
    s_mov_b32 s59, 16384
    buffer_load_dwordx4 v[28:31], v9, s[4:7], s66 offen sc1
    v_mfma_f32_16x16x32_bf16 v[164:167], v[68:71], v[108:111], v[164:167]
    buffer_load_dwordx4 v[172:175], v9, s[4:7], s59 offen sc1
    s_add_u32 s59, s59, 4096
    buffer_load_dwordx4 v[32:35], v9, s[4:7], s67 offen sc1
    s_waitcnt lgkmcnt(12)
    v_mfma_f32_16x16x32_bf16 v[168:171], v[68:71], v[112:115], v[168:171]
    ds_read_b128 v[68:71], v6 offset:3456
    buffer_load_dwordx4 v[176:179], v9, s[4:7], s59 offen sc1
    v_mfma_f32_16x16x32_bf16 v[160:163], v[64:67], v[108:111], v[160:163]
    s_add_u32 s59, s59, 4096
    buffer_load_dwordx4 v[36:39], v9, s[4:7], s68 offen sc1
    buffer_load_dwordx4 v[180:183], v9, s[4:7], s59 offen sc1
    v_mfma_f32_16x16x32_bf16 v[164:167], v[64:67], v[112:115], v[164:167]
    ds_read_b128 v[76:79], v7 offset:32
    s_add_u32 s59, s59, 4096
    buffer_load_dwordx4 v[40:43], v9, s[4:7], s69 offen sc1
    s_waitcnt lgkmcnt(12)
    v_mfma_f32_16x16x32_bf16 v[168:171], v[64:67], v[116:119], v[168:171]
    ds_read_b128 v[64:67], v6 offset:2944
    buffer_load_dwordx4 v[184:187], v9, s[4:7], s59 offen sc1
    v_mfma_f32_16x16x32_bf16 v[156:159], v[60:63], v[108:111], v[156:159]
    s_add_u32 s59, s59, 4096
    v_readlane_b32 s80, v14, 32
    v_readlane_b32 s81, v14, 33
    v_mfma_f32_16x16x32_bf16 v[160:163], v[60:63], v[112:115], v[160:163]
    v_readlane_b32 s82, v14, 34
    v_readlane_b32 s83, v14, 35
    v_mfma_f32_16x16x32_bf16 v[164:167], v[60:63], v[116:119], v[164:167]
    ds_read_b128 v[80:83], v7 offset:288
    v_readlane_b32 s84, v14, 36
    s_waitcnt lgkmcnt(12)
    v_mfma_f32_16x16x32_bf16 v[168:171], v[60:63], v[120:123], v[168:171]
    ds_read_b128 v[60:63], v6 offset:2432
    v_readlane_b32 s85, v14, 37
    v_mfma_f32_16x16x32_bf16 v[152:155], v[56:59], v[108:111], v[152:155]
    v_readlane_b32 s86, v14, 38
    v_readlane_b32 s87, v14, 39
    v_mfma_f32_16x16x32_bf16 v[156:159], v[56:59], v[112:115], v[156:159]
    v_readlane_b32 s88, v14, 40
    v_readlane_b32 s89, v14, 41
    v_mfma_f32_16x16x32_bf16 v[160:163], v[56:59], v[116:119], v[160:163]
    ds_read_b128 v[84:87], v7 offset:544
    v_readlane_b32 s90, v14, 42
    v_mfma_f32_16x16x32_bf16 v[164:167], v[56:59], v[120:123], v[164:167]
    v_readlane_b32 s91, v14, 43
    v_mov_b32 v192, s88
    s_waitcnt lgkmcnt(13)
    v_mfma_f32_16x16x32_bf16 v[168:171], v[56:59], v[124:127], v[168:171]
    ds_read_b128 v[56:59], v6 offset:1920
    v_mov_b32 v193, s89
    s_waitcnt lgkmcnt(13)
    v_mfma_f32_16x16x32_bf16 v[148:151], v[52:55], v[108:111], v[148:151]
    v_mov_b32 v194, s90
    v_mov_b32 v195, s91
    v_mfma_f32_16x16x32_bf16 v[152:155], v[52:55], v[112:115], v[152:155]
    ds_read_b128 v[88:91], v7 offset:800
    v_mul_f32 v188, s80, v192
    v_mfma_f32_16x16x32_bf16 v[156:159], v[52:55], v[116:119], v[156:159]
    v_mul_f32 v192, s84, v192
    v_mul_f32 v189, s81, v193
    v_mfma_f32_16x16x32_bf16 v[160:163], v[52:55], v[120:123], v[160:163]
    v_mul_f32 v193, s85, v193
    v_mul_f32 v190, s82, v194
    v_mfma_f32_16x16x32_bf16 v[164:167], v[52:55], v[124:127], v[164:167]
    ds_read_b128 v[92:95], v7 offset:1056
    v_mul_f32 v194, s86, v194
    s_waitcnt lgkmcnt(14)
    v_mfma_f32_16x16x32_bf16 v[168:171], v[52:55], v[128:131], v[168:171]
    ds_read_b128 v[52:55], v6 offset:1408
    v_mul_f32 v191, s83, v195
    s_waitcnt lgkmcnt(13)
    v_mfma_f32_16x16x32_bf16 v[144:147], v[48:51], v[108:111], v[144:147]
    v_mul_f32 v195, s87, v195
    v_mfma_f32_16x16x32_bf16 v[148:151], v[48:51], v[112:115], v[148:151]
    v_mfma_f32_16x16x32_bf16 v[152:155], v[48:51], v[116:119], v[152:155]
    ds_read_b128 v[96:99], v7 offset:1312
    v_mfma_f32_16x16x32_bf16 v[156:159], v[48:51], v[120:123], v[156:159]
    v_mfma_f32_16x16x32_bf16 v[160:163], v[48:51], v[124:127], v[160:163]
    v_mfma_f32_16x16x32_bf16 v[164:167], v[48:51], v[128:131], v[164:167]
    ds_read_b128 v[100:103], v7 offset:1568
    v_mfma_f32_16x16x32_bf16 v[168:171], v[48:51], v[132:135], v[168:171]
    ds_read_b128 v[48:51], v6 offset:896
    s_waitcnt lgkmcnt(14)
    v_mfma_f32_16x16x32_bf16 v[140:143], v[44:47], v[108:111], v[140:143]
    v_mfma_f32_16x16x32_bf16 v[144:147], v[44:47], v[112:115], v[144:147]
    v_mfma_f32_16x16x32_bf16 v[148:151], v[44:47], v[116:119], v[148:151]
    ds_read_b128 v[104:107], v7 offset:1824
    v_mfma_f32_16x16x32_bf16 v[152:155], v[44:47], v[120:123], v[152:155]
    v_mfma_f32_16x16x32_bf16 v[156:159], v[44:47], v[124:127], v[156:159]
    v_mfma_f32_16x16x32_bf16 v[160:163], v[44:47], v[128:131], v[160:163]
    v_mfma_f32_16x16x32_bf16 v[164:167], v[44:47], v[132:135], v[164:167]
    v_mfma_f32_16x16x32_bf16 v[168:171], v[44:47], v[136:139], v[168:171]
    ds_read_b128 v[44:47], v6 offset:384
    s_waitcnt lgkmcnt(13)
    v_mfma_f32_16x16x32_bf16 v[168:171], v[72:75], v[76:79], v[168:171]
    ds_read_b128 v[72:75], v6 offset:4032
    s_waitcnt vmcnt(7)
    v_lshlrev_b32 v196, 16, v28
    v_mfma_f32_16x16x32_bf16 v[164:167], v[68:71], v[76:79], v[164:167]
    v_and_b32 v198, s3, v28
    v_lshlrev_b32 v200, 16, v29
    s_waitcnt lgkmcnt(12)
    v_mfma_f32_16x16x32_bf16 v[168:171], v[68:71], v[80:83], v[168:171]
    ds_read_b128 v[68:71], v6 offset:3520
    v_and_b32 v202, s3, v29
    v_mfma_f32_16x16x32_bf16 v[160:163], v[64:67], v[76:79], v[160:163]
    v_lshlrev_b32 v197, 16, v30
    v_and_b32 v199, s3, v30
    v_mfma_f32_16x16x32_bf16 v[164:167], v[64:67], v[80:83], v[164:167]
    ds_read_b128 v[108:111], v7 offset:0
    v_lshlrev_b32 v201, 16, v31
    s_waitcnt lgkmcnt(12)
    v_mfma_f32_16x16x32_bf16 v[168:171], v[64:67], v[84:87], v[168:171]
    ds_read_b128 v[64:67], v6 offset:3008
    v_and_b32 v203, s3, v31
    v_mfma_f32_16x16x32_bf16 v[156:159], v[60:63], v[76:79], v[156:159]
    s_waitcnt vmcnt(6)
    v_fma_f32 v196, v196, v172, v174
    v_fma_f32 v197, v197, v173, v175
    v_mfma_f32_16x16x32_bf16 v[160:163], v[60:63], v[80:83], v[160:163]
    v_fma_f32 v198, v198, v172, v174
    v_fma_f32 v199, v199, v173, v175
    v_mfma_f32_16x16x32_bf16 v[164:167], v[60:63], v[84:87], v[164:167]
    ds_read_b128 v[112:115], v7 offset:256
    v_fma_f32 v200, v200, v172, v174
    s_waitcnt lgkmcnt(12)
    v_mfma_f32_16x16x32_bf16 v[168:171], v[60:63], v[88:91], v[168:171]
    ds_read_b128 v[60:63], v6 offset:2496
    v_fma_f32 v201, v201, v173, v175
    v_mfma_f32_16x16x32_bf16 v[152:155], v[56:59], v[76:79], v[152:155]
    v_fma_f32 v202, v202, v172, v174
    v_fma_f32 v203, v203, v173, v175
    v_mfma_f32_16x16x32_bf16 v[156:159], v[56:59], v[80:83], v[156:159]
    v_fma_f32 v196, v196, v192, v188
    v_fma_f32 v197, v197, v192, v188
    v_mfma_f32_16x16x32_bf16 v[160:163], v[56:59], v[84:87], v[160:163]
    ds_read_b128 v[116:119], v7 offset:512
    v_fma_f32 v198, v198, v193, v189
    v_mfma_f32_16x16x32_bf16 v[164:167], v[56:59], v[88:91], v[164:167]
    v_fma_f32 v199, v199, v193, v189
    v_fma_f32 v200, v200, v194, v190
    s_waitcnt lgkmcnt(13)
    v_mfma_f32_16x16x32_bf16 v[168:171], v[56:59], v[92:95], v[168:171]
    ds_read_b128 v[56:59], v6 offset:1984
    v_fma_f32 v201, v201, v194, v190
    s_waitcnt lgkmcnt(13)
    v_mfma_f32_16x16x32_bf16 v[148:151], v[52:55], v[76:79], v[148:151]
    v_fma_f32 v202, v202, v195, v191
    v_fma_f32 v203, v203, v195, v191
    v_mfma_f32_16x16x32_bf16 v[152:155], v[52:55], v[80:83], v[152:155]
    ds_read_b128 v[120:123], v7 offset:768
    s_waitcnt vmcnt(5)
    v_lshlrev_b32 v204, 16, v32
    v_mfma_f32_16x16x32_bf16 v[156:159], v[52:55], v[84:87], v[156:159]
    v_and_b32 v206, s3, v32
    v_lshlrev_b32 v208, 16, v33
    v_mfma_f32_16x16x32_bf16 v[160:163], v[52:55], v[88:91], v[160:163]
    v_and_b32 v210, s3, v33
    v_lshlrev_b32 v205, 16, v34
    v_mfma_f32_16x16x32_bf16 v[164:167], v[52:55], v[92:95], v[164:167]
    ds_read_b128 v[124:127], v7 offset:1024
    v_and_b32 v207, s3, v34
    s_waitcnt lgkmcnt(14)
    v_mfma_f32_16x16x32_bf16 v[168:171], v[52:55], v[96:99], v[168:171]
    ds_read_b128 v[52:55], v6 offset:1472
    v_lshlrev_b32 v209, 16, v35
    s_waitcnt lgkmcnt(13)
    v_mfma_f32_16x16x32_bf16 v[144:147], v[48:51], v[76:79], v[144:147]
    v_and_b32 v211, s3, v35
    s_waitcnt vmcnt(4)
    v_fma_f32 v204, v204, v176, v178
    v_mfma_f32_16x16x32_bf16 v[148:151], v[48:51], v[80:83], v[148:151]
    v_fma_f32 v205, v205, v177, v179
    v_fma_f32 v206, v206, v176, v178
    v_mfma_f32_16x16x32_bf16 v[152:155], v[48:51], v[84:87], v[152:155]
    ds_read_b128 v[128:131], v7 offset:1280
    v_fma_f32 v207, v207, v177, v179
    v_mfma_f32_16x16x32_bf16 v[156:159], v[48:51], v[88:91], v[156:159]
    v_fma_f32 v208, v208, v176, v178
    v_fma_f32 v209, v209, v177, v179
    v_mfma_f32_16x16x32_bf16 v[160:163], v[48:51], v[92:95], v[160:163]
    v_fma_f32 v210, v210, v176, v178
    v_fma_f32 v211, v211, v177, v179
    v_mfma_f32_16x16x32_bf16 v[164:167], v[48:51], v[96:99], v[164:167]
    ds_read_b128 v[132:135], v7 offset:1536
    v_fma_f32 v204, v204, v192, v188
    v_mfma_f32_16x16x32_bf16 v[168:171], v[48:51], v[100:103], v[168:171]
    ds_read_b128 v[48:51], v6 offset:960
    v_fma_f32 v205, v205, v192, v188
    s_waitcnt lgkmcnt(14)
    v_mfma_f32_16x16x32_bf16 v[140:143], v[44:47], v[76:79], v[140:143]
    v_fma_f32 v206, v206, v193, v189
    v_fma_f32 v207, v207, v193, v189
    v_mfma_f32_16x16x32_bf16 v[144:147], v[44:47], v[80:83], v[144:147]
    v_fma_f32 v208, v208, v194, v190
    v_fma_f32 v209, v209, v194, v190
    v_mfma_f32_16x16x32_bf16 v[148:151], v[44:47], v[84:87], v[148:151]
    ds_read_b128 v[136:139], v7 offset:1792
    v_fma_f32 v210, v210, v195, v191
    v_mfma_f32_16x16x32_bf16 v[152:155], v[44:47], v[88:91], v[152:155]
    v_fma_f32 v211, v211, v195, v191
    s_waitcnt vmcnt(3)
    v_lshlrev_b32 v212, 16, v36
    v_mfma_f32_16x16x32_bf16 v[156:159], v[44:47], v[92:95], v[156:159]
    v_and_b32 v214, s3, v36
    v_lshlrev_b32 v216, 16, v37
    v_mfma_f32_16x16x32_bf16 v[160:163], v[44:47], v[96:99], v[160:163]
    v_and_b32 v218, s3, v37
    v_lshlrev_b32 v213, 16, v38
    v_mfma_f32_16x16x32_bf16 v[164:167], v[44:47], v[100:103], v[164:167]
    v_and_b32 v215, s3, v38
    v_lshlrev_b32 v217, 16, v39
    v_mfma_f32_16x16x32_bf16 v[168:171], v[44:47], v[104:107], v[168:171]
    ds_read_b128 v[44:47], v6 offset:448
    v_and_b32 v219, s3, v39
    s_waitcnt lgkmcnt(13)
    v_mfma_f32_16x16x32_bf16 v[168:171], v[72:75], v[108:111], v[168:171]
    s_waitcnt vmcnt(2)
    v_fma_f32 v212, v212, v180, v182
    v_fma_f32 v213, v213, v181, v183
    v_mfma_f32_16x16x32_bf16 v[164:167], v[68:71], v[108:111], v[164:167]
    v_fma_f32 v214, v214, v180, v182
    v_fma_f32 v215, v215, v181, v183
    s_waitcnt lgkmcnt(11)
    v_mfma_f32_16x16x32_bf16 v[168:171], v[68:71], v[112:115], v[168:171]
    v_fma_f32 v216, v216, v180, v182
    v_fma_f32 v217, v217, v181, v183
    v_mfma_f32_16x16x32_bf16 v[160:163], v[64:67], v[108:111], v[160:163]
    v_fma_f32 v218, v218, v180, v182
    v_fma_f32 v219, v219, v181, v183
    v_mfma_f32_16x16x32_bf16 v[164:167], v[64:67], v[112:115], v[164:167]
    v_fma_f32 v212, v212, v192, v188
    v_fma_f32 v213, v213, v192, v188
    s_waitcnt lgkmcnt(9)
    v_mfma_f32_16x16x32_bf16 v[168:171], v[64:67], v[116:119], v[168:171]
    v_fma_f32 v214, v214, v193, v189
    v_fma_f32 v215, v215, v193, v189
    v_mfma_f32_16x16x32_bf16 v[156:159], v[60:63], v[108:111], v[156:159]
    v_fma_f32 v216, v216, v194, v190
    v_fma_f32 v217, v217, v194, v190
    v_mfma_f32_16x16x32_bf16 v[160:163], v[60:63], v[112:115], v[160:163]
    v_fma_f32 v218, v218, v195, v191
    v_fma_f32 v219, v219, v195, v191
    v_mfma_f32_16x16x32_bf16 v[164:167], v[60:63], v[116:119], v[164:167]
    s_waitcnt vmcnt(1)
    v_lshlrev_b32 v220, 16, v40
    v_and_b32 v222, s3, v40
    s_waitcnt lgkmcnt(7)
    v_mfma_f32_16x16x32_bf16 v[168:171], v[60:63], v[120:123], v[168:171]
    v_lshlrev_b32 v224, 16, v41
    v_and_b32 v226, s3, v41
    v_mfma_f32_16x16x32_bf16 v[152:155], v[56:59], v[108:111], v[152:155]
    v_lshlrev_b32 v221, 16, v42
    v_and_b32 v223, s3, v42
    v_mfma_f32_16x16x32_bf16 v[156:159], v[56:59], v[112:115], v[156:159]
    v_lshlrev_b32 v225, 16, v43
    v_and_b32 v227, s3, v43
    v_mfma_f32_16x16x32_bf16 v[160:163], v[56:59], v[116:119], v[160:163]
    s_waitcnt vmcnt(0)
    v_fma_f32 v220, v220, v184, v186
    v_fma_f32 v221, v221, v185, v187
    v_mfma_f32_16x16x32_bf16 v[164:167], v[56:59], v[120:123], v[164:167]
    v_fma_f32 v222, v222, v184, v186
    v_fma_f32 v223, v223, v185, v187
    s_waitcnt lgkmcnt(6)
    v_mfma_f32_16x16x32_bf16 v[168:171], v[56:59], v[124:127], v[168:171]
    v_fma_f32 v224, v224, v184, v186
    v_fma_f32 v225, v225, v185, v187
    s_waitcnt lgkmcnt(5)
    v_mfma_f32_16x16x32_bf16 v[148:151], v[52:55], v[108:111], v[148:151]
    v_fma_f32 v226, v226, v184, v186
    v_fma_f32 v227, v227, v185, v187
    v_mfma_f32_16x16x32_bf16 v[152:155], v[52:55], v[112:115], v[152:155]
    v_fma_f32 v220, v220, v192, v188
    v_fma_f32 v221, v221, v192, v188
    v_mfma_f32_16x16x32_bf16 v[156:159], v[52:55], v[116:119], v[156:159]
    v_fma_f32 v222, v222, v193, v189
    v_fma_f32 v223, v223, v193, v189
    v_mfma_f32_16x16x32_bf16 v[160:163], v[52:55], v[120:123], v[160:163]
    v_fma_f32 v224, v224, v194, v190
    v_fma_f32 v225, v225, v194, v190
    v_mfma_f32_16x16x32_bf16 v[164:167], v[52:55], v[124:127], v[164:167]
    v_fma_f32 v226, v226, v195, v191
    v_fma_f32 v227, v227, v195, v191
    s_waitcnt lgkmcnt(4)
    v_mfma_f32_16x16x32_bf16 v[168:171], v[52:55], v[128:131], v[168:171]
    s_waitcnt lgkmcnt(2)
    v_mfma_f32_16x16x32_bf16 v[144:147], v[48:51], v[108:111], v[144:147]
    v_mfma_f32_16x16x32_bf16 v[148:151], v[48:51], v[112:115], v[148:151]
    v_mfma_f32_16x16x32_bf16 v[152:155], v[48:51], v[116:119], v[152:155]
    v_mfma_f32_16x16x32_bf16 v[156:159], v[48:51], v[120:123], v[156:159]
    v_mfma_f32_16x16x32_bf16 v[160:163], v[48:51], v[124:127], v[160:163]
    v_mfma_f32_16x16x32_bf16 v[164:167], v[48:51], v[128:131], v[164:167]
    v_mfma_f32_16x16x32_bf16 v[168:171], v[48:51], v[132:135], v[168:171]
    s_waitcnt lgkmcnt(0)
    v_mfma_f32_16x16x32_bf16 v[140:143], v[44:47], v[108:111], v[140:143]
    v_mfma_f32_16x16x32_bf16 v[144:147], v[44:47], v[112:115], v[144:147]
    v_mfma_f32_16x16x32_bf16 v[148:151], v[44:47], v[116:119], v[148:151]
    v_mfma_f32_16x16x32_bf16 v[152:155], v[44:47], v[120:123], v[152:155]
    v_mfma_f32_16x16x32_bf16 v[156:159], v[44:47], v[124:127], v[156:159]
    v_mfma_f32_16x16x32_bf16 v[160:163], v[44:47], v[128:131], v[160:163]
    v_mfma_f32_16x16x32_bf16 v[164:167], v[44:47], v[132:135], v[164:167]
    v_mfma_f32_16x16x32_bf16 v[168:171], v[44:47], v[136:139], v[168:171]
    s_nop 0
    ds_write_b128 v8, v[140:143] offset:0
    ds_write_b128 v8, v[144:147] offset:1024
    ds_write_b128 v8, v[148:151] offset:2048
    ds_write_b128 v8, v[152:155] offset:3072
    ds_write_b128 v8, v[156:159] offset:4096
    ds_write_b128 v8, v[160:163] offset:5120
    ds_write_b128 v8, v[164:167] offset:6144
    ds_write_b128 v8, v[168:171] offset:7168
    v_lshlrev_b32 v76, 16, v28
    v_and_b32 v78, s3, v28
    v_lshlrev_b32 v80, 16, v29
    v_and_b32 v82, s3, v29
    v_lshlrev_b32 v77, 16, v30
    v_and_b32 v79, s3, v30
    v_lshlrev_b32 v81, 16, v31
    v_and_b32 v83, s3, v31
    v_lshlrev_b32 v84, 16, v32
    v_and_b32 v86, s3, v32
    v_lshlrev_b32 v88, 16, v33
    v_and_b32 v90, s3, v33
    v_lshlrev_b32 v85, 16, v34
    v_and_b32 v87, s3, v34
    v_lshlrev_b32 v89, 16, v35
    v_and_b32 v91, s3, v35
    v_lshlrev_b32 v92, 16, v36
    v_and_b32 v94, s3, v36
    v_lshlrev_b32 v96, 16, v37
    v_and_b32 v98, s3, v37
    v_lshlrev_b32 v93, 16, v38
    v_and_b32 v95, s3, v38
    v_lshlrev_b32 v97, 16, v39
    v_and_b32 v99, s3, v39
    v_lshlrev_b32 v100, 16, v40
    v_and_b32 v102, s3, v40
    v_lshlrev_b32 v104, 16, v41
    v_and_b32 v106, s3, v41
    v_lshlrev_b32 v101, 16, v42
    v_and_b32 v103, s3, v42
    v_lshlrev_b32 v105, 16, v43
    v_and_b32 v107, s3, v43
    s_waitcnt lgkmcnt(0)
    s_barrier
    ds_read_b64 v[44:45], v228 offset:0
    ds_read_b64 v[46:47], v228 offset:33024
    ds_read_b64 v[48:49], v229 offset:0
    ds_read_b64 v[50:51], v229 offset:33024
    ds_read_b64 v[52:53], v228 offset:2048
    ds_read_b64 v[54:55], v228 offset:35072
    ds_read_b64 v[56:57], v229 offset:2048
    ds_read_b64 v[58:59], v229 offset:35072
    ds_read_b64 v[60:61], v228 offset:4096
    ds_read_b64 v[62:63], v228 offset:37120
    ds_read_b64 v[64:65], v229 offset:4096
    ds_read_b64 v[66:67], v229 offset:37120
    ds_read_b64 v[68:69], v228 offset:6144
    ds_read_b64 v[70:71], v228 offset:39168
    ds_read_b64 v[72:73], v229 offset:6144
    ds_read_b64 v[74:75], v229 offset:39168
    s_waitcnt lgkmcnt(15)
    v_pk_fma_f32 v[196:197], v[196:197], v[44:45], v[76:77]
    s_waitcnt lgkmcnt(14)
    v_pk_fma_f32 v[198:199], v[198:199], v[46:47], v[78:79]
    s_waitcnt lgkmcnt(13)
    v_pk_fma_f32 v[200:201], v[200:201], v[48:49], v[80:81]
    s_waitcnt lgkmcnt(12)
    v_pk_fma_f32 v[202:203], v[202:203], v[50:51], v[82:83]
    v_cvt_pk_bf16_f32 v28, v196, v198
    v_cvt_pk_bf16_f32 v29, v200, v202
    v_cvt_pk_bf16_f32 v30, v197, v199
    v_cvt_pk_bf16_f32 v31, v201, v203
    buffer_store_dwordx4 v[28:31], v9, s[4:7], s62 offen
    s_waitcnt lgkmcnt(11)
    v_pk_fma_f32 v[204:205], v[204:205], v[52:53], v[84:85]
    s_waitcnt lgkmcnt(10)
    v_pk_fma_f32 v[206:207], v[206:207], v[54:55], v[86:87]
    s_waitcnt lgkmcnt(9)
    v_pk_fma_f32 v[208:209], v[208:209], v[56:57], v[88:89]
    s_waitcnt lgkmcnt(8)
    v_pk_fma_f32 v[210:211], v[210:211], v[58:59], v[90:91]
    v_cvt_pk_bf16_f32 v32, v204, v206
    v_cvt_pk_bf16_f32 v33, v208, v210
    v_cvt_pk_bf16_f32 v34, v205, v207
    v_cvt_pk_bf16_f32 v35, v209, v211
    buffer_store_dwordx4 v[32:35], v9, s[4:7], s63 offen
    s_waitcnt lgkmcnt(7)
    v_pk_fma_f32 v[212:213], v[212:213], v[60:61], v[92:93]
    s_waitcnt lgkmcnt(6)
    v_pk_fma_f32 v[214:215], v[214:215], v[62:63], v[94:95]
    s_waitcnt lgkmcnt(5)
    v_pk_fma_f32 v[216:217], v[216:217], v[64:65], v[96:97]
    s_waitcnt lgkmcnt(4)
    v_pk_fma_f32 v[218:219], v[218:219], v[66:67], v[98:99]
    v_cvt_pk_bf16_f32 v36, v212, v214
    v_cvt_pk_bf16_f32 v37, v216, v218
    v_cvt_pk_bf16_f32 v38, v213, v215
    v_cvt_pk_bf16_f32 v39, v217, v219
    buffer_store_dwordx4 v[36:39], v9, s[4:7], s64 offen
    s_waitcnt lgkmcnt(3)
    v_pk_fma_f32 v[220:221], v[220:221], v[68:69], v[100:101]
    s_waitcnt lgkmcnt(2)
    v_pk_fma_f32 v[222:223], v[222:223], v[70:71], v[102:103]
    s_waitcnt lgkmcnt(1)
    v_pk_fma_f32 v[224:225], v[224:225], v[72:73], v[104:105]
    s_waitcnt lgkmcnt(0)
    v_pk_fma_f32 v[226:227], v[226:227], v[74:75], v[106:107]
    v_cvt_pk_bf16_f32 v40, v220, v222
    v_cvt_pk_bf16_f32 v41, v224, v226
    v_cvt_pk_bf16_f32 v42, v221, v223
    v_cvt_pk_bf16_f32 v43, v225, v227
    buffer_store_dwordx4 v[40:43], v9, s[4:7], s65 offen
    s_branch L_ka_fin_2
L_ka_aux_3:
    s_sub_u32 s42, s2, 160
    v_lshrrev_b32 v1, 6, v0
    s_nop 0
    v_readfirstlane_b32 s39, v1
    s_cmp_lt_u32 s2, 248
    s_cbranch_scc1 L_ka_notag_5
    s_getpc_b64 s[40:41]
L_ka_pc_16:
    s_sub_u32 s40, s40, L_ka_pc_16-ka_kernel
    s_subb_u32 s41, s41, 0
    v_lshlrev_b32 v1, 7, v0
    v_min_u32 v1, ka_code_end-ka_kernel-4, v1
    global_load_dword v230, v1, s[40:41]
    s_cmp_lg_u32 s2, 252
    s_cbranch_scc1 L_ka_notag_5
    s_memrealtime s[50:51]
    s_waitcnt lgkmcnt(0)
    s_or_b32 s48, s50, 1
    v_mov_b32 v240, s48
    v_mov_b32 v241, s48
    v_cmp_eq_u32 vcc, 0, v0
    s_nop 0
    s_and_b64 exec, exec, vcc
    buffer_store_dwordx2 v[240:241], off, s[44:47], 0 sc1
    s_mov_b64 exec, -1
L_ka_notag_5:
    s_cmp_ge_u32 s2, 220
    s_cbranch_scc1 L_ka_stats_4
    s_load_dwordx2 s[8:9], s[0:1], 96
    s_mov_b32 s10, 4915200
    s_mov_b32 s11, 0x20000
    s_load_dwordx2 s[12:13], s[0:1], 88
    s_mov_b32 s14, 1280
    s_mov_b32 s15, 0x20000
    s_sub_u32 s16, s2, 160
    v_and_b32 v1, 7, v0
    v_lshrrev_b32 v2, 3, v0
    v_mul_u32_u24 v4, 40, v2
    v_mul_u32_u24 v3, 153600, v2
    v_lshl_add_u32 v3, v1, 4, v3
    s_lshl_b32 s17, s16, 7
    s_waitcnt lgkmcnt(0)
    buffer_load_dwordx4 v[6:9], v4, s[12:15], 0 offen
    buffer_load_dwordx4 v[10:13], v4, s[12:15], 0 offen offset:16
    buffer_load_dwordx2 v[14:15], v4, s[12:15], 0 offen offset:32
    s_mov_b32 s18, 0xbfb8aa3b
    s_waitcnt vmcnt(2)
    v_lshlrev_b32 v124, 16, v6
    v_and_b32 v125, s3, v6
    v_mul_f32 v126, s18, v124
    v_mul_f32 v127, s18, v125
    v_exp_f32 v126, v126
    v_exp_f32 v127, v127
    v_add_f32 v126, 1.0, v126
    v_add_f32 v127, 1.0, v127
    v_rcp_f32 v126, v126
    v_rcp_f32 v127, v127
    v_mul_f32 v124, v124, v126
    v_mul_f32 v125, v125, v127
    v_cvt_pk_bf16_f32 v124, v124, v125
    v_lshlrev_b32 v96, 16, v124
    v_and_b32 v97, s3, v124
    v_lshlrev_b32 v124, 16, v7
    v_and_b32 v125, s3, v7
    v_mul_f32 v126, s18, v124
    v_mul_f32 v127, s18, v125
    v_exp_f32 v126, v126
    v_exp_f32 v127, v127
    v_add_f32 v126, 1.0, v126
    v_add_f32 v127, 1.0, v127
    v_rcp_f32 v126, v126
    v_rcp_f32 v127, v127
    v_mul_f32 v124, v124, v126
    v_mul_f32 v125, v125, v127
    v_cvt_pk_bf16_f32 v124, v124, v125
    v_lshlrev_b32 v98, 16, v124
    v_and_b32 v99, s3, v124
    v_lshlrev_b32 v124, 16, v8
    v_and_b32 v125, s3, v8
    v_mul_f32 v126, s18, v124
    v_mul_f32 v127, s18, v125
    v_exp_f32 v126, v126
    v_exp_f32 v127, v127
    v_add_f32 v126, 1.0, v126
    v_add_f32 v127, 1.0, v127
    v_rcp_f32 v126, v126
    v_rcp_f32 v127, v127
    v_mul_f32 v124, v124, v126
    v_mul_f32 v125, v125, v127
    v_cvt_pk_bf16_f32 v124, v124, v125
    v_lshlrev_b32 v100, 16, v124
    v_and_b32 v101, s3, v124
    v_lshlrev_b32 v124, 16, v9
    v_and_b32 v125, s3, v9
    v_mul_f32 v126, s18, v124
    v_mul_f32 v127, s18, v125
    v_exp_f32 v126, v126
    v_exp_f32 v127, v127
    v_add_f32 v126, 1.0, v126
    v_add_f32 v127, 1.0, v127
    v_rcp_f32 v126, v126
    v_rcp_f32 v127, v127
    v_mul_f32 v124, v124, v126
    v_mul_f32 v125, v125, v127
    v_cvt_pk_bf16_f32 v124, v124, v125
    v_lshlrev_b32 v102, 16, v124
    v_and_b32 v103, s3, v124
    s_waitcnt vmcnt(1)
    v_lshlrev_b32 v124, 16, v10
    v_and_b32 v125, s3, v10
    v_mul_f32 v126, s18, v124
    v_mul_f32 v127, s18, v125
    v_exp_f32 v126, v126
    v_exp_f32 v127, v127
    v_add_f32 v126, 1.0, v126
    v_add_f32 v127, 1.0, v127
    v_rcp_f32 v126, v126
    v_rcp_f32 v127, v127
    v_mul_f32 v124, v124, v126
    v_mul_f32 v125, v125, v127
    v_cvt_pk_bf16_f32 v124, v124, v125
    v_lshlrev_b32 v104, 16, v124
    v_and_b32 v105, s3, v124
    v_lshlrev_b32 v124, 16, v11
    v_and_b32 v125, s3, v11
    v_mul_f32 v126, s18, v124
    v_mul_f32 v127, s18, v125
    v_exp_f32 v126, v126
    v_exp_f32 v127, v127
    v_add_f32 v126, 1.0, v126
    v_add_f32 v127, 1.0, v127
    v_rcp_f32 v126, v126
    v_rcp_f32 v127, v127
    v_mul_f32 v124, v124, v126
    v_mul_f32 v125, v125, v127
    v_cvt_pk_bf16_f32 v124, v124, v125
    v_lshlrev_b32 v106, 16, v124
    v_and_b32 v107, s3, v124
    v_lshlrev_b32 v124, 16, v12
    v_and_b32 v125, s3, v12
    v_mul_f32 v126, s18, v124
    v_mul_f32 v127, s18, v125
    v_exp_f32 v126, v126
    v_exp_f32 v127, v127
    v_add_f32 v126, 1.0, v126
    v_add_f32 v127, 1.0, v127
    v_rcp_f32 v126, v126
    v_rcp_f32 v127, v127
    v_mul_f32 v124, v124, v126
    v_mul_f32 v125, v125, v127
    v_cvt_pk_bf16_f32 v124, v124, v125
    v_lshlrev_b32 v108, 16, v124
    v_and_b32 v109, s3, v124
    v_lshlrev_b32 v124, 16, v13
    v_and_b32 v125, s3, v13
    v_mul_f32 v126, s18, v124
    v_mul_f32 v127, s18, v125
    v_exp_f32 v126, v126
    v_exp_f32 v127, v127
    v_add_f32 v126, 1.0, v126
    v_add_f32 v127, 1.0, v127
    v_rcp_f32 v126, v126
    v_rcp_f32 v127, v127
    v_mul_f32 v124, v124, v126
    v_mul_f32 v125, v125, v127
    v_cvt_pk_bf16_f32 v124, v124, v125
    v_lshlrev_b32 v110, 16, v124
    v_and_b32 v111, s3, v124
    s_waitcnt vmcnt(0)
    v_lshlrev_b32 v124, 16, v14
    v_and_b32 v125, s3, v14
    v_mul_f32 v126, s18, v124
    v_mul_f32 v127, s18, v125
    v_exp_f32 v126, v126
    v_exp_f32 v127, v127
    v_add_f32 v126, 1.0, v126
    v_add_f32 v127, 1.0, v127
    v_rcp_f32 v126, v126
    v_rcp_f32 v127, v127
    v_mul_f32 v124, v124, v126
    v_mul_f32 v125, v125, v127
    v_cvt_pk_bf16_f32 v124, v124, v125
    v_lshlrev_b32 v112, 16, v124
    v_and_b32 v113, s3, v124
    v_lshlrev_b32 v124, 16, v15
    v_and_b32 v125, s3, v15
    v_mul_f32 v126, s18, v124
    v_mul_f32 v127, s18, v125
    v_exp_f32 v126, v126
    v_exp_f32 v127, v127
    v_add_f32 v126, 1.0, v126
    v_add_f32 v127, 1.0, v127
    v_rcp_f32 v126, v126
    v_rcp_f32 v127, v127
    v_mul_f32 v124, v124, v126
    v_mul_f32 v125, v125, v127
    v_cvt_pk_bf16_f32 v124, v124, v125
    v_lshlrev_b32 v114, 16, v124
    v_and_b32 v115, s3, v124
    buffer_load_dwordx4 v[16:19], v3, s[8:11], s17 offen
    s_add_u32 s17, s17, 7680
    buffer_load_dwordx4 v[20:23], v3, s[8:11], s17 offen
    s_add_u32 s17, s17, 7680
    buffer_load_dwordx4 v[24:27], v3, s[8:11], s17 offen
    s_add_u32 s17, s17, 7680
    buffer_load_dwordx4 v[28:31], v3, s[8:11], s17 offen
    s_add_u32 s17, s17, 7680
    buffer_load_dwordx4 v[32:35], v3, s[8:11], s17 offen
    s_add_u32 s17, s17, 7680
    buffer_load_dwordx4 v[36:39], v3, s[8:11], s17 offen
    s_add_u32 s17, s17, 7680
    buffer_load_dwordx4 v[40:43], v3, s[8:11], s17 offen
    s_add_u32 s17, s17, 7680
    buffer_load_dwordx4 v[44:47], v3, s[8:11], s17 offen
    s_add_u32 s17, s17, 7680
    buffer_load_dwordx4 v[48:51], v3, s[8:11], s17 offen
    s_add_u32 s17, s17, 7680
    buffer_load_dwordx4 v[52:55], v3, s[8:11], s17 offen
    s_add_u32 s17, s17, 7680
    buffer_load_dwordx4 v[56:59], v3, s[8:11], s17 offen
    s_add_u32 s17, s17, 7680
    buffer_load_dwordx4 v[60:63], v3, s[8:11], s17 offen
    s_add_u32 s17, s17, 7680
    buffer_load_dwordx4 v[64:67], v3, s[8:11], s17 offen
    s_add_u32 s17, s17, 7680
    buffer_load_dwordx4 v[68:71], v3, s[8:11], s17 offen
    s_add_u32 s17, s17, 7680
    buffer_load_dwordx4 v[72:75], v3, s[8:11], s17 offen
    s_add_u32 s17, s17, 7680
    buffer_load_dwordx4 v[76:79], v3, s[8:11], s17 offen
    s_add_u32 s17, s17, 7680
    buffer_load_dwordx4 v[80:83], v3, s[8:11], s17 offen
    s_add_u32 s17, s17, 7680
    buffer_load_dwordx4 v[84:87], v3, s[8:11], s17 offen
    s_add_u32 s17, s17, 7680
    buffer_load_dwordx4 v[88:91], v3, s[8:11], s17 offen
    s_add_u32 s17, s17, 7680
    buffer_load_dwordx4 v[92:95], v3, s[8:11], s17 offen
    buffer_load_dwordx2 v[240:241], off, s[44:47], 0 sc1
    s_waitcnt vmcnt(20)
    v_lshlrev_b32 v124, 16, v16
    v_and_b32 v125, s3, v16
    v_lshlrev_b32 v126, 16, v17
    v_and_b32 v127, s3, v17
    v_lshlrev_b32 v128, 16, v18
    v_and_b32 v129, s3, v18
    v_lshlrev_b32 v130, 16, v19
    v_and_b32 v131, s3, v19
    v_pk_mul_f32 v[116:117], v[124:125], v[96:97] op_sel:[0,0] op_sel_hi:[1,0]
    v_pk_mul_f32 v[118:119], v[126:127], v[96:97] op_sel:[0,0] op_sel_hi:[1,0]
    v_pk_mul_f32 v[120:121], v[128:129], v[96:97] op_sel:[0,0] op_sel_hi:[1,0]
    v_pk_mul_f32 v[122:123], v[130:131], v[96:97] op_sel:[0,0] op_sel_hi:[1,0]
    s_waitcnt vmcnt(19)
    v_lshlrev_b32 v124, 16, v20
    v_and_b32 v125, s3, v20
    v_lshlrev_b32 v126, 16, v21
    v_and_b32 v127, s3, v21
    v_lshlrev_b32 v128, 16, v22
    v_and_b32 v129, s3, v22
    v_lshlrev_b32 v130, 16, v23
    v_and_b32 v131, s3, v23
    v_pk_fma_f32 v[116:117], v[124:125], v[96:97], v[116:117] op_sel:[0,1,0] op_sel_hi:[1,1,1]
    v_pk_fma_f32 v[118:119], v[126:127], v[96:97], v[118:119] op_sel:[0,1,0] op_sel_hi:[1,1,1]
    v_pk_fma_f32 v[120:121], v[128:129], v[96:97], v[120:121] op_sel:[0,1,0] op_sel_hi:[1,1,1]
    v_pk_fma_f32 v[122:123], v[130:131], v[96:97], v[122:123] op_sel:[0,1,0] op_sel_hi:[1,1,1]
    s_waitcnt vmcnt(18)
    v_lshlrev_b32 v124, 16, v24
    v_and_b32 v125, s3, v24
    v_lshlrev_b32 v126, 16, v25
    v_and_b32 v127, s3, v25
    v_lshlrev_b32 v128, 16, v26
    v_and_b32 v129, s3, v26
    v_lshlrev_b32 v130, 16, v27
    v_and_b32 v131, s3, v27
    v_pk_fma_f32 v[116:117], v[124:125], v[98:99], v[116:117] op_sel:[0,0,0] op_sel_hi:[1,0,1]
    v_pk_fma_f32 v[118:119], v[126:127], v[98:99], v[118:119] op_sel:[0,0,0] op_sel_hi:[1,0,1]
    v_pk_fma_f32 v[120:121], v[128:129], v[98:99], v[120:121] op_sel:[0,0,0] op_sel_hi:[1,0,1]
    v_pk_fma_f32 v[122:123], v[130:131], v[98:99], v[122:123] op_sel:[0,0,0] op_sel_hi:[1,0,1]
    s_waitcnt vmcnt(17)
    v_lshlrev_b32 v124, 16, v28
    v_and_b32 v125, s3, v28
    v_lshlrev_b32 v126, 16, v29
    v_and_b32 v127, s3, v29
    v_lshlrev_b32 v128, 16, v30
    v_and_b32 v129, s3, v30
    v_lshlrev_b32 v130, 16, v31
    v_and_b32 v131, s3, v31
    v_pk_fma_f32 v[116:117], v[124:125], v[98:99], v[116:117] op_sel:[0,1,0] op_sel_hi:[1,1,1]
    v_pk_fma_f32 v[118:119], v[126:127], v[98:99], v[118:119] op_sel:[0,1,0] op_sel_hi:[1,1,1]
    v_pk_fma_f32 v[120:121], v[128:129], v[98:99], v[120:121] op_sel:[0,1,0] op_sel_hi:[1,1,1]
    v_pk_fma_f32 v[122:123], v[130:131], v[98:99], v[122:123] op_sel:[0,1,0] op_sel_hi:[1,1,1]
    s_waitcnt vmcnt(16)
    v_lshlrev_b32 v124, 16, v32
    v_and_b32 v125, s3, v32
    v_lshlrev_b32 v126, 16, v33
    v_and_b32 v127, s3, v33
    v_lshlrev_b32 v128, 16, v34
    v_and_b32 v129, s3, v34
    v_lshlrev_b32 v130, 16, v35
    v_and_b32 v131, s3, v35
    v_pk_fma_f32 v[116:117], v[124:125], v[100:101], v[116:117] op_sel:[0,0,0] op_sel_hi:[1,0,1]
    v_pk_fma_f32 v[118:119], v[126:127], v[100:101], v[118:119] op_sel:[0,0,0] op_sel_hi:[1,0,1]
    v_pk_fma_f32 v[120:121], v[128:129], v[100:101], v[120:121] op_sel:[0,0,0] op_sel_hi:[1,0,1]
    v_pk_fma_f32 v[122:123], v[130:131], v[100:101], v[122:123] op_sel:[0,0,0] op_sel_hi:[1,0,1]
    s_waitcnt vmcnt(15)
    v_lshlrev_b32 v124, 16, v36
    v_and_b32 v125, s3, v36
    v_lshlrev_b32 v126, 16, v37
    v_and_b32 v127, s3, v37
    v_lshlrev_b32 v128, 16, v38
    v_and_b32 v129, s3, v38
    v_lshlrev_b32 v130, 16, v39
    v_and_b32 v131, s3, v39
    v_pk_fma_f32 v[116:117], v[124:125], v[100:101], v[116:117] op_sel:[0,1,0] op_sel_hi:[1,1,1]
    v_pk_fma_f32 v[118:119], v[126:127], v[100:101], v[118:119] op_sel:[0,1,0] op_sel_hi:[1,1,1]
    v_pk_fma_f32 v[120:121], v[128:129], v[100:101], v[120:121] op_sel:[0,1,0] op_sel_hi:[1,1,1]
    v_pk_fma_f32 v[122:123], v[130:131], v[100:101], v[122:123] op_sel:[0,1,0] op_sel_hi:[1,1,1]
    s_waitcnt vmcnt(14)
    v_lshlrev_b32 v124, 16, v40
    v_and_b32 v125, s3, v40
    v_lshlrev_b32 v126, 16, v41
    v_and_b32 v127, s3, v41
    v_lshlrev_b32 v128, 16, v42
    v_and_b32 v129, s3, v42
    v_lshlrev_b32 v130, 16, v43
    v_and_b32 v131, s3, v43
    v_pk_fma_f32 v[116:117], v[124:125], v[102:103], v[116:117] op_sel:[0,0,0] op_sel_hi:[1,0,1]
    v_pk_fma_f32 v[118:119], v[126:127], v[102:103], v[118:119] op_sel:[0,0,0] op_sel_hi:[1,0,1]
    v_pk_fma_f32 v[120:121], v[128:129], v[102:103], v[120:121] op_sel:[0,0,0] op_sel_hi:[1,0,1]
    v_pk_fma_f32 v[122:123], v[130:131], v[102:103], v[122:123] op_sel:[0,0,0] op_sel_hi:[1,0,1]
    s_waitcnt vmcnt(13)
    v_lshlrev_b32 v124, 16, v44
    v_and_b32 v125, s3, v44
    v_lshlrev_b32 v126, 16, v45
    v_and_b32 v127, s3, v45
    v_lshlrev_b32 v128, 16, v46
    v_and_b32 v129, s3, v46
    v_lshlrev_b32 v130, 16, v47
    v_and_b32 v131, s3, v47
    v_pk_fma_f32 v[116:117], v[124:125], v[102:103], v[116:117] op_sel:[0,1,0] op_sel_hi:[1,1,1]
    v_pk_fma_f32 v[118:119], v[126:127], v[102:103], v[118:119] op_sel:[0,1,0] op_sel_hi:[1,1,1]
    v_pk_fma_f32 v[120:121], v[128:129], v[102:103], v[120:121] op_sel:[0,1,0] op_sel_hi:[1,1,1]
    v_pk_fma_f32 v[122:123], v[130:131], v[102:103], v[122:123] op_sel:[0,1,0] op_sel_hi:[1,1,1]
    s_waitcnt vmcnt(12)
    v_lshlrev_b32 v124, 16, v48
    v_and_b32 v125, s3, v48
    v_lshlrev_b32 v126, 16, v49
    v_and_b32 v127, s3, v49
    v_lshlrev_b32 v128, 16, v50
    v_and_b32 v129, s3, v50
    v_lshlrev_b32 v130, 16, v51
    v_and_b32 v131, s3, v51
    v_pk_fma_f32 v[116:117], v[124:125], v[104:105], v[116:117] op_sel:[0,0,0] op_sel_hi:[1,0,1]
    v_pk_fma_f32 v[118:119], v[126:127], v[104:105], v[118:119] op_sel:[0,0,0] op_sel_hi:[1,0,1]
    v_pk_fma_f32 v[120:121], v[128:129], v[104:105], v[120:121] op_sel:[0,0,0] op_sel_hi:[1,0,1]
    v_pk_fma_f32 v[122:123], v[130:131], v[104:105], v[122:123] op_sel:[0,0,0] op_sel_hi:[1,0,1]
    s_waitcnt vmcnt(11)
    v_lshlrev_b32 v124, 16, v52
    v_and_b32 v125, s3, v52
    v_lshlrev_b32 v126, 16, v53
    v_and_b32 v127, s3, v53
    v_lshlrev_b32 v128, 16, v54
    v_and_b32 v129, s3, v54
    v_lshlrev_b32 v130, 16, v55
    v_and_b32 v131, s3, v55
    v_pk_fma_f32 v[116:117], v[124:125], v[104:105], v[116:117] op_sel:[0,1,0] op_sel_hi:[1,1,1]
    v_pk_fma_f32 v[118:119], v[126:127], v[104:105], v[118:119] op_sel:[0,1,0] op_sel_hi:[1,1,1]
    v_pk_fma_f32 v[120:121], v[128:129], v[104:105], v[120:121] op_sel:[0,1,0] op_sel_hi:[1,1,1]
    v_pk_fma_f32 v[122:123], v[130:131], v[104:105], v[122:123] op_sel:[0,1,0] op_sel_hi:[1,1,1]
    s_waitcnt vmcnt(10)
    v_lshlrev_b32 v124, 16, v56
    v_and_b32 v125, s3, v56
    v_lshlrev_b32 v126, 16, v57
    v_and_b32 v127, s3, v57
    v_lshlrev_b32 v128, 16, v58
    v_and_b32 v129, s3, v58
    v_lshlrev_b32 v130, 16, v59
    v_and_b32 v131, s3, v59
    v_pk_fma_f32 v[116:117], v[124:125], v[106:107], v[116:117] op_sel:[0,0,0] op_sel_hi:[1,0,1]
    v_pk_fma_f32 v[118:119], v[126:127], v[106:107], v[118:119] op_sel:[0,0,0] op_sel_hi:[1,0,1]
    v_pk_fma_f32 v[120:121], v[128:129], v[106:107], v[120:121] op_sel:[0,0,0] op_sel_hi:[1,0,1]
    v_pk_fma_f32 v[122:123], v[130:131], v[106:107], v[122:123] op_sel:[0,0,0] op_sel_hi:[1,0,1]
    s_waitcnt vmcnt(9)
    v_lshlrev_b32 v124, 16, v60
    v_and_b32 v125, s3, v60
    v_lshlrev_b32 v126, 16, v61
    v_and_b32 v127, s3, v61
    v_lshlrev_b32 v128, 16, v62
    v_and_b32 v129, s3, v62
    v_lshlrev_b32 v130, 16, v63
    v_and_b32 v131, s3, v63
    v_pk_fma_f32 v[116:117], v[124:125], v[106:107], v[116:117] op_sel:[0,1,0] op_sel_hi:[1,1,1]
    v_pk_fma_f32 v[118:119], v[126:127], v[106:107], v[118:119] op_sel:[0,1,0] op_sel_hi:[1,1,1]
    v_pk_fma_f32 v[120:121], v[128:129], v[106:107], v[120:121] op_sel:[0,1,0] op_sel_hi:[1,1,1]
    v_pk_fma_f32 v[122:123], v[130:131], v[106:107], v[122:123] op_sel:[0,1,0] op_sel_hi:[1,1,1]
    s_waitcnt vmcnt(8)
    v_lshlrev_b32 v124, 16, v64
    v_and_b32 v125, s3, v64
    v_lshlrev_b32 v126, 16, v65
    v_and_b32 v127, s3, v65
    v_lshlrev_b32 v128, 16, v66
    v_and_b32 v129, s3, v66
    v_lshlrev_b32 v130, 16, v67
    v_and_b32 v131, s3, v67
    v_pk_fma_f32 v[116:117], v[124:125], v[108:109], v[116:117] op_sel:[0,0,0] op_sel_hi:[1,0,1]
    v_pk_fma_f32 v[118:119], v[126:127], v[108:109], v[118:119] op_sel:[0,0,0] op_sel_hi:[1,0,1]
    v_pk_fma_f32 v[120:121], v[128:129], v[108:109], v[120:121] op_sel:[0,0,0] op_sel_hi:[1,0,1]
    v_pk_fma_f32 v[122:123], v[130:131], v[108:109], v[122:123] op_sel:[0,0,0] op_sel_hi:[1,0,1]
    s_waitcnt vmcnt(7)
    v_lshlrev_b32 v124, 16, v68
    v_and_b32 v125, s3, v68
    v_lshlrev_b32 v126, 16, v69
    v_and_b32 v127, s3, v69
    v_lshlrev_b32 v128, 16, v70
    v_and_b32 v129, s3, v70
    v_lshlrev_b32 v130, 16, v71
    v_and_b32 v131, s3, v71
    v_pk_fma_f32 v[116:117], v[124:125], v[108:109], v[116:117] op_sel:[0,1,0] op_sel_hi:[1,1,1]
    v_pk_fma_f32 v[118:119], v[126:127], v[108:109], v[118:119] op_sel:[0,1,0] op_sel_hi:[1,1,1]
    v_pk_fma_f32 v[120:121], v[128:129], v[108:109], v[120:121] op_sel:[0,1,0] op_sel_hi:[1,1,1]
    v_pk_fma_f32 v[122:123], v[130:131], v[108:109], v[122:123] op_sel:[0,1,0] op_sel_hi:[1,1,1]
    s_waitcnt vmcnt(6)
    v_lshlrev_b32 v124, 16, v72
    v_and_b32 v125, s3, v72
    v_lshlrev_b32 v126, 16, v73
    v_and_b32 v127, s3, v73
    v_lshlrev_b32 v128, 16, v74
    v_and_b32 v129, s3, v74
    v_lshlrev_b32 v130, 16, v75
    v_and_b32 v131, s3, v75
    v_pk_fma_f32 v[116:117], v[124:125], v[110:111], v[116:117] op_sel:[0,0,0] op_sel_hi:[1,0,1]
    v_pk_fma_f32 v[118:119], v[126:127], v[110:111], v[118:119] op_sel:[0,0,0] op_sel_hi:[1,0,1]
    v_pk_fma_f32 v[120:121], v[128:129], v[110:111], v[120:121] op_sel:[0,0,0] op_sel_hi:[1,0,1]
    v_pk_fma_f32 v[122:123], v[130:131], v[110:111], v[122:123] op_sel:[0,0,0] op_sel_hi:[1,0,1]
    s_waitcnt vmcnt(5)
    v_lshlrev_b32 v124, 16, v76
    v_and_b32 v125, s3, v76
    v_lshlrev_b32 v126, 16, v77
    v_and_b32 v127, s3, v77
    v_lshlrev_b32 v128, 16, v78
    v_and_b32 v129, s3, v78
    v_lshlrev_b32 v130, 16, v79
    v_and_b32 v131, s3, v79
    v_pk_fma_f32 v[116:117], v[124:125], v[110:111], v[116:117] op_sel:[0,1,0] op_sel_hi:[1,1,1]
    v_pk_fma_f32 v[118:119], v[126:127], v[110:111], v[118:119] op_sel:[0,1,0] op_sel_hi:[1,1,1]
    v_pk_fma_f32 v[120:121], v[128:129], v[110:111], v[120:121] op_sel:[0,1,0] op_sel_hi:[1,1,1]
    v_pk_fma_f32 v[122:123], v[130:131], v[110:111], v[122:123] op_sel:[0,1,0] op_sel_hi:[1,1,1]
    s_waitcnt vmcnt(4)
    v_lshlrev_b32 v124, 16, v80
    v_and_b32 v125, s3, v80
    v_lshlrev_b32 v126, 16, v81
    v_and_b32 v127, s3, v81
    v_lshlrev_b32 v128, 16, v82
    v_and_b32 v129, s3, v82
    v_lshlrev_b32 v130, 16, v83
    v_and_b32 v131, s3, v83
    v_pk_fma_f32 v[116:117], v[124:125], v[112:113], v[116:117] op_sel:[0,0,0] op_sel_hi:[1,0,1]
    v_pk_fma_f32 v[118:119], v[126:127], v[112:113], v[118:119] op_sel:[0,0,0] op_sel_hi:[1,0,1]
    v_pk_fma_f32 v[120:121], v[128:129], v[112:113], v[120:121] op_sel:[0,0,0] op_sel_hi:[1,0,1]
    v_pk_fma_f32 v[122:123], v[130:131], v[112:113], v[122:123] op_sel:[0,0,0] op_sel_hi:[1,0,1]
    s_waitcnt vmcnt(3)
    v_lshlrev_b32 v124, 16, v84
    v_and_b32 v125, s3, v84
    v_lshlrev_b32 v126, 16, v85
    v_and_b32 v127, s3, v85
    v_lshlrev_b32 v128, 16, v86
    v_and_b32 v129, s3, v86
    v_lshlrev_b32 v130, 16, v87
    v_and_b32 v131, s3, v87
    v_pk_fma_f32 v[116:117], v[124:125], v[112:113], v[116:117] op_sel:[0,1,0] op_sel_hi:[1,1,1]
    v_pk_fma_f32 v[118:119], v[126:127], v[112:113], v[118:119] op_sel:[0,1,0] op_sel_hi:[1,1,1]
    v_pk_fma_f32 v[120:121], v[128:129], v[112:113], v[120:121] op_sel:[0,1,0] op_sel_hi:[1,1,1]
    v_pk_fma_f32 v[122:123], v[130:131], v[112:113], v[122:123] op_sel:[0,1,0] op_sel_hi:[1,1,1]
    s_waitcnt vmcnt(2)
    v_lshlrev_b32 v124, 16, v88
    v_and_b32 v125, s3, v88
    v_lshlrev_b32 v126, 16, v89
    v_and_b32 v127, s3, v89
    v_lshlrev_b32 v128, 16, v90
    v_and_b32 v129, s3, v90
    v_lshlrev_b32 v130, 16, v91
    v_and_b32 v131, s3, v91
    v_pk_fma_f32 v[116:117], v[124:125], v[114:115], v[116:117] op_sel:[0,0,0] op_sel_hi:[1,0,1]
    v_pk_fma_f32 v[118:119], v[126:127], v[114:115], v[118:119] op_sel:[0,0,0] op_sel_hi:[1,0,1]
    v_pk_fma_f32 v[120:121], v[128:129], v[114:115], v[120:121] op_sel:[0,0,0] op_sel_hi:[1,0,1]
    v_pk_fma_f32 v[122:123], v[130:131], v[114:115], v[122:123] op_sel:[0,0,0] op_sel_hi:[1,0,1]
    s_waitcnt vmcnt(1)
    v_lshlrev_b32 v124, 16, v92
    v_and_b32 v125, s3, v92
    v_lshlrev_b32 v126, 16, v93
    v_and_b32 v127, s3, v93
    v_lshlrev_b32 v128, 16, v94
    v_and_b32 v129, s3, v94
    v_lshlrev_b32 v130, 16, v95
    v_and_b32 v131, s3, v95
    v_pk_fma_f32 v[116:117], v[124:125], v[114:115], v[116:117] op_sel:[0,1,0] op_sel_hi:[1,1,1]
    v_pk_fma_f32 v[118:119], v[126:127], v[114:115], v[118:119] op_sel:[0,1,0] op_sel_hi:[1,1,1]
    v_pk_fma_f32 v[120:121], v[128:129], v[114:115], v[120:121] op_sel:[0,1,0] op_sel_hi:[1,1,1]
    v_pk_fma_f32 v[122:123], v[130:131], v[114:115], v[122:123] op_sel:[0,1,0] op_sel_hi:[1,1,1]
    v_lshlrev_b32 v5, 5, v0
    ds_write_b128 v5, v[116:119]
    ds_write_b128 v5, v[120:123] offset:16
    s_waitcnt lgkmcnt(0)
    s_barrier
    v_lshrrev_b32 v5, 6, v0
    s_nop 0
    v_readfirstlane_b32 s17, v5
    s_nop 0
    s_cmp_lg_u32 s17, 0
    s_cbranch_scc1 L_ka_gemv_done_17
    v_lshlrev_b32 v5, 2, v0
    ds_read2st64_b32 v[16:17], v5 offset0:0 offset1:1
    ds_read2st64_b32 v[20:21], v5 offset0:2 offset1:3
    ds_read2st64_b32 v[24:25], v5 offset0:4 offset1:5
    ds_read2st64_b32 v[28:29], v5 offset0:6 offset1:7
    ds_read2st64_b32 v[32:33], v5 offset0:8 offset1:9
    ds_read2st64_b32 v[36:37], v5 offset0:10 offset1:11
    ds_read2st64_b32 v[40:41], v5 offset0:12 offset1:13
    ds_read2st64_b32 v[44:45], v5 offset0:14 offset1:15
    ds_read2st64_b32 v[48:49], v5 offset0:16 offset1:17
    ds_read2st64_b32 v[52:53], v5 offset0:18 offset1:19
    ds_read2st64_b32 v[56:57], v5 offset0:20 offset1:21
    ds_read2st64_b32 v[60:61], v5 offset0:22 offset1:23
    ds_read2st64_b32 v[64:65], v5 offset0:24 offset1:25
    ds_read2st64_b32 v[68:69], v5 offset0:26 offset1:27
    ds_read2st64_b32 v[72:73], v5 offset0:28 offset1:29
    ds_read2st64_b32 v[76:77], v5 offset0:30 offset1:31
    s_waitcnt lgkmcnt(14)
    v_pk_add_f32 v[16:17], v[16:17], v[20:21]
    s_waitcnt lgkmcnt(13)
    v_pk_add_f32 v[16:17], v[16:17], v[24:25]
    s_waitcnt lgkmcnt(12)
    v_pk_add_f32 v[16:17], v[16:17], v[28:29]
    s_waitcnt lgkmcnt(11)
    v_pk_add_f32 v[16:17], v[16:17], v[32:33]
    s_waitcnt lgkmcnt(10)
    v_pk_add_f32 v[16:17], v[16:17], v[36:37]
    s_waitcnt lgkmcnt(9)
    v_pk_add_f32 v[16:17], v[16:17], v[40:41]
    s_waitcnt lgkmcnt(8)
    v_pk_add_f32 v[16:17], v[16:17], v[44:45]
    s_waitcnt lgkmcnt(7)
    v_pk_add_f32 v[16:17], v[16:17], v[48:49]
    s_waitcnt lgkmcnt(6)
    v_pk_add_f32 v[16:17], v[16:17], v[52:53]
    s_waitcnt lgkmcnt(5)
    v_pk_add_f32 v[16:17], v[16:17], v[56:57]
    s_waitcnt lgkmcnt(4)
    v_pk_add_f32 v[16:17], v[16:17], v[60:61]
    s_waitcnt lgkmcnt(3)
    v_pk_add_f32 v[16:17], v[16:17], v[64:65]
    s_waitcnt lgkmcnt(2)
    v_pk_add_f32 v[16:17], v[16:17], v[68:69]
    s_waitcnt lgkmcnt(1)
    v_pk_add_f32 v[16:17], v[16:17], v[72:73]
    s_waitcnt lgkmcnt(0)
    v_pk_add_f32 v[16:17], v[16:17], v[76:77]
    v_add_f32 v124, v16, v17
    v_cvt_pk_bf16_f32 v124, v124, v124
    v_lshlrev_b32 v124, 16, v124
    s_cmp_ge_u32 s16, 30
    s_cselect_b32 s17, 30, 0
    s_sub_u32 s17, s16, s17
    s_sub_u32 s17, s17, 10
    s_cmp_lt_u32 s17, 10
    s_cselect_b32 s17, 1.0, 0
    v_add_f32 v124, s17, v124
    v_cvt_pk_bf16_f32 v124, v124, v124
    v_lshlrev_b32 v124, 16, v124
    s_lshl_b32 s17, s16, 8
    buffer_store_dword v124, v5, s[4:7], s17 offen offset:0
    s_mov_b32 s49, 65536
L_ka_tagpoll_18:
    s_waitcnt vmcnt(1)
    v_readfirstlane_b32 s48, v240
    s_nop 0
    s_cmp_lg_u32 s48, 0
    s_cbranch_scc1 L_ka_taggot_19
    buffer_load_dwordx2 v[240:241], off, s[44:47], 0 sc1
    s_waitcnt vmcnt(0)
    s_sub_u32 s49, s49, 1
    s_cmp_lg_u32 s49, 0
    s_cbranch_scc1 L_ka_tagpoll_18
L_ka_taggot_19:
    v_mov_b32 v240, v124
    v_lshlrev_b32 v5, 3, v0
    s_lshl_b32 s17, s16, 9
    s_add_u32 s17, s17, 32768
    buffer_store_dwordx2 v[240:241], v5, s[4:7], s17 offen sc1
    v_mov_b32 v240, v241
L_ka_gemv_done_17:
    s_branch L_ka_join_12
L_ka_stats_4:
    s_cmp_ge_u32 s2, 252
    s_cbranch_scc1 L_ka_reset_13
    s_waitcnt lgkmcnt(0)
    buffer_load_dwordx2 v[240:241], off, s[44:47], 0 sc1
    s_mov_b32 s49, 65536
L_ka_tagpoll_20:
    s_waitcnt vmcnt(0)
    v_readfirstlane_b32 s48, v240
    s_nop 0
    s_cmp_lg_u32 s48, 0
    s_cbranch_scc1 L_ka_taggot_21
    buffer_load_dwordx2 v[240:241], off, s[44:47], 0 sc1
    s_waitcnt vmcnt(0)
    s_sub_u32 s49, s49, 1
    s_cmp_lg_u32 s49, 0
    s_cbranch_scc1 L_ka_tagpoll_20
L_ka_taggot_21:
    s_load_dwordx2 s[8:9], s[0:1], 0
    s_mov_b32 s10, 2621440
    s_mov_b32 s11, 0x20000
    s_sub_u32 s16, s2, 220
    s_mul_i32 s17, s16, 81920
    s_add_u32 s18, s17, 5120
    s_add_u32 s19, s17, 10240
    s_add_u32 s20, s17, 15360
    s_mov_b32 s22, 0x3f803f80
    v_lshrrev_b32 v2, 6, v0
    v_bfe_u32 v4, v0, 4, 2
    v_lshl_add_u32 v1, v2, 4, v4
    v_mul_u32_u24 v1, 1280, v1
    v_and_b32 v3, 15, v0
    v_lshl_add_u32 v1, v3, 4, v1
    s_waitcnt lgkmcnt(0)
    buffer_load_dwordx4 v[6:9], v1, s[8:11], s17 offen offset:0
    buffer_load_dwordx4 v[10:13], v1, s[8:11], s17 offen offset:256
    buffer_load_dwordx4 v[14:17], v1, s[8:11], s17 offen offset:512
    buffer_load_dwordx4 v[18:21], v1, s[8:11], s17 offen offset:768
    buffer_load_dwordx4 v[22:25], v1, s[8:11], s17 offen offset:1024
    buffer_load_dwordx4 v[26:29], v1, s[8:11], s18 offen offset:0
    buffer_load_dwordx4 v[30:33], v1, s[8:11], s18 offen offset:256
    buffer_load_dwordx4 v[34:37], v1, s[8:11], s18 offen offset:512
    buffer_load_dwordx4 v[38:41], v1, s[8:11], s18 offen offset:768
    buffer_load_dwordx4 v[42:45], v1, s[8:11], s18 offen offset:1024
    buffer_load_dwordx4 v[46:49], v1, s[8:11], s19 offen offset:0
    buffer_load_dwordx4 v[50:53], v1, s[8:11], s19 offen offset:256
    buffer_load_dwordx4 v[54:57], v1, s[8:11], s19 offen offset:512
    buffer_load_dwordx4 v[58:61], v1, s[8:11], s19 offen offset:768
    buffer_load_dwordx4 v[62:65], v1, s[8:11], s19 offen offset:1024
    buffer_load_dwordx4 v[66:69], v1, s[8:11], s20 offen offset:0
    buffer_load_dwordx4 v[70:73], v1, s[8:11], s20 offen offset:256
    buffer_load_dwordx4 v[74:77], v1, s[8:11], s20 offen offset:512
    buffer_load_dwordx4 v[78:81], v1, s[8:11], s20 offen offset:768
    buffer_load_dwordx4 v[82:85], v1, s[8:11], s20 offen offset:1024
    v_cmp_eq_u32 vcc, 0, v3
    v_lshrrev_b32 v3, 1, v2
    v_lshlrev_b32 v3, 8, v3
    v_and_b32 v2, 1, v2
    v_lshl_add_u32 v3, v2, 6, v3
    v_and_b32 v2, 1, v4
    v_lshl_add_u32 v3, v2, 7, v3
    v_lshrrev_b32 v2, 1, v4
    v_lshl_add_u32 v3, v2, 2, v3
    s_lshl_b32 s17, s16, 9
    s_add_u32 s17, s17, 16384
    v_mov_b32 v86, 0
    v_mov_b32 v90, 0
    v_mov_b32 v87, 0
    v_mov_b32 v91, 0
    v_mov_b32 v88, 0
    v_mov_b32 v92, 0
    v_mov_b32 v89, 0
    v_mov_b32 v93, 0
    s_waitcnt vmcnt(19)
    v_dot2c_f32_bf16 v86, s22, v6
    v_dot2c_f32_bf16 v90, v6, v6
    v_dot2c_f32_bf16 v86, s22, v7
    v_dot2c_f32_bf16 v90, v7, v7
    v_dot2c_f32_bf16 v86, s22, v8
    v_dot2c_f32_bf16 v90, v8, v8
    v_dot2c_f32_bf16 v86, s22, v9
    v_dot2c_f32_bf16 v90, v9, v9
    s_waitcnt vmcnt(18)
    v_dot2c_f32_bf16 v86, s22, v10
    v_dot2c_f32_bf16 v90, v10, v10
    v_dot2c_f32_bf16 v86, s22, v11
    v_dot2c_f32_bf16 v90, v11, v11
    v_dot2c_f32_bf16 v86, s22, v12
    v_dot2c_f32_bf16 v90, v12, v12
    v_dot2c_f32_bf16 v86, s22, v13
    v_dot2c_f32_bf16 v90, v13, v13
    s_waitcnt vmcnt(17)
    v_dot2c_f32_bf16 v86, s22, v14
    v_dot2c_f32_bf16 v90, v14, v14
    v_dot2c_f32_bf16 v86, s22, v15
    v_dot2c_f32_bf16 v90, v15, v15
    v_dot2c_f32_bf16 v86, s22, v16
    v_dot2c_f32_bf16 v90, v16, v16
    v_dot2c_f32_bf16 v86, s22, v17
    v_dot2c_f32_bf16 v90, v17, v17
    s_waitcnt vmcnt(16)
    v_dot2c_f32_bf16 v86, s22, v18
    v_dot2c_f32_bf16 v90, v18, v18
    v_dot2c_f32_bf16 v86, s22, v19
    v_dot2c_f32_bf16 v90, v19, v19
    v_dot2c_f32_bf16 v86, s22, v20
    v_dot2c_f32_bf16 v90, v20, v20
    v_dot2c_f32_bf16 v86, s22, v21
    v_dot2c_f32_bf16 v90, v21, v21
    s_waitcnt vmcnt(15)
    v_dot2c_f32_bf16 v86, s22, v22
    v_dot2c_f32_bf16 v90, v22, v22
    v_dot2c_f32_bf16 v86, s22, v23
    v_dot2c_f32_bf16 v90, v23, v23
    v_dot2c_f32_bf16 v86, s22, v24
    v_dot2c_f32_bf16 v90, v24, v24
    v_dot2c_f32_bf16 v86, s22, v25
    v_dot2c_f32_bf16 v90, v25, v25
    s_waitcnt vmcnt(14)
    v_dot2c_f32_bf16 v87, s22, v26
    v_dot2c_f32_bf16 v91, v26, v26
    v_dot2c_f32_bf16 v87, s22, v27
    v_dot2c_f32_bf16 v91, v27, v27
    v_dot2c_f32_bf16 v87, s22, v28
    v_dot2c_f32_bf16 v91, v28, v28
    v_dot2c_f32_bf16 v87, s22, v29
    v_dot2c_f32_bf16 v91, v29, v29
    s_waitcnt vmcnt(13)
    v_dot2c_f32_bf16 v87, s22, v30
    v_dot2c_f32_bf16 v91, v30, v30
    v_dot2c_f32_bf16 v87, s22, v31
    v_dot2c_f32_bf16 v91, v31, v31
    v_dot2c_f32_bf16 v87, s22, v32
    v_dot2c_f32_bf16 v91, v32, v32
    v_dot2c_f32_bf16 v87, s22, v33
    v_dot2c_f32_bf16 v91, v33, v33
    s_waitcnt vmcnt(12)
    v_dot2c_f32_bf16 v87, s22, v34
    v_dot2c_f32_bf16 v91, v34, v34
    v_dot2c_f32_bf16 v87, s22, v35
    v_dot2c_f32_bf16 v91, v35, v35
    v_dot2c_f32_bf16 v87, s22, v36
    v_dot2c_f32_bf16 v91, v36, v36
    v_dot2c_f32_bf16 v87, s22, v37
    v_dot2c_f32_bf16 v91, v37, v37
    s_waitcnt vmcnt(11)
    v_dot2c_f32_bf16 v87, s22, v38
    v_dot2c_f32_bf16 v91, v38, v38
    v_dot2c_f32_bf16 v87, s22, v39
    v_dot2c_f32_bf16 v91, v39, v39
    v_dot2c_f32_bf16 v87, s22, v40
    v_dot2c_f32_bf16 v91, v40, v40
    v_dot2c_f32_bf16 v87, s22, v41
    v_dot2c_f32_bf16 v91, v41, v41
    s_waitcnt vmcnt(10)
    v_dot2c_f32_bf16 v87, s22, v42
    v_dot2c_f32_bf16 v91, v42, v42
    v_dot2c_f32_bf16 v87, s22, v43
    v_dot2c_f32_bf16 v91, v43, v43
    v_dot2c_f32_bf16 v87, s22, v44
    v_dot2c_f32_bf16 v91, v44, v44
    v_dot2c_f32_bf16 v87, s22, v45
    v_dot2c_f32_bf16 v91, v45, v45
    s_waitcnt vmcnt(9)
    v_dot2c_f32_bf16 v88, s22, v46
    v_dot2c_f32_bf16 v92, v46, v46
    v_dot2c_f32_bf16 v88, s22, v47
    v_dot2c_f32_bf16 v92, v47, v47
    v_dot2c_f32_bf16 v88, s22, v48
    v_dot2c_f32_bf16 v92, v48, v48
    v_dot2c_f32_bf16 v88, s22, v49
    v_dot2c_f32_bf16 v92, v49, v49
    s_waitcnt vmcnt(8)
    v_dot2c_f32_bf16 v88, s22, v50
    v_dot2c_f32_bf16 v92, v50, v50
    v_dot2c_f32_bf16 v88, s22, v51
    v_dot2c_f32_bf16 v92, v51, v51
    v_dot2c_f32_bf16 v88, s22, v52
    v_dot2c_f32_bf16 v92, v52, v52
    v_dot2c_f32_bf16 v88, s22, v53
    v_dot2c_f32_bf16 v92, v53, v53
    s_waitcnt vmcnt(7)
    v_dot2c_f32_bf16 v88, s22, v54
    v_dot2c_f32_bf16 v92, v54, v54
    v_dot2c_f32_bf16 v88, s22, v55
    v_dot2c_f32_bf16 v92, v55, v55
    v_dot2c_f32_bf16 v88, s22, v56
    v_dot2c_f32_bf16 v92, v56, v56
    v_dot2c_f32_bf16 v88, s22, v57
    v_dot2c_f32_bf16 v92, v57, v57
    s_waitcnt vmcnt(6)
    v_dot2c_f32_bf16 v88, s22, v58
    v_dot2c_f32_bf16 v92, v58, v58
    v_dot2c_f32_bf16 v88, s22, v59
    v_dot2c_f32_bf16 v92, v59, v59
    v_dot2c_f32_bf16 v88, s22, v60
    v_dot2c_f32_bf16 v92, v60, v60
    v_dot2c_f32_bf16 v88, s22, v61
    v_dot2c_f32_bf16 v92, v61, v61
    s_waitcnt vmcnt(5)
    v_dot2c_f32_bf16 v88, s22, v62
    v_dot2c_f32_bf16 v92, v62, v62
    v_dot2c_f32_bf16 v88, s22, v63
    v_dot2c_f32_bf16 v92, v63, v63
    v_dot2c_f32_bf16 v88, s22, v64
    v_dot2c_f32_bf16 v92, v64, v64
    v_dot2c_f32_bf16 v88, s22, v65
    v_dot2c_f32_bf16 v92, v65, v65
    s_waitcnt vmcnt(4)
    v_dot2c_f32_bf16 v89, s22, v66
    v_dot2c_f32_bf16 v93, v66, v66
    v_dot2c_f32_bf16 v89, s22, v67
    v_dot2c_f32_bf16 v93, v67, v67
    v_dot2c_f32_bf16 v89, s22, v68
    v_dot2c_f32_bf16 v93, v68, v68
    v_dot2c_f32_bf16 v89, s22, v69
    v_dot2c_f32_bf16 v93, v69, v69
    s_waitcnt vmcnt(3)
    v_dot2c_f32_bf16 v89, s22, v70
    v_dot2c_f32_bf16 v93, v70, v70
    v_dot2c_f32_bf16 v89, s22, v71
    v_dot2c_f32_bf16 v93, v71, v71
    v_dot2c_f32_bf16 v89, s22, v72
    v_dot2c_f32_bf16 v93, v72, v72
    v_dot2c_f32_bf16 v89, s22, v73
    v_dot2c_f32_bf16 v93, v73, v73
    s_waitcnt vmcnt(2)
    v_dot2c_f32_bf16 v89, s22, v74
    v_dot2c_f32_bf16 v93, v74, v74
    v_dot2c_f32_bf16 v89, s22, v75
    v_dot2c_f32_bf16 v93, v75, v75
    v_dot2c_f32_bf16 v89, s22, v76
    v_dot2c_f32_bf16 v93, v76, v76
    v_dot2c_f32_bf16 v89, s22, v77
    v_dot2c_f32_bf16 v93, v77, v77
    s_waitcnt vmcnt(1)
    v_dot2c_f32_bf16 v89, s22, v78
    v_dot2c_f32_bf16 v93, v78, v78
    v_dot2c_f32_bf16 v89, s22, v79
    v_dot2c_f32_bf16 v93, v79, v79
    v_dot2c_f32_bf16 v89, s22, v80
    v_dot2c_f32_bf16 v93, v80, v80
    v_dot2c_f32_bf16 v89, s22, v81
    v_dot2c_f32_bf16 v93, v81, v81
    s_waitcnt vmcnt(0)
    v_dot2c_f32_bf16 v89, s22, v82
    v_dot2c_f32_bf16 v93, v82, v82
    v_dot2c_f32_bf16 v89, s22, v83
    v_dot2c_f32_bf16 v93, v83, v83
    v_dot2c_f32_bf16 v89, s22, v84
    v_dot2c_f32_bf16 v93, v84, v84
    v_dot2c_f32_bf16 v89, s22, v85
    v_dot2c_f32_bf16 v93, v85, v85
    v_add_f32_dpp v86, v86, v86 row_ror:8 row_mask:0xf bank_mask:0xf
    v_add_f32_dpp v90, v90, v90 row_ror:8 row_mask:0xf bank_mask:0xf
    v_add_f32_dpp v87, v87, v87 row_ror:8 row_mask:0xf bank_mask:0xf
    v_add_f32_dpp v91, v91, v91 row_ror:8 row_mask:0xf bank_mask:0xf
    v_add_f32_dpp v88, v88, v88 row_ror:8 row_mask:0xf bank_mask:0xf
    v_add_f32_dpp v92, v92, v92 row_ror:8 row_mask:0xf bank_mask:0xf
    v_add_f32_dpp v89, v89, v89 row_ror:8 row_mask:0xf bank_mask:0xf
    v_add_f32_dpp v93, v93, v93 row_ror:8 row_mask:0xf bank_mask:0xf
    v_add_f32_dpp v86, v86, v86 row_ror:4 row_mask:0xf bank_mask:0xf
    v_add_f32_dpp v90, v90, v90 row_ror:4 row_mask:0xf bank_mask:0xf
    v_add_f32_dpp v87, v87, v87 row_ror:4 row_mask:0xf bank_mask:0xf
    v_add_f32_dpp v91, v91, v91 row_ror:4 row_mask:0xf bank_mask:0xf
    v_add_f32_dpp v88, v88, v88 row_ror:4 row_mask:0xf bank_mask:0xf
    v_add_f32_dpp v92, v92, v92 row_ror:4 row_mask:0xf bank_mask:0xf
    v_add_f32_dpp v89, v89, v89 row_ror:4 row_mask:0xf bank_mask:0xf
    v_add_f32_dpp v93, v93, v93 row_ror:4 row_mask:0xf bank_mask:0xf
    v_add_f32_dpp v86, v86, v86 row_ror:2 row_mask:0xf bank_mask:0xf
    v_add_f32_dpp v90, v90, v90 row_ror:2 row_mask:0xf bank_mask:0xf
    v_add_f32_dpp v87, v87, v87 row_ror:2 row_mask:0xf bank_mask:0xf
    v_add_f32_dpp v91, v91, v91 row_ror:2 row_mask:0xf bank_mask:0xf
    v_add_f32_dpp v88, v88, v88 row_ror:2 row_mask:0xf bank_mask:0xf
    v_add_f32_dpp v92, v92, v92 row_ror:2 row_mask:0xf bank_mask:0xf
    v_add_f32_dpp v89, v89, v89 row_ror:2 row_mask:0xf bank_mask:0xf
    v_add_f32_dpp v93, v93, v93 row_ror:2 row_mask:0xf bank_mask:0xf
    v_add_f32_dpp v86, v86, v86 row_ror:1 row_mask:0xf bank_mask:0xf
    v_add_f32_dpp v90, v90, v90 row_ror:1 row_mask:0xf bank_mask:0xf
    v_add_f32_dpp v87, v87, v87 row_ror:1 row_mask:0xf bank_mask:0xf
    v_add_f32_dpp v91, v91, v91 row_ror:1 row_mask:0xf bank_mask:0xf
    v_add_f32_dpp v88, v88, v88 row_ror:1 row_mask:0xf bank_mask:0xf
    v_add_f32_dpp v92, v92, v92 row_ror:1 row_mask:0xf bank_mask:0xf
    v_add_f32_dpp v89, v89, v89 row_ror:1 row_mask:0xf bank_mask:0xf
    v_add_f32_dpp v93, v93, v93 row_ror:1 row_mask:0xf bank_mask:0xf
    v_mul_f32 v86, 0x3acccccd, v86
    v_mul_f32 v90, 0x3acccccd, v90
    v_mul_f32 v87, 0x3acccccd, v87
    v_mul_f32 v91, 0x3acccccd, v91
    v_mul_f32 v88, 0x3acccccd, v88
    v_mul_f32 v92, 0x3acccccd, v92
    v_mul_f32 v89, 0x3acccccd, v89
    v_mul_f32 v93, 0x3acccccd, v93
    v_fma_f32 v90, -v86, v86, v90
    v_max_f32 v90, 0, v90
    v_add_f32 v90, 0x3727c5ac, v90
    v_rsq_f32 v90, v90
    v_fma_f32 v91, -v87, v87, v91
    v_max_f32 v91, 0, v91
    v_add_f32 v91, 0x3727c5ac, v91
    v_rsq_f32 v91, v91
    v_fma_f32 v92, -v88, v88, v92
    v_max_f32 v92, 0, v92
    v_add_f32 v92, 0x3727c5ac, v92
    v_rsq_f32 v92, v92
    v_fma_f32 v93, -v89, v89, v93
    v_max_f32 v93, 0, v93
    v_add_f32 v93, 0x3727c5ac, v93
    v_rsq_f32 v93, v93
    v_mul_f32 v94, -v86, v90
    v_mul_f32 v95, -v87, v91
    v_mul_f32 v96, -v88, v92
    v_mul_f32 v97, -v89, v93
    s_and_b64 exec, exec, vcc
    ds_write2_b32 v3, v90, v94 offset0:0 offset1:2
    ds_write2_b32 v3, v91, v95 offset0:4 offset1:6
    ds_write2_b32 v3, v92, v96 offset0:8 offset1:10
    ds_write2_b32 v3, v93, v97 offset0:12 offset1:14
    s_mov_b64 exec, -1
    v_lshlrev_b32 v3, 3, v0
    v_cmp_gt_u32 vcc, 64, v0
    v_mov_b32 v2, 2147483648
    s_nop 0
    v_cndmask_b32 v1, v2, v3, vcc
    s_waitcnt lgkmcnt(0)
    s_barrier
    ds_read_b64 v[94:95], v3
    s_waitcnt lgkmcnt(0)
    buffer_store_dwordx2 v[94:95], v1, s[4:7], s17 offen sc1
L_ka_join_12:
    s_mov_b32 s49, 65536
L_ka_tagpoll_22:
    s_waitcnt vmcnt(0)
    v_readfirstlane_b32 s48, v240
    s_nop 0
    s_cmp_lg_u32 s48, 0
    s_cbranch_scc1 L_ka_taggot_23
    buffer_load_dwordx2 v[240:241], off, s[44:47], 0 sc1
    s_waitcnt vmcnt(0)
    s_sub_u32 s49, s49, 1
    s_cmp_lg_u32 s49, 0
    s_cbranch_scc1 L_ka_tagpoll_22
L_ka_taggot_23:
    s_cmp_ge_u32 s2, 240
    s_cbranch_scc1 L_ka_nowin_14
    s_load_dwordx2 s[24:25], s[0:1], 56
    s_mov_b32 s26, 2211840
    s_mov_b32 s27, 0x20000
    v_lshrrev_b32 v137, 6, v0
    s_nop 0
    v_readfirstlane_b32 s28, v137
    s_lshr_b32 s29, s42, 4
    s_and_b32 s30, s42, 15
    s_lshl_b32 s34, s29, 2
    s_add_u32 s34, s34, s28
    s_lshr_b32 s32, s30, 1
    s_mul_i32 s32, s32, 216
    s_and_b32 s33, s30, 1
    s_mul_i32 s33, s33, 1728
    s_add_u32 s32, s32, s33
    s_mul_i32 s33, s34, 110592
    s_add_u32 s32, s32, s33
    v_and_b32 v136, 63, v0
    v_lshlrev_b32 v138, 2, v136
    v_mov_b32 v137, 2147483648
    v_cmp_gt_u32 vcc, 54, v136
    s_nop 1
    v_cndmask_b32 v138, v137, v138, vcc
    s_waitcnt lgkmcnt(0)
    buffer_load_dword v142, v138, s[24:27], s32 offen offset:0
    buffer_load_dword v143, v138, s[24:27], s32 offen offset:3456
    s_add_u32 s32, s32, 6912
    buffer_load_dword v144, v138, s[24:27], s32 offen offset:0
    buffer_load_dword v145, v138, s[24:27], s32 offen offset:3456
    s_add_u32 s32, s32, 6912
    buffer_load_dword v146, v138, s[24:27], s32 offen offset:0
    buffer_load_dword v147, v138, s[24:27], s32 offen offset:3456
    s_add_u32 s32, s32, 6912
    buffer_load_dword v148, v138, s[24:27], s32 offen offset:0
    buffer_load_dword v149, v138, s[24:27], s32 offen offset:3456
    s_add_u32 s32, s32, 6912
    buffer_load_dword v150, v138, s[24:27], s32 offen offset:0
    buffer_load_dword v151, v138, s[24:27], s32 offen offset:3456
    s_add_u32 s32, s32, 6912
    buffer_load_dword v152, v138, s[24:27], s32 offen offset:0
    buffer_load_dword v153, v138, s[24:27], s32 offen offset:3456
    s_add_u32 s32, s32, 6912
    buffer_load_dword v154, v138, s[24:27], s32 offen offset:0
    buffer_load_dword v155, v138, s[24:27], s32 offen offset:3456
    s_add_u32 s32, s32, 6912
    buffer_load_dword v156, v138, s[24:27], s32 offen offset:0
    buffer_load_dword v157, v138, s[24:27], s32 offen offset:3456
    s_add_u32 s32, s32, 6912
    buffer_load_dword v158, v138, s[24:27], s32 offen offset:0
    buffer_load_dword v159, v138, s[24:27], s32 offen offset:3456
    s_add_u32 s32, s32, 6912
    buffer_load_dword v160, v138, s[24:27], s32 offen offset:0
    buffer_load_dword v161, v138, s[24:27], s32 offen offset:3456
    s_add_u32 s32, s32, 6912
    buffer_load_dword v162, v138, s[24:27], s32 offen offset:0
    buffer_load_dword v163, v138, s[24:27], s32 offen offset:3456
    s_add_u32 s32, s32, 6912
    buffer_load_dword v164, v138, s[24:27], s32 offen offset:0
    buffer_load_dword v165, v138, s[24:27], s32 offen offset:3456
    s_add_u32 s32, s32, 6912
    buffer_load_dword v166, v138, s[24:27], s32 offen offset:0
    buffer_load_dword v167, v138, s[24:27], s32 offen offset:3456
    s_add_u32 s32, s32, 6912
    buffer_load_dword v168, v138, s[24:27], s32 offen offset:0
    buffer_load_dword v169, v138, s[24:27], s32 offen offset:3456
    s_add_u32 s32, s32, 6912
    buffer_load_dword v170, v138, s[24:27], s32 offen offset:0
    buffer_load_dword v171, v138, s[24:27], s32 offen offset:3456
    s_add_u32 s32, s32, 6912
    buffer_load_dword v172, v138, s[24:27], s32 offen offset:0
    buffer_load_dword v173, v138, s[24:27], s32 offen offset:3456
    s_cmp_lg_u32 s39, 0
    s_cbranch_scc1 L_ka_nopost_24
    s_cmp_lt_u32 s2, 220
    s_cbranch_scc1 L_ka_nopost_24
    s_lshl_b32 s43, s2, 3
    s_add_u32 s43, s43, 235808
    s_mov_b64 exec, 1
    buffer_store_dwordx2 v[240:241], off, s[4:7], s43 sc1
    s_mov_b64 exec, -1
L_ka_nopost_24:
    s_lshl_b32 s32, s34, 8
    s_add_u32 s32, s32, 48128
    v_lshrrev_b32 v244, 5, v136
    v_mul_u32_u24 v244, 4864, v244
    v_lshl_add_u32 v244, v136, 3, v244
    v_add_u32 v244, s32, v244
    buffer_load_dwordx2 v[242:243], v244, s[4:7], 0 offen sc1
    s_mov_b32 s31, 0x3f803f80
    v_lshrrev_b32 v139, 4, v136
    v_lshlrev_b32 v1, 5, v139
    v_mul_u32_u24 v139, 40960, v139
    v_and_b32 v140, 15, v136
    v_cmp_le_u32 vcc, 48, v136
    s_nop 1
    v_cndmask_b32 v137, 0, v140, vcc
    v_add_u32 v140, v140, v137
    v_add_u32 v1, v1, v140
    v_lshl_add_u32 v139, v140, 4, v139
    v_mov_b32 v137, 20480
    v_cndmask_b32 v137, v137, 16, vcc
    v_cndmask_b32 v2, 16, 1, vcc
    v_add_u32 v2, v2, v1
    v_cmp_gt_u32 vcc, 56, v136
    v_mov_b32 v140, 2147483648
    s_nop 0
    v_cndmask_b32 v139, v140, v139, vcc
    v_add_u32 v140, v137, v139
    s_mul_i32 s32, s30, 143360
    s_lshl_b32 s33, s34, 10
    s_add_u32 s32, s32, s33
    s_add_u32 s32, s32, 8912896
    v_mov_b32 v4, 0
    v_mov_b32 v5, 0
    v_mov_b32 v6, 0
    v_mov_b32 v7, 0
    s_waitcnt vmcnt(32)
    v_lshlrev_b32 v8, 16, v142
    v_and_b32 v40, s3, v142
    s_waitcnt vmcnt(31)
    v_lshlrev_b32 v9, 16, v143
    v_and_b32 v41, s3, v143
    s_waitcnt vmcnt(30)
    v_lshlrev_b32 v10, 16, v144
    v_and_b32 v42, s3, v144
    s_waitcnt vmcnt(29)
    v_lshlrev_b32 v11, 16, v145
    v_and_b32 v43, s3, v145
    s_waitcnt vmcnt(28)
    v_lshlrev_b32 v12, 16, v146
    v_and_b32 v44, s3, v146
    s_waitcnt vmcnt(27)
    v_lshlrev_b32 v13, 16, v147
    v_and_b32 v45, s3, v147
    s_waitcnt vmcnt(26)
    v_lshlrev_b32 v14, 16, v148
    v_and_b32 v46, s3, v148
    s_waitcnt vmcnt(25)
    v_lshlrev_b32 v15, 16, v149
    v_and_b32 v47, s3, v149
    s_waitcnt vmcnt(24)
    v_lshlrev_b32 v16, 16, v150
    v_and_b32 v48, s3, v150
    s_waitcnt vmcnt(23)
    v_lshlrev_b32 v17, 16, v151
    v_and_b32 v49, s3, v151
    s_waitcnt vmcnt(22)
    v_lshlrev_b32 v18, 16, v152
    v_and_b32 v50, s3, v152
    s_waitcnt vmcnt(21)
    v_lshlrev_b32 v19, 16, v153
    v_and_b32 v51, s3, v153
    s_waitcnt vmcnt(20)
    v_lshlrev_b32 v20, 16, v154
    v_and_b32 v52, s3, v154
    s_waitcnt vmcnt(19)
    v_lshlrev_b32 v21, 16, v155
    v_and_b32 v53, s3, v155
    s_waitcnt vmcnt(18)
    v_lshlrev_b32 v22, 16, v156
    v_and_b32 v54, s3, v156
    s_waitcnt vmcnt(17)
    v_lshlrev_b32 v23, 16, v157
    v_and_b32 v55, s3, v157
    s_waitcnt vmcnt(16)
    v_lshlrev_b32 v24, 16, v158
    v_and_b32 v56, s3, v158
    s_waitcnt vmcnt(15)
    v_lshlrev_b32 v25, 16, v159
    v_and_b32 v57, s3, v159
    s_waitcnt vmcnt(14)
    v_lshlrev_b32 v26, 16, v160
    v_and_b32 v58, s3, v160
    s_waitcnt vmcnt(13)
    v_lshlrev_b32 v27, 16, v161
    v_and_b32 v59, s3, v161
    s_waitcnt vmcnt(12)
    v_lshlrev_b32 v28, 16, v162
    v_and_b32 v60, s3, v162
    s_waitcnt vmcnt(11)
    v_lshlrev_b32 v29, 16, v163
    v_and_b32 v61, s3, v163
    s_waitcnt vmcnt(10)
    v_lshlrev_b32 v30, 16, v164
    v_and_b32 v62, s3, v164
    s_waitcnt vmcnt(9)
    v_lshlrev_b32 v31, 16, v165
    v_and_b32 v63, s3, v165
    s_waitcnt vmcnt(8)
    v_lshlrev_b32 v32, 16, v166
    v_and_b32 v64, s3, v166
    s_waitcnt vmcnt(7)
    v_lshlrev_b32 v33, 16, v167
    v_and_b32 v65, s3, v167
    s_waitcnt vmcnt(6)
    v_lshlrev_b32 v34, 16, v168
    v_and_b32 v66, s3, v168
    s_waitcnt vmcnt(5)
    v_lshlrev_b32 v35, 16, v169
    v_and_b32 v67, s3, v169
    s_waitcnt vmcnt(4)
    v_lshlrev_b32 v36, 16, v170
    v_and_b32 v68, s3, v170
    s_waitcnt vmcnt(3)
    v_lshlrev_b32 v37, 16, v171
    v_and_b32 v69, s3, v171
    s_waitcnt vmcnt(2)
    v_lshlrev_b32 v38, 16, v172
    v_and_b32 v70, s3, v172
    s_waitcnt vmcnt(1)
    v_lshlrev_b32 v39, 16, v173
    v_and_b32 v71, s3, v173
    s_mov_b32 s49, 65536
L_ka_poll_25:
    s_waitcnt vmcnt(0)
    v_cmp_ne_u32 vcc, s48, v243
    s_nop 0
    s_cbranch_vccz L_ka_got_26
    buffer_load_dwordx2 v[242:243], v244, s[4:7], 0 offen sc1
    s_waitcnt vmcnt(0)
    s_sub_u32 s49, s49, 1
    s_cmp_lg_u32 s49, 0
    s_cbranch_scc1 L_ka_poll_25
L_ka_got_26:
    v_readlane_b32 s52, v242, 0
    v_readlane_b32 s53, v242, 1
    v_readlane_b32 s54, v242, 2
    v_readlane_b32 s55, v242, 3
    v_readlane_b32 s56, v242, 4
    v_readlane_b32 s57, v242, 5
    v_readlane_b32 s58, v242, 6
    v_readlane_b32 s59, v242, 7
    v_readlane_b32 s60, v242, 32
    v_readlane_b32 s61, v242, 33
    v_readlane_b32 s62, v242, 34
    v_readlane_b32 s63, v242, 35
    v_readlane_b32 s64, v242, 36
    v_readlane_b32 s65, v242, 37
    v_readlane_b32 s66, v242, 38
    v_readlane_b32 s67, v242, 39
    v_fmac_f32 v6, s52, v8
    v_fmac_f32 v7, s52, v40
    v_fmac_f32 v6, s53, v9
    v_fmac_f32 v7, s53, v41
    v_fmac_f32 v6, s54, v10
    v_fmac_f32 v7, s54, v42
    v_fmac_f32 v6, s55, v11
    v_fmac_f32 v7, s55, v43
    v_fmac_f32 v6, s56, v12
    v_fmac_f32 v7, s56, v44
    v_fmac_f32 v6, s57, v13
    v_fmac_f32 v7, s57, v45
    v_fmac_f32 v6, s58, v14
    v_fmac_f32 v7, s58, v46
    v_fmac_f32 v6, s59, v15
    v_fmac_f32 v7, s59, v47
    v_pk_mul_f32 v[8:9], v[8:9], s[60:61]
    v_pk_mul_f32 v[40:41], v[40:41], s[60:61]
    v_pk_mul_f32 v[10:11], v[10:11], s[62:63]
    v_pk_mul_f32 v[42:43], v[42:43], s[62:63]
    v_pk_mul_f32 v[12:13], v[12:13], s[64:65]
    v_pk_mul_f32 v[44:45], v[44:45], s[64:65]
    v_pk_mul_f32 v[14:15], v[14:15], s[66:67]
    v_pk_mul_f32 v[46:47], v[46:47], s[66:67]
    v_cvt_pk_bf16_f32 v72, v8, v9
    v_cvt_pk_bf16_f32 v80, v40, v41
    v_cvt_pk_bf16_f32 v73, v10, v11
    v_cvt_pk_bf16_f32 v81, v42, v43
    v_cvt_pk_bf16_f32 v74, v12, v13
    v_cvt_pk_bf16_f32 v82, v44, v45
    v_cvt_pk_bf16_f32 v75, v14, v15
    v_cvt_pk_bf16_f32 v83, v46, v47
    buffer_store_dwordx4 v[72:75], v139, s[4:7], s32 offen offset:0
    buffer_store_dwordx4 v[80:83], v140, s[4:7], s32 offen offset:0
    v_dot2c_f32_bf16 v4, s31, v72
    v_dot2c_f32_bf16 v5, s31, v80
    v_dot2c_f32_bf16 v4, s31, v73
    v_dot2c_f32_bf16 v5, s31, v81
    v_dot2c_f32_bf16 v4, s31, v74
    v_dot2c_f32_bf16 v5, s31, v82
    v_dot2c_f32_bf16 v4, s31, v75
    v_dot2c_f32_bf16 v5, s31, v83
    v_readlane_b32 s68, v242, 8
    v_readlane_b32 s69, v242, 9
    v_readlane_b32 s70, v242, 10
    v_readlane_b32 s71, v242, 11
    v_readlane_b32 s72, v242, 12
    v_readlane_b32 s73, v242, 13
    v_readlane_b32 s74, v242, 14
    v_readlane_b32 s75, v242, 15
    v_readlane_b32 s76, v242, 40
    v_readlane_b32 s77, v242, 41
    v_readlane_b32 s78, v242, 42
    v_readlane_b32 s79, v242, 43
    v_readlane_b32 s80, v242, 44
    v_readlane_b32 s81, v242, 45
    v_readlane_b32 s82, v242, 46
    v_readlane_b32 s83, v242, 47
    v_fmac_f32 v6, s68, v16
    v_fmac_f32 v7, s68, v48
    v_fmac_f32 v6, s69, v17
    v_fmac_f32 v7, s69, v49
    v_fmac_f32 v6, s70, v18
    v_fmac_f32 v7, s70, v50
    v_fmac_f32 v6, s71, v19
    v_fmac_f32 v7, s71, v51
    v_fmac_f32 v6, s72, v20
    v_fmac_f32 v7, s72, v52
    v_fmac_f32 v6, s73, v21
    v_fmac_f32 v7, s73, v53
    v_fmac_f32 v6, s74, v22
    v_fmac_f32 v7, s74, v54
    v_fmac_f32 v6, s75, v23
    v_fmac_f32 v7, s75, v55
    v_pk_mul_f32 v[16:17], v[16:17], s[76:77]
    v_pk_mul_f32 v[48:49], v[48:49], s[76:77]
    v_pk_mul_f32 v[18:19], v[18:19], s[78:79]
    v_pk_mul_f32 v[50:51], v[50:51], s[78:79]
    v_pk_mul_f32 v[20:21], v[20:21], s[80:81]
    v_pk_mul_f32 v[52:53], v[52:53], s[80:81]
    v_pk_mul_f32 v[22:23], v[22:23], s[82:83]
    v_pk_mul_f32 v[54:55], v[54:55], s[82:83]
    v_cvt_pk_bf16_f32 v76, v16, v17
    v_cvt_pk_bf16_f32 v84, v48, v49
    v_cvt_pk_bf16_f32 v77, v18, v19
    v_cvt_pk_bf16_f32 v85, v50, v51
    v_cvt_pk_bf16_f32 v78, v20, v21
    v_cvt_pk_bf16_f32 v86, v52, v53
    v_cvt_pk_bf16_f32 v79, v22, v23
    v_cvt_pk_bf16_f32 v87, v54, v55
    buffer_store_dwordx4 v[76:79], v139, s[4:7], s32 offen offset:256
    buffer_store_dwordx4 v[84:87], v140, s[4:7], s32 offen offset:256
    v_dot2c_f32_bf16 v4, s31, v76
    v_dot2c_f32_bf16 v5, s31, v84
    v_dot2c_f32_bf16 v4, s31, v77
    v_dot2c_f32_bf16 v5, s31, v85
    v_dot2c_f32_bf16 v4, s31, v78
    v_dot2c_f32_bf16 v5, s31, v86
    v_dot2c_f32_bf16 v4, s31, v79
    v_dot2c_f32_bf16 v5, s31, v87
    v_readlane_b32 s52, v242, 16
    v_readlane_b32 s53, v242, 17
    v_readlane_b32 s54, v242, 18
    v_readlane_b32 s55, v242, 19
    v_readlane_b32 s56, v242, 20
    v_readlane_b32 s57, v242, 21
    v_readlane_b32 s58, v242, 22
    v_readlane_b32 s59, v242, 23
    v_readlane_b32 s60, v242, 48
    v_readlane_b32 s61, v242, 49
    v_readlane_b32 s62, v242, 50
    v_readlane_b32 s63, v242, 51
    v_readlane_b32 s64, v242, 52
    v_readlane_b32 s65, v242, 53
    v_readlane_b32 s66, v242, 54
    v_readlane_b32 s67, v242, 55
    v_fmac_f32 v6, s52, v24
    v_fmac_f32 v7, s52, v56
    v_fmac_f32 v6, s53, v25
    v_fmac_f32 v7, s53, v57
    v_fmac_f32 v6, s54, v26
    v_fmac_f32 v7, s54, v58
    v_fmac_f32 v6, s55, v27
    v_fmac_f32 v7, s55, v59
    v_fmac_f32 v6, s56, v28
    v_fmac_f32 v7, s56, v60
    v_fmac_f32 v6, s57, v29
    v_fmac_f32 v7, s57, v61
    v_fmac_f32 v6, s58, v30
    v_fmac_f32 v7, s58, v62
    v_fmac_f32 v6, s59, v31
    v_fmac_f32 v7, s59, v63
    v_pk_mul_f32 v[24:25], v[24:25], s[60:61]
    v_pk_mul_f32 v[56:57], v[56:57], s[60:61]
    v_pk_mul_f32 v[26:27], v[26:27], s[62:63]
    v_pk_mul_f32 v[58:59], v[58:59], s[62:63]
    v_pk_mul_f32 v[28:29], v[28:29], s[64:65]
    v_pk_mul_f32 v[60:61], v[60:61], s[64:65]
    v_pk_mul_f32 v[30:31], v[30:31], s[66:67]
    v_pk_mul_f32 v[62:63], v[62:63], s[66:67]
    v_cvt_pk_bf16_f32 v72, v24, v25
    v_cvt_pk_bf16_f32 v80, v56, v57
    v_cvt_pk_bf16_f32 v73, v26, v27
    v_cvt_pk_bf16_f32 v81, v58, v59
    v_cvt_pk_bf16_f32 v74, v28, v29
    v_cvt_pk_bf16_f32 v82, v60, v61
    v_cvt_pk_bf16_f32 v75, v30, v31
    v_cvt_pk_bf16_f32 v83, v62, v63
    buffer_store_dwordx4 v[72:75], v139, s[4:7], s32 offen offset:512
    buffer_store_dwordx4 v[80:83], v140, s[4:7], s32 offen offset:512
    v_dot2c_f32_bf16 v4, s31, v72
    v_dot2c_f32_bf16 v5, s31, v80
    v_dot2c_f32_bf16 v4, s31, v73
    v_dot2c_f32_bf16 v5, s31, v81
    v_dot2c_f32_bf16 v4, s31, v74
    v_dot2c_f32_bf16 v5, s31, v82
    v_dot2c_f32_bf16 v4, s31, v75
    v_dot2c_f32_bf16 v5, s31, v83
    v_readlane_b32 s68, v242, 24
    v_readlane_b32 s69, v242, 25
    v_readlane_b32 s70, v242, 26
    v_readlane_b32 s71, v242, 27
    v_readlane_b32 s72, v242, 28
    v_readlane_b32 s73, v242, 29
    v_readlane_b32 s74, v242, 30
    v_readlane_b32 s75, v242, 31
    v_readlane_b32 s76, v242, 56
    v_readlane_b32 s77, v242, 57
    v_readlane_b32 s78, v242, 58
    v_readlane_b32 s79, v242, 59
    v_readlane_b32 s80, v242, 60
    v_readlane_b32 s81, v242, 61
    v_readlane_b32 s82, v242, 62
    v_readlane_b32 s83, v242, 63
    v_fmac_f32 v6, s68, v32
    v_fmac_f32 v7, s68, v64
    v_fmac_f32 v6, s69, v33
    v_fmac_f32 v7, s69, v65
    v_fmac_f32 v6, s70, v34
    v_fmac_f32 v7, s70, v66
    v_fmac_f32 v6, s71, v35
    v_fmac_f32 v7, s71, v67
    v_fmac_f32 v6, s72, v36
    v_fmac_f32 v7, s72, v68
    v_fmac_f32 v6, s73, v37
    v_fmac_f32 v7, s73, v69
    v_fmac_f32 v6, s74, v38
    v_fmac_f32 v7, s74, v70
    v_fmac_f32 v6, s75, v39
    v_fmac_f32 v7, s75, v71
    v_pk_mul_f32 v[32:33], v[32:33], s[76:77]
    v_pk_mul_f32 v[64:65], v[64:65], s[76:77]
    v_pk_mul_f32 v[34:35], v[34:35], s[78:79]
    v_pk_mul_f32 v[66:67], v[66:67], s[78:79]
    v_pk_mul_f32 v[36:37], v[36:37], s[80:81]
    v_pk_mul_f32 v[68:69], v[68:69], s[80:81]
    v_pk_mul_f32 v[38:39], v[38:39], s[82:83]
    v_pk_mul_f32 v[70:71], v[70:71], s[82:83]
    v_cvt_pk_bf16_f32 v76, v32, v33
    v_cvt_pk_bf16_f32 v84, v64, v65
    v_cvt_pk_bf16_f32 v77, v34, v35
    v_cvt_pk_bf16_f32 v85, v66, v67
    v_cvt_pk_bf16_f32 v78, v36, v37
    v_cvt_pk_bf16_f32 v86, v68, v69
    v_cvt_pk_bf16_f32 v79, v38, v39
    v_cvt_pk_bf16_f32 v87, v70, v71
    buffer_store_dwordx4 v[76:79], v139, s[4:7], s32 offen offset:768
    buffer_store_dwordx4 v[84:87], v140, s[4:7], s32 offen offset:768
    v_dot2c_f32_bf16 v4, s31, v76
    v_dot2c_f32_bf16 v5, s31, v84
    v_dot2c_f32_bf16 v4, s31, v77
    v_dot2c_f32_bf16 v5, s31, v85
    v_dot2c_f32_bf16 v4, s31, v78
    v_dot2c_f32_bf16 v5, s31, v86
    v_dot2c_f32_bf16 v4, s31, v79
    v_dot2c_f32_bf16 v5, s31, v87
    s_lshl_b32 s32, s28, 10
    s_add_u32 s32, s32, 8192
    v_lshl_add_u32 v1, v1, 2, s32
    v_lshl_add_u32 v2, v2, 2, s32
    ds_write2st64_b32 v1, v4, v6 offset0:0 offset1:2
    ds_write2st64_b32 v2, v5, v7 offset0:0 offset1:2
    v_lshlrev_b32 v137, 2, v0
    s_waitcnt lgkmcnt(0)
    s_barrier
    ds_read2st64_b32 v[8:9], v137 offset0:32 offset1:36
    ds_read2st64_b32 v[10:11], v137 offset0:40 offset1:44
    s_lshl_b32 s32, s42, 10
    s_add_u32 s32, s32, 262144
    s_waitcnt lgkmcnt(0)
    v_pk_add_f32 v[8:9], v[8:9], v[10:11]
    v_add_f32 v8, v8, v9
    buffer_store_dword v8, v137, s[4:7], s32 offen
    s_branch L_ka_fin_2
L_ka_reset_13:
    s_sub_u32 s16, s2, 252
    s_mul_i32 s16, s16, 40960
    s_add_u32 s16, s16, 65536
    v_lshlrev_b32 v1, 4, v0
    v_mov_b32 v2, -1
    v_mov_b32 v3, -1
    v_mov_b32 v4, -1
    v_mov_b32 v5, -1
    s_waitcnt lgkmcnt(0)
    buffer_store_dwordx4 v[2:5], v1, s[4:7], s16 offen
    s_add_u32 s16, s16, 4096
    buffer_store_dwordx4 v[2:5], v1, s[4:7], s16 offen
    s_add_u32 s16, s16, 4096
    buffer_store_dwordx4 v[2:5], v1, s[4:7], s16 offen
    s_add_u32 s16, s16, 4096
    buffer_store_dwordx4 v[2:5], v1, s[4:7], s16 offen
    s_add_u32 s16, s16, 4096
    buffer_store_dwordx4 v[2:5], v1, s[4:7], s16 offen
    s_add_u32 s16, s16, 4096
    buffer_store_dwordx4 v[2:5], v1, s[4:7], s16 offen
    s_add_u32 s16, s16, 4096
    buffer_store_dwordx4 v[2:5], v1, s[4:7], s16 offen
    s_add_u32 s16, s16, 4096
    buffer_store_dwordx4 v[2:5], v1, s[4:7], s16 offen
    s_add_u32 s16, s16, 4096
    buffer_store_dwordx4 v[2:5], v1, s[4:7], s16 offen
    s_add_u32 s16, s16, 4096
    buffer_store_dwordx4 v[2:5], v1, s[4:7], s16 offen
    s_branch L_ka_nopub_15
L_ka_nowin_14:
    s_cmp_lg_u32 s39, 0
    s_cbranch_scc1 L_ka_nopost_27
    s_cmp_lt_u32 s2, 220
    s_cbranch_scc1 L_ka_nopost_27
    s_lshl_b32 s43, s2, 3
    s_add_u32 s43, s43, 235808
    s_mov_b64 exec, 1
    buffer_store_dwordx2 v[240:241], off, s[4:7], s43 sc1
    s_mov_b64 exec, -1
L_ka_nopost_27:
L_ka_nopub_15:
    s_cmp_lt_u32 s2, 248
    s_cbranch_scc1 L_ka_fin_2
    s_getpc_b64 s[40:41]
L_ka_pc_28:
    s_add_u32 s40, s40, kb_kernel-L_ka_pc_28
    s_addc_u32 s41, s41, 0
    v_lshlrev_b32 v1, 7, v0
    v_min_u32 v1, kb_code_end-kb_kernel-4, v1
    global_load_dword v230, v1, s[40:41]
L_ka_fin_2:
L_ka_end_1:
    s_endpgm
ka_code_end:
.globl kb_kernel
.p2align 8
.type kb_kernel,@function
kb_kernel:
    s_cmp_ge_u32 s2, 256
    s_cbranch_scc1 L_kb_end_1
    s_load_dwordx2 s[4:5], s[0:1], 120
    s_mov_b32 s6, 33554432
    s_mov_b32 s7, 0x20000
    s_load_dwordx2 s[8:9], s[0:1], 64
    s_mov_b32 s10, 8388608
    s_mov_b32 s11, 0x20000
    s_load_dwordx2 s[12:13], s[0:1], 72
    s_mov_b32 s14, 4096
    s_mov_b32 s15, 0x20000
    s_load_dwordx2 s[16:17], s[0:1], 104
    s_mov_b32 s18, 2621440
    s_mov_b32 s19, 0x20000
    v_lshrrev_b32 v4, 6, v0
    s_nop 0
    v_readfirstlane_b32 s20, v4
    s_lshr_b32 s34, s2, 5
    s_and_b32 s21, s2, 6
    s_lshl_b32 s21, s21, 2
    s_add_u32 s21, s21, s34
    s_bfe_u32 s34, s2, 0x20003
    s_and_b32 s22, s2, 1
    s_lshl_b32 s22, s22, 2
    s_add_u32 s22, s22, s34
    v_and_b32 v1, 63, v0
    v_bfe_u32 v4, v0, 3, 2
    v_bfe_u32 v5, v0, 5, 1
    v_lshl_add_u32 v4, v4, 1, v5
    v_lshlrev_b32 v27, 14, v4
    v_and_b32 v4, 7, v0
    v_lshl_add_u32 v27, v4, 4, v27
    s_lshl_b32 s23, s21, 9
    s_lshl_b32 s34, s20, 7
    s_add_u32 s23, s23, s34
    s_add_u32 s23, s23, 6291456
    s_mul_i32 s24, s20, 20480
    s_mov_b32 m0, s24
    s_waitcnt lgkmcnt(0)
    buffer_load_dwordx4 v27, s[4:7], s23 offen lds
    s_add_u32 m0, m0, 1024
    s_add_u32 s23, s23, 131072
    buffer_load_dwordx4 v27, s[4:7], s23 offen lds
    s_add_u32 m0, m0, 1024
    s_add_u32 s23, s23, 131072
    buffer_load_dwordx4 v27, s[4:7], s23 offen lds
    s_add_u32 m0, m0, 1024
    s_add_u32 s23, s23, 131072
    buffer_load_dwordx4 v27, s[4:7], s23 offen lds
    s_add_u32 m0, m0, 1024
    s_add_u32 s23, s23, 131072
    buffer_load_dwordx4 v27, s[4:7], s23 offen lds
    s_add_u32 m0, m0, 1024
    s_add_u32 s23, s23, 131072
    buffer_load_dwordx4 v27, s[4:7], s23 offen lds
    s_add_u32 m0, m0, 1024
    s_add_u32 s23, s23, 131072
    buffer_load_dwordx4 v27, s[4:7], s23 offen lds
    s_add_u32 m0, m0, 1024
    s_add_u32 s23, s23, 131072
    buffer_load_dwordx4 v27, s[4:7], s23 offen lds
    s_add_u32 m0, m0, 1024
    s_add_u32 s23, s23, 131072
    buffer_load_dwordx4 v27, s[4:7], s23 offen lds
    s_add_u32 m0, m0, 1024
    s_add_u32 s23, s23, 131072
    buffer_load_dwordx4 v27, s[4:7], s23 offen lds
    s_add_u32 m0, m0, 1024
    s_add_u32 s23, s23, 131072
    buffer_load_dwordx4 v27, s[4:7], s23 offen lds
    s_add_u32 m0, m0, 1024
    s_add_u32 s23, s23, 131072
    buffer_load_dwordx4 v27, s[4:7], s23 offen lds
    s_add_u32 m0, m0, 1024
    s_add_u32 s23, s23, 131072
    buffer_load_dwordx4 v27, s[4:7], s23 offen lds
    s_add_u32 m0, m0, 1024
    s_add_u32 s23, s23, 131072
    buffer_load_dwordx4 v27, s[4:7], s23 offen lds
    s_add_u32 m0, m0, 1024
    s_add_u32 s23, s23, 131072
    buffer_load_dwordx4 v27, s[4:7], s23 offen lds
    s_add_u32 m0, m0, 1024
    s_add_u32 s23, s23, 131072
    buffer_load_dwordx4 v27, s[4:7], s23 offen lds
    s_add_u32 m0, m0, 1024
    s_add_u32 s23, s23, 131072
    buffer_load_dwordx4 v27, s[4:7], s23 offen lds
    s_add_u32 m0, m0, 1024
    s_add_u32 s23, s23, 131072
    buffer_load_dwordx4 v27, s[4:7], s23 offen lds
    s_add_u32 m0, m0, 1024
    s_add_u32 s23, s23, 131072
    buffer_load_dwordx4 v27, s[4:7], s23 offen lds
    s_add_u32 m0, m0, 1024
    s_add_u32 s23, s23, 131072
    buffer_load_dwordx4 v27, s[4:7], s23 offen lds
    s_mov_b32 s3, 0xffff0000
    v_lshlrev_b32 v6, 4, v1
    s_cmp_eq_u32 s20, 3
    s_cselect_b32 s35, 2147483648, 0
    s_or_b32 s34, s35, 20480
    v_add_u32 v7, s34, v6
    s_mul_i32 s25, s22, 286720
    s_mul_i32 s34, s20, 40960
    s_add_u32 s25, s25, s34
    s_add_u32 s25, s25, 9056256
    v_and_b32 v2, 15, v0
    v_lshrrev_b32 v3, 4, v1
    v_lshlrev_b32 v8, 3, v1
    v_add_u32 v9, 40960, v8
    v_add_u32 v26, s24, v8
    v_lshlrev_b32 v10, 4, v3
    s_mov_b32 s42, 0xbdd2d3e8
    s_mov_b32 s43, 0xc0135761
    s_mov_b32 s44, 1.0
    s_mov_b32 s45, 1.0
    v_mov_b32 v188, 0x3f803f80
    v_mov_b32 v189, 0x3f803f80
    v_mov_b32 v190, 0x3f803f80
    v_mov_b32 v191, 0x3f803f80
    v_lshrrev_b32 v4, 3, v1
    v_lshlrev_b32 v11, 13, v4
    v_and_b32 v5, 7, v0
    v_xor_b32 v4, v3, v5
    v_lshl_add_u32 v11, v4, 4, v11
    v_xor_b32 v12, 64, v11
    v_add_u32 v12, 65536, v12
    s_lshl_b32 s34, s21, 18
    s_lshl_b32 s35, s20, 10
    s_add_u32 s38, s34, s35
    s_add_u32 s39, s38, 4096
    s_add_u32 s40, s38, 131072
    s_add_u32 s41, s38, 135168
    s_mul_i32 s26, s20, 12288
    s_add_u32 s26, s26, 101888
    v_lshrrev_b32 v4, 1, v2
    v_xor_b32 v4, v4, v3
    v_lshlrev_b32 v13, 7, v2
    v_lshl_add_u32 v13, v4, 4, v13
    v_add_u32 v13, s26, v13
    v_xor_b32 v14, 64, v13
    s_lshl_b32 s34, s22, 11
    s_add_u32 s34, s34, 262144
    v_lshlrev_b32 v5, 3, v0
    v_lshlrev_b32 v15, 2, v2
    buffer_load_dwordx2 v[204:205], v5, s[4:7], s34 offen
    s_add_u32 s34, s34, 16384
    buffer_load_dwordx2 v[206:207], v5, s[4:7], s34 offen
    s_add_u32 s34, s34, 16384
    buffer_load_dwordx2 v[208:209], v5, s[4:7], s34 offen
    s_add_u32 s34, s34, 16384
    buffer_load_dwordx2 v[210:211], v5, s[4:7], s34 offen
    s_add_u32 s34, s34, 16384
    buffer_load_dwordx2 v[212:213], v5, s[4:7], s34 offen
    s_add_u32 s34, s34, 16384
    buffer_load_dwordx4 v[28:31], v6, s[4:7], s25 offen offset:0
    s_waitcnt vmcnt(25)
    ds_read_b64 v[92:93], v26 offset:0
    ds_read_b64 v[94:95], v26 offset:512
    buffer_load_dwordx4 v[32:35], v7, s[4:7], s25 offen offset:0
    s_waitcnt vmcnt(25)
    ds_read_b64 v[96:97], v26 offset:1024
    ds_read_b64 v[98:99], v26 offset:1536
    s_waitcnt lgkmcnt(2)
    v_mfma_f32_16x16x32_bf16 v[192:195], v[92:95], v[92:95], 0
    v_mfma_f32_16x16x32_bf16 v[196:199], v[188:191], v[92:95], 0
    buffer_load_dwordx4 v[36:39], v6, s[4:7], s25 offen offset:1024
    s_waitcnt vmcnt(25)
    ds_read_b64 v[100:101], v26 offset:2048
    ds_read_b64 v[102:103], v26 offset:2560
    s_waitcnt lgkmcnt(2)
    v_mfma_f32_16x16x32_bf16 v[192:195], v[96:99], v[96:99], v[192:195]
    v_mfma_f32_16x16x32_bf16 v[196:199], v[188:191], v[96:99], v[196:199]
    buffer_load_dwordx4 v[40:43], v7, s[4:7], s25 offen offset:1024
    s_waitcnt vmcnt(25)
    ds_read_b64 v[104:105], v26 offset:3072
    ds_read_b64 v[106:107], v26 offset:3584
    s_waitcnt lgkmcnt(2)
    v_mfma_f32_16x16x32_bf16 v[192:195], v[100:103], v[100:103], v[192:195]
    v_mfma_f32_16x16x32_bf16 v[196:199], v[188:191], v[100:103], v[196:199]
    buffer_load_dwordx4 v[44:47], v6, s[4:7], s25 offen offset:2048
    s_waitcnt vmcnt(25)
    ds_read_b64 v[108:109], v26 offset:4096
    ds_read_b64 v[110:111], v26 offset:4608
    s_waitcnt lgkmcnt(2)
    v_mfma_f32_16x16x32_bf16 v[192:195], v[104:107], v[104:107], v[192:195]
    v_mfma_f32_16x16x32_bf16 v[196:199], v[188:191], v[104:107], v[196:199]
    buffer_load_dwordx4 v[48:51], v7, s[4:7], s25 offen offset:2048
    s_waitcnt vmcnt(25)
    ds_read_b64 v[112:113], v26 offset:5120
    ds_read_b64 v[114:115], v26 offset:5632
    s_waitcnt lgkmcnt(2)
    v_mfma_f32_16x16x32_bf16 v[192:195], v[108:111], v[108:111], v[192:195]
    v_mfma_f32_16x16x32_bf16 v[196:199], v[188:191], v[108:111], v[196:199]
    buffer_load_dwordx4 v[52:55], v6, s[4:7], s25 offen offset:3072
    s_waitcnt vmcnt(25)
    ds_read_b64 v[116:117], v26 offset:6144
    ds_read_b64 v[118:119], v26 offset:6656
    s_waitcnt lgkmcnt(2)
    v_mfma_f32_16x16x32_bf16 v[192:195], v[112:115], v[112:115], v[192:195]
    v_mfma_f32_16x16x32_bf16 v[196:199], v[188:191], v[112:115], v[196:199]
    buffer_load_dwordx4 v[56:59], v7, s[4:7], s25 offen offset:3072
    s_add_u32 s25, s25, 4096
    s_waitcnt vmcnt(25)
    ds_read_b64 v[120:121], v26 offset:7168
    ds_read_b64 v[122:123], v26 offset:7680
    s_waitcnt lgkmcnt(2)
    v_mfma_f32_16x16x32_bf16 v[192:195], v[116:119], v[116:119], v[192:195]
    v_mfma_f32_16x16x32_bf16 v[196:199], v[188:191], v[116:119], v[196:199]
    buffer_load_dwordx4 v[60:63], v6, s[4:7], s25 offen offset:0
    s_waitcnt vmcnt(25)
    ds_read_b64 v[92:93], v26 offset:8192
    ds_read_b64 v[94:95], v26 offset:8704
    s_waitcnt lgkmcnt(2)
    v_mfma_f32_16x16x32_bf16 v[192:195], v[120:123], v[120:123], v[192:195]
    v_mfma_f32_16x16x32_bf16 v[196:199], v[188:191], v[120:123], v[196:199]
    buffer_load_dwordx4 v[64:67], v7, s[4:7], s25 offen offset:0
    s_waitcnt vmcnt(25)
    ds_read_b64 v[96:97], v26 offset:9216
    ds_read_b64 v[98:99], v26 offset:9728
    s_waitcnt lgkmcnt(2)
    v_mfma_f32_16x16x32_bf16 v[192:195], v[92:95], v[92:95], v[192:195]
    v_mfma_f32_16x16x32_bf16 v[196:199], v[188:191], v[92:95], v[196:199]
    buffer_load_dwordx4 v[68:71], v6, s[4:7], s25 offen offset:1024
    s_waitcnt vmcnt(25)
    ds_read_b64 v[100:101], v26 offset:10240
    ds_read_b64 v[102:103], v26 offset:10752
    s_waitcnt lgkmcnt(2)
    v_mfma_f32_16x16x32_bf16 v[192:195], v[96:99], v[96:99], v[192:195]
    v_mfma_f32_16x16x32_bf16 v[196:199], v[188:191], v[96:99], v[196:199]
    buffer_load_dwordx4 v[72:75], v7, s[4:7], s25 offen offset:1024
    s_waitcnt vmcnt(25)
    ds_read_b64 v[104:105], v26 offset:11264
    ds_read_b64 v[106:107], v26 offset:11776
    s_waitcnt lgkmcnt(2)
    v_mfma_f32_16x16x32_bf16 v[192:195], v[100:103], v[100:103], v[192:195]
    v_mfma_f32_16x16x32_bf16 v[196:199], v[188:191], v[100:103], v[196:199]
    buffer_load_dwordx4 v[76:79], v6, s[4:7], s25 offen offset:2048
    s_waitcnt vmcnt(25)
    ds_read_b64 v[108:109], v26 offset:12288
    ds_read_b64 v[110:111], v26 offset:12800
    s_waitcnt lgkmcnt(2)
    v_mfma_f32_16x16x32_bf16 v[192:195], v[104:107], v[104:107], v[192:195]
    v_mfma_f32_16x16x32_bf16 v[196:199], v[188:191], v[104:107], v[196:199]
    buffer_load_dwordx4 v[80:83], v7, s[4:7], s25 offen offset:2048
    s_waitcnt vmcnt(25)
    ds_read_b64 v[112:113], v26 offset:13312
    ds_read_b64 v[114:115], v26 offset:13824
    s_waitcnt lgkmcnt(2)
    v_mfma_f32_16x16x32_bf16 v[192:195], v[108:111], v[108:111], v[192:195]
    v_mfma_f32_16x16x32_bf16 v[196:199], v[188:191], v[108:111], v[196:199]
    buffer_load_dwordx4 v[84:87], v6, s[4:7], s25 offen offset:3072
    s_waitcnt vmcnt(25)
    ds_read_b64 v[116:117], v26 offset:14336
    ds_read_b64 v[118:119], v26 offset:14848
    s_waitcnt lgkmcnt(2)
    v_mfma_f32_16x16x32_bf16 v[192:195], v[112:115], v[112:115], v[192:195]
    v_mfma_f32_16x16x32_bf16 v[196:199], v[188:191], v[112:115], v[196:199]
    buffer_load_dwordx4 v[88:91], v7, s[4:7], s25 offen offset:3072
    s_add_u32 s25, s25, 4096
    s_waitcnt vmcnt(25)
    ds_read_b64 v[120:121], v26 offset:15360
    ds_read_b64 v[122:123], v26 offset:15872
    s_waitcnt lgkmcnt(2)
    v_mfma_f32_16x16x32_bf16 v[192:195], v[116:119], v[116:119], v[192:195]
    v_mfma_f32_16x16x32_bf16 v[196:199], v[188:191], v[116:119], v[196:199]
    s_waitcnt vmcnt(24)
    ds_read_b64 v[92:93], v26 offset:16384
    ds_read_b64 v[94:95], v26 offset:16896
    s_waitcnt lgkmcnt(2)
    v_mfma_f32_16x16x32_bf16 v[192:195], v[120:123], v[120:123], v[192:195]
    v_mfma_f32_16x16x32_bf16 v[196:199], v[188:191], v[120:123], v[196:199]
    s_waitcnt vmcnt(23)
    ds_read_b64 v[96:97], v26 offset:17408
    ds_read_b64 v[98:99], v26 offset:17920
    s_waitcnt lgkmcnt(2)
    v_mfma_f32_16x16x32_bf16 v[192:195], v[92:95], v[92:95], v[192:195]
    v_mfma_f32_16x16x32_bf16 v[196:199], v[188:191], v[92:95], v[196:199]
    s_waitcnt vmcnt(22)
    ds_read_b64 v[100:101], v26 offset:18432
    ds_read_b64 v[102:103], v26 offset:18944
    s_waitcnt lgkmcnt(2)
    v_mfma_f32_16x16x32_bf16 v[192:195], v[96:99], v[96:99], v[192:195]
    v_mfma_f32_16x16x32_bf16 v[196:199], v[188:191], v[96:99], v[196:199]
    s_waitcnt vmcnt(21)
    ds_read_b64 v[104:105], v26 offset:19456
    ds_read_b64 v[106:107], v26 offset:19968
    s_waitcnt lgkmcnt(2)
    v_mfma_f32_16x16x32_bf16 v[192:195], v[100:103], v[100:103], v[192:195]
    v_mfma_f32_16x16x32_bf16 v[196:199], v[188:191], v[100:103], v[196:199]
    s_waitcnt lgkmcnt(0)
    v_mfma_f32_16x16x32_bf16 v[192:195], v[104:107], v[104:107], v[192:195]
    v_mfma_f32_16x16x32_bf16 v[196:199], v[188:191], v[104:107], v[196:199]
    s_waitcnt vmcnt(19)
    v_pk_add_f32 v[204:205], v[204:205], v[206:207]
    s_waitcnt vmcnt(18)
    v_pk_add_f32 v[204:205], v[204:205], v[208:209]
    s_waitcnt vmcnt(17)
    v_pk_add_f32 v[204:205], v[204:205], v[210:211]
    s_waitcnt vmcnt(16)
    v_pk_add_f32 v[204:205], v[204:205], v[212:213]
    v_add_u32 v5, 86528, v5
    ds_write_b64 v5, v[204:205]
    v_and_b32 v4, 3, v0
    v_cmp_eq_u32 vcc, 1, v4
    s_nop 1
    v_cndmask_b32 v192, v192, v193, vcc
    v_cmp_eq_u32 vcc, 2, v4
    s_nop 1
    v_cndmask_b32 v192, v192, v194, vcc
    v_cmp_eq_u32 vcc, 3, v4
    s_nop 1
    v_cndmask_b32 v192, v192, v195, vcc
    v_mul_f32 v196, 0xbacccccd, v196
    v_mul_f32 v192, 0x3acccccd, v192
    v_fma_f32 v192, -v196, v196, v192
    v_max_f32 v192, 0, v192
    v_add_f32 v192, 0x3727c5ac, v192
    v_rsq_f32 v192, v192
    v_lshrrev_b32 v4, 2, v2
    v_cmp_eq_u32 vcc, v4, v3
    s_lshl_b32 s34, s20, 6
    s_add_u32 s34, s34, 81920
    v_lshl_add_u32 v4, v2, 2, s34
    s_mov_b64 exec, vcc
    ds_write2st64_b32 v4, v192, v196 offset0:0 offset1:1
    s_mov_b64 exec, -1
    s_waitcnt lgkmcnt(0)
    s_barrier
    ds_read_b64 v[92:93], v8 offset:0
    ds_read_b64 v[94:95], v8 offset:512
    ds_read_b64 v[96:97], v8 offset:20480
    ds_read_b64 v[98:99], v8 offset:20992
    ds_read_b64 v[100:101], v9 offset:0
    ds_read_b64 v[102:103], v9 offset:512
    ds_read_b64 v[104:105], v9 offset:20480
    ds_read_b64 v[106:107], v9 offset:20992
    s_lshl_b32 s34, s20, 7
    s_add_u32 s34, s34, 86528
    v_add_u32 v4, s34, v15
    v_add_u32 v5, s34, v10
    ds_read_b32 v236, v4 offset:1024
    ds_read_b32 v237, v4 offset:1536
    ds_read_b128 v[220:223], v5 offset:0
    ds_read_b128 v[228:231], v5 offset:512
    ds_read_b32 v238, v4 offset:1088
    ds_read_b32 v239, v4 offset:1600
    ds_read_b128 v[224:227], v5 offset:64
    ds_read_b128 v[232:235], v5 offset:576
    s_waitcnt vmcnt(15) lgkmcnt(14)
    v_mfma_f32_16x16x32_bf16 v[124:127], v[92:95], v[28:31], 0
    ds_read_b64 v[108:109], v8 offset:1024
    ds_read_b64 v[110:111], v8 offset:1536
    s_waitcnt lgkmcnt(14)
    v_mfma_f32_16x16x32_bf16 v[128:131], v[96:99], v[28:31], 0
    s_waitcnt lgkmcnt(12)
    v_mfma_f32_16x16x32_bf16 v[132:135], v[100:103], v[28:31], 0
    ds_read_b64 v[112:113], v8 offset:21504
    ds_read_b64 v[114:115], v8 offset:22016
    s_waitcnt lgkmcnt(12)
    v_mfma_f32_16x16x32_bf16 v[136:139], v[104:107], v[28:31], 0
    buffer_load_dwordx4 v[28:31], v6, s[4:7], s25 offen offset:0
    s_waitcnt vmcnt(15)
    v_mfma_f32_16x16x32_bf16 v[140:143], v[92:95], v[32:35], 0
    ds_read_b64 v[116:117], v9 offset:1024
    ds_read_b64 v[118:119], v9 offset:1536
    v_mfma_f32_16x16x32_bf16 v[144:147], v[96:99], v[32:35], 0
    v_mfma_f32_16x16x32_bf16 v[148:151], v[100:103], v[32:35], 0
    ds_read_b64 v[120:121], v9 offset:21504
    ds_read_b64 v[122:123], v9 offset:22016
    v_mfma_f32_16x16x32_bf16 v[152:155], v[104:107], v[32:35], 0
    buffer_load_dwordx4 v[32:35], v7, s[4:7], s25 offen offset:0
    s_waitcnt vmcnt(15) lgkmcnt(6)
    v_mfma_f32_16x16x32_bf16 v[124:127], v[108:111], v[36:39], v[124:127]
    ds_read_b64 v[92:93], v8 offset:2048
    ds_read_b64 v[94:95], v8 offset:2560
    s_waitcnt lgkmcnt(6)
    v_mfma_f32_16x16x32_bf16 v[128:131], v[112:115], v[36:39], v[128:131]
    s_waitcnt lgkmcnt(4)
    v_mfma_f32_16x16x32_bf16 v[132:135], v[116:119], v[36:39], v[132:135]
    ds_read_b64 v[96:97], v8 offset:22528
    ds_read_b64 v[98:99], v8 offset:23040
    s_waitcnt lgkmcnt(4)
    v_mfma_f32_16x16x32_bf16 v[136:139], v[120:123], v[36:39], v[136:139]
    buffer_load_dwordx4 v[36:39], v6, s[4:7], s25 offen offset:1024
    s_waitcnt vmcnt(15)
    v_mfma_f32_16x16x32_bf16 v[140:143], v[108:111], v[40:43], v[140:143]
    ds_read_b64 v[100:101], v9 offset:2048
    ds_read_b64 v[102:103], v9 offset:2560
    v_mfma_f32_16x16x32_bf16 v[144:147], v[112:115], v[40:43], v[144:147]
    v_mfma_f32_16x16x32_bf16 v[148:151], v[116:119], v[40:43], v[148:151]
    ds_read_b64 v[104:105], v9 offset:22528
    ds_read_b64 v[106:107], v9 offset:23040
    v_mfma_f32_16x16x32_bf16 v[152:155], v[120:123], v[40:43], v[152:155]
    buffer_load_dwordx4 v[40:43], v7, s[4:7], s25 offen offset:1024
    s_waitcnt vmcnt(15) lgkmcnt(6)
    v_mfma_f32_16x16x32_bf16 v[124:127], v[92:95], v[44:47], v[124:127]
    ds_read_b64 v[108:109], v8 offset:3072
    ds_read_b64 v[110:111], v8 offset:3584
    s_waitcnt lgkmcnt(6)
    v_mfma_f32_16x16x32_bf16 v[128:131], v[96:99], v[44:47], v[128:131]
    s_waitcnt lgkmcnt(4)
    v_mfma_f32_16x16x32_bf16 v[132:135], v[100:103], v[44:47], v[132:135]
    ds_read_b64 v[112:113], v8 offset:23552
    ds_read_b64 v[114:115], v8 offset:24064
    s_waitcnt lgkmcnt(4)
    v_mfma_f32_16x16x32_bf16 v[136:139], v[104:107], v[44:47], v[136:139]
    buffer_load_dwordx4 v[44:47], v6, s[4:7], s25 offen offset:2048
    s_waitcnt vmcnt(15)
    v_mfma_f32_16x16x32_bf16 v[140:143], v[92:95], v[48:51], v[140:143]
    ds_read_b64 v[116:117], v9 offset:3072
    ds_read_b64 v[118:119], v9 offset:3584
    v_mfma_f32_16x16x32_bf16 v[144:147], v[96:99], v[48:51], v[144:147]
    v_mfma_f32_16x16x32_bf16 v[148:151], v[100:103], v[48:51], v[148:151]
    ds_read_b64 v[120:121], v9 offset:23552
    ds_read_b64 v[122:123], v9 offset:24064
    v_mfma_f32_16x16x32_bf16 v[152:155], v[104:107], v[48:51], v[152:155]
    buffer_load_dwordx4 v[48:51], v7, s[4:7], s25 offen offset:2048
    s_waitcnt vmcnt(15) lgkmcnt(6)
    v_mfma_f32_16x16x32_bf16 v[124:127], v[108:111], v[52:55], v[124:127]
    ds_read_b64 v[92:93], v8 offset:4096
    ds_read_b64 v[94:95], v8 offset:4608
    s_waitcnt lgkmcnt(6)
    v_mfma_f32_16x16x32_bf16 v[128:131], v[112:115], v[52:55], v[128:131]
    s_waitcnt lgkmcnt(4)
    v_mfma_f32_16x16x32_bf16 v[132:135], v[116:119], v[52:55], v[132:135]
    ds_read_b64 v[96:97], v8 offset:24576
    ds_read_b64 v[98:99], v8 offset:25088
    s_waitcnt lgkmcnt(4)
    v_mfma_f32_16x16x32_bf16 v[136:139], v[120:123], v[52:55], v[136:139]
    buffer_load_dwordx4 v[52:55], v6, s[4:7], s25 offen offset:3072
    s_waitcnt vmcnt(15)
    v_mfma_f32_16x16x32_bf16 v[140:143], v[108:111], v[56:59], v[140:143]
    ds_read_b64 v[100:101], v9 offset:4096
    ds_read_b64 v[102:103], v9 offset:4608
    v_mfma_f32_16x16x32_bf16 v[144:147], v[112:115], v[56:59], v[144:147]
    v_mfma_f32_16x16x32_bf16 v[148:151], v[116:119], v[56:59], v[148:151]
    ds_read_b64 v[104:105], v9 offset:24576
    ds_read_b64 v[106:107], v9 offset:25088
    v_mfma_f32_16x16x32_bf16 v[152:155], v[120:123], v[56:59], v[152:155]
    buffer_load_dwordx4 v[56:59], v7, s[4:7], s25 offen offset:3072
    s_add_u32 s25, s25, 4096
    s_waitcnt vmcnt(15) lgkmcnt(6)
    v_mfma_f32_16x16x32_bf16 v[124:127], v[92:95], v[60:63], v[124:127]
    ds_read_b64 v[108:109], v8 offset:5120
    ds_read_b64 v[110:111], v8 offset:5632
    s_waitcnt lgkmcnt(6)
    v_mfma_f32_16x16x32_bf16 v[128:131], v[96:99], v[60:63], v[128:131]
    s_waitcnt lgkmcnt(4)
    v_mfma_f32_16x16x32_bf16 v[132:135], v[100:103], v[60:63], v[132:135]
    ds_read_b64 v[112:113], v8 offset:25600
    ds_read_b64 v[114:115], v8 offset:26112
    s_waitcnt lgkmcnt(4)
    v_mfma_f32_16x16x32_bf16 v[136:139], v[104:107], v[60:63], v[136:139]
    buffer_load_dwordx4 v[60:63], v6, s[4:7], s25 offen offset:0
    s_waitcnt vmcnt(15)
    v_mfma_f32_16x16x32_bf16 v[140:143], v[92:95], v[64:67], v[140:143]
    ds_read_b64 v[116:117], v9 offset:5120
    ds_read_b64 v[118:119], v9 offset:5632
    v_mfma_f32_16x16x32_bf16 v[144:147], v[96:99], v[64:67], v[144:147]
    v_mfma_f32_16x16x32_bf16 v[148:151], v[100:103], v[64:67], v[148:151]
    ds_read_b64 v[120:121], v9 offset:25600
    ds_read_b64 v[122:123], v9 offset:26112
    v_mfma_f32_16x16x32_bf16 v[152:155], v[104:107], v[64:67], v[152:155]
    buffer_load_dwordx4 v[64:67], v7, s[4:7], s25 offen offset:0
    s_waitcnt vmcnt(15) lgkmcnt(6)
    v_mfma_f32_16x16x32_bf16 v[124:127], v[108:111], v[68:71], v[124:127]
    ds_read_b64 v[92:93], v8 offset:6144
    ds_read_b64 v[94:95], v8 offset:6656
    s_waitcnt lgkmcnt(6)
    v_mfma_f32_16x16x32_bf16 v[128:131], v[112:115], v[68:71], v[128:131]
    s_waitcnt lgkmcnt(4)
    v_mfma_f32_16x16x32_bf16 v[132:135], v[116:119], v[68:71], v[132:135]
    ds_read_b64 v[96:97], v8 offset:26624
    ds_read_b64 v[98:99], v8 offset:27136
    s_waitcnt lgkmcnt(4)
    v_mfma_f32_16x16x32_bf16 v[136:139], v[120:123], v[68:71], v[136:139]
    buffer_load_dwordx4 v[68:71], v6, s[4:7], s25 offen offset:1024
    s_waitcnt vmcnt(15)
    v_mfma_f32_16x16x32_bf16 v[140:143], v[108:111], v[72:75], v[140:143]
    ds_read_b64 v[100:101], v9 offset:6144
    ds_read_b64 v[102:103], v9 offset:6656
    v_mfma_f32_16x16x32_bf16 v[144:147], v[112:115], v[72:75], v[144:147]
    v_mfma_f32_16x16x32_bf16 v[148:151], v[116:119], v[72:75], v[148:151]
    ds_read_b64 v[104:105], v9 offset:26624
    ds_read_b64 v[106:107], v9 offset:27136
    v_mfma_f32_16x16x32_bf16 v[152:155], v[120:123], v[72:75], v[152:155]
    buffer_load_dwordx4 v[72:75], v7, s[4:7], s25 offen offset:1024
    s_waitcnt vmcnt(15) lgkmcnt(6)
    v_mfma_f32_16x16x32_bf16 v[124:127], v[92:95], v[76:79], v[124:127]
    ds_read_b64 v[108:109], v8 offset:7168
    ds_read_b64 v[110:111], v8 offset:7680
    s_waitcnt lgkmcnt(6)
    v_mfma_f32_16x16x32_bf16 v[128:131], v[96:99], v[76:79], v[128:131]
    s_waitcnt lgkmcnt(4)
    v_mfma_f32_16x16x32_bf16 v[132:135], v[100:103], v[76:79], v[132:135]
    ds_read_b64 v[112:113], v8 offset:27648
    ds_read_b64 v[114:115], v8 offset:28160
    s_waitcnt lgkmcnt(4)
    v_mfma_f32_16x16x32_bf16 v[136:139], v[104:107], v[76:79], v[136:139]
    buffer_load_dwordx4 v[76:79], v6, s[4:7], s25 offen offset:2048
    s_waitcnt vmcnt(15)
    v_mfma_f32_16x16x32_bf16 v[140:143], v[92:95], v[80:83], v[140:143]
    ds_read_b64 v[116:117], v9 offset:7168
    ds_read_b64 v[118:119], v9 offset:7680
    v_mfma_f32_16x16x32_bf16 v[144:147], v[96:99], v[80:83], v[144:147]
    v_mfma_f32_16x16x32_bf16 v[148:151], v[100:103], v[80:83], v[148:151]
    ds_read_b64 v[120:121], v9 offset:27648
    ds_read_b64 v[122:123], v9 offset:28160
    v_mfma_f32_16x16x32_bf16 v[152:155], v[104:107], v[80:83], v[152:155]
    buffer_load_dwordx4 v[80:83], v7, s[4:7], s25 offen offset:2048
    s_waitcnt vmcnt(15) lgkmcnt(6)
    v_mfma_f32_16x16x32_bf16 v[124:127], v[108:111], v[84:87], v[124:127]
    ds_read_b64 v[92:93], v8 offset:8192
    ds_read_b64 v[94:95], v8 offset:8704
    s_waitcnt lgkmcnt(6)
    v_mfma_f32_16x16x32_bf16 v[128:131], v[112:115], v[84:87], v[128:131]
    s_waitcnt lgkmcnt(4)
    v_mfma_f32_16x16x32_bf16 v[132:135], v[116:119], v[84:87], v[132:135]
    ds_read_b64 v[96:97], v8 offset:28672
    ds_read_b64 v[98:99], v8 offset:29184
    s_waitcnt lgkmcnt(4)
    v_mfma_f32_16x16x32_bf16 v[136:139], v[120:123], v[84:87], v[136:139]
    buffer_load_dwordx4 v[84:87], v6, s[4:7], s25 offen offset:3072
    s_waitcnt vmcnt(15)
    v_mfma_f32_16x16x32_bf16 v[140:143], v[108:111], v[88:91], v[140:143]
    ds_read_b64 v[100:101], v9 offset:8192
    ds_read_b64 v[102:103], v9 offset:8704
    v_mfma_f32_16x16x32_bf16 v[144:147], v[112:115], v[88:91], v[144:147]
    v_mfma_f32_16x16x32_bf16 v[148:151], v[116:119], v[88:91], v[148:151]
    ds_read_b64 v[104:105], v9 offset:28672
    ds_read_b64 v[106:107], v9 offset:29184
    v_mfma_f32_16x16x32_bf16 v[152:155], v[120:123], v[88:91], v[152:155]
    buffer_load_dwordx4 v[88:91], v7, s[4:7], s25 offen offset:3072
    s_add_u32 s25, s25, 4096
    s_waitcnt vmcnt(15) lgkmcnt(6)
    v_mfma_f32_16x16x32_bf16 v[124:127], v[92:95], v[28:31], v[124:127]
    ds_read_b64 v[108:109], v8 offset:9216
    ds_read_b64 v[110:111], v8 offset:9728
    s_waitcnt lgkmcnt(6)
    v_mfma_f32_16x16x32_bf16 v[128:131], v[96:99], v[28:31], v[128:131]
    s_waitcnt lgkmcnt(4)
    v_mfma_f32_16x16x32_bf16 v[132:135], v[100:103], v[28:31], v[132:135]
    ds_read_b64 v[112:113], v8 offset:29696
    ds_read_b64 v[114:115], v8 offset:30208
    s_waitcnt lgkmcnt(4)
    v_mfma_f32_16x16x32_bf16 v[136:139], v[104:107], v[28:31], v[136:139]
    buffer_load_dwordx4 v[28:31], v6, s[4:7], s25 offen offset:0
    s_waitcnt vmcnt(15)
    v_mfma_f32_16x16x32_bf16 v[140:143], v[92:95], v[32:35], v[140:143]
    ds_read_b64 v[116:117], v9 offset:9216
    ds_read_b64 v[118:119], v9 offset:9728
    v_mfma_f32_16x16x32_bf16 v[144:147], v[96:99], v[32:35], v[144:147]
    v_mfma_f32_16x16x32_bf16 v[148:151], v[100:103], v[32:35], v[148:151]
    ds_read_b64 v[120:121], v9 offset:29696
    ds_read_b64 v[122:123], v9 offset:30208
    v_mfma_f32_16x16x32_bf16 v[152:155], v[104:107], v[32:35], v[152:155]
    buffer_load_dwordx4 v[32:35], v7, s[4:7], s25 offen offset:0
    s_waitcnt vmcnt(15) lgkmcnt(6)
    v_mfma_f32_16x16x32_bf16 v[124:127], v[108:111], v[36:39], v[124:127]
    ds_read_b64 v[92:93], v8 offset:10240
    ds_read_b64 v[94:95], v8 offset:10752
    s_waitcnt lgkmcnt(6)
    v_mfma_f32_16x16x32_bf16 v[128:131], v[112:115], v[36:39], v[128:131]
    s_waitcnt lgkmcnt(4)
    v_mfma_f32_16x16x32_bf16 v[132:135], v[116:119], v[36:39], v[132:135]
    ds_read_b64 v[96:97], v8 offset:30720
    ds_read_b64 v[98:99], v8 offset:31232
    s_waitcnt lgkmcnt(4)
    v_mfma_f32_16x16x32_bf16 v[136:139], v[120:123], v[36:39], v[136:139]
    buffer_load_dwordx4 v[36:39], v6, s[4:7], s25 offen offset:1024
    s_waitcnt vmcnt(15)
    v_mfma_f32_16x16x32_bf16 v[140:143], v[108:111], v[40:43], v[140:143]
    ds_read_b64 v[100:101], v9 offset:10240
    ds_read_b64 v[102:103], v9 offset:10752
    v_mfma_f32_16x16x32_bf16 v[144:147], v[112:115], v[40:43], v[144:147]
    v_mfma_f32_16x16x32_bf16 v[148:151], v[116:119], v[40:43], v[148:151]
    ds_read_b64 v[104:105], v9 offset:30720
    ds_read_b64 v[106:107], v9 offset:31232
    v_mfma_f32_16x16x32_bf16 v[152:155], v[120:123], v[40:43], v[152:155]
    buffer_load_dwordx4 v[40:43], v7, s[4:7], s25 offen offset:1024
    s_waitcnt vmcnt(15) lgkmcnt(6)
    v_mfma_f32_16x16x32_bf16 v[124:127], v[92:95], v[44:47], v[124:127]
    ds_read_b64 v[108:109], v8 offset:11264
    ds_read_b64 v[110:111], v8 offset:11776
    s_waitcnt lgkmcnt(6)
    v_mfma_f32_16x16x32_bf16 v[128:131], v[96:99], v[44:47], v[128:131]
    s_waitcnt lgkmcnt(4)
    v_mfma_f32_16x16x32_bf16 v[132:135], v[100:103], v[44:47], v[132:135]
    ds_read_b64 v[112:113], v8 offset:31744
    ds_read_b64 v[114:115], v8 offset:32256
    s_waitcnt lgkmcnt(4)
    v_mfma_f32_16x16x32_bf16 v[136:139], v[104:107], v[44:47], v[136:139]
    buffer_load_dwordx4 v[44:47], v6, s[4:7], s25 offen offset:2048
    s_waitcnt vmcnt(15)
    v_mfma_f32_16x16x32_bf16 v[140:143], v[92:95], v[48:51], v[140:143]
    ds_read_b64 v[116:117], v9 offset:11264
    ds_read_b64 v[118:119], v9 offset:11776
    v_mfma_f32_16x16x32_bf16 v[144:147], v[96:99], v[48:51], v[144:147]
    v_mfma_f32_16x16x32_bf16 v[148:151], v[100:103], v[48:51], v[148:151]
    ds_read_b64 v[120:121], v9 offset:31744
    ds_read_b64 v[122:123], v9 offset:32256
    v_mfma_f32_16x16x32_bf16 v[152:155], v[104:107], v[48:51], v[152:155]
    buffer_load_dwordx4 v[48:51], v7, s[4:7], s25 offen offset:2048
    s_waitcnt vmcnt(15) lgkmcnt(6)
    v_mfma_f32_16x16x32_bf16 v[124:127], v[108:111], v[52:55], v[124:127]
    ds_read_b64 v[92:93], v8 offset:12288
    ds_read_b64 v[94:95], v8 offset:12800
    s_waitcnt lgkmcnt(6)
    v_mfma_f32_16x16x32_bf16 v[128:131], v[112:115], v[52:55], v[128:131]
    s_waitcnt lgkmcnt(4)
    v_mfma_f32_16x16x32_bf16 v[132:135], v[116:119], v[52:55], v[132:135]
    ds_read_b64 v[96:97], v8 offset:32768
    ds_read_b64 v[98:99], v8 offset:33280
    s_waitcnt lgkmcnt(4)
    v_mfma_f32_16x16x32_bf16 v[136:139], v[120:123], v[52:55], v[136:139]
    buffer_load_dwordx4 v[52:55], v6, s[4:7], s25 offen offset:3072
    s_waitcnt vmcnt(15)
    v_mfma_f32_16x16x32_bf16 v[140:143], v[108:111], v[56:59], v[140:143]
    ds_read_b64 v[100:101], v9 offset:12288
    ds_read_b64 v[102:103], v9 offset:12800
    v_mfma_f32_16x16x32_bf16 v[144:147], v[112:115], v[56:59], v[144:147]
    v_mfma_f32_16x16x32_bf16 v[148:151], v[116:119], v[56:59], v[148:151]
    ds_read_b64 v[104:105], v9 offset:32768
    ds_read_b64 v[106:107], v9 offset:33280
    v_mfma_f32_16x16x32_bf16 v[152:155], v[120:123], v[56:59], v[152:155]
    buffer_load_dwordx4 v[56:59], v7, s[4:7], s25 offen offset:3072
    s_sub_u32 s25, s25, 159744
    s_waitcnt vmcnt(15) lgkmcnt(6)
    v_mfma_f32_16x16x32_bf16 v[124:127], v[92:95], v[60:63], v[124:127]
    ds_read_b64 v[108:109], v8 offset:13312
    ds_read_b64 v[110:111], v8 offset:13824
    s_waitcnt lgkmcnt(6)
    v_mfma_f32_16x16x32_bf16 v[128:131], v[96:99], v[60:63], v[128:131]
    s_waitcnt lgkmcnt(4)
    v_mfma_f32_16x16x32_bf16 v[132:135], v[100:103], v[60:63], v[132:135]
    ds_read_b64 v[112:113], v8 offset:33792
    ds_read_b64 v[114:115], v8 offset:34304
    s_waitcnt lgkmcnt(4)
    v_mfma_f32_16x16x32_bf16 v[136:139], v[104:107], v[60:63], v[136:139]
    buffer_load_dwordx4 v[60:63], v6, s[4:7], s25 offen offset:0
    s_waitcnt vmcnt(15)
    v_mfma_f32_16x16x32_bf16 v[140:143], v[92:95], v[64:67], v[140:143]
    ds_read_b64 v[116:117], v9 offset:13312
    ds_read_b64 v[118:119], v9 offset:13824
    v_mfma_f32_16x16x32_bf16 v[144:147], v[96:99], v[64:67], v[144:147]
    v_mfma_f32_16x16x32_bf16 v[148:151], v[100:103], v[64:67], v[148:151]
    ds_read_b64 v[120:121], v9 offset:33792
    ds_read_b64 v[122:123], v9 offset:34304
    v_mfma_f32_16x16x32_bf16 v[152:155], v[104:107], v[64:67], v[152:155]
    buffer_load_dwordx4 v[64:67], v7, s[4:7], s25 offen offset:0
    s_waitcnt vmcnt(15) lgkmcnt(6)
    v_mfma_f32_16x16x32_bf16 v[124:127], v[108:111], v[68:71], v[124:127]
    ds_read_b64 v[92:93], v8 offset:14336
    ds_read_b64 v[94:95], v8 offset:14848
    s_waitcnt lgkmcnt(6)
    v_mfma_f32_16x16x32_bf16 v[128:131], v[112:115], v[68:71], v[128:131]
    s_waitcnt lgkmcnt(4)
    v_mfma_f32_16x16x32_bf16 v[132:135], v[116:119], v[68:71], v[132:135]
    ds_read_b64 v[96:97], v8 offset:34816
    ds_read_b64 v[98:99], v8 offset:35328
    s_waitcnt lgkmcnt(4)
    v_mfma_f32_16x16x32_bf16 v[136:139], v[120:123], v[68:71], v[136:139]
    buffer_load_dwordx4 v[68:71], v6, s[4:7], s25 offen offset:1024
    s_waitcnt vmcnt(15)
    v_mfma_f32_16x16x32_bf16 v[140:143], v[108:111], v[72:75], v[140:143]
    ds_read_b64 v[100:101], v9 offset:14336
    ds_read_b64 v[102:103], v9 offset:14848
    v_mfma_f32_16x16x32_bf16 v[144:147], v[112:115], v[72:75], v[144:147]
    v_mfma_f32_16x16x32_bf16 v[148:151], v[116:119], v[72:75], v[148:151]
    ds_read_b64 v[104:105], v9 offset:34816
    ds_read_b64 v[106:107], v9 offset:35328
    v_mfma_f32_16x16x32_bf16 v[152:155], v[120:123], v[72:75], v[152:155]
    buffer_load_dwordx4 v[72:75], v7, s[4:7], s25 offen offset:1024
    s_waitcnt vmcnt(15) lgkmcnt(6)
    v_mfma_f32_16x16x32_bf16 v[124:127], v[92:95], v[76:79], v[124:127]
    ds_read_b64 v[108:109], v8 offset:15360
    ds_read_b64 v[110:111], v8 offset:15872
    s_waitcnt lgkmcnt(6)
    v_mfma_f32_16x16x32_bf16 v[128:131], v[96:99], v[76:79], v[128:131]
    s_waitcnt lgkmcnt(4)
    v_mfma_f32_16x16x32_bf16 v[132:135], v[100:103], v[76:79], v[132:135]
    ds_read_b64 v[112:113], v8 offset:35840
    ds_read_b64 v[114:115], v8 offset:36352
    s_waitcnt lgkmcnt(4)
    v_mfma_f32_16x16x32_bf16 v[136:139], v[104:107], v[76:79], v[136:139]
    buffer_load_dwordx4 v[76:79], v6, s[4:7], s25 offen offset:2048
    s_waitcnt vmcnt(15)
    v_mfma_f32_16x16x32_bf16 v[140:143], v[92:95], v[80:83], v[140:143]
    ds_read_b64 v[116:117], v9 offset:15360
    ds_read_b64 v[118:119], v9 offset:15872
    v_mfma_f32_16x16x32_bf16 v[144:147], v[96:99], v[80:83], v[144:147]
    v_mfma_f32_16x16x32_bf16 v[148:151], v[100:103], v[80:83], v[148:151]
    ds_read_b64 v[120:121], v9 offset:35840
    ds_read_b64 v[122:123], v9 offset:36352
    v_mfma_f32_16x16x32_bf16 v[152:155], v[104:107], v[80:83], v[152:155]
    buffer_load_dwordx4 v[80:83], v7, s[4:7], s25 offen offset:2048
    s_waitcnt vmcnt(15) lgkmcnt(6)
    v_mfma_f32_16x16x32_bf16 v[124:127], v[108:111], v[84:87], v[124:127]
    ds_read_b64 v[92:93], v8 offset:16384
    ds_read_b64 v[94:95], v8 offset:16896
    s_waitcnt lgkmcnt(6)
    v_mfma_f32_16x16x32_bf16 v[128:131], v[112:115], v[84:87], v[128:131]
    s_waitcnt lgkmcnt(4)
    v_mfma_f32_16x16x32_bf16 v[132:135], v[116:119], v[84:87], v[132:135]
    ds_read_b64 v[96:97], v8 offset:36864
    ds_read_b64 v[98:99], v8 offset:37376
    s_waitcnt lgkmcnt(4)
    v_mfma_f32_16x16x32_bf16 v[136:139], v[120:123], v[84:87], v[136:139]
    buffer_load_dwordx4 v[84:87], v6, s[4:7], s25 offen offset:3072
    s_waitcnt vmcnt(15)
    v_mfma_f32_16x16x32_bf16 v[140:143], v[108:111], v[88:91], v[140:143]
    ds_read_b64 v[100:101], v9 offset:16384
    ds_read_b64 v[102:103], v9 offset:16896
    v_mfma_f32_16x16x32_bf16 v[144:147], v[112:115], v[88:91], v[144:147]
    v_mfma_f32_16x16x32_bf16 v[148:151], v[116:119], v[88:91], v[148:151]
    ds_read_b64 v[104:105], v9 offset:36864
    ds_read_b64 v[106:107], v9 offset:37376
    v_mfma_f32_16x16x32_bf16 v[152:155], v[120:123], v[88:91], v[152:155]
    buffer_load_dwordx4 v[88:91], v7, s[4:7], s25 offen offset:3072
    s_add_u32 s25, s25, 4096
    s_waitcnt vmcnt(15) lgkmcnt(6)
    v_mfma_f32_16x16x32_bf16 v[124:127], v[92:95], v[28:31], v[124:127]
    ds_read_b64 v[108:109], v8 offset:17408
    ds_read_b64 v[110:111], v8 offset:17920
    s_waitcnt lgkmcnt(6)
    v_mfma_f32_16x16x32_bf16 v[128:131], v[96:99], v[28:31], v[128:131]
    s_waitcnt lgkmcnt(4)
    v_mfma_f32_16x16x32_bf16 v[132:135], v[100:103], v[28:31], v[132:135]
    ds_read_b64 v[112:113], v8 offset:37888
    ds_read_b64 v[114:115], v8 offset:38400
    s_waitcnt lgkmcnt(4)
    v_mfma_f32_16x16x32_bf16 v[136:139], v[104:107], v[28:31], v[136:139]
    buffer_load_dwordx4 v[28:31], v6, s[4:7], s25 offen offset:0
    s_waitcnt vmcnt(15)
    v_mfma_f32_16x16x32_bf16 v[140:143], v[92:95], v[32:35], v[140:143]
    ds_read_b64 v[116:117], v9 offset:17408
    ds_read_b64 v[118:119], v9 offset:17920
    v_mfma_f32_16x16x32_bf16 v[144:147], v[96:99], v[32:35], v[144:147]
    v_mfma_f32_16x16x32_bf16 v[148:151], v[100:103], v[32:35], v[148:151]
    ds_read_b64 v[120:121], v9 offset:37888
    ds_read_b64 v[122:123], v9 offset:38400
    v_mfma_f32_16x16x32_bf16 v[152:155], v[104:107], v[32:35], v[152:155]
    buffer_load_dwordx4 v[32:35], v7, s[4:7], s25 offen offset:0
    s_waitcnt vmcnt(15) lgkmcnt(6)
    v_mfma_f32_16x16x32_bf16 v[124:127], v[108:111], v[36:39], v[124:127]
    ds_read_b64 v[92:93], v8 offset:18432
    ds_read_b64 v[94:95], v8 offset:18944
    s_waitcnt lgkmcnt(6)
    v_mfma_f32_16x16x32_bf16 v[128:131], v[112:115], v[36:39], v[128:131]
    s_waitcnt lgkmcnt(4)
    v_mfma_f32_16x16x32_bf16 v[132:135], v[116:119], v[36:39], v[132:135]
    ds_read_b64 v[96:97], v8 offset:38912
    ds_read_b64 v[98:99], v8 offset:39424
    s_waitcnt lgkmcnt(4)
    v_mfma_f32_16x16x32_bf16 v[136:139], v[120:123], v[36:39], v[136:139]
    buffer_load_dwordx4 v[36:39], v6, s[4:7], s25 offen offset:1024
    s_waitcnt vmcnt(15)
    v_mfma_f32_16x16x32_bf16 v[140:143], v[108:111], v[40:43], v[140:143]
    ds_read_b64 v[100:101], v9 offset:18432
    ds_read_b64 v[102:103], v9 offset:18944
    v_mfma_f32_16x16x32_bf16 v[144:147], v[112:115], v[40:43], v[144:147]
    v_mfma_f32_16x16x32_bf16 v[148:151], v[116:119], v[40:43], v[148:151]
    ds_read_b64 v[104:105], v9 offset:38912
    ds_read_b64 v[106:107], v9 offset:39424
    v_mfma_f32_16x16x32_bf16 v[152:155], v[120:123], v[40:43], v[152:155]
    buffer_load_dwordx4 v[40:43], v7, s[4:7], s25 offen offset:1024
    s_waitcnt vmcnt(15) lgkmcnt(6)
    v_mfma_f32_16x16x32_bf16 v[124:127], v[92:95], v[44:47], v[124:127]
    ds_read_b64 v[108:109], v8 offset:19456
    ds_read_b64 v[110:111], v8 offset:19968
    s_waitcnt lgkmcnt(6)
    v_mfma_f32_16x16x32_bf16 v[128:131], v[96:99], v[44:47], v[128:131]
    s_waitcnt lgkmcnt(4)
    v_mfma_f32_16x16x32_bf16 v[132:135], v[100:103], v[44:47], v[132:135]
    ds_read_b64 v[112:113], v8 offset:39936
    ds_read_b64 v[114:115], v8 offset:40448
    s_waitcnt lgkmcnt(4)
    v_mfma_f32_16x16x32_bf16 v[136:139], v[104:107], v[44:47], v[136:139]
    buffer_load_dwordx4 v[44:47], v6, s[4:7], s25 offen offset:2048
    s_waitcnt vmcnt(15)
    v_mfma_f32_16x16x32_bf16 v[140:143], v[92:95], v[48:51], v[140:143]
    ds_read_b64 v[116:117], v9 offset:19456
    ds_read_b64 v[118:119], v9 offset:19968
    v_mfma_f32_16x16x32_bf16 v[144:147], v[96:99], v[48:51], v[144:147]
    v_mfma_f32_16x16x32_bf16 v[148:151], v[100:103], v[48:51], v[148:151]
    ds_read_b64 v[120:121], v9 offset:39936
    ds_read_b64 v[122:123], v9 offset:40448
    v_mfma_f32_16x16x32_bf16 v[152:155], v[104:107], v[48:51], v[152:155]
    buffer_load_dwordx4 v[48:51], v7, s[4:7], s25 offen offset:2048
    s_waitcnt vmcnt(15) lgkmcnt(6)
    v_mfma_f32_16x16x32_bf16 v[124:127], v[108:111], v[52:55], v[124:127]
    s_waitcnt lgkmcnt(4)
    v_mfma_f32_16x16x32_bf16 v[128:131], v[112:115], v[52:55], v[128:131]
    s_waitcnt lgkmcnt(2)
    v_mfma_f32_16x16x32_bf16 v[132:135], v[116:119], v[52:55], v[132:135]
    s_waitcnt lgkmcnt(0)
    v_mfma_f32_16x16x32_bf16 v[136:139], v[120:123], v[52:55], v[136:139]
    buffer_load_dwordx4 v[52:55], v6, s[4:7], s25 offen offset:3072
    s_waitcnt vmcnt(15)
    v_mfma_f32_16x16x32_bf16 v[140:143], v[108:111], v[56:59], v[140:143]
    v_mfma_f32_16x16x32_bf16 v[144:147], v[112:115], v[56:59], v[144:147]
    v_mfma_f32_16x16x32_bf16 v[148:151], v[116:119], v[56:59], v[148:151]
    v_mfma_f32_16x16x32_bf16 v[152:155], v[120:123], v[56:59], v[152:155]
    buffer_load_dwordx4 v[56:59], v7, s[4:7], s25 offen offset:3072
    s_add_u32 s25, s25, 4096
    v_add_u32 v4, 81920, v10
    ds_read_b128 v[204:207], v4 offset:256
    ds_read_b128 v[188:191], v4 offset:0
    ds_read_b128 v[208:211], v4 offset:320
    ds_read_b128 v[192:195], v4 offset:64
    ds_read_b128 v[212:215], v4 offset:384
    ds_read_b128 v[196:199], v4 offset:128
    ds_read_b128 v[216:219], v4 offset:448
    ds_read_b128 v[200:203], v4 offset:192
    s_waitcnt lgkmcnt(7)
    v_pk_fma_f32 v[124:125], v[204:205], v[236:237], v[124:125] op_sel:[0,0,0] op_sel_hi:[1,0,1]
    s_add_u32 m0, s26, 1024
    s_nop 0
    buffer_load_dwordx4 v11, s[8:11], s38 offen offset:0 lds
    v_pk_fma_f32 v[126:127], v[206:207], v[236:237], v[126:127] op_sel:[0,0,0] op_sel_hi:[1,0,1]
    v_pk_fma_f32 v[140:141], v[204:205], v[238:239], v[140:141] op_sel:[0,0,0] op_sel_hi:[1,0,1]
    v_pk_fma_f32 v[142:143], v[206:207], v[238:239], v[142:143] op_sel:[0,0,0] op_sel_hi:[1,0,1]
    s_waitcnt lgkmcnt(6)
    v_pk_fma_f32 v[124:125], v[124:125], v[188:189], v[236:237] op_sel:[0,0,1] op_sel_hi:[1,1,1]
    v_pk_fma_f32 v[126:127], v[126:127], v[190:191], v[236:237] op_sel:[0,0,1] op_sel_hi:[1,1,1]
    v_pk_fma_f32 v[140:141], v[140:141], v[188:189], v[238:239] op_sel:[0,0,1] op_sel_hi:[1,1,1]
    v_pk_fma_f32 v[142:143], v[142:143], v[190:191], v[238:239] op_sel:[0,0,1] op_sel_hi:[1,1,1]
    v_pk_mul_f32 v[240:241], v[124:125], v[124:125]
    v_pk_mul_f32 v[242:243], v[126:127], v[126:127]
    v_pk_mul_f32 v[244:245], v[140:141], v[140:141]
    v_pk_mul_f32 v[246:247], v[142:143], v[142:143]
    v_pk_fma_f32 v[240:241], v[240:241], s[42:43], s[42:43] op_sel:[0,0,1] op_sel_hi:[1,0,1]
    v_pk_fma_f32 v[242:243], v[242:243], s[42:43], s[42:43] op_sel:[0,0,1] op_sel_hi:[1,0,1]
    v_pk_fma_f32 v[244:245], v[244:245], s[42:43], s[42:43] op_sel:[0,0,1] op_sel_hi:[1,0,1]
    v_pk_fma_f32 v[246:247], v[246:247], s[42:43], s[42:43] op_sel:[0,0,1] op_sel_hi:[1,0,1]
    v_pk_mul_f32 v[240:241], v[240:241], v[124:125]
    v_pk_mul_f32 v[242:243], v[242:243], v[126:127]
    v_pk_mul_f32 v[244:245], v[244:245], v[140:141]
    s_add_u32 m0, s26, 2048
    s_nop 0
    buffer_load_dwordx4 v12, s[8:11], s38 offen offset:0 lds
    v_pk_mul_f32 v[246:247], v[246:247], v[142:143]
    v_exp_f32 v240, v240
    v_exp_f32 v241, v241
    v_exp_f32 v242, v242
    v_exp_f32 v243, v243
    v_exp_f32 v244, v244
    v_exp_f32 v245, v245
    v_exp_f32 v246, v246
    v_exp_f32 v247, v247
    v_pk_add_f32 v[240:241], v[240:241], s[44:45]
    v_pk_add_f32 v[242:243], v[242:243], s[44:45]
    v_pk_add_f32 v[244:245], v[244:245], s[44:45]
    v_pk_add_f32 v[246:247], v[246:247], s[44:45]
    v_rcp_f32 v240, v240
    v_rcp_f32 v241, v241
    v_rcp_f32 v242, v242
    v_rcp_f32 v243, v243
    v_rcp_f32 v244, v244
    s_add_u32 m0, s26, 2944
    s_nop 0
    buffer_load_dwordx4 v11, s[8:11], s38 offen offset:128 lds
    v_rcp_f32 v245, v245
    v_rcp_f32 v246, v246
    v_rcp_f32 v247, v247
    v_pk_mul_f32 v[124:125], v[124:125], v[240:241]
    v_pk_mul_f32 v[126:127], v[126:127], v[242:243]
    v_pk_mul_f32 v[140:141], v[140:141], v[244:245]
    v_pk_mul_f32 v[142:143], v[142:143], v[246:247]
    v_pk_add_f32 v[188:189], v[124:125], v[140:141]
    v_pk_mul_f32 v[204:205], v[124:125], v[124:125]
    v_pk_add_f32 v[190:191], v[126:127], v[142:143]
    v_pk_mul_f32 v[206:207], v[126:127], v[126:127]
    v_pk_fma_f32 v[204:205], v[140:141], v[140:141], v[204:205]
    v_pk_fma_f32 v[206:207], v[142:143], v[142:143], v[206:207]
    s_waitcnt lgkmcnt(5)
    v_pk_fma_f32 v[128:129], v[208:209], v[236:237], v[128:129] op_sel:[0,0,0] op_sel_hi:[1,0,1]
    v_pk_fma_f32 v[130:131], v[210:211], v[236:237], v[130:131] op_sel:[0,0,0] op_sel_hi:[1,0,1]
    v_pk_fma_f32 v[144:145], v[208:209], v[238:239], v[144:145] op_sel:[0,0,0] op_sel_hi:[1,0,1]
    v_pk_fma_f32 v[146:147], v[210:211], v[238:239], v[146:147] op_sel:[0,0,0] op_sel_hi:[1,0,1]
    s_waitcnt lgkmcnt(4)
    v_pk_fma_f32 v[128:129], v[128:129], v[192:193], v[236:237] op_sel:[0,0,1] op_sel_hi:[1,1,1]
    s_add_u32 m0, s26, 3968
    s_nop 0
    buffer_load_dwordx4 v12, s[8:11], s38 offen offset:128 lds
    v_pk_fma_f32 v[130:131], v[130:131], v[194:195], v[236:237] op_sel:[0,0,1] op_sel_hi:[1,1,1]
    v_pk_fma_f32 v[144:145], v[144:145], v[192:193], v[238:239] op_sel:[0,0,1] op_sel_hi:[1,1,1]
    v_pk_fma_f32 v[146:147], v[146:147], v[194:195], v[238:239] op_sel:[0,0,1] op_sel_hi:[1,1,1]
    v_pk_mul_f32 v[240:241], v[128:129], v[128:129]
    v_pk_mul_f32 v[242:243], v[130:131], v[130:131]
    v_pk_mul_f32 v[244:245], v[144:145], v[144:145]
    v_pk_mul_f32 v[246:247], v[146:147], v[146:147]
    v_pk_fma_f32 v[240:241], v[240:241], s[42:43], s[42:43] op_sel:[0,0,1] op_sel_hi:[1,0,1]
    v_pk_fma_f32 v[242:243], v[242:243], s[42:43], s[42:43] op_sel:[0,0,1] op_sel_hi:[1,0,1]
    v_pk_fma_f32 v[244:245], v[244:245], s[42:43], s[42:43] op_sel:[0,0,1] op_sel_hi:[1,0,1]
    v_pk_fma_f32 v[246:247], v[246:247], s[42:43], s[42:43] op_sel:[0,0,1] op_sel_hi:[1,0,1]
    v_pk_mul_f32 v[240:241], v[240:241], v[128:129]
    v_pk_mul_f32 v[242:243], v[242:243], v[130:131]
    v_pk_mul_f32 v[244:245], v[244:245], v[144:145]
    v_pk_mul_f32 v[246:247], v[246:247], v[146:147]
    v_exp_f32 v240, v240
    v_exp_f32 v241, v241
    v_exp_f32 v242, v242
    s_add_u32 m0, s26, 4864
    s_nop 0
    buffer_load_dwordx4 v11, s[8:11], s38 offen offset:256 lds
    v_exp_f32 v243, v243
    v_exp_f32 v244, v244
    v_exp_f32 v245, v245
    v_exp_f32 v246, v246
    v_exp_f32 v247, v247
    v_pk_add_f32 v[240:241], v[240:241], s[44:45]
    v_pk_add_f32 v[242:243], v[242:243], s[44:45]
    v_pk_add_f32 v[244:245], v[244:245], s[44:45]
    v_pk_add_f32 v[246:247], v[246:247], s[44:45]
    v_rcp_f32 v240, v240
    v_rcp_f32 v241, v241
    v_rcp_f32 v242, v242
    v_rcp_f32 v243, v243
    v_rcp_f32 v244, v244
    v_rcp_f32 v245, v245
    v_rcp_f32 v246, v246
    v_rcp_f32 v247, v247
    v_pk_mul_f32 v[128:129], v[128:129], v[240:241]
    s_add_u32 m0, s26, 5888
    s_nop 0
    buffer_load_dwordx4 v12, s[8:11], s38 offen offset:256 lds
    v_pk_mul_f32 v[130:131], v[130:131], v[242:243]
    v_pk_mul_f32 v[144:145], v[144:145], v[244:245]
    v_pk_mul_f32 v[146:147], v[146:147], v[246:247]
    v_pk_add_f32 v[192:193], v[128:129], v[144:145]
    v_pk_mul_f32 v[208:209], v[128:129], v[128:129]
    v_pk_add_f32 v[194:195], v[130:131], v[146:147]
    v_pk_mul_f32 v[210:211], v[130:131], v[130:131]
    v_pk_fma_f32 v[208:209], v[144:145], v[144:145], v[208:209]
    v_pk_fma_f32 v[210:211], v[146:147], v[146:147], v[210:211]
    s_waitcnt lgkmcnt(3)
    v_pk_fma_f32 v[132:133], v[212:213], v[236:237], v[132:133] op_sel:[0,0,0] op_sel_hi:[1,0,1]
    v_pk_fma_f32 v[134:135], v[214:215], v[236:237], v[134:135] op_sel:[0,0,0] op_sel_hi:[1,0,1]
    v_pk_fma_f32 v[148:149], v[212:213], v[238:239], v[148:149] op_sel:[0,0,0] op_sel_hi:[1,0,1]
    v_pk_fma_f32 v[150:151], v[214:215], v[238:239], v[150:151] op_sel:[0,0,0] op_sel_hi:[1,0,1]
    s_waitcnt lgkmcnt(2)
    v_pk_fma_f32 v[132:133], v[132:133], v[196:197], v[236:237] op_sel:[0,0,1] op_sel_hi:[1,1,1]
    v_pk_fma_f32 v[134:135], v[134:135], v[198:199], v[236:237] op_sel:[0,0,1] op_sel_hi:[1,1,1]
    v_pk_fma_f32 v[148:149], v[148:149], v[196:197], v[238:239] op_sel:[0,0,1] op_sel_hi:[1,1,1]
    v_pk_fma_f32 v[150:151], v[150:151], v[198:199], v[238:239] op_sel:[0,0,1] op_sel_hi:[1,1,1]
    v_pk_mul_f32 v[240:241], v[132:133], v[132:133]
    s_add_u32 m0, s26, 6784
    s_nop 0
    buffer_load_dwordx4 v11, s[8:11], s38 offen offset:384 lds
    v_pk_mul_f32 v[242:243], v[134:135], v[134:135]
    v_pk_mul_f32 v[244:245], v[148:149], v[148:149]
    v_pk_mul_f32 v[246:247], v[150:151], v[150:151]
    v_pk_fma_f32 v[240:241], v[240:241], s[42:43], s[42:43] op_sel:[0,0,1] op_sel_hi:[1,0,1]
    v_pk_fma_f32 v[242:243], v[242:243], s[42:43], s[42:43] op_sel:[0,0,1] op_sel_hi:[1,0,1]
    v_pk_fma_f32 v[244:245], v[244:245], s[42:43], s[42:43] op_sel:[0,0,1] op_sel_hi:[1,0,1]
    v_pk_fma_f32 v[246:247], v[246:247], s[42:43], s[42:43] op_sel:[0,0,1] op_sel_hi:[1,0,1]
    v_pk_mul_f32 v[240:241], v[240:241], v[132:133]
    v_pk_mul_f32 v[242:243], v[242:243], v[134:135]
    v_pk_mul_f32 v[244:245], v[244:245], v[148:149]
    v_pk_mul_f32 v[246:247], v[246:247], v[150:151]
    v_exp_f32 v240, v240
    v_exp_f32 v241, v241
    v_exp_f32 v242, v242
    v_exp_f32 v243, v243
    v_exp_f32 v244, v244
    v_exp_f32 v245, v245
    v_exp_f32 v246, v246
    s_add_u32 m0, s26, 7808
    s_nop 0
    buffer_load_dwordx4 v12, s[8:11], s38 offen offset:384 lds
    v_exp_f32 v247, v247
    v_pk_add_f32 v[240:241], v[240:241], s[44:45]
    v_pk_add_f32 v[242:243], v[242:243], s[44:45]
    v_pk_add_f32 v[244:245], v[244:245], s[44:45]
    v_pk_add_f32 v[246:247], v[246:247], s[44:45]
    v_rcp_f32 v240, v240
    v_rcp_f32 v241, v241
    v_rcp_f32 v242, v242
    v_rcp_f32 v243, v243
    v_rcp_f32 v244, v244
    v_rcp_f32 v245, v245
    v_rcp_f32 v246, v246
    v_rcp_f32 v247, v247
    v_pk_mul_f32 v[132:133], v[132:133], v[240:241]
    v_pk_mul_f32 v[134:135], v[134:135], v[242:243]
    v_pk_mul_f32 v[148:149], v[148:149], v[244:245]
    v_pk_mul_f32 v[150:151], v[150:151], v[246:247]
    v_pk_add_f32 v[196:197], v[132:133], v[148:149]
    s_add_u32 m0, s26, 8704
    s_nop 0
    buffer_load_dwordx4 v11, s[8:11], s38 offen offset:512 lds
    v_pk_mul_f32 v[212:213], v[132:133], v[132:133]
    v_pk_add_f32 v[198:199], v[134:135], v[150:151]
    v_pk_mul_f32 v[214:215], v[134:135], v[134:135]
    v_pk_fma_f32 v[212:213], v[148:149], v[148:149], v[212:213]
    v_pk_fma_f32 v[214:215], v[150:151], v[150:151], v[214:215]
    s_waitcnt lgkmcnt(1)
    v_pk_fma_f32 v[136:137], v[216:217], v[236:237], v[136:137] op_sel:[0,0,0] op_sel_hi:[1,0,1]
    v_pk_fma_f32 v[138:139], v[218:219], v[236:237], v[138:139] op_sel:[0,0,0] op_sel_hi:[1,0,1]
    v_pk_fma_f32 v[152:153], v[216:217], v[238:239], v[152:153] op_sel:[0,0,0] op_sel_hi:[1,0,1]
    v_pk_fma_f32 v[154:155], v[218:219], v[238:239], v[154:155] op_sel:[0,0,0] op_sel_hi:[1,0,1]
    s_waitcnt lgkmcnt(0)
    v_pk_fma_f32 v[136:137], v[136:137], v[200:201], v[236:237] op_sel:[0,0,1] op_sel_hi:[1,1,1]
    v_pk_fma_f32 v[138:139], v[138:139], v[202:203], v[236:237] op_sel:[0,0,1] op_sel_hi:[1,1,1]
    v_pk_fma_f32 v[152:153], v[152:153], v[200:201], v[238:239] op_sel:[0,0,1] op_sel_hi:[1,1,1]
    v_pk_fma_f32 v[154:155], v[154:155], v[202:203], v[238:239] op_sel:[0,0,1] op_sel_hi:[1,1,1]
    v_pk_mul_f32 v[240:241], v[136:137], v[136:137]
    v_pk_mul_f32 v[242:243], v[138:139], v[138:139]
    v_pk_mul_f32 v[244:245], v[152:153], v[152:153]
    v_pk_mul_f32 v[246:247], v[154:155], v[154:155]
    v_pk_fma_f32 v[240:241], v[240:241], s[42:43], s[42:43] op_sel:[0,0,1] op_sel_hi:[1,0,1]
    s_add_u32 m0, s26, 9728
    s_nop 0
    buffer_load_dwordx4 v12, s[8:11], s38 offen offset:512 lds
    v_pk_fma_f32 v[242:243], v[242:243], s[42:43], s[42:43] op_sel:[0,0,1] op_sel_hi:[1,0,1]
    v_pk_fma_f32 v[244:245], v[244:245], s[42:43], s[42:43] op_sel:[0,0,1] op_sel_hi:[1,0,1]
    v_pk_fma_f32 v[246:247], v[246:247], s[42:43], s[42:43] op_sel:[0,0,1] op_sel_hi:[1,0,1]
    v_pk_mul_f32 v[240:241], v[240:241], v[136:137]
    v_pk_mul_f32 v[242:243], v[242:243], v[138:139]
    v_pk_mul_f32 v[244:245], v[244:245], v[152:153]
    v_pk_mul_f32 v[246:247], v[246:247], v[154:155]
    v_exp_f32 v240, v240
    v_exp_f32 v241, v241
    v_exp_f32 v242, v242
    v_exp_f32 v243, v243
    v_exp_f32 v244, v244
    v_exp_f32 v245, v245
    v_exp_f32 v246, v246
    v_exp_f32 v247, v247
    v_pk_add_f32 v[240:241], v[240:241], s[44:45]
    v_pk_add_f32 v[242:243], v[242:243], s[44:45]
    v_pk_add_f32 v[244:245], v[244:245], s[44:45]
    s_add_u32 m0, s26, 10624
    s_nop 0
    buffer_load_dwordx4 v11, s[8:11], s38 offen offset:640 lds
    v_pk_add_f32 v[246:247], v[246:247], s[44:45]
    v_rcp_f32 v240, v240
    v_rcp_f32 v241, v241
    v_rcp_f32 v242, v242
    v_rcp_f32 v243, v243
    v_rcp_f32 v244, v244
    v_rcp_f32 v245, v245
    v_rcp_f32 v246, v246
    v_rcp_f32 v247, v247
    v_pk_mul_f32 v[136:137], v[136:137], v[240:241]
    v_pk_mul_f32 v[138:139], v[138:139], v[242:243]
    v_pk_mul_f32 v[152:153], v[152:153], v[244:245]
    v_pk_mul_f32 v[154:155], v[154:155], v[246:247]
    v_pk_add_f32 v[200:201], v[136:137], v[152:153]
    v_pk_mul_f32 v[216:217], v[136:137], v[136:137]
    v_pk_add_f32 v[202:203], v[138:139], v[154:155]
    v_pk_mul_f32 v[218:219], v[138:139], v[138:139]
    v_pk_fma_f32 v[216:217], v[152:153], v[152:153], v[216:217]
    s_add_u32 m0, s26, 11648
    s_nop 0
    buffer_load_dwordx4 v12, s[8:11], s38 offen offset:640 lds
    v_pk_fma_f32 v[218:219], v[154:155], v[154:155], v[218:219]
    v_add_f32_dpp v188, v188, v188 row_ror:8 row_mask:0xf bank_mask:3
    v_add_f32_dpp v189, v189, v189 row_ror:8 row_mask:0xf bank_mask:3
    v_add_f32_dpp v190, v190, v190 row_ror:8 row_mask:0xf bank_mask:3
    v_add_f32_dpp v191, v191, v191 row_ror:8 row_mask:0xf bank_mask:3
    v_add_f32_dpp v192, v192, v192 row_ror:8 row_mask:0xf bank_mask:3
    v_add_f32_dpp v193, v193, v193 row_ror:8 row_mask:0xf bank_mask:3
    v_add_f32_dpp v194, v194, v194 row_ror:8 row_mask:0xf bank_mask:3
    v_add_f32_dpp v195, v195, v195 row_ror:8 row_mask:0xf bank_mask:3
    v_add_f32_dpp v196, v196, v196 row_ror:8 row_mask:0xf bank_mask:3
    v_add_f32_dpp v197, v197, v197 row_ror:8 row_mask:0xf bank_mask:3
    v_add_f32_dpp v198, v198, v198 row_ror:8 row_mask:0xf bank_mask:3
    v_add_f32_dpp v199, v199, v199 row_ror:8 row_mask:0xf bank_mask:3
    v_add_f32_dpp v200, v200, v200 row_ror:8 row_mask:0xf bank_mask:3
    v_add_f32_dpp v201, v201, v201 row_ror:8 row_mask:0xf bank_mask:3
    v_add_f32_dpp v202, v202, v202 row_ror:8 row_mask:0xf bank_mask:3
    v_add_f32_dpp v203, v203, v203 row_ror:8 row_mask:0xf bank_mask:3
    v_add_f32_dpp v188, v204, v204 row_ror:8 row_mask:0xf bank_mask:12
    v_add_f32_dpp v189, v205, v205 row_ror:8 row_mask:0xf bank_mask:12
    v_add_f32_dpp v190, v206, v206 row_ror:8 row_mask:0xf bank_mask:12
    v_add_f32_dpp v191, v207, v207 row_ror:8 row_mask:0xf bank_mask:12
    v_add_f32_dpp v192, v208, v208 row_ror:8 row_mask:0xf bank_mask:12
    v_add_f32_dpp v193, v209, v209 row_ror:8 row_mask:0xf bank_mask:12
    v_add_f32_dpp v194, v210, v210 row_ror:8 row_mask:0xf bank_mask:12
    v_add_f32_dpp v195, v211, v211 row_ror:8 row_mask:0xf bank_mask:12
    v_add_f32_dpp v196, v212, v212 row_ror:8 row_mask:0xf bank_mask:12
    v_add_f32_dpp v197, v213, v213 row_ror:8 row_mask:0xf bank_mask:12
    v_add_f32_dpp v198, v214, v214 row_ror:8 row_mask:0xf bank_mask:12
    v_add_f32_dpp v199, v215, v215 row_ror:8 row_mask:0xf bank_mask:12
    v_add_f32_dpp v200, v216, v216 row_ror:8 row_mask:0xf bank_mask:12
    v_add_f32_dpp v201, v217, v217 row_ror:8 row_mask:0xf bank_mask:12
    v_add_f32_dpp v202, v218, v218 row_ror:8 row_mask:0xf bank_mask:12
    v_add_f32_dpp v203, v219, v219 row_ror:8 row_mask:0xf bank_mask:12
    v_add_f32_dpp v188, v188, v188 row_half_mirror row_mask:0xf bank_mask:5
    v_add_f32_dpp v189, v189, v189 row_half_mirror row_mask:0xf bank_mask:5
    v_add_f32_dpp v190, v190, v190 row_half_mirror row_mask:0xf bank_mask:5
    v_add_f32_dpp v191, v191, v191 row_half_mirror row_mask:0xf bank_mask:5
    v_add_f32_dpp v192, v192, v192 row_half_mirror row_mask:0xf bank_mask:5
    v_add_f32_dpp v193, v193, v193 row_half_mirror row_mask:0xf bank_mask:5
    v_add_f32_dpp v194, v194, v194 row_half_mirror row_mask:0xf bank_mask:5
    v_add_f32_dpp v195, v195, v195 row_half_mirror row_mask:0xf bank_mask:5
    v_add_f32_dpp v188, v196, v196 row_half_mirror row_mask:0xf bank_mask:10
    v_add_f32_dpp v189, v197, v197 row_half_mirror row_mask:0xf bank_mask:10
    v_add_f32_dpp v190, v198, v198 row_half_mirror row_mask:0xf bank_mask:10
    v_add_f32_dpp v191, v199, v199 row_half_mirror row_mask:0xf bank_mask:10
    v_add_f32_dpp v192, v200, v200 row_half_mirror row_mask:0xf bank_mask:10
    v_add_f32_dpp v193, v201, v201 row_half_mirror row_mask:0xf bank_mask:10
    v_add_f32_dpp v194, v202, v202 row_half_mirror row_mask:0xf bank_mask:10
    v_add_f32_dpp v195, v203, v203 row_half_mirror row_mask:0xf bank_mask:10
    v_add_f32_dpp v188, v188, v188 quad_perm:[1,0,3,2] row_mask:0xf bank_mask:0xf
    v_add_f32_dpp v189, v189, v189 quad_perm:[1,0,3,2] row_mask:0xf bank_mask:0xf
    v_add_f32_dpp v190, v190, v190 quad_perm:[1,0,3,2] row_mask:0xf bank_mask:0xf
    v_add_f32_dpp v191, v191, v191 quad_perm:[1,0,3,2] row_mask:0xf bank_mask:0xf
    v_add_f32_dpp v192, v192, v192 quad_perm:[1,0,3,2] row_mask:0xf bank_mask:0xf
    v_add_f32_dpp v193, v193, v193 quad_perm:[1,0,3,2] row_mask:0xf bank_mask:0xf
    v_add_f32_dpp v194, v194, v194 quad_perm:[1,0,3,2] row_mask:0xf bank_mask:0xf
    v_add_f32_dpp v195, v195, v195 quad_perm:[1,0,3,2] row_mask:0xf bank_mask:0xf
    v_add_f32_dpp v188, v188, v188 quad_perm:[2,3,0,1] row_mask:0xf bank_mask:0xf
    v_add_f32_dpp v189, v189, v189 quad_perm:[2,3,0,1] row_mask:0xf bank_mask:0xf
    v_add_f32_dpp v190, v190, v190 quad_perm:[2,3,0,1] row_mask:0xf bank_mask:0xf
    v_add_f32_dpp v191, v191, v191 quad_perm:[2,3,0,1] row_mask:0xf bank_mask:0xf
    v_add_f32_dpp v192, v192, v192 quad_perm:[2,3,0,1] row_mask:0xf bank_mask:0xf
    v_add_f32_dpp v193, v193, v193 quad_perm:[2,3,0,1] row_mask:0xf bank_mask:0xf
    v_add_f32_dpp v194, v194, v194 quad_perm:[2,3,0,1] row_mask:0xf bank_mask:0xf
    v_add_f32_dpp v195, v195, v195 quad_perm:[2,3,0,1] row_mask:0xf bank_mask:0xf
    v_bfe_u32 v4, v0, 2, 2
    v_lshl_add_u32 v4, v4, 7, v10
    s_lshl_b32 s34, s20, 9
    s_add_u32 s36, s34, 82432
    v_add_u32 v4, s36, v4
    ds_write_b128 v4, v[188:191]
    ds_write_b128 v4, v[192:195] offset:64
    s_lshl_b32 s27, s21, 12
    s_add_u32 s27, s27, 65536
    s_waitcnt lgkmcnt(0)
    s_barrier
    s_cmp_lg_u32 s20, 3
    s_cbranch_scc1 L_kb_nopub_2
    v_lshlrev_b32 v4, 2, v1
    v_add_u32 v4, 82432, v4
    ds_read2st64_b32 v[240:241], v4 offset0:0 offset1:1
    ds_read2st64_b32 v[242:243], v4 offset0:2 offset1:3
    ds_read2st64_b32 v[244:245], v4 offset0:4 offset1:5
    ds_read2st64_b32 v[246:247], v4 offset0:6 offset1:7
    s_lshl_b32 s36, s22, 9
    s_add_u32 s36, s36, s27
    s_waitcnt lgkmcnt(2)
    v_pk_add_f32 v[240:241], v[240:241], v[242:243]
    s_waitcnt lgkmcnt(0)
    v_pk_add_f32 v[244:245], v[244:245], v[246:247]
    v_pk_add_f32 v[240:241], v[240:241], v[244:245]
    v_and_b32 v241, 0x7fffffff, v241
    buffer_store_dwordx2 v[240:241], v8, s[4:7], s36 offen sc1
L_kb_nopub_2:
    ds_read_b64 v[92:93], v8 offset:0
    ds_read_b64 v[94:95], v8 offset:512
    ds_read_b64 v[96:97], v8 offset:20480
    ds_read_b64 v[98:99], v8 offset:20992
    ds_read_b64 v[100:101], v9 offset:0
    ds_read_b64 v[102:103], v9 offset:512
    ds_read_b64 v[104:105], v9 offset:20480
    ds_read_b64 v[106:107], v9 offset:20992
    s_waitcnt vmcnt(27) lgkmcnt(6)
    v_mfma_f32_16x16x32_bf16 v[156:159], v[60:63], v[92:95], 0
    ds_read_b64 v[108:109], v8 offset:1024
    ds_read_b64 v[110:111], v8 offset:1536
    s_waitcnt lgkmcnt(6)
    v_mfma_f32_16x16x32_bf16 v[160:163], v[60:63], v[96:99], 0
    s_waitcnt lgkmcnt(4)
    v_mfma_f32_16x16x32_bf16 v[164:167], v[60:63], v[100:103], 0
    ds_read_b64 v[112:113], v8 offset:21504
    ds_read_b64 v[114:115], v8 offset:22016
    s_waitcnt lgkmcnt(4)
    v_mfma_f32_16x16x32_bf16 v[168:171], v[60:63], v[104:107], 0
    buffer_load_dwordx4 v[60:63], v6, s[4:7], s25 offen offset:0
    s_waitcnt vmcnt(27)
    v_mfma_f32_16x16x32_bf16 v[172:175], v[64:67], v[92:95], 0
    ds_read_b64 v[116:117], v9 offset:1024
    ds_read_b64 v[118:119], v9 offset:1536
    v_mfma_f32_16x16x32_bf16 v[176:179], v[64:67], v[96:99], 0
    v_mfma_f32_16x16x32_bf16 v[180:183], v[64:67], v[100:103], 0
    ds_read_b64 v[120:121], v9 offset:21504
    ds_read_b64 v[122:123], v9 offset:22016
    v_mfma_f32_16x16x32_bf16 v[184:187], v[64:67], v[104:107], 0
    buffer_load_dwordx4 v[64:67], v7, s[4:7], s25 offen offset:0
    s_waitcnt vmcnt(27) lgkmcnt(6)
    v_mfma_f32_16x16x32_bf16 v[156:159], v[68:71], v[108:111], v[156:159]
    ds_read_b64 v[92:93], v8 offset:2048
    ds_read_b64 v[94:95], v8 offset:2560
    s_waitcnt lgkmcnt(6)
    v_mfma_f32_16x16x32_bf16 v[160:163], v[68:71], v[112:115], v[160:163]
    s_waitcnt lgkmcnt(4)
    v_mfma_f32_16x16x32_bf16 v[164:167], v[68:71], v[116:119], v[164:167]
    ds_read_b64 v[96:97], v8 offset:22528
    ds_read_b64 v[98:99], v8 offset:23040
    s_waitcnt lgkmcnt(4)
    v_mfma_f32_16x16x32_bf16 v[168:171], v[68:71], v[120:123], v[168:171]
    buffer_load_dwordx4 v[68:71], v6, s[4:7], s25 offen offset:1024
    s_waitcnt vmcnt(27)
    v_mfma_f32_16x16x32_bf16 v[172:175], v[72:75], v[108:111], v[172:175]
    ds_read_b64 v[100:101], v9 offset:2048
    ds_read_b64 v[102:103], v9 offset:2560
    v_mfma_f32_16x16x32_bf16 v[176:179], v[72:75], v[112:115], v[176:179]
    v_mfma_f32_16x16x32_bf16 v[180:183], v[72:75], v[116:119], v[180:183]
    ds_read_b64 v[104:105], v9 offset:22528
    ds_read_b64 v[106:107], v9 offset:23040
    v_mfma_f32_16x16x32_bf16 v[184:187], v[72:75], v[120:123], v[184:187]
    buffer_load_dwordx4 v[72:75], v7, s[4:7], s25 offen offset:1024
    s_waitcnt vmcnt(27) lgkmcnt(6)
    v_mfma_f32_16x16x32_bf16 v[156:159], v[76:79], v[92:95], v[156:159]
    ds_read_b64 v[108:109], v8 offset:3072
    ds_read_b64 v[110:111], v8 offset:3584
    s_waitcnt lgkmcnt(6)
    v_mfma_f32_16x16x32_bf16 v[160:163], v[76:79], v[96:99], v[160:163]
    s_waitcnt lgkmcnt(4)
    v_mfma_f32_16x16x32_bf16 v[164:167], v[76:79], v[100:103], v[164:167]
    ds_read_b64 v[112:113], v8 offset:23552
    ds_read_b64 v[114:115], v8 offset:24064
    s_waitcnt lgkmcnt(4)
    v_mfma_f32_16x16x32_bf16 v[168:171], v[76:79], v[104:107], v[168:171]
    buffer_load_dwordx4 v[76:79], v6, s[4:7], s25 offen offset:2048
    s_waitcnt vmcnt(27)
    v_mfma_f32_16x16x32_bf16 v[172:175], v[80:83], v[92:95], v[172:175]
    ds_read_b64 v[116:117], v9 offset:3072
    ds_read_b64 v[118:119], v9 offset:3584
    v_mfma_f32_16x16x32_bf16 v[176:179], v[80:83], v[96:99], v[176:179]
    v_mfma_f32_16x16x32_bf16 v[180:183], v[80:83], v[100:103], v[180:183]
    ds_read_b64 v[120:121], v9 offset:23552
    ds_read_b64 v[122:123], v9 offset:24064
    v_mfma_f32_16x16x32_bf16 v[184:187], v[80:83], v[104:107], v[184:187]
    buffer_load_dwordx4 v[80:83], v7, s[4:7], s25 offen offset:2048
    s_waitcnt vmcnt(27) lgkmcnt(6)
    v_mfma_f32_16x16x32_bf16 v[156:159], v[84:87], v[108:111], v[156:159]
    ds_read_b64 v[92:93], v8 offset:4096
    ds_read_b64 v[94:95], v8 offset:4608
    s_waitcnt lgkmcnt(6)
    v_mfma_f32_16x16x32_bf16 v[160:163], v[84:87], v[112:115], v[160:163]
    s_waitcnt lgkmcnt(4)
    v_mfma_f32_16x16x32_bf16 v[164:167], v[84:87], v[116:119], v[164:167]
    ds_read_b64 v[96:97], v8 offset:24576
    ds_read_b64 v[98:99], v8 offset:25088
    s_waitcnt lgkmcnt(4)
    v_mfma_f32_16x16x32_bf16 v[168:171], v[84:87], v[120:123], v[168:171]
    buffer_load_dwordx4 v[84:87], v6, s[4:7], s25 offen offset:3072
    s_waitcnt vmcnt(27)
    v_mfma_f32_16x16x32_bf16 v[172:175], v[88:91], v[108:111], v[172:175]
    ds_read_b64 v[100:101], v9 offset:4096
    ds_read_b64 v[102:103], v9 offset:4608
    v_mfma_f32_16x16x32_bf16 v[176:179], v[88:91], v[112:115], v[176:179]
    v_mfma_f32_16x16x32_bf16 v[180:183], v[88:91], v[116:119], v[180:183]
    ds_read_b64 v[104:105], v9 offset:24576
    ds_read_b64 v[106:107], v9 offset:25088
    v_mfma_f32_16x16x32_bf16 v[184:187], v[88:91], v[120:123], v[184:187]
    buffer_load_dwordx4 v[88:91], v7, s[4:7], s25 offen offset:3072
    s_add_u32 s25, s25, 4096
    s_waitcnt vmcnt(27) lgkmcnt(6)
    v_mfma_f32_16x16x32_bf16 v[156:159], v[28:31], v[92:95], v[156:159]
    ds_read_b64 v[108:109], v8 offset:5120
    ds_read_b64 v[110:111], v8 offset:5632
    s_waitcnt lgkmcnt(6)
    v_mfma_f32_16x16x32_bf16 v[160:163], v[28:31], v[96:99], v[160:163]
    s_waitcnt lgkmcnt(4)
    v_mfma_f32_16x16x32_bf16 v[164:167], v[28:31], v[100:103], v[164:167]
    ds_read_b64 v[112:113], v8 offset:25600
    ds_read_b64 v[114:115], v8 offset:26112
    s_waitcnt lgkmcnt(4)
    v_mfma_f32_16x16x32_bf16 v[168:171], v[28:31], v[104:107], v[168:171]
    buffer_load_dwordx4 v[28:31], v6, s[4:7], s25 offen offset:0
    s_waitcnt vmcnt(27)
    v_mfma_f32_16x16x32_bf16 v[172:175], v[32:35], v[92:95], v[172:175]
    ds_read_b64 v[116:117], v9 offset:5120
    ds_read_b64 v[118:119], v9 offset:5632
    v_mfma_f32_16x16x32_bf16 v[176:179], v[32:35], v[96:99], v[176:179]
    v_mfma_f32_16x16x32_bf16 v[180:183], v[32:35], v[100:103], v[180:183]
    ds_read_b64 v[120:121], v9 offset:25600
    ds_read_b64 v[122:123], v9 offset:26112
    v_mfma_f32_16x16x32_bf16 v[184:187], v[32:35], v[104:107], v[184:187]
    buffer_load_dwordx4 v[32:35], v7, s[4:7], s25 offen offset:0
    s_waitcnt vmcnt(27) lgkmcnt(6)
    v_mfma_f32_16x16x32_bf16 v[156:159], v[36:39], v[108:111], v[156:159]
    ds_read_b64 v[92:93], v8 offset:6144
    ds_read_b64 v[94:95], v8 offset:6656
    s_waitcnt lgkmcnt(6)
    v_mfma_f32_16x16x32_bf16 v[160:163], v[36:39], v[112:115], v[160:163]
    s_waitcnt lgkmcnt(4)
    v_mfma_f32_16x16x32_bf16 v[164:167], v[36:39], v[116:119], v[164:167]
    ds_read_b64 v[96:97], v8 offset:26624
    ds_read_b64 v[98:99], v8 offset:27136
    s_waitcnt lgkmcnt(4)
    v_mfma_f32_16x16x32_bf16 v[168:171], v[36:39], v[120:123], v[168:171]
    buffer_load_dwordx4 v[36:39], v6, s[4:7], s25 offen offset:1024
    s_waitcnt vmcnt(27)
    v_mfma_f32_16x16x32_bf16 v[172:175], v[40:43], v[108:111], v[172:175]
    ds_read_b64 v[100:101], v9 offset:6144
    ds_read_b64 v[102:103], v9 offset:6656
    v_mfma_f32_16x16x32_bf16 v[176:179], v[40:43], v[112:115], v[176:179]
    v_mfma_f32_16x16x32_bf16 v[180:183], v[40:43], v[116:119], v[180:183]
    ds_read_b64 v[104:105], v9 offset:26624
    ds_read_b64 v[106:107], v9 offset:27136
    v_mfma_f32_16x16x32_bf16 v[184:187], v[40:43], v[120:123], v[184:187]
    buffer_load_dwordx4 v[40:43], v7, s[4:7], s25 offen offset:1024
    s_waitcnt vmcnt(27) lgkmcnt(6)
    v_mfma_f32_16x16x32_bf16 v[156:159], v[44:47], v[92:95], v[156:159]
    ds_read_b64 v[108:109], v8 offset:7168
    ds_read_b64 v[110:111], v8 offset:7680
    s_waitcnt lgkmcnt(6)
    v_mfma_f32_16x16x32_bf16 v[160:163], v[44:47], v[96:99], v[160:163]
    s_waitcnt lgkmcnt(4)
    v_mfma_f32_16x16x32_bf16 v[164:167], v[44:47], v[100:103], v[164:167]
    ds_read_b64 v[112:113], v8 offset:27648
    ds_read_b64 v[114:115], v8 offset:28160
    s_waitcnt lgkmcnt(4)
    v_mfma_f32_16x16x32_bf16 v[168:171], v[44:47], v[104:107], v[168:171]
    buffer_load_dwordx4 v[44:47], v6, s[4:7], s25 offen offset:2048
    s_waitcnt vmcnt(27)
    v_mfma_f32_16x16x32_bf16 v[172:175], v[48:51], v[92:95], v[172:175]
    ds_read_b64 v[116:117], v9 offset:7168
    ds_read_b64 v[118:119], v9 offset:7680
    v_mfma_f32_16x16x32_bf16 v[176:179], v[48:51], v[96:99], v[176:179]
    v_mfma_f32_16x16x32_bf16 v[180:183], v[48:51], v[100:103], v[180:183]
    ds_read_b64 v[120:121], v9 offset:27648
    ds_read_b64 v[122:123], v9 offset:28160
    v_mfma_f32_16x16x32_bf16 v[184:187], v[48:51], v[104:107], v[184:187]
    buffer_load_dwordx4 v[48:51], v7, s[4:7], s25 offen offset:2048
    buffer_load_dwordx2 v[188:189], v8, s[4:7], s27 offen offset:0 sc1
    buffer_load_dwordx2 v[190:191], v8, s[4:7], s27 offen offset:512 sc1
    buffer_load_dwordx2 v[192:193], v8, s[4:7], s27 offen offset:1024 sc1
    buffer_load_dwordx2 v[194:195], v8, s[4:7], s27 offen offset:1536 sc1
    buffer_load_dwordx2 v[196:197], v8, s[4:7], s27 offen offset:2048 sc1
    buffer_load_dwordx2 v[198:199], v8, s[4:7], s27 offen offset:2560 sc1
    buffer_load_dwordx2 v[200:201], v8, s[4:7], s27 offen offset:3072 sc1
    buffer_load_dwordx2 v[202:203], v8, s[4:7], s27 offen offset:3584 sc1
    s_waitcnt vmcnt(35) lgkmcnt(6)
    v_mfma_f32_16x16x32_bf16 v[156:159], v[52:55], v[108:111], v[156:159]
    ds_read_b64 v[92:93], v8 offset:8192
    ds_read_b64 v[94:95], v8 offset:8704
    s_waitcnt lgkmcnt(6)
    v_mfma_f32_16x16x32_bf16 v[160:163], v[52:55], v[112:115], v[160:163]
    s_waitcnt lgkmcnt(4)
    v_mfma_f32_16x16x32_bf16 v[164:167], v[52:55], v[116:119], v[164:167]
    ds_read_b64 v[96:97], v8 offset:28672
    ds_read_b64 v[98:99], v8 offset:29184
    s_waitcnt lgkmcnt(4)
    v_mfma_f32_16x16x32_bf16 v[168:171], v[52:55], v[120:123], v[168:171]
    buffer_load_dwordx4 v[52:55], v6, s[4:7], s25 offen offset:3072
    s_waitcnt vmcnt(35)
    v_mfma_f32_16x16x32_bf16 v[172:175], v[56:59], v[108:111], v[172:175]
    ds_read_b64 v[100:101], v9 offset:8192
    ds_read_b64 v[102:103], v9 offset:8704
    v_mfma_f32_16x16x32_bf16 v[176:179], v[56:59], v[112:115], v[176:179]
    v_mfma_f32_16x16x32_bf16 v[180:183], v[56:59], v[116:119], v[180:183]
    ds_read_b64 v[104:105], v9 offset:28672
    ds_read_b64 v[106:107], v9 offset:29184
    v_mfma_f32_16x16x32_bf16 v[184:187], v[56:59], v[120:123], v[184:187]
    buffer_load_dwordx4 v[56:59], v7, s[4:7], s25 offen offset:3072
    s_add_u32 s25, s25, 4096
    s_waitcnt vmcnt(23) lgkmcnt(6)
    v_mfma_f32_16x16x32_bf16 v[156:159], v[60:63], v[92:95], v[156:159]
    ds_read_b64 v[108:109], v8 offset:9216
    ds_read_b64 v[110:111], v8 offset:9728
    s_waitcnt lgkmcnt(6)
    v_mfma_f32_16x16x32_bf16 v[160:163], v[60:63], v[96:99], v[160:163]
    s_waitcnt lgkmcnt(4)
    v_mfma_f32_16x16x32_bf16 v[164:167], v[60:63], v[100:103], v[164:167]
    ds_read_b64 v[112:113], v8 offset:29696
    ds_read_b64 v[114:115], v8 offset:30208
    s_waitcnt lgkmcnt(4)
    v_mfma_f32_16x16x32_bf16 v[168:171], v[60:63], v[104:107], v[168:171]
    buffer_load_dwordx4 v[60:63], v6, s[4:7], s25 offen offset:0
    s_waitcnt vmcnt(23)
    v_mfma_f32_16x16x32_bf16 v[172:175], v[64:67], v[92:95], v[172:175]
    ds_read_b64 v[116:117], v9 offset:9216
    ds_read_b64 v[118:119], v9 offset:9728
    v_mfma_f32_16x16x32_bf16 v[176:179], v[64:67], v[96:99], v[176:179]
    v_mfma_f32_16x16x32_bf16 v[180:183], v[64:67], v[100:103], v[180:183]
    ds_read_b64 v[120:121], v9 offset:29696
    ds_read_b64 v[122:123], v9 offset:30208
    v_mfma_f32_16x16x32_bf16 v[184:187], v[64:67], v[104:107], v[184:187]
    buffer_load_dwordx4 v[64:67], v7, s[4:7], s25 offen offset:0
    s_waitcnt vmcnt(23) lgkmcnt(6)
    v_mfma_f32_16x16x32_bf16 v[156:159], v[68:71], v[108:111], v[156:159]
    ds_read_b64 v[92:93], v8 offset:10240
    ds_read_b64 v[94:95], v8 offset:10752
    s_waitcnt lgkmcnt(6)
    v_mfma_f32_16x16x32_bf16 v[160:163], v[68:71], v[112:115], v[160:163]
    s_waitcnt lgkmcnt(4)
    v_mfma_f32_16x16x32_bf16 v[164:167], v[68:71], v[116:119], v[164:167]
    ds_read_b64 v[96:97], v8 offset:30720
    ds_read_b64 v[98:99], v8 offset:31232
    s_waitcnt lgkmcnt(4)
    v_mfma_f32_16x16x32_bf16 v[168:171], v[68:71], v[120:123], v[168:171]
    buffer_load_dwordx4 v[68:71], v6, s[4:7], s25 offen offset:1024
    s_waitcnt vmcnt(23)
    v_mfma_f32_16x16x32_bf16 v[172:175], v[72:75], v[108:111], v[172:175]
    ds_read_b64 v[100:101], v9 offset:10240
    ds_read_b64 v[102:103], v9 offset:10752
    v_mfma_f32_16x16x32_bf16 v[176:179], v[72:75], v[112:115], v[176:179]
    v_mfma_f32_16x16x32_bf16 v[180:183], v[72:75], v[116:119], v[180:183]
    ds_read_b64 v[104:105], v9 offset:30720
    ds_read_b64 v[106:107], v9 offset:31232
    v_mfma_f32_16x16x32_bf16 v[184:187], v[72:75], v[120:123], v[184:187]
    buffer_load_dwordx4 v[72:75], v7, s[4:7], s25 offen offset:1024
    s_waitcnt vmcnt(23) lgkmcnt(6)
    v_mfma_f32_16x16x32_bf16 v[156:159], v[76:79], v[92:95], v[156:159]
    ds_read_b64 v[108:109], v8 offset:11264
    ds_read_b64 v[110:111], v8 offset:11776
    s_waitcnt lgkmcnt(6)
    v_mfma_f32_16x16x32_bf16 v[160:163], v[76:79], v[96:99], v[160:163]
    s_waitcnt lgkmcnt(4)
    v_mfma_f32_16x16x32_bf16 v[164:167], v[76:79], v[100:103], v[164:167]
    ds_read_b64 v[112:113], v8 offset:31744
    ds_read_b64 v[114:115], v8 offset:32256
    s_waitcnt lgkmcnt(4)
    v_mfma_f32_16x16x32_bf16 v[168:171], v[76:79], v[104:107], v[168:171]
    buffer_load_dwordx4 v[76:79], v6, s[4:7], s25 offen offset:2048
    s_waitcnt vmcnt(23)
    v_mfma_f32_16x16x32_bf16 v[172:175], v[80:83], v[92:95], v[172:175]
    ds_read_b64 v[116:117], v9 offset:11264
    ds_read_b64 v[118:119], v9 offset:11776
    v_mfma_f32_16x16x32_bf16 v[176:179], v[80:83], v[96:99], v[176:179]
    v_mfma_f32_16x16x32_bf16 v[180:183], v[80:83], v[100:103], v[180:183]
    ds_read_b64 v[120:121], v9 offset:31744
    ds_read_b64 v[122:123], v9 offset:32256
    v_mfma_f32_16x16x32_bf16 v[184:187], v[80:83], v[104:107], v[184:187]
    buffer_load_dwordx4 v[80:83], v7, s[4:7], s25 offen offset:2048
    s_waitcnt vmcnt(23) lgkmcnt(6)
    v_mfma_f32_16x16x32_bf16 v[156:159], v[84:87], v[108:111], v[156:159]
    ds_read_b64 v[92:93], v8 offset:12288
    ds_read_b64 v[94:95], v8 offset:12800
    s_waitcnt lgkmcnt(6)
    v_mfma_f32_16x16x32_bf16 v[160:163], v[84:87], v[112:115], v[160:163]
    s_waitcnt lgkmcnt(4)
    v_mfma_f32_16x16x32_bf16 v[164:167], v[84:87], v[116:119], v[164:167]
    ds_read_b64 v[96:97], v8 offset:32768
    ds_read_b64 v[98:99], v8 offset:33280
    s_waitcnt lgkmcnt(4)
    v_mfma_f32_16x16x32_bf16 v[168:171], v[84:87], v[120:123], v[168:171]
    buffer_load_dwordx4 v[84:87], v6, s[4:7], s25 offen offset:3072
    s_waitcnt vmcnt(23)
    v_mfma_f32_16x16x32_bf16 v[172:175], v[88:91], v[108:111], v[172:175]
    ds_read_b64 v[100:101], v9 offset:12288
    ds_read_b64 v[102:103], v9 offset:12800
    v_mfma_f32_16x16x32_bf16 v[176:179], v[88:91], v[112:115], v[176:179]
    v_mfma_f32_16x16x32_bf16 v[180:183], v[88:91], v[116:119], v[180:183]
    ds_read_b64 v[104:105], v9 offset:32768
    ds_read_b64 v[106:107], v9 offset:33280
    v_mfma_f32_16x16x32_bf16 v[184:187], v[88:91], v[120:123], v[184:187]
    buffer_load_dwordx4 v[88:91], v7, s[4:7], s25 offen offset:3072
    s_add_u32 s25, s25, 4096
    s_mov_b32 s32, 65536
L_kb_poll_3:
    s_waitcnt vmcnt(15)
    v_max3_u32 v4, v189, v191, v193
    s_waitcnt vmcnt(13)
    v_max3_u32 v4, v4, v195, v197
    s_waitcnt vmcnt(11)
    v_max3_u32 v4, v4, v199, v201
    s_waitcnt vmcnt(10)
    v_max_u32 v4, v4, v203
    v_cmp_eq_u32 vcc, -1, v4
    s_nop 0
    s_cbranch_vccz L_kb_got_4
    buffer_load_dwordx2 v[188:189], v8, s[4:7], s27 offen offset:0 sc1
    buffer_load_dwordx2 v[190:191], v8, s[4:7], s27 offen offset:512 sc1
    buffer_load_dwordx2 v[192:193], v8, s[4:7], s27 offen offset:1024 sc1
    buffer_load_dwordx2 v[194:195], v8, s[4:7], s27 offen offset:1536 sc1
    buffer_load_dwordx2 v[196:197], v8, s[4:7], s27 offen offset:2048 sc1
    buffer_load_dwordx2 v[198:199], v8, s[4:7], s27 offen offset:2560 sc1
    buffer_load_dwordx2 v[200:201], v8, s[4:7], s27 offen offset:3072 sc1
    buffer_load_dwordx2 v[202:203], v8, s[4:7], s27 offen offset:3584 sc1
    s_waitcnt vmcnt(0)
    s_sub_u32 s32, s32, 1
    s_cmp_lg_u32 s32, 0
    s_cbranch_scc1 L_kb_poll_3
L_kb_got_4:
    v_pk_add_f32 v[188:189], v[188:189], v[190:191]
    v_pk_add_f32 v[192:193], v[192:193], v[194:195]
    v_pk_add_f32 v[196:197], v[196:197], v[198:199]
    v_pk_add_f32 v[200:201], v[200:201], v[202:203]
    v_pk_add_f32 v[188:189], v[188:189], v[192:193]
    v_pk_add_f32 v[196:197], v[196:197], v[200:201]
    v_pk_add_f32 v[188:189], v[188:189], v[196:197]
    v_mul_f32 v240, 0xba97b426, v188
    v_mul_f32 v241, 0x3a97b426, v189
    v_fma_f32 v241, -v240, v240, v241
    v_max_f32 v241, 0, v241
    v_add_f32 v241, 0x3727c5ac, v241
    v_rsq_f32 v241, v241
    s_add_u32 s36, s34, 84480
    v_lshl_add_u32 v4, v1, 2, s36
    v_mul_f32 v240, v240, v241
    ds_write2st64_b32 v4, v241, v240 offset0:0 offset1:1
    v_add_u32 v4, s36, v10
    ds_read_b128 v[188:191], v4 offset:0
    ds_read_b128 v[204:207], v4 offset:256
    ds_read_b128 v[192:195], v4 offset:64
    ds_read_b128 v[208:211], v4 offset:320
    ds_read_b128 v[196:199], v4 offset:128
    ds_read_b128 v[212:215], v4 offset:384
    ds_read_b128 v[200:203], v4 offset:192
    ds_read_b128 v[216:219], v4 offset:448
    s_mul_i32 s28, s22, 458752
    s_add_u32 s28, s28, 12582912
    s_lshl_b32 s36, s20, 17
    s_add_u32 s36, s36, s28
    s_lshl_b32 s37, s21, 11
    s_add_u32 s36, s36, s37
    v_add_u32 v5, 45056, v7
    s_waitcnt lgkmcnt(6)
    v_pk_fma_f32 v[124:125], v[124:125], v[188:189], v[204:205]
    v_pk_fma_f32 v[126:127], v[126:127], v[190:191], v[206:207]
    s_waitcnt lgkmcnt(4)
    v_pk_fma_f32 v[128:129], v[128:129], v[192:193], v[208:209]
    v_pk_fma_f32 v[130:131], v[130:131], v[194:195], v[210:211]
    v_cvt_pk_bf16_f32 v240, v124, v128
    v_cvt_pk_bf16_f32 v241, v125, v129
    v_cvt_pk_bf16_f32 v242, v126, v130
    v_cvt_pk_bf16_f32 v243, v127, v131
    buffer_store_dwordx4 v[240:243], v6, s[4:7], s36 offen offset:0 sc1
    v_pk_fma_f32 v[140:141], v[140:141], v[188:189], v[204:205]
    v_pk_fma_f32 v[142:143], v[142:143], v[190:191], v[206:207]
    v_pk_fma_f32 v[144:145], v[144:145], v[192:193], v[208:209]
    v_pk_fma_f32 v[146:147], v[146:147], v[194:195], v[210:211]
    v_cvt_pk_bf16_f32 v244, v140, v144
    v_cvt_pk_bf16_f32 v245, v141, v145
    v_cvt_pk_bf16_f32 v246, v142, v146
    v_cvt_pk_bf16_f32 v247, v143, v147
    buffer_store_dwordx4 v[244:247], v5, s[4:7], s36 offen offset:0 sc1
    s_waitcnt lgkmcnt(2)
    v_pk_fma_f32 v[132:133], v[132:133], v[196:197], v[212:213]
    v_pk_fma_f32 v[134:135], v[134:135], v[198:199], v[214:215]
    s_waitcnt lgkmcnt(0)
    v_pk_fma_f32 v[136:137], v[136:137], v[200:201], v[216:217]
    v_pk_fma_f32 v[138:139], v[138:139], v[202:203], v[218:219]
    v_cvt_pk_bf16_f32 v240, v132, v136
    v_cvt_pk_bf16_f32 v241, v133, v137
    v_cvt_pk_bf16_f32 v242, v134, v138
    v_cvt_pk_bf16_f32 v243, v135, v139
    buffer_store_dwordx4 v[240:243], v6, s[4:7], s36 offen offset:1024 sc1
    v_pk_fma_f32 v[148:149], v[148:149], v[196:197], v[212:213]
    v_pk_fma_f32 v[150:151], v[150:151], v[198:199], v[214:215]
    v_pk_fma_f32 v[152:153], v[152:153], v[200:201], v[216:217]
    v_pk_fma_f32 v[154:155], v[154:155], v[202:203], v[218:219]
    v_cvt_pk_bf16_f32 v244, v148, v152
    v_cvt_pk_bf16_f32 v245, v149, v153
    v_cvt_pk_bf16_f32 v246, v150, v154
    v_cvt_pk_bf16_f32 v247, v151, v155
    buffer_store_dwordx4 v[244:247], v5, s[4:7], s36 offen offset:1024 sc1
    v_mfma_f32_16x16x32_bf16 v[156:159], v[28:31], v[92:95], v[156:159]
    ds_read_b64 v[108:109], v8 offset:13312
    ds_read_b64 v[110:111], v8 offset:13824
    v_mfma_f32_16x16x32_bf16 v[160:163], v[28:31], v[96:99], v[160:163]
    v_mfma_f32_16x16x32_bf16 v[164:167], v[28:31], v[100:103], v[164:167]
    ds_read_b64 v[112:113], v8 offset:33792
    ds_read_b64 v[114:115], v8 offset:34304
    v_mfma_f32_16x16x32_bf16 v[168:171], v[28:31], v[104:107], v[168:171]
    ds_read_b128 a[0:3], v13 offset:1024
    ds_read_b128 a[4:7], v14 offset:1024
    v_mfma_f32_16x16x32_bf16 v[172:175], v[32:35], v[92:95], v[172:175]
    ds_read_b64 v[116:117], v9 offset:13312
    ds_read_b64 v[118:119], v9 offset:13824
    v_mfma_f32_16x16x32_bf16 v[176:179], v[32:35], v[96:99], v[176:179]
    v_mfma_f32_16x16x32_bf16 v[180:183], v[32:35], v[100:103], v[180:183]
    ds_read_b64 v[120:121], v9 offset:33792
    ds_read_b64 v[122:123], v9 offset:34304
    v_mfma_f32_16x16x32_bf16 v[184:187], v[32:35], v[104:107], v[184:187]
    ds_read_b128 a[8:11], v13 offset:3072
    ds_read_b128 a[12:15], v14 offset:3072
    s_waitcnt lgkmcnt(6)
    s_add_u32 m0, s26, 256
    s_nop 0
    buffer_load_dwordx4 v11, s[8:11], s38 offen offset:768 lds
    v_mfma_f32_16x16x32_bf16 v[156:159], v[36:39], v[108:111], v[156:159]
    ds_read_b64 v[92:93], v8 offset:14336
    ds_read_b64 v[94:95], v8 offset:14848
    v_mfma_f32_16x16x32_bf16 v[160:163], v[36:39], v[112:115], v[160:163]
    s_waitcnt lgkmcnt(6)
    v_mfma_f32_16x16x32_bf16 v[164:167], v[36:39], v[116:119], v[164:167]
    ds_read_b64 v[96:97], v8 offset:34816
    ds_read_b64 v[98:99], v8 offset:35328
    s_waitcnt lgkmcnt(6)
    v_mfma_f32_16x16x32_bf16 v[168:171], v[36:39], v[120:123], v[168:171]
    s_add_u32 m0, s26, 1280
    s_nop 0
    buffer_load_dwordx4 v12, s[8:11], s38 offen offset:768 lds
    v_mfma_f32_16x16x32_bf16 v[172:175], v[40:43], v[108:111], v[172:175]
    ds_read_b64 v[100:101], v9 offset:14336
    ds_read_b64 v[102:103], v9 offset:14848
    v_mfma_f32_16x16x32_bf16 v[176:179], v[40:43], v[112:115], v[176:179]
    v_mfma_f32_16x16x32_bf16 v[180:183], v[40:43], v[116:119], v[180:183]
    ds_read_b64 v[104:105], v9 offset:34816
    ds_read_b64 v[106:107], v9 offset:35328
    v_mfma_f32_16x16x32_bf16 v[184:187], v[40:43], v[120:123], v[184:187]
    ds_read_b128 a[16:19], v13 offset:5120
    ds_read_b128 a[20:23], v14 offset:5120
    s_waitcnt lgkmcnt(10)
    s_add_u32 m0, s26, 2176
    s_nop 0
    buffer_load_dwordx4 v11, s[8:11], s38 offen offset:896 lds
    s_waitcnt lgkmcnt(8)
    v_mfma_f32_16x16x32_bf16 v[156:159], v[44:47], v[92:95], v[156:159]
    ds_read_b64 v[108:109], v8 offset:15360
    ds_read_b64 v[110:111], v8 offset:15872
    s_waitcnt lgkmcnt(8)
    v_mfma_f32_16x16x32_bf16 v[160:163], v[44:47], v[96:99], v[160:163]
    s_waitcnt lgkmcnt(6)
    v_mfma_f32_16x16x32_bf16 v[164:167], v[44:47], v[100:103], v[164:167]
    ds_read_b64 v[112:113], v8 offset:35840
    ds_read_b64 v[114:115], v8 offset:36352
    s_waitcnt lgkmcnt(6)
    v_mfma_f32_16x16x32_bf16 v[168:171], v[44:47], v[104:107], v[168:171]
    s_add_u32 m0, s26, 3200
    s_nop 0
    buffer_load_dwordx4 v12, s[8:11], s38 offen offset:896 lds
    v_mfma_f32_16x16x32_bf16 v[172:175], v[48:51], v[92:95], v[172:175]
    ds_read_b64 v[116:117], v9 offset:15360
    ds_read_b64 v[118:119], v9 offset:15872
    v_mfma_f32_16x16x32_bf16 v[176:179], v[48:51], v[96:99], v[176:179]
    v_mfma_f32_16x16x32_bf16 v[180:183], v[48:51], v[100:103], v[180:183]
    ds_read_b64 v[120:121], v9 offset:35840
    ds_read_b64 v[122:123], v9 offset:36352
    v_mfma_f32_16x16x32_bf16 v[184:187], v[48:51], v[104:107], v[184:187]
    ds_read_b128 a[24:27], v13 offset:7168
    ds_read_b128 a[28:31], v14 offset:7168
    s_waitcnt lgkmcnt(10)
    s_add_u32 m0, s26, 5120
    s_nop 0
    buffer_load_dwordx4 v11, s[8:11], s39 offen offset:0 lds
    s_waitcnt vmcnt(18) lgkmcnt(8)
    v_mfma_f32_16x16x32_bf16 v[156:159], v[52:55], v[108:111], v[156:159]
    ds_read_b64 v[92:93], v8 offset:16384
    ds_read_b64 v[94:95], v8 offset:16896
    s_waitcnt lgkmcnt(8)
    v_mfma_f32_16x16x32_bf16 v[160:163], v[52:55], v[112:115], v[160:163]
    s_waitcnt lgkmcnt(6)
    v_mfma_f32_16x16x32_bf16 v[164:167], v[52:55], v[116:119], v[164:167]
    ds_read_b64 v[96:97], v8 offset:36864
    ds_read_b64 v[98:99], v8 offset:37376
    s_waitcnt lgkmcnt(6)
    v_mfma_f32_16x16x32_bf16 v[168:171], v[52:55], v[120:123], v[168:171]
    s_add_u32 m0, s26, 6144
    s_nop 0
    buffer_load_dwordx4 v12, s[8:11], s39 offen offset:0 lds
    s_waitcnt vmcnt(18)
    v_mfma_f32_16x16x32_bf16 v[172:175], v[56:59], v[108:111], v[172:175]
    ds_read_b64 v[100:101], v9 offset:16384
    ds_read_b64 v[102:103], v9 offset:16896
    v_mfma_f32_16x16x32_bf16 v[176:179], v[56:59], v[112:115], v[176:179]
    v_mfma_f32_16x16x32_bf16 v[180:183], v[56:59], v[116:119], v[180:183]
    ds_read_b64 v[104:105], v9 offset:36864
    ds_read_b64 v[106:107], v9 offset:37376
    v_mfma_f32_16x16x32_bf16 v[184:187], v[56:59], v[120:123], v[184:187]
    ds_read_b128 a[32:35], v13 offset:9216
    ds_read_b128 a[36:39], v14 offset:9216
    s_waitcnt lgkmcnt(10)
    s_add_u32 m0, s26, 7040
    s_nop 0
    buffer_load_dwordx4 v11, s[8:11], s39 offen offset:128 lds
    s_waitcnt vmcnt(18) lgkmcnt(8)
    v_mfma_f32_16x16x32_bf16 v[156:159], v[60:63], v[92:95], v[156:159]
    ds_read_b64 v[108:109], v8 offset:17408
    ds_read_b64 v[110:111], v8 offset:17920
    s_waitcnt lgkmcnt(8)
    v_mfma_f32_16x16x32_bf16 v[160:163], v[60:63], v[96:99], v[160:163]
    s_waitcnt lgkmcnt(6)
    v_mfma_f32_16x16x32_bf16 v[164:167], v[60:63], v[100:103], v[164:167]
    ds_read_b64 v[112:113], v8 offset:37888
    ds_read_b64 v[114:115], v8 offset:38400
    s_waitcnt lgkmcnt(6)
    v_mfma_f32_16x16x32_bf16 v[168:171], v[60:63], v[104:107], v[168:171]
    s_add_u32 m0, s26, 8064
    s_nop 0
    buffer_load_dwordx4 v12, s[8:11], s39 offen offset:128 lds
    s_waitcnt vmcnt(18)
    v_mfma_f32_16x16x32_bf16 v[172:175], v[64:67], v[92:95], v[172:175]
    ds_read_b64 v[116:117], v9 offset:17408
    ds_read_b64 v[118:119], v9 offset:17920
    v_mfma_f32_16x16x32_bf16 v[176:179], v[64:67], v[96:99], v[176:179]
    v_mfma_f32_16x16x32_bf16 v[180:183], v[64:67], v[100:103], v[180:183]
    ds_read_b64 v[120:121], v9 offset:37888
    ds_read_b64 v[122:123], v9 offset:38400
    v_mfma_f32_16x16x32_bf16 v[184:187], v[64:67], v[104:107], v[184:187]
    ds_read_b128 a[40:43], v13 offset:11264
    ds_read_b128 a[44:47], v14 offset:11264
    s_waitcnt lgkmcnt(10)
    s_add_u32 m0, s26, 8960
    s_nop 0
    buffer_load_dwordx4 v11, s[8:11], s39 offen offset:256 lds
    s_waitcnt vmcnt(18) lgkmcnt(8)
    v_mfma_f32_16x16x32_bf16 v[156:159], v[68:71], v[108:111], v[156:159]
    ds_read_b64 v[92:93], v8 offset:18432
    ds_read_b64 v[94:95], v8 offset:18944
    s_waitcnt lgkmcnt(8)
    v_mfma_f32_16x16x32_bf16 v[160:163], v[68:71], v[112:115], v[160:163]
    s_waitcnt lgkmcnt(6)
    v_mfma_f32_16x16x32_bf16 v[164:167], v[68:71], v[116:119], v[164:167]
    ds_read_b64 v[96:97], v8 offset:38912
    ds_read_b64 v[98:99], v8 offset:39424
    s_waitcnt lgkmcnt(6)
    v_mfma_f32_16x16x32_bf16 v[168:171], v[68:71], v[120:123], v[168:171]
    s_add_u32 m0, s26, 9984
    s_nop 0
    buffer_load_dwordx4 v12, s[8:11], s39 offen offset:256 lds
    s_waitcnt vmcnt(18)
    v_mfma_f32_16x16x32_bf16 v[172:175], v[72:75], v[108:111], v[172:175]
    ds_read_b64 v[100:101], v9 offset:18432
    ds_read_b64 v[102:103], v9 offset:18944
    v_mfma_f32_16x16x32_bf16 v[176:179], v[72:75], v[112:115], v[176:179]
    v_mfma_f32_16x16x32_bf16 v[180:183], v[72:75], v[116:119], v[180:183]
    ds_read_b64 v[104:105], v9 offset:38912
    ds_read_b64 v[106:107], v9 offset:39424
    v_mfma_f32_16x16x32_bf16 v[184:187], v[72:75], v[120:123], v[184:187]
    s_waitcnt vmcnt(8)
    ds_read_b128 a[48:51], v13 offset:1024
    ds_read_b128 a[52:55], v14 offset:1024
    s_waitcnt lgkmcnt(10)
    s_add_u32 m0, s26, 10880
    s_nop 0
    buffer_load_dwordx4 v11, s[8:11], s39 offen offset:384 lds
    s_waitcnt lgkmcnt(8)
    v_mfma_f32_16x16x32_bf16 v[156:159], v[76:79], v[92:95], v[156:159]
    ds_read_b64 v[108:109], v8 offset:19456
    ds_read_b64 v[110:111], v8 offset:19968
    s_waitcnt lgkmcnt(8)
    v_mfma_f32_16x16x32_bf16 v[160:163], v[76:79], v[96:99], v[160:163]
    s_waitcnt lgkmcnt(6)
    v_mfma_f32_16x16x32_bf16 v[164:167], v[76:79], v[100:103], v[164:167]
    ds_read_b64 v[112:113], v8 offset:39936
    ds_read_b64 v[114:115], v8 offset:40448
    s_waitcnt lgkmcnt(6)
    v_mfma_f32_16x16x32_bf16 v[168:171], v[76:79], v[104:107], v[168:171]
    s_add_u32 m0, s26, 11904
    s_nop 0
    buffer_load_dwordx4 v12, s[8:11], s39 offen offset:384 lds
    v_mfma_f32_16x16x32_bf16 v[172:175], v[80:83], v[92:95], v[172:175]
    ds_read_b64 v[116:117], v9 offset:19456
    ds_read_b64 v[118:119], v9 offset:19968
    v_mfma_f32_16x16x32_bf16 v[176:179], v[80:83], v[96:99], v[176:179]
    v_mfma_f32_16x16x32_bf16 v[180:183], v[80:83], v[100:103], v[180:183]
    ds_read_b64 v[120:121], v9 offset:39936
    ds_read_b64 v[122:123], v9 offset:40448
    v_mfma_f32_16x16x32_bf16 v[184:187], v[80:83], v[104:107], v[184:187]
    s_waitcnt vmcnt(8)
    ds_read_b128 a[56:59], v13 offset:3072
    ds_read_b128 a[60:63], v14 offset:3072
    s_waitcnt lgkmcnt(10)
    s_add_u32 m0, s26, 512
    s_nop 0
    buffer_load_dwordx4 v11, s[8:11], s39 offen offset:512 lds
    s_waitcnt lgkmcnt(8)
    v_mfma_f32_16x16x32_bf16 v[156:159], v[84:87], v[108:111], v[156:159]
    s_waitcnt lgkmcnt(6)
    v_mfma_f32_16x16x32_bf16 v[160:163], v[84:87], v[112:115], v[160:163]
    s_waitcnt lgkmcnt(4)
    v_mfma_f32_16x16x32_bf16 v[164:167], v[84:87], v[116:119], v[164:167]
    s_waitcnt lgkmcnt(2)
    v_mfma_f32_16x16x32_bf16 v[168:171], v[84:87], v[120:123], v[168:171]
    s_add_u32 m0, s26, 1536
    s_nop 0
    buffer_load_dwordx4 v12, s[8:11], s39 offen offset:512 lds
    v_mfma_f32_16x16x32_bf16 v[172:175], v[88:91], v[108:111], v[172:175]
    v_mfma_f32_16x16x32_bf16 v[176:179], v[88:91], v[112:115], v[176:179]
    v_mfma_f32_16x16x32_bf16 v[180:183], v[88:91], v[116:119], v[180:183]
    v_mfma_f32_16x16x32_bf16 v[184:187], v[88:91], v[120:123], v[184:187]
    s_waitcnt vmcnt(8)
    ds_read_b128 a[64:67], v13 offset:5120
    ds_read_b128 a[68:71], v14 offset:5120
    s_waitcnt lgkmcnt(2)
    s_add_u32 m0, s26, 2432
    s_nop 0
    buffer_load_dwordx4 v11, s[8:11], s39 offen offset:640 lds
    s_lshl_b32 s36, s22, 5
    s_add_u32 s36, s36, s21
    s_lshl_b32 s36, s36, 2
    s_add_u32 s36, s36, s20
    s_lshl_b32 s36, s36, 2
    s_add_u32 s36, s36, 196608
    v_mov_b32 v4, 0
    s_mov_b64 exec, 1
    buffer_store_dword v4, off, s[4:7], s36 sc1
    s_mov_b64 exec, -1
    s_mul_i32 s36, s22, 10
    v_add_u32 v4, s36, v3
    v_lshrrev_b32 v5, 2, v4
    v_and_b32 v4, 3, v4
    v_lshlrev_b32 v4, 7, v4
    v_lshl_add_u32 v4, v5, 10, v4
    v_lshl_add_u32 v4, v2, 3, v4
    v_add_u32 v4, s24, v4
    ds_read_b64 v[16:17], v4 offset:0
    ds_read_b64 v[18:19], v4 offset:512
    ds_read_b64 v[20:21], v4 offset:1024
    ds_read_b64 v[22:23], v4 offset:1536
    v_lshrrev_b32 v4, 1, v3
    v_add3_u32 v4, v4, s36, 8
    v_lshrrev_b32 v5, 2, v4
    v_and_b32 v4, 3, v4
    v_lshlrev_b32 v4, 7, v4
    v_lshl_add_u32 v4, v5, 10, v4
    v_and_b32 v5, 1, v3
    v_lshl_add_u32 v4, v5, 9, v4
    v_lshl_add_u32 v4, v2, 3, v4
    v_add_u32 v4, s24, v4
    ds_read_b64 v[24:25], v4
    v_lshlrev_b32 v4, 2, v2
    v_add_u32 v4, 81920, v4
    ds_read2_b32 v[188:189], v4 offset0:0 offset1:64
    ds_read2_b32 v[190:191], v4 offset0:16 offset1:80
    ds_read2_b32 v[192:193], v4 offset0:32 offset1:96
    ds_read2_b32 v[194:195], v4 offset0:48 offset1:112
    s_lshl_b32 s36, s20, 10
    s_add_u32 s36, s36, 86528
    v_add_u32 v4, s36, v6
    s_waitcnt lgkmcnt(3)
    v_pk_fma_f32 v[156:157], v[220:221], v[188:189], v[156:157] op_sel:[0,1,0] op_sel_hi:[1,1,1]
    s_add_u32 m0, s26, 3456
    s_nop 0
    buffer_load_dwordx4 v12, s[8:11], s39 offen offset:640 lds
    v_pk_fma_f32 v[158:159], v[222:223], v[188:189], v[158:159] op_sel:[0,1,0] op_sel_hi:[1,1,1]
    v_pk_fma_f32 v[172:173], v[224:225], v[188:189], v[172:173] op_sel:[0,1,0] op_sel_hi:[1,1,1]
    v_pk_fma_f32 v[174:175], v[226:227], v[188:189], v[174:175] op_sel:[0,1,0] op_sel_hi:[1,1,1]
    v_pk_fma_f32 v[156:157], v[156:157], v[188:189], v[228:229] op_sel:[0,0,0] op_sel_hi:[1,0,1]
    v_pk_fma_f32 v[158:159], v[158:159], v[188:189], v[230:231] op_sel:[0,0,0] op_sel_hi:[1,0,1]
    v_pk_fma_f32 v[172:173], v[172:173], v[188:189], v[232:233] op_sel:[0,0,0] op_sel_hi:[1,0,1]
    v_pk_fma_f32 v[174:175], v[174:175], v[188:189], v[234:235] op_sel:[0,0,0] op_sel_hi:[1,0,1]
    v_pk_mul_f32 v[240:241], v[156:157], v[156:157]
    v_pk_mul_f32 v[242:243], v[158:159], v[158:159]
    v_pk_mul_f32 v[244:245], v[172:173], v[172:173]
    v_pk_mul_f32 v[246:247], v[174:175], v[174:175]
    v_pk_fma_f32 v[240:241], v[240:241], s[42:43], s[42:43] op_sel:[0,0,1] op_sel_hi:[1,0,1]
    v_pk_fma_f32 v[242:243], v[242:243], s[42:43], s[42:43] op_sel:[0,0,1] op_sel_hi:[1,0,1]
    v_pk_fma_f32 v[244:245], v[244:245], s[42:43], s[42:43] op_sel:[0,0,1] op_sel_hi:[1,0,1]
    s_waitcnt vmcnt(9)
    ds_read_b128 a[72:75], v13 offset:7168
    ds_read_b128 a[76:79], v14 offset:7168
    s_add_u32 m0, s26, 4352
    s_nop 0
    buffer_load_dwordx4 v11, s[8:11], s39 offen offset:768 lds
    v_pk_fma_f32 v[246:247], v[246:247], s[42:43], s[42:43] op_sel:[0,0,1] op_sel_hi:[1,0,1]
    v_pk_mul_f32 v[240:241], v[240:241], v[156:157]
    v_pk_mul_f32 v[242:243], v[242:243], v[158:159]
    v_pk_mul_f32 v[244:245], v[244:245], v[172:173]
    v_pk_mul_f32 v[246:247], v[246:247], v[174:175]
    v_exp_f32 v240, v240
    v_exp_f32 v241, v241
    v_exp_f32 v242, v242
    v_exp_f32 v243, v243
    v_exp_f32 v244, v244
    v_exp_f32 v245, v245
    v_exp_f32 v246, v246
    v_exp_f32 v247, v247
    v_pk_add_f32 v[240:241], v[240:241], s[44:45]
    s_add_u32 m0, s26, 5376
    s_nop 0
    buffer_load_dwordx4 v12, s[8:11], s39 offen offset:768 lds
    v_pk_add_f32 v[242:243], v[242:243], s[44:45]
    v_pk_add_f32 v[244:245], v[244:245], s[44:45]
    v_pk_add_f32 v[246:247], v[246:247], s[44:45]
    v_rcp_f32 v240, v240
    v_rcp_f32 v241, v241
    v_rcp_f32 v242, v242
    v_rcp_f32 v243, v243
    v_rcp_f32 v244, v244
    v_rcp_f32 v245, v245
    v_rcp_f32 v246, v246
    v_rcp_f32 v247, v247
    v_pk_mul_f32 v[156:157], v[156:157], v[240:241]
    v_pk_mul_f32 v[158:159], v[158:159], v[242:243]
    v_pk_mul_f32 v[172:173], v[172:173], v[244:245]
    s_waitcnt vmcnt(9)
    ds_read_b128 a[80:83], v13 offset:9216
    ds_read_b128 a[84:87], v14 offset:9216
    s_waitcnt lgkmcnt(2)
    s_add_u32 m0, s26, 6272
    s_nop 0
    buffer_load_dwordx4 v11, s[8:11], s39 offen offset:896 lds
    v_pk_mul_f32 v[174:175], v[174:175], v[246:247]
    v_cvt_pk_bf16_f32 v204, v156, v172
    v_cvt_pk_bf16_f32 v205, v157, v173
    v_cvt_pk_bf16_f32 v206, v158, v174
    v_cvt_pk_bf16_f32 v207, v159, v175
    ds_write_b128 v4, v[204:207] offset:0
    v_pk_fma_f32 v[160:161], v[220:221], v[190:191], v[160:161] op_sel:[0,1,0] op_sel_hi:[1,1,1]
    v_pk_fma_f32 v[162:163], v[222:223], v[190:191], v[162:163] op_sel:[0,1,0] op_sel_hi:[1,1,1]
    v_pk_fma_f32 v[176:177], v[224:225], v[190:191], v[176:177] op_sel:[0,1,0] op_sel_hi:[1,1,1]
    v_pk_fma_f32 v[178:179], v[226:227], v[190:191], v[178:179] op_sel:[0,1,0] op_sel_hi:[1,1,1]
    v_pk_fma_f32 v[160:161], v[160:161], v[190:191], v[228:229] op_sel:[0,0,0] op_sel_hi:[1,0,1]
    v_pk_fma_f32 v[162:163], v[162:163], v[190:191], v[230:231] op_sel:[0,0,0] op_sel_hi:[1,0,1]
    v_pk_fma_f32 v[176:177], v[176:177], v[190:191], v[232:233] op_sel:[0,0,0] op_sel_hi:[1,0,1]
    v_pk_fma_f32 v[178:179], v[178:179], v[190:191], v[234:235] op_sel:[0,0,0] op_sel_hi:[1,0,1]
    s_add_u32 m0, s26, 7296
    s_nop 0
    buffer_load_dwordx4 v12, s[8:11], s39 offen offset:896 lds
    v_pk_mul_f32 v[240:241], v[160:161], v[160:161]
    v_pk_mul_f32 v[242:243], v[162:163], v[162:163]
    v_pk_mul_f32 v[244:245], v[176:177], v[176:177]
    v_pk_mul_f32 v[246:247], v[178:179], v[178:179]
    v_pk_fma_f32 v[240:241], v[240:241], s[42:43], s[42:43] op_sel:[0,0,1] op_sel_hi:[1,0,1]
    v_pk_fma_f32 v[242:243], v[242:243], s[42:43], s[42:43] op_sel:[0,0,1] op_sel_hi:[1,0,1]
    v_pk_fma_f32 v[244:245], v[244:245], s[42:43], s[42:43] op_sel:[0,0,1] op_sel_hi:[1,0,1]
    v_pk_fma_f32 v[246:247], v[246:247], s[42:43], s[42:43] op_sel:[0,0,1] op_sel_hi:[1,0,1]
    v_pk_mul_f32 v[240:241], v[240:241], v[160:161]
    v_pk_mul_f32 v[242:243], v[242:243], v[162:163]
    v_pk_mul_f32 v[244:245], v[244:245], v[176:177]
    v_pk_mul_f32 v[246:247], v[246:247], v[178:179]
    v_exp_f32 v240, v240
    v_exp_f32 v241, v241
    s_waitcnt vmcnt(9)
    ds_read_b128 a[88:91], v13 offset:11264
    ds_read_b128 a[92:95], v14 offset:11264
    s_waitcnt lgkmcnt(3)
    s_add_u32 m0, s26, 9216
    s_nop 0
    buffer_load_dwordx4 v11, s[8:11], s40 offen offset:0 lds
    v_exp_f32 v242, v242
    v_exp_f32 v243, v243
    v_exp_f32 v244, v244
    v_exp_f32 v245, v245
    v_exp_f32 v246, v246
    v_exp_f32 v247, v247
    v_pk_add_f32 v[240:241], v[240:241], s[44:45]
    v_pk_add_f32 v[242:243], v[242:243], s[44:45]
    v_pk_add_f32 v[244:245], v[244:245], s[44:45]
    v_pk_add_f32 v[246:247], v[246:247], s[44:45]
    v_rcp_f32 v240, v240
    v_rcp_f32 v241, v241
    v_rcp_f32 v242, v242
    v_rcp_f32 v243, v243
    s_add_u32 m0, s26, 10240
    s_nop 0
    buffer_load_dwordx4 v12, s[8:11], s40 offen offset:0 lds
    v_rcp_f32 v244, v244
    v_rcp_f32 v245, v245
    v_rcp_f32 v246, v246
    v_rcp_f32 v247, v247
    v_pk_mul_f32 v[160:161], v[160:161], v[240:241]
    v_pk_mul_f32 v[162:163], v[162:163], v[242:243]
    v_pk_mul_f32 v[176:177], v[176:177], v[244:245]
    v_pk_mul_f32 v[178:179], v[178:179], v[246:247]
    v_cvt_pk_bf16_f32 v208, v160, v176
    v_cvt_pk_bf16_f32 v209, v161, v177
    v_cvt_pk_bf16_f32 v210, v162, v178
    v_cvt_pk_bf16_f32 v211, v163, v179
    ds_write_b128 v4, v[208:211] offset:4096
    v_pk_fma_f32 v[164:165], v[220:221], v[192:193], v[164:165] op_sel:[0,1,0] op_sel_hi:[1,1,1]
    s_waitcnt vmcnt(9)
    ds_read_b128 a[96:99], v13 offset:1024
    ds_read_b128 a[100:103], v14 offset:1024
    s_waitcnt lgkmcnt(3)
    s_add_u32 m0, s26, 11136
    s_nop 0
    buffer_load_dwordx4 v11, s[8:11], s40 offen offset:128 lds
    v_pk_fma_f32 v[166:167], v[222:223], v[192:193], v[166:167] op_sel:[0,1,0] op_sel_hi:[1,1,1]
    v_pk_fma_f32 v[180:181], v[224:225], v[192:193], v[180:181] op_sel:[0,1,0] op_sel_hi:[1,1,1]
    v_pk_fma_f32 v[182:183], v[226:227], v[192:193], v[182:183] op_sel:[0,1,0] op_sel_hi:[1,1,1]
    v_pk_fma_f32 v[164:165], v[164:165], v[192:193], v[228:229] op_sel:[0,0,0] op_sel_hi:[1,0,1]
    v_pk_fma_f32 v[166:167], v[166:167], v[192:193], v[230:231] op_sel:[0,0,0] op_sel_hi:[1,0,1]
    v_pk_fma_f32 v[180:181], v[180:181], v[192:193], v[232:233] op_sel:[0,0,0] op_sel_hi:[1,0,1]
    v_pk_fma_f32 v[182:183], v[182:183], v[192:193], v[234:235] op_sel:[0,0,0] op_sel_hi:[1,0,1]
    v_pk_mul_f32 v[240:241], v[164:165], v[164:165]
    v_pk_mul_f32 v[242:243], v[166:167], v[166:167]
    v_pk_mul_f32 v[244:245], v[180:181], v[180:181]
    v_pk_mul_f32 v[246:247], v[182:183], v[182:183]
    v_pk_fma_f32 v[240:241], v[240:241], s[42:43], s[42:43] op_sel:[0,0,1] op_sel_hi:[1,0,1]
    v_pk_fma_f32 v[242:243], v[242:243], s[42:43], s[42:43] op_sel:[0,0,1] op_sel_hi:[1,0,1]
    v_pk_fma_f32 v[244:245], v[244:245], s[42:43], s[42:43] op_sel:[0,0,1] op_sel_hi:[1,0,1]
    s_add_u32 m0, s26, 12160
    s_nop 0
    buffer_load_dwordx4 v12, s[8:11], s40 offen offset:128 lds
    v_pk_fma_f32 v[246:247], v[246:247], s[42:43], s[42:43] op_sel:[0,0,1] op_sel_hi:[1,0,1]
    v_pk_mul_f32 v[240:241], v[240:241], v[164:165]
    v_pk_mul_f32 v[242:243], v[242:243], v[166:167]
    v_pk_mul_f32 v[244:245], v[244:245], v[180:181]
    v_pk_mul_f32 v[246:247], v[246:247], v[182:183]
    v_exp_f32 v240, v240
    v_exp_f32 v241, v241
    v_exp_f32 v242, v242
    v_exp_f32 v243, v243
    v_exp_f32 v244, v244
    v_exp_f32 v245, v245
    v_exp_f32 v246, v246
    v_exp_f32 v247, v247
    v_pk_add_f32 v[240:241], v[240:241], s[44:45]
    s_waitcnt vmcnt(8)
    ds_read_b128 a[104:107], v13 offset:3072
    ds_read_b128 a[108:111], v14 offset:3072
    s_waitcnt lgkmcnt(2)
    s_add_u32 m0, s26, 768
    s_nop 0
    buffer_load_dwordx4 v11, s[8:11], s40 offen offset:256 lds
    v_pk_add_f32 v[242:243], v[242:243], s[44:45]
    v_pk_add_f32 v[244:245], v[244:245], s[44:45]
    v_pk_add_f32 v[246:247], v[246:247], s[44:45]
    v_rcp_f32 v240, v240
    v_rcp_f32 v241, v241
    v_rcp_f32 v242, v242
    v_rcp_f32 v243, v243
    v_rcp_f32 v244, v244
    v_rcp_f32 v245, v245
    v_rcp_f32 v246, v246
    v_rcp_f32 v247, v247
    v_pk_mul_f32 v[164:165], v[164:165], v[240:241]
    v_pk_mul_f32 v[166:167], v[166:167], v[242:243]
    v_pk_mul_f32 v[180:181], v[180:181], v[244:245]
    s_add_u32 m0, s26, 1792
    s_nop 0
    buffer_load_dwordx4 v12, s[8:11], s40 offen offset:256 lds
    v_pk_mul_f32 v[182:183], v[182:183], v[246:247]
    v_cvt_pk_bf16_f32 v212, v164, v180
    v_cvt_pk_bf16_f32 v213, v165, v181
    v_cvt_pk_bf16_f32 v214, v166, v182
    v_cvt_pk_bf16_f32 v215, v167, v183
    ds_write_b128 v4, v[212:215] offset:8192
    v_pk_fma_f32 v[168:169], v[220:221], v[194:195], v[168:169] op_sel:[0,1,0] op_sel_hi:[1,1,1]
    v_pk_fma_f32 v[170:171], v[222:223], v[194:195], v[170:171] op_sel:[0,1,0] op_sel_hi:[1,1,1]
    v_pk_fma_f32 v[184:185], v[224:225], v[194:195], v[184:185] op_sel:[0,1,0] op_sel_hi:[1,1,1]
    v_pk_fma_f32 v[186:187], v[226:227], v[194:195], v[186:187] op_sel:[0,1,0] op_sel_hi:[1,1,1]
    v_pk_fma_f32 v[168:169], v[168:169], v[194:195], v[228:229] op_sel:[0,0,0] op_sel_hi:[1,0,1]
    v_pk_fma_f32 v[170:171], v[170:171], v[194:195], v[230:231] op_sel:[0,0,0] op_sel_hi:[1,0,1]
    v_pk_fma_f32 v[184:185], v[184:185], v[194:195], v[232:233] op_sel:[0,0,0] op_sel_hi:[1,0,1]
    v_pk_fma_f32 v[186:187], v[186:187], v[194:195], v[234:235] op_sel:[0,0,0] op_sel_hi:[1,0,1]
    s_waitcnt vmcnt(8)
    ds_read_b128 a[112:115], v13 offset:5120
    ds_read_b128 a[116:119], v14 offset:5120
    s_waitcnt lgkmcnt(3)
    s_add_u32 m0, s26, 2688
    s_nop 0
    buffer_load_dwordx4 v11, s[8:11], s40 offen offset:384 lds
    v_pk_mul_f32 v[240:241], v[168:169], v[168:169]
    v_pk_mul_f32 v[242:243], v[170:171], v[170:171]
    v_pk_mul_f32 v[244:245], v[184:185], v[184:185]
    v_pk_mul_f32 v[246:247], v[186:187], v[186:187]
    v_pk_fma_f32 v[240:241], v[240:241], s[42:43], s[42:43] op_sel:[0,0,1] op_sel_hi:[1,0,1]
    v_pk_fma_f32 v[242:243], v[242:243], s[42:43], s[42:43] op_sel:[0,0,1] op_sel_hi:[1,0,1]
    v_pk_fma_f32 v[244:245], v[244:245], s[42:43], s[42:43] op_sel:[0,0,1] op_sel_hi:[1,0,1]
    v_pk_fma_f32 v[246:247], v[246:247], s[42:43], s[42:43] op_sel:[0,0,1] op_sel_hi:[1,0,1]
    v_pk_mul_f32 v[240:241], v[240:241], v[168:169]
    v_pk_mul_f32 v[242:243], v[242:243], v[170:171]
    v_pk_mul_f32 v[244:245], v[244:245], v[184:185]
    v_pk_mul_f32 v[246:247], v[246:247], v[186:187]
    v_exp_f32 v240, v240
    v_exp_f32 v241, v241
    s_add_u32 m0, s26, 3712
    s_nop 0
    buffer_load_dwordx4 v12, s[8:11], s40 offen offset:384 lds
    v_exp_f32 v242, v242
    v_exp_f32 v243, v243
    v_exp_f32 v244, v244
    v_exp_f32 v245, v245
    v_exp_f32 v246, v246
    v_exp_f32 v247, v247
    v_pk_add_f32 v[240:241], v[240:241], s[44:45]
    v_pk_add_f32 v[242:243], v[242:243], s[44:45]
    v_pk_add_f32 v[244:245], v[244:245], s[44:45]
    v_pk_add_f32 v[246:247], v[246:247], s[44:45]
    v_rcp_f32 v240, v240
    v_rcp_f32 v241, v241
    v_rcp_f32 v242, v242
    v_rcp_f32 v243, v243
    s_waitcnt vmcnt(8)
    ds_read_b128 a[120:123], v13 offset:7168
    ds_read_b128 a[124:127], v14 offset:7168
    s_waitcnt lgkmcnt(2)
    s_add_u32 m0, s26, 4608
    s_nop 0
    buffer_load_dwordx4 v11, s[8:11], s40 offen offset:512 lds
    v_rcp_f32 v244, v244
    v_rcp_f32 v245, v245
    v_rcp_f32 v246, v246
    v_rcp_f32 v247, v247
    v_pk_mul_f32 v[168:169], v[168:169], v[240:241]
    v_pk_mul_f32 v[170:171], v[170:171], v[242:243]
    v_pk_mul_f32 v[184:185], v[184:185], v[244:245]
    v_pk_mul_f32 v[186:187], v[186:187], v[246:247]
    v_cvt_pk_bf16_f32 v216, v168, v184
    v_cvt_pk_bf16_f32 v217, v169, v185
    v_cvt_pk_bf16_f32 v218, v170, v186
    v_cvt_pk_bf16_f32 v219, v171, v187
    ds_write_b128 v4, v[216:219] offset:12288
    s_waitcnt lgkmcnt(0)
    s_barrier
    s_lshl_b32 s36, s20, 12
    v_add_u32 v26, s36, v6
    v_add_u32 v4, 86528, v26
    ds_read_b128 v[28:31], v4 offset:0
    ds_read_b128 v[32:35], v4 offset:1024
    ds_read_b128 v[36:39], v4 offset:2048
    ds_read_b128 v[40:43], v4 offset:3072
    s_lshl_b32 s36, s20, 10
    v_add_u32 v27, s36, v6
    s_lshl_b32 s34, s21, 6
    s_lshr_b32 s35, s20, 1
    s_lshl_b32 s35, s35, 5
    s_add_u32 s34, s34, s35
    s_and_b32 s35, s20, 1
    s_add_u32 s23, s34, s35
    s_lshl_b32 s34, s23, 1
    buffer_load_ushort v15, v15, s[12:15], s34 offen
    s_mul_i32 s34, s22, 320
    s_add_u32 s34, s34, 12800
    v_lshlrev_b32 v4, 5, v3
    buffer_load_dwordx4 v[44:47], v4, s[4:7], s34 offen offset:0
    buffer_load_dwordx4 v[48:51], v4, s[4:7], s34 offen offset:16
    buffer_load_dwordx4 v[52:55], v4, s[4:7], s34 offen offset:128
    buffer_load_dwordx4 v[56:59], v4, s[4:7], s34 offen offset:144
    buffer_load_dwordx4 v[60:63], v10, s[4:7], s34 offen offset:256
    s_lshl_b32 s34, s21, 2
    s_add_u32 s34, s34, s20
    s_lshl_b32 s27, s34, 7
    s_add_u32 s27, s27, 200704
    s_mul_i32 s34, s34, 28672
    s_add_u32 s25, s34, 20447232
    s_mul_i32 s29, s22, 3072
    s_add_u32 s29, s29, s25
    s_lshr_b32 s30, s22, 1
    s_lshl_b32 s30, s30, 10
    s_add_u32 s30, s30, s25
    s_and_b32 s35, s22, 1
    s_lshl_b32 s35, s35, 3
    s_add_u32 s30, s30, s35
    s_add_u32 s30, s30, 24576
    s_lshl_b32 s34, s20, 14
    s_add_u32 s28, s28, s34
    s_mul_i32 s24, s20, 5120
    s_mul_i32 s31, s22, 143360
    s_add_u32 s31, s31, s24
    s_add_u32 s31, s31, 11206656
    s_add_u32 m0, s26, 5632
    s_nop 0
    buffer_load_dwordx4 v12, s[8:11], s40 offen offset:512 lds
    s_waitcnt vmcnt(14)
    ds_read_b128 a[128:131], v13 offset:9216
    ds_read_b128 a[132:135], v14 offset:9216
    s_add_u32 m0, s26, 6528
    s_nop 0
    buffer_load_dwordx4 v11, s[8:11], s40 offen offset:640 lds
    s_add_u32 m0, s26, 7552
    s_nop 0
    buffer_load_dwordx4 v12, s[8:11], s40 offen offset:640 lds
    s_waitcnt vmcnt(14)
    ds_read_b128 a[136:139], v13 offset:11264
    ds_read_b128 a[140:143], v14 offset:11264
    s_waitcnt lgkmcnt(2)
    s_add_u32 m0, s26, 8448
    s_nop 0
    buffer_load_dwordx4 v11, s[8:11], s40 offen offset:768 lds
    s_add_u32 m0, s26, 9472
    s_nop 0
    buffer_load_dwordx4 v12, s[8:11], s40 offen offset:768 lds
    s_waitcnt vmcnt(14)
    ds_read_b128 a[144:147], v13 offset:1024
    ds_read_b128 a[148:151], v14 offset:1024
    s_waitcnt lgkmcnt(2)
    s_add_u32 m0, s26, 10368
    s_nop 0
    buffer_load_dwordx4 v11, s[8:11], s40 offen offset:896 lds
    s_add_u32 m0, s26, 11392
    s_nop 0
    buffer_load_dwordx4 v12, s[8:11], s40 offen offset:896 lds
    s_waitcnt vmcnt(14)
    ds_read_b128 a[152:155], v13 offset:3072
    ds_read_b128 a[156:159], v14 offset:3072
    s_waitcnt lgkmcnt(2)
    s_add_u32 m0, s26, 1024
    s_nop 0
    buffer_load_dwordx4 v11, s[8:11], s41 offen offset:0 lds
    s_add_u32 m0, s26, 2048
    s_nop 0
    buffer_load_dwordx4 v12, s[8:11], s41 offen offset:0 lds
    s_waitcnt vmcnt(8)
    ds_read_b128 a[160:163], v13 offset:5120
    ds_read_b128 a[164:167], v14 offset:5120
    s_waitcnt lgkmcnt(2)
    s_add_u32 m0, s26, 2944
    s_nop 0
    buffer_load_dwordx4 v11, s[8:11], s41 offen offset:128 lds
    s_add_u32 m0, s26, 3968
    s_nop 0
    buffer_load_dwordx4 v12, s[8:11], s41 offen offset:128 lds
    s_waitcnt vmcnt(8)
    ds_read_b128 a[168:171], v13 offset:7168
    ds_read_b128 a[172:175], v14 offset:7168
    s_waitcnt lgkmcnt(2)
    s_add_u32 m0, s26, 4864
    s_nop 0
    buffer_load_dwordx4 v11, s[8:11], s41 offen offset:256 lds
    s_add_u32 m0, s26, 5888
    s_nop 0
    buffer_load_dwordx4 v12, s[8:11], s41 offen offset:256 lds
    s_waitcnt vmcnt(8)
    ds_read_b128 a[176:179], v13 offset:9216
    ds_read_b128 a[180:183], v14 offset:9216
    s_waitcnt lgkmcnt(2)
    s_add_u32 m0, s26, 6784
    s_nop 0
    buffer_load_dwordx4 v11, s[8:11], s41 offen offset:384 lds
    s_add_u32 m0, s26, 7808
    s_nop 0
    buffer_load_dwordx4 v12, s[8:11], s41 offen offset:384 lds
    s_waitcnt vmcnt(8)
    ds_read_b128 a[184:187], v13 offset:11264
    ds_read_b128 a[188:191], v14 offset:11264
    s_waitcnt lgkmcnt(2)
    s_add_u32 m0, s26, 8704
    s_nop 0
    buffer_load_dwordx4 v11, s[8:11], s41 offen offset:512 lds
    s_add_u32 m0, s26, 9728
    s_nop 0
    buffer_load_dwordx4 v12, s[8:11], s41 offen offset:512 lds
    s_waitcnt vmcnt(8)
    ds_read_b128 a[192:195], v13 offset:1024
    ds_read_b128 a[196:199], v14 offset:1024
    s_waitcnt lgkmcnt(2)
    s_add_u32 m0, s26, 10624
    s_nop 0
    buffer_load_dwordx4 v11, s[8:11], s41 offen offset:640 lds
    s_add_u32 m0, s26, 11648
    s_nop 0
    buffer_load_dwordx4 v12, s[8:11], s41 offen offset:640 lds
    s_waitcnt vmcnt(8)
    ds_read_b128 a[200:203], v13 offset:3072
    ds_read_b128 a[204:207], v14 offset:3072
    s_waitcnt lgkmcnt(2)
    s_add_u32 m0, s26, 256
    s_nop 0
    buffer_load_dwordx4 v11, s[8:11], s41 offen offset:768 lds
    s_add_u32 m0, s26, 1280
    s_nop 0
    buffer_load_dwordx4 v12, s[8:11], s41 offen offset:768 lds
    s_waitcnt vmcnt(8)
    ds_read_b128 a[208:211], v13 offset:5120
    ds_read_b128 a[212:215], v14 offset:5120
    s_waitcnt lgkmcnt(2)
    s_add_u32 m0, s26, 2176
    s_nop 0
    buffer_load_dwordx4 v11, s[8:11], s41 offen offset:896 lds
    s_add_u32 m0, s26, 3200
    s_nop 0
    buffer_load_dwordx4 v12, s[8:11], s41 offen offset:896 lds
    s_lshl_b32 s34, s22, 2
    s_add_u32 s34, s34, s20
    s_lshl_b32 s34, s34, 7
    s_add_u32 s34, s34, 196608
    v_and_b32 v9, 31, v0
    v_lshlrev_b32 v9, 2, v9
    s_mov_b32 s32, 65536
L_kb_pollz_5:
    buffer_load_dword v4, v9, s[4:7], s34 offen sc1
    s_waitcnt vmcnt(0)
    v_cmp_eq_u32 vcc, -1, v4
    s_nop 0
    s_cbranch_vccz L_kb_gotz_6
    s_sub_u32 s32, s32, 1
    s_cmp_lg_u32 s32, 0
    s_cbranch_scc1 L_kb_pollz_5
L_kb_gotz_6:
    buffer_load_dwordx4 v[64:67], v6, s[4:7], s28 offen offset:0 sc1
    ds_read_b128 a[216:219], v13 offset:7168
    ds_read_b128 a[220:223], v14 offset:7168
    buffer_load_dwordx4 v[68:71], v6, s[4:7], s28 offen offset:1024 sc1
    ds_read_b128 a[224:227], v13 offset:9216
    ds_read_b128 a[228:231], v14 offset:9216
    buffer_load_dwordx4 v[72:75], v6, s[4:7], s28 offen offset:2048 sc1
    ds_read_b128 a[232:235], v13 offset:11264
    ds_read_b128 a[236:239], v14 offset:11264
    buffer_load_dwordx4 v[76:79], v6, s[4:7], s28 offen offset:3072 sc1
    s_add_u32 s28, s28, 4096
    ds_read_b128 a[240:243], v13 offset:1024
    ds_read_b128 a[244:247], v14 offset:1024
    buffer_load_dwordx4 v[80:83], v6, s[4:7], s28 offen offset:0 sc1
    ds_read_b128 a[248:251], v13 offset:3072
    ds_read_b128 a[252:255], v14 offset:3072
    buffer_load_dwordx4 v[84:87], v6, s[4:7], s28 offen offset:1024 sc1
    buffer_load_dwordx4 v[88:91], v6, s[4:7], s28 offen offset:2048 sc1
    buffer_load_dwordx4 v[92:95], v6, s[4:7], s28 offen offset:3072 sc1
    s_add_u32 s28, s28, 4096
    buffer_load_dwordx4 v[96:99], v6, s[4:7], s28 offen offset:0 sc1
    buffer_load_dwordx4 v[100:103], v6, s[4:7], s28 offen offset:1024 sc1
    buffer_load_dwordx4 v[104:107], v6, s[4:7], s28 offen offset:2048 sc1
    buffer_load_dwordx4 v[108:111], v6, s[4:7], s28 offen offset:3072 sc1
    s_add_u32 s28, s28, 4096
    buffer_load_dwordx4 v[112:115], v6, s[4:7], s28 offen offset:0 sc1
    buffer_load_dwordx4 v[116:119], v6, s[4:7], s28 offen offset:1024 sc1
    buffer_load_dwordx4 v[120:123], v6, s[4:7], s28 offen offset:2048 sc1
    buffer_load_dwordx4 v[124:127], v6, s[4:7], s28 offen offset:3072 sc1
    s_add_u32 s28, s28, 53248
    v_lshlrev_b32 v15, 16, v15
    s_waitcnt vmcnt(15)
    v_mfma_f32_16x16x32_bf16 v[128:131], v[64:67], a[0:3], 0
    v_mfma_f32_16x16x32_bf16 v[132:135], v[64:67], a[64:67], 0
    v_mfma_f32_16x16x32_bf16 v[136:139], v[64:67], a[128:131], 0
    v_mfma_f32_16x16x32_bf16 v[140:143], v[64:67], a[192:195], 0
    buffer_load_dwordx4 v[64:67], v6, s[4:7], s28 offen offset:0 sc1
    s_waitcnt vmcnt(15)
    v_mfma_f32_16x16x32_bf16 v[128:131], v[68:71], a[4:7], v[128:131]
    v_mfma_f32_16x16x32_bf16 v[132:135], v[68:71], a[68:71], v[132:135]
    v_mfma_f32_16x16x32_bf16 v[136:139], v[68:71], a[132:135], v[136:139]
    v_mfma_f32_16x16x32_bf16 v[140:143], v[68:71], a[196:199], v[140:143]
    buffer_load_dwordx4 v[68:71], v6, s[4:7], s28 offen offset:1024 sc1
    s_waitcnt vmcnt(15)
    v_mfma_f32_16x16x32_bf16 v[128:131], v[72:75], a[8:11], v[128:131]
    v_mfma_f32_16x16x32_bf16 v[132:135], v[72:75], a[72:75], v[132:135]
    v_mfma_f32_16x16x32_bf16 v[136:139], v[72:75], a[136:139], v[136:139]
    v_mfma_f32_16x16x32_bf16 v[140:143], v[72:75], a[200:203], v[140:143]
    buffer_load_dwordx4 v[72:75], v6, s[4:7], s28 offen offset:2048 sc1
    s_waitcnt vmcnt(15)
    v_mfma_f32_16x16x32_bf16 v[128:131], v[76:79], a[12:15], v[128:131]
    v_mfma_f32_16x16x32_bf16 v[132:135], v[76:79], a[76:79], v[132:135]
    v_mfma_f32_16x16x32_bf16 v[136:139], v[76:79], a[140:143], v[136:139]
    v_mfma_f32_16x16x32_bf16 v[140:143], v[76:79], a[204:207], v[140:143]
    buffer_load_dwordx4 v[76:79], v6, s[4:7], s28 offen offset:3072 sc1
    s_add_u32 s28, s28, 4096
    s_waitcnt vmcnt(15)
    v_mfma_f32_16x16x32_bf16 v[128:131], v[80:83], a[16:19], v[128:131]
    v_mfma_f32_16x16x32_bf16 v[132:135], v[80:83], a[80:83], v[132:135]
    v_mfma_f32_16x16x32_bf16 v[136:139], v[80:83], a[144:147], v[136:139]
    s_waitcnt lgkmcnt(11)
    v_mfma_f32_16x16x32_bf16 v[140:143], v[80:83], a[208:211], v[140:143]
    buffer_load_dwordx4 v[80:83], v6, s[4:7], s28 offen offset:0 sc1
    s_waitcnt vmcnt(15)
    v_mfma_f32_16x16x32_bf16 v[128:131], v[84:87], a[20:23], v[128:131]
    v_mfma_f32_16x16x32_bf16 v[132:135], v[84:87], a[84:87], v[132:135]
    v_mfma_f32_16x16x32_bf16 v[136:139], v[84:87], a[148:151], v[136:139]
    s_waitcnt lgkmcnt(10)
    v_mfma_f32_16x16x32_bf16 v[140:143], v[84:87], a[212:215], v[140:143]
    buffer_load_dwordx4 v[84:87], v6, s[4:7], s28 offen offset:1024 sc1
    s_waitcnt vmcnt(15)
    v_mfma_f32_16x16x32_bf16 v[128:131], v[88:91], a[24:27], v[128:131]
    v_mfma_f32_16x16x32_bf16 v[132:135], v[88:91], a[88:91], v[132:135]
    v_mfma_f32_16x16x32_bf16 v[136:139], v[88:91], a[152:155], v[136:139]
    s_waitcnt lgkmcnt(9)
    v_mfma_f32_16x16x32_bf16 v[140:143], v[88:91], a[216:219], v[140:143]
    buffer_load_dwordx4 v[88:91], v6, s[4:7], s28 offen offset:2048 sc1
    s_waitcnt vmcnt(15)
    v_mfma_f32_16x16x32_bf16 v[128:131], v[92:95], a[28:31], v[128:131]
    v_mfma_f32_16x16x32_bf16 v[132:135], v[92:95], a[92:95], v[132:135]
    v_mfma_f32_16x16x32_bf16 v[136:139], v[92:95], a[156:159], v[136:139]
    s_waitcnt lgkmcnt(8)
    v_mfma_f32_16x16x32_bf16 v[140:143], v[92:95], a[220:223], v[140:143]
    buffer_load_dwordx4 v[92:95], v6, s[4:7], s28 offen offset:3072 sc1
    s_add_u32 s28, s28, 4096
    s_waitcnt vmcnt(15)
    v_mfma_f32_16x16x32_bf16 v[128:131], v[96:99], a[32:35], v[128:131]
    v_mfma_f32_16x16x32_bf16 v[132:135], v[96:99], a[96:99], v[132:135]
    v_mfma_f32_16x16x32_bf16 v[136:139], v[96:99], a[160:163], v[136:139]
    s_waitcnt lgkmcnt(7)
    v_mfma_f32_16x16x32_bf16 v[140:143], v[96:99], a[224:227], v[140:143]
    buffer_load_dwordx4 v[96:99], v6, s[4:7], s28 offen offset:0 sc1
    s_waitcnt vmcnt(15)
    v_mfma_f32_16x16x32_bf16 v[128:131], v[100:103], a[36:39], v[128:131]
    v_mfma_f32_16x16x32_bf16 v[132:135], v[100:103], a[100:103], v[132:135]
    v_mfma_f32_16x16x32_bf16 v[136:139], v[100:103], a[164:167], v[136:139]
    s_waitcnt lgkmcnt(6)
    v_mfma_f32_16x16x32_bf16 v[140:143], v[100:103], a[228:231], v[140:143]
    buffer_load_dwordx4 v[100:103], v6, s[4:7], s28 offen offset:1024 sc1
    s_waitcnt vmcnt(15)
    v_mfma_f32_16x16x32_bf16 v[128:131], v[104:107], a[40:43], v[128:131]
    v_mfma_f32_16x16x32_bf16 v[132:135], v[104:107], a[104:107], v[132:135]
    v_mfma_f32_16x16x32_bf16 v[136:139], v[104:107], a[168:171], v[136:139]
    s_waitcnt lgkmcnt(5)
    v_mfma_f32_16x16x32_bf16 v[140:143], v[104:107], a[232:235], v[140:143]
    buffer_load_dwordx4 v[104:107], v6, s[4:7], s28 offen offset:2048 sc1
    s_waitcnt vmcnt(15)
    v_mfma_f32_16x16x32_bf16 v[128:131], v[108:111], a[44:47], v[128:131]
    v_mfma_f32_16x16x32_bf16 v[132:135], v[108:111], a[108:111], v[132:135]
    v_mfma_f32_16x16x32_bf16 v[136:139], v[108:111], a[172:175], v[136:139]
    s_waitcnt lgkmcnt(4)
    v_mfma_f32_16x16x32_bf16 v[140:143], v[108:111], a[236:239], v[140:143]
    buffer_load_dwordx4 v[108:111], v6, s[4:7], s28 offen offset:3072 sc1
    s_add_u32 s28, s28, 4096
    s_waitcnt vmcnt(15)
    v_mfma_f32_16x16x32_bf16 v[128:131], v[112:115], a[48:51], v[128:131]
    v_mfma_f32_16x16x32_bf16 v[132:135], v[112:115], a[112:115], v[132:135]
    v_mfma_f32_16x16x32_bf16 v[136:139], v[112:115], a[176:179], v[136:139]
    s_waitcnt lgkmcnt(3)
    v_mfma_f32_16x16x32_bf16 v[140:143], v[112:115], a[240:243], v[140:143]
    buffer_load_dwordx4 v[112:115], v6, s[4:7], s28 offen offset:0 sc1
    s_waitcnt vmcnt(15)
    v_mfma_f32_16x16x32_bf16 v[128:131], v[116:119], a[52:55], v[128:131]
    v_mfma_f32_16x16x32_bf16 v[132:135], v[116:119], a[116:119], v[132:135]
    v_mfma_f32_16x16x32_bf16 v[136:139], v[116:119], a[180:183], v[136:139]
    s_waitcnt lgkmcnt(2)
    v_mfma_f32_16x16x32_bf16 v[140:143], v[116:119], a[244:247], v[140:143]
    buffer_load_dwordx4 v[116:119], v6, s[4:7], s28 offen offset:1024 sc1
    s_waitcnt vmcnt(15)
    v_mfma_f32_16x16x32_bf16 v[128:131], v[120:123], a[56:59], v[128:131]
    v_mfma_f32_16x16x32_bf16 v[132:135], v[120:123], a[120:123], v[132:135]
    v_mfma_f32_16x16x32_bf16 v[136:139], v[120:123], a[184:187], v[136:139]
    s_waitcnt lgkmcnt(1)
    v_mfma_f32_16x16x32_bf16 v[140:143], v[120:123], a[248:251], v[140:143]
    buffer_load_dwordx4 v[120:123], v6, s[4:7], s28 offen offset:2048 sc1
    s_waitcnt vmcnt(15)
    v_mfma_f32_16x16x32_bf16 v[128:131], v[124:127], a[60:63], v[128:131]
    v_mfma_f32_16x16x32_bf16 v[132:135], v[124:127], a[124:127], v[132:135]
    v_mfma_f32_16x16x32_bf16 v[136:139], v[124:127], a[188:191], v[136:139]
    s_waitcnt lgkmcnt(0)
    v_mfma_f32_16x16x32_bf16 v[140:143], v[124:127], a[252:255], v[140:143]
    buffer_load_dwordx4 v[124:127], v6, s[4:7], s28 offen offset:3072 sc1
    s_add_u32 s28, s28, 53248
    s_waitcnt vmcnt(15)
    v_mfma_f32_16x16x32_bf16 v[144:147], v[64:67], a[0:3], 0
    v_mfma_f32_16x16x32_bf16 v[148:151], v[64:67], a[64:67], 0
    v_mfma_f32_16x16x32_bf16 v[152:155], v[64:67], a[128:131], 0
    v_mfma_f32_16x16x32_bf16 v[156:159], v[64:67], a[192:195], 0
    buffer_load_dwordx4 v[64:67], v6, s[4:7], s28 offen offset:0 sc1
    s_waitcnt vmcnt(15)
    v_mfma_f32_16x16x32_bf16 v[144:147], v[68:71], a[4:7], v[144:147]
    v_mfma_f32_16x16x32_bf16 v[148:151], v[68:71], a[68:71], v[148:151]
    v_mfma_f32_16x16x32_bf16 v[152:155], v[68:71], a[132:135], v[152:155]
    v_mfma_f32_16x16x32_bf16 v[156:159], v[68:71], a[196:199], v[156:159]
    buffer_load_dwordx4 v[68:71], v6, s[4:7], s28 offen offset:1024 sc1
    s_waitcnt vmcnt(15)
    v_mfma_f32_16x16x32_bf16 v[144:147], v[72:75], a[8:11], v[144:147]
    ds_write_b128 v26, v[128:131] offset:0
    v_mfma_f32_16x16x32_bf16 v[148:151], v[72:75], a[72:75], v[148:151]
    ds_write_b128 v26, v[132:135] offset:1024
    v_mfma_f32_16x16x32_bf16 v[152:155], v[72:75], a[136:139], v[152:155]
    ds_write_b128 v26, v[136:139] offset:2048
    v_mfma_f32_16x16x32_bf16 v[156:159], v[72:75], a[200:203], v[156:159]
    buffer_load_dwordx4 v[72:75], v6, s[4:7], s28 offen offset:2048 sc1
    s_waitcnt vmcnt(15)
    v_mfma_f32_16x16x32_bf16 v[144:147], v[76:79], a[12:15], v[144:147]
    ds_write_b128 v26, v[140:143] offset:3072
    v_mfma_f32_16x16x32_bf16 v[148:151], v[76:79], a[76:79], v[148:151]
    v_mfma_f32_16x16x32_bf16 v[152:155], v[76:79], a[140:143], v[152:155]
    v_mfma_f32_16x16x32_bf16 v[156:159], v[76:79], a[204:207], v[156:159]
    buffer_load_dwordx4 v[76:79], v6, s[4:7], s28 offen offset:3072 sc1
    s_add_u32 s28, s28, 4096
    s_waitcnt vmcnt(15)
    v_mfma_f32_16x16x32_bf16 v[144:147], v[80:83], a[16:19], v[144:147]
    v_mfma_f32_16x16x32_bf16 v[148:151], v[80:83], a[80:83], v[148:151]
    v_mfma_f32_16x16x32_bf16 v[152:155], v[80:83], a[144:147], v[152:155]
    v_mfma_f32_16x16x32_bf16 v[156:159], v[80:83], a[208:211], v[156:159]
    buffer_load_dwordx4 v[80:83], v6, s[4:7], s28 offen offset:0 sc1
    s_waitcnt vmcnt(15)
    v_mfma_f32_16x16x32_bf16 v[144:147], v[84:87], a[20:23], v[144:147]
    s_waitcnt lgkmcnt(0)
    s_barrier
    ds_read_b128 v[160:163], v27 offset:0
    v_mfma_f32_16x16x32_bf16 v[148:151], v[84:87], a[84:87], v[148:151]
    ds_read_b128 v[164:167], v27 offset:4096
    v_mfma_f32_16x16x32_bf16 v[152:155], v[84:87], a[148:151], v[152:155]
    ds_read_b128 v[168:171], v27 offset:8192
    v_mfma_f32_16x16x32_bf16 v[156:159], v[84:87], a[212:215], v[156:159]
    buffer_load_dwordx4 v[84:87], v6, s[4:7], s28 offen offset:1024 sc1
    s_waitcnt vmcnt(15)
    v_mfma_f32_16x16x32_bf16 v[144:147], v[88:91], a[24:27], v[144:147]
    ds_read_b128 v[172:175], v27 offset:12288
    v_mfma_f32_16x16x32_bf16 v[148:151], v[88:91], a[88:91], v[148:151]
    v_mfma_f32_16x16x32_bf16 v[152:155], v[88:91], a[152:155], v[152:155]
    v_mfma_f32_16x16x32_bf16 v[156:159], v[88:91], a[216:219], v[156:159]
    buffer_load_dwordx4 v[88:91], v6, s[4:7], s28 offen offset:2048 sc1
    s_waitcnt vmcnt(15)
    v_mfma_f32_16x16x32_bf16 v[144:147], v[92:95], a[28:31], v[144:147]
    v_mfma_f32_16x16x32_bf16 v[148:151], v[92:95], a[92:95], v[148:151]
    v_mfma_f32_16x16x32_bf16 v[152:155], v[92:95], a[156:159], v[152:155]
    v_mfma_f32_16x16x32_bf16 v[156:159], v[92:95], a[220:223], v[156:159]
    buffer_load_dwordx4 v[92:95], v6, s[4:7], s28 offen offset:3072 sc1
    s_add_u32 s28, s28, 4096
    s_waitcnt vmcnt(15)
    v_mfma_f32_16x16x32_bf16 v[144:147], v[96:99], a[32:35], v[144:147]
    v_lshlrev_b32 v184, 16, v28
    v_lshlrev_b32 v185, 16, v29
    v_mfma_f32_16x16x32_bf16 v[148:151], v[96:99], a[96:99], v[148:151]
    v_lshlrev_b32 v186, 16, v30
    v_lshlrev_b32 v187, 16, v31
    v_mfma_f32_16x16x32_bf16 v[152:155], v[96:99], a[160:163], v[152:155]
    s_waitcnt lgkmcnt(3)
    v_add_f32 v160, v160, v15
    v_add_f32 v161, v161, v15
    v_mfma_f32_16x16x32_bf16 v[156:159], v[96:99], a[224:227], v[156:159]
    buffer_load_dwordx4 v[96:99], v6, s[4:7], s28 offen offset:0 sc1
    s_waitcnt vmcnt(15)
    v_mfma_f32_16x16x32_bf16 v[144:147], v[100:103], a[36:39], v[144:147]
    v_add_f32 v162, v162, v15
    v_add_f32 v163, v163, v15
    v_mfma_f32_16x16x32_bf16 v[148:151], v[100:103], a[100:103], v[148:151]
    s_waitcnt lgkmcnt(2)
    v_add_f32 v160, v160, v164
    v_add_f32 v161, v161, v165
    v_mfma_f32_16x16x32_bf16 v[152:155], v[100:103], a[164:167], v[152:155]
    v_add_f32 v162, v162, v166
    v_add_f32 v163, v163, v167
    v_mfma_f32_16x16x32_bf16 v[156:159], v[100:103], a[228:231], v[156:159]
    buffer_load_dwordx4 v[100:103], v6, s[4:7], s28 offen offset:1024 sc1
    s_waitcnt vmcnt(15)
    v_mfma_f32_16x16x32_bf16 v[144:147], v[104:107], a[40:43], v[144:147]
    s_waitcnt lgkmcnt(0)
    v_add_f32 v168, v168, v172
    v_add_f32 v169, v169, v173
    v_mfma_f32_16x16x32_bf16 v[148:151], v[104:107], a[104:107], v[148:151]
    v_add_f32 v170, v170, v174
    v_add_f32 v171, v171, v175
    v_mfma_f32_16x16x32_bf16 v[152:155], v[104:107], a[168:171], v[152:155]
    v_add_f32 v160, v160, v168
    v_add_f32 v161, v161, v169
    v_mfma_f32_16x16x32_bf16 v[156:159], v[104:107], a[232:235], v[156:159]
    buffer_load_dwordx4 v[104:107], v6, s[4:7], s28 offen offset:2048 sc1
    s_waitcnt vmcnt(15)
    v_mfma_f32_16x16x32_bf16 v[144:147], v[108:111], a[44:47], v[144:147]
    v_add_f32 v162, v162, v170
    v_add_f32 v163, v163, v171
    v_mfma_f32_16x16x32_bf16 v[148:151], v[108:111], a[108:111], v[148:151]
    v_mul_f32 v176, v160, v184
    v_mul_f32 v177, v161, v185
    v_mfma_f32_16x16x32_bf16 v[152:155], v[108:111], a[172:175], v[152:155]
    v_mul_f32 v178, v162, v186
    v_mul_f32 v179, v163, v187
    v_mfma_f32_16x16x32_bf16 v[156:159], v[108:111], a[236:239], v[156:159]
    buffer_load_dwordx4 v[108:111], v6, s[4:7], s28 offen offset:3072 sc1
    s_add_u32 s28, s28, 4096
    s_waitcnt vmcnt(15)
    v_mfma_f32_16x16x32_bf16 v[144:147], v[112:115], a[48:51], v[144:147]
    v_mfma_f32_16x16x32_bf16 v[148:151], v[112:115], a[112:115], v[148:151]
    v_mfma_f32_16x16x32_bf16 v[152:155], v[112:115], a[176:179], v[152:155]
    v_mfma_f32_16x16x32_bf16 v[156:159], v[112:115], a[240:243], v[156:159]
    buffer_load_dwordx4 v[112:115], v6, s[4:7], s28 offen offset:0 sc1
    s_waitcnt vmcnt(15)
    v_mfma_f32_16x16x32_bf16 v[144:147], v[116:119], a[52:55], v[144:147]
    v_mfma_f32_16x16x32_bf16 v[148:151], v[116:119], a[116:119], v[148:151]
    v_mfma_f32_16x16x32_bf16 v[152:155], v[116:119], a[180:183], v[152:155]
    v_mfma_f32_16x16x32_bf16 v[156:159], v[116:119], a[244:247], v[156:159]
    buffer_load_dwordx4 v[116:119], v6, s[4:7], s28 offen offset:1024 sc1
    s_waitcnt vmcnt(15)
    v_mfma_f32_16x16x32_bf16 v[144:147], v[120:123], a[56:59], v[144:147]
    v_mfma_f32_16x16x32_bf16 v[148:151], v[120:123], a[120:123], v[148:151]
    v_mfma_f32_16x16x32_bf16 v[152:155], v[120:123], a[184:187], v[152:155]
    v_mfma_f32_16x16x32_bf16 v[156:159], v[120:123], a[248:251], v[156:159]
    buffer_load_dwordx4 v[120:123], v6, s[4:7], s28 offen offset:2048 sc1
    s_waitcnt vmcnt(15)
    v_mfma_f32_16x16x32_bf16 v[144:147], v[124:127], a[60:63], v[144:147]
    v_mfma_f32_16x16x32_bf16 v[148:151], v[124:127], a[124:127], v[148:151]
    v_mfma_f32_16x16x32_bf16 v[152:155], v[124:127], a[188:191], v[152:155]
    v_mfma_f32_16x16x32_bf16 v[156:159], v[124:127], a[252:255], v[156:159]
    buffer_load_dwordx4 v[124:127], v6, s[4:7], s28 offen offset:3072 sc1
    s_add_u32 s28, s28, 53248
    s_waitcnt vmcnt(15)
    v_mfma_f32_16x16x32_bf16 v[128:131], v[64:67], a[0:3], 0
    v_mfma_f32_16x16x32_bf16 v[132:135], v[64:67], a[64:67], 0
    v_mfma_f32_16x16x32_bf16 v[136:139], v[64:67], a[128:131], 0
    v_mfma_f32_16x16x32_bf16 v[140:143], v[64:67], a[192:195], 0
    buffer_load_dwordx4 v[64:67], v6, s[4:7], s28 offen offset:0 sc1
    s_waitcnt vmcnt(15)
    v_mfma_f32_16x16x32_bf16 v[128:131], v[68:71], a[4:7], v[128:131]
    v_mfma_f32_16x16x32_bf16 v[132:135], v[68:71], a[68:71], v[132:135]
    v_mfma_f32_16x16x32_bf16 v[136:139], v[68:71], a[132:135], v[136:139]
    v_mfma_f32_16x16x32_bf16 v[140:143], v[68:71], a[196:199], v[140:143]
    buffer_load_dwordx4 v[68:71], v6, s[4:7], s28 offen offset:1024 sc1
    s_waitcnt vmcnt(15)
    v_mfma_f32_16x16x32_bf16 v[128:131], v[72:75], a[8:11], v[128:131]
    ds_write_b128 v26, v[144:147] offset:16384
    v_mfma_f32_16x16x32_bf16 v[132:135], v[72:75], a[72:75], v[132:135]
    ds_write_b128 v26, v[148:151] offset:17408
    v_mfma_f32_16x16x32_bf16 v[136:139], v[72:75], a[136:139], v[136:139]
    ds_write_b128 v26, v[152:155] offset:18432
    v_mfma_f32_16x16x32_bf16 v[140:143], v[72:75], a[200:203], v[140:143]
    buffer_load_dwordx4 v[72:75], v6, s[4:7], s28 offen offset:2048 sc1
    s_waitcnt vmcnt(15)
    v_mfma_f32_16x16x32_bf16 v[128:131], v[76:79], a[12:15], v[128:131]
    ds_write_b128 v26, v[156:159] offset:19456
    v_mfma_f32_16x16x32_bf16 v[132:135], v[76:79], a[76:79], v[132:135]
    v_mfma_f32_16x16x32_bf16 v[136:139], v[76:79], a[140:143], v[136:139]
    v_mfma_f32_16x16x32_bf16 v[140:143], v[76:79], a[204:207], v[140:143]
    buffer_load_dwordx4 v[76:79], v6, s[4:7], s28 offen offset:3072 sc1
    s_add_u32 s28, s28, 4096
    s_waitcnt vmcnt(15)
    v_mfma_f32_16x16x32_bf16 v[128:131], v[80:83], a[16:19], v[128:131]
    v_mfma_f32_16x16x32_bf16 v[132:135], v[80:83], a[80:83], v[132:135]
    v_mfma_f32_16x16x32_bf16 v[136:139], v[80:83], a[144:147], v[136:139]
    v_mfma_f32_16x16x32_bf16 v[140:143], v[80:83], a[208:211], v[140:143]
    buffer_load_dwordx4 v[80:83], v6, s[4:7], s28 offen offset:0 sc1
    s_waitcnt vmcnt(15)
    v_mfma_f32_16x16x32_bf16 v[128:131], v[84:87], a[20:23], v[128:131]
    s_waitcnt lgkmcnt(0)
    s_barrier
    ds_read_b128 v[160:163], v27 offset:16384
    v_mfma_f32_16x16x32_bf16 v[132:135], v[84:87], a[84:87], v[132:135]
    ds_read_b128 v[164:167], v27 offset:20480
    v_mfma_f32_16x16x32_bf16 v[136:139], v[84:87], a[148:151], v[136:139]
    ds_read_b128 v[168:171], v27 offset:24576
    v_mfma_f32_16x16x32_bf16 v[140:143], v[84:87], a[212:215], v[140:143]
    buffer_load_dwordx4 v[84:87], v6, s[4:7], s28 offen offset:1024 sc1
    s_waitcnt vmcnt(15)
    v_mfma_f32_16x16x32_bf16 v[128:131], v[88:91], a[24:27], v[128:131]
    ds_read_b128 v[172:175], v27 offset:28672
    v_mfma_f32_16x16x32_bf16 v[132:135], v[88:91], a[88:91], v[132:135]
    v_mfma_f32_16x16x32_bf16 v[136:139], v[88:91], a[152:155], v[136:139]
    v_mfma_f32_16x16x32_bf16 v[140:143], v[88:91], a[216:219], v[140:143]
    buffer_load_dwordx4 v[88:91], v6, s[4:7], s28 offen offset:2048 sc1
    s_waitcnt vmcnt(15)
    v_mfma_f32_16x16x32_bf16 v[128:131], v[92:95], a[28:31], v[128:131]
    v_mfma_f32_16x16x32_bf16 v[132:135], v[92:95], a[92:95], v[132:135]
    v_mfma_f32_16x16x32_bf16 v[136:139], v[92:95], a[156:159], v[136:139]
    v_mfma_f32_16x16x32_bf16 v[140:143], v[92:95], a[220:223], v[140:143]
    buffer_load_dwordx4 v[92:95], v6, s[4:7], s28 offen offset:3072 sc1
    s_add_u32 s28, s28, 4096
    s_waitcnt vmcnt(15)
    v_mfma_f32_16x16x32_bf16 v[128:131], v[96:99], a[32:35], v[128:131]
    v_and_b32 v184, s3, v28
    v_and_b32 v185, s3, v29
    v_mfma_f32_16x16x32_bf16 v[132:135], v[96:99], a[96:99], v[132:135]
    v_and_b32 v186, s3, v30
    v_and_b32 v187, s3, v31
    v_mfma_f32_16x16x32_bf16 v[136:139], v[96:99], a[160:163], v[136:139]
    s_waitcnt lgkmcnt(3)
    v_add_f32 v160, v160, v15
    v_add_f32 v161, v161, v15
    v_mfma_f32_16x16x32_bf16 v[140:143], v[96:99], a[224:227], v[140:143]
    buffer_load_dwordx4 v[96:99], v6, s[4:7], s28 offen offset:0 sc1
    s_waitcnt vmcnt(15)
    v_mfma_f32_16x16x32_bf16 v[128:131], v[100:103], a[36:39], v[128:131]
    v_add_f32 v162, v162, v15
    v_add_f32 v163, v163, v15
    v_mfma_f32_16x16x32_bf16 v[132:135], v[100:103], a[100:103], v[132:135]
    s_waitcnt lgkmcnt(2)
    v_add_f32 v160, v160, v164
    v_add_f32 v161, v161, v165
    v_mfma_f32_16x16x32_bf16 v[136:139], v[100:103], a[164:167], v[136:139]
    v_add_f32 v162, v162, v166
    v_add_f32 v163, v163, v167
    v_mfma_f32_16x16x32_bf16 v[140:143], v[100:103], a[228:231], v[140:143]
    buffer_load_dwordx4 v[100:103], v6, s[4:7], s28 offen offset:1024 sc1
    s_waitcnt vmcnt(15)
    v_mfma_f32_16x16x32_bf16 v[128:131], v[104:107], a[40:43], v[128:131]
    s_waitcnt lgkmcnt(0)
    v_add_f32 v168, v168, v172
    v_add_f32 v169, v169, v173
    v_mfma_f32_16x16x32_bf16 v[132:135], v[104:107], a[104:107], v[132:135]
    v_add_f32 v170, v170, v174
    v_add_f32 v171, v171, v175
    v_mfma_f32_16x16x32_bf16 v[136:139], v[104:107], a[168:171], v[136:139]
    v_add_f32 v160, v160, v168
    v_add_f32 v161, v161, v169
    v_mfma_f32_16x16x32_bf16 v[140:143], v[104:107], a[232:235], v[140:143]
    buffer_load_dwordx4 v[104:107], v6, s[4:7], s28 offen offset:2048 sc1
    s_waitcnt vmcnt(15)
    v_mfma_f32_16x16x32_bf16 v[128:131], v[108:111], a[44:47], v[128:131]
    v_add_f32 v162, v162, v170
    v_add_f32 v163, v163, v171
    v_mfma_f32_16x16x32_bf16 v[132:135], v[108:111], a[108:111], v[132:135]
    v_mul_f32 v180, v160, v184
    v_mul_f32 v181, v161, v185
    v_mfma_f32_16x16x32_bf16 v[136:139], v[108:111], a[172:175], v[136:139]
    v_mul_f32 v182, v162, v186
    v_mul_f32 v183, v163, v187
    v_mfma_f32_16x16x32_bf16 v[140:143], v[108:111], a[236:239], v[140:143]
    buffer_load_dwordx4 v[108:111], v6, s[4:7], s28 offen offset:3072 sc1
    s_add_u32 s28, s28, 4096
    s_waitcnt vmcnt(15)
    v_mfma_f32_16x16x32_bf16 v[128:131], v[112:115], a[48:51], v[128:131]
    v_cvt_pk_bf16_f32 v188, v176, v180
    v_cvt_pk_bf16_f32 v189, v177, v181
    v_mfma_f32_16x16x32_bf16 v[132:135], v[112:115], a[112:115], v[132:135]
    v_cvt_pk_bf16_f32 v190, v178, v182
    v_cvt_pk_bf16_f32 v191, v179, v183
    v_mfma_f32_16x16x32_bf16 v[136:139], v[112:115], a[176:179], v[136:139]
    buffer_store_dwordx4 v[188:191], v6, s[4:7], s29 offen offset:0 sc1
    v_mfma_f32_16x16x32_bf16 v[140:143], v[112:115], a[240:243], v[140:143]
    buffer_load_dwordx4 v[112:115], v6, s[4:7], s28 offen offset:0 sc1
    s_waitcnt vmcnt(16)
    v_mfma_f32_16x16x32_bf16 v[128:131], v[116:119], a[52:55], v[128:131]
    v_mfma_f32_16x16x32_bf16 v[132:135], v[116:119], a[116:119], v[132:135]
    v_mfma_f32_16x16x32_bf16 v[136:139], v[116:119], a[180:183], v[136:139]
    v_mfma_f32_16x16x32_bf16 v[140:143], v[116:119], a[244:247], v[140:143]
    buffer_load_dwordx4 v[116:119], v6, s[4:7], s28 offen offset:1024 sc1
    s_waitcnt vmcnt(16)
    v_mfma_f32_16x16x32_bf16 v[128:131], v[120:123], a[56:59], v[128:131]
    v_mfma_f32_16x16x32_bf16 v[132:135], v[120:123], a[120:123], v[132:135]
    v_mfma_f32_16x16x32_bf16 v[136:139], v[120:123], a[184:187], v[136:139]
    v_mfma_f32_16x16x32_bf16 v[140:143], v[120:123], a[248:251], v[140:143]
    buffer_load_dwordx4 v[120:123], v6, s[4:7], s28 offen offset:2048 sc1
    s_waitcnt vmcnt(16)
    v_mfma_f32_16x16x32_bf16 v[128:131], v[124:127], a[60:63], v[128:131]
    v_mfma_f32_16x16x32_bf16 v[132:135], v[124:127], a[124:127], v[132:135]
    v_mfma_f32_16x16x32_bf16 v[136:139], v[124:127], a[188:191], v[136:139]
    v_mfma_f32_16x16x32_bf16 v[140:143], v[124:127], a[252:255], v[140:143]
    buffer_load_dwordx4 v[124:127], v6, s[4:7], s28 offen offset:3072 sc1
    s_add_u32 s28, s28, 53248
    s_waitcnt vmcnt(16)
    v_mfma_f32_16x16x32_bf16 v[144:147], v[64:67], a[0:3], 0
    v_mfma_f32_16x16x32_bf16 v[148:151], v[64:67], a[64:67], 0
    v_mfma_f32_16x16x32_bf16 v[152:155], v[64:67], a[128:131], 0
    v_mfma_f32_16x16x32_bf16 v[156:159], v[64:67], a[192:195], 0
    buffer_load_dwordx4 v[64:67], v6, s[4:7], s28 offen offset:0 sc1
    s_waitcnt vmcnt(16)
    v_mfma_f32_16x16x32_bf16 v[144:147], v[68:71], a[4:7], v[144:147]
    v_mfma_f32_16x16x32_bf16 v[148:151], v[68:71], a[68:71], v[148:151]
    v_mfma_f32_16x16x32_bf16 v[152:155], v[68:71], a[132:135], v[152:155]
    v_mfma_f32_16x16x32_bf16 v[156:159], v[68:71], a[196:199], v[156:159]
    buffer_load_dwordx4 v[68:71], v6, s[4:7], s28 offen offset:1024 sc1
    s_waitcnt vmcnt(16)
    v_mfma_f32_16x16x32_bf16 v[144:147], v[72:75], a[8:11], v[144:147]
    ds_write_b128 v26, v[128:131] offset:0
    v_mfma_f32_16x16x32_bf16 v[148:151], v[72:75], a[72:75], v[148:151]
    ds_write_b128 v26, v[132:135] offset:1024
    v_mfma_f32_16x16x32_bf16 v[152:155], v[72:75], a[136:139], v[152:155]
    ds_write_b128 v26, v[136:139] offset:2048
    v_mfma_f32_16x16x32_bf16 v[156:159], v[72:75], a[200:203], v[156:159]
    buffer_load_dwordx4 v[72:75], v6, s[4:7], s28 offen offset:2048 sc1
    s_waitcnt vmcnt(16)
    v_mfma_f32_16x16x32_bf16 v[144:147], v[76:79], a[12:15], v[144:147]
    ds_write_b128 v26, v[140:143] offset:3072
    v_mfma_f32_16x16x32_bf16 v[148:151], v[76:79], a[76:79], v[148:151]
    v_mfma_f32_16x16x32_bf16 v[152:155], v[76:79], a[140:143], v[152:155]
    v_mfma_f32_16x16x32_bf16 v[156:159], v[76:79], a[204:207], v[156:159]
    buffer_load_dwordx4 v[76:79], v6, s[4:7], s28 offen offset:3072 sc1
    s_add_u32 s28, s28, 4096
    s_waitcnt vmcnt(16)
    v_mfma_f32_16x16x32_bf16 v[144:147], v[80:83], a[16:19], v[144:147]
    v_mfma_f32_16x16x32_bf16 v[148:151], v[80:83], a[80:83], v[148:151]
    v_mfma_f32_16x16x32_bf16 v[152:155], v[80:83], a[144:147], v[152:155]
    v_mfma_f32_16x16x32_bf16 v[156:159], v[80:83], a[208:211], v[156:159]
    buffer_load_dwordx4 v[80:83], v6, s[4:7], s28 offen offset:0 sc1
    s_waitcnt vmcnt(16)
    v_mfma_f32_16x16x32_bf16 v[144:147], v[84:87], a[20:23], v[144:147]
    s_waitcnt lgkmcnt(0)
    s_barrier
    ds_read_b128 v[160:163], v27 offset:0
    v_mfma_f32_16x16x32_bf16 v[148:151], v[84:87], a[84:87], v[148:151]
    ds_read_b128 v[164:167], v27 offset:4096
    v_mfma_f32_16x16x32_bf16 v[152:155], v[84:87], a[148:151], v[152:155]
    ds_read_b128 v[168:171], v27 offset:8192
    v_mfma_f32_16x16x32_bf16 v[156:159], v[84:87], a[212:215], v[156:159]
    buffer_load_dwordx4 v[84:87], v6, s[4:7], s28 offen offset:1024 sc1
    s_waitcnt vmcnt(16)
    v_mfma_f32_16x16x32_bf16 v[144:147], v[88:91], a[24:27], v[144:147]
    ds_read_b128 v[172:175], v27 offset:12288
    v_mfma_f32_16x16x32_bf16 v[148:151], v[88:91], a[88:91], v[148:151]
    v_mfma_f32_16x16x32_bf16 v[152:155], v[88:91], a[152:155], v[152:155]
    v_mfma_f32_16x16x32_bf16 v[156:159], v[88:91], a[216:219], v[156:159]
    buffer_load_dwordx4 v[88:91], v6, s[4:7], s28 offen offset:2048 sc1
    s_waitcnt vmcnt(16)
    v_mfma_f32_16x16x32_bf16 v[144:147], v[92:95], a[28:31], v[144:147]
    v_mfma_f32_16x16x32_bf16 v[148:151], v[92:95], a[92:95], v[148:151]
    v_mfma_f32_16x16x32_bf16 v[152:155], v[92:95], a[156:159], v[152:155]
    v_mfma_f32_16x16x32_bf16 v[156:159], v[92:95], a[220:223], v[156:159]
    buffer_load_dwordx4 v[92:95], v6, s[4:7], s28 offen offset:3072 sc1
    s_add_u32 s28, s28, 4096
    s_waitcnt vmcnt(16)
    v_mfma_f32_16x16x32_bf16 v[144:147], v[96:99], a[32:35], v[144:147]
    v_lshlrev_b32 v184, 16, v32
    v_lshlrev_b32 v185, 16, v33
    v_mfma_f32_16x16x32_bf16 v[148:151], v[96:99], a[96:99], v[148:151]
    v_lshlrev_b32 v186, 16, v34
    v_lshlrev_b32 v187, 16, v35
    v_mfma_f32_16x16x32_bf16 v[152:155], v[96:99], a[160:163], v[152:155]
    s_waitcnt lgkmcnt(3)
    v_add_f32 v160, v160, v15
    v_add_f32 v161, v161, v15
    v_mfma_f32_16x16x32_bf16 v[156:159], v[96:99], a[224:227], v[156:159]
    buffer_load_dwordx4 v[96:99], v6, s[4:7], s28 offen offset:0 sc1
    s_waitcnt vmcnt(16)
    v_mfma_f32_16x16x32_bf16 v[144:147], v[100:103], a[36:39], v[144:147]
    v_add_f32 v162, v162, v15
    v_add_f32 v163, v163, v15
    v_mfma_f32_16x16x32_bf16 v[148:151], v[100:103], a[100:103], v[148:151]
    s_waitcnt lgkmcnt(2)
    v_add_f32 v160, v160, v164
    v_add_f32 v161, v161, v165
    v_mfma_f32_16x16x32_bf16 v[152:155], v[100:103], a[164:167], v[152:155]
    v_add_f32 v162, v162, v166
    v_add_f32 v163, v163, v167
    v_mfma_f32_16x16x32_bf16 v[156:159], v[100:103], a[228:231], v[156:159]
    buffer_load_dwordx4 v[100:103], v6, s[4:7], s28 offen offset:1024 sc1
    s_waitcnt vmcnt(16)
    v_mfma_f32_16x16x32_bf16 v[144:147], v[104:107], a[40:43], v[144:147]
    s_waitcnt lgkmcnt(0)
    v_add_f32 v168, v168, v172
    v_add_f32 v169, v169, v173
    v_mfma_f32_16x16x32_bf16 v[148:151], v[104:107], a[104:107], v[148:151]
    v_add_f32 v170, v170, v174
    v_add_f32 v171, v171, v175
    v_mfma_f32_16x16x32_bf16 v[152:155], v[104:107], a[168:171], v[152:155]
    v_add_f32 v160, v160, v168
    v_add_f32 v161, v161, v169
    v_mfma_f32_16x16x32_bf16 v[156:159], v[104:107], a[232:235], v[156:159]
    buffer_load_dwordx4 v[104:107], v6, s[4:7], s28 offen offset:2048 sc1
    s_waitcnt vmcnt(16)
    v_mfma_f32_16x16x32_bf16 v[144:147], v[108:111], a[44:47], v[144:147]
    v_add_f32 v162, v162, v170
    v_add_f32 v163, v163, v171
    v_mfma_f32_16x16x32_bf16 v[148:151], v[108:111], a[108:111], v[148:151]
    v_mul_f32 v176, v160, v184
    v_mul_f32 v177, v161, v185
    v_mfma_f32_16x16x32_bf16 v[152:155], v[108:111], a[172:175], v[152:155]
    v_mul_f32 v178, v162, v186
    v_mul_f32 v179, v163, v187
    v_mfma_f32_16x16x32_bf16 v[156:159], v[108:111], a[236:239], v[156:159]
    buffer_load_dwordx4 v[108:111], v6, s[4:7], s28 offen offset:3072 sc1
    s_add_u32 s28, s28, 4096
    s_waitcnt vmcnt(15)
    v_mfma_f32_16x16x32_bf16 v[144:147], v[112:115], a[48:51], v[144:147]
    v_mfma_f32_16x16x32_bf16 v[148:151], v[112:115], a[112:115], v[148:151]
    v_mfma_f32_16x16x32_bf16 v[152:155], v[112:115], a[176:179], v[152:155]
    v_mfma_f32_16x16x32_bf16 v[156:159], v[112:115], a[240:243], v[156:159]
    buffer_load_dwordx4 v[112:115], v6, s[4:7], s28 offen offset:0 sc1
    s_waitcnt vmcnt(15)
    v_mfma_f32_16x16x32_bf16 v[144:147], v[116:119], a[52:55], v[144:147]
    v_mfma_f32_16x16x32_bf16 v[148:151], v[116:119], a[116:119], v[148:151]
    v_mfma_f32_16x16x32_bf16 v[152:155], v[116:119], a[180:183], v[152:155]
    v_mfma_f32_16x16x32_bf16 v[156:159], v[116:119], a[244:247], v[156:159]
    buffer_load_dwordx4 v[116:119], v6, s[4:7], s28 offen offset:1024 sc1
    s_waitcnt vmcnt(15)
    v_mfma_f32_16x16x32_bf16 v[144:147], v[120:123], a[56:59], v[144:147]
    v_mfma_f32_16x16x32_bf16 v[148:151], v[120:123], a[120:123], v[148:151]
    v_mfma_f32_16x16x32_bf16 v[152:155], v[120:123], a[184:187], v[152:155]
    v_mfma_f32_16x16x32_bf16 v[156:159], v[120:123], a[248:251], v[156:159]
    buffer_load_dwordx4 v[120:123], v6, s[4:7], s28 offen offset:2048 sc1
    s_waitcnt vmcnt(15)
    v_mfma_f32_16x16x32_bf16 v[144:147], v[124:127], a[60:63], v[144:147]
    v_mfma_f32_16x16x32_bf16 v[148:151], v[124:127], a[124:127], v[148:151]
    v_mfma_f32_16x16x32_bf16 v[152:155], v[124:127], a[188:191], v[152:155]
    v_mfma_f32_16x16x32_bf16 v[156:159], v[124:127], a[252:255], v[156:159]
    buffer_load_dwordx4 v[124:127], v6, s[4:7], s28 offen offset:3072 sc1
    s_add_u32 s28, s28, 53248
    s_waitcnt vmcnt(15)
    v_mfma_f32_16x16x32_bf16 v[128:131], v[64:67], a[0:3], 0
    v_mfma_f32_16x16x32_bf16 v[132:135], v[64:67], a[64:67], 0
    v_mfma_f32_16x16x32_bf16 v[136:139], v[64:67], a[128:131], 0
    v_mfma_f32_16x16x32_bf16 v[140:143], v[64:67], a[192:195], 0
    buffer_load_dwordx4 v[64:67], v6, s[4:7], s28 offen offset:0 sc1
    s_waitcnt vmcnt(15)
    v_mfma_f32_16x16x32_bf16 v[128:131], v[68:71], a[4:7], v[128:131]
    v_mfma_f32_16x16x32_bf16 v[132:135], v[68:71], a[68:71], v[132:135]
    v_mfma_f32_16x16x32_bf16 v[136:139], v[68:71], a[132:135], v[136:139]
    v_mfma_f32_16x16x32_bf16 v[140:143], v[68:71], a[196:199], v[140:143]
    buffer_load_dwordx4 v[68:71], v6, s[4:7], s28 offen offset:1024 sc1
    s_waitcnt vmcnt(15)
    v_mfma_f32_16x16x32_bf16 v[128:131], v[72:75], a[8:11], v[128:131]
    ds_write_b128 v26, v[144:147] offset:16384
    v_mfma_f32_16x16x32_bf16 v[132:135], v[72:75], a[72:75], v[132:135]
    ds_write_b128 v26, v[148:151] offset:17408
    v_mfma_f32_16x16x32_bf16 v[136:139], v[72:75], a[136:139], v[136:139]
    ds_write_b128 v26, v[152:155] offset:18432
    v_mfma_f32_16x16x32_bf16 v[140:143], v[72:75], a[200:203], v[140:143]
    buffer_load_dwordx4 v[72:75], v6, s[4:7], s28 offen offset:2048 sc1
    s_waitcnt vmcnt(15)
    v_mfma_f32_16x16x32_bf16 v[128:131], v[76:79], a[12:15], v[128:131]
    ds_write_b128 v26, v[156:159] offset:19456
    v_mfma_f32_16x16x32_bf16 v[132:135], v[76:79], a[76:79], v[132:135]
    v_mfma_f32_16x16x32_bf16 v[136:139], v[76:79], a[140:143], v[136:139]
    v_mfma_f32_16x16x32_bf16 v[140:143], v[76:79], a[204:207], v[140:143]
    buffer_load_dwordx4 v[76:79], v6, s[4:7], s28 offen offset:3072 sc1
    s_add_u32 s28, s28, 4096
    s_waitcnt vmcnt(15)
    v_mfma_f32_16x16x32_bf16 v[128:131], v[80:83], a[16:19], v[128:131]
    v_mfma_f32_16x16x32_bf16 v[132:135], v[80:83], a[80:83], v[132:135]
    v_mfma_f32_16x16x32_bf16 v[136:139], v[80:83], a[144:147], v[136:139]
    v_mfma_f32_16x16x32_bf16 v[140:143], v[80:83], a[208:211], v[140:143]
    buffer_load_dwordx4 v[80:83], v6, s[4:7], s28 offen offset:0 sc1
    s_waitcnt vmcnt(15)
    v_mfma_f32_16x16x32_bf16 v[128:131], v[84:87], a[20:23], v[128:131]
    s_waitcnt lgkmcnt(0)
    s_barrier
    ds_read_b128 v[160:163], v27 offset:16384
    v_mfma_f32_16x16x32_bf16 v[132:135], v[84:87], a[84:87], v[132:135]
    ds_read_b128 v[164:167], v27 offset:20480
    v_mfma_f32_16x16x32_bf16 v[136:139], v[84:87], a[148:151], v[136:139]
    ds_read_b128 v[168:171], v27 offset:24576
    v_mfma_f32_16x16x32_bf16 v[140:143], v[84:87], a[212:215], v[140:143]
    buffer_load_dwordx4 v[84:87], v6, s[4:7], s28 offen offset:1024 sc1
    s_waitcnt vmcnt(15)
    v_mfma_f32_16x16x32_bf16 v[128:131], v[88:91], a[24:27], v[128:131]
    ds_read_b128 v[172:175], v27 offset:28672
    v_mfma_f32_16x16x32_bf16 v[132:135], v[88:91], a[88:91], v[132:135]
    v_mfma_f32_16x16x32_bf16 v[136:139], v[88:91], a[152:155], v[136:139]
    v_mfma_f32_16x16x32_bf16 v[140:143], v[88:91], a[216:219], v[140:143]
    buffer_load_dwordx4 v[88:91], v6, s[4:7], s28 offen offset:2048 sc1
    s_waitcnt vmcnt(15)
    v_mfma_f32_16x16x32_bf16 v[128:131], v[92:95], a[28:31], v[128:131]
    v_mfma_f32_16x16x32_bf16 v[132:135], v[92:95], a[92:95], v[132:135]
    v_mfma_f32_16x16x32_bf16 v[136:139], v[92:95], a[156:159], v[136:139]
    v_mfma_f32_16x16x32_bf16 v[140:143], v[92:95], a[220:223], v[140:143]
    buffer_load_dwordx4 v[92:95], v6, s[4:7], s28 offen offset:3072 sc1
    s_add_u32 s28, s28, 4096
    s_waitcnt vmcnt(15)
    v_mfma_f32_16x16x32_bf16 v[128:131], v[96:99], a[32:35], v[128:131]
    v_and_b32 v184, s3, v32
    v_and_b32 v185, s3, v33
    v_mfma_f32_16x16x32_bf16 v[132:135], v[96:99], a[96:99], v[132:135]
    v_and_b32 v186, s3, v34
    v_and_b32 v187, s3, v35
    v_mfma_f32_16x16x32_bf16 v[136:139], v[96:99], a[160:163], v[136:139]
    s_waitcnt lgkmcnt(3)
    v_add_f32 v160, v160, v15
    v_add_f32 v161, v161, v15
    v_mfma_f32_16x16x32_bf16 v[140:143], v[96:99], a[224:227], v[140:143]
    buffer_load_dwordx4 v[96:99], v6, s[4:7], s28 offen offset:0 sc1
    s_waitcnt vmcnt(15)
    v_mfma_f32_16x16x32_bf16 v[128:131], v[100:103], a[36:39], v[128:131]
    v_add_f32 v162, v162, v15
    v_add_f32 v163, v163, v15
    v_mfma_f32_16x16x32_bf16 v[132:135], v[100:103], a[100:103], v[132:135]
    s_waitcnt lgkmcnt(2)
    v_add_f32 v160, v160, v164
    v_add_f32 v161, v161, v165
    v_mfma_f32_16x16x32_bf16 v[136:139], v[100:103], a[164:167], v[136:139]
    v_add_f32 v162, v162, v166
    v_add_f32 v163, v163, v167
    v_mfma_f32_16x16x32_bf16 v[140:143], v[100:103], a[228:231], v[140:143]
    buffer_load_dwordx4 v[100:103], v6, s[4:7], s28 offen offset:1024 sc1
    s_waitcnt vmcnt(15)
    v_mfma_f32_16x16x32_bf16 v[128:131], v[104:107], a[40:43], v[128:131]
    s_waitcnt lgkmcnt(0)
    v_add_f32 v168, v168, v172
    v_add_f32 v169, v169, v173
    v_mfma_f32_16x16x32_bf16 v[132:135], v[104:107], a[104:107], v[132:135]
    v_add_f32 v170, v170, v174
    v_add_f32 v171, v171, v175
    v_mfma_f32_16x16x32_bf16 v[136:139], v[104:107], a[168:171], v[136:139]
    v_add_f32 v160, v160, v168
    v_add_f32 v161, v161, v169
    v_mfma_f32_16x16x32_bf16 v[140:143], v[104:107], a[232:235], v[140:143]
    buffer_load_dwordx4 v[104:107], v6, s[4:7], s28 offen offset:2048 sc1
    s_waitcnt vmcnt(15)
    v_mfma_f32_16x16x32_bf16 v[128:131], v[108:111], a[44:47], v[128:131]
    v_add_f32 v162, v162, v170
    v_add_f32 v163, v163, v171
    v_mfma_f32_16x16x32_bf16 v[132:135], v[108:111], a[108:111], v[132:135]
    v_mul_f32 v180, v160, v184
    v_mul_f32 v181, v161, v185
    v_mfma_f32_16x16x32_bf16 v[136:139], v[108:111], a[172:175], v[136:139]
    v_mul_f32 v182, v162, v186
    v_mul_f32 v183, v163, v187
    v_mfma_f32_16x16x32_bf16 v[140:143], v[108:111], a[236:239], v[140:143]
    buffer_load_dwordx4 v[108:111], v6, s[4:7], s28 offen offset:3072 sc1
    s_add_u32 s28, s28, 4096
    s_waitcnt vmcnt(15)
    v_mfma_f32_16x16x32_bf16 v[128:131], v[112:115], a[48:51], v[128:131]
    v_cvt_pk_bf16_f32 v188, v176, v180
    v_cvt_pk_bf16_f32 v189, v177, v181
    v_mfma_f32_16x16x32_bf16 v[132:135], v[112:115], a[112:115], v[132:135]
    v_cvt_pk_bf16_f32 v190, v178, v182
    v_cvt_pk_bf16_f32 v191, v179, v183
    v_mfma_f32_16x16x32_bf16 v[136:139], v[112:115], a[176:179], v[136:139]
    buffer_store_dwordx4 v[188:191], v6, s[4:7], s29 offen offset:1024 sc1
    v_mfma_f32_16x16x32_bf16 v[140:143], v[112:115], a[240:243], v[140:143]
    buffer_load_dwordx4 v[112:115], v6, s[4:7], s28 offen offset:0 sc1
    s_waitcnt vmcnt(16)
    v_mfma_f32_16x16x32_bf16 v[128:131], v[116:119], a[52:55], v[128:131]
    v_mfma_f32_16x16x32_bf16 v[132:135], v[116:119], a[116:119], v[132:135]
    v_mfma_f32_16x16x32_bf16 v[136:139], v[116:119], a[180:183], v[136:139]
    v_mfma_f32_16x16x32_bf16 v[140:143], v[116:119], a[244:247], v[140:143]
    buffer_load_dwordx4 v[116:119], v6, s[4:7], s28 offen offset:1024 sc1
    s_waitcnt vmcnt(16)
    v_mfma_f32_16x16x32_bf16 v[128:131], v[120:123], a[56:59], v[128:131]
    v_mfma_f32_16x16x32_bf16 v[132:135], v[120:123], a[120:123], v[132:135]
    v_mfma_f32_16x16x32_bf16 v[136:139], v[120:123], a[184:187], v[136:139]
    v_mfma_f32_16x16x32_bf16 v[140:143], v[120:123], a[248:251], v[140:143]
    buffer_load_dwordx4 v[120:123], v6, s[4:7], s28 offen offset:2048 sc1
    s_waitcnt vmcnt(16)
    v_mfma_f32_16x16x32_bf16 v[128:131], v[124:127], a[60:63], v[128:131]
    v_mfma_f32_16x16x32_bf16 v[132:135], v[124:127], a[124:127], v[132:135]
    v_mfma_f32_16x16x32_bf16 v[136:139], v[124:127], a[188:191], v[136:139]
    v_mfma_f32_16x16x32_bf16 v[140:143], v[124:127], a[252:255], v[140:143]
    buffer_load_dwordx4 v[124:127], v6, s[4:7], s28 offen offset:3072 sc1
    s_add_u32 s28, s28, 53248
    s_waitcnt vmcnt(16)
    v_mfma_f32_16x16x32_bf16 v[144:147], v[64:67], a[0:3], 0
    v_mfma_f32_16x16x32_bf16 v[148:151], v[64:67], a[64:67], 0
    v_mfma_f32_16x16x32_bf16 v[152:155], v[64:67], a[128:131], 0
    v_mfma_f32_16x16x32_bf16 v[156:159], v[64:67], a[192:195], 0
    buffer_load_dwordx4 v[64:67], v6, s[4:7], s28 offen offset:0 sc1
    s_waitcnt vmcnt(16)
    v_mfma_f32_16x16x32_bf16 v[144:147], v[68:71], a[4:7], v[144:147]
    v_mfma_f32_16x16x32_bf16 v[148:151], v[68:71], a[68:71], v[148:151]
    v_mfma_f32_16x16x32_bf16 v[152:155], v[68:71], a[132:135], v[152:155]
    v_mfma_f32_16x16x32_bf16 v[156:159], v[68:71], a[196:199], v[156:159]
    buffer_load_dwordx4 v[68:71], v6, s[4:7], s28 offen offset:1024 sc1
    s_waitcnt vmcnt(16)
    v_mfma_f32_16x16x32_bf16 v[144:147], v[72:75], a[8:11], v[144:147]
    ds_write_b128 v26, v[128:131] offset:0
    v_mfma_f32_16x16x32_bf16 v[148:151], v[72:75], a[72:75], v[148:151]
    ds_write_b128 v26, v[132:135] offset:1024
    v_mfma_f32_16x16x32_bf16 v[152:155], v[72:75], a[136:139], v[152:155]
    ds_write_b128 v26, v[136:139] offset:2048
    v_mfma_f32_16x16x32_bf16 v[156:159], v[72:75], a[200:203], v[156:159]
    buffer_load_dwordx4 v[72:75], v6, s[4:7], s28 offen offset:2048 sc1
    s_waitcnt vmcnt(16)
    v_mfma_f32_16x16x32_bf16 v[144:147], v[76:79], a[12:15], v[144:147]
    ds_write_b128 v26, v[140:143] offset:3072
    v_mfma_f32_16x16x32_bf16 v[148:151], v[76:79], a[76:79], v[148:151]
    v_mfma_f32_16x16x32_bf16 v[152:155], v[76:79], a[140:143], v[152:155]
    v_mfma_f32_16x16x32_bf16 v[156:159], v[76:79], a[204:207], v[156:159]
    buffer_load_dwordx4 v[76:79], v6, s[4:7], s28 offen offset:3072 sc1
    s_add_u32 s28, s28, 4096
    s_waitcnt vmcnt(16)
    v_mfma_f32_16x16x32_bf16 v[144:147], v[80:83], a[16:19], v[144:147]
    v_mfma_f32_16x16x32_bf16 v[148:151], v[80:83], a[80:83], v[148:151]
    v_mfma_f32_16x16x32_bf16 v[152:155], v[80:83], a[144:147], v[152:155]
    v_mfma_f32_16x16x32_bf16 v[156:159], v[80:83], a[208:211], v[156:159]
    buffer_load_dwordx4 v[80:83], v6, s[4:7], s28 offen offset:0 sc1
    s_waitcnt vmcnt(16)
    v_mfma_f32_16x16x32_bf16 v[144:147], v[84:87], a[20:23], v[144:147]
    s_waitcnt lgkmcnt(0)
    s_barrier
    ds_read_b128 v[160:163], v27 offset:0
    v_mfma_f32_16x16x32_bf16 v[148:151], v[84:87], a[84:87], v[148:151]
    ds_read_b128 v[164:167], v27 offset:4096
    v_mfma_f32_16x16x32_bf16 v[152:155], v[84:87], a[148:151], v[152:155]
    ds_read_b128 v[168:171], v27 offset:8192
    v_mfma_f32_16x16x32_bf16 v[156:159], v[84:87], a[212:215], v[156:159]
    buffer_load_dwordx4 v[84:87], v6, s[4:7], s28 offen offset:1024 sc1
    s_waitcnt vmcnt(16)
    v_mfma_f32_16x16x32_bf16 v[144:147], v[88:91], a[24:27], v[144:147]
    ds_read_b128 v[172:175], v27 offset:12288
    v_mfma_f32_16x16x32_bf16 v[148:151], v[88:91], a[88:91], v[148:151]
    v_mfma_f32_16x16x32_bf16 v[152:155], v[88:91], a[152:155], v[152:155]
    v_mfma_f32_16x16x32_bf16 v[156:159], v[88:91], a[216:219], v[156:159]
    buffer_load_dwordx4 v[88:91], v6, s[4:7], s28 offen offset:2048 sc1
    s_waitcnt vmcnt(16)
    v_mfma_f32_16x16x32_bf16 v[144:147], v[92:95], a[28:31], v[144:147]
    v_mfma_f32_16x16x32_bf16 v[148:151], v[92:95], a[92:95], v[148:151]
    v_mfma_f32_16x16x32_bf16 v[152:155], v[92:95], a[156:159], v[152:155]
    v_mfma_f32_16x16x32_bf16 v[156:159], v[92:95], a[220:223], v[156:159]
    buffer_load_dwordx4 v[92:95], v6, s[4:7], s28 offen offset:3072 sc1
    s_add_u32 s28, s28, 4096
    s_waitcnt vmcnt(16)
    v_mfma_f32_16x16x32_bf16 v[144:147], v[96:99], a[32:35], v[144:147]
    v_lshlrev_b32 v184, 16, v36
    v_lshlrev_b32 v185, 16, v37
    v_mfma_f32_16x16x32_bf16 v[148:151], v[96:99], a[96:99], v[148:151]
    v_lshlrev_b32 v186, 16, v38
    v_lshlrev_b32 v187, 16, v39
    v_mfma_f32_16x16x32_bf16 v[152:155], v[96:99], a[160:163], v[152:155]
    s_waitcnt lgkmcnt(3)
    v_add_f32 v160, v160, v15
    v_add_f32 v161, v161, v15
    v_mfma_f32_16x16x32_bf16 v[156:159], v[96:99], a[224:227], v[156:159]
    buffer_load_dwordx4 v[96:99], v6, s[4:7], s28 offen offset:0 sc1
    s_waitcnt vmcnt(16)
    v_mfma_f32_16x16x32_bf16 v[144:147], v[100:103], a[36:39], v[144:147]
    v_add_f32 v162, v162, v15
    v_add_f32 v163, v163, v15
    v_mfma_f32_16x16x32_bf16 v[148:151], v[100:103], a[100:103], v[148:151]
    s_waitcnt lgkmcnt(2)
    v_add_f32 v160, v160, v164
    v_add_f32 v161, v161, v165
    v_mfma_f32_16x16x32_bf16 v[152:155], v[100:103], a[164:167], v[152:155]
    v_add_f32 v162, v162, v166
    v_add_f32 v163, v163, v167
    v_mfma_f32_16x16x32_bf16 v[156:159], v[100:103], a[228:231], v[156:159]
    buffer_load_dwordx4 v[100:103], v6, s[4:7], s28 offen offset:1024 sc1
    s_waitcnt vmcnt(16)
    v_mfma_f32_16x16x32_bf16 v[144:147], v[104:107], a[40:43], v[144:147]
    s_waitcnt lgkmcnt(0)
    v_add_f32 v168, v168, v172
    v_add_f32 v169, v169, v173
    v_mfma_f32_16x16x32_bf16 v[148:151], v[104:107], a[104:107], v[148:151]
    v_add_f32 v170, v170, v174
    v_add_f32 v171, v171, v175
    v_mfma_f32_16x16x32_bf16 v[152:155], v[104:107], a[168:171], v[152:155]
    v_add_f32 v160, v160, v168
    v_add_f32 v161, v161, v169
    v_mfma_f32_16x16x32_bf16 v[156:159], v[104:107], a[232:235], v[156:159]
    buffer_load_dwordx4 v[104:107], v6, s[4:7], s28 offen offset:2048 sc1
    s_waitcnt vmcnt(16)
    v_mfma_f32_16x16x32_bf16 v[144:147], v[108:111], a[44:47], v[144:147]
    v_add_f32 v162, v162, v170
    v_add_f32 v163, v163, v171
    v_mfma_f32_16x16x32_bf16 v[148:151], v[108:111], a[108:111], v[148:151]
    v_mul_f32 v176, v160, v184
    v_mul_f32 v177, v161, v185
    v_mfma_f32_16x16x32_bf16 v[152:155], v[108:111], a[172:175], v[152:155]
    v_mul_f32 v178, v162, v186
    v_mul_f32 v179, v163, v187
    v_mfma_f32_16x16x32_bf16 v[156:159], v[108:111], a[236:239], v[156:159]
    buffer_load_dwordx4 v[108:111], v6, s[4:7], s28 offen offset:3072 sc1
    s_add_u32 s28, s28, 4096
    s_waitcnt vmcnt(15)
    v_mfma_f32_16x16x32_bf16 v[144:147], v[112:115], a[48:51], v[144:147]
    v_mfma_f32_16x16x32_bf16 v[148:151], v[112:115], a[112:115], v[148:151]
    v_mfma_f32_16x16x32_bf16 v[152:155], v[112:115], a[176:179], v[152:155]
    v_mfma_f32_16x16x32_bf16 v[156:159], v[112:115], a[240:243], v[156:159]
    buffer_load_dwordx4 v[112:115], v6, s[4:7], s28 offen offset:0 sc1
    s_waitcnt vmcnt(15)
    v_mfma_f32_16x16x32_bf16 v[144:147], v[116:119], a[52:55], v[144:147]
    v_mfma_f32_16x16x32_bf16 v[148:151], v[116:119], a[116:119], v[148:151]
    v_mfma_f32_16x16x32_bf16 v[152:155], v[116:119], a[180:183], v[152:155]
    v_mfma_f32_16x16x32_bf16 v[156:159], v[116:119], a[244:247], v[156:159]
    buffer_load_dwordx4 v[116:119], v6, s[4:7], s28 offen offset:1024 sc1
    s_waitcnt vmcnt(15)
    v_mfma_f32_16x16x32_bf16 v[144:147], v[120:123], a[56:59], v[144:147]
    v_mfma_f32_16x16x32_bf16 v[148:151], v[120:123], a[120:123], v[148:151]
    v_mfma_f32_16x16x32_bf16 v[152:155], v[120:123], a[184:187], v[152:155]
    v_mfma_f32_16x16x32_bf16 v[156:159], v[120:123], a[248:251], v[156:159]
    buffer_load_dwordx4 v[120:123], v6, s[4:7], s28 offen offset:2048 sc1
    s_waitcnt vmcnt(15)
    v_mfma_f32_16x16x32_bf16 v[144:147], v[124:127], a[60:63], v[144:147]
    v_mfma_f32_16x16x32_bf16 v[148:151], v[124:127], a[124:127], v[148:151]
    v_mfma_f32_16x16x32_bf16 v[152:155], v[124:127], a[188:191], v[152:155]
    v_mfma_f32_16x16x32_bf16 v[156:159], v[124:127], a[252:255], v[156:159]
    buffer_load_dwordx4 v[124:127], v6, s[4:7], s28 offen offset:3072 sc1
    s_add_u32 s28, s28, 53248
    s_waitcnt vmcnt(15)
    v_mfma_f32_16x16x32_bf16 v[128:131], v[64:67], a[0:3], 0
    v_mfma_f32_16x16x32_bf16 v[132:135], v[64:67], a[64:67], 0
    v_mfma_f32_16x16x32_bf16 v[136:139], v[64:67], a[128:131], 0
    v_mfma_f32_16x16x32_bf16 v[140:143], v[64:67], a[192:195], 0
    s_add_u32 m0, s24, 40960
    s_nop 0
    buffer_load_dwordx4 v6, s[4:7], s31 offen offset:0 lds
    s_waitcnt vmcnt(15)
    v_mfma_f32_16x16x32_bf16 v[128:131], v[68:71], a[4:7], v[128:131]
    v_mfma_f32_16x16x32_bf16 v[132:135], v[68:71], a[68:71], v[132:135]
    v_mfma_f32_16x16x32_bf16 v[136:139], v[68:71], a[132:135], v[136:139]
    v_mfma_f32_16x16x32_bf16 v[140:143], v[68:71], a[196:199], v[140:143]
    s_waitcnt vmcnt(14)
    v_mfma_f32_16x16x32_bf16 v[128:131], v[72:75], a[8:11], v[128:131]
    ds_write_b128 v26, v[144:147] offset:16384
    v_mfma_f32_16x16x32_bf16 v[132:135], v[72:75], a[72:75], v[132:135]
    ds_write_b128 v26, v[148:151] offset:17408
    v_mfma_f32_16x16x32_bf16 v[136:139], v[72:75], a[136:139], v[136:139]
    ds_write_b128 v26, v[152:155] offset:18432
    v_mfma_f32_16x16x32_bf16 v[140:143], v[72:75], a[200:203], v[140:143]
    buffer_load_dwordx4 v6, s[4:7], s31 offen offset:1024 lds
    s_waitcnt vmcnt(14)
    v_mfma_f32_16x16x32_bf16 v[128:131], v[76:79], a[12:15], v[128:131]
    ds_write_b128 v26, v[156:159] offset:19456
    v_mfma_f32_16x16x32_bf16 v[132:135], v[76:79], a[76:79], v[132:135]
    v_mfma_f32_16x16x32_bf16 v[136:139], v[76:79], a[140:143], v[136:139]
    v_mfma_f32_16x16x32_bf16 v[140:143], v[76:79], a[204:207], v[140:143]
    s_waitcnt vmcnt(13)
    v_mfma_f32_16x16x32_bf16 v[128:131], v[80:83], a[16:19], v[128:131]
    v_mfma_f32_16x16x32_bf16 v[132:135], v[80:83], a[80:83], v[132:135]
    v_mfma_f32_16x16x32_bf16 v[136:139], v[80:83], a[144:147], v[136:139]
    v_mfma_f32_16x16x32_bf16 v[140:143], v[80:83], a[208:211], v[140:143]
    buffer_load_dwordx4 v6, s[4:7], s31 offen offset:2048 lds
    s_waitcnt vmcnt(13)
    v_mfma_f32_16x16x32_bf16 v[128:131], v[84:87], a[20:23], v[128:131]
    s_waitcnt lgkmcnt(0)
    s_barrier
    ds_read_b128 v[160:163], v27 offset:16384
    v_mfma_f32_16x16x32_bf16 v[132:135], v[84:87], a[84:87], v[132:135]
    ds_read_b128 v[164:167], v27 offset:20480
    v_mfma_f32_16x16x32_bf16 v[136:139], v[84:87], a[148:151], v[136:139]
    ds_read_b128 v[168:171], v27 offset:24576
    v_mfma_f32_16x16x32_bf16 v[140:143], v[84:87], a[212:215], v[140:143]
    s_waitcnt vmcnt(12)
    v_mfma_f32_16x16x32_bf16 v[128:131], v[88:91], a[24:27], v[128:131]
    ds_read_b128 v[172:175], v27 offset:28672
    v_mfma_f32_16x16x32_bf16 v[132:135], v[88:91], a[88:91], v[132:135]
    v_mfma_f32_16x16x32_bf16 v[136:139], v[88:91], a[152:155], v[136:139]
    v_mfma_f32_16x16x32_bf16 v[140:143], v[88:91], a[216:219], v[140:143]
    buffer_load_dwordx4 v6, s[4:7], s31 offen offset:3072 lds
    s_add_u32 s31, s31, 4096
    s_waitcnt vmcnt(12)
    v_mfma_f32_16x16x32_bf16 v[128:131], v[92:95], a[28:31], v[128:131]
    v_mfma_f32_16x16x32_bf16 v[132:135], v[92:95], a[92:95], v[132:135]
    v_mfma_f32_16x16x32_bf16 v[136:139], v[92:95], a[156:159], v[136:139]
    v_mfma_f32_16x16x32_bf16 v[140:143], v[92:95], a[220:223], v[140:143]
    s_waitcnt vmcnt(11)
    v_mfma_f32_16x16x32_bf16 v[128:131], v[96:99], a[32:35], v[128:131]
    v_and_b32 v184, s3, v36
    v_and_b32 v185, s3, v37
    v_mfma_f32_16x16x32_bf16 v[132:135], v[96:99], a[96:99], v[132:135]
    v_and_b32 v186, s3, v38
    v_and_b32 v187, s3, v39
    v_mfma_f32_16x16x32_bf16 v[136:139], v[96:99], a[160:163], v[136:139]
    s_waitcnt lgkmcnt(3)
    v_add_f32 v160, v160, v15
    v_add_f32 v161, v161, v15
    v_mfma_f32_16x16x32_bf16 v[140:143], v[96:99], a[224:227], v[140:143]
    s_add_u32 m0, s24, 45056
    s_nop 0
    buffer_load_dwordx4 v6, s[4:7], s31 offen offset:0 lds
    s_add_u32 s31, s31, 16384
    s_waitcnt vmcnt(11)
    v_mfma_f32_16x16x32_bf16 v[128:131], v[100:103], a[36:39], v[128:131]
    v_add_f32 v162, v162, v15
    v_add_f32 v163, v163, v15
    v_mfma_f32_16x16x32_bf16 v[132:135], v[100:103], a[100:103], v[132:135]
    s_waitcnt lgkmcnt(2)
    v_add_f32 v160, v160, v164
    v_add_f32 v161, v161, v165
    v_mfma_f32_16x16x32_bf16 v[136:139], v[100:103], a[164:167], v[136:139]
    v_add_f32 v162, v162, v166
    v_add_f32 v163, v163, v167
    v_mfma_f32_16x16x32_bf16 v[140:143], v[100:103], a[228:231], v[140:143]
    s_waitcnt vmcnt(10)
    v_mfma_f32_16x16x32_bf16 v[128:131], v[104:107], a[40:43], v[128:131]
    s_waitcnt lgkmcnt(0)
    v_add_f32 v168, v168, v172
    v_add_f32 v169, v169, v173
    v_mfma_f32_16x16x32_bf16 v[132:135], v[104:107], a[104:107], v[132:135]
    v_add_f32 v170, v170, v174
    v_add_f32 v171, v171, v175
    v_mfma_f32_16x16x32_bf16 v[136:139], v[104:107], a[168:171], v[136:139]
    v_add_f32 v160, v160, v168
    v_add_f32 v161, v161, v169
    v_mfma_f32_16x16x32_bf16 v[140:143], v[104:107], a[232:235], v[140:143]
    s_add_u32 m0, s24, 61440
    s_nop 0
    buffer_load_dwordx4 v6, s[4:7], s31 offen offset:0 lds
    s_waitcnt vmcnt(10)
    v_mfma_f32_16x16x32_bf16 v[128:131], v[108:111], a[44:47], v[128:131]
    v_add_f32 v162, v162, v170
    v_add_f32 v163, v163, v171
    v_mfma_f32_16x16x32_bf16 v[132:135], v[108:111], a[108:111], v[132:135]
    v_mul_f32 v180, v160, v184
    v_mul_f32 v181, v161, v185
    v_mfma_f32_16x16x32_bf16 v[136:139], v[108:111], a[172:175], v[136:139]
    v_mul_f32 v182, v162, v186
    v_mul_f32 v183, v163, v187
    v_mfma_f32_16x16x32_bf16 v[140:143], v[108:111], a[236:239], v[140:143]
    s_waitcnt vmcnt(9)
    v_mfma_f32_16x16x32_bf16 v[128:131], v[112:115], a[48:51], v[128:131]
    v_cvt_pk_bf16_f32 v188, v176, v180
    v_cvt_pk_bf16_f32 v189, v177, v181
    v_mfma_f32_16x16x32_bf16 v[132:135], v[112:115], a[112:115], v[132:135]
    v_cvt_pk_bf16_f32 v190, v178, v182
    v_cvt_pk_bf16_f32 v191, v179, v183
    v_mfma_f32_16x16x32_bf16 v[136:139], v[112:115], a[176:179], v[136:139]
    buffer_store_dwordx4 v[188:191], v6, s[4:7], s29 offen offset:2048 sc1
    v_mfma_f32_16x16x32_bf16 v[140:143], v[112:115], a[240:243], v[140:143]
    buffer_load_dwordx4 v6, s[4:7], s31 offen offset:1024 lds
    s_waitcnt vmcnt(10)
    v_mfma_f32_16x16x32_bf16 v[128:131], v[116:119], a[52:55], v[128:131]
    v_mfma_f32_16x16x32_bf16 v[132:135], v[116:119], a[116:119], v[132:135]
    v_mfma_f32_16x16x32_bf16 v[136:139], v[116:119], a[180:183], v[136:139]
    v_mfma_f32_16x16x32_bf16 v[140:143], v[116:119], a[244:247], v[140:143]
    s_waitcnt vmcnt(9)
    v_mfma_f32_16x16x32_bf16 v[128:131], v[120:123], a[56:59], v[128:131]
    v_mfma_f32_16x16x32_bf16 v[132:135], v[120:123], a[120:123], v[132:135]
    v_mfma_f32_16x16x32_bf16 v[136:139], v[120:123], a[184:187], v[136:139]
    v_mfma_f32_16x16x32_bf16 v[140:143], v[120:123], a[248:251], v[140:143]
    buffer_load_dwordx4 v6, s[4:7], s31 offen offset:2048 lds
    s_waitcnt vmcnt(9)
    v_mfma_f32_16x16x32_bf16 v[128:131], v[124:127], a[60:63], v[128:131]
    v_mfma_f32_16x16x32_bf16 v[132:135], v[124:127], a[124:127], v[132:135]
    v_mfma_f32_16x16x32_bf16 v[136:139], v[124:127], a[188:191], v[136:139]
    v_mfma_f32_16x16x32_bf16 v[140:143], v[124:127], a[252:255], v[140:143]
    s_nop 4
    ds_write_b128 v26, v[128:131] offset:0
    ds_write_b128 v26, v[132:135] offset:1024
    ds_write_b128 v26, v[136:139] offset:2048
    ds_write_b128 v26, v[140:143] offset:3072
    s_waitcnt lgkmcnt(0)
    s_barrier
    ds_read_b128 v[160:163], v27 offset:0
    ds_read_b128 v[164:167], v27 offset:4096
    ds_read_b128 v[168:171], v27 offset:8192
    ds_read_b128 v[172:175], v27 offset:12288
    v_lshlrev_b32 v184, 16, v40
    v_lshlrev_b32 v185, 16, v41
    v_lshlrev_b32 v186, 16, v42
    v_lshlrev_b32 v187, 16, v43
    s_waitcnt lgkmcnt(3)
    v_add_f32 v160, v160, v15
    v_add_f32 v161, v161, v15
    v_add_f32 v162, v162, v15
    v_add_f32 v163, v163, v15
    s_waitcnt lgkmcnt(2)
    v_add_f32 v160, v160, v164
    v_add_f32 v161, v161, v165
    v_add_f32 v162, v162, v166
    v_add_f32 v163, v163, v167
    s_waitcnt lgkmcnt(0)
    v_add_f32 v168, v168, v172
    v_add_f32 v169, v169, v173
    v_add_f32 v170, v170, v174
    v_add_f32 v171, v171, v175
    v_add_f32 v160, v160, v168
    v_add_f32 v161, v161, v169
    v_add_f32 v162, v162, v170
    v_add_f32 v163, v163, v171
    v_mul_f32 v176, v160, v184
    v_mul_f32 v177, v161, v185
    v_mul_f32 v178, v162, v186
    v_mul_f32 v179, v163, v187
    v_cvt_pk_bf16_f32 v188, v176, v177
    v_cvt_pk_bf16_f32 v189, v178, v179
    buffer_store_dwordx2 v[188:189], v6, s[4:7], s30 offen sc1
    buffer_load_dwordx4 v6, s[4:7], s31 offen offset:3072 lds
    s_add_u32 s31, s31, 4096
    s_add_u32 m0, s24, 65536
    s_nop 0
    buffer_load_dwordx4 v6, s[4:7], s31 offen offset:0 lds
    s_add_u32 s31, s31, 16384
    s_add_u32 m0, s24, 81920
    s_nop 0
    buffer_load_dwordx4 v6, s[4:7], s31 offen offset:0 lds
    buffer_load_dwordx4 v6, s[4:7], s31 offen offset:1024 lds
    buffer_load_dwordx4 v6, s[4:7], s31 offen offset:2048 lds
    buffer_load_dwordx4 v6, s[4:7], s31 offen offset:3072 lds
    s_add_u32 s31, s31, 4096
    s_add_u32 m0, s24, 86016
    s_nop 0
    buffer_load_dwordx4 v6, s[4:7], s31 offen offset:0 lds
    s_add_u32 s31, s31, 16384
    s_add_u32 m0, s24, 102400
    s_nop 0
    buffer_load_dwordx4 v6, s[4:7], s31 offen offset:0 lds
    buffer_load_dwordx4 v6, s[4:7], s31 offen offset:1024 lds
    buffer_load_dwordx4 v6, s[4:7], s31 offen offset:2048 lds
    s_lshl_b32 s34, s22, 2
    s_add_u32 s34, s34, s27
    v_mov_b32 v4, 0
    s_waitcnt vmcnt(10)
    s_mov_b64 exec, 1
    buffer_store_dword v4, off, s[4:7], s34 sc1
    s_mov_b64 exec, -1
    buffer_load_dwordx4 v6, s[4:7], s31 offen offset:3072 lds
    s_add_u32 s31, s31, 4096
    s_add_u32 m0, s24, 106496
    s_nop 0
    buffer_load_dwordx4 v6, s[4:7], s31 offen offset:0 lds
    s_add_u32 s31, s31, 16384
    s_add_u32 m0, s24, 122880
    s_nop 0
    buffer_load_dwordx4 v6, s[4:7], s31 offen offset:0 lds
    buffer_load_dwordx4 v6, s[4:7], s31 offen offset:1024 lds
    buffer_load_dwordx4 v6, s[4:7], s31 offen offset:2048 lds
    buffer_load_dwordx4 v6, s[4:7], s31 offen offset:3072 lds
    s_add_u32 s31, s31, 4096
    s_add_u32 m0, s24, 126976
    s_nop 0
    buffer_load_dwordx4 v6, s[4:7], s31 offen offset:0 lds
    s_add_u32 s31, s31, 16384
    s_add_u32 m0, s24, 143360
    s_nop 0
    buffer_load_dwordx4 v6, s[4:7], s31 offen offset:0 lds
    buffer_load_dwordx4 v6, s[4:7], s31 offen offset:1024 lds
    buffer_load_dwordx4 v6, s[4:7], s31 offen offset:2048 lds
    buffer_load_dwordx4 v6, s[4:7], s31 offen offset:3072 lds
    s_add_u32 s31, s31, 4096
    s_add_u32 m0, s24, 147456
    s_nop 0
    buffer_load_dwordx4 v6, s[4:7], s31 offen offset:0 lds
    s_add_u32 s31, s31, 16384
    s_add_u32 m0, s24, 20480
    s_nop 0
    buffer_load_dwordx4 v6, s[4:7], s31 offen offset:0 lds
    buffer_load_dwordx4 v6, s[4:7], s31 offen offset:1024 lds
    buffer_load_dwordx4 v6, s[4:7], s31 offen offset:2048 lds
    buffer_load_dwordx4 v6, s[4:7], s31 offen offset:3072 lds
    s_add_u32 s31, s31, 4096
    s_add_u32 m0, s24, 24576
    s_nop 0
    buffer_load_dwordx4 v6, s[4:7], s31 offen offset:0 lds
    s_add_u32 s31, s31, 16384
    v_add_u32 v236, 20480, v6
    v_add_u32 v237, 81920, v6
    v_add_u32 v238, 143360, v6
    v_and_b32 v9, 7, v0
    v_lshlrev_b32 v9, 2, v9
    s_mov_b32 s32, 65536
L_kb_pollp_7:
    buffer_load_dword v4, v9, s[4:7], s27 offen sc1
    s_waitcnt vmcnt(0)
    v_cmp_eq_u32 vcc, -1, v4
    s_nop 0
    s_cbranch_vccz L_kb_gotp_8
    s_sub_u32 s32, s32, 1
    s_cmp_lg_u32 s32, 0
    s_cbranch_scc1 L_kb_pollp_7
L_kb_gotp_8:
    s_barrier
    buffer_load_dwordx4 v[64:67], v6, s[4:7], s25 offen offset:0 sc1
    buffer_load_dwordx4 v[68:71], v6, s[4:7], s25 offen offset:1024 sc1
    buffer_load_dwordx4 v[72:75], v6, s[4:7], s25 offen offset:2048 sc1
    buffer_load_dwordx4 v[76:79], v6, s[4:7], s25 offen offset:3072 sc1
    s_add_u32 s25, s25, 4096
    buffer_load_dwordx4 v[80:83], v6, s[4:7], s25 offen offset:0 sc1
    buffer_load_dwordx4 v[84:87], v6, s[4:7], s25 offen offset:1024 sc1
    buffer_load_dwordx4 v[88:91], v6, s[4:7], s25 offen offset:2048 sc1
    buffer_load_dwordx4 v[92:95], v6, s[4:7], s25 offen offset:3072 sc1
    s_add_u32 s25, s25, 4096
    buffer_load_dwordx4 v[96:99], v6, s[4:7], s25 offen offset:0 sc1
    buffer_load_dwordx4 v[100:103], v6, s[4:7], s25 offen offset:1024 sc1
    buffer_load_dwordx4 v[104:107], v6, s[4:7], s25 offen offset:2048 sc1
    buffer_load_dwordx4 v[108:111], v6, s[4:7], s25 offen offset:3072 sc1
    s_add_u32 s25, s25, 4096
    ds_read_b128 v[196:199], v236 offset:20480
    ds_read_b128 v[200:203], v236 offset:21504
    ds_read_b128 v[204:207], v236 offset:22528
    ds_read_b128 v[208:211], v236 offset:23552
    ds_read_b128 v[212:215], v236 offset:24576
    ds_read_b128 v[216:219], v236 offset:25600
    ds_read_b128 v[220:223], v236 offset:26624
    ds_read_b128 v[224:227], v236 offset:27648
    v_mul_u32_u24 v239, 2560, v2
    s_mul_i32 s34, s23, 1280
    s_mul_i32 s35, s22, 160
    s_add_u32 s34, s34, s35
    v_lshl_add_u32 v4, v3, 3, v239
    v_lshl_add_u32 v239, v3, 4, v239
    s_waitcnt vmcnt(11) lgkmcnt(7)
    v_mfma_f32_16x16x32_bf16 v[176:179], v[196:199], v[64:67], 0
    ds_read_b128 v[228:231], v236 offset:28672
    s_waitcnt lgkmcnt(7)
    v_mfma_f32_16x16x32_bf16 v[180:183], v[200:203], v[64:67], 0
    ds_read_b128 v[232:235], v236 offset:29696
    s_waitcnt lgkmcnt(7)
    v_mfma_f32_16x16x32_bf16 v[184:187], v[204:207], v[64:67], 0
    ds_read_b128 v[196:199], v236 offset:30720
    buffer_load_dwordx4 v[112:115], v6, s[4:7], s25 offen offset:0 sc1
    s_waitcnt lgkmcnt(7)
    v_mfma_f32_16x16x32_bf16 v[188:191], v[208:211], v[64:67], 0
    ds_read_b128 v[200:203], v236 offset:31744
    s_waitcnt lgkmcnt(7)
    v_mfma_f32_16x16x32_bf16 v[192:195], v[212:215], v[64:67], 0
    ds_read_b128 v[204:207], v236 offset:32768
    s_waitcnt vmcnt(11) lgkmcnt(7)
    v_mfma_f32_16x16x32_bf16 v[176:179], v[216:219], v[68:71], v[176:179]
    ds_read_b128 v[208:211], v236 offset:33792
    s_waitcnt lgkmcnt(7)
    v_mfma_f32_16x16x32_bf16 v[180:183], v[220:223], v[68:71], v[180:183]
    ds_read_b128 v[212:215], v236 offset:34816
    s_waitcnt lgkmcnt(7)
    v_mfma_f32_16x16x32_bf16 v[184:187], v[224:227], v[68:71], v[184:187]
    ds_read_b128 v[216:219], v236 offset:35840
    buffer_load_dwordx4 v[116:119], v6, s[4:7], s25 offen offset:1024 sc1
    s_waitcnt lgkmcnt(7)
    v_mfma_f32_16x16x32_bf16 v[188:191], v[228:231], v[68:71], v[188:191]
    ds_read_b128 v[220:223], v236 offset:36864
    s_waitcnt lgkmcnt(7)
    v_mfma_f32_16x16x32_bf16 v[192:195], v[232:235], v[68:71], v[192:195]
    ds_read_b128 v[224:227], v236 offset:37888
    s_waitcnt vmcnt(11) lgkmcnt(7)
    v_mfma_f32_16x16x32_bf16 v[176:179], v[196:199], v[72:75], v[176:179]
    ds_read_b128 v[228:231], v236 offset:38912
    s_waitcnt lgkmcnt(7)
    v_mfma_f32_16x16x32_bf16 v[180:183], v[200:203], v[72:75], v[180:183]
    ds_read_b128 v[232:235], v236 offset:39936
    s_waitcnt lgkmcnt(7)
    v_mfma_f32_16x16x32_bf16 v[184:187], v[204:207], v[72:75], v[184:187]
    ds_read_b128 v[196:199], v236 offset:40960
    buffer_load_dwordx4 v[120:123], v6, s[4:7], s25 offen offset:2048 sc1
    s_waitcnt lgkmcnt(7)
    v_mfma_f32_16x16x32_bf16 v[188:191], v[208:211], v[72:75], v[188:191]
    ds_read_b128 v[200:203], v236 offset:41984
    s_waitcnt lgkmcnt(7)
    v_mfma_f32_16x16x32_bf16 v[192:195], v[212:215], v[72:75], v[192:195]
    ds_read_b128 v[204:207], v236 offset:43008
    s_waitcnt vmcnt(11) lgkmcnt(7)
    v_mfma_f32_16x16x32_bf16 v[176:179], v[216:219], v[76:79], v[176:179]
    ds_read_b128 v[208:211], v236 offset:44032
    s_waitcnt lgkmcnt(7)
    v_mfma_f32_16x16x32_bf16 v[180:183], v[220:223], v[76:79], v[180:183]
    ds_read_b128 v[212:215], v236 offset:45056
    s_waitcnt lgkmcnt(7)
    v_mfma_f32_16x16x32_bf16 v[184:187], v[224:227], v[76:79], v[184:187]
    ds_read_b128 v[216:219], v236 offset:46080
    buffer_load_dwordx4 v[124:127], v6, s[4:7], s25 offen offset:3072 sc1
    s_add_u32 s25, s25, 4096
    s_waitcnt lgkmcnt(7)
    v_mfma_f32_16x16x32_bf16 v[188:191], v[228:231], v[76:79], v[188:191]
    ds_read_b128 v[220:223], v236 offset:47104
    s_waitcnt lgkmcnt(7)
    v_mfma_f32_16x16x32_bf16 v[192:195], v[232:235], v[76:79], v[192:195]
    ds_read_b128 v[224:227], v236 offset:48128
    s_waitcnt vmcnt(11) lgkmcnt(7)
    v_mfma_f32_16x16x32_bf16 v[176:179], v[196:199], v[80:83], v[176:179]
    ds_read_b128 v[228:231], v236 offset:49152
    s_waitcnt lgkmcnt(7)
    v_mfma_f32_16x16x32_bf16 v[180:183], v[200:203], v[80:83], v[180:183]
    ds_read_b128 v[232:235], v236 offset:50176
    s_waitcnt lgkmcnt(7)
    v_mfma_f32_16x16x32_bf16 v[184:187], v[204:207], v[80:83], v[184:187]
    ds_read_b128 v[196:199], v236 offset:51200
    buffer_load_dwordx4 v[128:131], v6, s[4:7], s25 offen offset:0 sc1
    s_waitcnt lgkmcnt(7)
    v_mfma_f32_16x16x32_bf16 v[188:191], v[208:211], v[80:83], v[188:191]
    ds_read_b128 v[200:203], v236 offset:52224
    s_waitcnt lgkmcnt(7)
    v_mfma_f32_16x16x32_bf16 v[192:195], v[212:215], v[80:83], v[192:195]
    ds_read_b128 v[204:207], v236 offset:53248
    s_waitcnt vmcnt(11) lgkmcnt(7)
    v_mfma_f32_16x16x32_bf16 v[176:179], v[216:219], v[84:87], v[176:179]
    ds_read_b128 v[208:211], v236 offset:54272
    s_waitcnt lgkmcnt(7)
    v_mfma_f32_16x16x32_bf16 v[180:183], v[220:223], v[84:87], v[180:183]
    ds_read_b128 v[212:215], v236 offset:55296
    s_waitcnt lgkmcnt(7)
    v_mfma_f32_16x16x32_bf16 v[184:187], v[224:227], v[84:87], v[184:187]
    ds_read_b128 v[216:219], v236 offset:56320
    buffer_load_dwordx4 v[132:135], v6, s[4:7], s25 offen offset:1024 sc1
    s_waitcnt lgkmcnt(7)
    v_mfma_f32_16x16x32_bf16 v[188:191], v[228:231], v[84:87], v[188:191]
    ds_read_b128 v[220:223], v236 offset:57344
    s_waitcnt lgkmcnt(7)
    v_mfma_f32_16x16x32_bf16 v[192:195], v[232:235], v[84:87], v[192:195]
    ds_read_b128 v[224:227], v236 offset:58368
    s_waitcnt vmcnt(11) lgkmcnt(7)
    v_mfma_f32_16x16x32_bf16 v[176:179], v[196:199], v[88:91], v[176:179]
    ds_read_b128 v[228:231], v236 offset:59392
    s_waitcnt lgkmcnt(7)
    v_mfma_f32_16x16x32_bf16 v[180:183], v[200:203], v[88:91], v[180:183]
    ds_read_b128 v[232:235], v236 offset:60416
    s_waitcnt lgkmcnt(7)
    v_mfma_f32_16x16x32_bf16 v[184:187], v[204:207], v[88:91], v[184:187]
    ds_read_b128 v[196:199], v237 offset:0
    buffer_load_dwordx4 v[136:139], v6, s[4:7], s25 offen offset:2048 sc1
    s_waitcnt lgkmcnt(7)
    v_mfma_f32_16x16x32_bf16 v[188:191], v[208:211], v[88:91], v[188:191]
    ds_read_b128 v[200:203], v237 offset:1024
    s_waitcnt lgkmcnt(7)
    v_mfma_f32_16x16x32_bf16 v[192:195], v[212:215], v[88:91], v[192:195]
    ds_read_b128 v[204:207], v237 offset:2048
    s_waitcnt vmcnt(11) lgkmcnt(7)
    v_mfma_f32_16x16x32_bf16 v[176:179], v[216:219], v[92:95], v[176:179]
    ds_read_b128 v[208:211], v237 offset:3072
    s_waitcnt lgkmcnt(7)
    v_mfma_f32_16x16x32_bf16 v[180:183], v[220:223], v[92:95], v[180:183]
    ds_read_b128 v[212:215], v237 offset:4096
    s_waitcnt lgkmcnt(7)
    v_mfma_f32_16x16x32_bf16 v[184:187], v[224:227], v[92:95], v[184:187]
    ds_read_b128 v[216:219], v237 offset:5120
    buffer_load_dwordx4 v[140:143], v6, s[4:7], s25 offen offset:3072 sc1
    s_add_u32 s25, s25, 4096
    s_waitcnt lgkmcnt(7)
    v_mfma_f32_16x16x32_bf16 v[188:191], v[228:231], v[92:95], v[188:191]
    ds_read_b128 v[220:223], v237 offset:6144
    s_waitcnt lgkmcnt(7)
    v_mfma_f32_16x16x32_bf16 v[192:195], v[232:235], v[92:95], v[192:195]
    ds_read_b128 v[224:227], v237 offset:7168
    s_waitcnt vmcnt(11) lgkmcnt(7)
    v_mfma_f32_16x16x32_bf16 v[176:179], v[196:199], v[96:99], v[176:179]
    ds_read_b128 v[228:231], v237 offset:8192
    s_waitcnt lgkmcnt(7)
    v_mfma_f32_16x16x32_bf16 v[180:183], v[200:203], v[96:99], v[180:183]
    ds_read_b128 v[232:235], v237 offset:9216
    s_waitcnt lgkmcnt(7)
    v_mfma_f32_16x16x32_bf16 v[184:187], v[204:207], v[96:99], v[184:187]
    ds_read_b128 v[196:199], v237 offset:10240
    buffer_load_dwordx4 v[144:147], v6, s[4:7], s25 offen offset:0 sc1
    s_waitcnt lgkmcnt(7)
    v_mfma_f32_16x16x32_bf16 v[188:191], v[208:211], v[96:99], v[188:191]
    ds_read_b128 v[200:203], v237 offset:11264
    s_waitcnt lgkmcnt(7)
    v_mfma_f32_16x16x32_bf16 v[192:195], v[212:215], v[96:99], v[192:195]
    ds_read_b128 v[204:207], v237 offset:12288
    s_waitcnt vmcnt(11) lgkmcnt(7)
    v_mfma_f32_16x16x32_bf16 v[176:179], v[216:219], v[100:103], v[176:179]
    ds_read_b128 v[208:211], v237 offset:13312
    s_waitcnt lgkmcnt(7)
    v_mfma_f32_16x16x32_bf16 v[180:183], v[220:223], v[100:103], v[180:183]
    ds_read_b128 v[212:215], v237 offset:14336
    s_waitcnt lgkmcnt(7)
    v_mfma_f32_16x16x32_bf16 v[184:187], v[224:227], v[100:103], v[184:187]
    ds_read_b128 v[216:219], v237 offset:15360
    buffer_load_dwordx4 v[148:151], v6, s[4:7], s25 offen offset:1024 sc1
    s_waitcnt lgkmcnt(7)
    v_mfma_f32_16x16x32_bf16 v[188:191], v[228:231], v[100:103], v[188:191]
    ds_read_b128 v[220:223], v237 offset:16384
    s_waitcnt lgkmcnt(7)
    v_mfma_f32_16x16x32_bf16 v[192:195], v[232:235], v[100:103], v[192:195]
    ds_read_b128 v[224:227], v237 offset:17408
    s_waitcnt vmcnt(11) lgkmcnt(7)
    v_mfma_f32_16x16x32_bf16 v[176:179], v[196:199], v[104:107], v[176:179]
    ds_read_b128 v[228:231], v237 offset:18432
    s_waitcnt lgkmcnt(7)
    v_mfma_f32_16x16x32_bf16 v[180:183], v[200:203], v[104:107], v[180:183]
    ds_read_b128 v[232:235], v237 offset:19456
    s_waitcnt lgkmcnt(7)
    v_mfma_f32_16x16x32_bf16 v[184:187], v[204:207], v[104:107], v[184:187]
    ds_read_b128 v[196:199], v237 offset:20480
    buffer_load_dwordx4 v[152:155], v6, s[4:7], s25 offen offset:2048 sc1
    s_waitcnt lgkmcnt(7)
    v_mfma_f32_16x16x32_bf16 v[188:191], v[208:211], v[104:107], v[188:191]
    ds_read_b128 v[200:203], v237 offset:21504
    s_waitcnt lgkmcnt(7)
    v_mfma_f32_16x16x32_bf16 v[192:195], v[212:215], v[104:107], v[192:195]
    ds_read_b128 v[204:207], v237 offset:22528
    s_waitcnt vmcnt(11) lgkmcnt(7)
    v_mfma_f32_16x16x32_bf16 v[176:179], v[216:219], v[108:111], v[176:179]
    ds_read_b128 v[208:211], v237 offset:23552
    s_waitcnt lgkmcnt(7)
    v_mfma_f32_16x16x32_bf16 v[180:183], v[220:223], v[108:111], v[180:183]
    ds_read_b128 v[212:215], v237 offset:24576
    s_waitcnt lgkmcnt(7)
    v_mfma_f32_16x16x32_bf16 v[184:187], v[224:227], v[108:111], v[184:187]
    ds_read_b128 v[216:219], v237 offset:25600
    buffer_load_dwordx4 v[156:159], v6, s[4:7], s25 offen offset:3072 sc1
    s_add_u32 s25, s25, 4096
    s_waitcnt lgkmcnt(7)
    v_mfma_f32_16x16x32_bf16 v[188:191], v[228:231], v[108:111], v[188:191]
    ds_read_b128 v[220:223], v237 offset:26624
    s_waitcnt lgkmcnt(7)
    v_mfma_f32_16x16x32_bf16 v[192:195], v[232:235], v[108:111], v[192:195]
    ds_read_b128 v[224:227], v237 offset:27648
    s_waitcnt vmcnt(11) lgkmcnt(7)
    v_mfma_f32_16x16x32_bf16 v[176:179], v[196:199], v[112:115], v[176:179]
    ds_read_b128 v[228:231], v237 offset:28672
    s_waitcnt lgkmcnt(7)
    v_mfma_f32_16x16x32_bf16 v[180:183], v[200:203], v[112:115], v[180:183]
    ds_read_b128 v[232:235], v237 offset:29696
    s_waitcnt lgkmcnt(7)
    v_mfma_f32_16x16x32_bf16 v[184:187], v[204:207], v[112:115], v[184:187]
    ds_read_b128 v[196:199], v237 offset:30720
    buffer_load_dwordx4 v[160:163], v6, s[4:7], s25 offen offset:0 sc1
    s_waitcnt lgkmcnt(7)
    v_mfma_f32_16x16x32_bf16 v[188:191], v[208:211], v[112:115], v[188:191]
    ds_read_b128 v[200:203], v237 offset:31744
    s_waitcnt lgkmcnt(7)
    v_mfma_f32_16x16x32_bf16 v[192:195], v[212:215], v[112:115], v[192:195]
    ds_read_b128 v[204:207], v237 offset:32768
    s_waitcnt vmcnt(11) lgkmcnt(7)
    v_mfma_f32_16x16x32_bf16 v[176:179], v[216:219], v[116:119], v[176:179]
    ds_read_b128 v[208:211], v237 offset:33792
    s_waitcnt lgkmcnt(7)
    v_mfma_f32_16x16x32_bf16 v[180:183], v[220:223], v[116:119], v[180:183]
    ds_read_b128 v[212:215], v237 offset:34816
    s_waitcnt lgkmcnt(7)
    v_mfma_f32_16x16x32_bf16 v[184:187], v[224:227], v[116:119], v[184:187]
    ds_read_b128 v[216:219], v237 offset:35840
    buffer_load_dwordx4 v[164:167], v6, s[4:7], s25 offen offset:1024 sc1
    s_waitcnt lgkmcnt(7)
    v_mfma_f32_16x16x32_bf16 v[188:191], v[228:231], v[116:119], v[188:191]
    ds_read_b128 v[220:223], v237 offset:36864
    s_waitcnt lgkmcnt(7)
    v_mfma_f32_16x16x32_bf16 v[192:195], v[232:235], v[116:119], v[192:195]
    ds_read_b128 v[224:227], v237 offset:37888
    s_waitcnt vmcnt(11) lgkmcnt(7)
    v_mfma_f32_16x16x32_bf16 v[176:179], v[196:199], v[120:123], v[176:179]
    ds_read_b128 v[228:231], v237 offset:38912
    s_waitcnt lgkmcnt(7)
    v_mfma_f32_16x16x32_bf16 v[180:183], v[200:203], v[120:123], v[180:183]
    ds_read_b128 v[232:235], v237 offset:39936
    s_waitcnt lgkmcnt(7)
    v_mfma_f32_16x16x32_bf16 v[184:187], v[204:207], v[120:123], v[184:187]
    ds_read_b128 v[196:199], v237 offset:40960
    buffer_load_dwordx4 v[168:171], v6, s[4:7], s25 offen offset:2048 sc1
    s_waitcnt lgkmcnt(7)
    v_mfma_f32_16x16x32_bf16 v[188:191], v[208:211], v[120:123], v[188:191]
    ds_read_b128 v[200:203], v237 offset:41984
    s_waitcnt lgkmcnt(7)
    v_mfma_f32_16x16x32_bf16 v[192:195], v[212:215], v[120:123], v[192:195]
    ds_read_b128 v[204:207], v237 offset:43008
    s_waitcnt vmcnt(11) lgkmcnt(7)
    v_mfma_f32_16x16x32_bf16 v[176:179], v[216:219], v[124:127], v[176:179]
    ds_read_b128 v[208:211], v237 offset:44032
    s_waitcnt lgkmcnt(7)
    v_mfma_f32_16x16x32_bf16 v[180:183], v[220:223], v[124:127], v[180:183]
    ds_read_b128 v[212:215], v237 offset:45056
    s_waitcnt lgkmcnt(7)
    v_mfma_f32_16x16x32_bf16 v[184:187], v[224:227], v[124:127], v[184:187]
    ds_read_b128 v[216:219], v237 offset:46080
    buffer_load_dwordx4 v[172:175], v6, s[4:7], s25 offen offset:3072 sc1
    s_add_u32 s25, s25, 4096
    s_waitcnt lgkmcnt(7)
    v_mfma_f32_16x16x32_bf16 v[188:191], v[228:231], v[124:127], v[188:191]
    ds_read_b128 v[220:223], v237 offset:47104
    s_waitcnt lgkmcnt(7)
    v_mfma_f32_16x16x32_bf16 v[192:195], v[232:235], v[124:127], v[192:195]
    ds_read_b128 v[224:227], v237 offset:48128
    s_waitcnt vmcnt(11) lgkmcnt(7)
    v_mfma_f32_16x16x32_bf16 v[176:179], v[196:199], v[128:131], v[176:179]
    ds_read_b128 v[228:231], v237 offset:49152
    s_waitcnt lgkmcnt(7)
    v_mfma_f32_16x16x32_bf16 v[180:183], v[200:203], v[128:131], v[180:183]
    ds_read_b128 v[232:235], v237 offset:50176
    s_waitcnt lgkmcnt(7)
    v_mfma_f32_16x16x32_bf16 v[184:187], v[204:207], v[128:131], v[184:187]
    ds_read_b128 v[196:199], v237 offset:51200
    s_waitcnt lgkmcnt(7)
    v_mfma_f32_16x16x32_bf16 v[188:191], v[208:211], v[128:131], v[188:191]
    ds_read_b128 v[200:203], v237 offset:52224
    s_waitcnt lgkmcnt(7)
    v_mfma_f32_16x16x32_bf16 v[192:195], v[212:215], v[128:131], v[192:195]
    ds_read_b128 v[204:207], v237 offset:53248
    s_waitcnt vmcnt(10) lgkmcnt(7)
    v_mfma_f32_16x16x32_bf16 v[176:179], v[216:219], v[132:135], v[176:179]
    ds_read_b128 v[208:211], v237 offset:54272
    s_waitcnt lgkmcnt(7)
    v_mfma_f32_16x16x32_bf16 v[180:183], v[220:223], v[132:135], v[180:183]
    ds_read_b128 v[212:215], v237 offset:55296
    s_waitcnt lgkmcnt(7)
    v_mfma_f32_16x16x32_bf16 v[184:187], v[224:227], v[132:135], v[184:187]
    ds_read_b128 v[216:219], v237 offset:56320
    s_waitcnt lgkmcnt(7)
    v_mfma_f32_16x16x32_bf16 v[188:191], v[228:231], v[132:135], v[188:191]
    ds_read_b128 v[220:223], v237 offset:57344
    s_waitcnt lgkmcnt(7)
    v_mfma_f32_16x16x32_bf16 v[192:195], v[232:235], v[132:135], v[192:195]
    ds_read_b128 v[224:227], v237 offset:58368
    s_waitcnt vmcnt(9) lgkmcnt(7)
    v_mfma_f32_16x16x32_bf16 v[176:179], v[196:199], v[136:139], v[176:179]
    ds_read_b128 v[228:231], v237 offset:59392
    s_waitcnt lgkmcnt(7)
    v_mfma_f32_16x16x32_bf16 v[180:183], v[200:203], v[136:139], v[180:183]
    ds_read_b128 v[232:235], v237 offset:60416
    s_waitcnt lgkmcnt(7)
    v_mfma_f32_16x16x32_bf16 v[184:187], v[204:207], v[136:139], v[184:187]
    ds_read_b128 v[196:199], v238 offset:0
    s_waitcnt lgkmcnt(7)
    v_mfma_f32_16x16x32_bf16 v[188:191], v[208:211], v[136:139], v[188:191]
    ds_read_b128 v[200:203], v238 offset:1024
    s_waitcnt lgkmcnt(7)
    v_mfma_f32_16x16x32_bf16 v[192:195], v[212:215], v[136:139], v[192:195]
    ds_read_b128 v[204:207], v238 offset:2048
    s_waitcnt vmcnt(8) lgkmcnt(7)
    v_mfma_f32_16x16x32_bf16 v[176:179], v[216:219], v[140:143], v[176:179]
    ds_read_b128 v[208:211], v238 offset:3072
    s_waitcnt lgkmcnt(7)
    v_mfma_f32_16x16x32_bf16 v[180:183], v[220:223], v[140:143], v[180:183]
    ds_read_b128 v[212:215], v238 offset:4096
    s_waitcnt lgkmcnt(7)
    v_mfma_f32_16x16x32_bf16 v[184:187], v[224:227], v[140:143], v[184:187]
    ds_read_b128 v[216:219], v238 offset:5120
    s_waitcnt lgkmcnt(7)
    v_mfma_f32_16x16x32_bf16 v[188:191], v[228:231], v[140:143], v[188:191]
    ds_read_b128 v[220:223], v238 offset:6144
    s_waitcnt lgkmcnt(7)
    v_mfma_f32_16x16x32_bf16 v[192:195], v[232:235], v[140:143], v[192:195]
    ds_read_b128 v[224:227], v238 offset:7168
    s_waitcnt vmcnt(7) lgkmcnt(7)
    v_mfma_f32_16x16x32_bf16 v[176:179], v[196:199], v[144:147], v[176:179]
    ds_read_b128 v[228:231], v238 offset:8192
    s_waitcnt lgkmcnt(7)
    v_mfma_f32_16x16x32_bf16 v[180:183], v[200:203], v[144:147], v[180:183]
    ds_read_b128 v[232:235], v238 offset:9216
    s_waitcnt lgkmcnt(7)
    v_mfma_f32_16x16x32_bf16 v[184:187], v[204:207], v[144:147], v[184:187]
    ds_read_b128 v[196:199], v238 offset:10240
    s_waitcnt lgkmcnt(7)
    v_mfma_f32_16x16x32_bf16 v[188:191], v[208:211], v[144:147], v[188:191]
    ds_read_b128 v[200:203], v238 offset:11264
    s_waitcnt lgkmcnt(7)
    v_mfma_f32_16x16x32_bf16 v[192:195], v[212:215], v[144:147], v[192:195]
    ds_read_b128 v[204:207], v238 offset:12288
    s_waitcnt vmcnt(6) lgkmcnt(7)
    v_mfma_f32_16x16x32_bf16 v[176:179], v[216:219], v[148:151], v[176:179]
    ds_read_b128 v[208:211], v238 offset:13312
    s_waitcnt lgkmcnt(7)
    v_mfma_f32_16x16x32_bf16 v[180:183], v[220:223], v[148:151], v[180:183]
    ds_read_b128 v[212:215], v238 offset:14336
    s_waitcnt lgkmcnt(7)
    v_mfma_f32_16x16x32_bf16 v[184:187], v[224:227], v[148:151], v[184:187]
    ds_read_b128 v[216:219], v238 offset:15360
    s_waitcnt lgkmcnt(7)
    v_mfma_f32_16x16x32_bf16 v[188:191], v[228:231], v[148:151], v[188:191]
    ds_read_b128 v[220:223], v238 offset:16384
    s_waitcnt lgkmcnt(7)
    v_mfma_f32_16x16x32_bf16 v[192:195], v[232:235], v[148:151], v[192:195]
    ds_read_b128 v[224:227], v238 offset:17408
    s_waitcnt vmcnt(5) lgkmcnt(7)
    v_mfma_f32_16x16x32_bf16 v[176:179], v[196:199], v[152:155], v[176:179]
    ds_read_b128 v[228:231], v238 offset:18432
    s_waitcnt lgkmcnt(7)
    v_mfma_f32_16x16x32_bf16 v[180:183], v[200:203], v[152:155], v[180:183]
    ds_read_b128 v[232:235], v238 offset:19456
    s_waitcnt lgkmcnt(7)
    v_mfma_f32_16x16x32_bf16 v[184:187], v[204:207], v[152:155], v[184:187]
    ds_read_b128 v[196:199], v236 offset:0
    s_waitcnt lgkmcnt(7)
    v_mfma_f32_16x16x32_bf16 v[188:191], v[208:211], v[152:155], v[188:191]
    ds_read_b128 v[200:203], v236 offset:1024
    s_waitcnt lgkmcnt(7)
    v_mfma_f32_16x16x32_bf16 v[192:195], v[212:215], v[152:155], v[192:195]
    ds_read_b128 v[204:207], v236 offset:2048
    s_waitcnt vmcnt(4) lgkmcnt(7)
    v_mfma_f32_16x16x32_bf16 v[176:179], v[216:219], v[156:159], v[176:179]
    ds_read_b128 v[208:211], v236 offset:3072
    s_waitcnt lgkmcnt(7)
    v_mfma_f32_16x16x32_bf16 v[180:183], v[220:223], v[156:159], v[180:183]
    ds_read_b128 v[212:215], v236 offset:4096
    s_waitcnt lgkmcnt(7)
    v_mfma_f32_16x16x32_bf16 v[184:187], v[224:227], v[156:159], v[184:187]
    ds_read_b128 v[216:219], v236 offset:5120
    s_waitcnt lgkmcnt(7)
    v_mfma_f32_16x16x32_bf16 v[188:191], v[228:231], v[156:159], v[188:191]
    ds_read_b128 v[220:223], v236 offset:6144
    s_waitcnt lgkmcnt(7)
    v_mfma_f32_16x16x32_bf16 v[192:195], v[232:235], v[156:159], v[192:195]
    ds_read_b128 v[224:227], v236 offset:7168
    s_waitcnt vmcnt(3) lgkmcnt(7)
    v_mfma_f32_16x16x32_bf16 v[176:179], v[196:199], v[160:163], v[176:179]
    ds_read_b128 v[228:231], v236 offset:8192
    s_waitcnt lgkmcnt(7)
    v_mfma_f32_16x16x32_bf16 v[180:183], v[200:203], v[160:163], v[180:183]
    ds_read_b128 v[232:235], v236 offset:9216
    s_waitcnt lgkmcnt(7)
    v_mfma_f32_16x16x32_bf16 v[184:187], v[204:207], v[160:163], v[184:187]
    ds_read_b128 v[196:199], v236 offset:10240
    s_waitcnt lgkmcnt(7)
    v_mfma_f32_16x16x32_bf16 v[188:191], v[208:211], v[160:163], v[188:191]
    ds_read_b128 v[200:203], v236 offset:11264
    s_waitcnt lgkmcnt(7)
    v_mfma_f32_16x16x32_bf16 v[192:195], v[212:215], v[160:163], v[192:195]
    ds_read_b128 v[204:207], v236 offset:12288
    s_waitcnt vmcnt(2) lgkmcnt(7)
    v_mfma_f32_16x16x32_bf16 v[176:179], v[216:219], v[164:167], v[176:179]
    ds_read_b128 v[208:211], v236 offset:13312
    s_waitcnt lgkmcnt(7)
    v_mfma_f32_16x16x32_bf16 v[180:183], v[220:223], v[164:167], v[180:183]
    ds_read_b128 v[212:215], v236 offset:14336
    s_waitcnt lgkmcnt(7)
    v_mfma_f32_16x16x32_bf16 v[184:187], v[224:227], v[164:167], v[184:187]
    ds_read_b128 v[216:219], v236 offset:15360
    s_waitcnt lgkmcnt(7)
    v_mfma_f32_16x16x32_bf16 v[188:191], v[228:231], v[164:167], v[188:191]
    ds_read_b128 v[220:223], v236 offset:16384
    s_waitcnt lgkmcnt(7)
    v_mfma_f32_16x16x32_bf16 v[192:195], v[232:235], v[164:167], v[192:195]
    ds_read_b128 v[224:227], v236 offset:17408
    s_waitcnt vmcnt(1) lgkmcnt(7)
    v_mfma_f32_16x16x32_bf16 v[176:179], v[196:199], v[168:171], v[176:179]
    ds_read_b128 v[228:231], v236 offset:18432
    s_waitcnt lgkmcnt(7)
    v_mfma_f32_16x16x32_bf16 v[180:183], v[200:203], v[168:171], v[180:183]
    ds_read_b128 v[232:235], v236 offset:19456
    s_waitcnt lgkmcnt(7)
    v_mfma_f32_16x16x32_bf16 v[184:187], v[204:207], v[168:171], v[184:187]
    s_waitcnt lgkmcnt(6)
    v_mfma_f32_16x16x32_bf16 v[188:191], v[208:211], v[168:171], v[188:191]
    s_waitcnt lgkmcnt(5)
    v_mfma_f32_16x16x32_bf16 v[192:195], v[212:215], v[168:171], v[192:195]
    s_waitcnt vmcnt(0) lgkmcnt(4)
    v_mfma_f32_16x16x32_bf16 v[176:179], v[216:219], v[172:175], v[176:179]
    s_waitcnt lgkmcnt(3)
    v_mfma_f32_16x16x32_bf16 v[180:183], v[220:223], v[172:175], v[180:183]
    s_waitcnt lgkmcnt(2)
    v_mfma_f32_16x16x32_bf16 v[184:187], v[224:227], v[172:175], v[184:187]
    s_waitcnt lgkmcnt(1)
    v_mfma_f32_16x16x32_bf16 v[188:191], v[228:231], v[172:175], v[188:191]
    s_waitcnt lgkmcnt(0)
    v_mfma_f32_16x16x32_bf16 v[192:195], v[232:235], v[172:175], v[192:195]
    v_lshlrev_b32 v196, 16, v16
    v_and_b32 v200, s3, v16
    v_lshlrev_b32 v197, 16, v17
    v_and_b32 v201, s3, v17
    v_lshlrev_b32 v198, 16, v18
    v_and_b32 v202, s3, v18
    v_lshlrev_b32 v199, 16, v19
    v_and_b32 v203, s3, v19
    v_fmac_f32 v196, v44, v176
    v_fmac_f32 v200, v45, v180
    v_fmac_f32 v197, v46, v177
    v_fmac_f32 v201, v47, v181
    v_fmac_f32 v198, v48, v178
    v_fmac_f32 v202, v49, v182
    v_fmac_f32 v199, v50, v179
    v_fmac_f32 v203, v51, v183
    v_cvt_pk_bf16_f32 v16, v196, v200
    v_cvt_pk_bf16_f32 v17, v197, v201
    v_cvt_pk_bf16_f32 v18, v198, v202
    v_cvt_pk_bf16_f32 v19, v199, v203
    buffer_store_dwordx4 v[16:19], v239, s[16:19], s34 offen offset:0
    v_lshlrev_b32 v196, 16, v20
    v_and_b32 v200, s3, v20
    v_lshlrev_b32 v197, 16, v21
    v_and_b32 v201, s3, v21
    v_lshlrev_b32 v198, 16, v22
    v_and_b32 v202, s3, v22
    v_lshlrev_b32 v199, 16, v23
    v_and_b32 v203, s3, v23
    v_fmac_f32 v196, v52, v184
    v_fmac_f32 v200, v53, v188
    v_fmac_f32 v197, v54, v185
    v_fmac_f32 v201, v55, v189
    v_fmac_f32 v198, v56, v186
    v_fmac_f32 v202, v57, v190
    v_fmac_f32 v199, v58, v187
    v_fmac_f32 v203, v59, v191
    v_cvt_pk_bf16_f32 v20, v196, v200
    v_cvt_pk_bf16_f32 v21, v197, v201
    v_cvt_pk_bf16_f32 v22, v198, v202
    v_cvt_pk_bf16_f32 v23, v199, v203
    buffer_store_dwordx4 v[20:23], v239, s[16:19], s34 offen offset:64
    v_lshlrev_b32 v196, 16, v24
    v_and_b32 v197, s3, v24
    v_lshlrev_b32 v198, 16, v25
    v_and_b32 v199, s3, v25
    v_fmac_f32 v196, v60, v192
    v_fmac_f32 v197, v61, v193
    v_fmac_f32 v198, v62, v194
    v_fmac_f32 v199, v63, v195
    v_cvt_pk_bf16_f32 v24, v196, v197
    v_cvt_pk_bf16_f32 v25, v198, v199
    buffer_store_dwordx2 v[24:25], v4, s[16:19], s34 offen offset:128
L_kb_end_1:
    s_endpgm
kb_code_end:
.section .rodata,"a"
.p2align 6
.amdhsa_kernel ka_kernel
  .amdhsa_next_free_vgpr 245
  .amdhsa_next_free_sgpr 92
  .amdhsa_accum_offset 248
  .amdhsa_group_segment_fixed_size 0
  .amdhsa_kernarg_size 128
  .amdhsa_user_sgpr_count 2
  .amdhsa_user_sgpr_kernarg_segment_ptr 1
  .amdhsa_system_sgpr_workgroup_id_x 1
  .amdhsa_float_denorm_mode_32 3
.end_amdhsa_kernel
.p2align 6
.amdhsa_kernel kb_kernel
  .amdhsa_next_free_vgpr 504
  .amdhsa_next_free_sgpr 46
  .amdhsa_accum_offset 248
  .amdhsa_group_segment_fixed_size 0
  .amdhsa_kernarg_size 128
  .amdhsa_user_sgpr_count 2
  .amdhsa_user_sgpr_kernarg_segment_ptr 1
  .amdhsa_system_sgpr_workgroup_id_x 1
  .amdhsa_float_denorm_mode_32 3
.end_amdhsa_kernel
```

```asm
; @launch grid=(256,1,1) block=(256,1,1) lds=163840
.amdgcn_target "amdgcn-amd-amdhsa--gfx950"
.text
.globl adaLN_cond__ssm_conv_h3__mixer_gmlp__prompt_kernel
.p2align 8
.type adaLN_cond__ssm_conv_h3__mixer_gmlp__prompt_kernel,@function
adaLN_cond__ssm_conv_h3__mixer_gmlp__prompt_kernel:
    s_cmp_ge_u32 s2, 256
    s_cbranch_scc1 L_adaL_end_1
    s_load_dwordx2 s[4:5], s[0:1], 120
    s_mov_b32 s6, 33554432
    s_mov_b32 s7, 0x20000
    s_load_dwordx2 s[44:45], s[0:1], 112
    s_mov_b32 s46, 256
    s_mov_b32 s47, 0x20000
    s_load_dwordx2 s[32:33], s[0:1], 64
    s_mov_b32 s34, 8388608
    s_mov_b32 s35, 0x20000
    s_mov_b32 s3, 0xffff0000
    s_cmp_ge_u32 s2, 160
    s_cbranch_scc1 L_adaL_aux_2
    s_load_dwordx2 s[8:9], s[0:1], 8
    s_mov_b32 s10, 2621440
    s_mov_b32 s11, 0x20000
    s_load_dwordx2 s[12:13], s[0:1], 16
    s_mov_b32 s14, 2621440
    s_mov_b32 s15, 0x20000
    s_load_dwordx2 s[20:21], s[0:1], 24
    s_mov_b32 s22, 5120
    s_mov_b32 s23, 0x20000
    s_load_dwordx2 s[16:17], s[0:1], 0
    s_mov_b32 s18, 2621440
    s_mov_b32 s19, 0x20000
    s_load_dwordx2 s[24:25], s[0:1], 32
    s_mov_b32 s26, 2621440
    s_mov_b32 s27, 0x20000
    s_load_dwordx2 s[28:29], s[0:1], 40
    s_mov_b32 s30, 1280
    s_mov_b32 s31, 0x20000
    s_load_dwordx2 s[36:37], s[0:1], 80
    s_mov_b32 s38, 1105920
    s_mov_b32 s39, 0x20000
    s_lshr_b32 s52, s2, 4
    s_and_b32 s53, s2, 15
    v_and_b32 v49, 31, v0
    v_lshrrev_b32 v3, 5, v0
    s_mul_i32 s60, s53, 163840
    s_lshl_b32 s61, s52, 7
    s_add_u32 s64, s60, s61
    v_mul_u32_u24 v46, 20480, v3
    v_lshl_add_u32 v46, v49, 2, v46
    s_sub_u32 s60, s64, 3840
    v_add_u32 v47, s60, v46
    s_lshl_b32 s61, s52, 9
    v_lshl_add_u32 v48, v49, 4, s61
    s_add_u32 s65, s64, 5120
    s_add_u32 s66, s64, 10240
    s_add_u32 s67, s64, 15360
    s_waitcnt lgkmcnt(0)
    buffer_load_dword v55, v46, s[8:11], s64 offen offset:0
    buffer_load_dword v56, v46, s[8:11], s64 offen offset:1280
    buffer_load_dword v57, v46, s[8:11], s64 offen offset:2560
    buffer_load_dword v58, v46, s[8:11], s64 offen offset:3840
    buffer_load_dword v59, v46, s[8:11], s65 offen offset:0
    buffer_load_dword v60, v46, s[8:11], s65 offen offset:1280
    buffer_load_dword v61, v46, s[8:11], s65 offen offset:2560
    buffer_load_dword v62, v46, s[8:11], s65 offen offset:3840
    buffer_load_dword v52, v47, s[8:11], 0 offen offset:0
    buffer_load_dword v53, v47, s[8:11], 0 offen offset:1280
    buffer_load_dword v54, v47, s[8:11], 0 offen offset:2560
    buffer_load_dwordx4 v[88:91], v48, s[20:23], 0 offen
    buffer_load_dword v72, v46, s[12:15], s64 offen offset:0
    buffer_load_dword v73, v46, s[12:15], s64 offen offset:1280
    buffer_load_dword v74, v46, s[12:15], s64 offen offset:2560
    buffer_load_dword v75, v46, s[12:15], s64 offen offset:3840
    buffer_load_dword v76, v46, s[12:15], s65 offen offset:0
    buffer_load_dword v77, v46, s[12:15], s65 offen offset:1280
    buffer_load_dword v78, v46, s[12:15], s65 offen offset:2560
    buffer_load_dword v79, v46, s[12:15], s65 offen offset:3840
    buffer_load_dword v63, v46, s[8:11], s66 offen offset:0
    buffer_load_dword v64, v46, s[8:11], s66 offen offset:1280
    buffer_load_dword v65, v46, s[8:11], s66 offen offset:2560
    buffer_load_dword v66, v46, s[8:11], s66 offen offset:3840
    buffer_load_dword v67, v46, s[8:11], s67 offen offset:0
    buffer_load_dword v68, v46, s[8:11], s67 offen offset:1280
    buffer_load_dword v69, v46, s[8:11], s67 offen offset:2560
    buffer_load_dword v70, v46, s[8:11], s67 offen offset:3840
    buffer_load_dword v80, v46, s[12:15], s66 offen offset:0
    buffer_load_dword v81, v46, s[12:15], s66 offen offset:1280
    buffer_load_dword v82, v46, s[12:15], s66 offen offset:2560
    buffer_load_dword v83, v46, s[12:15], s66 offen offset:3840
    buffer_load_dword v84, v46, s[12:15], s67 offen offset:0
    buffer_load_dword v85, v46, s[12:15], s67 offen offset:1280
    buffer_load_dword v86, v46, s[12:15], s67 offen offset:2560
    buffer_load_dword v87, v46, s[12:15], s67 offen offset:3840
    v_mul_u32_u24 v124, 528, v49
    v_lshl_add_u32 v124, v3, 4, v124
    v_add_u32 v124, 132096, v124
    v_mul_u32_u24 v125, 528, v3
    v_lshl_add_u32 v125, v49, 4, v125
    v_add_u32 v125, 132096, v125
    v_lshrrev_b32 v2, 6, v0
    s_nop 0
    v_readfirstlane_b32 s54, v2
    v_and_b32 v1, 63, v0
    s_lshl_b32 s55, s2, 2
    s_add_u32 s55, s55, s54
    s_lshl_b32 s60, s55, 12
    v_lshl_add_u32 v4, v1, 4, s60
    v_and_b32 v44, 7, v0
    v_lshrrev_b32 v45, 3, v0
    v_mul_u32_u24 v46, 5120, v45
    v_lshl_add_u32 v46, v44, 4, v46
    v_add_u32 v46, s64, v46
    s_lshl_b32 s55, s55, 1
    buffer_load_dwordx4 v[96:99], v4, s[24:27], 0 offen offset:0
    buffer_load_dwordx4 v[104:107], v4, s[24:27], 0 offen offset:1024
    buffer_load_dwordx4 v[112:115], v4, s[24:27], 0 offen offset:2048
    buffer_load_dwordx4 v[120:123], v4, s[24:27], 0 offen offset:3072
    buffer_load_ushort v5, off, s[28:31], s55
    s_mul_i32 s60, s54, 2176
    s_add_u32 s60, s60, 150528
    v_mul_u32_u24 v24, 272, v44
    v_and_b32 v2, 7, v45
    v_lshl_add_u32 v24, v2, 4, v24
    v_add_u32 v24, s60, v24
    v_lshrrev_b32 v2, 4, v1
    v_and_b32 v3, 15, v1
    v_mul_u32_u24 v25, 272, v2
    v_lshl_add_u32 v25, v3, 4, v25
    v_add_u32 v25, s60, v25
    v_lshlrev_b32 v26, 15, v2
    v_lshl_add_u32 v26, v3, 4, v26
    v_lshlrev_b32 v126, 11, v45
    v_lshl_add_u32 v126, v44, 4, v126
    s_lshl_b32 s60, s52, 18
    s_lshl_b32 s61, s53, 7
    s_add_u32 s64, s60, s61
    s_add_u32 s64, s64, 1048576
    s_lshl_b32 s61, s53, 10
    s_add_u32 s68, s60, s61
    s_lshl_b32 s61, s54, 8
    s_add_u32 s68, s68, s61
    s_add_u32 s68, s68, 3670016
    s_add_u32 s65, s64, 65536
    s_add_u32 s69, s68, 131072
    s_add_u32 s66, s64, 131072
    s_add_u32 s70, s68, 16384
    s_add_u32 s67, s64, 196608
    s_add_u32 s71, s68, 147456
    s_mul_i32 s56, s54, 33024
    s_mul_i32 s57, s54, 4608
    s_add_u32 s57, s57, 132096
    v_lshrrev_b32 v127, 4, v1
    v_bfe_u32 v2, v1, 3, 1
    v_bfe_u32 v3, v1, 2, 1
    v_xor_b32 v3, v2, v3
    v_and_b32 v128, 3, v1
    v_lshl_add_u32 v128, v128, 1, v2
    v_mul_u32_u24 v6, 4128, v128
    v_lshl_add_u32 v6, v3, 4, v6
    v_lshl_add_u32 v128, v3, 3, v128
    v_and_b32 v2, 1, v127
    v_lshrrev_b32 v3, 1, v127
    v_lshl_add_u32 v129, v2, 1, v3
    v_mul_u32_u24 v7, 2304, v3
    v_and_b32 v3, 15, v1
    v_add_u32 v2, v2, v3
    v_lshl_add_u32 v7, v2, 4, v7
    s_add_u32 s61, s57, 16
    v_add_u32 v7, s61, v7
    v_sub_u32 v2, 3, v129
    v_lshl_add_u32 v6, v2, 4, v6
    v_add_u32 v6, s56, v6
    v_lshlrev_b32 v131, 3, v129
    v_sub_u32 v131, v131, v128
    v_subrev_u32 v131, 9, v131
    v_bfe_u32 v2, v1, 5, 1
    v_bfe_u32 v3, v1, 4, 1
    v_xor_b32 v3, v2, v3
    v_lshl_add_u32 v8, v2, 2, v3
    v_and_b32 v2, 1, v1
    v_lshl_add_u32 v8, v2, 1, v8
    v_bfe_u32 v2, v1, 1, 1
    v_and_b32 v3, 4, v1
    v_or_b32 v2, v2, v3
    v_xor_b32 v8, v2, v8
    v_bfe_u32 v2, v1, 1, 3
    v_lshl_add_u32 v8, v2, 3, v8
    v_lshl_add_u32 v8, v8, 4, s56
    v_lshl_add_u32 v130, v1, 4, s56
    v_lshlrev_b32 v9, 4, v0
    v_mul_u32_u24 v132, 2304, v127
    v_and_b32 v3, 15, v1
    v_lshl_add_u32 v132, v3, 4, v132
    v_add_u32 v132, s57, v132
    s_lshl_b32 s58, s2, 9
    s_add_u32 s58, s58, 786432
    v_lshlrev_b32 v10, 5, v3
    s_lshl_b32 s60, s52, 8
    s_add_u32 s60, s60, s53
    s_lshl_b32 s60, s60, 5
    s_add_u32 s63, s60, 786432
    s_cmp_lg_u32 s54, 0
    s_cselect_b32 s63, 33554432, s63
    v_lshlrev_b32 v27, 9, v1
    v_and_b32 v3, 7, v1
    v_mul_u32_u24 v3, 4128, v3
    v_add_u32 v3, s56, v3
    v_cmp_lt_u32 vcc, 31, v1
    s_nop 1
    v_cndmask_b32 v132, v132, v3, vcc
    s_waitcnt vmcnt(40)
    v_lshlrev_b32 v148, 16, v55
    v_and_b32 v149, s3, v55
    buffer_load_dwordx2 v[12:13], off, s[44:47], 0 sc1
    s_waitcnt vmcnt(40)
    v_lshlrev_b32 v150, 16, v56
    v_and_b32 v151, s3, v56
    s_waitcnt vmcnt(39)
    v_lshlrev_b32 v152, 16, v57
    v_and_b32 v153, s3, v57
    s_waitcnt vmcnt(38)
    v_lshlrev_b32 v154, 16, v58
    v_and_b32 v155, s3, v58
    s_waitcnt vmcnt(37)
    v_lshlrev_b32 v156, 16, v59
    v_and_b32 v157, s3, v59
    s_waitcnt vmcnt(36)
    v_lshlrev_b32 v158, 16, v60
    v_and_b32 v159, s3, v60
    s_waitcnt vmcnt(35)
    v_lshlrev_b32 v160, 16, v61
    v_and_b32 v161, s3, v61
    s_waitcnt vmcnt(34)
    v_lshlrev_b32 v162, 16, v62
    v_and_b32 v163, s3, v62
    s_waitcnt vmcnt(33)
    v_lshlrev_b32 v142, 16, v52
    v_and_b32 v143, s3, v52
    s_waitcnt vmcnt(32)
    v_lshlrev_b32 v144, 16, v53
    v_and_b32 v145, s3, v53
    s_waitcnt vmcnt(31)
    v_lshlrev_b32 v146, 16, v54
    v_and_b32 v147, s3, v54
    s_waitcnt vmcnt(30)
    v_lshlrev_b32 v134, 16, v88
    v_and_b32 v136, s3, v88
    v_lshlrev_b32 v138, 16, v89
    v_and_b32 v140, s3, v89
    v_lshlrev_b32 v135, 16, v90
    v_and_b32 v137, s3, v90
    v_lshlrev_b32 v139, 16, v91
    v_and_b32 v141, s3, v91
    v_pk_mul_f32 v[196:197], v[142:143], v[140:141]
    v_pk_mul_f32 v[198:199], v[144:145], v[140:141]
    v_pk_mul_f32 v[200:201], v[146:147], v[140:141]
    v_pk_mul_f32 v[202:203], v[148:149], v[140:141]
    v_pk_mul_f32 v[204:205], v[150:151], v[140:141]
    v_pk_mul_f32 v[206:207], v[152:153], v[140:141]
    v_pk_mul_f32 v[208:209], v[154:155], v[140:141]
    v_pk_mul_f32 v[210:211], v[156:157], v[140:141]
    v_pk_fma_f32 v[196:197], v[144:145], v[138:139], v[196:197]
    v_pk_fma_f32 v[198:199], v[146:147], v[138:139], v[198:199]
    v_pk_fma_f32 v[200:201], v[148:149], v[138:139], v[200:201]
    v_pk_fma_f32 v[202:203], v[150:151], v[138:139], v[202:203]
    v_pk_fma_f32 v[204:205], v[152:153], v[138:139], v[204:205]
    v_pk_fma_f32 v[206:207], v[154:155], v[138:139], v[206:207]
    v_pk_fma_f32 v[208:209], v[156:157], v[138:139], v[208:209]
    v_pk_fma_f32 v[210:211], v[158:159], v[138:139], v[210:211]
    v_pk_fma_f32 v[196:197], v[146:147], v[136:137], v[196:197]
    v_pk_fma_f32 v[198:199], v[148:149], v[136:137], v[198:199]
    v_pk_fma_f32 v[200:201], v[150:151], v[136:137], v[200:201]
    v_pk_fma_f32 v[202:203], v[152:153], v[136:137], v[202:203]
    v_pk_fma_f32 v[204:205], v[154:155], v[136:137], v[204:205]
    v_pk_fma_f32 v[206:207], v[156:157], v[136:137], v[206:207]
    v_pk_fma_f32 v[208:209], v[158:159], v[136:137], v[208:209]
    v_pk_fma_f32 v[210:211], v[160:161], v[136:137], v[210:211]
    v_pk_fma_f32 v[196:197], v[148:149], v[134:135], v[196:197]
    v_pk_fma_f32 v[198:199], v[150:151], v[134:135], v[198:199]
    v_pk_fma_f32 v[200:201], v[152:153], v[134:135], v[200:201]
    v_pk_fma_f32 v[202:203], v[154:155], v[134:135], v[202:203]
    v_pk_fma_f32 v[204:205], v[156:157], v[134:135], v[204:205]
    v_pk_fma_f32 v[206:207], v[158:159], v[134:135], v[206:207]
    v_pk_fma_f32 v[208:209], v[160:161], v[134:135], v[208:209]
    v_pk_fma_f32 v[210:211], v[162:163], v[134:135], v[210:211]
    s_waitcnt vmcnt(29)
    v_lshlrev_b32 v180, 16, v72
    v_and_b32 v181, s3, v72
    s_waitcnt vmcnt(28)
    v_lshlrev_b32 v182, 16, v73
    v_and_b32 v183, s3, v73
    s_waitcnt vmcnt(27)
    v_lshlrev_b32 v184, 16, v74
    v_and_b32 v185, s3, v74
    s_waitcnt vmcnt(26)
    v_lshlrev_b32 v186, 16, v75
    v_and_b32 v187, s3, v75
    s_waitcnt vmcnt(25)
    v_lshlrev_b32 v188, 16, v76
    v_and_b32 v189, s3, v76
    s_waitcnt vmcnt(24)
    v_lshlrev_b32 v190, 16, v77
    v_and_b32 v191, s3, v77
    s_waitcnt vmcnt(23)
    v_lshlrev_b32 v192, 16, v78
    v_and_b32 v193, s3, v78
    s_waitcnt vmcnt(22)
    v_lshlrev_b32 v194, 16, v79
    v_and_b32 v195, s3, v79
    v_pk_mul_f32 v[196:197], v[196:197], v[180:181]
    v_pk_mul_f32 v[198:199], v[198:199], v[182:183]
    v_pk_mul_f32 v[200:201], v[200:201], v[184:185]
    v_pk_mul_f32 v[202:203], v[202:203], v[186:187]
    v_pk_mul_f32 v[204:205], v[204:205], v[188:189]
    v_pk_mul_f32 v[206:207], v[206:207], v[190:191]
    v_pk_mul_f32 v[208:209], v[208:209], v[192:193]
    v_pk_mul_f32 v[210:211], v[210:211], v[194:195]
    v_cvt_pk_bf16_f32 v212, v210, v208
    v_cvt_pk_bf16_f32 v213, v206, v204
    v_cvt_pk_bf16_f32 v214, v202, v200
    v_cvt_pk_bf16_f32 v215, v198, v196
    ds_write_b128 v124, v[212:215] offset:0
    v_cvt_pk_bf16_f32 v216, v211, v209
    v_cvt_pk_bf16_f32 v217, v207, v205
    v_cvt_pk_bf16_f32 v218, v203, v201
    v_cvt_pk_bf16_f32 v219, v199, v197
    ds_write_b128 v124, v[216:219] offset:256
    s_waitcnt vmcnt(21)
    v_lshlrev_b32 v164, 16, v63
    v_and_b32 v165, s3, v63
    s_waitcnt vmcnt(20)
    v_lshlrev_b32 v166, 16, v64
    v_and_b32 v167, s3, v64
    s_waitcnt vmcnt(19)
    v_lshlrev_b32 v168, 16, v65
    v_and_b32 v169, s3, v65
    s_waitcnt vmcnt(18)
    v_lshlrev_b32 v170, 16, v66
    v_and_b32 v171, s3, v66
    s_waitcnt vmcnt(17)
    v_lshlrev_b32 v172, 16, v67
    v_and_b32 v173, s3, v67
    s_waitcnt vmcnt(16)
    v_lshlrev_b32 v174, 16, v68
    v_and_b32 v175, s3, v68
    s_waitcnt vmcnt(15)
    v_lshlrev_b32 v176, 16, v69
    v_and_b32 v177, s3, v69
    s_waitcnt vmcnt(14)
    v_lshlrev_b32 v178, 16, v70
    v_and_b32 v179, s3, v70
    v_pk_mul_f32 v[196:197], v[158:159], v[140:141]
    v_pk_mul_f32 v[198:199], v[160:161], v[140:141]
    v_pk_mul_f32 v[200:201], v[162:163], v[140:141]
    v_pk_mul_f32 v[202:203], v[164:165], v[140:141]
    v_pk_mul_f32 v[204:205], v[166:167], v[140:141]
    v_pk_mul_f32 v[206:207], v[168:169], v[140:141]
    v_pk_mul_f32 v[208:209], v[170:171], v[140:141]
    v_pk_mul_f32 v[210:211], v[172:173], v[140:141]
    v_pk_fma_f32 v[196:197], v[160:161], v[138:139], v[196:197]
    v_pk_fma_f32 v[198:199], v[162:163], v[138:139], v[198:199]
    v_pk_fma_f32 v[200:201], v[164:165], v[138:139], v[200:201]
    v_pk_fma_f32 v[202:203], v[166:167], v[138:139], v[202:203]
    v_pk_fma_f32 v[204:205], v[168:169], v[138:139], v[204:205]
    v_pk_fma_f32 v[206:207], v[170:171], v[138:139], v[206:207]
    v_pk_fma_f32 v[208:209], v[172:173], v[138:139], v[208:209]
    v_pk_fma_f32 v[210:211], v[174:175], v[138:139], v[210:211]
    v_pk_fma_f32 v[196:197], v[162:163], v[136:137], v[196:197]
    v_pk_fma_f32 v[198:199], v[164:165], v[136:137], v[198:199]
    v_pk_fma_f32 v[200:201], v[166:167], v[136:137], v[200:201]
    v_pk_fma_f32 v[202:203], v[168:169], v[136:137], v[202:203]
    v_pk_fma_f32 v[204:205], v[170:171], v[136:137], v[204:205]
    v_pk_fma_f32 v[206:207], v[172:173], v[136:137], v[206:207]
    v_pk_fma_f32 v[208:209], v[174:175], v[136:137], v[208:209]
    v_pk_fma_f32 v[210:211], v[176:177], v[136:137], v[210:211]
    v_pk_fma_f32 v[196:197], v[164:165], v[134:135], v[196:197]
    v_pk_fma_f32 v[198:199], v[166:167], v[134:135], v[198:199]
    v_pk_fma_f32 v[200:201], v[168:169], v[134:135], v[200:201]
    v_pk_fma_f32 v[202:203], v[170:171], v[134:135], v[202:203]
    v_pk_fma_f32 v[204:205], v[172:173], v[134:135], v[204:205]
    v_pk_fma_f32 v[206:207], v[174:175], v[134:135], v[206:207]
    v_pk_fma_f32 v[208:209], v[176:177], v[134:135], v[208:209]
    v_pk_fma_f32 v[210:211], v[178:179], v[134:135], v[210:211]
    s_waitcnt vmcnt(13)
    v_lshlrev_b32 v180, 16, v80
    v_and_b32 v181, s3, v80
    s_waitcnt vmcnt(12)
    v_lshlrev_b32 v182, 16, v81
    v_and_b32 v183, s3, v81
    s_waitcnt vmcnt(11)
    v_lshlrev_b32 v184, 16, v82
    v_and_b32 v185, s3, v82
    s_waitcnt vmcnt(10)
    v_lshlrev_b32 v186, 16, v83
    v_and_b32 v187, s3, v83
    s_waitcnt vmcnt(9)
    v_lshlrev_b32 v188, 16, v84
    v_and_b32 v189, s3, v84
    s_waitcnt vmcnt(8)
    v_lshlrev_b32 v190, 16, v85
    v_and_b32 v191, s3, v85
    s_waitcnt vmcnt(7)
    v_lshlrev_b32 v192, 16, v86
    v_and_b32 v193, s3, v86
    s_waitcnt vmcnt(6)
    v_lshlrev_b32 v194, 16, v87
    v_and_b32 v195, s3, v87
    v_pk_mul_f32 v[196:197], v[196:197], v[180:181]
    v_pk_mul_f32 v[198:199], v[198:199], v[182:183]
    v_pk_mul_f32 v[200:201], v[200:201], v[184:185]
    v_pk_mul_f32 v[202:203], v[202:203], v[186:187]
    v_pk_mul_f32 v[204:205], v[204:205], v[188:189]
    v_pk_mul_f32 v[206:207], v[206:207], v[190:191]
    v_pk_mul_f32 v[208:209], v[208:209], v[192:193]
    v_pk_mul_f32 v[210:211], v[210:211], v[194:195]
    v_cvt_pk_bf16_f32 v212, v210, v208
    v_cvt_pk_bf16_f32 v213, v206, v204
    v_cvt_pk_bf16_f32 v214, v202, v200
    v_cvt_pk_bf16_f32 v215, v198, v196
    ds_write_b128 v124, v[212:215] offset:128
    v_cvt_pk_bf16_f32 v216, v211, v209
    v_cvt_pk_bf16_f32 v217, v207, v205
    v_cvt_pk_bf16_f32 v218, v203, v201
    v_cvt_pk_bf16_f32 v219, v199, v197
    ds_write_b128 v124, v[216:219] offset:384
    s_waitcnt lgkmcnt(0)
    s_barrier
    ds_read_b128 v[52:55], v125 offset:0
    ds_read_b128 v[56:59], v125 offset:4224
    ds_read_b128 v[60:63], v125 offset:8448
    ds_read_b128 v[64:67], v125 offset:12672
    s_waitcnt lgkmcnt(3)
    buffer_store_dwordx4 v[52:55], v126, s[4:7], s64 offen sc1
    s_waitcnt lgkmcnt(2)
    buffer_store_dwordx4 v[56:59], v126, s[4:7], s65 offen sc1
    s_waitcnt lgkmcnt(1)
    buffer_store_dwordx4 v[60:63], v126, s[4:7], s66 offen sc1
    s_waitcnt lgkmcnt(0)
    buffer_store_dwordx4 v[64:67], v126, s[4:7], s67 offen sc1
    s_mov_b32 s49, 65536
L_adaL_tagpoll_4:
    s_waitcnt vmcnt(4)
    v_readfirstlane_b32 s48, v12
    s_nop 0
    s_cmp_lg_u32 s48, 0
    s_cbranch_scc1 L_adaL_taggot_5
    buffer_load_dwordx2 v[12:13], off, s[44:47], 0 sc1
    s_waitcnt vmcnt(0)
    s_sub_u32 s49, s49, 1
    s_cmp_lg_u32 s49, 0
    s_cbranch_scc1 L_adaL_tagpoll_4
L_adaL_taggot_5:
    ds_write_b128 v130, v[96:99] offset:28912
    v_mov_b32 v92, 0
    v_mov_b32 v93, 0
    v_mov_b32 v94, 0
    v_mov_b32 v95, 0
    v_mov_b32_dpp v92, v96 wave_shr:1 row_mask:0xf bank_mask:0xf
    v_mov_b32_dpp v93, v97 wave_shr:1 row_mask:0xf bank_mask:0xf
    v_mov_b32_dpp v94, v98 wave_shr:1 row_mask:0xf bank_mask:0xf
    v_mov_b32_dpp v95, v99 wave_shr:1 row_mask:0xf bank_mask:0xf
    ds_write_b128 v130, v[94:97] offset:12400
    v_alignbit_b32 v134, v93, v92, 16
    v_alignbit_b32 v135, v94, v93, 16
    v_alignbit_b32 v136, v95, v94, 16
    v_alignbit_b32 v137, v96, v95, 16
    v_alignbit_b32 v138, v97, v96, 16
    v_alignbit_b32 v139, v98, v97, 16
    ds_write_b128 v130, v[134:137] offset:16
    v_mov_b32 v148, v93
    v_mov_b32 v149, v94
    v_mov_b32 v150, v95
    v_mov_b32 v151, v96
    v_mov_b32 v152, v97
    v_mov_b32 v153, v98
    ds_write_b128 v130, v[136:139] offset:16528
    ds_write_b128 v130, v[148:151] offset:4144
    v_alignbit_b32 v142, v94, v93, 16
    v_alignbit_b32 v143, v95, v94, 16
    v_alignbit_b32 v144, v96, v95, 16
    v_alignbit_b32 v145, v97, v96, 16
    v_alignbit_b32 v146, v98, v97, 16
    v_alignbit_b32 v147, v99, v98, 16
    ds_write_b128 v130, v[150:153] offset:20656
    ds_write_b128 v130, v[142:145] offset:8272
    ds_write_b128 v130, v[144:147] offset:24784
    s_waitcnt vmcnt(0)
    s_barrier
    s_mov_b64 exec, 65535
    buffer_store_dword v12, v27, s[4:7], s63 offen sc1
    s_mov_b64 exec, -1
    buffer_load_dwordx4 v[28:31], v46, s[16:19], 0 offen offset:0
    buffer_load_dwordx4 v[32:35], v46, s[16:19], 0 offen offset:1280
    buffer_load_dwordx4 v[36:39], v46, s[16:19], 0 offen offset:2560
    buffer_load_dwordx4 v[40:43], v46, s[16:19], 0 offen offset:3840
    ds_write_b128 v130, v[104:107] offset:29936
    v_mov_b32_dpp v100, v96 wave_ror:1 row_mask:0xf bank_mask:0xf
    v_mov_b32_dpp v101, v97 wave_ror:1 row_mask:0xf bank_mask:0xf
    v_mov_b32_dpp v102, v98 wave_ror:1 row_mask:0xf bank_mask:0xf
    v_mov_b32_dpp v103, v99 wave_ror:1 row_mask:0xf bank_mask:0xf
    v_mov_b32_dpp v100, v104 wave_shr:1 row_mask:0xf bank_mask:0xf
    v_mov_b32_dpp v101, v105 wave_shr:1 row_mask:0xf bank_mask:0xf
    v_mov_b32_dpp v102, v106 wave_shr:1 row_mask:0xf bank_mask:0xf
    v_mov_b32_dpp v103, v107 wave_shr:1 row_mask:0xf bank_mask:0xf
    ds_write_b128 v130, v[102:105] offset:13424
    v_alignbit_b32 v134, v101, v100, 16
    v_alignbit_b32 v135, v102, v101, 16
    v_alignbit_b32 v136, v103, v102, 16
    v_alignbit_b32 v137, v104, v103, 16
    v_alignbit_b32 v138, v105, v104, 16
    v_alignbit_b32 v139, v106, v105, 16
    ds_write_b128 v130, v[134:137] offset:1040
    v_mov_b32 v148, v101
    v_mov_b32 v149, v102
    v_mov_b32 v150, v103
    v_mov_b32 v151, v104
    v_mov_b32 v152, v105
    v_mov_b32 v153, v106
    ds_write_b128 v130, v[136:139] offset:17552
    ds_write_b128 v130, v[148:151] offset:5168
    v_alignbit_b32 v142, v102, v101, 16
    v_alignbit_b32 v143, v103, v102, 16
    v_alignbit_b32 v144, v104, v103, 16
    v_alignbit_b32 v145, v105, v104, 16
    v_alignbit_b32 v146, v106, v105, 16
    v_alignbit_b32 v147, v107, v106, 16
    ds_write_b128 v130, v[150:153] offset:21680
    ds_write_b128 v130, v[142:145] offset:9296
    ds_write_b128 v130, v[144:147] offset:25808
    ds_write_b128 v130, v[112:115] offset:30960
    v_mov_b32_dpp v108, v104 wave_ror:1 row_mask:0xf bank_mask:0xf
    v_mov_b32_dpp v109, v105 wave_ror:1 row_mask:0xf bank_mask:0xf
    v_mov_b32_dpp v110, v106 wave_ror:1 row_mask:0xf bank_mask:0xf
    v_mov_b32_dpp v111, v107 wave_ror:1 row_mask:0xf bank_mask:0xf
    v_mov_b32_dpp v108, v112 wave_shr:1 row_mask:0xf bank_mask:0xf
    v_mov_b32_dpp v109, v113 wave_shr:1 row_mask:0xf bank_mask:0xf
    v_mov_b32_dpp v110, v114 wave_shr:1 row_mask:0xf bank_mask:0xf
    v_mov_b32_dpp v111, v115 wave_shr:1 row_mask:0xf bank_mask:0xf
    ds_write_b128 v130, v[110:113] offset:14448
    v_alignbit_b32 v134, v109, v108, 16
    v_alignbit_b32 v135, v110, v109, 16
    v_alignbit_b32 v136, v111, v110, 16
    v_alignbit_b32 v137, v112, v111, 16
    v_alignbit_b32 v138, v113, v112, 16
    v_alignbit_b32 v139, v114, v113, 16
    ds_write_b128 v130, v[134:137] offset:2064
    v_mov_b32 v148, v109
    v_mov_b32 v149, v110
    v_mov_b32 v150, v111
    v_mov_b32 v151, v112
    v_mov_b32 v152, v113
    v_mov_b32 v153, v114
    ds_write_b128 v130, v[136:139] offset:18576
    ds_write_b128 v130, v[148:151] offset:6192
    v_alignbit_b32 v142, v110, v109, 16
    v_alignbit_b32 v143, v111, v110, 16
    v_alignbit_b32 v144, v112, v111, 16
    v_alignbit_b32 v145, v113, v112, 16
    v_alignbit_b32 v146, v114, v113, 16
    v_alignbit_b32 v147, v115, v114, 16
    ds_write_b128 v130, v[150:153] offset:22704
    ds_write_b128 v130, v[142:145] offset:10320
    ds_write_b128 v130, v[144:147] offset:26832
    ds_write_b128 v130, v[120:123] offset:31984
    v_mov_b32_dpp v116, v112 wave_ror:1 row_mask:0xf bank_mask:0xf
    v_mov_b32_dpp v117, v113 wave_ror:1 row_mask:0xf bank_mask:0xf
    v_mov_b32_dpp v118, v114 wave_ror:1 row_mask:0xf bank_mask:0xf
    v_mov_b32_dpp v119, v115 wave_ror:1 row_mask:0xf bank_mask:0xf
    v_mov_b32_dpp v116, v120 wave_shr:1 row_mask:0xf bank_mask:0xf
    v_mov_b32_dpp v117, v121 wave_shr:1 row_mask:0xf bank_mask:0xf
    v_mov_b32_dpp v118, v122 wave_shr:1 row_mask:0xf bank_mask:0xf
    v_mov_b32_dpp v119, v123 wave_shr:1 row_mask:0xf bank_mask:0xf
    ds_write_b128 v130, v[118:121] offset:15472
    v_alignbit_b32 v134, v117, v116, 16
    v_alignbit_b32 v135, v118, v117, 16
    v_alignbit_b32 v136, v119, v118, 16
    v_alignbit_b32 v137, v120, v119, 16
    v_alignbit_b32 v138, v121, v120, 16
    v_alignbit_b32 v139, v122, v121, 16
    ds_write_b128 v130, v[134:137] offset:3088
    v_mov_b32 v148, v117
    v_mov_b32 v149, v118
    v_mov_b32 v150, v119
    v_mov_b32 v151, v120
    v_mov_b32 v152, v121
    v_mov_b32 v153, v122
    ds_write_b128 v130, v[136:139] offset:19600
    ds_write_b128 v130, v[148:151] offset:7216
    v_alignbit_b32 v142, v118, v117, 16
    v_alignbit_b32 v143, v119, v118, 16
    v_alignbit_b32 v144, v120, v119, 16
    v_alignbit_b32 v145, v121, v120, 16
    v_alignbit_b32 v146, v122, v121, 16
    v_alignbit_b32 v147, v123, v122, 16
    ds_write_b128 v130, v[150:153] offset:23728
    ds_write_b128 v130, v[142:145] offset:11344
    ds_write_b128 v130, v[144:147] offset:27856
    buffer_load_dword v14, v10, s[4:7], s58 offen sc1
    v_mov_b32 v180, 0
    v_mov_b32 v181, 0
    v_mov_b32 v182, 0
    v_mov_b32 v183, 0
    ds_write_b128 v132, v[180:183]
    v_and_b32 v3, 1, v131
    v_lshlrev_b32 v3, 4, v3
    v_lshlrev_b32 v5, v3, v5
    v_ashrrev_i32 v131, 1, v131
    v_cmp_eq_u32 vcc, 0, v131
    s_nop 1
    v_cndmask_b32 v20, 0, v5, vcc
    v_cmp_eq_u32 vcc, 1, v131
    s_nop 1
    v_cndmask_b32 v21, 0, v5, vcc
    v_cmp_eq_u32 vcc, 2, v131
    s_nop 1
    v_cndmask_b32 v22, 0, v5, vcc
    v_cmp_eq_u32 vcc, 3, v131
    s_nop 1
    v_cndmask_b32 v23, 0, v5, vcc
    ds_read_b128 v[72:75], v6 offset:3584
    ds_read_b128 v[68:71], v6 offset:3072
    ds_read_b128 v[64:67], v6 offset:2560
    ds_read_b128 v[60:63], v6 offset:2048
    ds_read_b128 v[56:59], v6 offset:1536
    ds_read_b128 v[52:55], v6 offset:1024
    ds_read_b128 v[48:51], v6 offset:512
    ds_read_b128 v[44:47], v6 offset:0
    s_mov_b32 s49, 65536
L_adaL_poll_6:
    s_waitcnt vmcnt(0)
    v_cmp_ne_u32 vcc, s48, v14
    s_nop 0
    s_cbranch_vccz L_adaL_got_7
    buffer_load_dword v14, v10, s[4:7], s58 offen sc1
    s_waitcnt vmcnt(0)
    s_sub_u32 s49, s49, 1
    s_cmp_lg_u32 s49, 0
    s_cbranch_scc1 L_adaL_poll_6
L_adaL_got_7:
    s_mov_b32 s61, 1048576
    s_add_u32 m0, s57, 256
    s_nop 0
    buffer_load_dwordx4 v4, s[4:7], s61 offen offset:0 sc1 lds
    buffer_load_dwordx4 v4, s[4:7], s61 offen offset:1024 sc1 lds
    s_add_u32 m0, s57, 512
    s_nop 0
    buffer_load_dwordx4 v4, s[4:7], s61 offen offset:2048 sc1 lds
    buffer_load_dwordx4 v4, s[4:7], s61 offen offset:3072 sc1 lds
    ds_write2_b64 v24, v[28:29], v[36:37] offset0:0 offset1:1
    ds_write2_b64 v24, v[32:33], v[40:41] offset0:16 offset1:17
    ds_read_b128 v[172:175], v25 offset:0
    ds_read_b128 v[176:179], v25 offset:1088
    ds_write2_b64 v24, v[30:31], v[38:39] offset0:0 offset1:1
    ds_write2_b64 v24, v[34:35], v[42:43] offset0:16 offset1:17
    ds_read_b128 v[180:183], v25 offset:0
    ds_read_b128 v[184:187], v25 offset:1088
    s_waitcnt lgkmcnt(5)
    buffer_store_dwordx4 v[172:175], v26, s[4:7], s68 offen sc1
    s_waitcnt lgkmcnt(4)
    buffer_store_dwordx4 v[176:179], v26, s[4:7], s69 offen sc1
    s_waitcnt lgkmcnt(1)
    buffer_store_dwordx4 v[180:183], v26, s[4:7], s70 offen sc1
    s_waitcnt lgkmcnt(0)
    buffer_store_dwordx4 v[184:187], v26, s[4:7], s71 offen sc1
    s_lshl_b32 s61, s2, 14
    s_add_u32 s68, s61, 3670016
    s_add_u32 s64, s61, 6291456
    s_add_u32 s69, s61, 3674112
    s_add_u32 s65, s61, 6295552
    s_add_u32 s70, s61, 3678208
    s_add_u32 s66, s61, 6299648
    s_add_u32 s71, s61, 3682304
    s_add_u32 s67, s61, 6303744
    s_and_b32 s62, s2, 7
    s_lshl_b32 s63, s2, 2
    s_add_u32 s63, s63, s54
    s_lshl_b32 s63, s63, 2
    s_add_u32 s63, s63, 98304
    v_lshlrev_b32 v24, 12, v1
    s_lshl_b32 s58, s62, 4
    s_add_u32 s58, s58, s52
    s_lshl_b32 s58, s58, 8
    s_add_u32 s58, s58, 98304
    v_lshlrev_b32 v27, 2, v1
    v_bfe_u32 v2, v1, 2, 3
    v_min_u32 v2, 2, v2
    v_mul_u32_u24 v2, 5120, v2
    v_and_b32 v3, 3, v1
    v_lshl_add_u32 v2, v3, 3, v2
    s_lshl_b32 s61, s2, 5
    s_add_u32 s61, s61, 32768
    v_add_u32 v2, s61, v2
    s_lshl_b32 s62, s62, 8
    s_add_u32 s62, s62, 180224
    v_lshl_add_u32 v10, v1, 3, s62
    v_cmp_gt_u32 vcc, 32, v1
    s_nop 1
    v_cndmask_b32 v10, v2, v10, vcc
    v_bfe_u32 v2, v0, 4, 1
    v_bfe_u32 v3, v0, 5, 1
    v_lshl_add_u32 v2, v3, 2, v2
    v_lshlrev_b32 v2, 1, v2
    v_xor_b32 v2, v0, v2
    v_lshlrev_b32 v228, 3, v2
    v_add_u32 v229, 66048, v228
    s_mul_i32 s60, s2, 8192
    s_add_u32 s60, s60, 7077888
    v_lshlrev_b32 v230, 5, v0
    s_waitcnt vmcnt(4)
    ds_read_b128 v[76:79], v7 offset:224
    ds_read_b128 v[80:83], v7 offset:480
    ds_read_b128 v[84:87], v7 offset:736
    ds_read_b128 v[88:91], v7 offset:992
    ds_read_b128 v[92:95], v7 offset:1248
    ds_read_b128 v[96:99], v7 offset:1504
    ds_read_b128 v[100:103], v7 offset:1760
    ds_read_b128 v[104:107], v7 offset:2016
    s_waitcnt lgkmcnt(7)
    v_mfma_f32_16x16x32_bf16 v[140:143], v[20:23], v[76:79], 0
    s_waitcnt lgkmcnt(6)
    v_mfma_f32_16x16x32_bf16 v[144:147], v[20:23], v[80:83], 0
    s_waitcnt lgkmcnt(5)
    v_mfma_f32_16x16x32_bf16 v[148:151], v[20:23], v[84:87], 0
    s_waitcnt lgkmcnt(4)
    v_mfma_f32_16x16x32_bf16 v[152:155], v[20:23], v[88:91], 0
    s_waitcnt lgkmcnt(3)
    v_mfma_f32_16x16x32_bf16 v[156:159], v[20:23], v[92:95], 0
    s_waitcnt lgkmcnt(2)
    v_mfma_f32_16x16x32_bf16 v[160:163], v[20:23], v[96:99], 0
    s_waitcnt lgkmcnt(0)
    v_mfma_f32_16x16x32_bf16 v[164:167], v[20:23], v[100:103], 0
    v_mfma_f32_16x16x32_bf16 v[168:171], v[20:23], v[104:107], 0
    v_mfma_f32_16x16x32_bf16 v[168:171], v[72:75], v[76:79], v[168:171]
    ds_read_b128 v[72:75], v6 offset:3648
    s_mul_i32 s78, s2, 52429
    v_mfma_f32_16x16x32_bf16 v[164:167], v[68:71], v[76:79], v[164:167]
    buffer_load_dword v2, v230, s[32:35], s60 offen
    s_add_u32 s60, s60, 8192
    s_lshr_b32 s78, s78, 18
    v_mfma_f32_16x16x32_bf16 v[168:171], v[68:71], v[80:83], v[168:171]
    ds_read_b128 v[68:71], v6 offset:3136
    s_mul_i32 s79, s78, 43691
    v_mfma_f32_16x16x32_bf16 v[160:163], v[64:67], v[76:79], v[160:163]
    s_lshr_b32 s79, s79, 17
    s_mul_i32 s79, s79, 12
    s_lshl_b32 s80, s78, 5
    v_mfma_f32_16x16x32_bf16 v[164:167], v[64:67], v[80:83], v[164:167]
    ds_read_b128 v[108:111], v7 offset:192
    s_add_u32 s79, s79, s80
    v_mfma_f32_16x16x32_bf16 v[168:171], v[64:67], v[84:87], v[168:171]
    ds_read_b128 v[64:67], v6 offset:2624
    s_lshl_b32 s80, s54, 3
    v_mfma_f32_16x16x32_bf16 v[156:159], v[60:63], v[76:79], v[156:159]
    s_add_u32 s79, s79, s80
    s_mul_i32 s80, s78, 216
    s_and_b32 s81, s54, 1
    v_mfma_f32_16x16x32_bf16 v[160:163], v[60:63], v[80:83], v[160:163]
    s_lshl_b32 s81, s81, 3
    s_add_u32 s80, s80, s81
    s_lshr_b32 s81, s54, 1
    v_mfma_f32_16x16x32_bf16 v[164:167], v[60:63], v[84:87], v[164:167]
    ds_read_b128 v[112:115], v7 offset:448
    s_add_u32 s80, s80, s81
    v_mfma_f32_16x16x32_bf16 v[168:171], v[60:63], v[88:91], v[168:171]
    ds_read_b128 v[60:63], v6 offset:2112
    s_sub_u32 s80, s80, 5088
    v_mfma_f32_16x16x32_bf16 v[152:155], v[56:59], v[76:79], v[152:155]
    s_cmp_ge_u32 s78, 24
    s_cselect_b32 s72, s80, s79
    s_cselect_b32 s73, 129280, 0
    s_cselect_b32 s81, 1280, 0
    v_mfma_f32_16x16x32_bf16 v[156:159], v[56:59], v[80:83], v[156:159]
    s_add_u32 s73, s73, 1280
    s_add_u32 s81, s81, 1280
    s_mul_i32 s72, s72, 1280
    v_mfma_f32_16x16x32_bf16 v[160:163], v[56:59], v[84:87], v[160:163]
    ds_read_b128 v[116:119], v7 offset:704
    s_mul_i32 s79, s78, 5
    v_mfma_f32_16x16x32_bf16 v[164:167], v[56:59], v[88:91], v[164:167]
    s_sub_u32 s79, s2, s79
    s_lshl_b32 s79, s79, 6
    v_add_u32 v196, s79, v1
    v_mfma_f32_16x16x32_bf16 v[168:171], v[56:59], v[92:95], v[168:171]
    ds_read_b128 v[56:59], v6 offset:1600
    v_lshlrev_b32 v197, 2, v196
    v_mfma_f32_16x16x32_bf16 v[148:151], v[52:55], v[76:79], v[148:151]
    buffer_load_dword v200, v197, s[36:39], s72 offen
    s_add_u32 s72, s72, s81
    v_mfma_f32_16x16x32_bf16 v[152:155], v[52:55], v[80:83], v[152:155]
    ds_read_b128 v[120:123], v7 offset:960
    v_mfma_f32_16x16x32_bf16 v[156:159], v[52:55], v[84:87], v[156:159]
    buffer_load_dword v201, v197, s[36:39], s72 offen
    s_add_u32 s72, s72, s81
    v_mfma_f32_16x16x32_bf16 v[160:163], v[52:55], v[88:91], v[160:163]
    buffer_load_dword v202, v197, s[36:39], s72 offen
    s_add_u32 s72, s72, s81
    v_mfma_f32_16x16x32_bf16 v[164:167], v[52:55], v[92:95], v[164:167]
    ds_read_b128 v[124:127], v7 offset:1216
    v_mfma_f32_16x16x32_bf16 v[168:171], v[52:55], v[96:99], v[168:171]
    ds_read_b128 v[52:55], v6 offset:1088
    v_mfma_f32_16x16x32_bf16 v[144:147], v[48:51], v[76:79], v[144:147]
    buffer_load_dword v203, v197, s[36:39], s72 offen
    s_add_u32 s72, s72, s73
    v_mfma_f32_16x16x32_bf16 v[148:151], v[48:51], v[80:83], v[148:151]
    buffer_load_dword v204, v197, s[36:39], s72 offen
    s_add_u32 s72, s72, s81
    v_mfma_f32_16x16x32_bf16 v[152:155], v[48:51], v[84:87], v[152:155]
    ds_read_b128 v[128:131], v7 offset:1472
    v_mfma_f32_16x16x32_bf16 v[156:159], v[48:51], v[88:91], v[156:159]
    buffer_load_dword v205, v197, s[36:39], s72 offen
    s_add_u32 s72, s72, s81
    v_mfma_f32_16x16x32_bf16 v[160:163], v[48:51], v[92:95], v[160:163]
    buffer_load_dword v206, v197, s[36:39], s72 offen
    s_add_u32 s72, s72, s81
    v_mfma_f32_16x16x32_bf16 v[164:167], v[48:51], v[96:99], v[164:167]
    ds_read_b128 v[132:135], v7 offset:1728
    v_mfma_f32_16x16x32_bf16 v[168:171], v[48:51], v[100:103], v[168:171]
    ds_read_b128 v[48:51], v6 offset:576
    v_mfma_f32_16x16x32_bf16 v[140:143], v[44:47], v[76:79], v[140:143]
    buffer_load_dword v207, v197, s[36:39], s72 offen
    v_mfma_f32_16x16x32_bf16 v[144:147], v[44:47], v[80:83], v[144:147]
    v_mfma_f32_16x16x32_bf16 v[148:151], v[44:47], v[84:87], v[148:151]
    ds_read_b128 v[136:139], v7 offset:1984
    v_mfma_f32_16x16x32_bf16 v[152:155], v[44:47], v[88:91], v[152:155]
    v_mfma_f32_16x16x32_bf16 v[156:159], v[44:47], v[92:95], v[156:159]
    v_mfma_f32_16x16x32_bf16 v[160:163], v[44:47], v[96:99], v[160:163]
    v_mfma_f32_16x16x32_bf16 v[164:167], v[44:47], v[100:103], v[164:167]
    v_mfma_f32_16x16x32_bf16 v[168:171], v[44:47], v[104:107], v[168:171]
    ds_read_b128 v[44:47], v6 offset:64
    s_waitcnt vmcnt(9) lgkmcnt(2)
    s_mov_b64 exec, 255
    buffer_store_dword v12, v24, s[4:7], s63 offen sc1
    s_mov_b64 exec, -1
    v_mfma_f32_16x16x32_bf16 v[168:171], v[72:75], v[108:111], v[168:171]
    ds_read_b128 v[72:75], v6 offset:3712
    v_mfma_f32_16x16x32_bf16 v[164:167], v[68:71], v[108:111], v[164:167]
    v_mfma_f32_16x16x32_bf16 v[168:171], v[68:71], v[112:115], v[168:171]
    ds_read_b128 v[68:71], v6 offset:3200
    v_mfma_f32_16x16x32_bf16 v[160:163], v[64:67], v[108:111], v[160:163]
    v_mfma_f32_16x16x32_bf16 v[164:167], v[64:67], v[112:115], v[164:167]
    ds_read_b128 v[76:79], v7 offset:160
    v_mfma_f32_16x16x32_bf16 v[168:171], v[64:67], v[116:119], v[168:171]
    ds_read_b128 v[64:67], v6 offset:2688
    v_mfma_f32_16x16x32_bf16 v[156:159], v[60:63], v[108:111], v[156:159]
    v_mfma_f32_16x16x32_bf16 v[160:163], v[60:63], v[112:115], v[160:163]
    v_mfma_f32_16x16x32_bf16 v[164:167], v[60:63], v[116:119], v[164:167]
    ds_read_b128 v[80:83], v7 offset:416
    v_mfma_f32_16x16x32_bf16 v[168:171], v[60:63], v[120:123], v[168:171]
    ds_read_b128 v[60:63], v6 offset:2176
    v_mfma_f32_16x16x32_bf16 v[152:155], v[56:59], v[108:111], v[152:155]
    v_mfma_f32_16x16x32_bf16 v[156:159], v[56:59], v[112:115], v[156:159]
    v_mfma_f32_16x16x32_bf16 v[160:163], v[56:59], v[116:119], v[160:163]
    ds_read_b128 v[84:87], v7 offset:672
    v_mfma_f32_16x16x32_bf16 v[164:167], v[56:59], v[120:123], v[164:167]
    v_mfma_f32_16x16x32_bf16 v[168:171], v[56:59], v[124:127], v[168:171]
    ds_read_b128 v[56:59], v6 offset:1664
    v_mfma_f32_16x16x32_bf16 v[148:151], v[52:55], v[108:111], v[148:151]
    v_mfma_f32_16x16x32_bf16 v[152:155], v[52:55], v[112:115], v[152:155]
    ds_read_b128 v[88:91], v7 offset:928
    v_mfma_f32_16x16x32_bf16 v[156:159], v[52:55], v[116:119], v[156:159]
    v_mfma_f32_16x16x32_bf16 v[160:163], v[52:55], v[120:123], v[160:163]
    v_mfma_f32_16x16x32_bf16 v[164:167], v[52:55], v[124:127], v[164:167]
    ds_read_b128 v[92:95], v7 offset:1184
    v_mfma_f32_16x16x32_bf16 v[168:171], v[52:55], v[128:131], v[168:171]
    ds_read_b128 v[52:55], v6 offset:1152
    v_mfma_f32_16x16x32_bf16 v[144:147], v[48:51], v[108:111], v[144:147]
    v_mfma_f32_16x16x32_bf16 v[148:151], v[48:51], v[112:115], v[148:151]
    v_mfma_f32_16x16x32_bf16 v[152:155], v[48:51], v[116:119], v[152:155]
    ds_read_b128 v[96:99], v7 offset:1440
    v_mfma_f32_16x16x32_bf16 v[156:159], v[48:51], v[120:123], v[156:159]
    v_mfma_f32_16x16x32_bf16 v[160:163], v[48:51], v[124:127], v[160:163]
    v_mfma_f32_16x16x32_bf16 v[164:167], v[48:51], v[128:131], v[164:167]
    ds_read_b128 v[100:103], v7 offset:1696
    v_mfma_f32_16x16x32_bf16 v[168:171], v[48:51], v[132:135], v[168:171]
    ds_read_b128 v[48:51], v6 offset:640
    s_waitcnt lgkmcnt(3)
    v_mfma_f32_16x16x32_bf16 v[140:143], v[44:47], v[108:111], v[140:143]
    v_mfma_f32_16x16x32_bf16 v[144:147], v[44:47], v[112:115], v[144:147]
    v_mfma_f32_16x16x32_bf16 v[148:151], v[44:47], v[116:119], v[148:151]
    ds_read_b128 v[104:107], v7 offset:1952
    v_mfma_f32_16x16x32_bf16 v[152:155], v[44:47], v[120:123], v[152:155]
    v_mfma_f32_16x16x32_bf16 v[156:159], v[44:47], v[124:127], v[156:159]
    v_mfma_f32_16x16x32_bf16 v[160:163], v[44:47], v[128:131], v[160:163]
    v_mfma_f32_16x16x32_bf16 v[164:167], v[44:47], v[132:135], v[164:167]
    v_mfma_f32_16x16x32_bf16 v[168:171], v[44:47], v[136:139], v[168:171]
    ds_read_b128 v[44:47], v6 offset:128
    v_mfma_f32_16x16x32_bf16 v[168:171], v[72:75], v[76:79], v[168:171]
    ds_read_b128 v[72:75], v6 offset:3776
    v_lshrrev_b32 v240, 6, v0
    v_mfma_f32_16x16x32_bf16 v[164:167], v[68:71], v[76:79], v[164:167]
    v_readfirstlane_b32 s82, v240
    s_bfe_u32 s87, s2, 0x30003
    v_mfma_f32_16x16x32_bf16 v[168:171], v[68:71], v[80:83], v[168:171]
    ds_read_b128 v[68:71], v6 offset:3264
    s_and_b32 s83, s2, 6
    v_mfma_f32_16x16x32_bf16 v[160:163], v[64:67], v[76:79], v[160:163]
    s_lshl_b32 s83, s83, 2
    s_add_u32 s83, s83, s87
    s_lshr_b32 s87, s2, 6
    v_mfma_f32_16x16x32_bf16 v[164:167], v[64:67], v[80:83], v[164:167]
    ds_read_b128 v[108:111], v7 offset:128
    s_and_b32 s84, s2, 1
    v_mfma_f32_16x16x32_bf16 v[168:171], v[64:67], v[84:87], v[168:171]
    ds_read_b128 v[64:67], v6 offset:2752
    s_lshl_b32 s84, s84, 2
    v_mfma_f32_16x16x32_bf16 v[156:159], v[60:63], v[76:79], v[156:159]
    s_add_u32 s84, s84, s87
    v_and_b32 v240, 63, v0
    v_lshlrev_b32 v241, 4, v240
    v_mfma_f32_16x16x32_bf16 v[160:163], v[60:63], v[80:83], v[160:163]
    s_add_u32 s87, s82, 1
    s_lshl_b32 s87, s87, 29
    s_and_b32 s87, s87, 2147483648
    v_mfma_f32_16x16x32_bf16 v[164:167], v[60:63], v[84:87], v[164:167]
    ds_read_b128 v[112:115], v7 offset:384
    s_or_b32 s87, s87, 20480
    v_mfma_f32_16x16x32_bf16 v[168:171], v[60:63], v[88:91], v[168:171]
    ds_read_b128 v[60:63], v6 offset:2240
    v_add_u32 v242, s87, v241
    v_mfma_f32_16x16x32_bf16 v[152:155], v[56:59], v[76:79], v[152:155]
    s_mul_i32 s85, s84, 286720
    s_mul_i32 s87, s82, 40960
    s_add_u32 s85, s85, s87
    v_mfma_f32_16x16x32_bf16 v[156:159], v[56:59], v[80:83], v[156:159]
    s_add_u32 s85, s85, 9056256
    s_and_b32 s86, s2, 7
    s_mul_i32 s86, s86, 3840
    v_mfma_f32_16x16x32_bf16 v[160:163], v[56:59], v[84:87], v[160:163]
    ds_read_b128 v[116:119], v7 offset:640
    s_mul_i32 s87, s84, 384
    v_mfma_f32_16x16x32_bf16 v[164:167], v[56:59], v[88:91], v[164:167]
    s_add_u32 s86, s86, s87
    s_add_u32 s86, s86, 65536
    v_min_u32 v243, 9, v240
    v_mfma_f32_16x16x32_bf16 v[168:171], v[56:59], v[92:95], v[168:171]
    ds_read_b128 v[56:59], v6 offset:1728
    v_lshlrev_b32 v243, 5, v243
    v_mfma_f32_16x16x32_bf16 v[148:151], v[52:55], v[76:79], v[148:151]
    v_mfma_f32_16x16x32_bf16 v[152:155], v[52:55], v[80:83], v[152:155]
    ds_read_b128 v[120:123], v7 offset:896
    v_mfma_f32_16x16x32_bf16 v[156:159], v[52:55], v[84:87], v[156:159]
    v_mfma_f32_16x16x32_bf16 v[160:163], v[52:55], v[88:91], v[160:163]
    v_mfma_f32_16x16x32_bf16 v[164:167], v[52:55], v[92:95], v[164:167]
    ds_read_b128 v[124:127], v7 offset:1152
    s_waitcnt lgkmcnt(3)
    v_mfma_f32_16x16x32_bf16 v[168:171], v[52:55], v[96:99], v[168:171]
    ds_read_b128 v[52:55], v6 offset:1216
    v_mfma_f32_16x16x32_bf16 v[144:147], v[48:51], v[76:79], v[144:147]
    v_mfma_f32_16x16x32_bf16 v[148:151], v[48:51], v[80:83], v[148:151]
    v_mfma_f32_16x16x32_bf16 v[152:155], v[48:51], v[84:87], v[152:155]
    ds_read_b128 v[128:131], v7 offset:1408
    v_mfma_f32_16x16x32_bf16 v[156:159], v[48:51], v[88:91], v[156:159]
    v_mfma_f32_16x16x32_bf16 v[160:163], v[48:51], v[92:95], v[160:163]
    v_mfma_f32_16x16x32_bf16 v[164:167], v[48:51], v[96:99], v[164:167]
    ds_read_b128 v[132:135], v7 offset:1664
    v_mfma_f32_16x16x32_bf16 v[168:171], v[48:51], v[100:103], v[168:171]
    ds_read_b128 v[48:51], v6 offset:704
    v_mfma_f32_16x16x32_bf16 v[140:143], v[44:47], v[76:79], v[140:143]
    v_mfma_f32_16x16x32_bf16 v[144:147], v[44:47], v[80:83], v[144:147]
    v_mfma_f32_16x16x32_bf16 v[148:151], v[44:47], v[84:87], v[148:151]
    ds_read_b128 v[136:139], v7 offset:1920
    v_mfma_f32_16x16x32_bf16 v[152:155], v[44:47], v[88:91], v[152:155]
    v_mfma_f32_16x16x32_bf16 v[156:159], v[44:47], v[92:95], v[156:159]
    v_mfma_f32_16x16x32_bf16 v[160:163], v[44:47], v[96:99], v[160:163]
    v_mfma_f32_16x16x32_bf16 v[164:167], v[44:47], v[100:103], v[164:167]
    v_mfma_f32_16x16x32_bf16 v[168:171], v[44:47], v[104:107], v[168:171]
    ds_read_b128 v[44:47], v6 offset:192
    v_mfma_f32_16x16x32_bf16 v[168:171], v[72:75], v[108:111], v[168:171]
    ds_read_b128 v[72:75], v6 offset:3840
    v_mfma_f32_16x16x32_bf16 v[164:167], v[68:71], v[108:111], v[164:167]
    v_mfma_f32_16x16x32_bf16 v[168:171], v[68:71], v[112:115], v[168:171]
    ds_read_b128 v[68:71], v6 offset:3328
    v_mfma_f32_16x16x32_bf16 v[160:163], v[64:67], v[108:111], v[160:163]
    v_mfma_f32_16x16x32_bf16 v[164:167], v[64:67], v[112:115], v[164:167]
    ds_read_b128 v[76:79], v7 offset:96
    v_mfma_f32_16x16x32_bf16 v[168:171], v[64:67], v[116:119], v[168:171]
    ds_read_b128 v[64:67], v6 offset:2816
    v_mfma_f32_16x16x32_bf16 v[156:159], v[60:63], v[108:111], v[156:159]
    v_mfma_f32_16x16x32_bf16 v[160:163], v[60:63], v[112:115], v[160:163]
    v_mfma_f32_16x16x32_bf16 v[164:167], v[60:63], v[116:119], v[164:167]
    ds_read_b128 v[80:83], v7 offset:352
    s_waitcnt lgkmcnt(3)
    v_mfma_f32_16x16x32_bf16 v[168:171], v[60:63], v[120:123], v[168:171]
    ds_read_b128 v[60:63], v6 offset:2304
    v_mfma_f32_16x16x32_bf16 v[152:155], v[56:59], v[108:111], v[152:155]
    v_mfma_f32_16x16x32_bf16 v[156:159], v[56:59], v[112:115], v[156:159]
    v_mfma_f32_16x16x32_bf16 v[160:163], v[56:59], v[116:119], v[160:163]
    ds_read_b128 v[84:87], v7 offset:608
    v_mfma_f32_16x16x32_bf16 v[164:167], v[56:59], v[120:123], v[164:167]
    v_mfma_f32_16x16x32_bf16 v[168:171], v[56:59], v[124:127], v[168:171]
    ds_read_b128 v[56:59], v6 offset:1792
    v_mfma_f32_16x16x32_bf16 v[148:151], v[52:55], v[108:111], v[148:151]
    v_mfma_f32_16x16x32_bf16 v[152:155], v[52:55], v[112:115], v[152:155]
    ds_read_b128 v[88:91], v7 offset:864
    v_mfma_f32_16x16x32_bf16 v[156:159], v[52:55], v[116:119], v[156:159]
    v_mfma_f32_16x16x32_bf16 v[160:163], v[52:55], v[120:123], v[160:163]
    v_mfma_f32_16x16x32_bf16 v[164:167], v[52:55], v[124:127], v[164:167]
    ds_read_b128 v[92:95], v7 offset:1120
    v_mfma_f32_16x16x32_bf16 v[168:171], v[52:55], v[128:131], v[168:171]
    ds_read_b128 v[52:55], v6 offset:1280
    v_mfma_f32_16x16x32_bf16 v[144:147], v[48:51], v[108:111], v[144:147]
    v_mfma_f32_16x16x32_bf16 v[148:151], v[48:51], v[112:115], v[148:151]
    v_mfma_f32_16x16x32_bf16 v[152:155], v[48:51], v[116:119], v[152:155]
    ds_read_b128 v[96:99], v7 offset:1376
    v_mfma_f32_16x16x32_bf16 v[156:159], v[48:51], v[120:123], v[156:159]
    v_mfma_f32_16x16x32_bf16 v[160:163], v[48:51], v[124:127], v[160:163]
    v_mfma_f32_16x16x32_bf16 v[164:167], v[48:51], v[128:131], v[164:167]
    ds_read_b128 v[100:103], v7 offset:1632
    v_mfma_f32_16x16x32_bf16 v[168:171], v[48:51], v[132:135], v[168:171]
    ds_read_b128 v[48:51], v6 offset:768
    v_mfma_f32_16x16x32_bf16 v[140:143], v[44:47], v[108:111], v[140:143]
    v_mfma_f32_16x16x32_bf16 v[144:147], v[44:47], v[112:115], v[144:147]
    v_mfma_f32_16x16x32_bf16 v[148:151], v[44:47], v[116:119], v[148:151]
    ds_read_b128 v[104:107], v7 offset:1888
    v_mfma_f32_16x16x32_bf16 v[152:155], v[44:47], v[120:123], v[152:155]
    v_mfma_f32_16x16x32_bf16 v[156:159], v[44:47], v[124:127], v[156:159]
    v_mfma_f32_16x16x32_bf16 v[160:163], v[44:47], v[128:131], v[160:163]
    v_mfma_f32_16x16x32_bf16 v[164:167], v[44:47], v[132:135], v[164:167]
    v_mfma_f32_16x16x32_bf16 v[168:171], v[44:47], v[136:139], v[168:171]
    ds_read_b128 v[44:47], v6 offset:256
    buffer_load_dwordx2 v[14:15], v10, s[4:7], 0 offen sc1
    buffer_load_dword v16, v27, s[4:7], s58 offen sc1
    s_waitcnt lgkmcnt(2)
    v_mfma_f32_16x16x32_bf16 v[168:171], v[72:75], v[76:79], v[168:171]
    ds_read_b128 v[72:75], v6 offset:3904
    s_mov_b32 s75, 0x05040100
    v_mfma_f32_16x16x32_bf16 v[164:167], v[68:71], v[76:79], v[164:167]
    s_mov_b32 s76, 0x07060302
    s_mul_i32 s74, s78, 5120
    s_lshl_b32 s79, s54, 8
    v_mfma_f32_16x16x32_bf16 v[168:171], v[68:71], v[80:83], v[168:171]
    ds_read_b128 v[68:71], v6 offset:3392
    s_add_u32 s74, s74, s79
    v_mfma_f32_16x16x32_bf16 v[160:163], v[64:67], v[76:79], v[160:163]
    s_add_u32 s74, s74, 11206656
    s_cmp_ge_u32 s78, 28
    s_cselect_b32 s74, 33554432, s74
    v_mfma_f32_16x16x32_bf16 v[164:167], v[64:67], v[80:83], v[164:167]
    ds_read_b128 v[108:111], v7 offset:64
    v_mul_u32_u24 v197, 1639, v196
    v_mfma_f32_16x16x32_bf16 v[168:171], v[64:67], v[84:87], v[168:171]
    ds_read_b128 v[64:67], v6 offset:2880
    v_lshrrev_b32 v197, 16, v197
    v_mfma_f32_16x16x32_bf16 v[156:159], v[60:63], v[76:79], v[156:159]
    v_mul_u32_u24 v198, 143360, v197
    v_mul_u32_u24 v197, 40, v197
    v_mfma_f32_16x16x32_bf16 v[160:163], v[60:63], v[80:83], v[160:163]
    v_sub_u32 v196, v196, v197
    v_lshrrev_b32 v197, 4, v196
    v_mfma_f32_16x16x32_bf16 v[164:167], v[60:63], v[84:87], v[164:167]
    ds_read_b128 v[112:115], v7 offset:320
    v_lshl_add_u32 v198, v197, 11, v198
    v_mfma_f32_16x16x32_bf16 v[168:171], v[60:63], v[88:91], v[168:171]
    ds_read_b128 v[60:63], v6 offset:2368
    v_cmp_le_u32 vcc, 32, v196
    v_mfma_f32_16x16x32_bf16 v[152:155], v[56:59], v[76:79], v[152:155]
    v_and_b32 v196, 15, v196
    v_mov_b32 v199, 1024
    v_mfma_f32_16x16x32_bf16 v[156:159], v[56:59], v[80:83], v[156:159]
    v_cndmask_b32 v197, 0, v196, vcc
    v_cndmask_b32 v199, v199, 16, vcc
    v_mfma_f32_16x16x32_bf16 v[160:163], v[56:59], v[84:87], v[160:163]
    ds_read_b128 v[116:119], v7 offset:576
    v_add_u32 v196, v196, v197
    v_mfma_f32_16x16x32_bf16 v[164:167], v[56:59], v[88:91], v[164:167]
    v_lshl_add_u32 v198, v196, 4, v198
    v_add_u32 v199, v198, v199
    v_mfma_f32_16x16x32_bf16 v[168:171], v[56:59], v[92:95], v[168:171]
    ds_read_b128 v[56:59], v6 offset:1856
    s_waitcnt vmcnt(3) lgkmcnt(2)
    v_perm_b32 v208, v201, v200, s75
    v_mfma_f32_16x16x32_bf16 v[148:151], v[52:55], v[76:79], v[148:151]
    v_perm_b32 v209, v203, v202, s75
    v_perm_b32 v210, v205, v204, s75
    v_mfma_f32_16x16x32_bf16 v[152:155], v[52:55], v[80:83], v[152:155]
    ds_read_b128 v[120:123], v7 offset:832
    v_perm_b32 v211, v207, v206, s75
    v_mfma_f32_16x16x32_bf16 v[156:159], v[52:55], v[84:87], v[156:159]
    v_perm_b32 v212, v201, v200, s76
    v_perm_b32 v213, v203, v202, s76
    v_mfma_f32_16x16x32_bf16 v[160:163], v[52:55], v[88:91], v[160:163]
    v_perm_b32 v214, v205, v204, s76
    v_perm_b32 v215, v207, v206, s76
    v_mfma_f32_16x16x32_bf16 v[164:167], v[52:55], v[92:95], v[164:167]
    ds_read_b128 v[124:127], v7 offset:1088
    v_mfma_f32_16x16x32_bf16 v[168:171], v[52:55], v[96:99], v[168:171]
    ds_read_b128 v[52:55], v6 offset:1344
    v_mfma_f32_16x16x32_bf16 v[144:147], v[48:51], v[76:79], v[144:147]
    buffer_store_dwordx4 v[208:211], v198, s[4:7], s74 offen sc1
    v_mfma_f32_16x16x32_bf16 v[148:151], v[48:51], v[80:83], v[148:151]
    buffer_store_dwordx4 v[212:215], v199, s[4:7], s74 offen sc1
    v_mfma_f32_16x16x32_bf16 v[152:155], v[48:51], v[84:87], v[152:155]
    ds_read_b128 v[128:131], v7 offset:1344
    v_mfma_f32_16x16x32_bf16 v[156:159], v[48:51], v[88:91], v[156:159]
    v_mfma_f32_16x16x32_bf16 v[160:163], v[48:51], v[92:95], v[160:163]
    v_mfma_f32_16x16x32_bf16 v[164:167], v[48:51], v[96:99], v[164:167]
    ds_read_b128 v[132:135], v7 offset:1600
    v_mfma_f32_16x16x32_bf16 v[168:171], v[48:51], v[100:103], v[168:171]
    ds_read_b128 v[48:51], v6 offset:832
    v_mfma_f32_16x16x32_bf16 v[140:143], v[44:47], v[76:79], v[140:143]
    v_mfma_f32_16x16x32_bf16 v[144:147], v[44:47], v[80:83], v[144:147]
    v_mfma_f32_16x16x32_bf16 v[148:151], v[44:47], v[84:87], v[148:151]
    ds_read_b128 v[136:139], v7 offset:1856
    v_mfma_f32_16x16x32_bf16 v[152:155], v[44:47], v[88:91], v[152:155]
    v_mfma_f32_16x16x32_bf16 v[156:159], v[44:47], v[92:95], v[156:159]
    v_mfma_f32_16x16x32_bf16 v[160:163], v[44:47], v[96:99], v[160:163]
    v_mfma_f32_16x16x32_bf16 v[164:167], v[44:47], v[100:103], v[164:167]
    v_mfma_f32_16x16x32_bf16 v[168:171], v[44:47], v[104:107], v[168:171]
    ds_read_b128 v[44:47], v6 offset:320
    v_mfma_f32_16x16x32_bf16 v[168:171], v[72:75], v[108:111], v[168:171]
    ds_read_b128 v[72:75], v6 offset:3968
    v_mfma_f32_16x16x32_bf16 v[164:167], v[68:71], v[108:111], v[164:167]
    v_mfma_f32_16x16x32_bf16 v[168:171], v[68:71], v[112:115], v[168:171]
    ds_read_b128 v[68:71], v6 offset:3456
    v_mfma_f32_16x16x32_bf16 v[160:163], v[64:67], v[108:111], v[160:163]
    v_mfma_f32_16x16x32_bf16 v[164:167], v[64:67], v[112:115], v[164:167]
    ds_read_b128 v[76:79], v7 offset:32
    s_waitcnt lgkmcnt(4)
    v_mfma_f32_16x16x32_bf16 v[168:171], v[64:67], v[116:119], v[168:171]
    ds_read_b128 v[64:67], v6 offset:2944
    v_mfma_f32_16x16x32_bf16 v[156:159], v[60:63], v[108:111], v[156:159]
    v_mfma_f32_16x16x32_bf16 v[160:163], v[60:63], v[112:115], v[160:163]
    v_mfma_f32_16x16x32_bf16 v[164:167], v[60:63], v[116:119], v[164:167]
    ds_read_b128 v[80:83], v7 offset:288
    v_mfma_f32_16x16x32_bf16 v[168:171], v[60:63], v[120:123], v[168:171]
    ds_read_b128 v[60:63], v6 offset:2432
    v_mfma_f32_16x16x32_bf16 v[152:155], v[56:59], v[108:111], v[152:155]
    v_mfma_f32_16x16x32_bf16 v[156:159], v[56:59], v[112:115], v[156:159]
    v_mfma_f32_16x16x32_bf16 v[160:163], v[56:59], v[116:119], v[160:163]
    ds_read_b128 v[84:87], v7 offset:544
    v_mfma_f32_16x16x32_bf16 v[164:167], v[56:59], v[120:123], v[164:167]
    v_mfma_f32_16x16x32_bf16 v[168:171], v[56:59], v[124:127], v[168:171]
    ds_read_b128 v[56:59], v6 offset:1920
    v_mfma_f32_16x16x32_bf16 v[148:151], v[52:55], v[108:111], v[148:151]
    v_mfma_f32_16x16x32_bf16 v[152:155], v[52:55], v[112:115], v[152:155]
    ds_read_b128 v[88:91], v7 offset:800
    v_mfma_f32_16x16x32_bf16 v[156:159], v[52:55], v[116:119], v[156:159]
    v_mfma_f32_16x16x32_bf16 v[160:163], v[52:55], v[120:123], v[160:163]
    v_mfma_f32_16x16x32_bf16 v[164:167], v[52:55], v[124:127], v[164:167]
    ds_read_b128 v[92:95], v7 offset:1056
    v_mfma_f32_16x16x32_bf16 v[168:171], v[52:55], v[128:131], v[168:171]
    ds_read_b128 v[52:55], v6 offset:1408
    v_mfma_f32_16x16x32_bf16 v[144:147], v[48:51], v[108:111], v[144:147]
    v_mfma_f32_16x16x32_bf16 v[148:151], v[48:51], v[112:115], v[148:151]
    v_mfma_f32_16x16x32_bf16 v[152:155], v[48:51], v[116:119], v[152:155]
    ds_read_b128 v[96:99], v7 offset:1312
    v_mfma_f32_16x16x32_bf16 v[156:159], v[48:51], v[120:123], v[156:159]
    v_mfma_f32_16x16x32_bf16 v[160:163], v[48:51], v[124:127], v[160:163]
    v_mfma_f32_16x16x32_bf16 v[164:167], v[48:51], v[128:131], v[164:167]
    ds_read_b128 v[100:103], v7 offset:1568
    v_mfma_f32_16x16x32_bf16 v[168:171], v[48:51], v[132:135], v[168:171]
    ds_read_b128 v[48:51], v6 offset:896
    s_waitcnt lgkmcnt(3)
    v_mfma_f32_16x16x32_bf16 v[140:143], v[44:47], v[108:111], v[140:143]
    v_mfma_f32_16x16x32_bf16 v[144:147], v[44:47], v[112:115], v[144:147]
    v_mfma_f32_16x16x32_bf16 v[148:151], v[44:47], v[116:119], v[148:151]
    ds_read_b128 v[104:107], v7 offset:1824
    v_mfma_f32_16x16x32_bf16 v[152:155], v[44:47], v[120:123], v[152:155]
    v_mfma_f32_16x16x32_bf16 v[156:159], v[44:47], v[124:127], v[156:159]
    v_mfma_f32_16x16x32_bf16 v[160:163], v[44:47], v[128:131], v[160:163]
    v_mfma_f32_16x16x32_bf16 v[164:167], v[44:47], v[132:135], v[164:167]
    v_mfma_f32_16x16x32_bf16 v[168:171], v[44:47], v[136:139], v[168:171]
    ds_read_b128 v[44:47], v6 offset:384
    s_mov_b32 s49, 65536
L_adaL_poll_8:
    s_waitcnt vmcnt(3) lgkmcnt(2)
    v_cmp_ne_u32 vcc, s48, v15
    s_waitcnt vmcnt(2)
    v_cmp_ne_u32 s[50:51], s48, v16
    s_nop 0
    s_or_b64 vcc, vcc, s[50:51]
    s_cbranch_vccz L_adaL_got_9
    buffer_load_dwordx2 v[14:15], v10, s[4:7], 0 offen sc1
    buffer_load_dword v16, v27, s[4:7], s58 offen sc1
    s_waitcnt vmcnt(0)
    s_sub_u32 s49, s49, 1
    s_cmp_lg_u32 s49, 0
    s_cbranch_scc1 L_adaL_poll_8
L_adaL_got_9:
    v_mfma_f32_16x16x32_bf16 v[168:171], v[72:75], v[76:79], v[168:171]
    ds_read_b128 v[72:75], v6 offset:4032
    v_mfma_f32_16x16x32_bf16 v[164:167], v[68:71], v[76:79], v[164:167]
    buffer_load_dwordx4 v[28:31], v9, s[4:7], s68 offen sc1
    v_mfma_f32_16x16x32_bf16 v[168:171], v[68:71], v[80:83], v[168:171]
    ds_read_b128 v[68:71], v6 offset:3520
    v_mfma_f32_16x16x32_bf16 v[160:163], v[64:67], v[76:79], v[160:163]
    buffer_load_dwordx4 v[32:35], v9, s[4:7], s69 offen sc1
    v_mfma_f32_16x16x32_bf16 v[164:167], v[64:67], v[80:83], v[164:167]
    ds_read_b128 v[108:111], v7 offset:0
    v_mfma_f32_16x16x32_bf16 v[168:171], v[64:67], v[84:87], v[168:171]
    ds_read_b128 v[64:67], v6 offset:3008
    v_mfma_f32_16x16x32_bf16 v[156:159], v[60:63], v[76:79], v[156:159]
    buffer_load_dwordx4 v[36:39], v9, s[4:7], s70 offen sc1
    v_mfma_f32_16x16x32_bf16 v[160:163], v[60:63], v[80:83], v[160:163]
    buffer_load_dwordx4 v[40:43], v9, s[4:7], s71 offen sc1
    s_mov_b32 s61, 16384
    v_mfma_f32_16x16x32_bf16 v[164:167], v[60:63], v[84:87], v[164:167]
    ds_read_b128 v[112:115], v7 offset:256
    v_mfma_f32_16x16x32_bf16 v[168:171], v[60:63], v[88:91], v[168:171]
    ds_read_b128 v[60:63], v6 offset:2496
    v_mfma_f32_16x16x32_bf16 v[152:155], v[56:59], v[76:79], v[152:155]
    buffer_load_dwordx4 v[172:175], v9, s[4:7], s61 offen sc1
    s_add_u32 s61, s61, 4096
    v_mfma_f32_16x16x32_bf16 v[156:159], v[56:59], v[80:83], v[156:159]
    buffer_load_dwordx4 v[176:179], v9, s[4:7], s61 offen sc1
    s_add_u32 s61, s61, 4096
    v_mfma_f32_16x16x32_bf16 v[160:163], v[56:59], v[84:87], v[160:163]
    ds_read_b128 v[116:119], v7 offset:512
    v_mfma_f32_16x16x32_bf16 v[164:167], v[56:59], v[88:91], v[164:167]
    buffer_load_dwordx4 v[180:183], v9, s[4:7], s61 offen sc1
    s_add_u32 s61, s61, 4096
    v_mfma_f32_16x16x32_bf16 v[168:171], v[56:59], v[92:95], v[168:171]
    ds_read_b128 v[56:59], v6 offset:1984
    v_mfma_f32_16x16x32_bf16 v[148:151], v[52:55], v[76:79], v[148:151]
    buffer_load_dwordx4 v[184:187], v9, s[4:7], s61 offen sc1
    s_add_u32 s61, s61, 4096
    v_mfma_f32_16x16x32_bf16 v[152:155], v[52:55], v[80:83], v[152:155]
    ds_read_b128 v[120:123], v7 offset:768
    v_readlane_b32 s8, v14, 32
    v_mfma_f32_16x16x32_bf16 v[156:159], v[52:55], v[84:87], v[156:159]
    v_readlane_b32 s9, v14, 33
    v_readlane_b32 s10, v14, 34
    v_mfma_f32_16x16x32_bf16 v[160:163], v[52:55], v[88:91], v[160:163]
    v_readlane_b32 s11, v14, 35
    v_readlane_b32 s12, v14, 36
    v_mfma_f32_16x16x32_bf16 v[164:167], v[52:55], v[92:95], v[164:167]
    ds_read_b128 v[124:127], v7 offset:1024
    v_readlane_b32 s13, v14, 37
    v_mfma_f32_16x16x32_bf16 v[168:171], v[52:55], v[96:99], v[168:171]
    ds_read_b128 v[52:55], v6 offset:1472
    v_readlane_b32 s14, v14, 38
    v_mfma_f32_16x16x32_bf16 v[144:147], v[48:51], v[76:79], v[144:147]
    v_readlane_b32 s15, v14, 39
    v_readlane_b32 s16, v14, 40
    v_mfma_f32_16x16x32_bf16 v[148:151], v[48:51], v[80:83], v[148:151]
    v_readlane_b32 s17, v14, 41
    v_readlane_b32 s18, v14, 42
    v_mfma_f32_16x16x32_bf16 v[152:155], v[48:51], v[84:87], v[152:155]
    ds_read_b128 v[128:131], v7 offset:1280
    v_readlane_b32 s19, v14, 43
    v_mfma_f32_16x16x32_bf16 v[156:159], v[48:51], v[88:91], v[156:159]
    v_mov_b32 v192, s16
    v_mov_b32 v193, s17
    v_mfma_f32_16x16x32_bf16 v[160:163], v[48:51], v[92:95], v[160:163]
    v_mov_b32 v194, s18
    v_mov_b32 v195, s19
    v_mfma_f32_16x16x32_bf16 v[164:167], v[48:51], v[96:99], v[164:167]
    ds_read_b128 v[132:135], v7 offset:1536
    v_mul_f32 v188, s8, v192
    v_mfma_f32_16x16x32_bf16 v[168:171], v[48:51], v[100:103], v[168:171]
    ds_read_b128 v[48:51], v6 offset:960
    v_mul_f32 v192, s12, v192
    s_waitcnt lgkmcnt(3)
    v_mfma_f32_16x16x32_bf16 v[140:143], v[44:47], v[76:79], v[140:143]
    v_mul_f32 v189, s9, v193
    v_mul_f32 v193, s13, v193
    v_mfma_f32_16x16x32_bf16 v[144:147], v[44:47], v[80:83], v[144:147]
    v_mul_f32 v190, s10, v194
    v_mul_f32 v194, s14, v194
    v_mfma_f32_16x16x32_bf16 v[148:151], v[44:47], v[84:87], v[148:151]
    ds_read_b128 v[136:139], v7 offset:1792
    v_mul_f32 v191, s11, v195
    v_mfma_f32_16x16x32_bf16 v[152:155], v[44:47], v[88:91], v[152:155]
    v_mul_f32 v195, s15, v195
    v_mfma_f32_16x16x32_bf16 v[156:159], v[44:47], v[92:95], v[156:159]
    v_mfma_f32_16x16x32_bf16 v[160:163], v[44:47], v[96:99], v[160:163]
    v_mfma_f32_16x16x32_bf16 v[164:167], v[44:47], v[100:103], v[164:167]
    v_mfma_f32_16x16x32_bf16 v[168:171], v[44:47], v[104:107], v[168:171]
    ds_read_b128 v[44:47], v6 offset:448
    v_mfma_f32_16x16x32_bf16 v[168:171], v[72:75], v[108:111], v[168:171]
    s_waitcnt vmcnt(7) lgkmcnt(1)
    v_lshlrev_b32 v196, 16, v28
    v_and_b32 v198, s3, v28
    v_mfma_f32_16x16x32_bf16 v[164:167], v[68:71], v[108:111], v[164:167]
    v_lshlrev_b32 v200, 16, v29
    v_and_b32 v202, s3, v29
    v_mfma_f32_16x16x32_bf16 v[168:171], v[68:71], v[112:115], v[168:171]
    v_lshlrev_b32 v197, 16, v30
    v_and_b32 v199, s3, v30
    v_mfma_f32_16x16x32_bf16 v[160:163], v[64:67], v[108:111], v[160:163]
    v_lshlrev_b32 v201, 16, v31
    v_and_b32 v203, s3, v31
    v_mfma_f32_16x16x32_bf16 v[164:167], v[64:67], v[112:115], v[164:167]
    s_waitcnt vmcnt(3) lgkmcnt(0)
    v_fma_f32 v196, v196, v172, v174
    v_fma_f32 v197, v197, v173, v175
    v_mfma_f32_16x16x32_bf16 v[168:171], v[64:67], v[116:119], v[168:171]
    v_fma_f32 v198, v198, v172, v174
    v_fma_f32 v199, v199, v173, v175
    v_mfma_f32_16x16x32_bf16 v[156:159], v[60:63], v[108:111], v[156:159]
    v_fma_f32 v200, v200, v172, v174
    v_fma_f32 v201, v201, v173, v175
    v_mfma_f32_16x16x32_bf16 v[160:163], v[60:63], v[112:115], v[160:163]
    v_fma_f32 v202, v202, v172, v174
    v_fma_f32 v203, v203, v173, v175
    v_mfma_f32_16x16x32_bf16 v[164:167], v[60:63], v[116:119], v[164:167]
    v_fma_f32 v196, v196, v192, v188
    v_fma_f32 v197, v197, v192, v188
    v_mfma_f32_16x16x32_bf16 v[168:171], v[60:63], v[120:123], v[168:171]
    v_fma_f32 v198, v198, v193, v189
    v_fma_f32 v199, v199, v193, v189
    v_mfma_f32_16x16x32_bf16 v[152:155], v[56:59], v[108:111], v[152:155]
    v_fma_f32 v200, v200, v194, v190
    v_fma_f32 v201, v201, v194, v190
    v_mfma_f32_16x16x32_bf16 v[156:159], v[56:59], v[112:115], v[156:159]
    v_fma_f32 v202, v202, v195, v191
    v_fma_f32 v203, v203, v195, v191
    v_mfma_f32_16x16x32_bf16 v[160:163], v[56:59], v[116:119], v[160:163]
    v_lshlrev_b32 v204, 16, v32
    v_and_b32 v206, s3, v32
    v_mfma_f32_16x16x32_bf16 v[164:167], v[56:59], v[120:123], v[164:167]
    v_lshlrev_b32 v208, 16, v33
    v_and_b32 v210, s3, v33
    v_mfma_f32_16x16x32_bf16 v[168:171], v[56:59], v[124:127], v[168:171]
    v_lshlrev_b32 v205, 16, v34
    v_and_b32 v207, s3, v34
    v_mfma_f32_16x16x32_bf16 v[148:151], v[52:55], v[108:111], v[148:151]
    v_lshlrev_b32 v209, 16, v35
    v_and_b32 v211, s3, v35
    v_mfma_f32_16x16x32_bf16 v[152:155], v[52:55], v[112:115], v[152:155]
    s_waitcnt vmcnt(2)
    v_fma_f32 v204, v204, v176, v178
    v_fma_f32 v205, v205, v177, v179
    v_mfma_f32_16x16x32_bf16 v[156:159], v[52:55], v[116:119], v[156:159]
    v_fma_f32 v206, v206, v176, v178
    v_fma_f32 v207, v207, v177, v179
    v_mfma_f32_16x16x32_bf16 v[160:163], v[52:55], v[120:123], v[160:163]
    v_fma_f32 v208, v208, v176, v178
    v_fma_f32 v209, v209, v177, v179
    v_mfma_f32_16x16x32_bf16 v[164:167], v[52:55], v[124:127], v[164:167]
    v_fma_f32 v210, v210, v176, v178
    v_fma_f32 v211, v211, v177, v179
    v_mfma_f32_16x16x32_bf16 v[168:171], v[52:55], v[128:131], v[168:171]
    v_fma_f32 v204, v204, v192, v188
    v_fma_f32 v205, v205, v192, v188
    v_mfma_f32_16x16x32_bf16 v[144:147], v[48:51], v[108:111], v[144:147]
    v_fma_f32 v206, v206, v193, v189
    v_fma_f32 v207, v207, v193, v189
    v_mfma_f32_16x16x32_bf16 v[148:151], v[48:51], v[112:115], v[148:151]
    v_fma_f32 v208, v208, v194, v190
    v_fma_f32 v209, v209, v194, v190
    v_mfma_f32_16x16x32_bf16 v[152:155], v[48:51], v[116:119], v[152:155]
    v_fma_f32 v210, v210, v195, v191
    v_fma_f32 v211, v211, v195, v191
    v_mfma_f32_16x16x32_bf16 v[156:159], v[48:51], v[120:123], v[156:159]
    v_lshlrev_b32 v212, 16, v36
    v_and_b32 v214, s3, v36
    v_mfma_f32_16x16x32_bf16 v[160:163], v[48:51], v[124:127], v[160:163]
    v_lshlrev_b32 v216, 16, v37
    v_and_b32 v218, s3, v37
    v_mfma_f32_16x16x32_bf16 v[164:167], v[48:51], v[128:131], v[164:167]
    v_lshlrev_b32 v213, 16, v38
    v_and_b32 v215, s3, v38
    v_mfma_f32_16x16x32_bf16 v[168:171], v[48:51], v[132:135], v[168:171]
    v_lshlrev_b32 v217, 16, v39
    v_and_b32 v219, s3, v39
    v_mfma_f32_16x16x32_bf16 v[140:143], v[44:47], v[108:111], v[140:143]
    s_waitcnt vmcnt(1)
    v_fma_f32 v212, v212, v180, v182
    v_fma_f32 v213, v213, v181, v183
    v_mfma_f32_16x16x32_bf16 v[144:147], v[44:47], v[112:115], v[144:147]
    v_fma_f32 v214, v214, v180, v182
    v_fma_f32 v215, v215, v181, v183
    v_mfma_f32_16x16x32_bf16 v[148:151], v[44:47], v[116:119], v[148:151]
    v_fma_f32 v216, v216, v180, v182
    v_fma_f32 v217, v217, v181, v183
    v_mfma_f32_16x16x32_bf16 v[152:155], v[44:47], v[120:123], v[152:155]
    v_fma_f32 v218, v218, v180, v182
    v_fma_f32 v219, v219, v181, v183
    v_mfma_f32_16x16x32_bf16 v[156:159], v[44:47], v[124:127], v[156:159]
    v_fma_f32 v212, v212, v192, v188
    v_fma_f32 v213, v213, v192, v188
    v_mfma_f32_16x16x32_bf16 v[160:163], v[44:47], v[128:131], v[160:163]
    v_fma_f32 v214, v214, v193, v189
    v_fma_f32 v215, v215, v193, v189
    v_mfma_f32_16x16x32_bf16 v[164:167], v[44:47], v[132:135], v[164:167]
    v_fma_f32 v216, v216, v194, v190
    v_fma_f32 v217, v217, v194, v190
    v_mfma_f32_16x16x32_bf16 v[168:171], v[44:47], v[136:139], v[168:171]
    v_fma_f32 v218, v218, v195, v191
    v_fma_f32 v219, v219, v195, v191
    v_lshlrev_b32 v220, 16, v40
    v_and_b32 v222, s3, v40
    v_lshlrev_b32 v224, 16, v41
    v_and_b32 v226, s3, v41
    v_lshlrev_b32 v221, 16, v42
    v_and_b32 v223, s3, v42
    v_lshlrev_b32 v225, 16, v43
    v_and_b32 v227, s3, v43
    s_waitcnt vmcnt(0)
    v_fma_f32 v220, v220, v184, v186
    v_fma_f32 v221, v221, v185, v187
    v_fma_f32 v222, v222, v184, v186
    v_fma_f32 v223, v223, v185, v187
    v_fma_f32 v224, v224, v184, v186
    v_fma_f32 v225, v225, v185, v187
    v_fma_f32 v226, v226, v184, v186
    v_fma_f32 v227, v227, v185, v187
    v_fma_f32 v220, v220, v192, v188
    v_fma_f32 v221, v221, v192, v188
    v_fma_f32 v222, v222, v193, v189
    v_fma_f32 v223, v223, v193, v189
    v_fma_f32 v224, v224, v194, v190
    v_fma_f32 v225, v225, v194, v190
    v_fma_f32 v226, v226, v195, v191
    v_fma_f32 v227, v227, v195, v191
    buffer_load_dword v244, v243, s[4:7], s86 offen sc1
    ds_write_b128 v8, v[140:143] offset:0
    ds_write_b128 v8, v[144:147] offset:1024
    ds_write_b128 v8, v[148:151] offset:2048
    ds_write_b128 v8, v[152:155] offset:3072
    ds_write_b128 v8, v[156:159] offset:4096
    ds_write_b128 v8, v[160:163] offset:5120
    ds_write_b128 v8, v[164:167] offset:6144
    ds_write_b128 v8, v[168:171] offset:7168
    v_lshlrev_b32 v76, 16, v28
    v_and_b32 v78, s3, v28
    v_lshlrev_b32 v80, 16, v29
    v_and_b32 v82, s3, v29
    v_lshlrev_b32 v77, 16, v30
    v_and_b32 v79, s3, v30
    v_lshlrev_b32 v81, 16, v31
    v_and_b32 v83, s3, v31
    v_lshlrev_b32 v84, 16, v32
    v_and_b32 v86, s3, v32
    v_lshlrev_b32 v88, 16, v33
    v_and_b32 v90, s3, v33
    v_lshlrev_b32 v85, 16, v34
    v_and_b32 v87, s3, v34
    v_lshlrev_b32 v89, 16, v35
    v_and_b32 v91, s3, v35
    v_lshlrev_b32 v92, 16, v36
    v_and_b32 v94, s3, v36
    v_lshlrev_b32 v96, 16, v37
    v_and_b32 v98, s3, v37
    v_lshlrev_b32 v93, 16, v38
    v_and_b32 v95, s3, v38
    v_lshlrev_b32 v97, 16, v39
    v_and_b32 v99, s3, v39
    v_lshlrev_b32 v100, 16, v40
    v_and_b32 v102, s3, v40
    v_lshlrev_b32 v104, 16, v41
    v_and_b32 v106, s3, v41
    v_lshlrev_b32 v101, 16, v42
    v_and_b32 v103, s3, v42
    v_lshlrev_b32 v105, 16, v43
    v_and_b32 v107, s3, v43
    s_waitcnt lgkmcnt(0)
    s_barrier
    ds_read_b64 v[44:45], v228 offset:0
    ds_read_b64 v[46:47], v228 offset:33024
    ds_read_b64 v[48:49], v229 offset:0
    ds_read_b64 v[50:51], v229 offset:33024
    ds_read_b64 v[52:53], v228 offset:2048
    ds_read_b64 v[54:55], v228 offset:35072
    ds_read_b64 v[56:57], v229 offset:2048
    ds_read_b64 v[58:59], v229 offset:35072
    ds_read_b64 v[60:61], v228 offset:4096
    ds_read_b64 v[62:63], v228 offset:37120
    ds_read_b64 v[64:65], v229 offset:4096
    ds_read_b64 v[66:67], v229 offset:37120
    ds_read_b64 v[68:69], v228 offset:6144
    ds_read_b64 v[70:71], v228 offset:39168
    ds_read_b64 v[72:73], v229 offset:6144
    ds_read_b64 v[74:75], v229 offset:39168
    s_waitcnt lgkmcnt(15)
    v_pk_fma_f32 v[196:197], v[196:197], v[44:45], v[76:77]
    s_waitcnt lgkmcnt(14)
    v_pk_fma_f32 v[198:199], v[198:199], v[46:47], v[78:79]
    s_waitcnt lgkmcnt(13)
    v_pk_fma_f32 v[200:201], v[200:201], v[48:49], v[80:81]
    s_waitcnt lgkmcnt(12)
    v_pk_fma_f32 v[202:203], v[202:203], v[50:51], v[82:83]
    v_cvt_pk_bf16_f32 v28, v196, v198
    v_cvt_pk_bf16_f32 v29, v200, v202
    v_cvt_pk_bf16_f32 v30, v197, v199
    v_cvt_pk_bf16_f32 v31, v201, v203
    buffer_store_dwordx4 v[28:31], v9, s[4:7], s64 offen sc1
    s_waitcnt lgkmcnt(11)
    v_pk_fma_f32 v[204:205], v[204:205], v[52:53], v[84:85]
    s_waitcnt lgkmcnt(10)
    v_pk_fma_f32 v[206:207], v[206:207], v[54:55], v[86:87]
    s_waitcnt lgkmcnt(9)
    v_pk_fma_f32 v[208:209], v[208:209], v[56:57], v[88:89]
    s_waitcnt lgkmcnt(8)
    v_pk_fma_f32 v[210:211], v[210:211], v[58:59], v[90:91]
    v_cvt_pk_bf16_f32 v32, v204, v206
    v_cvt_pk_bf16_f32 v33, v208, v210
    v_cvt_pk_bf16_f32 v34, v205, v207
    v_cvt_pk_bf16_f32 v35, v209, v211
    buffer_store_dwordx4 v[32:35], v9, s[4:7], s65 offen sc1
    s_waitcnt lgkmcnt(7)
    v_pk_fma_f32 v[212:213], v[212:213], v[60:61], v[92:93]
    s_waitcnt lgkmcnt(6)
    v_pk_fma_f32 v[214:215], v[214:215], v[62:63], v[94:95]
    s_waitcnt lgkmcnt(5)
    v_pk_fma_f32 v[216:217], v[216:217], v[64:65], v[96:97]
    s_waitcnt lgkmcnt(4)
    v_pk_fma_f32 v[218:219], v[218:219], v[66:67], v[98:99]
    v_cvt_pk_bf16_f32 v36, v212, v214
    v_cvt_pk_bf16_f32 v37, v216, v218
    v_cvt_pk_bf16_f32 v38, v213, v215
    v_cvt_pk_bf16_f32 v39, v217, v219
    buffer_store_dwordx4 v[36:39], v9, s[4:7], s66 offen sc1
    s_waitcnt lgkmcnt(0)
    v_pk_fma_f32 v[220:221], v[220:221], v[68:69], v[100:101]
    v_pk_fma_f32 v[222:223], v[222:223], v[70:71], v[102:103]
    v_pk_fma_f32 v[224:225], v[224:225], v[72:73], v[104:105]
    v_pk_fma_f32 v[226:227], v[226:227], v[74:75], v[106:107]
    v_cvt_pk_bf16_f32 v40, v220, v222
    v_cvt_pk_bf16_f32 v41, v224, v226
    v_cvt_pk_bf16_f32 v42, v221, v223
    v_cvt_pk_bf16_f32 v43, v225, v227
    buffer_store_dwordx4 v[40:43], v9, s[4:7], s67 offen sc1
L_adaL_join_3:
    s_load_dwordx2 s[12:13], s[0:1], 72
    s_mov_b32 s14, 4096
    s_mov_b32 s15, 0x20000
    s_load_dwordx2 s[16:17], s[0:1], 104
    s_mov_b32 s18, 2621440
    s_mov_b32 s19, 0x20000
    v_mov_b32 v13, s48
    s_lshl_b32 s62, s82, 8
    s_add_u32 s62, s62, s2
    s_lshl_b32 s55, s62, 5
    s_add_u32 s55, s55, 131072
    s_cmp_ge_u32 s62, 160
    s_cselect_b32 s55, 33554432, s55
    v_mul_u32_u24 v14, 5376, v240
    s_and_b32 s60, s2, 7
    s_mul_i32 s60, s60, 5376
    s_mul_i32 s62, s82, 1280
    s_add_u32 s60, s60, s62
    s_add_u32 s60, s60, 131072
    v_min_u32 v26, 39, v240
    v_lshlrev_b32 v26, 5, v26
    s_waitcnt vmcnt(0)
    s_barrier
    s_mov_b64 exec, 255
    buffer_store_dword v13, v14, s[4:7], s55 offen sc1
    s_mov_b64 exec, -1
    s_mov_b32 s49, 65536
L_adaL_poll_10:
    v_cmp_ne_u32 vcc, s48, v244
    s_nop 0
    s_cbranch_vccz L_adaL_got_11
    buffer_load_dword v244, v243, s[4:7], s86 offen sc1
    s_waitcnt vmcnt(0)
    s_sub_u32 s49, s49, 1
    s_cmp_lg_u32 s49, 0
    s_cbranch_scc1 L_adaL_poll_10
L_adaL_got_11:
    buffer_load_dwordx4 a[96:99], v241, s[4:7], s85 offen offset:0 sc1
    v_bfe_u32 v3, v0, 3, 2
    v_bfe_u32 v4, v0, 5, 1
    v_lshl_add_u32 v3, v3, 1, v4
    v_lshlrev_b32 v15, 14, v3
    buffer_load_dwordx4 a[100:103], v242, s[4:7], s85 offen offset:0 sc1
    v_and_b32 v3, 7, v0
    v_lshl_add_u32 v15, v3, 4, v15
    s_lshl_b32 s52, s83, 9
    s_lshl_b32 s62, s82, 7
    buffer_load_dwordx4 a[104:107], v241, s[4:7], s85 offen offset:1024 sc1
    s_add_u32 s52, s52, s62
    s_add_u32 s52, s52, 6291456
    s_mul_i32 s53, s82, 20480
    v_and_b32 v1, 15, v0
    buffer_load_dwordx4 a[108:111], v242, s[4:7], s85 offen offset:1024 sc1
    v_lshrrev_b32 v2, 4, v240
    v_lshlrev_b32 v5, 3, v240
    v_add_u32 v6, 40960, v5
    v_add_u32 v14, s53, v5
    buffer_load_dwordx4 a[112:115], v241, s[4:7], s85 offen offset:2048 sc1
    v_lshlrev_b32 v7, 4, v2
    s_mov_b32 s70, 0xbdd2d3e8
    s_mov_b32 s71, 0xc0135761
    s_mov_b32 s72, 1.0
    buffer_load_dwordx4 a[116:119], v242, s[4:7], s85 offen offset:2048 sc1
    s_mov_b32 s73, 1.0
    v_mov_b32 v132, 0x3f803f80
    v_mov_b32 v133, 0x3f803f80
    v_mov_b32 v134, 0x3f803f80
    buffer_load_dwordx4 a[120:123], v241, s[4:7], s85 offen offset:3072 sc1
    v_mov_b32 v135, 0x3f803f80
    v_lshrrev_b32 v3, 3, v240
    v_lshlrev_b32 v8, 13, v3
    v_and_b32 v4, 7, v0
    buffer_load_dwordx4 a[124:127], v242, s[4:7], s85 offen offset:3072 sc1
    s_add_u32 s85, s85, 4096
    v_xor_b32 v3, v2, v4
    v_lshl_add_u32 v8, v3, 4, v8
    v_xor_b32 v9, 64, v8
    v_add_u32 v9, 65536, v9
    buffer_load_dwordx4 a[128:131], v241, s[4:7], s85 offen offset:0 sc1
    s_lshl_b32 s62, s83, 18
    s_lshl_b32 s63, s82, 10
    s_add_u32 s66, s62, s63
    s_add_u32 s67, s66, 4096
    buffer_load_dwordx4 a[132:135], v242, s[4:7], s85 offen offset:0 sc1
    s_add_u32 s68, s66, 131072
    s_add_u32 s69, s66, 135168
    s_mul_i32 s54, s82, 14336
    s_add_u32 s54, s54, 101888
    buffer_load_dwordx4 a[136:139], v241, s[4:7], s85 offen offset:1024 sc1
    v_lshrrev_b32 v3, 1, v1
    v_xor_b32 v3, v3, v2
    v_lshlrev_b32 v10, 7, v1
    v_lshl_add_u32 v10, v3, 4, v10
    buffer_load_dwordx4 a[140:143], v242, s[4:7], s85 offen offset:1024 sc1
    v_add_u32 v10, s54, v10
    v_xor_b32 v11, 64, v10
    v_lshlrev_b32 v12, 2, v1
    s_lshl_b32 s62, s84, 11
    buffer_load_dwordx4 a[144:147], v241, s[4:7], s85 offen offset:2048 sc1
    s_add_u32 s62, s62, 262144
    v_lshlrev_b32 v4, 3, v0
    buffer_load_dwordx4 a[148:151], v242, s[4:7], s85 offen offset:2048 sc1
    buffer_load_dwordx4 a[152:155], v241, s[4:7], s85 offen offset:3072 sc1
    buffer_load_dwordx4 a[156:159], v242, s[4:7], s85 offen offset:3072 sc1
    s_add_u32 s85, s85, 4096
    buffer_load_dwordx2 v[180:181], v4, s[4:7], s62 offen sc1
    s_add_u32 s62, s62, 16384
    buffer_load_dwordx2 v[182:183], v4, s[4:7], s62 offen sc1
    s_add_u32 s62, s62, 16384
    buffer_load_dwordx2 v[184:185], v4, s[4:7], s62 offen sc1
    s_add_u32 s62, s62, 16384
    buffer_load_dwordx2 v[186:187], v4, s[4:7], s62 offen sc1
    s_add_u32 s62, s62, 16384
    buffer_load_dwordx2 v[188:189], v4, s[4:7], s62 offen sc1
    s_add_u32 s62, s62, 16384
    buffer_load_dword v27, v26, s[4:7], s60 offen sc1
    s_waitcnt vmcnt(4)
    v_pk_add_f32 v[180:181], v[180:181], v[182:183]
    s_waitcnt vmcnt(3)
    v_pk_add_f32 v[180:181], v[180:181], v[184:185]
    s_waitcnt vmcnt(2)
    v_pk_add_f32 v[180:181], v[180:181], v[186:187]
    s_waitcnt vmcnt(1)
    v_pk_add_f32 v[180:181], v[180:181], v[188:189]
    v_add_u32 v4, 86528, v4
    s_mov_b32 s49, 65536
L_adaL_poll_12:
    s_waitcnt vmcnt(0)
    v_cmp_ne_u32 vcc, s48, v27
    s_nop 0
    s_cbranch_vccz L_adaL_got_13
    buffer_load_dword v27, v26, s[4:7], s60 offen sc1
    s_waitcnt vmcnt(0)
    s_sub_u32 s49, s49, 1
    s_cmp_lg_u32 s49, 0
    s_cbranch_scc1 L_adaL_poll_12
L_adaL_got_13:
    s_barrier
    s_mov_b32 m0, s53
    s_nop 0
    buffer_load_dwordx4 v15, s[4:7], s52 offen sc1 lds
    s_add_u32 m0, m0, 1024
    s_add_u32 s52, s52, 131072
    buffer_load_dwordx4 v15, s[4:7], s52 offen sc1 lds
    s_add_u32 m0, m0, 1024
    s_add_u32 s52, s52, 131072
    buffer_load_dwordx4 v15, s[4:7], s52 offen sc1 lds
    s_add_u32 m0, m0, 1024
    s_add_u32 s52, s52, 131072
    buffer_load_dwordx4 v15, s[4:7], s52 offen sc1 lds
    s_add_u32 m0, m0, 1024
    s_add_u32 s52, s52, 131072
    buffer_load_dwordx4 v15, s[4:7], s52 offen sc1 lds
    s_add_u32 m0, m0, 1024
    s_add_u32 s52, s52, 131072
    buffer_load_dwordx4 v15, s[4:7], s52 offen sc1 lds
    s_add_u32 m0, m0, 1024
    s_add_u32 s52, s52, 131072
    buffer_load_dwordx4 v15, s[4:7], s52 offen sc1 lds
    s_add_u32 m0, m0, 1024
    s_add_u32 s52, s52, 131072
    buffer_load_dwordx4 v15, s[4:7], s52 offen sc1 lds
    s_add_u32 m0, m0, 1024
    s_add_u32 s52, s52, 131072
    buffer_load_dwordx4 v15, s[4:7], s52 offen sc1 lds
    s_add_u32 m0, m0, 1024
    s_add_u32 s52, s52, 131072
    buffer_load_dwordx4 v15, s[4:7], s52 offen sc1 lds
    s_add_u32 m0, m0, 1024
    s_add_u32 s52, s52, 131072
    buffer_load_dwordx4 v15, s[4:7], s52 offen sc1 lds
    s_add_u32 m0, m0, 1024
    s_add_u32 s52, s52, 131072
    buffer_load_dwordx4 v15, s[4:7], s52 offen sc1 lds
    s_add_u32 m0, m0, 1024
    s_add_u32 s52, s52, 131072
    buffer_load_dwordx4 v15, s[4:7], s52 offen sc1 lds
    s_add_u32 m0, m0, 1024
    s_add_u32 s52, s52, 131072
    buffer_load_dwordx4 v15, s[4:7], s52 offen sc1 lds
    s_add_u32 m0, m0, 1024
    s_add_u32 s52, s52, 131072
    buffer_load_dwordx4 v15, s[4:7], s52 offen sc1 lds
    s_add_u32 m0, m0, 1024
    s_add_u32 s52, s52, 131072
    buffer_load_dwordx4 v15, s[4:7], s52 offen sc1 lds
    s_add_u32 m0, m0, 1024
    s_add_u32 s52, s52, 131072
    buffer_load_dwordx4 v15, s[4:7], s52 offen sc1 lds
    s_add_u32 m0, m0, 1024
    s_add_u32 s52, s52, 131072
    buffer_load_dwordx4 v15, s[4:7], s52 offen sc1 lds
    s_add_u32 m0, m0, 1024
    s_add_u32 s52, s52, 131072
    buffer_load_dwordx4 v15, s[4:7], s52 offen sc1 lds
    s_add_u32 m0, m0, 1024
    s_add_u32 s52, s52, 131072
    buffer_load_dwordx4 v15, s[4:7], s52 offen sc1 lds
    ds_write_b64 v4, v[180:181]
    s_lshl_b32 s60, s83, 3
    s_add_u32 s60, s60, s84
    s_lshl_b32 s60, s60, 15
    v_lshlrev_b32 v26, 5, v0
    s_waitcnt vmcnt(19)
    ds_read_b64 v[92:93], v14 offset:0
    ds_read_b64 v[94:95], v14 offset:512
    s_waitcnt lgkmcnt(0)
    v_mfma_f32_16x16x32_bf16 v[136:139], v[92:95], v[92:95], 0
    s_waitcnt vmcnt(18)
    ds_read_b64 v[96:97], v14 offset:1024
    v_mfma_f32_16x16x32_bf16 v[140:143], v[132:135], v[92:95], 0
    ds_read_b64 v[98:99], v14 offset:1536
    s_waitcnt lgkmcnt(0)
    v_mfma_f32_16x16x32_bf16 v[136:139], v[96:99], v[96:99], v[136:139]
    s_waitcnt vmcnt(17)
    ds_read_b64 v[92:93], v14 offset:2048
    v_mfma_f32_16x16x32_bf16 v[140:143], v[132:135], v[96:99], v[140:143]
    ds_read_b64 v[94:95], v14 offset:2560
    s_waitcnt lgkmcnt(0)
    v_mfma_f32_16x16x32_bf16 v[136:139], v[92:95], v[92:95], v[136:139]
    s_waitcnt vmcnt(16)
    ds_read_b64 v[96:97], v14 offset:3072
    v_mfma_f32_16x16x32_bf16 v[140:143], v[132:135], v[92:95], v[140:143]
    ds_read_b64 v[98:99], v14 offset:3584
    s_waitcnt lgkmcnt(0)
    v_mfma_f32_16x16x32_bf16 v[136:139], v[96:99], v[96:99], v[136:139]
    s_waitcnt vmcnt(15)
    ds_read_b64 v[92:93], v14 offset:4096
    v_mfma_f32_16x16x32_bf16 v[140:143], v[132:135], v[96:99], v[140:143]
    ds_read_b64 v[94:95], v14 offset:4608
    s_waitcnt lgkmcnt(0)
    s_barrier
    ds_read_b64 v[44:45], v5 offset:0
    ds_read_b64 v[46:47], v5 offset:512
    ds_read_b64 v[48:49], v5 offset:20480
    ds_read_b64 v[50:51], v5 offset:20992
    ds_read_b64 v[52:53], v6 offset:0
    ds_read_b64 v[54:55], v6 offset:512
    ds_read_b64 v[56:57], v6 offset:20480
    ds_read_b64 v[58:59], v6 offset:20992
    ds_read_b64 v[60:61], v5 offset:1024
    ds_read_b64 v[62:63], v5 offset:1536
    ds_read_b64 v[64:65], v5 offset:21504
    ds_read_b64 v[66:67], v5 offset:22016
    ds_read_b64 v[68:69], v6 offset:1024
    ds_read_b64 v[70:71], v6 offset:1536
    ds_read_b64 v[72:73], v6 offset:21504
    ds_read_b64 v[74:75], v6 offset:22016
    s_lshl_b32 s62, s82, 7
    s_add_u32 s62, s62, 86528
    v_add_u32 v3, s62, v12
    v_add_u32 v4, s62, v7
    ds_read_b32 v212, v3 offset:1024
    ds_read_b32 v213, v3 offset:1536
    ds_read_b128 v[196:199], v4 offset:0
    ds_read_b128 v[204:207], v4 offset:512
    ds_read_b32 v214, v3 offset:1088
    ds_read_b32 v215, v3 offset:1600
    ds_read_b128 v[200:203], v4 offset:64
    ds_read_b128 v[208:211], v4 offset:576
    v_mfma_f32_16x16x32_bf16 v[136:139], v[92:95], v[92:95], v[136:139]
    s_waitcnt vmcnt(14)
    ds_read_b64 v[96:97], v14 offset:5120
    v_mfma_f32_16x16x32_bf16 v[140:143], v[132:135], v[92:95], v[140:143]
    ds_read_b64 v[98:99], v14 offset:5632
    s_waitcnt lgkmcnt(15)
    v_mfma_f32_16x16x32_bf16 v[100:103], v[44:47], a[96:99], 0
    ds_read2st64_b64 v[76:79], v5 offset0:4 offset1:5
    v_mfma_f32_16x16x32_bf16 v[104:107], v[48:51], a[96:99], 0
    ds_read_b64 v[80:81], v5 offset:22528
    v_mfma_f32_16x16x32_bf16 v[108:111], v[52:55], a[96:99], 0
    ds_read_b64 v[82:83], v5 offset:23040
    v_mfma_f32_16x16x32_bf16 v[112:115], v[56:59], a[96:99], 0
    buffer_load_dwordx4 a[160:163], v241, s[4:7], s85 offen offset:0 sc1
    v_mfma_f32_16x16x32_bf16 v[116:119], v[44:47], a[100:103], 0
    ds_read2st64_b64 v[84:87], v5 offset0:84 offset1:85
    v_mfma_f32_16x16x32_bf16 v[120:123], v[48:51], a[100:103], 0
    ds_read_b64 v[88:89], v6 offset:22528
    v_mfma_f32_16x16x32_bf16 v[124:127], v[52:55], a[100:103], 0
    ds_read_b64 v[90:91], v6 offset:23040
    v_mfma_f32_16x16x32_bf16 v[128:131], v[56:59], a[100:103], 0
    buffer_load_dwordx4 a[164:167], v242, s[4:7], s85 offen offset:0 sc1
    s_waitcnt lgkmcnt(4)
    v_mfma_f32_16x16x32_bf16 v[136:139], v[96:99], v[96:99], v[136:139]
    s_waitcnt vmcnt(15) lgkmcnt(3)
    ds_read_b64 v[92:93], v14 offset:6144
    v_mfma_f32_16x16x32_bf16 v[140:143], v[132:135], v[96:99], v[140:143]
    ds_read_b64 v[94:95], v14 offset:6656
    v_mfma_f32_16x16x32_bf16 v[100:103], v[60:63], a[104:107], v[100:103]
    ds_read2st64_b64 v[44:47], v5 offset0:6 offset1:7
    v_mfma_f32_16x16x32_bf16 v[104:107], v[64:67], a[104:107], v[104:107]
    ds_read_b64 v[48:49], v5 offset:23552
    v_mfma_f32_16x16x32_bf16 v[108:111], v[68:71], a[104:107], v[108:111]
    ds_read_b64 v[50:51], v5 offset:24064
    v_mfma_f32_16x16x32_bf16 v[112:115], v[72:75], a[104:107], v[112:115]
    buffer_load_dwordx4 a[168:171], v241, s[4:7], s85 offen offset:1024 sc1
    v_mfma_f32_16x16x32_bf16 v[116:119], v[60:63], a[108:111], v[116:119]
    ds_read2st64_b64 v[52:55], v5 offset0:86 offset1:87
    v_mfma_f32_16x16x32_bf16 v[120:123], v[64:67], a[108:111], v[120:123]
    ds_read_b64 v[56:57], v6 offset:23552
    v_mfma_f32_16x16x32_bf16 v[124:127], v[68:71], a[108:111], v[124:127]
    ds_read_b64 v[58:59], v6 offset:24064
    v_mfma_f32_16x16x32_bf16 v[128:131], v[72:75], a[108:111], v[128:131]
    buffer_load_dwordx4 a[172:175], v242, s[4:7], s85 offen offset:1024 sc1
    s_waitcnt lgkmcnt(4)
    v_mfma_f32_16x16x32_bf16 v[136:139], v[92:95], v[92:95], v[136:139]
    s_waitcnt vmcnt(16) lgkmcnt(3)
    ds_read_b64 v[96:97], v14 offset:7168
    v_mfma_f32_16x16x32_bf16 v[140:143], v[132:135], v[92:95], v[140:143]
    ds_read_b64 v[98:99], v14 offset:7680
    v_mfma_f32_16x16x32_bf16 v[100:103], v[76:79], a[112:115], v[100:103]
    ds_read2st64_b64 v[60:63], v5 offset0:8 offset1:9
    v_mfma_f32_16x16x32_bf16 v[104:107], v[80:83], a[112:115], v[104:107]
    ds_read_b64 v[64:65], v5 offset:24576
    v_mfma_f32_16x16x32_bf16 v[108:111], v[84:87], a[112:115], v[108:111]
    ds_read_b64 v[66:67], v5 offset:25088
    v_mfma_f32_16x16x32_bf16 v[112:115], v[88:91], a[112:115], v[112:115]
    buffer_load_dwordx4 a[176:179], v241, s[4:7], s85 offen offset:2048 sc1
    v_mfma_f32_16x16x32_bf16 v[116:119], v[76:79], a[116:119], v[116:119]
    ds_read2st64_b64 v[68:71], v5 offset0:88 offset1:89
    v_mfma_f32_16x16x32_bf16 v[120:123], v[80:83], a[116:119], v[120:123]
    ds_read_b64 v[72:73], v6 offset:24576
    v_mfma_f32_16x16x32_bf16 v[124:127], v[84:87], a[116:119], v[124:127]
    ds_read_b64 v[74:75], v6 offset:25088
    v_mfma_f32_16x16x32_bf16 v[128:131], v[88:91], a[116:119], v[128:131]
    buffer_load_dwordx4 a[180:183], v242, s[4:7], s85 offen offset:2048 sc1
    s_waitcnt lgkmcnt(4)
    v_mfma_f32_16x16x32_bf16 v[136:139], v[96:99], v[96:99], v[136:139]
    s_waitcnt vmcnt(17) lgkmcnt(3)
    ds_read_b64 v[92:93], v14 offset:8192
    v_mfma_f32_16x16x32_bf16 v[140:143], v[132:135], v[96:99], v[140:143]
    ds_read_b64 v[94:95], v14 offset:8704
    s_waitcnt vmcnt(16)
    s_barrier
    v_mfma_f32_16x16x32_bf16 v[100:103], v[44:47], a[120:123], v[100:103]
    ds_read2st64_b64 v[76:79], v5 offset0:10 offset1:11
    v_mfma_f32_16x16x32_bf16 v[104:107], v[48:51], a[120:123], v[104:107]
    ds_read_b64 v[80:81], v5 offset:25600
    v_mfma_f32_16x16x32_bf16 v[108:111], v[52:55], a[120:123], v[108:111]
    ds_read_b64 v[82:83], v5 offset:26112
    v_mfma_f32_16x16x32_bf16 v[112:115], v[56:59], a[120:123], v[112:115]
    buffer_load_dwordx4 a[184:187], v241, s[4:7], s85 offen offset:3072 sc1
    v_mfma_f32_16x16x32_bf16 v[116:119], v[44:47], a[124:127], v[116:119]
    ds_read2st64_b64 v[84:87], v5 offset0:90 offset1:91
    v_mfma_f32_16x16x32_bf16 v[120:123], v[48:51], a[124:127], v[120:123]
    ds_read_b64 v[88:89], v6 offset:25600
    v_mfma_f32_16x16x32_bf16 v[124:127], v[52:55], a[124:127], v[124:127]
    ds_read_b64 v[90:91], v6 offset:26112
    v_mfma_f32_16x16x32_bf16 v[128:131], v[56:59], a[124:127], v[128:131]
    buffer_load_dwordx4 a[188:191], v242, s[4:7], s85 offen offset:3072 sc1
    s_add_u32 s85, s85, 4096
    s_waitcnt lgkmcnt(4)
    v_mfma_f32_16x16x32_bf16 v[136:139], v[92:95], v[92:95], v[136:139]
    ds_read_b64 v[96:97], v14 offset:9216
    v_mfma_f32_16x16x32_bf16 v[140:143], v[132:135], v[92:95], v[140:143]
    ds_read_b64 v[98:99], v14 offset:9728
    v_mfma_f32_16x16x32_bf16 v[100:103], v[60:63], a[128:131], v[100:103]
    ds_read2st64_b64 v[44:47], v5 offset0:12 offset1:13
    v_mfma_f32_16x16x32_bf16 v[104:107], v[64:67], a[128:131], v[104:107]
    ds_read_b64 v[48:49], v5 offset:26624
    v_mfma_f32_16x16x32_bf16 v[108:111], v[68:71], a[128:131], v[108:111]
    ds_read_b64 v[50:51], v5 offset:27136
    v_mfma_f32_16x16x32_bf16 v[112:115], v[72:75], a[128:131], v[112:115]
    buffer_load_dwordx4 a[192:195], v241, s[4:7], s85 offen offset:0 sc1
    v_mfma_f32_16x16x32_bf16 v[116:119], v[60:63], a[132:135], v[116:119]
    ds_read2st64_b64 v[52:55], v5 offset0:92 offset1:93
    v_mfma_f32_16x16x32_bf16 v[120:123], v[64:67], a[132:135], v[120:123]
    ds_read_b64 v[56:57], v6 offset:26624
    v_mfma_f32_16x16x32_bf16 v[124:127], v[68:71], a[132:135], v[124:127]
    ds_read_b64 v[58:59], v6 offset:27136
    v_mfma_f32_16x16x32_bf16 v[128:131], v[72:75], a[132:135], v[128:131]
    buffer_load_dwordx4 a[196:199], v242, s[4:7], s85 offen offset:0 sc1
    s_waitcnt lgkmcnt(4)
    v_mfma_f32_16x16x32_bf16 v[136:139], v[96:99], v[96:99], v[136:139]
    s_waitcnt vmcnt(19) lgkmcnt(3)
    ds_read_b64 v[92:93], v14 offset:10240
    v_mfma_f32_16x16x32_bf16 v[140:143], v[132:135], v[96:99], v[140:143]
    ds_read_b64 v[94:95], v14 offset:10752
    v_mfma_f32_16x16x32_bf16 v[100:103], v[76:79], a[136:139], v[100:103]
    ds_read2st64_b64 v[60:63], v5 offset0:14 offset1:15
    v_mfma_f32_16x16x32_bf16 v[104:107], v[80:83], a[136:139], v[104:107]
    ds_read_b64 v[64:65], v5 offset:27648
    v_mfma_f32_16x16x32_bf16 v[108:111], v[84:87], a[136:139], v[108:111]
    ds_read_b64 v[66:67], v5 offset:28160
    v_mfma_f32_16x16x32_bf16 v[112:115], v[88:91], a[136:139], v[112:115]
    buffer_load_dwordx4 a[200:203], v241, s[4:7], s85 offen offset:1024 sc1
    v_mfma_f32_16x16x32_bf16 v[116:119], v[76:79], a[140:143], v[116:119]
    ds_read2st64_b64 v[68:71], v5 offset0:94 offset1:95
    v_mfma_f32_16x16x32_bf16 v[120:123], v[80:83], a[140:143], v[120:123]
    ds_read_b64 v[72:73], v6 offset:27648
    v_mfma_f32_16x16x32_bf16 v[124:127], v[84:87], a[140:143], v[124:127]
    ds_read_b64 v[74:75], v6 offset:28160
    v_mfma_f32_16x16x32_bf16 v[128:131], v[88:91], a[140:143], v[128:131]
    buffer_load_dwordx4 a[204:207], v242, s[4:7], s85 offen offset:1024 sc1
    s_waitcnt lgkmcnt(4)
    v_mfma_f32_16x16x32_bf16 v[136:139], v[92:95], v[92:95], v[136:139]
    s_waitcnt vmcnt(20) lgkmcnt(3)
    ds_read_b64 v[96:97], v14 offset:11264
    v_mfma_f32_16x16x32_bf16 v[140:143], v[132:135], v[92:95], v[140:143]
    ds_read_b64 v[98:99], v14 offset:11776
    v_mfma_f32_16x16x32_bf16 v[100:103], v[44:47], a[144:147], v[100:103]
    ds_read2st64_b64 v[76:79], v5 offset0:16 offset1:17
    v_mfma_f32_16x16x32_bf16 v[104:107], v[48:51], a[144:147], v[104:107]
    ds_read_b64 v[80:81], v5 offset:28672
    v_mfma_f32_16x16x32_bf16 v[108:111], v[52:55], a[144:147], v[108:111]
    ds_read_b64 v[82:83], v5 offset:29184
    v_mfma_f32_16x16x32_bf16 v[112:115], v[56:59], a[144:147], v[112:115]
    buffer_load_dwordx4 a[208:211], v241, s[4:7], s85 offen offset:2048 sc1
    v_mfma_f32_16x16x32_bf16 v[116:119], v[44:47], a[148:151], v[116:119]
    ds_read2st64_b64 v[84:87], v5 offset0:96 offset1:97
    v_mfma_f32_16x16x32_bf16 v[120:123], v[48:51], a[148:151], v[120:123]
    ds_read_b64 v[88:89], v6 offset:28672
    v_mfma_f32_16x16x32_bf16 v[124:127], v[52:55], a[148:151], v[124:127]
    ds_read_b64 v[90:91], v6 offset:29184
    v_mfma_f32_16x16x32_bf16 v[128:131], v[56:59], a[148:151], v[128:131]
    buffer_load_dwordx4 a[212:215], v242, s[4:7], s85 offen offset:2048 sc1
    s_waitcnt lgkmcnt(4)
    v_mfma_f32_16x16x32_bf16 v[136:139], v[96:99], v[96:99], v[136:139]
    s_waitcnt vmcnt(21) lgkmcnt(3)
    ds_read_b64 v[92:93], v14 offset:12288
    v_mfma_f32_16x16x32_bf16 v[140:143], v[132:135], v[96:99], v[140:143]
    ds_read_b64 v[94:95], v14 offset:12800
    v_mfma_f32_16x16x32_bf16 v[100:103], v[60:63], a[152:155], v[100:103]
    ds_read2st64_b64 v[44:47], v5 offset0:18 offset1:19
    v_mfma_f32_16x16x32_bf16 v[104:107], v[64:67], a[152:155], v[104:107]
    ds_read_b64 v[48:49], v5 offset:29696
    v_mfma_f32_16x16x32_bf16 v[108:111], v[68:71], a[152:155], v[108:111]
    ds_read_b64 v[50:51], v5 offset:30208
    v_mfma_f32_16x16x32_bf16 v[112:115], v[72:75], a[152:155], v[112:115]
    buffer_load_dwordx4 a[216:219], v241, s[4:7], s85 offen offset:3072 sc1
    v_mfma_f32_16x16x32_bf16 v[116:119], v[60:63], a[156:159], v[116:119]
    ds_read2st64_b64 v[52:55], v5 offset0:98 offset1:99
    v_mfma_f32_16x16x32_bf16 v[120:123], v[64:67], a[156:159], v[120:123]
    ds_read_b64 v[56:57], v6 offset:29696
    v_mfma_f32_16x16x32_bf16 v[124:127], v[68:71], a[156:159], v[124:127]
    ds_read_b64 v[58:59], v6 offset:30208
    v_mfma_f32_16x16x32_bf16 v[128:131], v[72:75], a[156:159], v[128:131]
    buffer_load_dwordx4 a[220:223], v242, s[4:7], s85 offen offset:3072 sc1
    s_add_u32 s85, s85, 4096
    s_waitcnt lgkmcnt(4)
    v_mfma_f32_16x16x32_bf16 v[136:139], v[92:95], v[92:95], v[136:139]
    s_waitcnt vmcnt(22) lgkmcnt(3)
    ds_read_b64 v[96:97], v14 offset:13312
    v_mfma_f32_16x16x32_bf16 v[140:143], v[132:135], v[92:95], v[140:143]
    ds_read_b64 v[98:99], v14 offset:13824
    s_waitcnt vmcnt(21)
    s_barrier
    s_waitcnt vmcnt(14)
    v_mfma_f32_16x16x32_bf16 v[100:103], v[76:79], a[160:163], v[100:103]
    ds_read2st64_b64 v[60:63], v5 offset0:20 offset1:21
    v_mfma_f32_16x16x32_bf16 v[104:107], v[80:83], a[160:163], v[104:107]
    ds_read_b64 v[64:65], v5 offset:30720
    v_mfma_f32_16x16x32_bf16 v[108:111], v[84:87], a[160:163], v[108:111]
    ds_read_b64 v[66:67], v5 offset:31232
    v_mfma_f32_16x16x32_bf16 v[112:115], v[88:91], a[160:163], v[112:115]
    buffer_load_dwordx4 a[224:227], v241, s[4:7], s85 offen offset:0 sc1
    v_mfma_f32_16x16x32_bf16 v[116:119], v[76:79], a[164:167], v[116:119]
    ds_read2st64_b64 v[68:71], v5 offset0:100 offset1:101
    v_mfma_f32_16x16x32_bf16 v[120:123], v[80:83], a[164:167], v[120:123]
    ds_read_b64 v[72:73], v6 offset:30720
    v_mfma_f32_16x16x32_bf16 v[124:127], v[84:87], a[164:167], v[124:127]
    ds_read_b64 v[74:75], v6 offset:31232
    v_mfma_f32_16x16x32_bf16 v[128:131], v[88:91], a[164:167], v[128:131]
    buffer_load_dwordx4 a[228:231], v242, s[4:7], s85 offen offset:0 sc1
    s_waitcnt lgkmcnt(4)
    v_mfma_f32_16x16x32_bf16 v[136:139], v[96:99], v[96:99], v[136:139]
    ds_read_b64 v[92:93], v14 offset:14336
    v_mfma_f32_16x16x32_bf16 v[140:143], v[132:135], v[96:99], v[140:143]
    ds_read_b64 v[94:95], v14 offset:14848
    s_waitcnt vmcnt(14) lgkmcnt(5)
    v_mfma_f32_16x16x32_bf16 v[100:103], v[44:47], a[168:171], v[100:103]
    ds_read2st64_b64 v[76:79], v5 offset0:22 offset1:23
    v_mfma_f32_16x16x32_bf16 v[104:107], v[48:51], a[168:171], v[104:107]
    ds_read_b64 v[80:81], v5 offset:31744
    v_mfma_f32_16x16x32_bf16 v[108:111], v[52:55], a[168:171], v[108:111]
    ds_read_b64 v[82:83], v5 offset:32256
    v_mfma_f32_16x16x32_bf16 v[112:115], v[56:59], a[168:171], v[112:115]
    buffer_load_dwordx4 a[232:235], v241, s[4:7], s85 offen offset:1024 sc1
    v_mfma_f32_16x16x32_bf16 v[116:119], v[44:47], a[172:175], v[116:119]
    ds_read2st64_b64 v[84:87], v5 offset0:102 offset1:103
    v_mfma_f32_16x16x32_bf16 v[120:123], v[48:51], a[172:175], v[120:123]
    ds_read_b64 v[88:89], v6 offset:31744
    v_mfma_f32_16x16x32_bf16 v[124:127], v[52:55], a[172:175], v[124:127]
    ds_read_b64 v[90:91], v6 offset:32256
    v_mfma_f32_16x16x32_bf16 v[128:131], v[56:59], a[172:175], v[128:131]
    buffer_load_dwordx4 a[236:239], v242, s[4:7], s85 offen offset:1024 sc1
    s_waitcnt lgkmcnt(4)
    v_mfma_f32_16x16x32_bf16 v[136:139], v[92:95], v[92:95], v[136:139]
    ds_read_b64 v[96:97], v14 offset:15360
    v_mfma_f32_16x16x32_bf16 v[140:143], v[132:135], v[92:95], v[140:143]
    ds_read_b64 v[98:99], v14 offset:15872
    s_waitcnt vmcnt(14) lgkmcnt(5)
    v_mfma_f32_16x16x32_bf16 v[100:103], v[60:63], a[176:179], v[100:103]
    ds_read2st64_b64 v[44:47], v5 offset0:24 offset1:25
    v_mfma_f32_16x16x32_bf16 v[104:107], v[64:67], a[176:179], v[104:107]
    ds_read_b64 v[48:49], v5 offset:32768
    v_mfma_f32_16x16x32_bf16 v[108:111], v[68:71], a[176:179], v[108:111]
    ds_read_b64 v[50:51], v5 offset:33280
    v_mfma_f32_16x16x32_bf16 v[112:115], v[72:75], a[176:179], v[112:115]
    buffer_load_dwordx4 a[240:243], v241, s[4:7], s85 offen offset:2048 sc1
    v_mfma_f32_16x16x32_bf16 v[116:119], v[60:63], a[180:183], v[116:119]
    ds_read2st64_b64 v[52:55], v5 offset0:104 offset1:105
    v_mfma_f32_16x16x32_bf16 v[120:123], v[64:67], a[180:183], v[120:123]
    ds_read_b64 v[56:57], v6 offset:32768
    v_mfma_f32_16x16x32_bf16 v[124:127], v[68:71], a[180:183], v[124:127]
    ds_read_b64 v[58:59], v6 offset:33280
    v_mfma_f32_16x16x32_bf16 v[128:131], v[72:75], a[180:183], v[128:131]
    buffer_load_dwordx4 a[244:247], v242, s[4:7], s85 offen offset:2048 sc1
    s_waitcnt lgkmcnt(4)
    v_mfma_f32_16x16x32_bf16 v[136:139], v[96:99], v[96:99], v[136:139]
    ds_read_b64 v[92:93], v14 offset:16384
    v_mfma_f32_16x16x32_bf16 v[140:143], v[132:135], v[96:99], v[140:143]
    ds_read_b64 v[94:95], v14 offset:16896
    s_waitcnt vmcnt(14) lgkmcnt(5)
    v_mfma_f32_16x16x32_bf16 v[100:103], v[76:79], a[184:187], v[100:103]
    ds_read2st64_b64 v[60:63], v5 offset0:26 offset1:27
    v_mfma_f32_16x16x32_bf16 v[104:107], v[80:83], a[184:187], v[104:107]
    ds_read_b64 v[64:65], v5 offset:33792
    v_mfma_f32_16x16x32_bf16 v[108:111], v[84:87], a[184:187], v[108:111]
    ds_read_b64 v[66:67], v5 offset:34304
    v_mfma_f32_16x16x32_bf16 v[112:115], v[88:91], a[184:187], v[112:115]
    buffer_load_dwordx4 a[248:251], v241, s[4:7], s85 offen offset:3072 sc1
    v_mfma_f32_16x16x32_bf16 v[116:119], v[76:79], a[188:191], v[116:119]
    ds_read2st64_b64 v[68:71], v5 offset0:106 offset1:107
    v_mfma_f32_16x16x32_bf16 v[120:123], v[80:83], a[188:191], v[120:123]
    ds_read_b64 v[72:73], v6 offset:33792
    v_mfma_f32_16x16x32_bf16 v[124:127], v[84:87], a[188:191], v[124:127]
    ds_read_b64 v[74:75], v6 offset:34304
    v_mfma_f32_16x16x32_bf16 v[128:131], v[88:91], a[188:191], v[128:131]
    buffer_load_dwordx4 a[252:255], v242, s[4:7], s85 offen offset:3072 sc1
    s_sub_u32 s85, s85, 159744
    s_waitcnt lgkmcnt(4)
    v_mfma_f32_16x16x32_bf16 v[136:139], v[92:95], v[92:95], v[136:139]
    ds_read_b64 v[96:97], v14 offset:17408
    v_mfma_f32_16x16x32_bf16 v[140:143], v[132:135], v[92:95], v[140:143]
    ds_read_b64 v[98:99], v14 offset:17920
    s_waitcnt vmcnt(14) lgkmcnt(5)
    v_mfma_f32_16x16x32_bf16 v[100:103], v[44:47], a[192:195], v[100:103]
    ds_read2st64_b64 v[76:79], v5 offset0:28 offset1:29
    v_mfma_f32_16x16x32_bf16 v[104:107], v[48:51], a[192:195], v[104:107]
    ds_read_b64 v[80:81], v5 offset:34816
    v_mfma_f32_16x16x32_bf16 v[108:111], v[52:55], a[192:195], v[108:111]
    ds_read_b64 v[82:83], v5 offset:35328
    v_mfma_f32_16x16x32_bf16 v[112:115], v[56:59], a[192:195], v[112:115]
    buffer_load_dwordx4 a[96:99], v241, s[4:7], s85 offen offset:0 sc1
    v_mfma_f32_16x16x32_bf16 v[116:119], v[44:47], a[196:199], v[116:119]
    ds_read2st64_b64 v[84:87], v5 offset0:108 offset1:109
    v_mfma_f32_16x16x32_bf16 v[120:123], v[48:51], a[196:199], v[120:123]
    ds_read_b64 v[88:89], v6 offset:34816
    v_mfma_f32_16x16x32_bf16 v[124:127], v[52:55], a[196:199], v[124:127]
    ds_read_b64 v[90:91], v6 offset:35328
    v_mfma_f32_16x16x32_bf16 v[128:131], v[56:59], a[196:199], v[128:131]
    buffer_load_dwordx4 a[100:103], v242, s[4:7], s85 offen offset:0 sc1
    s_waitcnt lgkmcnt(4)
    v_mfma_f32_16x16x32_bf16 v[136:139], v[96:99], v[96:99], v[136:139]
    ds_read_b64 v[92:93], v14 offset:18432
    v_mfma_f32_16x16x32_bf16 v[140:143], v[132:135], v[96:99], v[140:143]
    ds_read_b64 v[94:95], v14 offset:18944
    s_barrier
    s_waitcnt vmcnt(14) lgkmcnt(5)
    v_mfma_f32_16x16x32_bf16 v[100:103], v[60:63], a[200:203], v[100:103]
    ds_read2st64_b64 v[44:47], v5 offset0:30 offset1:31
    v_mfma_f32_16x16x32_bf16 v[104:107], v[64:67], a[200:203], v[104:107]
    ds_read_b64 v[48:49], v5 offset:35840
    v_mfma_f32_16x16x32_bf16 v[108:111], v[68:71], a[200:203], v[108:111]
    ds_read_b64 v[50:51], v5 offset:36352
    v_mfma_f32_16x16x32_bf16 v[112:115], v[72:75], a[200:203], v[112:115]
    buffer_load_dwordx4 a[104:107], v241, s[4:7], s85 offen offset:1024 sc1
    v_mfma_f32_16x16x32_bf16 v[116:119], v[60:63], a[204:207], v[116:119]
    ds_read2st64_b64 v[52:55], v5 offset0:110 offset1:111
    v_mfma_f32_16x16x32_bf16 v[120:123], v[64:67], a[204:207], v[120:123]
    ds_read_b64 v[56:57], v6 offset:35840
    v_mfma_f32_16x16x32_bf16 v[124:127], v[68:71], a[204:207], v[124:127]
    ds_read_b64 v[58:59], v6 offset:36352
    v_mfma_f32_16x16x32_bf16 v[128:131], v[72:75], a[204:207], v[128:131]
    buffer_load_dwordx4 a[108:111], v242, s[4:7], s85 offen offset:1024 sc1
    s_waitcnt lgkmcnt(4)
    v_mfma_f32_16x16x32_bf16 v[136:139], v[92:95], v[92:95], v[136:139]
    ds_read_b64 v[96:97], v14 offset:19456
    v_mfma_f32_16x16x32_bf16 v[140:143], v[132:135], v[92:95], v[140:143]
    ds_read_b64 v[98:99], v14 offset:19968
    s_waitcnt vmcnt(14) lgkmcnt(5)
    v_mfma_f32_16x16x32_bf16 v[100:103], v[76:79], a[208:211], v[100:103]
    ds_read2st64_b64 v[60:63], v5 offset0:32 offset1:33
    v_mfma_f32_16x16x32_bf16 v[104:107], v[80:83], a[208:211], v[104:107]
    ds_read_b64 v[64:65], v5 offset:36864
    v_mfma_f32_16x16x32_bf16 v[108:111], v[84:87], a[208:211], v[108:111]
    ds_read_b64 v[66:67], v5 offset:37376
    v_mfma_f32_16x16x32_bf16 v[112:115], v[88:91], a[208:211], v[112:115]
    buffer_load_dwordx4 a[112:115], v241, s[4:7], s85 offen offset:2048 sc1
    v_mfma_f32_16x16x32_bf16 v[116:119], v[76:79], a[212:215], v[116:119]
    ds_read2st64_b64 v[68:71], v5 offset0:112 offset1:113
    v_mfma_f32_16x16x32_bf16 v[120:123], v[80:83], a[212:215], v[120:123]
    ds_read_b64 v[72:73], v6 offset:36864
    v_mfma_f32_16x16x32_bf16 v[124:127], v[84:87], a[212:215], v[124:127]
    ds_read_b64 v[74:75], v6 offset:37376
    v_mfma_f32_16x16x32_bf16 v[128:131], v[88:91], a[212:215], v[128:131]
    buffer_load_dwordx4 a[116:119], v242, s[4:7], s85 offen offset:2048 sc1
    s_waitcnt lgkmcnt(4)
    v_mfma_f32_16x16x32_bf16 v[136:139], v[96:99], v[96:99], v[136:139]
    v_mfma_f32_16x16x32_bf16 v[140:143], v[132:135], v[96:99], v[140:143]
    s_waitcnt vmcnt(14) lgkmcnt(3)
    v_mfma_f32_16x16x32_bf16 v[100:103], v[44:47], a[216:219], v[100:103]
    ds_read2st64_b64 v[76:79], v5 offset0:34 offset1:35
    v_mfma_f32_16x16x32_bf16 v[104:107], v[48:51], a[216:219], v[104:107]
    ds_read_b64 v[80:81], v5 offset:37888
    v_mfma_f32_16x16x32_bf16 v[108:111], v[52:55], a[216:219], v[108:111]
    ds_read_b64 v[82:83], v5 offset:38400
    v_mfma_f32_16x16x32_bf16 v[112:115], v[56:59], a[216:219], v[112:115]
    buffer_load_dwordx4 a[120:123], v241, s[4:7], s85 offen offset:3072 sc1
    v_mfma_f32_16x16x32_bf16 v[116:119], v[44:47], a[220:223], v[116:119]
    ds_read2st64_b64 v[84:87], v5 offset0:114 offset1:115
    v_mfma_f32_16x16x32_bf16 v[120:123], v[48:51], a[220:223], v[120:123]
    ds_read_b64 v[88:89], v6 offset:37888
    v_mfma_f32_16x16x32_bf16 v[124:127], v[52:55], a[220:223], v[124:127]
    ds_read_b64 v[90:91], v6 offset:38400
    v_mfma_f32_16x16x32_bf16 v[128:131], v[56:59], a[220:223], v[128:131]
    buffer_load_dwordx4 a[124:127], v242, s[4:7], s85 offen offset:3072 sc1
    s_add_u32 s85, s85, 4096
    s_waitcnt vmcnt(14) lgkmcnt(4)
    v_mfma_f32_16x16x32_bf16 v[100:103], v[60:63], a[224:227], v[100:103]
    ds_read2st64_b64 v[44:47], v5 offset0:36 offset1:37
    v_and_b32 v3, 3, v0
    v_mfma_f32_16x16x32_bf16 v[104:107], v[64:67], a[224:227], v[104:107]
    ds_read_b64 v[48:49], v5 offset:38912
    v_cmp_eq_u32 vcc, 1, v3
    v_mfma_f32_16x16x32_bf16 v[108:111], v[68:71], a[224:227], v[108:111]
    ds_read_b64 v[50:51], v5 offset:39424
    v_cndmask_b32 v136, v136, v137, vcc
    v_mfma_f32_16x16x32_bf16 v[112:115], v[72:75], a[224:227], v[112:115]
    buffer_load_dwordx4 a[128:131], v241, s[4:7], s85 offen offset:0 sc1
    v_mfma_f32_16x16x32_bf16 v[116:119], v[60:63], a[228:231], v[116:119]
    ds_read2st64_b64 v[52:55], v5 offset0:116 offset1:117
    v_cmp_eq_u32 vcc, 2, v3
    v_mfma_f32_16x16x32_bf16 v[120:123], v[64:67], a[228:231], v[120:123]
    ds_read_b64 v[56:57], v6 offset:38912
    v_cndmask_b32 v136, v136, v138, vcc
    v_mfma_f32_16x16x32_bf16 v[124:127], v[68:71], a[228:231], v[124:127]
    ds_read_b64 v[58:59], v6 offset:39424
    v_cmp_eq_u32 vcc, 3, v3
    v_mfma_f32_16x16x32_bf16 v[128:131], v[72:75], a[228:231], v[128:131]
    buffer_load_dwordx4 a[132:135], v242, s[4:7], s85 offen offset:0 sc1
    s_waitcnt vmcnt(14) lgkmcnt(3)
    v_mfma_f32_16x16x32_bf16 v[100:103], v[76:79], a[232:235], v[100:103]
    ds_read2st64_b64 v[60:63], v5 offset0:38 offset1:39
    v_cndmask_b32 v136, v136, v139, vcc
    v_mfma_f32_16x16x32_bf16 v[104:107], v[80:83], a[232:235], v[104:107]
    ds_read_b64 v[64:65], v5 offset:39936
    v_mul_f32 v140, 0xbacccccd, v140
    v_mfma_f32_16x16x32_bf16 v[108:111], v[84:87], a[232:235], v[108:111]
    ds_read_b64 v[66:67], v5 offset:40448
    v_mul_f32 v136, 0x3acccccd, v136
    v_mfma_f32_16x16x32_bf16 v[112:115], v[88:91], a[232:235], v[112:115]
    buffer_load_dwordx4 a[136:139], v241, s[4:7], s85 offen offset:1024 sc1
    v_mfma_f32_16x16x32_bf16 v[116:119], v[76:79], a[236:239], v[116:119]
    ds_read2st64_b64 v[68:71], v5 offset0:118 offset1:119
    v_fma_f32 v136, -v140, v140, v136
    v_mfma_f32_16x16x32_bf16 v[120:123], v[80:83], a[236:239], v[120:123]
    ds_read_b64 v[72:73], v6 offset:39936
    v_max_f32 v136, 0, v136
    v_mfma_f32_16x16x32_bf16 v[124:127], v[84:87], a[236:239], v[124:127]
    ds_read_b64 v[74:75], v6 offset:40448
    v_add_f32 v136, 0x3727c5ac, v136
    v_mfma_f32_16x16x32_bf16 v[128:131], v[88:91], a[236:239], v[128:131]
    buffer_load_dwordx4 a[140:143], v242, s[4:7], s85 offen offset:1024 sc1
    s_waitcnt vmcnt(14) lgkmcnt(3)
    v_mfma_f32_16x16x32_bf16 v[100:103], v[44:47], a[240:243], v[100:103]
    v_rsq_f32 v136, v136
    v_mfma_f32_16x16x32_bf16 v[104:107], v[48:51], a[240:243], v[104:107]
    v_lshrrev_b32 v3, 2, v1
    v_cmp_eq_u32 vcc, v3, v2
    v_mfma_f32_16x16x32_bf16 v[108:111], v[52:55], a[240:243], v[108:111]
    s_lshl_b32 s62, s82, 6
    s_add_u32 s62, s62, 81920
    v_lshl_add_u32 v3, v1, 2, s62
    v_mfma_f32_16x16x32_bf16 v[112:115], v[56:59], a[240:243], v[112:115]
    buffer_load_dwordx4 a[144:147], v241, s[4:7], s85 offen offset:2048 sc1
    v_mfma_f32_16x16x32_bf16 v[116:119], v[44:47], a[244:247], v[116:119]
    s_mov_b64 exec, vcc
    ds_write2st64_b32 v3, v136, v140 offset0:0 offset1:1
    s_mov_b64 exec, -1
    v_mfma_f32_16x16x32_bf16 v[120:123], v[48:51], a[244:247], v[120:123]
    v_mfma_f32_16x16x32_bf16 v[124:127], v[52:55], a[244:247], v[124:127]
    v_mfma_f32_16x16x32_bf16 v[128:131], v[56:59], a[244:247], v[128:131]
    buffer_load_dwordx4 a[148:151], v242, s[4:7], s85 offen offset:2048 sc1
    s_waitcnt vmcnt(14) lgkmcnt(1)
    v_mfma_f32_16x16x32_bf16 v[100:103], v[60:63], a[248:251], v[100:103]
    v_mfma_f32_16x16x32_bf16 v[104:107], v[64:67], a[248:251], v[104:107]
    v_mfma_f32_16x16x32_bf16 v[108:111], v[68:71], a[248:251], v[108:111]
    v_mfma_f32_16x16x32_bf16 v[112:115], v[72:75], a[248:251], v[112:115]
    buffer_load_dwordx4 a[152:155], v241, s[4:7], s85 offen offset:3072 sc1
    v_mfma_f32_16x16x32_bf16 v[116:119], v[60:63], a[252:255], v[116:119]
    v_mfma_f32_16x16x32_bf16 v[120:123], v[64:67], a[252:255], v[120:123]
    v_mfma_f32_16x16x32_bf16 v[124:127], v[68:71], a[252:255], v[124:127]
    v_mfma_f32_16x16x32_bf16 v[128:131], v[72:75], a[252:255], v[128:131]
    buffer_load_dwordx4 a[156:159], v242, s[4:7], s85 offen offset:3072 sc1
    s_add_u32 s85, s85, 4096
    s_waitcnt lgkmcnt(0)
    s_barrier
    v_add_u32 v3, 81920, v7
    ds_read_b128 v[180:183], v3 offset:256
    ds_read_b128 v[164:167], v3 offset:0
    ds_read_b128 v[184:187], v3 offset:320
    ds_read_b128 v[168:171], v3 offset:64
    ds_read_b128 v[188:191], v3 offset:384
    ds_read_b128 v[172:175], v3 offset:128
    ds_read_b128 v[192:195], v3 offset:448
    ds_read_b128 v[176:179], v3 offset:192
    s_waitcnt lgkmcnt(7)
    v_pk_fma_f32 v[100:101], v[180:181], v[212:213], v[100:101] op_sel:[0,0,0] op_sel_hi:[1,0,1]
    v_pk_fma_f32 v[102:103], v[182:183], v[212:213], v[102:103] op_sel:[0,0,0] op_sel_hi:[1,0,1]
    v_pk_fma_f32 v[116:117], v[180:181], v[214:215], v[116:117] op_sel:[0,0,0] op_sel_hi:[1,0,1]
    buffer_load_dwordx4 a[160:163], v241, s[4:7], s85 offen offset:0 sc1
    v_pk_fma_f32 v[118:119], v[182:183], v[214:215], v[118:119] op_sel:[0,0,0] op_sel_hi:[1,0,1]
    s_waitcnt lgkmcnt(6)
    v_pk_fma_f32 v[100:101], v[100:101], v[164:165], v[212:213] op_sel:[0,0,1] op_sel_hi:[1,1,1]
    v_pk_fma_f32 v[102:103], v[102:103], v[166:167], v[212:213] op_sel:[0,0,1] op_sel_hi:[1,1,1]
    v_pk_fma_f32 v[116:117], v[116:117], v[164:165], v[214:215] op_sel:[0,0,1] op_sel_hi:[1,1,1]
    v_pk_fma_f32 v[118:119], v[118:119], v[166:167], v[214:215] op_sel:[0,0,1] op_sel_hi:[1,1,1]
    v_pk_mul_f32 v[216:217], v[100:101], v[100:101]
    v_pk_mul_f32 v[218:219], v[102:103], v[102:103]
    v_pk_mul_f32 v[220:221], v[116:117], v[116:117]
    v_pk_mul_f32 v[222:223], v[118:119], v[118:119]
    v_pk_fma_f32 v[216:217], v[216:217], s[70:71], s[70:71] op_sel:[0,0,1] op_sel_hi:[1,0,1]
    v_pk_fma_f32 v[218:219], v[218:219], s[70:71], s[70:71] op_sel:[0,0,1] op_sel_hi:[1,0,1]
    v_pk_fma_f32 v[220:221], v[220:221], s[70:71], s[70:71] op_sel:[0,0,1] op_sel_hi:[1,0,1]
    buffer_load_dwordx4 a[164:167], v242, s[4:7], s85 offen offset:0 sc1
    v_pk_fma_f32 v[222:223], v[222:223], s[70:71], s[70:71] op_sel:[0,0,1] op_sel_hi:[1,0,1]
    v_pk_mul_f32 v[216:217], v[216:217], v[100:101]
    v_pk_mul_f32 v[218:219], v[218:219], v[102:103]
    v_pk_mul_f32 v[220:221], v[220:221], v[116:117]
    v_pk_mul_f32 v[222:223], v[222:223], v[118:119]
    v_exp_f32 v216, v216
    v_exp_f32 v217, v217
    v_exp_f32 v218, v218
    v_exp_f32 v219, v219
    v_exp_f32 v220, v220
    v_exp_f32 v221, v221
    v_exp_f32 v222, v222
    buffer_load_dwordx4 a[168:171], v241, s[4:7], s85 offen offset:1024 sc1
    v_exp_f32 v223, v223
    v_pk_add_f32 v[216:217], v[216:217], s[72:73]
    v_pk_add_f32 v[218:219], v[218:219], s[72:73]
    v_pk_add_f32 v[220:221], v[220:221], s[72:73]
    v_pk_add_f32 v[222:223], v[222:223], s[72:73]
    v_rcp_f32 v216, v216
    v_rcp_f32 v217, v217
    v_rcp_f32 v218, v218
    v_rcp_f32 v219, v219
    v_rcp_f32 v220, v220
    v_rcp_f32 v221, v221
    v_rcp_f32 v222, v222
    buffer_load_dwordx4 a[172:175], v242, s[4:7], s85 offen offset:1024 sc1
    v_rcp_f32 v223, v223
    v_pk_mul_f32 v[100:101], v[100:101], v[216:217]
    v_pk_mul_f32 v[102:103], v[102:103], v[218:219]
    v_pk_mul_f32 v[116:117], v[116:117], v[220:221]
    v_pk_mul_f32 v[118:119], v[118:119], v[222:223]
    v_pk_add_f32 v[164:165], v[100:101], v[116:117]
    v_pk_mul_f32 v[180:181], v[100:101], v[100:101]
    v_pk_add_f32 v[166:167], v[102:103], v[118:119]
    v_pk_mul_f32 v[182:183], v[102:103], v[102:103]
    v_pk_fma_f32 v[180:181], v[116:117], v[116:117], v[180:181]
    v_pk_fma_f32 v[182:183], v[118:119], v[118:119], v[182:183]
    s_waitcnt lgkmcnt(0)
    v_pk_fma_f32 v[104:105], v[184:185], v[212:213], v[104:105] op_sel:[0,0,0] op_sel_hi:[1,0,1]
    buffer_load_dwordx4 a[176:179], v241, s[4:7], s85 offen offset:2048 sc1
    v_pk_fma_f32 v[106:107], v[186:187], v[212:213], v[106:107] op_sel:[0,0,0] op_sel_hi:[1,0,1]
    v_pk_fma_f32 v[120:121], v[184:185], v[214:215], v[120:121] op_sel:[0,0,0] op_sel_hi:[1,0,1]
    v_pk_fma_f32 v[122:123], v[186:187], v[214:215], v[122:123] op_sel:[0,0,0] op_sel_hi:[1,0,1]
    v_pk_fma_f32 v[104:105], v[104:105], v[168:169], v[212:213] op_sel:[0,0,1] op_sel_hi:[1,1,1]
    v_pk_fma_f32 v[106:107], v[106:107], v[170:171], v[212:213] op_sel:[0,0,1] op_sel_hi:[1,1,1]
    v_pk_fma_f32 v[120:121], v[120:121], v[168:169], v[214:215] op_sel:[0,0,1] op_sel_hi:[1,1,1]
    v_pk_fma_f32 v[122:123], v[122:123], v[170:171], v[214:215] op_sel:[0,0,1] op_sel_hi:[1,1,1]
    v_pk_mul_f32 v[216:217], v[104:105], v[104:105]
    v_pk_mul_f32 v[218:219], v[106:107], v[106:107]
    v_pk_mul_f32 v[220:221], v[120:121], v[120:121]
    v_pk_mul_f32 v[222:223], v[122:123], v[122:123]
    v_pk_fma_f32 v[216:217], v[216:217], s[70:71], s[70:71] op_sel:[0,0,1] op_sel_hi:[1,0,1]
    buffer_load_dwordx4 a[180:183], v242, s[4:7], s85 offen offset:2048 sc1
    v_pk_fma_f32 v[218:219], v[218:219], s[70:71], s[70:71] op_sel:[0,0,1] op_sel_hi:[1,0,1]
    v_pk_fma_f32 v[220:221], v[220:221], s[70:71], s[70:71] op_sel:[0,0,1] op_sel_hi:[1,0,1]
    v_pk_fma_f32 v[222:223], v[222:223], s[70:71], s[70:71] op_sel:[0,0,1] op_sel_hi:[1,0,1]
    v_pk_mul_f32 v[216:217], v[216:217], v[104:105]
    v_pk_mul_f32 v[218:219], v[218:219], v[106:107]
    v_pk_mul_f32 v[220:221], v[220:221], v[120:121]
    v_pk_mul_f32 v[222:223], v[222:223], v[122:123]
    v_exp_f32 v216, v216
    v_exp_f32 v217, v217
    v_exp_f32 v218, v218
    v_exp_f32 v219, v219
    v_exp_f32 v220, v220
    buffer_load_dwordx4 a[184:187], v241, s[4:7], s85 offen offset:3072 sc1
    v_exp_f32 v221, v221
    v_exp_f32 v222, v222
    v_exp_f32 v223, v223
    v_pk_add_f32 v[216:217], v[216:217], s[72:73]
    v_pk_add_f32 v[218:219], v[218:219], s[72:73]
    v_pk_add_f32 v[220:221], v[220:221], s[72:73]
    v_pk_add_f32 v[222:223], v[222:223], s[72:73]
    v_rcp_f32 v216, v216
    v_rcp_f32 v217, v217
    v_rcp_f32 v218, v218
    v_rcp_f32 v219, v219
    v_rcp_f32 v220, v220
    buffer_load_dwordx4 a[188:191], v242, s[4:7], s85 offen offset:3072 sc1
    s_add_u32 s85, s85, 4096
    v_rcp_f32 v221, v221
    v_rcp_f32 v222, v222
    v_rcp_f32 v223, v223
    v_pk_mul_f32 v[104:105], v[104:105], v[216:217]
    v_pk_mul_f32 v[106:107], v[106:107], v[218:219]
    v_pk_mul_f32 v[120:121], v[120:121], v[220:221]
    v_pk_mul_f32 v[122:123], v[122:123], v[222:223]
    v_pk_add_f32 v[168:169], v[104:105], v[120:121]
    v_pk_mul_f32 v[184:185], v[104:105], v[104:105]
    v_pk_add_f32 v[170:171], v[106:107], v[122:123]
    v_pk_mul_f32 v[186:187], v[106:107], v[106:107]
    v_pk_fma_f32 v[184:185], v[120:121], v[120:121], v[184:185]
    buffer_load_dwordx4 a[192:195], v241, s[4:7], s85 offen offset:0 sc1
    v_pk_fma_f32 v[186:187], v[122:123], v[122:123], v[186:187]
    v_pk_fma_f32 v[108:109], v[188:189], v[212:213], v[108:109] op_sel:[0,0,0] op_sel_hi:[1,0,1]
    v_pk_fma_f32 v[110:111], v[190:191], v[212:213], v[110:111] op_sel:[0,0,0] op_sel_hi:[1,0,1]
    v_pk_fma_f32 v[124:125], v[188:189], v[214:215], v[124:125] op_sel:[0,0,0] op_sel_hi:[1,0,1]
    v_pk_fma_f32 v[126:127], v[190:191], v[214:215], v[126:127] op_sel:[0,0,0] op_sel_hi:[1,0,1]
    v_pk_fma_f32 v[108:109], v[108:109], v[172:173], v[212:213] op_sel:[0,0,1] op_sel_hi:[1,1,1]
    v_pk_fma_f32 v[110:111], v[110:111], v[174:175], v[212:213] op_sel:[0,0,1] op_sel_hi:[1,1,1]
    v_pk_fma_f32 v[124:125], v[124:125], v[172:173], v[214:215] op_sel:[0,0,1] op_sel_hi:[1,1,1]
    v_pk_fma_f32 v[126:127], v[126:127], v[174:175], v[214:215] op_sel:[0,0,1] op_sel_hi:[1,1,1]
    v_pk_mul_f32 v[216:217], v[108:109], v[108:109]
    v_pk_mul_f32 v[218:219], v[110:111], v[110:111]
    v_pk_mul_f32 v[220:221], v[124:125], v[124:125]
    buffer_load_dwordx4 a[196:199], v242, s[4:7], s85 offen offset:0 sc1
    v_pk_mul_f32 v[222:223], v[126:127], v[126:127]
    v_pk_fma_f32 v[216:217], v[216:217], s[70:71], s[70:71] op_sel:[0,0,1] op_sel_hi:[1,0,1]
    v_pk_fma_f32 v[218:219], v[218:219], s[70:71], s[70:71] op_sel:[0,0,1] op_sel_hi:[1,0,1]
    v_pk_fma_f32 v[220:221], v[220:221], s[70:71], s[70:71] op_sel:[0,0,1] op_sel_hi:[1,0,1]
    v_pk_fma_f32 v[222:223], v[222:223], s[70:71], s[70:71] op_sel:[0,0,1] op_sel_hi:[1,0,1]
    v_pk_mul_f32 v[216:217], v[216:217], v[108:109]
    v_pk_mul_f32 v[218:219], v[218:219], v[110:111]
    v_pk_mul_f32 v[220:221], v[220:221], v[124:125]
    v_pk_mul_f32 v[222:223], v[222:223], v[126:127]
    v_exp_f32 v216, v216
    v_exp_f32 v217, v217
    v_exp_f32 v218, v218
    buffer_load_dwordx4 a[200:203], v241, s[4:7], s85 offen offset:1024 sc1
    v_exp_f32 v219, v219
    v_exp_f32 v220, v220
    v_exp_f32 v221, v221
    v_exp_f32 v222, v222
    v_exp_f32 v223, v223
    v_pk_add_f32 v[216:217], v[216:217], s[72:73]
    v_pk_add_f32 v[218:219], v[218:219], s[72:73]
    v_pk_add_f32 v[220:221], v[220:221], s[72:73]
    v_pk_add_f32 v[222:223], v[222:223], s[72:73]
    v_rcp_f32 v216, v216
    v_rcp_f32 v217, v217
    v_rcp_f32 v218, v218
    buffer_load_dwordx4 a[204:207], v242, s[4:7], s85 offen offset:1024 sc1
    v_rcp_f32 v219, v219
    v_rcp_f32 v220, v220
    v_rcp_f32 v221, v221
    v_rcp_f32 v222, v222
    v_rcp_f32 v223, v223
    v_pk_mul_f32 v[108:109], v[108:109], v[216:217]
    v_pk_mul_f32 v[110:111], v[110:111], v[218:219]
    v_pk_mul_f32 v[124:125], v[124:125], v[220:221]
    v_pk_mul_f32 v[126:127], v[126:127], v[222:223]
    v_pk_add_f32 v[172:173], v[108:109], v[124:125]
    v_pk_mul_f32 v[188:189], v[108:109], v[108:109]
    v_pk_add_f32 v[174:175], v[110:111], v[126:127]
    buffer_load_dwordx4 a[208:211], v241, s[4:7], s85 offen offset:2048 sc1
    v_pk_mul_f32 v[190:191], v[110:111], v[110:111]
    v_pk_fma_f32 v[188:189], v[124:125], v[124:125], v[188:189]
    v_pk_fma_f32 v[190:191], v[126:127], v[126:127], v[190:191]
    v_pk_fma_f32 v[112:113], v[192:193], v[212:213], v[112:113] op_sel:[0,0,0] op_sel_hi:[1,0,1]
    v_pk_fma_f32 v[114:115], v[194:195], v[212:213], v[114:115] op_sel:[0,0,0] op_sel_hi:[1,0,1]
    v_pk_fma_f32 v[128:129], v[192:193], v[214:215], v[128:129] op_sel:[0,0,0] op_sel_hi:[1,0,1]
    v_pk_fma_f32 v[130:131], v[194:195], v[214:215], v[130:131] op_sel:[0,0,0] op_sel_hi:[1,0,1]
    v_pk_fma_f32 v[112:113], v[112:113], v[176:177], v[212:213] op_sel:[0,0,1] op_sel_hi:[1,1,1]
    v_pk_fma_f32 v[114:115], v[114:115], v[178:179], v[212:213] op_sel:[0,0,1] op_sel_hi:[1,1,1]
    v_pk_fma_f32 v[128:129], v[128:129], v[176:177], v[214:215] op_sel:[0,0,1] op_sel_hi:[1,1,1]
    v_pk_fma_f32 v[130:131], v[130:131], v[178:179], v[214:215] op_sel:[0,0,1] op_sel_hi:[1,1,1]
    v_pk_mul_f32 v[216:217], v[112:113], v[112:113]
    buffer_load_dwordx4 a[212:215], v242, s[4:7], s85 offen offset:2048 sc1
    v_pk_mul_f32 v[218:219], v[114:115], v[114:115]
    v_pk_mul_f32 v[220:221], v[128:129], v[128:129]
    v_pk_mul_f32 v[222:223], v[130:131], v[130:131]
    v_pk_fma_f32 v[216:217], v[216:217], s[70:71], s[70:71] op_sel:[0,0,1] op_sel_hi:[1,0,1]
    v_pk_fma_f32 v[218:219], v[218:219], s[70:71], s[70:71] op_sel:[0,0,1] op_sel_hi:[1,0,1]
    v_pk_fma_f32 v[220:221], v[220:221], s[70:71], s[70:71] op_sel:[0,0,1] op_sel_hi:[1,0,1]
    v_pk_fma_f32 v[222:223], v[222:223], s[70:71], s[70:71] op_sel:[0,0,1] op_sel_hi:[1,0,1]
    v_pk_mul_f32 v[216:217], v[216:217], v[112:113]
    v_pk_mul_f32 v[218:219], v[218:219], v[114:115]
    v_pk_mul_f32 v[220:221], v[220:221], v[128:129]
    v_pk_mul_f32 v[222:223], v[222:223], v[130:131]
    v_exp_f32 v216, v216
    buffer_load_dwordx4 a[216:219], v241, s[4:7], s85 offen offset:3072 sc1
    v_exp_f32 v217, v217
    v_exp_f32 v218, v218
    v_exp_f32 v219, v219
    v_exp_f32 v220, v220
    v_exp_f32 v221, v221
    v_exp_f32 v222, v222
    v_exp_f32 v223, v223
    v_pk_add_f32 v[216:217], v[216:217], s[72:73]
    v_pk_add_f32 v[218:219], v[218:219], s[72:73]
    v_pk_add_f32 v[220:221], v[220:221], s[72:73]
    v_pk_add_f32 v[222:223], v[222:223], s[72:73]
    v_rcp_f32 v216, v216
    buffer_load_dwordx4 a[220:223], v242, s[4:7], s85 offen offset:3072 sc1
    s_add_u32 s85, s85, 4096
    v_rcp_f32 v217, v217
    v_rcp_f32 v218, v218
    v_rcp_f32 v219, v219
    v_rcp_f32 v220, v220
    v_rcp_f32 v221, v221
    v_rcp_f32 v222, v222
    v_rcp_f32 v223, v223
    v_pk_mul_f32 v[112:113], v[112:113], v[216:217]
    v_pk_mul_f32 v[114:115], v[114:115], v[218:219]
    v_pk_mul_f32 v[128:129], v[128:129], v[220:221]
    v_pk_mul_f32 v[130:131], v[130:131], v[222:223]
    v_pk_add_f32 v[176:177], v[112:113], v[128:129]
    buffer_load_dwordx4 a[224:227], v241, s[4:7], s85 offen offset:0 sc1
    v_pk_mul_f32 v[192:193], v[112:113], v[112:113]
    v_pk_add_f32 v[178:179], v[114:115], v[130:131]
    v_pk_mul_f32 v[194:195], v[114:115], v[114:115]
    v_pk_fma_f32 v[192:193], v[128:129], v[128:129], v[192:193]
    v_pk_fma_f32 v[194:195], v[130:131], v[130:131], v[194:195]
    v_add_f32_dpp v164, v164, v164 row_ror:8 row_mask:0xf bank_mask:3
    v_add_f32_dpp v165, v165, v165 row_ror:8 row_mask:0xf bank_mask:3
    v_add_f32_dpp v166, v166, v166 row_ror:8 row_mask:0xf bank_mask:3
    v_add_f32_dpp v167, v167, v167 row_ror:8 row_mask:0xf bank_mask:3
    v_add_f32_dpp v168, v168, v168 row_ror:8 row_mask:0xf bank_mask:3
    v_add_f32_dpp v169, v169, v169 row_ror:8 row_mask:0xf bank_mask:3
    v_add_f32_dpp v170, v170, v170 row_ror:8 row_mask:0xf bank_mask:3
    buffer_load_dwordx4 a[228:231], v242, s[4:7], s85 offen offset:0 sc1
    v_add_f32_dpp v171, v171, v171 row_ror:8 row_mask:0xf bank_mask:3
    v_add_f32_dpp v172, v172, v172 row_ror:8 row_mask:0xf bank_mask:3
    v_add_f32_dpp v173, v173, v173 row_ror:8 row_mask:0xf bank_mask:3
    v_add_f32_dpp v174, v174, v174 row_ror:8 row_mask:0xf bank_mask:3
    v_add_f32_dpp v175, v175, v175 row_ror:8 row_mask:0xf bank_mask:3
    v_add_f32_dpp v176, v176, v176 row_ror:8 row_mask:0xf bank_mask:3
    v_add_f32_dpp v177, v177, v177 row_ror:8 row_mask:0xf bank_mask:3
    v_add_f32_dpp v178, v178, v178 row_ror:8 row_mask:0xf bank_mask:3
    v_add_f32_dpp v179, v179, v179 row_ror:8 row_mask:0xf bank_mask:3
    v_add_f32_dpp v164, v180, v180 row_ror:8 row_mask:0xf bank_mask:12
    v_add_f32_dpp v165, v181, v181 row_ror:8 row_mask:0xf bank_mask:12
    v_add_f32_dpp v166, v182, v182 row_ror:8 row_mask:0xf bank_mask:12
    buffer_load_dwordx4 a[232:235], v241, s[4:7], s85 offen offset:1024 sc1
    v_add_f32_dpp v167, v183, v183 row_ror:8 row_mask:0xf bank_mask:12
    v_add_f32_dpp v168, v184, v184 row_ror:8 row_mask:0xf bank_mask:12
    v_add_f32_dpp v169, v185, v185 row_ror:8 row_mask:0xf bank_mask:12
    v_add_f32_dpp v170, v186, v186 row_ror:8 row_mask:0xf bank_mask:12
    v_add_f32_dpp v171, v187, v187 row_ror:8 row_mask:0xf bank_mask:12
    v_add_f32_dpp v172, v188, v188 row_ror:8 row_mask:0xf bank_mask:12
    v_add_f32_dpp v173, v189, v189 row_ror:8 row_mask:0xf bank_mask:12
    v_add_f32_dpp v174, v190, v190 row_ror:8 row_mask:0xf bank_mask:12
    v_add_f32_dpp v175, v191, v191 row_ror:8 row_mask:0xf bank_mask:12
    v_add_f32_dpp v176, v192, v192 row_ror:8 row_mask:0xf bank_mask:12
    v_add_f32_dpp v177, v193, v193 row_ror:8 row_mask:0xf bank_mask:12
    v_add_f32_dpp v178, v194, v194 row_ror:8 row_mask:0xf bank_mask:12
    buffer_load_dwordx4 a[236:239], v242, s[4:7], s85 offen offset:1024 sc1
    v_add_f32_dpp v179, v195, v195 row_ror:8 row_mask:0xf bank_mask:12
    v_add_f32_dpp v164, v164, v164 row_half_mirror row_mask:0xf bank_mask:5
    v_add_f32_dpp v165, v165, v165 row_half_mirror row_mask:0xf bank_mask:5
    v_add_f32_dpp v166, v166, v166 row_half_mirror row_mask:0xf bank_mask:5
    v_add_f32_dpp v167, v167, v167 row_half_mirror row_mask:0xf bank_mask:5
    v_add_f32_dpp v168, v168, v168 row_half_mirror row_mask:0xf bank_mask:5
    v_add_f32_dpp v169, v169, v169 row_half_mirror row_mask:0xf bank_mask:5
    v_add_f32_dpp v170, v170, v170 row_half_mirror row_mask:0xf bank_mask:5
    v_add_f32_dpp v171, v171, v171 row_half_mirror row_mask:0xf bank_mask:5
    v_add_f32_dpp v164, v172, v172 row_half_mirror row_mask:0xf bank_mask:10
    v_add_f32_dpp v165, v173, v173 row_half_mirror row_mask:0xf bank_mask:10
    v_add_f32_dpp v166, v174, v174 row_half_mirror row_mask:0xf bank_mask:10
    buffer_load_dwordx4 a[240:243], v241, s[4:7], s85 offen offset:2048 sc1
    v_add_f32_dpp v167, v175, v175 row_half_mirror row_mask:0xf bank_mask:10
    v_add_f32_dpp v168, v176, v176 row_half_mirror row_mask:0xf bank_mask:10
    v_add_f32_dpp v169, v177, v177 row_half_mirror row_mask:0xf bank_mask:10
    v_add_f32_dpp v170, v178, v178 row_half_mirror row_mask:0xf bank_mask:10
    v_add_f32_dpp v171, v179, v179 row_half_mirror row_mask:0xf bank_mask:10
    v_add_f32_dpp v164, v164, v164 quad_perm:[1,0,3,2] row_mask:0xf bank_mask:0xf
    v_add_f32_dpp v165, v165, v165 quad_perm:[1,0,3,2] row_mask:0xf bank_mask:0xf
    v_add_f32_dpp v166, v166, v166 quad_perm:[1,0,3,2] row_mask:0xf bank_mask:0xf
    v_add_f32_dpp v167, v167, v167 quad_perm:[1,0,3,2] row_mask:0xf bank_mask:0xf
    v_add_f32_dpp v168, v168, v168 quad_perm:[1,0,3,2] row_mask:0xf bank_mask:0xf
    v_add_f32_dpp v169, v169, v169 quad_perm:[1,0,3,2] row_mask:0xf bank_mask:0xf
    v_add_f32_dpp v170, v170, v170 quad_perm:[1,0,3,2] row_mask:0xf bank_mask:0xf
    buffer_load_dwordx4 a[244:247], v242, s[4:7], s85 offen offset:2048 sc1
    v_add_f32_dpp v171, v171, v171 quad_perm:[1,0,3,2] row_mask:0xf bank_mask:0xf
    v_add_f32_dpp v164, v164, v164 quad_perm:[2,3,0,1] row_mask:0xf bank_mask:0xf
    v_add_f32_dpp v165, v165, v165 quad_perm:[2,3,0,1] row_mask:0xf bank_mask:0xf
    v_add_f32_dpp v166, v166, v166 quad_perm:[2,3,0,1] row_mask:0xf bank_mask:0xf
    v_add_f32_dpp v167, v167, v167 quad_perm:[2,3,0,1] row_mask:0xf bank_mask:0xf
    v_add_f32_dpp v168, v168, v168 quad_perm:[2,3,0,1] row_mask:0xf bank_mask:0xf
    v_add_f32_dpp v169, v169, v169 quad_perm:[2,3,0,1] row_mask:0xf bank_mask:0xf
    v_add_f32_dpp v170, v170, v170 quad_perm:[2,3,0,1] row_mask:0xf bank_mask:0xf
    v_add_f32_dpp v171, v171, v171 quad_perm:[2,3,0,1] row_mask:0xf bank_mask:0xf
    v_bfe_u32 v3, v0, 2, 2
    v_lshl_add_u32 v3, v3, 7, v7
    s_lshl_b32 s62, s82, 9
    s_add_u32 s64, s62, 82432
    v_add_u32 v3, s64, v3
    ds_write_b128 v3, v[164:167]
    ds_write_b128 v3, v[168:171] offset:64
    s_lshl_b32 s55, s83, 13
    s_add_u32 s55, s55, 524288
    s_waitcnt lgkmcnt(0)
    s_barrier
    s_cmp_lg_u32 s82, 3
    s_cbranch_scc1 L_adaL_nopub_14
    v_lshlrev_b32 v3, 2, v240
    v_add_u32 v3, 82432, v3
    ds_read2st64_b32 v[216:217], v3 offset0:0 offset1:1
    ds_read2st64_b32 v[218:219], v3 offset0:2 offset1:3
    ds_read2st64_b32 v[220:221], v3 offset0:4 offset1:5
    ds_read2st64_b32 v[222:223], v3 offset0:6 offset1:7
    s_lshl_b32 s64, s84, 10
    s_add_u32 s64, s64, s55
    s_waitcnt lgkmcnt(2)
    v_pk_add_f32 v[216:217], v[216:217], v[218:219]
    s_waitcnt lgkmcnt(0)
    v_pk_add_f32 v[220:221], v[220:221], v[222:223]
    v_pk_add_f32 v[216:217], v[216:217], v[220:221]
    v_mov_b32 v219, v13
    v_mov_b32 v218, v217
    v_mov_b32 v217, v13
    buffer_store_dwordx4 v[216:219], v241, s[4:7], s64 offen sc1
L_adaL_nopub_14:
    ds_read_b64 v[44:45], v5 offset:0
    ds_read_b64 v[46:47], v5 offset:512
    ds_read_b64 v[48:49], v5 offset:20480
    ds_read_b64 v[50:51], v5 offset:20992
    ds_read_b64 v[52:53], v6 offset:0
    ds_read_b64 v[54:55], v6 offset:512
    ds_read_b64 v[56:57], v6 offset:20480
    ds_read_b64 v[58:59], v6 offset:20992
    ds_read_b64 v[60:61], v5 offset:1024
    ds_read_b64 v[62:63], v5 offset:1536
    ds_read_b64 v[64:65], v5 offset:21504
    ds_read_b64 v[66:67], v5 offset:22016
    ds_read_b64 v[68:69], v6 offset:1024
    ds_read_b64 v[70:71], v6 offset:1536
    ds_read_b64 v[72:73], v6 offset:21504
    ds_read_b64 v[74:75], v6 offset:22016
    s_waitcnt vmcnt(30) lgkmcnt(8)
    v_mfma_f32_16x16x32_bf16 v[132:135], a[96:99], v[44:47], 0
    ds_read2st64_b64 v[76:79], v5 offset0:4 offset1:5
    v_mfma_f32_16x16x32_bf16 v[136:139], a[96:99], v[48:51], 0
    ds_read_b64 v[80:81], v5 offset:22528
    v_mfma_f32_16x16x32_bf16 v[140:143], a[96:99], v[52:55], 0
    ds_read_b64 v[82:83], v5 offset:23040
    v_mfma_f32_16x16x32_bf16 v[144:147], a[96:99], v[56:59], 0
    buffer_load_dwordx4 a[248:251], v241, s[4:7], s85 offen offset:3072 sc1
    v_mfma_f32_16x16x32_bf16 v[148:151], a[100:103], v[44:47], 0
    ds_read2st64_b64 v[84:87], v5 offset0:84 offset1:85
    v_mfma_f32_16x16x32_bf16 v[152:155], a[100:103], v[48:51], 0
    ds_read_b64 v[88:89], v6 offset:22528
    v_mfma_f32_16x16x32_bf16 v[156:159], a[100:103], v[52:55], 0
    ds_read_b64 v[90:91], v6 offset:23040
    v_mfma_f32_16x16x32_bf16 v[160:163], a[100:103], v[56:59], 0
    buffer_load_dwordx4 a[252:255], v242, s[4:7], s85 offen offset:3072 sc1
    s_add_u32 s85, s85, 4096
    s_waitcnt lgkmcnt(4)
    v_mfma_f32_16x16x32_bf16 v[132:135], a[104:107], v[60:63], v[132:135]
    ds_read2st64_b64 v[44:47], v5 offset0:6 offset1:7
    s_add_u32 m0, s54, 1024
    v_mfma_f32_16x16x32_bf16 v[136:139], a[104:107], v[64:67], v[136:139]
    buffer_load_dwordx4 v8, s[32:35], s66 offen offset:0 lds
    s_add_u32 m0, s54, 2048
    v_mfma_f32_16x16x32_bf16 v[140:143], a[104:107], v[68:71], v[140:143]
    ds_read2st64_b64 v[48:51], v5 offset0:46 offset1:47
    v_mfma_f32_16x16x32_bf16 v[144:147], a[104:107], v[72:75], v[144:147]
    buffer_load_dwordx4 v9, s[32:35], s66 offen offset:0 lds
    s_add_u32 m0, s54, 2944
    v_mfma_f32_16x16x32_bf16 v[148:151], a[108:111], v[60:63], v[148:151]
    ds_read2st64_b64 v[52:55], v5 offset0:86 offset1:87
    v_mfma_f32_16x16x32_bf16 v[152:155], a[108:111], v[64:67], v[152:155]
    buffer_load_dwordx4 v8, s[32:35], s66 offen offset:128 lds
    s_add_u32 m0, s54, 3968
    v_mfma_f32_16x16x32_bf16 v[156:159], a[108:111], v[68:71], v[156:159]
    ds_read2st64_b64 v[56:59], v5 offset0:126 offset1:127
    v_mfma_f32_16x16x32_bf16 v[160:163], a[108:111], v[72:75], v[160:163]
    buffer_load_dwordx4 v9, s[32:35], s66 offen offset:128 lds
    s_waitcnt lgkmcnt(3)
    v_mfma_f32_16x16x32_bf16 v[132:135], a[112:115], v[76:79], v[132:135]
    ds_read2st64_b64 v[60:63], v5 offset0:8 offset1:9
    s_add_u32 m0, s54, 4864
    v_mfma_f32_16x16x32_bf16 v[136:139], a[112:115], v[80:83], v[136:139]
    buffer_load_dwordx4 v8, s[32:35], s66 offen offset:256 lds
    s_add_u32 m0, s54, 5888
    v_mfma_f32_16x16x32_bf16 v[140:143], a[112:115], v[84:87], v[140:143]
    ds_read2st64_b64 v[64:67], v5 offset0:48 offset1:49
    v_mfma_f32_16x16x32_bf16 v[144:147], a[112:115], v[88:91], v[144:147]
    buffer_load_dwordx4 v9, s[32:35], s66 offen offset:256 lds
    s_add_u32 m0, s54, 6784
    v_mfma_f32_16x16x32_bf16 v[148:151], a[116:119], v[76:79], v[148:151]
    ds_read2st64_b64 v[68:71], v5 offset0:88 offset1:89
    v_mfma_f32_16x16x32_bf16 v[152:155], a[116:119], v[80:83], v[152:155]
    buffer_load_dwordx4 v8, s[32:35], s66 offen offset:384 lds
    s_add_u32 m0, s54, 7808
    v_mfma_f32_16x16x32_bf16 v[156:159], a[116:119], v[84:87], v[156:159]
    ds_read2st64_b64 v[72:75], v5 offset0:128 offset1:129
    v_mfma_f32_16x16x32_bf16 v[160:163], a[116:119], v[88:91], v[160:163]
    buffer_load_dwordx4 v9, s[32:35], s66 offen offset:384 lds
    s_waitcnt lgkmcnt(3)
    v_mfma_f32_16x16x32_bf16 v[132:135], a[120:123], v[44:47], v[132:135]
    ds_read2st64_b64 v[76:79], v5 offset0:10 offset1:11
    s_add_u32 m0, s54, 8704
    v_mfma_f32_16x16x32_bf16 v[136:139], a[120:123], v[48:51], v[136:139]
    buffer_load_dwordx4 v8, s[32:35], s66 offen offset:512 lds
    s_add_u32 m0, s54, 9728
    v_mfma_f32_16x16x32_bf16 v[140:143], a[120:123], v[52:55], v[140:143]
    ds_read2st64_b64 v[80:83], v5 offset0:50 offset1:51
    v_mfma_f32_16x16x32_bf16 v[144:147], a[120:123], v[56:59], v[144:147]
    buffer_load_dwordx4 v9, s[32:35], s66 offen offset:512 lds
    s_add_u32 m0, s54, 10624
    v_mfma_f32_16x16x32_bf16 v[148:151], a[124:127], v[44:47], v[148:151]
    ds_read2st64_b64 v[84:87], v5 offset0:90 offset1:91
    v_mfma_f32_16x16x32_bf16 v[152:155], a[124:127], v[48:51], v[152:155]
    buffer_load_dwordx4 v8, s[32:35], s66 offen offset:640 lds
    s_add_u32 m0, s54, 11648
    v_mfma_f32_16x16x32_bf16 v[156:159], a[124:127], v[52:55], v[156:159]
    ds_read2st64_b64 v[88:91], v5 offset0:130 offset1:131
    v_mfma_f32_16x16x32_bf16 v[160:163], a[124:127], v[56:59], v[160:163]
    buffer_load_dwordx4 v9, s[32:35], s66 offen offset:640 lds
    s_waitcnt vmcnt(37) lgkmcnt(3)
    v_mfma_f32_16x16x32_bf16 v[132:135], a[128:131], v[60:63], v[132:135]
    ds_read2st64_b64 v[44:47], v5 offset0:12 offset1:13
    s_add_u32 m0, s54, 12544
    v_mfma_f32_16x16x32_bf16 v[136:139], a[128:131], v[64:67], v[136:139]
    buffer_load_dwordx4 v8, s[32:35], s66 offen offset:768 lds
    s_add_u32 m0, s54, 13568
    v_mfma_f32_16x16x32_bf16 v[140:143], a[128:131], v[68:71], v[140:143]
    ds_read2st64_b64 v[48:51], v5 offset0:52 offset1:53
    v_mfma_f32_16x16x32_bf16 v[144:147], a[128:131], v[72:75], v[144:147]
    buffer_load_dwordx4 v9, s[32:35], s66 offen offset:768 lds
    s_waitcnt vmcnt(12) lgkmcnt(3)
    v_mfma_f32_16x16x32_bf16 v[148:151], a[132:135], v[60:63], v[148:151]
    ds_read2st64_b64 v[52:55], v5 offset0:92 offset1:93
    v_mfma_f32_16x16x32_bf16 v[152:155], a[132:135], v[64:67], v[152:155]
    ds_read_b128 a[0:3], v10 offset:1024
    v_mfma_f32_16x16x32_bf16 v[156:159], a[132:135], v[68:71], v[156:159]
    ds_read2st64_b64 v[56:59], v5 offset0:132 offset1:133
    v_mfma_f32_16x16x32_bf16 v[160:163], a[132:135], v[72:75], v[160:163]
    ds_read_b128 a[4:7], v11 offset:1024
    s_waitcnt lgkmcnt(5)
    v_mfma_f32_16x16x32_bf16 v[132:135], a[136:139], v[76:79], v[132:135]
    ds_read2st64_b64 v[60:63], v5 offset0:14 offset1:15
    s_waitcnt vmcnt(10) lgkmcnt(5)
    v_mfma_f32_16x16x32_bf16 v[136:139], a[136:139], v[80:83], v[136:139]
    ds_read_b128 a[8:11], v10 offset:3072
    v_mfma_f32_16x16x32_bf16 v[140:143], a[136:139], v[84:87], v[140:143]
    ds_read2st64_b64 v[64:67], v5 offset0:54 offset1:55
    v_mfma_f32_16x16x32_bf16 v[144:147], a[136:139], v[88:91], v[144:147]
    ds_read_b128 a[12:15], v11 offset:3072
    s_waitcnt lgkmcnt(4)
    v_mfma_f32_16x16x32_bf16 v[148:151], a[140:143], v[76:79], v[148:151]
    ds_read2st64_b64 v[68:71], v5 offset0:94 offset1:95
    s_add_u32 m0, s54, 128
    v_mfma_f32_16x16x32_bf16 v[152:155], a[140:143], v[80:83], v[152:155]
    buffer_load_dwordx4 v8, s[32:35], s66 offen offset:896 lds
    s_add_u32 m0, s54, 1152
    v_mfma_f32_16x16x32_bf16 v[156:159], a[140:143], v[84:87], v[156:159]
    ds_read2st64_b64 v[72:75], v5 offset0:134 offset1:135
    v_mfma_f32_16x16x32_bf16 v[160:163], a[140:143], v[88:91], v[160:163]
    buffer_load_dwordx4 v9, s[32:35], s66 offen offset:896 lds
    v_mfma_f32_16x16x32_bf16 v[132:135], a[144:147], v[44:47], v[132:135]
    ds_read2st64_b64 v[76:79], v5 offset0:16 offset1:17
    s_waitcnt vmcnt(10) lgkmcnt(4)
    v_mfma_f32_16x16x32_bf16 v[136:139], a[144:147], v[48:51], v[136:139]
    ds_read_b128 a[16:19], v10 offset:5120
    v_mfma_f32_16x16x32_bf16 v[140:143], a[144:147], v[52:55], v[140:143]
    ds_read2st64_b64 v[80:83], v5 offset0:56 offset1:57
    v_mfma_f32_16x16x32_bf16 v[144:147], a[144:147], v[56:59], v[144:147]
    ds_read_b128 a[20:23], v11 offset:5120
    s_waitcnt lgkmcnt(5)
    v_mfma_f32_16x16x32_bf16 v[148:151], a[148:151], v[44:47], v[148:151]
    ds_read2st64_b64 v[84:87], v5 offset0:96 offset1:97
    s_add_u32 m0, s54, 3072
    v_mfma_f32_16x16x32_bf16 v[152:155], a[148:151], v[48:51], v[152:155]
    buffer_load_dwordx4 v8, s[32:35], s67 offen offset:0 lds
    s_add_u32 m0, s54, 4096
    v_mfma_f32_16x16x32_bf16 v[156:159], a[148:151], v[52:55], v[156:159]
    ds_read2st64_b64 v[88:91], v5 offset0:136 offset1:137
    v_mfma_f32_16x16x32_bf16 v[160:163], a[148:151], v[56:59], v[160:163]
    buffer_load_dwordx4 v9, s[32:35], s67 offen offset:0 lds
    s_add_u32 s64, s55, 4096
    buffer_load_dwordx4 v[164:167], v241, s[4:7], s55 offen offset:0 sc1
    buffer_load_dwordx4 v[168:171], v241, s[4:7], s55 offen offset:1024 sc1
    buffer_load_dwordx4 v[172:175], v241, s[4:7], s55 offen offset:2048 sc1
    buffer_load_dwordx4 v[176:179], v241, s[4:7], s55 offen offset:3072 sc1
    buffer_load_dwordx4 v[180:183], v241, s[4:7], s64 offen offset:0 sc1
    buffer_load_dwordx4 v[184:187], v241, s[4:7], s64 offen offset:1024 sc1
    buffer_load_dwordx4 v[188:191], v241, s[4:7], s64 offen offset:2048 sc1
    buffer_load_dwordx4 v[192:195], v241, s[4:7], s64 offen offset:3072 sc1
    s_waitcnt lgkmcnt(4)
    v_mfma_f32_16x16x32_bf16 v[132:135], a[152:155], v[60:63], v[132:135]
    ds_read2st64_b64 v[44:47], v5 offset0:18 offset1:19
    s_waitcnt vmcnt(18) lgkmcnt(4)
    v_mfma_f32_16x16x32_bf16 v[136:139], a[152:155], v[64:67], v[136:139]
    ds_read_b128 a[24:27], v10 offset:7168
    v_mfma_f32_16x16x32_bf16 v[140:143], a[152:155], v[68:71], v[140:143]
    ds_read2st64_b64 v[48:51], v5 offset0:58 offset1:59
    v_mfma_f32_16x16x32_bf16 v[144:147], a[152:155], v[72:75], v[144:147]
    ds_read_b128 a[28:31], v11 offset:7168
    s_waitcnt lgkmcnt(5)
    v_mfma_f32_16x16x32_bf16 v[148:151], a[156:159], v[60:63], v[148:151]
    ds_read2st64_b64 v[52:55], v5 offset0:98 offset1:99
    s_add_u32 m0, s54, 4992
    v_mfma_f32_16x16x32_bf16 v[152:155], a[156:159], v[64:67], v[152:155]
    buffer_load_dwordx4 v8, s[32:35], s67 offen offset:128 lds
    s_add_u32 m0, s54, 6016
    v_mfma_f32_16x16x32_bf16 v[156:159], a[156:159], v[68:71], v[156:159]
    ds_read2st64_b64 v[56:59], v5 offset0:138 offset1:139
    v_mfma_f32_16x16x32_bf16 v[160:163], a[156:159], v[72:75], v[160:163]
    buffer_load_dwordx4 v9, s[32:35], s67 offen offset:128 lds
    s_waitcnt lgkmcnt(4)
    v_mfma_f32_16x16x32_bf16 v[132:135], a[160:163], v[76:79], v[132:135]
    ds_read2st64_b64 v[60:63], v5 offset0:20 offset1:21
    s_waitcnt vmcnt(18) lgkmcnt(4)
    v_mfma_f32_16x16x32_bf16 v[136:139], a[160:163], v[80:83], v[136:139]
    ds_read_b128 a[32:35], v10 offset:9216
    v_mfma_f32_16x16x32_bf16 v[140:143], a[160:163], v[84:87], v[140:143]
    ds_read2st64_b64 v[64:67], v5 offset0:60 offset1:61
    v_mfma_f32_16x16x32_bf16 v[144:147], a[160:163], v[88:91], v[144:147]
    ds_read_b128 a[36:39], v11 offset:9216
    s_waitcnt lgkmcnt(5)
    v_mfma_f32_16x16x32_bf16 v[148:151], a[164:167], v[76:79], v[148:151]
    ds_read2st64_b64 v[68:71], v5 offset0:100 offset1:101
    s_add_u32 m0, s54, 6912
    v_mfma_f32_16x16x32_bf16 v[152:155], a[164:167], v[80:83], v[152:155]
    buffer_load_dwordx4 v8, s[32:35], s67 offen offset:256 lds
    s_add_u32 m0, s54, 7936
    v_mfma_f32_16x16x32_bf16 v[156:159], a[164:167], v[84:87], v[156:159]
    ds_read2st64_b64 v[72:75], v5 offset0:140 offset1:141
    v_mfma_f32_16x16x32_bf16 v[160:163], a[164:167], v[88:91], v[160:163]
    buffer_load_dwordx4 v9, s[32:35], s67 offen offset:256 lds
    s_waitcnt lgkmcnt(4)
    v_mfma_f32_16x16x32_bf16 v[132:135], a[168:171], v[44:47], v[132:135]
    ds_read2st64_b64 v[76:79], v5 offset0:22 offset1:23
    s_waitcnt vmcnt(18) lgkmcnt(4)
    v_mfma_f32_16x16x32_bf16 v[136:139], a[168:171], v[48:51], v[136:139]
    ds_read_b128 a[40:43], v10 offset:11264
    v_mfma_f32_16x16x32_bf16 v[140:143], a[168:171], v[52:55], v[140:143]
    ds_read2st64_b64 v[80:83], v5 offset0:62 offset1:63
    v_mfma_f32_16x16x32_bf16 v[144:147], a[168:171], v[56:59], v[144:147]
    ds_read_b128 a[44:47], v11 offset:11264
    s_waitcnt lgkmcnt(5)
    v_mfma_f32_16x16x32_bf16 v[148:151], a[172:175], v[44:47], v[148:151]
    ds_read2st64_b64 v[84:87], v5 offset0:102 offset1:103
    s_add_u32 m0, s54, 8832
    v_mfma_f32_16x16x32_bf16 v[152:155], a[172:175], v[48:51], v[152:155]
    buffer_load_dwordx4 v8, s[32:35], s67 offen offset:384 lds
    s_add_u32 m0, s54, 9856
    v_mfma_f32_16x16x32_bf16 v[156:159], a[172:175], v[52:55], v[156:159]
    ds_read2st64_b64 v[88:91], v5 offset0:142 offset1:143
    v_mfma_f32_16x16x32_bf16 v[160:163], a[172:175], v[56:59], v[160:163]
    buffer_load_dwordx4 v9, s[32:35], s67 offen offset:384 lds
    s_waitcnt lgkmcnt(4)
    v_mfma_f32_16x16x32_bf16 v[132:135], a[176:179], v[60:63], v[132:135]
    ds_read2st64_b64 v[44:47], v5 offset0:24 offset1:25
    s_waitcnt vmcnt(18) lgkmcnt(4)
    v_mfma_f32_16x16x32_bf16 v[136:139], a[176:179], v[64:67], v[136:139]
    ds_read_b128 a[48:51], v10 offset:13312
    v_mfma_f32_16x16x32_bf16 v[140:143], a[176:179], v[68:71], v[140:143]
    ds_read2st64_b64 v[48:51], v5 offset0:64 offset1:65
    v_mfma_f32_16x16x32_bf16 v[144:147], a[176:179], v[72:75], v[144:147]
    ds_read_b128 a[52:55], v11 offset:13312
    s_waitcnt lgkmcnt(5)
    v_mfma_f32_16x16x32_bf16 v[148:151], a[180:183], v[60:63], v[148:151]
    ds_read2st64_b64 v[52:55], v5 offset0:104 offset1:105
    s_add_u32 m0, s54, 10752
    v_mfma_f32_16x16x32_bf16 v[152:155], a[180:183], v[64:67], v[152:155]
    buffer_load_dwordx4 v8, s[32:35], s67 offen offset:512 lds
    s_add_u32 m0, s54, 11776
    v_mfma_f32_16x16x32_bf16 v[156:159], a[180:183], v[68:71], v[156:159]
    ds_read2st64_b64 v[56:59], v5 offset0:144 offset1:145
    v_mfma_f32_16x16x32_bf16 v[160:163], a[180:183], v[72:75], v[160:163]
    buffer_load_dwordx4 v9, s[32:35], s67 offen offset:512 lds
    s_waitcnt lgkmcnt(4)
    v_mfma_f32_16x16x32_bf16 v[132:135], a[184:187], v[76:79], v[132:135]
    ds_read2st64_b64 v[60:63], v5 offset0:26 offset1:27
    s_waitcnt vmcnt(18) lgkmcnt(4)
    v_mfma_f32_16x16x32_bf16 v[136:139], a[184:187], v[80:83], v[136:139]
    ds_read_b128 a[56:59], v10 offset:1024
    v_mfma_f32_16x16x32_bf16 v[140:143], a[184:187], v[84:87], v[140:143]
    ds_read2st64_b64 v[64:67], v5 offset0:66 offset1:67
    v_mfma_f32_16x16x32_bf16 v[144:147], a[184:187], v[88:91], v[144:147]
    ds_read_b128 a[60:63], v11 offset:1024
    s_waitcnt lgkmcnt(5)
    v_mfma_f32_16x16x32_bf16 v[148:151], a[188:191], v[76:79], v[148:151]
    ds_read2st64_b64 v[68:71], v5 offset0:106 offset1:107
    s_add_u32 m0, s54, 12672
    v_mfma_f32_16x16x32_bf16 v[152:155], a[188:191], v[80:83], v[152:155]
    buffer_load_dwordx4 v8, s[32:35], s67 offen offset:640 lds
    s_add_u32 m0, s54, 13696
    v_mfma_f32_16x16x32_bf16 v[156:159], a[188:191], v[84:87], v[156:159]
    ds_read2st64_b64 v[72:75], v5 offset0:146 offset1:147
    v_mfma_f32_16x16x32_bf16 v[160:163], a[188:191], v[88:91], v[160:163]
    buffer_load_dwordx4 v9, s[32:35], s67 offen offset:640 lds
    s_mov_b32 s49, 65536
L_adaL_poll_15:
    s_waitcnt vmcnt(17) lgkmcnt(4)
    v_min3_u32 v3, v165, v167, v13
    s_waitcnt vmcnt(16)
    v_min3_u32 v3, v3, v169, v171
    s_waitcnt vmcnt(15)
    v_min3_u32 v3, v3, v173, v175
    s_waitcnt vmcnt(14)
    v_min3_u32 v3, v3, v177, v179
    s_waitcnt vmcnt(13) lgkmcnt(3)
    v_min3_u32 v3, v3, v181, v183
    s_waitcnt vmcnt(12)
    v_min3_u32 v3, v3, v185, v187
    s_waitcnt vmcnt(11)
    v_min3_u32 v3, v3, v189, v191
    s_waitcnt vmcnt(10)
    v_min3_u32 v3, v3, v193, v195
    v_max3_u32 v4, v165, v167, v13
    v_max3_u32 v4, v4, v169, v171
    v_max3_u32 v4, v4, v173, v175
    v_max3_u32 v4, v4, v177, v179
    v_max3_u32 v4, v4, v181, v183
    v_max3_u32 v4, v4, v185, v187
    v_max3_u32 v4, v4, v189, v191
    v_max3_u32 v4, v4, v193, v195
    v_cmp_ne_u32 vcc, v3, v4
    s_nop 0
    s_cbranch_vccz L_adaL_got_16
    s_add_u32 s64, s55, 4096
    buffer_load_dwordx4 v[164:167], v241, s[4:7], s55 offen offset:0 sc1
    buffer_load_dwordx4 v[168:171], v241, s[4:7], s55 offen offset:1024 sc1
    buffer_load_dwordx4 v[172:175], v241, s[4:7], s55 offen offset:2048 sc1
    buffer_load_dwordx4 v[176:179], v241, s[4:7], s55 offen offset:3072 sc1
    buffer_load_dwordx4 v[180:183], v241, s[4:7], s64 offen offset:0 sc1
    buffer_load_dwordx4 v[184:187], v241, s[4:7], s64 offen offset:1024 sc1
    buffer_load_dwordx4 v[188:191], v241, s[4:7], s64 offen offset:2048 sc1
    buffer_load_dwordx4 v[192:195], v241, s[4:7], s64 offen offset:3072 sc1
    s_waitcnt vmcnt(0)
    s_sub_u32 s49, s49, 1
    s_cmp_lg_u32 s49, 0
    s_cbranch_scc1 L_adaL_poll_15
L_adaL_got_16:
    v_add_f32 v164, v164, v168
    v_add_f32 v166, v166, v170
    v_add_f32 v172, v172, v176
    v_add_f32 v174, v174, v178
    v_add_f32 v180, v180, v184
    v_add_f32 v182, v182, v186
    v_add_f32 v188, v188, v192
    v_add_f32 v190, v190, v194
    v_add_f32 v164, v164, v172
    v_add_f32 v166, v166, v174
    v_add_f32 v180, v180, v188
    v_add_f32 v182, v182, v190
    v_add_f32 v164, v164, v180
    v_add_f32 v166, v166, v182
    v_mul_f32 v216, 0xba97b426, v164
    v_mul_f32 v217, 0x3a97b426, v166
    v_fma_f32 v217, -v216, v216, v217
    v_max_f32 v217, 0, v217
    v_add_f32 v217, 0x3727c5ac, v217
    v_rsq_f32 v217, v217
    s_add_u32 s64, s62, 84480
    v_lshl_add_u32 v3, v240, 2, s64
    v_mul_f32 v216, v216, v217
    ds_write2st64_b32 v3, v217, v216 offset0:0 offset1:1
    v_add_u32 v3, s64, v7
    ds_read_b128 v[164:167], v3 offset:0
    ds_read_b128 v[180:183], v3 offset:256
    ds_read_b128 v[168:171], v3 offset:64
    ds_read_b128 v[184:187], v3 offset:320
    ds_read_b128 v[172:175], v3 offset:128
    ds_read_b128 v[188:191], v3 offset:384
    ds_read_b128 v[176:179], v3 offset:192
    ds_read_b128 v[192:195], v3 offset:448
    s_mul_i32 s56, s84, 458752
    s_add_u32 s56, s56, 12582912
    s_lshl_b32 s64, s82, 17
    s_add_u32 s64, s64, s56
    s_lshl_b32 s65, s83, 11
    s_add_u32 s64, s64, s65
    v_add_u32 v4, 45056, v242
    s_waitcnt lgkmcnt(6)
    v_pk_fma_f32 v[100:101], v[100:101], v[164:165], v[180:181]
    v_pk_fma_f32 v[102:103], v[102:103], v[166:167], v[182:183]
    s_waitcnt lgkmcnt(4)
    v_pk_fma_f32 v[104:105], v[104:105], v[168:169], v[184:185]
    v_pk_fma_f32 v[106:107], v[106:107], v[170:171], v[186:187]
    v_cvt_pk_bf16_f32 v216, v100, v104
    v_cvt_pk_bf16_f32 v217, v101, v105
    v_cvt_pk_bf16_f32 v218, v102, v106
    v_cvt_pk_bf16_f32 v219, v103, v107
    buffer_store_dwordx4 v[216:219], v241, s[4:7], s64 offen offset:0 sc1
    v_pk_fma_f32 v[116:117], v[116:117], v[164:165], v[180:181]
    v_pk_fma_f32 v[118:119], v[118:119], v[166:167], v[182:183]
    v_pk_fma_f32 v[120:121], v[120:121], v[168:169], v[184:185]
    v_pk_fma_f32 v[122:123], v[122:123], v[170:171], v[186:187]
    v_cvt_pk_bf16_f32 v220, v116, v120
    v_cvt_pk_bf16_f32 v221, v117, v121
    v_cvt_pk_bf16_f32 v222, v118, v122
    v_cvt_pk_bf16_f32 v223, v119, v123
    buffer_store_dwordx4 v[220:223], v4, s[4:7], s64 offen offset:0 sc1
    s_waitcnt lgkmcnt(2)
    v_pk_fma_f32 v[108:109], v[108:109], v[172:173], v[188:189]
    v_pk_fma_f32 v[110:111], v[110:111], v[174:175], v[190:191]
    s_waitcnt lgkmcnt(0)
    v_pk_fma_f32 v[112:113], v[112:113], v[176:177], v[192:193]
    v_pk_fma_f32 v[114:115], v[114:115], v[178:179], v[194:195]
    v_cvt_pk_bf16_f32 v216, v108, v112
    v_cvt_pk_bf16_f32 v217, v109, v113
    v_cvt_pk_bf16_f32 v218, v110, v114
    v_cvt_pk_bf16_f32 v219, v111, v115
    buffer_store_dwordx4 v[216:219], v241, s[4:7], s64 offen offset:1024 sc1
    v_pk_fma_f32 v[124:125], v[124:125], v[172:173], v[188:189]
    v_pk_fma_f32 v[126:127], v[126:127], v[174:175], v[190:191]
    v_pk_fma_f32 v[128:129], v[128:129], v[176:177], v[192:193]
    v_pk_fma_f32 v[130:131], v[130:131], v[178:179], v[194:195]
    v_cvt_pk_bf16_f32 v220, v124, v128
    v_cvt_pk_bf16_f32 v221, v125, v129
    v_cvt_pk_bf16_f32 v222, v126, v130
    v_cvt_pk_bf16_f32 v223, v127, v131
    buffer_store_dwordx4 v[220:223], v4, s[4:7], s64 offen offset:1024 sc1
    v_mfma_f32_16x16x32_bf16 v[132:135], a[192:195], v[44:47], v[132:135]
    ds_read2st64_b64 v[76:79], v5 offset0:28 offset1:29
    v_mfma_f32_16x16x32_bf16 v[136:139], a[192:195], v[48:51], v[136:139]
    ds_read_b128 a[64:67], v10 offset:3072
    v_mfma_f32_16x16x32_bf16 v[140:143], a[192:195], v[52:55], v[140:143]
    ds_read2st64_b64 v[80:83], v5 offset0:68 offset1:69
    v_mfma_f32_16x16x32_bf16 v[144:147], a[192:195], v[56:59], v[144:147]
    ds_read_b128 a[68:71], v11 offset:3072
    v_mfma_f32_16x16x32_bf16 v[148:151], a[196:199], v[44:47], v[148:151]
    ds_read2st64_b64 v[84:87], v5 offset0:108 offset1:109
    s_add_u32 m0, s54, 256
    v_mfma_f32_16x16x32_bf16 v[152:155], a[196:199], v[48:51], v[152:155]
    buffer_load_dwordx4 v8, s[32:35], s67 offen offset:768 lds
    s_add_u32 m0, s54, 1280
    v_mfma_f32_16x16x32_bf16 v[156:159], a[196:199], v[52:55], v[156:159]
    ds_read2st64_b64 v[88:91], v5 offset0:148 offset1:149
    v_mfma_f32_16x16x32_bf16 v[160:163], a[196:199], v[56:59], v[160:163]
    buffer_load_dwordx4 v9, s[32:35], s67 offen offset:768 lds
    v_mfma_f32_16x16x32_bf16 v[132:135], a[200:203], v[60:63], v[132:135]
    ds_read2st64_b64 v[44:47], v5 offset0:30 offset1:31
    s_waitcnt vmcnt(14) lgkmcnt(4)
    v_mfma_f32_16x16x32_bf16 v[136:139], a[200:203], v[64:67], v[136:139]
    ds_read_b128 a[72:75], v10 offset:5120
    v_mfma_f32_16x16x32_bf16 v[140:143], a[200:203], v[68:71], v[140:143]
    ds_read2st64_b64 v[48:51], v5 offset0:70 offset1:71
    v_mfma_f32_16x16x32_bf16 v[144:147], a[200:203], v[72:75], v[144:147]
    ds_read_b128 a[76:79], v11 offset:5120
    s_waitcnt lgkmcnt(5)
    v_mfma_f32_16x16x32_bf16 v[148:151], a[204:207], v[60:63], v[148:151]
    ds_read2st64_b64 v[52:55], v5 offset0:110 offset1:111
    s_add_u32 m0, s54, 2176
    v_mfma_f32_16x16x32_bf16 v[152:155], a[204:207], v[64:67], v[152:155]
    buffer_load_dwordx4 v8, s[32:35], s67 offen offset:896 lds
    s_add_u32 m0, s54, 3200
    v_mfma_f32_16x16x32_bf16 v[156:159], a[204:207], v[68:71], v[156:159]
    ds_read2st64_b64 v[56:59], v5 offset0:150 offset1:151
    v_mfma_f32_16x16x32_bf16 v[160:163], a[204:207], v[72:75], v[160:163]
    buffer_load_dwordx4 v9, s[32:35], s67 offen offset:896 lds
    s_waitcnt lgkmcnt(4)
    v_mfma_f32_16x16x32_bf16 v[132:135], a[208:211], v[76:79], v[132:135]
    ds_read2st64_b64 v[60:63], v5 offset0:32 offset1:33
    s_waitcnt vmcnt(14) lgkmcnt(4)
    v_mfma_f32_16x16x32_bf16 v[136:139], a[208:211], v[80:83], v[136:139]
    ds_read_b128 a[80:83], v10 offset:7168
    v_mfma_f32_16x16x32_bf16 v[140:143], a[208:211], v[84:87], v[140:143]
    ds_read2st64_b64 v[64:67], v5 offset0:72 offset1:73
    v_mfma_f32_16x16x32_bf16 v[144:147], a[208:211], v[88:91], v[144:147]
    ds_read_b128 a[84:87], v11 offset:7168
    s_waitcnt lgkmcnt(5)
    v_mfma_f32_16x16x32_bf16 v[148:151], a[212:215], v[76:79], v[148:151]
    ds_read2st64_b64 v[68:71], v5 offset0:112 offset1:113
    s_add_u32 m0, s54, 5120
    v_mfma_f32_16x16x32_bf16 v[152:155], a[212:215], v[80:83], v[152:155]
    buffer_load_dwordx4 v8, s[32:35], s68 offen offset:0 lds
    s_add_u32 m0, s54, 6144
    v_mfma_f32_16x16x32_bf16 v[156:159], a[212:215], v[84:87], v[156:159]
    ds_read2st64_b64 v[72:75], v5 offset0:152 offset1:153
    v_mfma_f32_16x16x32_bf16 v[160:163], a[212:215], v[88:91], v[160:163]
    buffer_load_dwordx4 v9, s[32:35], s68 offen offset:0 lds
    s_waitcnt lgkmcnt(4)
    v_mfma_f32_16x16x32_bf16 v[132:135], a[216:219], v[44:47], v[132:135]
    ds_read2st64_b64 v[76:79], v5 offset0:34 offset1:35
    s_waitcnt vmcnt(14) lgkmcnt(4)
    v_mfma_f32_16x16x32_bf16 v[136:139], a[216:219], v[48:51], v[136:139]
    ds_read_b128 a[88:91], v10 offset:9216
    v_mfma_f32_16x16x32_bf16 v[140:143], a[216:219], v[52:55], v[140:143]
    ds_read2st64_b64 v[80:83], v5 offset0:74 offset1:75
    v_mfma_f32_16x16x32_bf16 v[144:147], a[216:219], v[56:59], v[144:147]
    ds_read_b128 a[92:95], v11 offset:9216
    s_waitcnt lgkmcnt(5)
    v_mfma_f32_16x16x32_bf16 v[148:151], a[220:223], v[44:47], v[148:151]
    ds_read2st64_b64 v[84:87], v5 offset0:114 offset1:115
    s_add_u32 m0, s54, 7040
    v_mfma_f32_16x16x32_bf16 v[152:155], a[220:223], v[48:51], v[152:155]
    buffer_load_dwordx4 v8, s[32:35], s68 offen offset:128 lds
    s_add_u32 m0, s54, 8064
    v_mfma_f32_16x16x32_bf16 v[156:159], a[220:223], v[52:55], v[156:159]
    ds_read2st64_b64 v[88:91], v5 offset0:154 offset1:155
    v_mfma_f32_16x16x32_bf16 v[160:163], a[220:223], v[56:59], v[160:163]
    buffer_load_dwordx4 v9, s[32:35], s68 offen offset:128 lds
    s_waitcnt lgkmcnt(4)
    v_mfma_f32_16x16x32_bf16 v[132:135], a[224:227], v[60:63], v[132:135]
    ds_read2st64_b64 v[44:47], v5 offset0:36 offset1:37
    s_waitcnt vmcnt(14) lgkmcnt(4)
    v_mfma_f32_16x16x32_bf16 v[136:139], a[224:227], v[64:67], v[136:139]
    ds_read_b128 a[96:99], v10 offset:11264
    v_mfma_f32_16x16x32_bf16 v[140:143], a[224:227], v[68:71], v[140:143]
    ds_read2st64_b64 v[48:51], v5 offset0:76 offset1:77
    v_mfma_f32_16x16x32_bf16 v[144:147], a[224:227], v[72:75], v[144:147]
    ds_read_b128 a[100:103], v11 offset:11264
    s_waitcnt lgkmcnt(5)
    v_mfma_f32_16x16x32_bf16 v[148:151], a[228:231], v[60:63], v[148:151]
    ds_read2st64_b64 v[52:55], v5 offset0:116 offset1:117
    s_add_u32 m0, s54, 8960
    v_mfma_f32_16x16x32_bf16 v[152:155], a[228:231], v[64:67], v[152:155]
    buffer_load_dwordx4 v8, s[32:35], s68 offen offset:256 lds
    s_add_u32 m0, s54, 9984
    v_mfma_f32_16x16x32_bf16 v[156:159], a[228:231], v[68:71], v[156:159]
    ds_read2st64_b64 v[56:59], v5 offset0:156 offset1:157
    v_mfma_f32_16x16x32_bf16 v[160:163], a[228:231], v[72:75], v[160:163]
    buffer_load_dwordx4 v9, s[32:35], s68 offen offset:256 lds
    s_waitcnt lgkmcnt(4)
    v_mfma_f32_16x16x32_bf16 v[132:135], a[232:235], v[76:79], v[132:135]
    ds_read2st64_b64 v[60:63], v5 offset0:38 offset1:39
    s_waitcnt vmcnt(14) lgkmcnt(4)
    v_mfma_f32_16x16x32_bf16 v[136:139], a[232:235], v[80:83], v[136:139]
    ds_read_b128 a[104:107], v10 offset:13312
    v_mfma_f32_16x16x32_bf16 v[140:143], a[232:235], v[84:87], v[140:143]
    ds_read2st64_b64 v[64:67], v5 offset0:78 offset1:79
    v_mfma_f32_16x16x32_bf16 v[144:147], a[232:235], v[88:91], v[144:147]
    ds_read_b128 a[108:111], v11 offset:13312
    s_waitcnt lgkmcnt(5)
    v_mfma_f32_16x16x32_bf16 v[148:151], a[236:239], v[76:79], v[148:151]
    ds_read2st64_b64 v[68:71], v5 offset0:118 offset1:119
    s_add_u32 m0, s54, 10880
    v_mfma_f32_16x16x32_bf16 v[152:155], a[236:239], v[80:83], v[152:155]
    buffer_load_dwordx4 v8, s[32:35], s68 offen offset:384 lds
    s_add_u32 m0, s54, 11904
    v_mfma_f32_16x16x32_bf16 v[156:159], a[236:239], v[84:87], v[156:159]
    ds_read2st64_b64 v[72:75], v5 offset0:158 offset1:159
    v_mfma_f32_16x16x32_bf16 v[160:163], a[236:239], v[88:91], v[160:163]
    buffer_load_dwordx4 v9, s[32:35], s68 offen offset:384 lds
    s_waitcnt lgkmcnt(4)
    v_mfma_f32_16x16x32_bf16 v[132:135], a[240:243], v[44:47], v[132:135]
    s_waitcnt vmcnt(10) lgkmcnt(3)
    ds_read_b128 a[112:115], v10 offset:1024
    v_mfma_f32_16x16x32_bf16 v[136:139], a[240:243], v[48:51], v[136:139]
    ds_read_b128 a[116:119], v11 offset:1024
    s_waitcnt lgkmcnt(4)
    v_mfma_f32_16x16x32_bf16 v[140:143], a[240:243], v[52:55], v[140:143]
    s_add_u32 m0, s54, 12800
    s_nop 0
    buffer_load_dwordx4 v8, s[32:35], s68 offen offset:512 lds
    v_mfma_f32_16x16x32_bf16 v[144:147], a[240:243], v[56:59], v[144:147]
    s_add_u32 m0, s54, 13824
    s_nop 0
    buffer_load_dwordx4 v9, s[32:35], s68 offen offset:512 lds
    v_mfma_f32_16x16x32_bf16 v[148:151], a[244:247], v[44:47], v[148:151]
    v_mfma_f32_16x16x32_bf16 v[152:155], a[244:247], v[48:51], v[152:155]
    v_mfma_f32_16x16x32_bf16 v[156:159], a[244:247], v[52:55], v[156:159]
    v_mfma_f32_16x16x32_bf16 v[160:163], a[244:247], v[56:59], v[160:163]
    s_waitcnt lgkmcnt(0)
    v_mfma_f32_16x16x32_bf16 v[132:135], a[248:251], v[60:63], v[132:135]
    s_waitcnt vmcnt(10)
    ds_read_b128 a[120:123], v10 offset:3072
    v_mfma_f32_16x16x32_bf16 v[136:139], a[248:251], v[64:67], v[136:139]
    ds_read_b128 a[124:127], v11 offset:3072
    v_mfma_f32_16x16x32_bf16 v[140:143], a[248:251], v[68:71], v[140:143]
    s_add_u32 m0, s54, 384
    s_nop 0
    buffer_load_dwordx4 v8, s[32:35], s68 offen offset:640 lds
    v_mfma_f32_16x16x32_bf16 v[144:147], a[248:251], v[72:75], v[144:147]
    s_add_u32 m0, s54, 1408
    s_nop 0
    buffer_load_dwordx4 v9, s[32:35], s68 offen offset:640 lds
    v_mfma_f32_16x16x32_bf16 v[148:151], a[252:255], v[60:63], v[148:151]
    v_mfma_f32_16x16x32_bf16 v[152:155], a[252:255], v[64:67], v[152:155]
    v_mfma_f32_16x16x32_bf16 v[156:159], a[252:255], v[68:71], v[156:159]
    v_mfma_f32_16x16x32_bf16 v[160:163], a[252:255], v[72:75], v[160:163]
    s_lshl_b32 s64, s84, 5
    s_add_u32 s64, s64, s83
    s_lshl_b32 s64, s64, 5
    s_add_u32 s64, s64, 196608
    s_cmp_lg_u32 s82, 0
    s_cselect_b32 s64, 33554432, s64
    v_mul_u32_u24 v3, 8448, v240
    s_barrier
    s_mov_b64 exec, 15
    buffer_store_dword v13, v3, s[4:7], s64 offen sc1
    s_mov_b64 exec, -1
    s_mul_i32 s64, s84, 10
    v_add_u32 v3, s64, v2
    v_lshrrev_b32 v4, 2, v3
    v_and_b32 v3, 3, v3
    v_lshlrev_b32 v3, 7, v3
    v_lshl_add_u32 v3, v4, 10, v3
    v_lshl_add_u32 v3, v1, 3, v3
    v_add_u32 v3, s53, v3
    ds_read_b64 v[16:17], v3 offset:0
    ds_read_b64 v[18:19], v3 offset:512
    ds_read_b64 v[20:21], v3 offset:1024
    ds_read_b64 v[22:23], v3 offset:1536
    v_lshrrev_b32 v3, 1, v2
    v_add3_u32 v3, v3, s64, 8
    v_lshrrev_b32 v4, 2, v3
    v_and_b32 v3, 3, v3
    v_lshlrev_b32 v3, 7, v3
    v_lshl_add_u32 v3, v4, 10, v3
    v_and_b32 v4, 1, v2
    v_lshl_add_u32 v3, v4, 9, v3
    v_lshl_add_u32 v3, v1, 3, v3
    v_add_u32 v3, s53, v3
    ds_read_b64 v[24:25], v3
    v_lshlrev_b32 v3, 2, v1
    v_add_u32 v3, 81920, v3
    ds_read2_b32 v[164:165], v3 offset0:0 offset1:64
    ds_read2_b32 v[166:167], v3 offset0:16 offset1:80
    ds_read2_b32 v[168:169], v3 offset0:32 offset1:96
    ds_read2_b32 v[170:171], v3 offset0:48 offset1:112
    s_lshl_b32 s64, s82, 10
    s_add_u32 s64, s64, 86528
    v_add_u32 v3, s64, v241
    s_waitcnt lgkmcnt(3)
    v_pk_fma_f32 v[132:133], v[196:197], v[164:165], v[132:133] op_sel:[0,1,0] op_sel_hi:[1,1,1]
    v_pk_fma_f32 v[134:135], v[198:199], v[164:165], v[134:135] op_sel:[0,1,0] op_sel_hi:[1,1,1]
    v_pk_fma_f32 v[148:149], v[200:201], v[164:165], v[148:149] op_sel:[0,1,0] op_sel_hi:[1,1,1]
    v_pk_fma_f32 v[150:151], v[202:203], v[164:165], v[150:151] op_sel:[0,1,0] op_sel_hi:[1,1,1]
    v_pk_fma_f32 v[132:133], v[132:133], v[164:165], v[204:205] op_sel:[0,0,0] op_sel_hi:[1,0,1]
    s_waitcnt vmcnt(11)
    ds_read_b128 a[128:131], v10 offset:5120
    ds_read_b128 a[132:135], v11 offset:5120
    s_add_u32 m0, s54, 2304
    s_nop 0
    buffer_load_dwordx4 v8, s[32:35], s68 offen offset:768 lds
    v_pk_fma_f32 v[134:135], v[134:135], v[164:165], v[206:207] op_sel:[0,0,0] op_sel_hi:[1,0,1]
    v_pk_fma_f32 v[148:149], v[148:149], v[164:165], v[208:209] op_sel:[0,0,0] op_sel_hi:[1,0,1]
    v_pk_fma_f32 v[150:151], v[150:151], v[164:165], v[210:211] op_sel:[0,0,0] op_sel_hi:[1,0,1]
    v_pk_mul_f32 v[216:217], v[132:133], v[132:133]
    v_pk_mul_f32 v[218:219], v[134:135], v[134:135]
    v_pk_mul_f32 v[220:221], v[148:149], v[148:149]
    v_pk_mul_f32 v[222:223], v[150:151], v[150:151]
    v_pk_fma_f32 v[216:217], v[216:217], s[70:71], s[70:71] op_sel:[0,0,1] op_sel_hi:[1,0,1]
    v_pk_fma_f32 v[218:219], v[218:219], s[70:71], s[70:71] op_sel:[0,0,1] op_sel_hi:[1,0,1]
    v_pk_fma_f32 v[220:221], v[220:221], s[70:71], s[70:71] op_sel:[0,0,1] op_sel_hi:[1,0,1]
    v_pk_fma_f32 v[222:223], v[222:223], s[70:71], s[70:71] op_sel:[0,0,1] op_sel_hi:[1,0,1]
    v_pk_mul_f32 v[216:217], v[216:217], v[132:133]
    s_add_u32 m0, s54, 3328
    s_nop 0
    buffer_load_dwordx4 v9, s[32:35], s68 offen offset:768 lds
    v_pk_mul_f32 v[218:219], v[218:219], v[134:135]
    v_pk_mul_f32 v[220:221], v[220:221], v[148:149]
    v_pk_mul_f32 v[222:223], v[222:223], v[150:151]
    v_exp_f32 v216, v216
    v_exp_f32 v217, v217
    v_exp_f32 v218, v218
    v_exp_f32 v219, v219
    v_exp_f32 v220, v220
    v_exp_f32 v221, v221
    v_exp_f32 v222, v222
    v_exp_f32 v223, v223
    v_pk_add_f32 v[216:217], v[216:217], s[72:73]
    s_waitcnt vmcnt(11) lgkmcnt(0)
    ds_read_b128 a[136:139], v10 offset:7168
    ds_read_b128 a[140:143], v11 offset:7168
    s_add_u32 m0, s54, 4224
    s_nop 0
    buffer_load_dwordx4 v8, s[32:35], s68 offen offset:896 lds
    v_pk_add_f32 v[218:219], v[218:219], s[72:73]
    v_pk_add_f32 v[220:221], v[220:221], s[72:73]
    v_pk_add_f32 v[222:223], v[222:223], s[72:73]
    v_rcp_f32 v216, v216
    v_rcp_f32 v217, v217
    v_rcp_f32 v218, v218
    v_rcp_f32 v219, v219
    v_rcp_f32 v220, v220
    v_rcp_f32 v221, v221
    v_rcp_f32 v222, v222
    v_rcp_f32 v223, v223
    v_pk_mul_f32 v[132:133], v[132:133], v[216:217]
    s_add_u32 m0, s54, 5248
    s_nop 0
    buffer_load_dwordx4 v9, s[32:35], s68 offen offset:896 lds
    v_pk_mul_f32 v[134:135], v[134:135], v[218:219]
    v_pk_mul_f32 v[148:149], v[148:149], v[220:221]
    v_pk_mul_f32 v[150:151], v[150:151], v[222:223]
    v_cvt_pk_bf16_f32 v180, v132, v148
    v_cvt_pk_bf16_f32 v181, v133, v149
    v_cvt_pk_bf16_f32 v182, v134, v150
    v_cvt_pk_bf16_f32 v183, v135, v151
    ds_write_b128 v3, v[180:183] offset:0
    v_pk_fma_f32 v[136:137], v[196:197], v[166:167], v[136:137] op_sel:[0,1,0] op_sel_hi:[1,1,1]
    v_pk_fma_f32 v[138:139], v[198:199], v[166:167], v[138:139] op_sel:[0,1,0] op_sel_hi:[1,1,1]
    v_pk_fma_f32 v[152:153], v[200:201], v[166:167], v[152:153] op_sel:[0,1,0] op_sel_hi:[1,1,1]
    v_pk_fma_f32 v[154:155], v[202:203], v[166:167], v[154:155] op_sel:[0,1,0] op_sel_hi:[1,1,1]
    s_waitcnt vmcnt(11)
    ds_read_b128 a[144:147], v10 offset:9216
    ds_read_b128 a[148:151], v11 offset:9216
    s_waitcnt lgkmcnt(3)
    s_add_u32 m0, s54, 7168
    s_nop 0
    buffer_load_dwordx4 v8, s[32:35], s69 offen offset:0 lds
    v_pk_fma_f32 v[136:137], v[136:137], v[166:167], v[204:205] op_sel:[0,0,0] op_sel_hi:[1,0,1]
    v_pk_fma_f32 v[138:139], v[138:139], v[166:167], v[206:207] op_sel:[0,0,0] op_sel_hi:[1,0,1]
    v_pk_fma_f32 v[152:153], v[152:153], v[166:167], v[208:209] op_sel:[0,0,0] op_sel_hi:[1,0,1]
    v_pk_fma_f32 v[154:155], v[154:155], v[166:167], v[210:211] op_sel:[0,0,0] op_sel_hi:[1,0,1]
    v_pk_mul_f32 v[216:217], v[136:137], v[136:137]
    v_pk_mul_f32 v[218:219], v[138:139], v[138:139]
    v_pk_mul_f32 v[220:221], v[152:153], v[152:153]
    v_pk_mul_f32 v[222:223], v[154:155], v[154:155]
    v_pk_fma_f32 v[216:217], v[216:217], s[70:71], s[70:71] op_sel:[0,0,1] op_sel_hi:[1,0,1]
    v_pk_fma_f32 v[218:219], v[218:219], s[70:71], s[70:71] op_sel:[0,0,1] op_sel_hi:[1,0,1]
    v_pk_fma_f32 v[220:221], v[220:221], s[70:71], s[70:71] op_sel:[0,0,1] op_sel_hi:[1,0,1]
    v_pk_fma_f32 v[222:223], v[222:223], s[70:71], s[70:71] op_sel:[0,0,1] op_sel_hi:[1,0,1]
    s_add_u32 m0, s54, 8192
    s_nop 0
    buffer_load_dwordx4 v9, s[32:35], s69 offen offset:0 lds
    v_pk_mul_f32 v[216:217], v[216:217], v[136:137]
    v_pk_mul_f32 v[218:219], v[218:219], v[138:139]
    v_pk_mul_f32 v[220:221], v[220:221], v[152:153]
    v_pk_mul_f32 v[222:223], v[222:223], v[154:155]
    v_exp_f32 v216, v216
    v_exp_f32 v217, v217
    v_exp_f32 v218, v218
    v_exp_f32 v219, v219
    v_exp_f32 v220, v220
    v_exp_f32 v221, v221
    v_exp_f32 v222, v222
    v_exp_f32 v223, v223
    s_waitcnt vmcnt(11) lgkmcnt(0)
    ds_read_b128 a[152:155], v10 offset:11264
    ds_read_b128 a[156:159], v11 offset:11264
    s_add_u32 m0, s54, 9088
    s_nop 0
    buffer_load_dwordx4 v8, s[32:35], s69 offen offset:128 lds
    v_pk_add_f32 v[216:217], v[216:217], s[72:73]
    v_pk_add_f32 v[218:219], v[218:219], s[72:73]
    v_pk_add_f32 v[220:221], v[220:221], s[72:73]
    v_pk_add_f32 v[222:223], v[222:223], s[72:73]
    v_rcp_f32 v216, v216
    v_rcp_f32 v217, v217
    v_rcp_f32 v218, v218
    v_rcp_f32 v219, v219
    v_rcp_f32 v220, v220
    v_rcp_f32 v221, v221
    v_rcp_f32 v222, v222
    v_rcp_f32 v223, v223
    s_add_u32 m0, s54, 10112
    s_nop 0
    buffer_load_dwordx4 v9, s[32:35], s69 offen offset:128 lds
    v_pk_mul_f32 v[136:137], v[136:137], v[216:217]
    v_pk_mul_f32 v[138:139], v[138:139], v[218:219]
    v_pk_mul_f32 v[152:153], v[152:153], v[220:221]
    v_pk_mul_f32 v[154:155], v[154:155], v[222:223]
    v_cvt_pk_bf16_f32 v184, v136, v152
    v_cvt_pk_bf16_f32 v185, v137, v153
    v_cvt_pk_bf16_f32 v186, v138, v154
    v_cvt_pk_bf16_f32 v187, v139, v155
    ds_write_b128 v3, v[184:187] offset:4096
    v_pk_fma_f32 v[140:141], v[196:197], v[168:169], v[140:141] op_sel:[0,1,0] op_sel_hi:[1,1,1]
    v_pk_fma_f32 v[142:143], v[198:199], v[168:169], v[142:143] op_sel:[0,1,0] op_sel_hi:[1,1,1]
    v_pk_fma_f32 v[156:157], v[200:201], v[168:169], v[156:157] op_sel:[0,1,0] op_sel_hi:[1,1,1]
    s_waitcnt vmcnt(11)
    ds_read_b128 a[160:163], v10 offset:13312
    ds_read_b128 a[164:167], v11 offset:13312
    s_waitcnt lgkmcnt(3)
    s_add_u32 m0, s54, 11008
    s_nop 0
    buffer_load_dwordx4 v8, s[32:35], s69 offen offset:256 lds
    v_pk_fma_f32 v[158:159], v[202:203], v[168:169], v[158:159] op_sel:[0,1,0] op_sel_hi:[1,1,1]
    v_pk_fma_f32 v[140:141], v[140:141], v[168:169], v[204:205] op_sel:[0,0,0] op_sel_hi:[1,0,1]
    v_pk_fma_f32 v[142:143], v[142:143], v[168:169], v[206:207] op_sel:[0,0,0] op_sel_hi:[1,0,1]
    v_pk_fma_f32 v[156:157], v[156:157], v[168:169], v[208:209] op_sel:[0,0,0] op_sel_hi:[1,0,1]
    v_pk_fma_f32 v[158:159], v[158:159], v[168:169], v[210:211] op_sel:[0,0,0] op_sel_hi:[1,0,1]
    v_pk_mul_f32 v[216:217], v[140:141], v[140:141]
    v_pk_mul_f32 v[218:219], v[142:143], v[142:143]
    v_pk_mul_f32 v[220:221], v[156:157], v[156:157]
    v_pk_mul_f32 v[222:223], v[158:159], v[158:159]
    v_pk_fma_f32 v[216:217], v[216:217], s[70:71], s[70:71] op_sel:[0,0,1] op_sel_hi:[1,0,1]
    v_pk_fma_f32 v[218:219], v[218:219], s[70:71], s[70:71] op_sel:[0,0,1] op_sel_hi:[1,0,1]
    v_pk_fma_f32 v[220:221], v[220:221], s[70:71], s[70:71] op_sel:[0,0,1] op_sel_hi:[1,0,1]
    s_add_u32 m0, s54, 12032
    s_nop 0
    buffer_load_dwordx4 v9, s[32:35], s69 offen offset:256 lds
    v_pk_fma_f32 v[222:223], v[222:223], s[70:71], s[70:71] op_sel:[0,0,1] op_sel_hi:[1,0,1]
    v_pk_mul_f32 v[216:217], v[216:217], v[140:141]
    v_pk_mul_f32 v[218:219], v[218:219], v[142:143]
    v_pk_mul_f32 v[220:221], v[220:221], v[156:157]
    v_pk_mul_f32 v[222:223], v[222:223], v[158:159]
    v_exp_f32 v216, v216
    v_exp_f32 v217, v217
    v_exp_f32 v218, v218
    v_exp_f32 v219, v219
    v_exp_f32 v220, v220
    v_exp_f32 v221, v221
    v_exp_f32 v222, v222
    s_waitcnt vmcnt(11) lgkmcnt(0)
    ds_read_b128 a[168:171], v10 offset:1024
    ds_read_b128 a[172:175], v11 offset:1024
    s_add_u32 m0, s54, 12928
    s_nop 0
    buffer_load_dwordx4 v8, s[32:35], s69 offen offset:384 lds
    v_exp_f32 v223, v223
    v_pk_add_f32 v[216:217], v[216:217], s[72:73]
    v_pk_add_f32 v[218:219], v[218:219], s[72:73]
    v_pk_add_f32 v[220:221], v[220:221], s[72:73]
    v_pk_add_f32 v[222:223], v[222:223], s[72:73]
    v_rcp_f32 v216, v216
    v_rcp_f32 v217, v217
    v_rcp_f32 v218, v218
    v_rcp_f32 v219, v219
    v_rcp_f32 v220, v220
    v_rcp_f32 v221, v221
    v_rcp_f32 v222, v222
    s_add_u32 m0, s54, 13952
    s_nop 0
    buffer_load_dwordx4 v9, s[32:35], s69 offen offset:384 lds
    v_rcp_f32 v223, v223
    v_pk_mul_f32 v[140:141], v[140:141], v[216:217]
    v_pk_mul_f32 v[142:143], v[142:143], v[218:219]
    v_pk_mul_f32 v[156:157], v[156:157], v[220:221]
    v_pk_mul_f32 v[158:159], v[158:159], v[222:223]
    v_cvt_pk_bf16_f32 v188, v140, v156
    v_cvt_pk_bf16_f32 v189, v141, v157
    v_cvt_pk_bf16_f32 v190, v142, v158
    v_cvt_pk_bf16_f32 v191, v143, v159
    ds_write_b128 v3, v[188:191] offset:8192
    v_pk_fma_f32 v[144:145], v[196:197], v[170:171], v[144:145] op_sel:[0,1,0] op_sel_hi:[1,1,1]
    v_pk_fma_f32 v[146:147], v[198:199], v[170:171], v[146:147] op_sel:[0,1,0] op_sel_hi:[1,1,1]
    s_waitcnt vmcnt(10)
    ds_read_b128 a[176:179], v10 offset:3072
    ds_read_b128 a[180:183], v11 offset:3072
    s_waitcnt lgkmcnt(3)
    s_add_u32 m0, s54, 512
    s_nop 0
    buffer_load_dwordx4 v8, s[32:35], s69 offen offset:512 lds
    v_pk_fma_f32 v[160:161], v[200:201], v[170:171], v[160:161] op_sel:[0,1,0] op_sel_hi:[1,1,1]
    v_pk_fma_f32 v[162:163], v[202:203], v[170:171], v[162:163] op_sel:[0,1,0] op_sel_hi:[1,1,1]
    v_pk_fma_f32 v[144:145], v[144:145], v[170:171], v[204:205] op_sel:[0,0,0] op_sel_hi:[1,0,1]
    v_pk_fma_f32 v[146:147], v[146:147], v[170:171], v[206:207] op_sel:[0,0,0] op_sel_hi:[1,0,1]
    v_pk_fma_f32 v[160:161], v[160:161], v[170:171], v[208:209] op_sel:[0,0,0] op_sel_hi:[1,0,1]
    v_pk_fma_f32 v[162:163], v[162:163], v[170:171], v[210:211] op_sel:[0,0,0] op_sel_hi:[1,0,1]
    v_pk_mul_f32 v[216:217], v[144:145], v[144:145]
    v_pk_mul_f32 v[218:219], v[146:147], v[146:147]
    v_pk_mul_f32 v[220:221], v[160:161], v[160:161]
    v_pk_mul_f32 v[222:223], v[162:163], v[162:163]
    v_pk_fma_f32 v[216:217], v[216:217], s[70:71], s[70:71] op_sel:[0,0,1] op_sel_hi:[1,0,1]
    v_pk_fma_f32 v[218:219], v[218:219], s[70:71], s[70:71] op_sel:[0,0,1] op_sel_hi:[1,0,1]
    s_add_u32 m0, s54, 1536
    s_nop 0
    buffer_load_dwordx4 v9, s[32:35], s69 offen offset:512 lds
    v_pk_fma_f32 v[220:221], v[220:221], s[70:71], s[70:71] op_sel:[0,0,1] op_sel_hi:[1,0,1]
    v_pk_fma_f32 v[222:223], v[222:223], s[70:71], s[70:71] op_sel:[0,0,1] op_sel_hi:[1,0,1]
    v_pk_mul_f32 v[216:217], v[216:217], v[144:145]
    v_pk_mul_f32 v[218:219], v[218:219], v[146:147]
    v_pk_mul_f32 v[220:221], v[220:221], v[160:161]
    v_pk_mul_f32 v[222:223], v[222:223], v[162:163]
    v_exp_f32 v216, v216
    v_exp_f32 v217, v217
    v_exp_f32 v218, v218
    v_exp_f32 v219, v219
    v_exp_f32 v220, v220
    v_exp_f32 v221, v221
    s_waitcnt vmcnt(10) lgkmcnt(0)
    ds_read_b128 a[184:187], v10 offset:5120
    ds_read_b128 a[188:191], v11 offset:5120
    s_add_u32 m0, s54, 2432
    s_nop 0
    buffer_load_dwordx4 v8, s[32:35], s69 offen offset:640 lds
    v_exp_f32 v222, v222
    v_exp_f32 v223, v223
    v_pk_add_f32 v[216:217], v[216:217], s[72:73]
    v_pk_add_f32 v[218:219], v[218:219], s[72:73]
    v_pk_add_f32 v[220:221], v[220:221], s[72:73]
    v_pk_add_f32 v[222:223], v[222:223], s[72:73]
    v_rcp_f32 v216, v216
    v_rcp_f32 v217, v217
    v_rcp_f32 v218, v218
    v_rcp_f32 v219, v219
    v_rcp_f32 v220, v220
    v_rcp_f32 v221, v221
    s_add_u32 m0, s54, 3456
    s_nop 0
    buffer_load_dwordx4 v9, s[32:35], s69 offen offset:640 lds
    v_rcp_f32 v222, v222
    v_rcp_f32 v223, v223
    v_pk_mul_f32 v[144:145], v[144:145], v[216:217]
    v_pk_mul_f32 v[146:147], v[146:147], v[218:219]
    v_pk_mul_f32 v[160:161], v[160:161], v[220:221]
    v_pk_mul_f32 v[162:163], v[162:163], v[222:223]
    v_cvt_pk_bf16_f32 v192, v144, v160
    v_cvt_pk_bf16_f32 v193, v145, v161
    v_cvt_pk_bf16_f32 v194, v146, v162
    v_cvt_pk_bf16_f32 v195, v147, v163
    ds_write_b128 v3, v[192:195] offset:12288
    s_waitcnt lgkmcnt(0)
    s_barrier
    s_lshl_b32 s64, s82, 12
    v_add_u32 v14, s64, v241
    v_add_u32 v3, 86528, v14
    ds_read_b128 v[28:31], v3 offset:0
    ds_read_b128 v[32:35], v3 offset:1024
    ds_read_b128 v[36:39], v3 offset:2048
    ds_read_b128 v[40:43], v3 offset:3072
    s_lshl_b32 s64, s82, 10
    v_add_u32 v15, s64, v241
    s_lshl_b32 s62, s83, 6
    s_lshr_b32 s63, s82, 1
    s_lshl_b32 s63, s63, 5
    s_add_u32 s62, s62, s63
    s_and_b32 s63, s82, 1
    s_add_u32 s52, s62, s63
    s_lshl_b32 s62, s52, 1
    buffer_load_ushort v12, v12, s[12:15], s62 offen
    s_mul_i32 s62, s84, 320
    s_add_u32 s62, s62, 12800
    v_lshlrev_b32 v3, 5, v2
    buffer_load_dwordx4 v[44:47], v3, s[4:7], s62 offen offset:0 sc1
    buffer_load_dwordx4 v[48:51], v3, s[4:7], s62 offen offset:16 sc1
    buffer_load_dwordx4 v[52:55], v3, s[4:7], s62 offen offset:128 sc1
    buffer_load_dwordx4 v[56:59], v3, s[4:7], s62 offen offset:144 sc1
    buffer_load_dwordx4 v[60:63], v7, s[4:7], s62 offen offset:256 sc1
    s_lshl_b32 s62, s83, 2
    s_add_u32 s62, s62, s82
    s_lshl_b32 s55, s62, 8
    s_add_u32 s55, s55, 917504
    s_mul_i32 s62, s62, 28672
    s_add_u32 s85, s62, 20447232
    s_mul_i32 s57, s84, 3072
    s_add_u32 s57, s57, s85
    s_lshr_b32 s58, s84, 1
    s_lshl_b32 s58, s58, 10
    s_add_u32 s58, s58, s85
    s_and_b32 s63, s84, 1
    s_lshl_b32 s63, s63, 3
    s_add_u32 s58, s58, s63
    s_add_u32 s58, s58, 24576
    s_lshl_b32 s62, s82, 14
    s_add_u32 s56, s56, s62
    s_mul_i32 s53, s82, 5120
    s_mul_i32 s59, s84, 143360
    s_add_u32 s59, s59, s53
    s_add_u32 s59, s59, 11206656
    s_lshl_b32 s62, s84, 2
    s_add_u32 s62, s62, s82
    s_lshl_b32 s62, s62, 8
    s_lshr_b32 s63, s83, 3
    s_mul_i32 s63, s63, 8448
    s_add_u32 s62, s62, s63
    s_add_u32 s60, s62, 196608
    v_and_b32 v26, 7, v0
    v_lshlrev_b32 v26, 5, v26
    buffer_load_dword v27, v26, s[4:7], s60 offen sc1
    s_waitcnt vmcnt(17)
    ds_read_b128 a[192:195], v10 offset:7168
    ds_read_b128 a[196:199], v11 offset:7168
    s_add_u32 m0, s54, 4352
    s_nop 0
    buffer_load_dwordx4 v8, s[32:35], s69 offen offset:768 lds
    s_add_u32 m0, s54, 5376
    s_nop 0
    buffer_load_dwordx4 v9, s[32:35], s69 offen offset:768 lds
    s_waitcnt vmcnt(17)
    ds_read_b128 a[200:203], v10 offset:9216
    ds_read_b128 a[204:207], v11 offset:9216
    s_waitcnt lgkmcnt(2)
    s_add_u32 m0, s54, 6272
    s_nop 0
    buffer_load_dwordx4 v8, s[32:35], s69 offen offset:896 lds
    s_add_u32 m0, s54, 7296
    s_nop 0
    buffer_load_dwordx4 v9, s[32:35], s69 offen offset:896 lds
    s_mov_b32 s49, 65536
L_adaL_poll_17:
    s_waitcnt vmcnt(4)
    v_cmp_ne_u32 vcc, s48, v27
    s_nop 0
    s_cbranch_vccz L_adaL_got_18
    buffer_load_dword v27, v26, s[4:7], s60 offen sc1
    s_waitcnt vmcnt(0)
    s_sub_u32 s49, s49, 1
    s_cmp_lg_u32 s49, 0
    s_cbranch_scc1 L_adaL_poll_17
L_adaL_got_18:
    buffer_load_dwordx4 v[64:67], v241, s[4:7], s56 offen offset:0 sc1
    ds_read_b128 a[208:211], v10 offset:11264
    ds_read_b128 a[212:215], v11 offset:11264
    buffer_load_dwordx4 v[68:71], v241, s[4:7], s56 offen offset:1024 sc1
    ds_read_b128 a[216:219], v10 offset:13312
    ds_read_b128 a[220:223], v11 offset:13312
    buffer_load_dwordx4 v[72:75], v241, s[4:7], s56 offen offset:2048 sc1
    ds_read_b128 a[224:227], v10 offset:1024
    ds_read_b128 a[228:231], v11 offset:1024
    buffer_load_dwordx4 v[76:79], v241, s[4:7], s56 offen offset:3072 sc1
    s_add_u32 s56, s56, 4096
    ds_read_b128 a[232:235], v10 offset:3072
    ds_read_b128 a[236:239], v11 offset:3072
    buffer_load_dwordx4 v[80:83], v241, s[4:7], s56 offen offset:0 sc1
    s_waitcnt vmcnt(7)
    ds_read_b128 a[240:243], v10 offset:5120
    ds_read_b128 a[244:247], v11 offset:5120
    buffer_load_dwordx4 v[84:87], v241, s[4:7], s56 offen offset:1024 sc1
    s_waitcnt vmcnt(6)
    ds_read_b128 a[248:251], v10 offset:7168
    ds_read_b128 a[252:255], v11 offset:7168
    buffer_load_dwordx4 v[88:91], v241, s[4:7], s56 offen offset:2048 sc1
    buffer_load_dwordx4 v[92:95], v241, s[4:7], s56 offen offset:3072 sc1
    s_add_u32 s56, s56, 4096
    buffer_load_dwordx4 v[96:99], v241, s[4:7], s56 offen offset:0 sc1
    buffer_load_dwordx4 v[100:103], v241, s[4:7], s56 offen offset:1024 sc1
    buffer_load_dwordx4 v[104:107], v241, s[4:7], s56 offen offset:2048 sc1
    buffer_load_dwordx4 v[108:111], v241, s[4:7], s56 offen offset:3072 sc1
    s_add_u32 s56, s56, 4096
    buffer_load_dwordx4 v[112:115], v241, s[4:7], s56 offen offset:0 sc1
    buffer_load_dwordx4 v[116:119], v241, s[4:7], s56 offen offset:1024 sc1
    buffer_load_dwordx4 v[120:123], v241, s[4:7], s56 offen offset:2048 sc1
    buffer_load_dwordx4 v[124:127], v241, s[4:7], s56 offen offset:3072 sc1
    s_add_u32 s56, s56, 53248
    v_lshlrev_b32 v12, 16, v12
    s_waitcnt vmcnt(15)
    v_mfma_f32_16x16x32_bf16 v[128:131], v[64:67], a[0:3], 0
    v_mfma_f32_16x16x32_bf16 v[132:135], v[64:67], a[64:67], 0
    v_mfma_f32_16x16x32_bf16 v[136:139], v[64:67], a[128:131], 0
    v_mfma_f32_16x16x32_bf16 v[140:143], v[64:67], a[192:195], 0
    buffer_load_dwordx4 v[64:67], v241, s[4:7], s56 offen offset:0 sc1
    s_waitcnt vmcnt(15)
    v_mfma_f32_16x16x32_bf16 v[128:131], v[68:71], a[4:7], v[128:131]
    v_mfma_f32_16x16x32_bf16 v[132:135], v[68:71], a[68:71], v[132:135]
    v_mfma_f32_16x16x32_bf16 v[136:139], v[68:71], a[132:135], v[136:139]
    v_mfma_f32_16x16x32_bf16 v[140:143], v[68:71], a[196:199], v[140:143]
    buffer_load_dwordx4 v[68:71], v241, s[4:7], s56 offen offset:1024 sc1
    s_waitcnt vmcnt(15) lgkmcnt(0)
    v_mfma_f32_16x16x32_bf16 v[128:131], v[72:75], a[8:11], v[128:131]
    v_mfma_f32_16x16x32_bf16 v[132:135], v[72:75], a[72:75], v[132:135]
    v_mfma_f32_16x16x32_bf16 v[136:139], v[72:75], a[136:139], v[136:139]
    v_mfma_f32_16x16x32_bf16 v[140:143], v[72:75], a[200:203], v[140:143]
    buffer_load_dwordx4 v[72:75], v241, s[4:7], s56 offen offset:2048 sc1
    s_waitcnt vmcnt(15)
    v_mfma_f32_16x16x32_bf16 v[128:131], v[76:79], a[12:15], v[128:131]
    v_mfma_f32_16x16x32_bf16 v[132:135], v[76:79], a[76:79], v[132:135]
    v_mfma_f32_16x16x32_bf16 v[136:139], v[76:79], a[140:143], v[136:139]
    v_mfma_f32_16x16x32_bf16 v[140:143], v[76:79], a[204:207], v[140:143]
    buffer_load_dwordx4 v[76:79], v241, s[4:7], s56 offen offset:3072 sc1
    s_add_u32 s56, s56, 4096
    s_waitcnt vmcnt(15)
    v_mfma_f32_16x16x32_bf16 v[128:131], v[80:83], a[16:19], v[128:131]
    v_mfma_f32_16x16x32_bf16 v[132:135], v[80:83], a[80:83], v[132:135]
    v_mfma_f32_16x16x32_bf16 v[136:139], v[80:83], a[144:147], v[136:139]
    v_mfma_f32_16x16x32_bf16 v[140:143], v[80:83], a[208:211], v[140:143]
    buffer_load_dwordx4 v[80:83], v241, s[4:7], s56 offen offset:0 sc1
    s_waitcnt vmcnt(15)
    v_mfma_f32_16x16x32_bf16 v[128:131], v[84:87], a[20:23], v[128:131]
    v_mfma_f32_16x16x32_bf16 v[132:135], v[84:87], a[84:87], v[132:135]
    v_mfma_f32_16x16x32_bf16 v[136:139], v[84:87], a[148:151], v[136:139]
    v_mfma_f32_16x16x32_bf16 v[140:143], v[84:87], a[212:215], v[140:143]
    buffer_load_dwordx4 v[84:87], v241, s[4:7], s56 offen offset:1024 sc1
    s_waitcnt vmcnt(15)
    v_mfma_f32_16x16x32_bf16 v[128:131], v[88:91], a[24:27], v[128:131]
    v_mfma_f32_16x16x32_bf16 v[132:135], v[88:91], a[88:91], v[132:135]
    v_mfma_f32_16x16x32_bf16 v[136:139], v[88:91], a[152:155], v[136:139]
    v_mfma_f32_16x16x32_bf16 v[140:143], v[88:91], a[216:219], v[140:143]
    buffer_load_dwordx4 v[88:91], v241, s[4:7], s56 offen offset:2048 sc1
    s_waitcnt vmcnt(15)
    v_mfma_f32_16x16x32_bf16 v[128:131], v[92:95], a[28:31], v[128:131]
    v_mfma_f32_16x16x32_bf16 v[132:135], v[92:95], a[92:95], v[132:135]
    v_mfma_f32_16x16x32_bf16 v[136:139], v[92:95], a[156:159], v[136:139]
    v_mfma_f32_16x16x32_bf16 v[140:143], v[92:95], a[220:223], v[140:143]
    buffer_load_dwordx4 v[92:95], v241, s[4:7], s56 offen offset:3072 sc1
    s_add_u32 s56, s56, 4096
    s_waitcnt vmcnt(15)
    v_mfma_f32_16x16x32_bf16 v[128:131], v[96:99], a[32:35], v[128:131]
    v_mfma_f32_16x16x32_bf16 v[132:135], v[96:99], a[96:99], v[132:135]
    v_mfma_f32_16x16x32_bf16 v[136:139], v[96:99], a[160:163], v[136:139]
    v_mfma_f32_16x16x32_bf16 v[140:143], v[96:99], a[224:227], v[140:143]
    buffer_load_dwordx4 v[96:99], v241, s[4:7], s56 offen offset:0 sc1
    s_waitcnt vmcnt(15)
    v_mfma_f32_16x16x32_bf16 v[128:131], v[100:103], a[36:39], v[128:131]
    v_mfma_f32_16x16x32_bf16 v[132:135], v[100:103], a[100:103], v[132:135]
    v_mfma_f32_16x16x32_bf16 v[136:139], v[100:103], a[164:167], v[136:139]
    v_mfma_f32_16x16x32_bf16 v[140:143], v[100:103], a[228:231], v[140:143]
    buffer_load_dwordx4 v[100:103], v241, s[4:7], s56 offen offset:1024 sc1
    s_waitcnt vmcnt(15)
    v_mfma_f32_16x16x32_bf16 v[128:131], v[104:107], a[40:43], v[128:131]
    v_mfma_f32_16x16x32_bf16 v[132:135], v[104:107], a[104:107], v[132:135]
    v_mfma_f32_16x16x32_bf16 v[136:139], v[104:107], a[168:171], v[136:139]
    v_mfma_f32_16x16x32_bf16 v[140:143], v[104:107], a[232:235], v[140:143]
    buffer_load_dwordx4 v[104:107], v241, s[4:7], s56 offen offset:2048 sc1
    s_waitcnt vmcnt(15)
    v_mfma_f32_16x16x32_bf16 v[128:131], v[108:111], a[44:47], v[128:131]
    v_mfma_f32_16x16x32_bf16 v[132:135], v[108:111], a[108:111], v[132:135]
    v_mfma_f32_16x16x32_bf16 v[136:139], v[108:111], a[172:175], v[136:139]
    v_mfma_f32_16x16x32_bf16 v[140:143], v[108:111], a[236:239], v[140:143]
    buffer_load_dwordx4 v[108:111], v241, s[4:7], s56 offen offset:3072 sc1
    s_add_u32 s56, s56, 4096
    s_waitcnt vmcnt(15)
    v_mfma_f32_16x16x32_bf16 v[128:131], v[112:115], a[48:51], v[128:131]
    v_mfma_f32_16x16x32_bf16 v[132:135], v[112:115], a[112:115], v[132:135]
    v_mfma_f32_16x16x32_bf16 v[136:139], v[112:115], a[176:179], v[136:139]
    v_mfma_f32_16x16x32_bf16 v[140:143], v[112:115], a[240:243], v[140:143]
    buffer_load_dwordx4 v[112:115], v241, s[4:7], s56 offen offset:0 sc1
    s_waitcnt vmcnt(15)
    v_mfma_f32_16x16x32_bf16 v[128:131], v[116:119], a[52:55], v[128:131]
    v_mfma_f32_16x16x32_bf16 v[132:135], v[116:119], a[116:119], v[132:135]
    v_mfma_f32_16x16x32_bf16 v[136:139], v[116:119], a[180:183], v[136:139]
    v_mfma_f32_16x16x32_bf16 v[140:143], v[116:119], a[244:247], v[140:143]
    buffer_load_dwordx4 v[116:119], v241, s[4:7], s56 offen offset:1024 sc1
    s_waitcnt vmcnt(15)
    v_mfma_f32_16x16x32_bf16 v[128:131], v[120:123], a[56:59], v[128:131]
    v_mfma_f32_16x16x32_bf16 v[132:135], v[120:123], a[120:123], v[132:135]
    v_mfma_f32_16x16x32_bf16 v[136:139], v[120:123], a[184:187], v[136:139]
    v_mfma_f32_16x16x32_bf16 v[140:143], v[120:123], a[248:251], v[140:143]
    buffer_load_dwordx4 v[120:123], v241, s[4:7], s56 offen offset:2048 sc1
    s_waitcnt vmcnt(15)
    v_mfma_f32_16x16x32_bf16 v[128:131], v[124:127], a[60:63], v[128:131]
    v_mfma_f32_16x16x32_bf16 v[132:135], v[124:127], a[124:127], v[132:135]
    v_mfma_f32_16x16x32_bf16 v[136:139], v[124:127], a[188:191], v[136:139]
    v_mfma_f32_16x16x32_bf16 v[140:143], v[124:127], a[252:255], v[140:143]
    buffer_load_dwordx4 v[124:127], v241, s[4:7], s56 offen offset:3072 sc1
    s_add_u32 s56, s56, 53248
    s_waitcnt vmcnt(15)
    v_mfma_f32_16x16x32_bf16 v[144:147], v[64:67], a[0:3], 0
    v_mfma_f32_16x16x32_bf16 v[148:151], v[64:67], a[64:67], 0
    v_mfma_f32_16x16x32_bf16 v[152:155], v[64:67], a[128:131], 0
    v_mfma_f32_16x16x32_bf16 v[156:159], v[64:67], a[192:195], 0
    buffer_load_dwordx4 v[64:67], v241, s[4:7], s56 offen offset:0 sc1
    s_waitcnt vmcnt(15)
    v_mfma_f32_16x16x32_bf16 v[144:147], v[68:71], a[4:7], v[144:147]
    v_mfma_f32_16x16x32_bf16 v[148:151], v[68:71], a[68:71], v[148:151]
    v_mfma_f32_16x16x32_bf16 v[152:155], v[68:71], a[132:135], v[152:155]
    v_mfma_f32_16x16x32_bf16 v[156:159], v[68:71], a[196:199], v[156:159]
    buffer_load_dwordx4 v[68:71], v241, s[4:7], s56 offen offset:1024 sc1
    s_waitcnt vmcnt(15)
    v_mfma_f32_16x16x32_bf16 v[144:147], v[72:75], a[8:11], v[144:147]
    ds_write_b128 v14, v[128:131] offset:0
    v_mfma_f32_16x16x32_bf16 v[148:151], v[72:75], a[72:75], v[148:151]
    ds_write_b128 v14, v[132:135] offset:1024
    v_mfma_f32_16x16x32_bf16 v[152:155], v[72:75], a[136:139], v[152:155]
    ds_write_b128 v14, v[136:139] offset:2048
    v_mfma_f32_16x16x32_bf16 v[156:159], v[72:75], a[200:203], v[156:159]
    buffer_load_dwordx4 v[72:75], v241, s[4:7], s56 offen offset:2048 sc1
    s_waitcnt vmcnt(15)
    v_mfma_f32_16x16x32_bf16 v[144:147], v[76:79], a[12:15], v[144:147]
    ds_write_b128 v14, v[140:143] offset:3072
    v_mfma_f32_16x16x32_bf16 v[148:151], v[76:79], a[76:79], v[148:151]
    v_mfma_f32_16x16x32_bf16 v[152:155], v[76:79], a[140:143], v[152:155]
    v_mfma_f32_16x16x32_bf16 v[156:159], v[76:79], a[204:207], v[156:159]
    buffer_load_dwordx4 v[76:79], v241, s[4:7], s56 offen offset:3072 sc1
    s_add_u32 s56, s56, 4096
    s_waitcnt vmcnt(15)
    v_mfma_f32_16x16x32_bf16 v[144:147], v[80:83], a[16:19], v[144:147]
    v_mfma_f32_16x16x32_bf16 v[148:151], v[80:83], a[80:83], v[148:151]
    v_mfma_f32_16x16x32_bf16 v[152:155], v[80:83], a[144:147], v[152:155]
    v_mfma_f32_16x16x32_bf16 v[156:159], v[80:83], a[208:211], v[156:159]
    buffer_load_dwordx4 v[80:83], v241, s[4:7], s56 offen offset:0 sc1
    s_waitcnt vmcnt(15) lgkmcnt(0)
    v_mfma_f32_16x16x32_bf16 v[144:147], v[84:87], a[20:23], v[144:147]
    s_barrier
    v_mfma_f32_16x16x32_bf16 v[148:151], v[84:87], a[84:87], v[148:151]
    ds_read_b128 v[160:163], v15 offset:0
    v_mfma_f32_16x16x32_bf16 v[152:155], v[84:87], a[148:151], v[152:155]
    ds_read_b128 v[164:167], v15 offset:4096
    v_mfma_f32_16x16x32_bf16 v[156:159], v[84:87], a[212:215], v[156:159]
    buffer_load_dwordx4 v[84:87], v241, s[4:7], s56 offen offset:1024 sc1
    s_waitcnt vmcnt(15)
    v_mfma_f32_16x16x32_bf16 v[144:147], v[88:91], a[24:27], v[144:147]
    ds_read_b128 v[168:171], v15 offset:8192
    v_mfma_f32_16x16x32_bf16 v[148:151], v[88:91], a[88:91], v[148:151]
    ds_read_b128 v[172:175], v15 offset:12288
    v_mfma_f32_16x16x32_bf16 v[152:155], v[88:91], a[152:155], v[152:155]
    v_mfma_f32_16x16x32_bf16 v[156:159], v[88:91], a[216:219], v[156:159]
    buffer_load_dwordx4 v[88:91], v241, s[4:7], s56 offen offset:2048 sc1
    s_waitcnt vmcnt(15) lgkmcnt(3)
    v_mfma_f32_16x16x32_bf16 v[144:147], v[92:95], a[28:31], v[144:147]
    v_mfma_f32_16x16x32_bf16 v[148:151], v[92:95], a[92:95], v[148:151]
    v_mfma_f32_16x16x32_bf16 v[152:155], v[92:95], a[156:159], v[152:155]
    v_mfma_f32_16x16x32_bf16 v[156:159], v[92:95], a[220:223], v[156:159]
    buffer_load_dwordx4 v[92:95], v241, s[4:7], s56 offen offset:3072 sc1
    s_add_u32 s56, s56, 4096
    s_waitcnt vmcnt(15) lgkmcnt(0)
    v_mfma_f32_16x16x32_bf16 v[144:147], v[96:99], a[32:35], v[144:147]
    v_lshlrev_b32 v184, 16, v28
    v_lshlrev_b32 v185, 16, v29
    v_mfma_f32_16x16x32_bf16 v[148:151], v[96:99], a[96:99], v[148:151]
    v_lshlrev_b32 v186, 16, v30
    v_lshlrev_b32 v187, 16, v31
    v_mfma_f32_16x16x32_bf16 v[152:155], v[96:99], a[160:163], v[152:155]
    v_add_f32 v160, v160, v12
    v_add_f32 v161, v161, v12
    v_mfma_f32_16x16x32_bf16 v[156:159], v[96:99], a[224:227], v[156:159]
    buffer_load_dwordx4 v[96:99], v241, s[4:7], s56 offen offset:0 sc1
    s_waitcnt vmcnt(15)
    v_mfma_f32_16x16x32_bf16 v[144:147], v[100:103], a[36:39], v[144:147]
    v_add_f32 v162, v162, v12
    v_add_f32 v163, v163, v12
    v_mfma_f32_16x16x32_bf16 v[148:151], v[100:103], a[100:103], v[148:151]
    v_add_f32 v160, v160, v164
    v_add_f32 v161, v161, v165
    v_mfma_f32_16x16x32_bf16 v[152:155], v[100:103], a[164:167], v[152:155]
    v_add_f32 v162, v162, v166
    v_add_f32 v163, v163, v167
    v_mfma_f32_16x16x32_bf16 v[156:159], v[100:103], a[228:231], v[156:159]
    buffer_load_dwordx4 v[100:103], v241, s[4:7], s56 offen offset:1024 sc1
    s_waitcnt vmcnt(15)
    v_mfma_f32_16x16x32_bf16 v[144:147], v[104:107], a[40:43], v[144:147]
    v_add_f32 v168, v168, v172
    v_add_f32 v169, v169, v173
    v_mfma_f32_16x16x32_bf16 v[148:151], v[104:107], a[104:107], v[148:151]
    v_add_f32 v170, v170, v174
    v_add_f32 v171, v171, v175
    v_mfma_f32_16x16x32_bf16 v[152:155], v[104:107], a[168:171], v[152:155]
    v_add_f32 v160, v160, v168
    v_add_f32 v161, v161, v169
    v_mfma_f32_16x16x32_bf16 v[156:159], v[104:107], a[232:235], v[156:159]
    buffer_load_dwordx4 v[104:107], v241, s[4:7], s56 offen offset:2048 sc1
    s_waitcnt vmcnt(15)
    v_mfma_f32_16x16x32_bf16 v[144:147], v[108:111], a[44:47], v[144:147]
    v_add_f32 v162, v162, v170
    v_add_f32 v163, v163, v171
    v_mfma_f32_16x16x32_bf16 v[148:151], v[108:111], a[108:111], v[148:151]
    v_mul_f32 v176, v160, v184
    v_mul_f32 v177, v161, v185
    v_mfma_f32_16x16x32_bf16 v[152:155], v[108:111], a[172:175], v[152:155]
    v_mul_f32 v178, v162, v186
    v_mul_f32 v179, v163, v187
    v_mfma_f32_16x16x32_bf16 v[156:159], v[108:111], a[236:239], v[156:159]
    buffer_load_dwordx4 v[108:111], v241, s[4:7], s56 offen offset:3072 sc1
    s_add_u32 s56, s56, 4096
    s_waitcnt vmcnt(15)
    v_mfma_f32_16x16x32_bf16 v[144:147], v[112:115], a[48:51], v[144:147]
    v_mfma_f32_16x16x32_bf16 v[148:151], v[112:115], a[112:115], v[148:151]
    v_mfma_f32_16x16x32_bf16 v[152:155], v[112:115], a[176:179], v[152:155]
    v_mfma_f32_16x16x32_bf16 v[156:159], v[112:115], a[240:243], v[156:159]
    buffer_load_dwordx4 v[112:115], v241, s[4:7], s56 offen offset:0 sc1
    s_waitcnt vmcnt(15)
    v_mfma_f32_16x16x32_bf16 v[144:147], v[116:119], a[52:55], v[144:147]
    v_mfma_f32_16x16x32_bf16 v[148:151], v[116:119], a[116:119], v[148:151]
    v_mfma_f32_16x16x32_bf16 v[152:155], v[116:119], a[180:183], v[152:155]
    v_mfma_f32_16x16x32_bf16 v[156:159], v[116:119], a[244:247], v[156:159]
    buffer_load_dwordx4 v[116:119], v241, s[4:7], s56 offen offset:1024 sc1
    s_waitcnt vmcnt(15)
    v_mfma_f32_16x16x32_bf16 v[144:147], v[120:123], a[56:59], v[144:147]
    v_mfma_f32_16x16x32_bf16 v[148:151], v[120:123], a[120:123], v[148:151]
    v_mfma_f32_16x16x32_bf16 v[152:155], v[120:123], a[184:187], v[152:155]
    v_mfma_f32_16x16x32_bf16 v[156:159], v[120:123], a[248:251], v[156:159]
    buffer_load_dwordx4 v[120:123], v241, s[4:7], s56 offen offset:2048 sc1
    s_waitcnt vmcnt(15)
    v_mfma_f32_16x16x32_bf16 v[144:147], v[124:127], a[60:63], v[144:147]
    v_mfma_f32_16x16x32_bf16 v[148:151], v[124:127], a[124:127], v[148:151]
    v_mfma_f32_16x16x32_bf16 v[152:155], v[124:127], a[188:191], v[152:155]
    v_mfma_f32_16x16x32_bf16 v[156:159], v[124:127], a[252:255], v[156:159]
    buffer_load_dwordx4 v[124:127], v241, s[4:7], s56 offen offset:3072 sc1
    s_add_u32 s56, s56, 53248
    s_waitcnt vmcnt(15)
    v_mfma_f32_16x16x32_bf16 v[128:131], v[64:67], a[0:3], 0
    v_mfma_f32_16x16x32_bf16 v[132:135], v[64:67], a[64:67], 0
    v_mfma_f32_16x16x32_bf16 v[136:139], v[64:67], a[128:131], 0
    v_mfma_f32_16x16x32_bf16 v[140:143], v[64:67], a[192:195], 0
    buffer_load_dwordx4 v[64:67], v241, s[4:7], s56 offen offset:0 sc1
    s_waitcnt vmcnt(15)
    v_mfma_f32_16x16x32_bf16 v[128:131], v[68:71], a[4:7], v[128:131]
    v_mfma_f32_16x16x32_bf16 v[132:135], v[68:71], a[68:71], v[132:135]
    v_mfma_f32_16x16x32_bf16 v[136:139], v[68:71], a[132:135], v[136:139]
    v_mfma_f32_16x16x32_bf16 v[140:143], v[68:71], a[196:199], v[140:143]
    buffer_load_dwordx4 v[68:71], v241, s[4:7], s56 offen offset:1024 sc1
    s_waitcnt vmcnt(15)
    v_mfma_f32_16x16x32_bf16 v[128:131], v[72:75], a[8:11], v[128:131]
    ds_write_b128 v14, v[144:147] offset:16384
    v_mfma_f32_16x16x32_bf16 v[132:135], v[72:75], a[72:75], v[132:135]
    ds_write_b128 v14, v[148:151] offset:17408
    v_mfma_f32_16x16x32_bf16 v[136:139], v[72:75], a[136:139], v[136:139]
    ds_write_b128 v14, v[152:155] offset:18432
    v_mfma_f32_16x16x32_bf16 v[140:143], v[72:75], a[200:203], v[140:143]
    buffer_load_dwordx4 v[72:75], v241, s[4:7], s56 offen offset:2048 sc1
    s_waitcnt vmcnt(15)
    v_mfma_f32_16x16x32_bf16 v[128:131], v[76:79], a[12:15], v[128:131]
    ds_write_b128 v14, v[156:159] offset:19456
    v_mfma_f32_16x16x32_bf16 v[132:135], v[76:79], a[76:79], v[132:135]
    v_mfma_f32_16x16x32_bf16 v[136:139], v[76:79], a[140:143], v[136:139]
    v_mfma_f32_16x16x32_bf16 v[140:143], v[76:79], a[204:207], v[140:143]
    buffer_load_dwordx4 v[76:79], v241, s[4:7], s56 offen offset:3072 sc1
    s_add_u32 s56, s56, 4096
    s_waitcnt vmcnt(15)
    v_mfma_f32_16x16x32_bf16 v[128:131], v[80:83], a[16:19], v[128:131]
    v_mfma_f32_16x16x32_bf16 v[132:135], v[80:83], a[80:83], v[132:135]
    v_mfma_f32_16x16x32_bf16 v[136:139], v[80:83], a[144:147], v[136:139]
    v_mfma_f32_16x16x32_bf16 v[140:143], v[80:83], a[208:211], v[140:143]
    buffer_load_dwordx4 v[80:83], v241, s[4:7], s56 offen offset:0 sc1
    s_waitcnt vmcnt(15) lgkmcnt(0)
    v_mfma_f32_16x16x32_bf16 v[128:131], v[84:87], a[20:23], v[128:131]
    s_barrier
    v_mfma_f32_16x16x32_bf16 v[132:135], v[84:87], a[84:87], v[132:135]
    ds_read_b128 v[160:163], v15 offset:16384
    v_mfma_f32_16x16x32_bf16 v[136:139], v[84:87], a[148:151], v[136:139]
    ds_read_b128 v[164:167], v15 offset:20480
    v_mfma_f32_16x16x32_bf16 v[140:143], v[84:87], a[212:215], v[140:143]
    buffer_load_dwordx4 v[84:87], v241, s[4:7], s56 offen offset:1024 sc1
    s_waitcnt vmcnt(15)
    v_mfma_f32_16x16x32_bf16 v[128:131], v[88:91], a[24:27], v[128:131]
    ds_read_b128 v[168:171], v15 offset:24576
    v_mfma_f32_16x16x32_bf16 v[132:135], v[88:91], a[88:91], v[132:135]
    ds_read_b128 v[172:175], v15 offset:28672
    v_mfma_f32_16x16x32_bf16 v[136:139], v[88:91], a[152:155], v[136:139]
    v_mfma_f32_16x16x32_bf16 v[140:143], v[88:91], a[216:219], v[140:143]
    buffer_load_dwordx4 v[88:91], v241, s[4:7], s56 offen offset:2048 sc1
    s_waitcnt vmcnt(15) lgkmcnt(3)
    v_mfma_f32_16x16x32_bf16 v[128:131], v[92:95], a[28:31], v[128:131]
    v_mfma_f32_16x16x32_bf16 v[132:135], v[92:95], a[92:95], v[132:135]
    v_mfma_f32_16x16x32_bf16 v[136:139], v[92:95], a[156:159], v[136:139]
    v_mfma_f32_16x16x32_bf16 v[140:143], v[92:95], a[220:223], v[140:143]
    buffer_load_dwordx4 v[92:95], v241, s[4:7], s56 offen offset:3072 sc1
    s_add_u32 s56, s56, 4096
    s_waitcnt vmcnt(15) lgkmcnt(0)
    v_mfma_f32_16x16x32_bf16 v[128:131], v[96:99], a[32:35], v[128:131]
    v_and_b32 v184, s3, v28
    v_and_b32 v185, s3, v29
    v_mfma_f32_16x16x32_bf16 v[132:135], v[96:99], a[96:99], v[132:135]
    v_and_b32 v186, s3, v30
    v_and_b32 v187, s3, v31
    v_mfma_f32_16x16x32_bf16 v[136:139], v[96:99], a[160:163], v[136:139]
    v_add_f32 v160, v160, v12
    v_add_f32 v161, v161, v12
    v_mfma_f32_16x16x32_bf16 v[140:143], v[96:99], a[224:227], v[140:143]
    buffer_load_dwordx4 v[96:99], v241, s[4:7], s56 offen offset:0 sc1
    s_waitcnt vmcnt(15)
    v_mfma_f32_16x16x32_bf16 v[128:131], v[100:103], a[36:39], v[128:131]
    v_add_f32 v162, v162, v12
    v_add_f32 v163, v163, v12
    v_mfma_f32_16x16x32_bf16 v[132:135], v[100:103], a[100:103], v[132:135]
    v_add_f32 v160, v160, v164
    v_add_f32 v161, v161, v165
    v_mfma_f32_16x16x32_bf16 v[136:139], v[100:103], a[164:167], v[136:139]
    v_add_f32 v162, v162, v166
    v_add_f32 v163, v163, v167
    v_mfma_f32_16x16x32_bf16 v[140:143], v[100:103], a[228:231], v[140:143]
    buffer_load_dwordx4 v[100:103], v241, s[4:7], s56 offen offset:1024 sc1
    s_waitcnt vmcnt(15)
    v_mfma_f32_16x16x32_bf16 v[128:131], v[104:107], a[40:43], v[128:131]
    v_add_f32 v168, v168, v172
    v_add_f32 v169, v169, v173
    v_mfma_f32_16x16x32_bf16 v[132:135], v[104:107], a[104:107], v[132:135]
    v_add_f32 v170, v170, v174
    v_add_f32 v171, v171, v175
    v_mfma_f32_16x16x32_bf16 v[136:139], v[104:107], a[168:171], v[136:139]
    v_add_f32 v160, v160, v168
    v_add_f32 v161, v161, v169
    v_mfma_f32_16x16x32_bf16 v[140:143], v[104:107], a[232:235], v[140:143]
    buffer_load_dwordx4 v[104:107], v241, s[4:7], s56 offen offset:2048 sc1
    s_waitcnt vmcnt(15)
    v_mfma_f32_16x16x32_bf16 v[128:131], v[108:111], a[44:47], v[128:131]
    v_add_f32 v162, v162, v170
    v_add_f32 v163, v163, v171
    v_mfma_f32_16x16x32_bf16 v[132:135], v[108:111], a[108:111], v[132:135]
    v_mul_f32 v180, v160, v184
    v_mul_f32 v181, v161, v185
    v_mfma_f32_16x16x32_bf16 v[136:139], v[108:111], a[172:175], v[136:139]
    v_mul_f32 v182, v162, v186
    v_mul_f32 v183, v163, v187
    v_mfma_f32_16x16x32_bf16 v[140:143], v[108:111], a[236:239], v[140:143]
    buffer_load_dwordx4 v[108:111], v241, s[4:7], s56 offen offset:3072 sc1
    s_add_u32 s56, s56, 4096
    s_waitcnt vmcnt(15)
    v_mfma_f32_16x16x32_bf16 v[128:131], v[112:115], a[48:51], v[128:131]
    v_cvt_pk_bf16_f32 v188, v176, v180
    v_cvt_pk_bf16_f32 v189, v177, v181
    v_mfma_f32_16x16x32_bf16 v[132:135], v[112:115], a[112:115], v[132:135]
    v_cvt_pk_bf16_f32 v190, v178, v182
    v_cvt_pk_bf16_f32 v191, v179, v183
    v_mfma_f32_16x16x32_bf16 v[136:139], v[112:115], a[176:179], v[136:139]
    buffer_store_dwordx4 v[188:191], v241, s[4:7], s57 offen offset:0 sc1
    v_mfma_f32_16x16x32_bf16 v[140:143], v[112:115], a[240:243], v[140:143]
    buffer_load_dwordx4 v[112:115], v241, s[4:7], s56 offen offset:0 sc1
    s_waitcnt vmcnt(16)
    v_mfma_f32_16x16x32_bf16 v[128:131], v[116:119], a[52:55], v[128:131]
    v_mfma_f32_16x16x32_bf16 v[132:135], v[116:119], a[116:119], v[132:135]
    v_mfma_f32_16x16x32_bf16 v[136:139], v[116:119], a[180:183], v[136:139]
    v_mfma_f32_16x16x32_bf16 v[140:143], v[116:119], a[244:247], v[140:143]
    buffer_load_dwordx4 v[116:119], v241, s[4:7], s56 offen offset:1024 sc1
    s_waitcnt vmcnt(16)
    v_mfma_f32_16x16x32_bf16 v[128:131], v[120:123], a[56:59], v[128:131]
    v_mfma_f32_16x16x32_bf16 v[132:135], v[120:123], a[120:123], v[132:135]
    v_mfma_f32_16x16x32_bf16 v[136:139], v[120:123], a[184:187], v[136:139]
    v_mfma_f32_16x16x32_bf16 v[140:143], v[120:123], a[248:251], v[140:143]
    buffer_load_dwordx4 v[120:123], v241, s[4:7], s56 offen offset:2048 sc1
    s_waitcnt vmcnt(16)
    v_mfma_f32_16x16x32_bf16 v[128:131], v[124:127], a[60:63], v[128:131]
    v_mfma_f32_16x16x32_bf16 v[132:135], v[124:127], a[124:127], v[132:135]
    v_mfma_f32_16x16x32_bf16 v[136:139], v[124:127], a[188:191], v[136:139]
    v_mfma_f32_16x16x32_bf16 v[140:143], v[124:127], a[252:255], v[140:143]
    buffer_load_dwordx4 v[124:127], v241, s[4:7], s56 offen offset:3072 sc1
    s_add_u32 s56, s56, 53248
    s_waitcnt vmcnt(16)
    v_mfma_f32_16x16x32_bf16 v[144:147], v[64:67], a[0:3], 0
    v_mfma_f32_16x16x32_bf16 v[148:151], v[64:67], a[64:67], 0
    v_mfma_f32_16x16x32_bf16 v[152:155], v[64:67], a[128:131], 0
    v_mfma_f32_16x16x32_bf16 v[156:159], v[64:67], a[192:195], 0
    buffer_load_dwordx4 v[64:67], v241, s[4:7], s56 offen offset:0 sc1
    s_waitcnt vmcnt(16)
    v_mfma_f32_16x16x32_bf16 v[144:147], v[68:71], a[4:7], v[144:147]
    v_mfma_f32_16x16x32_bf16 v[148:151], v[68:71], a[68:71], v[148:151]
    v_mfma_f32_16x16x32_bf16 v[152:155], v[68:71], a[132:135], v[152:155]
    v_mfma_f32_16x16x32_bf16 v[156:159], v[68:71], a[196:199], v[156:159]
    buffer_load_dwordx4 v[68:71], v241, s[4:7], s56 offen offset:1024 sc1
    s_waitcnt vmcnt(16)
    v_mfma_f32_16x16x32_bf16 v[144:147], v[72:75], a[8:11], v[144:147]
    ds_write_b128 v14, v[128:131] offset:0
    v_mfma_f32_16x16x32_bf16 v[148:151], v[72:75], a[72:75], v[148:151]
    ds_write_b128 v14, v[132:135] offset:1024
    v_mfma_f32_16x16x32_bf16 v[152:155], v[72:75], a[136:139], v[152:155]
    ds_write_b128 v14, v[136:139] offset:2048
    v_mfma_f32_16x16x32_bf16 v[156:159], v[72:75], a[200:203], v[156:159]
    buffer_load_dwordx4 v[72:75], v241, s[4:7], s56 offen offset:2048 sc1
    s_waitcnt vmcnt(16)
    v_mfma_f32_16x16x32_bf16 v[144:147], v[76:79], a[12:15], v[144:147]
    ds_write_b128 v14, v[140:143] offset:3072
    v_mfma_f32_16x16x32_bf16 v[148:151], v[76:79], a[76:79], v[148:151]
    v_mfma_f32_16x16x32_bf16 v[152:155], v[76:79], a[140:143], v[152:155]
    v_mfma_f32_16x16x32_bf16 v[156:159], v[76:79], a[204:207], v[156:159]
    buffer_load_dwordx4 v[76:79], v241, s[4:7], s56 offen offset:3072 sc1
    s_add_u32 s56, s56, 4096
    s_waitcnt vmcnt(16)
    v_mfma_f32_16x16x32_bf16 v[144:147], v[80:83], a[16:19], v[144:147]
    v_mfma_f32_16x16x32_bf16 v[148:151], v[80:83], a[80:83], v[148:151]
    v_mfma_f32_16x16x32_bf16 v[152:155], v[80:83], a[144:147], v[152:155]
    v_mfma_f32_16x16x32_bf16 v[156:159], v[80:83], a[208:211], v[156:159]
    buffer_load_dwordx4 v[80:83], v241, s[4:7], s56 offen offset:0 sc1
    s_waitcnt vmcnt(16) lgkmcnt(0)
    v_mfma_f32_16x16x32_bf16 v[144:147], v[84:87], a[20:23], v[144:147]
    s_barrier
    v_mfma_f32_16x16x32_bf16 v[148:151], v[84:87], a[84:87], v[148:151]
    ds_read_b128 v[160:163], v15 offset:0
    v_mfma_f32_16x16x32_bf16 v[152:155], v[84:87], a[148:151], v[152:155]
    ds_read_b128 v[164:167], v15 offset:4096
    v_mfma_f32_16x16x32_bf16 v[156:159], v[84:87], a[212:215], v[156:159]
    buffer_load_dwordx4 v[84:87], v241, s[4:7], s56 offen offset:1024 sc1
    s_waitcnt vmcnt(16)
    v_mfma_f32_16x16x32_bf16 v[144:147], v[88:91], a[24:27], v[144:147]
    ds_read_b128 v[168:171], v15 offset:8192
    v_mfma_f32_16x16x32_bf16 v[148:151], v[88:91], a[88:91], v[148:151]
    ds_read_b128 v[172:175], v15 offset:12288
    v_mfma_f32_16x16x32_bf16 v[152:155], v[88:91], a[152:155], v[152:155]
    v_mfma_f32_16x16x32_bf16 v[156:159], v[88:91], a[216:219], v[156:159]
    buffer_load_dwordx4 v[88:91], v241, s[4:7], s56 offen offset:2048 sc1
    s_waitcnt vmcnt(16) lgkmcnt(3)
    v_mfma_f32_16x16x32_bf16 v[144:147], v[92:95], a[28:31], v[144:147]
    v_mfma_f32_16x16x32_bf16 v[148:151], v[92:95], a[92:95], v[148:151]
    v_mfma_f32_16x16x32_bf16 v[152:155], v[92:95], a[156:159], v[152:155]
    v_mfma_f32_16x16x32_bf16 v[156:159], v[92:95], a[220:223], v[156:159]
    buffer_load_dwordx4 v[92:95], v241, s[4:7], s56 offen offset:3072 sc1
    s_add_u32 s56, s56, 4096
    s_waitcnt vmcnt(16) lgkmcnt(0)
    v_mfma_f32_16x16x32_bf16 v[144:147], v[96:99], a[32:35], v[144:147]
    v_lshlrev_b32 v184, 16, v32
    v_lshlrev_b32 v185, 16, v33
    v_mfma_f32_16x16x32_bf16 v[148:151], v[96:99], a[96:99], v[148:151]
    v_lshlrev_b32 v186, 16, v34
    v_lshlrev_b32 v187, 16, v35
    v_mfma_f32_16x16x32_bf16 v[152:155], v[96:99], a[160:163], v[152:155]
    v_add_f32 v160, v160, v12
    v_add_f32 v161, v161, v12
    v_mfma_f32_16x16x32_bf16 v[156:159], v[96:99], a[224:227], v[156:159]
    buffer_load_dwordx4 v[96:99], v241, s[4:7], s56 offen offset:0 sc1
    s_waitcnt vmcnt(16)
    v_mfma_f32_16x16x32_bf16 v[144:147], v[100:103], a[36:39], v[144:147]
    v_add_f32 v162, v162, v12
    v_add_f32 v163, v163, v12
    v_mfma_f32_16x16x32_bf16 v[148:151], v[100:103], a[100:103], v[148:151]
    v_add_f32 v160, v160, v164
    v_add_f32 v161, v161, v165
    v_mfma_f32_16x16x32_bf16 v[152:155], v[100:103], a[164:167], v[152:155]
    v_add_f32 v162, v162, v166
    v_add_f32 v163, v163, v167
    v_mfma_f32_16x16x32_bf16 v[156:159], v[100:103], a[228:231], v[156:159]
    buffer_load_dwordx4 v[100:103], v241, s[4:7], s56 offen offset:1024 sc1
    s_waitcnt vmcnt(16)
    v_mfma_f32_16x16x32_bf16 v[144:147], v[104:107], a[40:43], v[144:147]
    v_add_f32 v168, v168, v172
    v_add_f32 v169, v169, v173
    v_mfma_f32_16x16x32_bf16 v[148:151], v[104:107], a[104:107], v[148:151]
    v_add_f32 v170, v170, v174
    v_add_f32 v171, v171, v175
    v_mfma_f32_16x16x32_bf16 v[152:155], v[104:107], a[168:171], v[152:155]
    v_add_f32 v160, v160, v168
    v_add_f32 v161, v161, v169
    v_mfma_f32_16x16x32_bf16 v[156:159], v[104:107], a[232:235], v[156:159]
    buffer_load_dwordx4 v[104:107], v241, s[4:7], s56 offen offset:2048 sc1
    s_waitcnt vmcnt(16)
    v_mfma_f32_16x16x32_bf16 v[144:147], v[108:111], a[44:47], v[144:147]
    v_add_f32 v162, v162, v170
    v_add_f32 v163, v163, v171
    v_mfma_f32_16x16x32_bf16 v[148:151], v[108:111], a[108:111], v[148:151]
    v_mul_f32 v176, v160, v184
    v_mul_f32 v177, v161, v185
    v_mfma_f32_16x16x32_bf16 v[152:155], v[108:111], a[172:175], v[152:155]
    v_mul_f32 v178, v162, v186
    v_mul_f32 v179, v163, v187
    v_mfma_f32_16x16x32_bf16 v[156:159], v[108:111], a[236:239], v[156:159]
    buffer_load_dwordx4 v[108:111], v241, s[4:7], s56 offen offset:3072 sc1
    s_add_u32 s56, s56, 4096
    s_waitcnt vmcnt(15)
    v_mfma_f32_16x16x32_bf16 v[144:147], v[112:115], a[48:51], v[144:147]
    v_mfma_f32_16x16x32_bf16 v[148:151], v[112:115], a[112:115], v[148:151]
    v_mfma_f32_16x16x32_bf16 v[152:155], v[112:115], a[176:179], v[152:155]
    v_mfma_f32_16x16x32_bf16 v[156:159], v[112:115], a[240:243], v[156:159]
    buffer_load_dwordx4 v[112:115], v241, s[4:7], s56 offen offset:0 sc1
    s_waitcnt vmcnt(15)
    v_mfma_f32_16x16x32_bf16 v[144:147], v[116:119], a[52:55], v[144:147]
    v_mfma_f32_16x16x32_bf16 v[148:151], v[116:119], a[116:119], v[148:151]
    v_mfma_f32_16x16x32_bf16 v[152:155], v[116:119], a[180:183], v[152:155]
    v_mfma_f32_16x16x32_bf16 v[156:159], v[116:119], a[244:247], v[156:159]
    buffer_load_dwordx4 v[116:119], v241, s[4:7], s56 offen offset:1024 sc1
    s_waitcnt vmcnt(15)
    v_mfma_f32_16x16x32_bf16 v[144:147], v[120:123], a[56:59], v[144:147]
    v_mfma_f32_16x16x32_bf16 v[148:151], v[120:123], a[120:123], v[148:151]
    v_mfma_f32_16x16x32_bf16 v[152:155], v[120:123], a[184:187], v[152:155]
    v_mfma_f32_16x16x32_bf16 v[156:159], v[120:123], a[248:251], v[156:159]
    buffer_load_dwordx4 v[120:123], v241, s[4:7], s56 offen offset:2048 sc1
    s_waitcnt vmcnt(15)
    v_mfma_f32_16x16x32_bf16 v[144:147], v[124:127], a[60:63], v[144:147]
    v_mfma_f32_16x16x32_bf16 v[148:151], v[124:127], a[124:127], v[148:151]
    v_mfma_f32_16x16x32_bf16 v[152:155], v[124:127], a[188:191], v[152:155]
    v_mfma_f32_16x16x32_bf16 v[156:159], v[124:127], a[252:255], v[156:159]
    buffer_load_dwordx4 v[124:127], v241, s[4:7], s56 offen offset:3072 sc1
    s_add_u32 s56, s56, 53248
    s_waitcnt vmcnt(15)
    v_mfma_f32_16x16x32_bf16 v[128:131], v[64:67], a[0:3], 0
    v_mfma_f32_16x16x32_bf16 v[132:135], v[64:67], a[64:67], 0
    v_mfma_f32_16x16x32_bf16 v[136:139], v[64:67], a[128:131], 0
    v_mfma_f32_16x16x32_bf16 v[140:143], v[64:67], a[192:195], 0
    buffer_load_dwordx4 v[64:67], v241, s[4:7], s56 offen offset:0 sc1
    s_waitcnt vmcnt(15)
    v_mfma_f32_16x16x32_bf16 v[128:131], v[68:71], a[4:7], v[128:131]
    v_mfma_f32_16x16x32_bf16 v[132:135], v[68:71], a[68:71], v[132:135]
    v_mfma_f32_16x16x32_bf16 v[136:139], v[68:71], a[132:135], v[136:139]
    v_mfma_f32_16x16x32_bf16 v[140:143], v[68:71], a[196:199], v[140:143]
    buffer_load_dwordx4 v[68:71], v241, s[4:7], s56 offen offset:1024 sc1
    s_waitcnt vmcnt(15)
    v_mfma_f32_16x16x32_bf16 v[128:131], v[72:75], a[8:11], v[128:131]
    ds_write_b128 v14, v[144:147] offset:16384
    v_mfma_f32_16x16x32_bf16 v[132:135], v[72:75], a[72:75], v[132:135]
    ds_write_b128 v14, v[148:151] offset:17408
    v_mfma_f32_16x16x32_bf16 v[136:139], v[72:75], a[136:139], v[136:139]
    ds_write_b128 v14, v[152:155] offset:18432
    v_mfma_f32_16x16x32_bf16 v[140:143], v[72:75], a[200:203], v[140:143]
    buffer_load_dwordx4 v[72:75], v241, s[4:7], s56 offen offset:2048 sc1
    s_waitcnt vmcnt(15)
    v_mfma_f32_16x16x32_bf16 v[128:131], v[76:79], a[12:15], v[128:131]
    ds_write_b128 v14, v[156:159] offset:19456
    v_mfma_f32_16x16x32_bf16 v[132:135], v[76:79], a[76:79], v[132:135]
    v_mfma_f32_16x16x32_bf16 v[136:139], v[76:79], a[140:143], v[136:139]
    v_mfma_f32_16x16x32_bf16 v[140:143], v[76:79], a[204:207], v[140:143]
    buffer_load_dwordx4 v[76:79], v241, s[4:7], s56 offen offset:3072 sc1
    s_add_u32 s56, s56, 4096
    s_waitcnt vmcnt(15)
    v_mfma_f32_16x16x32_bf16 v[128:131], v[80:83], a[16:19], v[128:131]
    v_mfma_f32_16x16x32_bf16 v[132:135], v[80:83], a[80:83], v[132:135]
    v_mfma_f32_16x16x32_bf16 v[136:139], v[80:83], a[144:147], v[136:139]
    v_mfma_f32_16x16x32_bf16 v[140:143], v[80:83], a[208:211], v[140:143]
    buffer_load_dwordx4 v[80:83], v241, s[4:7], s56 offen offset:0 sc1
    s_waitcnt vmcnt(15) lgkmcnt(0)
    v_mfma_f32_16x16x32_bf16 v[128:131], v[84:87], a[20:23], v[128:131]
    s_barrier
    v_mfma_f32_16x16x32_bf16 v[132:135], v[84:87], a[84:87], v[132:135]
    ds_read_b128 v[160:163], v15 offset:16384
    v_mfma_f32_16x16x32_bf16 v[136:139], v[84:87], a[148:151], v[136:139]
    ds_read_b128 v[164:167], v15 offset:20480
    v_mfma_f32_16x16x32_bf16 v[140:143], v[84:87], a[212:215], v[140:143]
    buffer_load_dwordx4 v[84:87], v241, s[4:7], s56 offen offset:1024 sc1
    s_waitcnt vmcnt(15)
    v_mfma_f32_16x16x32_bf16 v[128:131], v[88:91], a[24:27], v[128:131]
    ds_read_b128 v[168:171], v15 offset:24576
    v_mfma_f32_16x16x32_bf16 v[132:135], v[88:91], a[88:91], v[132:135]
    ds_read_b128 v[172:175], v15 offset:28672
    v_mfma_f32_16x16x32_bf16 v[136:139], v[88:91], a[152:155], v[136:139]
    v_mfma_f32_16x16x32_bf16 v[140:143], v[88:91], a[216:219], v[140:143]
    buffer_load_dwordx4 v[88:91], v241, s[4:7], s56 offen offset:2048 sc1
    s_waitcnt vmcnt(15) lgkmcnt(3)
    v_mfma_f32_16x16x32_bf16 v[128:131], v[92:95], a[28:31], v[128:131]
    v_mfma_f32_16x16x32_bf16 v[132:135], v[92:95], a[92:95], v[132:135]
    v_mfma_f32_16x16x32_bf16 v[136:139], v[92:95], a[156:159], v[136:139]
    v_mfma_f32_16x16x32_bf16 v[140:143], v[92:95], a[220:223], v[140:143]
    buffer_load_dwordx4 v[92:95], v241, s[4:7], s56 offen offset:3072 sc1
    s_add_u32 s56, s56, 4096
    s_waitcnt vmcnt(15) lgkmcnt(0)
    v_mfma_f32_16x16x32_bf16 v[128:131], v[96:99], a[32:35], v[128:131]
    v_and_b32 v184, s3, v32
    v_and_b32 v185, s3, v33
    v_mfma_f32_16x16x32_bf16 v[132:135], v[96:99], a[96:99], v[132:135]
    v_and_b32 v186, s3, v34
    v_and_b32 v187, s3, v35
    v_mfma_f32_16x16x32_bf16 v[136:139], v[96:99], a[160:163], v[136:139]
    v_add_f32 v160, v160, v12
    v_add_f32 v161, v161, v12
    v_mfma_f32_16x16x32_bf16 v[140:143], v[96:99], a[224:227], v[140:143]
    buffer_load_dwordx4 v[96:99], v241, s[4:7], s56 offen offset:0 sc1
    s_waitcnt vmcnt(15)
    v_mfma_f32_16x16x32_bf16 v[128:131], v[100:103], a[36:39], v[128:131]
    v_add_f32 v162, v162, v12
    v_add_f32 v163, v163, v12
    v_mfma_f32_16x16x32_bf16 v[132:135], v[100:103], a[100:103], v[132:135]
    v_add_f32 v160, v160, v164
    v_add_f32 v161, v161, v165
    v_mfma_f32_16x16x32_bf16 v[136:139], v[100:103], a[164:167], v[136:139]
    v_add_f32 v162, v162, v166
    v_add_f32 v163, v163, v167
    v_mfma_f32_16x16x32_bf16 v[140:143], v[100:103], a[228:231], v[140:143]
    buffer_load_dwordx4 v[100:103], v241, s[4:7], s56 offen offset:1024 sc1
    s_waitcnt vmcnt(15)
    v_mfma_f32_16x16x32_bf16 v[128:131], v[104:107], a[40:43], v[128:131]
    v_add_f32 v168, v168, v172
    v_add_f32 v169, v169, v173
    v_mfma_f32_16x16x32_bf16 v[132:135], v[104:107], a[104:107], v[132:135]
    v_add_f32 v170, v170, v174
    v_add_f32 v171, v171, v175
    v_mfma_f32_16x16x32_bf16 v[136:139], v[104:107], a[168:171], v[136:139]
    v_add_f32 v160, v160, v168
    v_add_f32 v161, v161, v169
    v_mfma_f32_16x16x32_bf16 v[140:143], v[104:107], a[232:235], v[140:143]
    buffer_load_dwordx4 v[104:107], v241, s[4:7], s56 offen offset:2048 sc1
    s_waitcnt vmcnt(15)
    v_mfma_f32_16x16x32_bf16 v[128:131], v[108:111], a[44:47], v[128:131]
    v_add_f32 v162, v162, v170
    v_add_f32 v163, v163, v171
    v_mfma_f32_16x16x32_bf16 v[132:135], v[108:111], a[108:111], v[132:135]
    v_mul_f32 v180, v160, v184
    v_mul_f32 v181, v161, v185
    v_mfma_f32_16x16x32_bf16 v[136:139], v[108:111], a[172:175], v[136:139]
    v_mul_f32 v182, v162, v186
    v_mul_f32 v183, v163, v187
    v_mfma_f32_16x16x32_bf16 v[140:143], v[108:111], a[236:239], v[140:143]
    buffer_load_dwordx4 v[108:111], v241, s[4:7], s56 offen offset:3072 sc1
    s_add_u32 s56, s56, 4096
    s_waitcnt vmcnt(15)
    v_mfma_f32_16x16x32_bf16 v[128:131], v[112:115], a[48:51], v[128:131]
    v_cvt_pk_bf16_f32 v188, v176, v180
    v_cvt_pk_bf16_f32 v189, v177, v181
    v_mfma_f32_16x16x32_bf16 v[132:135], v[112:115], a[112:115], v[132:135]
    v_cvt_pk_bf16_f32 v190, v178, v182
    v_cvt_pk_bf16_f32 v191, v179, v183
    v_mfma_f32_16x16x32_bf16 v[136:139], v[112:115], a[176:179], v[136:139]
    buffer_store_dwordx4 v[188:191], v241, s[4:7], s57 offen offset:1024 sc1
    v_mfma_f32_16x16x32_bf16 v[140:143], v[112:115], a[240:243], v[140:143]
    buffer_load_dwordx4 v[112:115], v241, s[4:7], s56 offen offset:0 sc1
    s_waitcnt vmcnt(16)
    v_mfma_f32_16x16x32_bf16 v[128:131], v[116:119], a[52:55], v[128:131]
    v_mfma_f32_16x16x32_bf16 v[132:135], v[116:119], a[116:119], v[132:135]
    v_mfma_f32_16x16x32_bf16 v[136:139], v[116:119], a[180:183], v[136:139]
    v_mfma_f32_16x16x32_bf16 v[140:143], v[116:119], a[244:247], v[140:143]
    buffer_load_dwordx4 v[116:119], v241, s[4:7], s56 offen offset:1024 sc1
    s_waitcnt vmcnt(16)
    v_mfma_f32_16x16x32_bf16 v[128:131], v[120:123], a[56:59], v[128:131]
    v_mfma_f32_16x16x32_bf16 v[132:135], v[120:123], a[120:123], v[132:135]
    v_mfma_f32_16x16x32_bf16 v[136:139], v[120:123], a[184:187], v[136:139]
    v_mfma_f32_16x16x32_bf16 v[140:143], v[120:123], a[248:251], v[140:143]
    buffer_load_dwordx4 v[120:123], v241, s[4:7], s56 offen offset:2048 sc1
    s_waitcnt vmcnt(16)
    v_mfma_f32_16x16x32_bf16 v[128:131], v[124:127], a[60:63], v[128:131]
    v_mfma_f32_16x16x32_bf16 v[132:135], v[124:127], a[124:127], v[132:135]
    v_mfma_f32_16x16x32_bf16 v[136:139], v[124:127], a[188:191], v[136:139]
    v_mfma_f32_16x16x32_bf16 v[140:143], v[124:127], a[252:255], v[140:143]
    buffer_load_dwordx4 v[124:127], v241, s[4:7], s56 offen offset:3072 sc1
    s_add_u32 s56, s56, 53248
    s_waitcnt vmcnt(16)
    v_mfma_f32_16x16x32_bf16 v[144:147], v[64:67], a[0:3], 0
    v_mfma_f32_16x16x32_bf16 v[148:151], v[64:67], a[64:67], 0
    v_mfma_f32_16x16x32_bf16 v[152:155], v[64:67], a[128:131], 0
    v_mfma_f32_16x16x32_bf16 v[156:159], v[64:67], a[192:195], 0
    buffer_load_dwordx4 v[64:67], v241, s[4:7], s56 offen offset:0 sc1
    s_waitcnt vmcnt(16)
    v_mfma_f32_16x16x32_bf16 v[144:147], v[68:71], a[4:7], v[144:147]
    v_mfma_f32_16x16x32_bf16 v[148:151], v[68:71], a[68:71], v[148:151]
    v_mfma_f32_16x16x32_bf16 v[152:155], v[68:71], a[132:135], v[152:155]
    v_mfma_f32_16x16x32_bf16 v[156:159], v[68:71], a[196:199], v[156:159]
    buffer_load_dwordx4 v[68:71], v241, s[4:7], s56 offen offset:1024 sc1
    s_waitcnt vmcnt(16)
    v_mfma_f32_16x16x32_bf16 v[144:147], v[72:75], a[8:11], v[144:147]
    ds_write_b128 v14, v[128:131] offset:0
    v_mfma_f32_16x16x32_bf16 v[148:151], v[72:75], a[72:75], v[148:151]
    ds_write_b128 v14, v[132:135] offset:1024
    v_mfma_f32_16x16x32_bf16 v[152:155], v[72:75], a[136:139], v[152:155]
    ds_write_b128 v14, v[136:139] offset:2048
    v_mfma_f32_16x16x32_bf16 v[156:159], v[72:75], a[200:203], v[156:159]
    buffer_load_dwordx4 v[72:75], v241, s[4:7], s56 offen offset:2048 sc1
    s_waitcnt vmcnt(16)
    v_mfma_f32_16x16x32_bf16 v[144:147], v[76:79], a[12:15], v[144:147]
    ds_write_b128 v14, v[140:143] offset:3072
    v_mfma_f32_16x16x32_bf16 v[148:151], v[76:79], a[76:79], v[148:151]
    v_mfma_f32_16x16x32_bf16 v[152:155], v[76:79], a[140:143], v[152:155]
    v_mfma_f32_16x16x32_bf16 v[156:159], v[76:79], a[204:207], v[156:159]
    buffer_load_dwordx4 v[76:79], v241, s[4:7], s56 offen offset:3072 sc1
    s_add_u32 s56, s56, 4096
    s_waitcnt vmcnt(16)
    v_mfma_f32_16x16x32_bf16 v[144:147], v[80:83], a[16:19], v[144:147]
    v_mfma_f32_16x16x32_bf16 v[148:151], v[80:83], a[80:83], v[148:151]
    v_mfma_f32_16x16x32_bf16 v[152:155], v[80:83], a[144:147], v[152:155]
    v_mfma_f32_16x16x32_bf16 v[156:159], v[80:83], a[208:211], v[156:159]
    buffer_load_dwordx4 v[80:83], v241, s[4:7], s56 offen offset:0 sc1
    s_waitcnt vmcnt(16) lgkmcnt(0)
    v_mfma_f32_16x16x32_bf16 v[144:147], v[84:87], a[20:23], v[144:147]
    s_barrier
    v_mfma_f32_16x16x32_bf16 v[148:151], v[84:87], a[84:87], v[148:151]
    ds_read_b128 v[160:163], v15 offset:0
    v_mfma_f32_16x16x32_bf16 v[152:155], v[84:87], a[148:151], v[152:155]
    ds_read_b128 v[164:167], v15 offset:4096
    v_mfma_f32_16x16x32_bf16 v[156:159], v[84:87], a[212:215], v[156:159]
    buffer_load_dwordx4 v[84:87], v241, s[4:7], s56 offen offset:1024 sc1
    s_waitcnt vmcnt(16)
    v_mfma_f32_16x16x32_bf16 v[144:147], v[88:91], a[24:27], v[144:147]
    ds_read_b128 v[168:171], v15 offset:8192
    v_mfma_f32_16x16x32_bf16 v[148:151], v[88:91], a[88:91], v[148:151]
    ds_read_b128 v[172:175], v15 offset:12288
    v_mfma_f32_16x16x32_bf16 v[152:155], v[88:91], a[152:155], v[152:155]
    v_mfma_f32_16x16x32_bf16 v[156:159], v[88:91], a[216:219], v[156:159]
    buffer_load_dwordx4 v[88:91], v241, s[4:7], s56 offen offset:2048 sc1
    s_waitcnt vmcnt(16) lgkmcnt(3)
    v_mfma_f32_16x16x32_bf16 v[144:147], v[92:95], a[28:31], v[144:147]
    v_mfma_f32_16x16x32_bf16 v[148:151], v[92:95], a[92:95], v[148:151]
    v_mfma_f32_16x16x32_bf16 v[152:155], v[92:95], a[156:159], v[152:155]
    v_mfma_f32_16x16x32_bf16 v[156:159], v[92:95], a[220:223], v[156:159]
    buffer_load_dwordx4 v[92:95], v241, s[4:7], s56 offen offset:3072 sc1
    s_add_u32 s56, s56, 4096
    s_waitcnt vmcnt(16) lgkmcnt(0)
    v_mfma_f32_16x16x32_bf16 v[144:147], v[96:99], a[32:35], v[144:147]
    v_lshlrev_b32 v184, 16, v36
    v_lshlrev_b32 v185, 16, v37
    v_mfma_f32_16x16x32_bf16 v[148:151], v[96:99], a[96:99], v[148:151]
    v_lshlrev_b32 v186, 16, v38
    v_lshlrev_b32 v187, 16, v39
    v_mfma_f32_16x16x32_bf16 v[152:155], v[96:99], a[160:163], v[152:155]
    v_add_f32 v160, v160, v12
    v_add_f32 v161, v161, v12
    v_mfma_f32_16x16x32_bf16 v[156:159], v[96:99], a[224:227], v[156:159]
    buffer_load_dwordx4 v[96:99], v241, s[4:7], s56 offen offset:0 sc1
    s_waitcnt vmcnt(16)
    v_mfma_f32_16x16x32_bf16 v[144:147], v[100:103], a[36:39], v[144:147]
    v_add_f32 v162, v162, v12
    v_add_f32 v163, v163, v12
    v_mfma_f32_16x16x32_bf16 v[148:151], v[100:103], a[100:103], v[148:151]
    v_add_f32 v160, v160, v164
    v_add_f32 v161, v161, v165
    v_mfma_f32_16x16x32_bf16 v[152:155], v[100:103], a[164:167], v[152:155]
    v_add_f32 v162, v162, v166
    v_add_f32 v163, v163, v167
    v_mfma_f32_16x16x32_bf16 v[156:159], v[100:103], a[228:231], v[156:159]
    buffer_load_dwordx4 v[100:103], v241, s[4:7], s56 offen offset:1024 sc1
    s_waitcnt vmcnt(16)
    v_mfma_f32_16x16x32_bf16 v[144:147], v[104:107], a[40:43], v[144:147]
    v_add_f32 v168, v168, v172
    v_add_f32 v169, v169, v173
    v_mfma_f32_16x16x32_bf16 v[148:151], v[104:107], a[104:107], v[148:151]
    v_add_f32 v170, v170, v174
    v_add_f32 v171, v171, v175
    v_mfma_f32_16x16x32_bf16 v[152:155], v[104:107], a[168:171], v[152:155]
    v_add_f32 v160, v160, v168
    v_add_f32 v161, v161, v169
    v_mfma_f32_16x16x32_bf16 v[156:159], v[104:107], a[232:235], v[156:159]
    buffer_load_dwordx4 v[104:107], v241, s[4:7], s56 offen offset:2048 sc1
    s_waitcnt vmcnt(16)
    v_mfma_f32_16x16x32_bf16 v[144:147], v[108:111], a[44:47], v[144:147]
    v_add_f32 v162, v162, v170
    v_add_f32 v163, v163, v171
    v_mfma_f32_16x16x32_bf16 v[148:151], v[108:111], a[108:111], v[148:151]
    v_mul_f32 v176, v160, v184
    v_mul_f32 v177, v161, v185
    v_mfma_f32_16x16x32_bf16 v[152:155], v[108:111], a[172:175], v[152:155]
    v_mul_f32 v178, v162, v186
    v_mul_f32 v179, v163, v187
    v_mfma_f32_16x16x32_bf16 v[156:159], v[108:111], a[236:239], v[156:159]
    buffer_load_dwordx4 v[108:111], v241, s[4:7], s56 offen offset:3072 sc1
    s_add_u32 s56, s56, 4096
    s_waitcnt vmcnt(15)
    v_mfma_f32_16x16x32_bf16 v[144:147], v[112:115], a[48:51], v[144:147]
    v_mfma_f32_16x16x32_bf16 v[148:151], v[112:115], a[112:115], v[148:151]
    v_mfma_f32_16x16x32_bf16 v[152:155], v[112:115], a[176:179], v[152:155]
    v_mfma_f32_16x16x32_bf16 v[156:159], v[112:115], a[240:243], v[156:159]
    buffer_load_dwordx4 v[112:115], v241, s[4:7], s56 offen offset:0 sc1
    s_waitcnt vmcnt(15)
    v_mfma_f32_16x16x32_bf16 v[144:147], v[116:119], a[52:55], v[144:147]
    v_mfma_f32_16x16x32_bf16 v[148:151], v[116:119], a[116:119], v[148:151]
    v_mfma_f32_16x16x32_bf16 v[152:155], v[116:119], a[180:183], v[152:155]
    v_mfma_f32_16x16x32_bf16 v[156:159], v[116:119], a[244:247], v[156:159]
    buffer_load_dwordx4 v[116:119], v241, s[4:7], s56 offen offset:1024 sc1
    s_waitcnt vmcnt(15)
    v_mfma_f32_16x16x32_bf16 v[144:147], v[120:123], a[56:59], v[144:147]
    v_mfma_f32_16x16x32_bf16 v[148:151], v[120:123], a[120:123], v[148:151]
    v_mfma_f32_16x16x32_bf16 v[152:155], v[120:123], a[184:187], v[152:155]
    v_mfma_f32_16x16x32_bf16 v[156:159], v[120:123], a[248:251], v[156:159]
    buffer_load_dwordx4 v[120:123], v241, s[4:7], s56 offen offset:2048 sc1
    s_waitcnt vmcnt(15)
    v_mfma_f32_16x16x32_bf16 v[144:147], v[124:127], a[60:63], v[144:147]
    v_mfma_f32_16x16x32_bf16 v[148:151], v[124:127], a[124:127], v[148:151]
    v_mfma_f32_16x16x32_bf16 v[152:155], v[124:127], a[188:191], v[152:155]
    v_mfma_f32_16x16x32_bf16 v[156:159], v[124:127], a[252:255], v[156:159]
    buffer_load_dwordx4 v[124:127], v241, s[4:7], s56 offen offset:3072 sc1
    s_add_u32 s56, s56, 53248
    s_waitcnt vmcnt(15)
    v_mfma_f32_16x16x32_bf16 v[128:131], v[64:67], a[0:3], 0
    v_mfma_f32_16x16x32_bf16 v[132:135], v[64:67], a[64:67], 0
    v_mfma_f32_16x16x32_bf16 v[136:139], v[64:67], a[128:131], 0
    v_mfma_f32_16x16x32_bf16 v[140:143], v[64:67], a[192:195], 0
    s_add_u32 m0, s53, 40960
    s_nop 0
    buffer_load_dwordx4 v241, s[4:7], s59 offen offset:0 sc1 lds
    s_waitcnt vmcnt(15)
    v_mfma_f32_16x16x32_bf16 v[128:131], v[68:71], a[4:7], v[128:131]
    v_mfma_f32_16x16x32_bf16 v[132:135], v[68:71], a[68:71], v[132:135]
    v_mfma_f32_16x16x32_bf16 v[136:139], v[68:71], a[132:135], v[136:139]
    v_mfma_f32_16x16x32_bf16 v[140:143], v[68:71], a[196:199], v[140:143]
    s_waitcnt vmcnt(14)
    v_mfma_f32_16x16x32_bf16 v[128:131], v[72:75], a[8:11], v[128:131]
    ds_write_b128 v14, v[144:147] offset:16384
    v_mfma_f32_16x16x32_bf16 v[132:135], v[72:75], a[72:75], v[132:135]
    ds_write_b128 v14, v[148:151] offset:17408
    v_mfma_f32_16x16x32_bf16 v[136:139], v[72:75], a[136:139], v[136:139]
    ds_write_b128 v14, v[152:155] offset:18432
    v_mfma_f32_16x16x32_bf16 v[140:143], v[72:75], a[200:203], v[140:143]
    buffer_load_dwordx4 v241, s[4:7], s59 offen offset:1024 sc1 lds
    s_waitcnt vmcnt(14)
    v_mfma_f32_16x16x32_bf16 v[128:131], v[76:79], a[12:15], v[128:131]
    ds_write_b128 v14, v[156:159] offset:19456
    v_mfma_f32_16x16x32_bf16 v[132:135], v[76:79], a[76:79], v[132:135]
    v_mfma_f32_16x16x32_bf16 v[136:139], v[76:79], a[140:143], v[136:139]
    v_mfma_f32_16x16x32_bf16 v[140:143], v[76:79], a[204:207], v[140:143]
    s_waitcnt vmcnt(13)
    v_mfma_f32_16x16x32_bf16 v[128:131], v[80:83], a[16:19], v[128:131]
    v_mfma_f32_16x16x32_bf16 v[132:135], v[80:83], a[80:83], v[132:135]
    v_mfma_f32_16x16x32_bf16 v[136:139], v[80:83], a[144:147], v[136:139]
    v_mfma_f32_16x16x32_bf16 v[140:143], v[80:83], a[208:211], v[140:143]
    buffer_load_dwordx4 v241, s[4:7], s59 offen offset:2048 sc1 lds
    s_waitcnt vmcnt(13) lgkmcnt(0)
    v_mfma_f32_16x16x32_bf16 v[128:131], v[84:87], a[20:23], v[128:131]
    s_barrier
    v_mfma_f32_16x16x32_bf16 v[132:135], v[84:87], a[84:87], v[132:135]
    ds_read_b128 v[160:163], v15 offset:16384
    v_mfma_f32_16x16x32_bf16 v[136:139], v[84:87], a[148:151], v[136:139]
    ds_read_b128 v[164:167], v15 offset:20480
    v_mfma_f32_16x16x32_bf16 v[140:143], v[84:87], a[212:215], v[140:143]
    s_waitcnt vmcnt(12)
    v_mfma_f32_16x16x32_bf16 v[128:131], v[88:91], a[24:27], v[128:131]
    ds_read_b128 v[168:171], v15 offset:24576
    v_mfma_f32_16x16x32_bf16 v[132:135], v[88:91], a[88:91], v[132:135]
    ds_read_b128 v[172:175], v15 offset:28672
    v_mfma_f32_16x16x32_bf16 v[136:139], v[88:91], a[152:155], v[136:139]
    v_mfma_f32_16x16x32_bf16 v[140:143], v[88:91], a[216:219], v[140:143]
    buffer_load_dwordx4 v241, s[4:7], s59 offen offset:3072 sc1 lds
    s_add_u32 s59, s59, 4096
    s_waitcnt vmcnt(12) lgkmcnt(3)
    v_mfma_f32_16x16x32_bf16 v[128:131], v[92:95], a[28:31], v[128:131]
    v_mfma_f32_16x16x32_bf16 v[132:135], v[92:95], a[92:95], v[132:135]
    v_mfma_f32_16x16x32_bf16 v[136:139], v[92:95], a[156:159], v[136:139]
    v_mfma_f32_16x16x32_bf16 v[140:143], v[92:95], a[220:223], v[140:143]
    s_waitcnt vmcnt(11) lgkmcnt(0)
    v_mfma_f32_16x16x32_bf16 v[128:131], v[96:99], a[32:35], v[128:131]
    v_and_b32 v184, s3, v36
    v_and_b32 v185, s3, v37
    v_mfma_f32_16x16x32_bf16 v[132:135], v[96:99], a[96:99], v[132:135]
    v_and_b32 v186, s3, v38
    v_and_b32 v187, s3, v39
    v_mfma_f32_16x16x32_bf16 v[136:139], v[96:99], a[160:163], v[136:139]
    v_add_f32 v160, v160, v12
    v_add_f32 v161, v161, v12
    v_mfma_f32_16x16x32_bf16 v[140:143], v[96:99], a[224:227], v[140:143]
    s_add_u32 m0, s53, 45056
    s_nop 0
    buffer_load_dwordx4 v241, s[4:7], s59 offen offset:0 sc1 lds
    s_add_u32 s59, s59, 16384
    s_waitcnt vmcnt(11)
    v_mfma_f32_16x16x32_bf16 v[128:131], v[100:103], a[36:39], v[128:131]
    v_add_f32 v162, v162, v12
    v_add_f32 v163, v163, v12
    v_mfma_f32_16x16x32_bf16 v[132:135], v[100:103], a[100:103], v[132:135]
    v_add_f32 v160, v160, v164
    v_add_f32 v161, v161, v165
    v_mfma_f32_16x16x32_bf16 v[136:139], v[100:103], a[164:167], v[136:139]
    v_add_f32 v162, v162, v166
    v_add_f32 v163, v163, v167
    v_mfma_f32_16x16x32_bf16 v[140:143], v[100:103], a[228:231], v[140:143]
    s_waitcnt vmcnt(10)
    v_mfma_f32_16x16x32_bf16 v[128:131], v[104:107], a[40:43], v[128:131]
    v_add_f32 v168, v168, v172
    v_add_f32 v169, v169, v173
    v_mfma_f32_16x16x32_bf16 v[132:135], v[104:107], a[104:107], v[132:135]
    v_add_f32 v170, v170, v174
    v_add_f32 v171, v171, v175
    v_mfma_f32_16x16x32_bf16 v[136:139], v[104:107], a[168:171], v[136:139]
    v_add_f32 v160, v160, v168
    v_add_f32 v161, v161, v169
    v_mfma_f32_16x16x32_bf16 v[140:143], v[104:107], a[232:235], v[140:143]
    s_add_u32 m0, s53, 61440
    s_nop 0
    buffer_load_dwordx4 v241, s[4:7], s59 offen offset:0 sc1 lds
    s_waitcnt vmcnt(10)
    v_mfma_f32_16x16x32_bf16 v[128:131], v[108:111], a[44:47], v[128:131]
    v_add_f32 v162, v162, v170
    v_add_f32 v163, v163, v171
    v_mfma_f32_16x16x32_bf16 v[132:135], v[108:111], a[108:111], v[132:135]
    v_mul_f32 v180, v160, v184
    v_mul_f32 v181, v161, v185
    v_mfma_f32_16x16x32_bf16 v[136:139], v[108:111], a[172:175], v[136:139]
    v_mul_f32 v182, v162, v186
    v_mul_f32 v183, v163, v187
    v_mfma_f32_16x16x32_bf16 v[140:143], v[108:111], a[236:239], v[140:143]
    s_waitcnt vmcnt(9)
    v_mfma_f32_16x16x32_bf16 v[128:131], v[112:115], a[48:51], v[128:131]
    v_cvt_pk_bf16_f32 v188, v176, v180
    v_cvt_pk_bf16_f32 v189, v177, v181
    v_mfma_f32_16x16x32_bf16 v[132:135], v[112:115], a[112:115], v[132:135]
    v_cvt_pk_bf16_f32 v190, v178, v182
    v_cvt_pk_bf16_f32 v191, v179, v183
    v_mfma_f32_16x16x32_bf16 v[136:139], v[112:115], a[176:179], v[136:139]
    buffer_store_dwordx4 v[188:191], v241, s[4:7], s57 offen offset:2048 sc1
    v_mfma_f32_16x16x32_bf16 v[140:143], v[112:115], a[240:243], v[140:143]
    buffer_load_dwordx4 v241, s[4:7], s59 offen offset:1024 sc1 lds
    s_waitcnt vmcnt(10)
    v_mfma_f32_16x16x32_bf16 v[128:131], v[116:119], a[52:55], v[128:131]
    v_mfma_f32_16x16x32_bf16 v[132:135], v[116:119], a[116:119], v[132:135]
    v_mfma_f32_16x16x32_bf16 v[136:139], v[116:119], a[180:183], v[136:139]
    v_mfma_f32_16x16x32_bf16 v[140:143], v[116:119], a[244:247], v[140:143]
    s_waitcnt vmcnt(9)
    v_mfma_f32_16x16x32_bf16 v[128:131], v[120:123], a[56:59], v[128:131]
    v_mfma_f32_16x16x32_bf16 v[132:135], v[120:123], a[120:123], v[132:135]
    v_mfma_f32_16x16x32_bf16 v[136:139], v[120:123], a[184:187], v[136:139]
    v_mfma_f32_16x16x32_bf16 v[140:143], v[120:123], a[248:251], v[140:143]
    buffer_load_dwordx4 v241, s[4:7], s59 offen offset:2048 sc1 lds
    s_waitcnt vmcnt(9)
    v_mfma_f32_16x16x32_bf16 v[128:131], v[124:127], a[60:63], v[128:131]
    v_mfma_f32_16x16x32_bf16 v[132:135], v[124:127], a[124:127], v[132:135]
    v_mfma_f32_16x16x32_bf16 v[136:139], v[124:127], a[188:191], v[136:139]
    v_mfma_f32_16x16x32_bf16 v[140:143], v[124:127], a[252:255], v[140:143]
    s_nop 4
    ds_write_b128 v14, v[128:131] offset:0
    ds_write_b128 v14, v[132:135] offset:1024
    ds_write_b128 v14, v[136:139] offset:2048
    ds_write_b128 v14, v[140:143] offset:3072
    s_waitcnt lgkmcnt(0)
    s_barrier
    ds_read_b128 v[160:163], v15 offset:0
    ds_read_b128 v[164:167], v15 offset:4096
    ds_read_b128 v[168:171], v15 offset:8192
    ds_read_b128 v[172:175], v15 offset:12288
    v_lshlrev_b32 v184, 16, v40
    v_lshlrev_b32 v185, 16, v41
    v_lshlrev_b32 v186, 16, v42
    v_lshlrev_b32 v187, 16, v43
    s_waitcnt lgkmcnt(3)
    v_add_f32 v160, v160, v12
    v_add_f32 v161, v161, v12
    v_add_f32 v162, v162, v12
    v_add_f32 v163, v163, v12
    s_waitcnt lgkmcnt(2)
    v_add_f32 v160, v160, v164
    v_add_f32 v161, v161, v165
    v_add_f32 v162, v162, v166
    v_add_f32 v163, v163, v167
    s_waitcnt lgkmcnt(0)
    v_add_f32 v168, v168, v172
    v_add_f32 v169, v169, v173
    v_add_f32 v170, v170, v174
    v_add_f32 v171, v171, v175
    v_add_f32 v160, v160, v168
    v_add_f32 v161, v161, v169
    v_add_f32 v162, v162, v170
    v_add_f32 v163, v163, v171
    v_mul_f32 v176, v160, v184
    v_mul_f32 v177, v161, v185
    v_mul_f32 v178, v162, v186
    v_mul_f32 v179, v163, v187
    v_cvt_pk_bf16_f32 v188, v176, v177
    v_cvt_pk_bf16_f32 v189, v178, v179
    buffer_store_dwordx2 v[188:189], v241, s[4:7], s58 offen sc1
    buffer_load_dwordx4 v241, s[4:7], s59 offen offset:3072 sc1 lds
    s_add_u32 s59, s59, 4096
    s_add_u32 m0, s53, 65536
    s_nop 0
    buffer_load_dwordx4 v241, s[4:7], s59 offen offset:0 sc1 lds
    s_add_u32 s59, s59, 16384
    s_add_u32 m0, s53, 81920
    s_nop 0
    buffer_load_dwordx4 v241, s[4:7], s59 offen offset:0 sc1 lds
    buffer_load_dwordx4 v241, s[4:7], s59 offen offset:1024 sc1 lds
    buffer_load_dwordx4 v241, s[4:7], s59 offen offset:2048 sc1 lds
    buffer_load_dwordx4 v241, s[4:7], s59 offen offset:3072 sc1 lds
    s_add_u32 s59, s59, 4096
    s_add_u32 m0, s53, 86016
    s_nop 0
    buffer_load_dwordx4 v241, s[4:7], s59 offen offset:0 sc1 lds
    s_add_u32 s59, s59, 16384
    s_add_u32 m0, s53, 102400
    s_nop 0
    buffer_load_dwordx4 v241, s[4:7], s59 offen offset:0 sc1 lds
    buffer_load_dwordx4 v241, s[4:7], s59 offen offset:1024 sc1 lds
    buffer_load_dwordx4 v241, s[4:7], s59 offen offset:2048 sc1 lds
    s_lshl_b32 s62, s84, 5
    s_add_u32 s62, s62, s55
    v_mul_u32_u24 v3, 33024, v240
    s_waitcnt vmcnt(10)
    s_mov_b64 exec, 3
    buffer_store_dword v13, v3, s[4:7], s62 offen sc1
    s_mov_b64 exec, -1
    s_lshr_b32 s62, s84, 2
    s_mul_i32 s62, s62, 33024
    s_add_u32 s55, s55, s62
    buffer_load_dwordx4 v241, s[4:7], s59 offen offset:3072 sc1 lds
    s_add_u32 s59, s59, 4096
    s_add_u32 m0, s53, 106496
    s_nop 0
    buffer_load_dwordx4 v241, s[4:7], s59 offen offset:0 sc1 lds
    s_add_u32 s59, s59, 16384
    s_add_u32 m0, s53, 122880
    s_nop 0
    buffer_load_dwordx4 v241, s[4:7], s59 offen offset:0 sc1 lds
    buffer_load_dwordx4 v241, s[4:7], s59 offen offset:1024 sc1 lds
    buffer_load_dwordx4 v241, s[4:7], s59 offen offset:2048 sc1 lds
    buffer_load_dwordx4 v241, s[4:7], s59 offen offset:3072 sc1 lds
    s_add_u32 s59, s59, 4096
    s_add_u32 m0, s53, 126976
    s_nop 0
    buffer_load_dwordx4 v241, s[4:7], s59 offen offset:0 sc1 lds
    s_add_u32 s59, s59, 16384
    s_add_u32 m0, s53, 143360
    s_nop 0
    buffer_load_dwordx4 v241, s[4:7], s59 offen offset:0 sc1 lds
    buffer_load_dwordx4 v241, s[4:7], s59 offen offset:1024 sc1 lds
    buffer_load_dwordx4 v241, s[4:7], s59 offen offset:2048 sc1 lds
    buffer_load_dwordx4 v241, s[4:7], s59 offen offset:3072 sc1 lds
    s_add_u32 s59, s59, 4096
    s_add_u32 m0, s53, 147456
    s_nop 0
    buffer_load_dwordx4 v241, s[4:7], s59 offen offset:0 sc1 lds
    s_add_u32 s59, s59, 16384
    s_add_u32 m0, s53, 20480
    s_nop 0
    buffer_load_dwordx4 v241, s[4:7], s59 offen offset:0 sc1 lds
    buffer_load_dwordx4 v241, s[4:7], s59 offen offset:1024 sc1 lds
    buffer_load_dwordx4 v241, s[4:7], s59 offen offset:2048 sc1 lds
    buffer_load_dwordx4 v241, s[4:7], s59 offen offset:3072 sc1 lds
    s_add_u32 s59, s59, 4096
    s_add_u32 m0, s53, 24576
    s_nop 0
    buffer_load_dwordx4 v241, s[4:7], s59 offen offset:0 sc1 lds
    s_add_u32 s59, s59, 16384
    v_add_u32 v236, 20480, v241
    v_add_u32 v237, 81920, v241
    v_add_u32 v238, 143360, v241
    buffer_load_dword v27, v26, s[4:7], s55 offen sc1
    s_mov_b32 s49, 65536
L_adaL_poll_19:
    s_waitcnt vmcnt(0)
    v_cmp_ne_u32 vcc, s48, v27
    s_nop 0
    s_cbranch_vccz L_adaL_got_20
    buffer_load_dword v27, v26, s[4:7], s55 offen sc1
    s_waitcnt vmcnt(0)
    s_sub_u32 s49, s49, 1
    s_cmp_lg_u32 s49, 0
    s_cbranch_scc1 L_adaL_poll_19
L_adaL_got_20:
    s_barrier
    buffer_load_dwordx4 v[64:67], v241, s[4:7], s85 offen offset:0 sc1
    buffer_load_dwordx4 v[68:71], v241, s[4:7], s85 offen offset:1024 sc1
    buffer_load_dwordx4 v[72:75], v241, s[4:7], s85 offen offset:2048 sc1
    buffer_load_dwordx4 v[76:79], v241, s[4:7], s85 offen offset:3072 sc1
    s_add_u32 s85, s85, 4096
    buffer_load_dwordx4 v[80:83], v241, s[4:7], s85 offen offset:0 sc1
    buffer_load_dwordx4 v[84:87], v241, s[4:7], s85 offen offset:1024 sc1
    buffer_load_dwordx4 v[88:91], v241, s[4:7], s85 offen offset:2048 sc1
    buffer_load_dwordx4 v[92:95], v241, s[4:7], s85 offen offset:3072 sc1
    s_add_u32 s85, s85, 4096
    buffer_load_dwordx4 v[96:99], v241, s[4:7], s85 offen offset:0 sc1
    buffer_load_dwordx4 v[100:103], v241, s[4:7], s85 offen offset:1024 sc1
    buffer_load_dwordx4 v[104:107], v241, s[4:7], s85 offen offset:2048 sc1
    buffer_load_dwordx4 v[108:111], v241, s[4:7], s85 offen offset:3072 sc1
    s_add_u32 s85, s85, 4096
    ds_read_b128 v[196:199], v236 offset:20480
    ds_read_b128 v[200:203], v236 offset:21504
    ds_read_b128 v[204:207], v236 offset:22528
    ds_read_b128 v[208:211], v236 offset:23552
    ds_read_b128 v[212:215], v236 offset:24576
    ds_read_b128 v[216:219], v236 offset:25600
    ds_read_b128 v[220:223], v236 offset:26624
    ds_read_b128 v[224:227], v236 offset:27648
    v_mul_u32_u24 v239, 2560, v1
    s_mul_i32 s62, s52, 1280
    s_mul_i32 s63, s84, 160
    s_add_u32 s62, s62, s63
    v_lshl_add_u32 v3, v2, 3, v239
    v_lshl_add_u32 v239, v2, 4, v239
    s_waitcnt vmcnt(11) lgkmcnt(7)
    v_mfma_f32_16x16x32_bf16 v[176:179], v[196:199], v[64:67], 0
    ds_read_b128 v[228:231], v236 offset:28672
    s_waitcnt lgkmcnt(7)
    v_mfma_f32_16x16x32_bf16 v[180:183], v[200:203], v[64:67], 0
    ds_read_b128 v[232:235], v236 offset:29696
    s_waitcnt lgkmcnt(7)
    v_mfma_f32_16x16x32_bf16 v[184:187], v[204:207], v[64:67], 0
    ds_read_b128 v[196:199], v236 offset:30720
    buffer_load_dwordx4 v[112:115], v241, s[4:7], s85 offen offset:0 sc1
    s_waitcnt lgkmcnt(7)
    v_mfma_f32_16x16x32_bf16 v[188:191], v[208:211], v[64:67], 0
    ds_read_b128 v[200:203], v236 offset:31744
    s_waitcnt lgkmcnt(7)
    v_mfma_f32_16x16x32_bf16 v[192:195], v[212:215], v[64:67], 0
    ds_read_b128 v[204:207], v236 offset:32768
    s_waitcnt vmcnt(11) lgkmcnt(7)
    v_mfma_f32_16x16x32_bf16 v[176:179], v[216:219], v[68:71], v[176:179]
    ds_read_b128 v[208:211], v236 offset:33792
    s_waitcnt lgkmcnt(6)
    v_mfma_f32_16x16x32_bf16 v[180:183], v[220:223], v[68:71], v[180:183]
    ds_read_b128 v[212:215], v236 offset:34816
    v_mfma_f32_16x16x32_bf16 v[184:187], v[224:227], v[68:71], v[184:187]
    ds_read_b128 v[216:219], v236 offset:35840
    buffer_load_dwordx4 v[116:119], v241, s[4:7], s85 offen offset:1024 sc1
    s_waitcnt lgkmcnt(6)
    v_mfma_f32_16x16x32_bf16 v[188:191], v[228:231], v[68:71], v[188:191]
    ds_read_b128 v[220:223], v236 offset:36864
    v_mfma_f32_16x16x32_bf16 v[192:195], v[232:235], v[68:71], v[192:195]
    ds_read_b128 v[224:227], v236 offset:37888
    s_waitcnt vmcnt(11) lgkmcnt(6)
    v_mfma_f32_16x16x32_bf16 v[176:179], v[196:199], v[72:75], v[176:179]
    ds_read_b128 v[228:231], v236 offset:38912
    v_mfma_f32_16x16x32_bf16 v[180:183], v[200:203], v[72:75], v[180:183]
    ds_read_b128 v[232:235], v236 offset:39936
    s_waitcnt lgkmcnt(6)
    v_mfma_f32_16x16x32_bf16 v[184:187], v[204:207], v[72:75], v[184:187]
    ds_read_b128 v[196:199], v236 offset:40960
    buffer_load_dwordx4 v[120:123], v241, s[4:7], s85 offen offset:2048 sc1
    v_mfma_f32_16x16x32_bf16 v[188:191], v[208:211], v[72:75], v[188:191]
    ds_read_b128 v[200:203], v236 offset:41984
    s_waitcnt lgkmcnt(6)
    v_mfma_f32_16x16x32_bf16 v[192:195], v[212:215], v[72:75], v[192:195]
    ds_read_b128 v[204:207], v236 offset:43008
    s_waitcnt vmcnt(11) lgkmcnt(6)
    v_mfma_f32_16x16x32_bf16 v[176:179], v[216:219], v[76:79], v[176:179]
    ds_read_b128 v[208:211], v236 offset:44032
    v_mfma_f32_16x16x32_bf16 v[180:183], v[220:223], v[76:79], v[180:183]
    ds_read_b128 v[212:215], v236 offset:45056
    s_waitcnt lgkmcnt(6)
    v_mfma_f32_16x16x32_bf16 v[184:187], v[224:227], v[76:79], v[184:187]
    ds_read_b128 v[216:219], v236 offset:46080
    buffer_load_dwordx4 v[124:127], v241, s[4:7], s85 offen offset:3072 sc1
    s_add_u32 s85, s85, 4096
    v_mfma_f32_16x16x32_bf16 v[188:191], v[228:231], v[76:79], v[188:191]
    ds_read_b128 v[220:223], v236 offset:47104
    s_waitcnt lgkmcnt(6)
    v_mfma_f32_16x16x32_bf16 v[192:195], v[232:235], v[76:79], v[192:195]
    ds_read_b128 v[224:227], v236 offset:48128
    s_waitcnt vmcnt(11) lgkmcnt(6)
    v_mfma_f32_16x16x32_bf16 v[176:179], v[196:199], v[80:83], v[176:179]
    ds_read_b128 v[228:231], v236 offset:49152
    v_mfma_f32_16x16x32_bf16 v[180:183], v[200:203], v[80:83], v[180:183]
    ds_read_b128 v[232:235], v236 offset:50176
    s_waitcnt lgkmcnt(6)
    v_mfma_f32_16x16x32_bf16 v[184:187], v[204:207], v[80:83], v[184:187]
    ds_read_b128 v[196:199], v236 offset:51200
    buffer_load_dwordx4 v[128:131], v241, s[4:7], s85 offen offset:0 sc1
    v_mfma_f32_16x16x32_bf16 v[188:191], v[208:211], v[80:83], v[188:191]
    ds_read_b128 v[200:203], v236 offset:52224
    s_waitcnt lgkmcnt(6)
    v_mfma_f32_16x16x32_bf16 v[192:195], v[212:215], v[80:83], v[192:195]
    ds_read_b128 v[204:207], v236 offset:53248
    s_waitcnt vmcnt(11) lgkmcnt(6)
    v_mfma_f32_16x16x32_bf16 v[176:179], v[216:219], v[84:87], v[176:179]
    ds_read_b128 v[208:211], v236 offset:54272
    v_mfma_f32_16x16x32_bf16 v[180:183], v[220:223], v[84:87], v[180:183]
    ds_read_b128 v[212:215], v236 offset:55296
    s_waitcnt lgkmcnt(6)
    v_mfma_f32_16x16x32_bf16 v[184:187], v[224:227], v[84:87], v[184:187]
    ds_read_b128 v[216:219], v236 offset:56320
    buffer_load_dwordx4 v[132:135], v241, s[4:7], s85 offen offset:1024 sc1
    v_mfma_f32_16x16x32_bf16 v[188:191], v[228:231], v[84:87], v[188:191]
    ds_read_b128 v[220:223], v236 offset:57344
    s_waitcnt lgkmcnt(6)
    v_mfma_f32_16x16x32_bf16 v[192:195], v[232:235], v[84:87], v[192:195]
    ds_read_b128 v[224:227], v236 offset:58368
    s_waitcnt vmcnt(11) lgkmcnt(6)
    v_mfma_f32_16x16x32_bf16 v[176:179], v[196:199], v[88:91], v[176:179]
    ds_read_b128 v[228:231], v236 offset:59392
    v_mfma_f32_16x16x32_bf16 v[180:183], v[200:203], v[88:91], v[180:183]
    ds_read_b128 v[232:235], v236 offset:60416
    s_waitcnt lgkmcnt(6)
    v_mfma_f32_16x16x32_bf16 v[184:187], v[204:207], v[88:91], v[184:187]
    ds_read_b128 v[196:199], v237 offset:0
    buffer_load_dwordx4 v[136:139], v241, s[4:7], s85 offen offset:2048 sc1
    v_mfma_f32_16x16x32_bf16 v[188:191], v[208:211], v[88:91], v[188:191]
    ds_read_b128 v[200:203], v237 offset:1024
    s_waitcnt lgkmcnt(6)
    v_mfma_f32_16x16x32_bf16 v[192:195], v[212:215], v[88:91], v[192:195]
    ds_read_b128 v[204:207], v237 offset:2048
    s_waitcnt vmcnt(11) lgkmcnt(6)
    v_mfma_f32_16x16x32_bf16 v[176:179], v[216:219], v[92:95], v[176:179]
    ds_read_b128 v[208:211], v237 offset:3072
    v_mfma_f32_16x16x32_bf16 v[180:183], v[220:223], v[92:95], v[180:183]
    ds_read_b128 v[212:215], v237 offset:4096
    s_waitcnt lgkmcnt(6)
    v_mfma_f32_16x16x32_bf16 v[184:187], v[224:227], v[92:95], v[184:187]
    ds_read_b128 v[216:219], v237 offset:5120
    buffer_load_dwordx4 v[140:143], v241, s[4:7], s85 offen offset:3072 sc1
    s_add_u32 s85, s85, 4096
    v_mfma_f32_16x16x32_bf16 v[188:191], v[228:231], v[92:95], v[188:191]
    ds_read_b128 v[220:223], v237 offset:6144
    s_waitcnt lgkmcnt(6)
    v_mfma_f32_16x16x32_bf16 v[192:195], v[232:235], v[92:95], v[192:195]
    ds_read_b128 v[224:227], v237 offset:7168
    s_waitcnt vmcnt(11) lgkmcnt(6)
    v_mfma_f32_16x16x32_bf16 v[176:179], v[196:199], v[96:99], v[176:179]
    ds_read_b128 v[228:231], v237 offset:8192
    v_mfma_f32_16x16x32_bf16 v[180:183], v[200:203], v[96:99], v[180:183]
    ds_read_b128 v[232:235], v237 offset:9216
    s_waitcnt lgkmcnt(6)
    v_mfma_f32_16x16x32_bf16 v[184:187], v[204:207], v[96:99], v[184:187]
    ds_read_b128 v[196:199], v237 offset:10240
    buffer_load_dwordx4 v[144:147], v241, s[4:7], s85 offen offset:0 sc1
    v_mfma_f32_16x16x32_bf16 v[188:191], v[208:211], v[96:99], v[188:191]
    ds_read_b128 v[200:203], v237 offset:11264
    s_waitcnt lgkmcnt(6)
    v_mfma_f32_16x16x32_bf16 v[192:195], v[212:215], v[96:99], v[192:195]
    ds_read_b128 v[204:207], v237 offset:12288
    s_waitcnt vmcnt(11) lgkmcnt(6)
    v_mfma_f32_16x16x32_bf16 v[176:179], v[216:219], v[100:103], v[176:179]
    ds_read_b128 v[208:211], v237 offset:13312
    v_mfma_f32_16x16x32_bf16 v[180:183], v[220:223], v[100:103], v[180:183]
    ds_read_b128 v[212:215], v237 offset:14336
    s_waitcnt lgkmcnt(6)
    v_mfma_f32_16x16x32_bf16 v[184:187], v[224:227], v[100:103], v[184:187]
    ds_read_b128 v[216:219], v237 offset:15360
    buffer_load_dwordx4 v[148:151], v241, s[4:7], s85 offen offset:1024 sc1
    v_mfma_f32_16x16x32_bf16 v[188:191], v[228:231], v[100:103], v[188:191]
    ds_read_b128 v[220:223], v237 offset:16384
    s_waitcnt lgkmcnt(6)
    v_mfma_f32_16x16x32_bf16 v[192:195], v[232:235], v[100:103], v[192:195]
    ds_read_b128 v[224:227], v237 offset:17408
    s_waitcnt vmcnt(11) lgkmcnt(6)
    v_mfma_f32_16x16x32_bf16 v[176:179], v[196:199], v[104:107], v[176:179]
    ds_read_b128 v[228:231], v237 offset:18432
    v_mfma_f32_16x16x32_bf16 v[180:183], v[200:203], v[104:107], v[180:183]
    ds_read_b128 v[232:235], v237 offset:19456
    s_waitcnt lgkmcnt(6)
    v_mfma_f32_16x16x32_bf16 v[184:187], v[204:207], v[104:107], v[184:187]
    ds_read_b128 v[196:199], v237 offset:20480
    buffer_load_dwordx4 v[152:155], v241, s[4:7], s85 offen offset:2048 sc1
    v_mfma_f32_16x16x32_bf16 v[188:191], v[208:211], v[104:107], v[188:191]
    ds_read_b128 v[200:203], v237 offset:21504
    s_waitcnt lgkmcnt(6)
    v_mfma_f32_16x16x32_bf16 v[192:195], v[212:215], v[104:107], v[192:195]
    ds_read_b128 v[204:207], v237 offset:22528
    s_waitcnt vmcnt(11) lgkmcnt(6)
    v_mfma_f32_16x16x32_bf16 v[176:179], v[216:219], v[108:111], v[176:179]
    ds_read_b128 v[208:211], v237 offset:23552
    v_mfma_f32_16x16x32_bf16 v[180:183], v[220:223], v[108:111], v[180:183]
    ds_read_b128 v[212:215], v237 offset:24576
    s_waitcnt lgkmcnt(6)
    v_mfma_f32_16x16x32_bf16 v[184:187], v[224:227], v[108:111], v[184:187]
    ds_read_b128 v[216:219], v237 offset:25600
    buffer_load_dwordx4 v[156:159], v241, s[4:7], s85 offen offset:3072 sc1
    s_add_u32 s85, s85, 4096
    v_mfma_f32_16x16x32_bf16 v[188:191], v[228:231], v[108:111], v[188:191]
    ds_read_b128 v[220:223], v237 offset:26624
    s_waitcnt lgkmcnt(6)
    v_mfma_f32_16x16x32_bf16 v[192:195], v[232:235], v[108:111], v[192:195]
    ds_read_b128 v[224:227], v237 offset:27648
    s_waitcnt vmcnt(11) lgkmcnt(6)
    v_mfma_f32_16x16x32_bf16 v[176:179], v[196:199], v[112:115], v[176:179]
    ds_read_b128 v[228:231], v237 offset:28672
    v_mfma_f32_16x16x32_bf16 v[180:183], v[200:203], v[112:115], v[180:183]
    ds_read_b128 v[232:235], v237 offset:29696
    s_waitcnt lgkmcnt(6)
    v_mfma_f32_16x16x32_bf16 v[184:187], v[204:207], v[112:115], v[184:187]
    ds_read_b128 v[196:199], v237 offset:30720
    buffer_load_dwordx4 v[160:163], v241, s[4:7], s85 offen offset:0 sc1
    v_mfma_f32_16x16x32_bf16 v[188:191], v[208:211], v[112:115], v[188:191]
    ds_read_b128 v[200:203], v237 offset:31744
    s_waitcnt lgkmcnt(6)
    v_mfma_f32_16x16x32_bf16 v[192:195], v[212:215], v[112:115], v[192:195]
    ds_read_b128 v[204:207], v237 offset:32768
    s_waitcnt vmcnt(11) lgkmcnt(6)
    v_mfma_f32_16x16x32_bf16 v[176:179], v[216:219], v[116:119], v[176:179]
    ds_read_b128 v[208:211], v237 offset:33792
    v_mfma_f32_16x16x32_bf16 v[180:183], v[220:223], v[116:119], v[180:183]
    ds_read_b128 v[212:215], v237 offset:34816
    s_waitcnt lgkmcnt(6)
    v_mfma_f32_16x16x32_bf16 v[184:187], v[224:227], v[116:119], v[184:187]
    ds_read_b128 v[216:219], v237 offset:35840
    buffer_load_dwordx4 v[164:167], v241, s[4:7], s85 offen offset:1024 sc1
    v_mfma_f32_16x16x32_bf16 v[188:191], v[228:231], v[116:119], v[188:191]
    ds_read_b128 v[220:223], v237 offset:36864
    s_waitcnt lgkmcnt(6)
    v_mfma_f32_16x16x32_bf16 v[192:195], v[232:235], v[116:119], v[192:195]
    ds_read_b128 v[224:227], v237 offset:37888
    s_waitcnt vmcnt(11) lgkmcnt(6)
    v_mfma_f32_16x16x32_bf16 v[176:179], v[196:199], v[120:123], v[176:179]
    ds_read_b128 v[228:231], v237 offset:38912
    v_mfma_f32_16x16x32_bf16 v[180:183], v[200:203], v[120:123], v[180:183]
    ds_read_b128 v[232:235], v237 offset:39936
    s_waitcnt lgkmcnt(6)
    v_mfma_f32_16x16x32_bf16 v[184:187], v[204:207], v[120:123], v[184:187]
    ds_read_b128 v[196:199], v237 offset:40960
    buffer_load_dwordx4 v[168:171], v241, s[4:7], s85 offen offset:2048 sc1
    v_mfma_f32_16x16x32_bf16 v[188:191], v[208:211], v[120:123], v[188:191]
    ds_read_b128 v[200:203], v237 offset:41984
    s_waitcnt lgkmcnt(6)
    v_mfma_f32_16x16x32_bf16 v[192:195], v[212:215], v[120:123], v[192:195]
    ds_read_b128 v[204:207], v237 offset:43008
    s_waitcnt vmcnt(11) lgkmcnt(6)
    v_mfma_f32_16x16x32_bf16 v[176:179], v[216:219], v[124:127], v[176:179]
    ds_read_b128 v[208:211], v237 offset:44032
    v_mfma_f32_16x16x32_bf16 v[180:183], v[220:223], v[124:127], v[180:183]
    ds_read_b128 v[212:215], v237 offset:45056
    s_waitcnt lgkmcnt(6)
    v_mfma_f32_16x16x32_bf16 v[184:187], v[224:227], v[124:127], v[184:187]
    ds_read_b128 v[216:219], v237 offset:46080
    buffer_load_dwordx4 v[172:175], v241, s[4:7], s85 offen offset:3072 sc1
    s_add_u32 s85, s85, 4096
    v_mfma_f32_16x16x32_bf16 v[188:191], v[228:231], v[124:127], v[188:191]
    ds_read_b128 v[220:223], v237 offset:47104
    s_waitcnt lgkmcnt(6)
    v_mfma_f32_16x16x32_bf16 v[192:195], v[232:235], v[124:127], v[192:195]
    ds_read_b128 v[224:227], v237 offset:48128
    s_waitcnt vmcnt(11) lgkmcnt(6)
    v_mfma_f32_16x16x32_bf16 v[176:179], v[196:199], v[128:131], v[176:179]
    ds_read_b128 v[228:231], v237 offset:49152
    v_mfma_f32_16x16x32_bf16 v[180:183], v[200:203], v[128:131], v[180:183]
    ds_read_b128 v[232:235], v237 offset:50176
    s_waitcnt lgkmcnt(6)
    v_mfma_f32_16x16x32_bf16 v[184:187], v[204:207], v[128:131], v[184:187]
    ds_read_b128 v[196:199], v237 offset:51200
    v_mfma_f32_16x16x32_bf16 v[188:191], v[208:211], v[128:131], v[188:191]
    ds_read_b128 v[200:203], v237 offset:52224
    s_waitcnt lgkmcnt(6)
    v_mfma_f32_16x16x32_bf16 v[192:195], v[212:215], v[128:131], v[192:195]
    ds_read_b128 v[204:207], v237 offset:53248
    s_waitcnt vmcnt(10) lgkmcnt(6)
    v_mfma_f32_16x16x32_bf16 v[176:179], v[216:219], v[132:135], v[176:179]
    ds_read_b128 v[208:211], v237 offset:54272
    v_mfma_f32_16x16x32_bf16 v[180:183], v[220:223], v[132:135], v[180:183]
    ds_read_b128 v[212:215], v237 offset:55296
    s_waitcnt lgkmcnt(6)
    v_mfma_f32_16x16x32_bf16 v[184:187], v[224:227], v[132:135], v[184:187]
    ds_read_b128 v[216:219], v237 offset:56320
    v_mfma_f32_16x16x32_bf16 v[188:191], v[228:231], v[132:135], v[188:191]
    ds_read_b128 v[220:223], v237 offset:57344
    s_waitcnt lgkmcnt(6)
    v_mfma_f32_16x16x32_bf16 v[192:195], v[232:235], v[132:135], v[192:195]
    ds_read_b128 v[224:227], v237 offset:58368
    s_waitcnt vmcnt(9) lgkmcnt(6)
    v_mfma_f32_16x16x32_bf16 v[176:179], v[196:199], v[136:139], v[176:179]
    ds_read_b128 v[228:231], v237 offset:59392
    v_mfma_f32_16x16x32_bf16 v[180:183], v[200:203], v[136:139], v[180:183]
    ds_read_b128 v[232:235], v237 offset:60416
    s_waitcnt lgkmcnt(6)
    v_mfma_f32_16x16x32_bf16 v[184:187], v[204:207], v[136:139], v[184:187]
    ds_read_b128 v[196:199], v238 offset:0
    v_mfma_f32_16x16x32_bf16 v[188:191], v[208:211], v[136:139], v[188:191]
    ds_read_b128 v[200:203], v238 offset:1024
    s_waitcnt lgkmcnt(6)
    v_mfma_f32_16x16x32_bf16 v[192:195], v[212:215], v[136:139], v[192:195]
    ds_read_b128 v[204:207], v238 offset:2048
    s_waitcnt vmcnt(8) lgkmcnt(6)
    v_mfma_f32_16x16x32_bf16 v[176:179], v[216:219], v[140:143], v[176:179]
    ds_read_b128 v[208:211], v238 offset:3072
    v_mfma_f32_16x16x32_bf16 v[180:183], v[220:223], v[140:143], v[180:183]
    ds_read_b128 v[212:215], v238 offset:4096
    s_waitcnt lgkmcnt(6)
    v_mfma_f32_16x16x32_bf16 v[184:187], v[224:227], v[140:143], v[184:187]
    ds_read_b128 v[216:219], v238 offset:5120
    v_mfma_f32_16x16x32_bf16 v[188:191], v[228:231], v[140:143], v[188:191]
    ds_read_b128 v[220:223], v238 offset:6144
    s_waitcnt lgkmcnt(6)
    v_mfma_f32_16x16x32_bf16 v[192:195], v[232:235], v[140:143], v[192:195]
    ds_read_b128 v[224:227], v238 offset:7168
    s_waitcnt vmcnt(7) lgkmcnt(6)
    v_mfma_f32_16x16x32_bf16 v[176:179], v[196:199], v[144:147], v[176:179]
    ds_read_b128 v[228:231], v238 offset:8192
    v_mfma_f32_16x16x32_bf16 v[180:183], v[200:203], v[144:147], v[180:183]
    ds_read_b128 v[232:235], v238 offset:9216
    s_waitcnt lgkmcnt(6)
    v_mfma_f32_16x16x32_bf16 v[184:187], v[204:207], v[144:147], v[184:187]
    ds_read_b128 v[196:199], v238 offset:10240
    v_mfma_f32_16x16x32_bf16 v[188:191], v[208:211], v[144:147], v[188:191]
    ds_read_b128 v[200:203], v238 offset:11264
    s_waitcnt lgkmcnt(6)
    v_mfma_f32_16x16x32_bf16 v[192:195], v[212:215], v[144:147], v[192:195]
    ds_read_b128 v[204:207], v238 offset:12288
    s_waitcnt vmcnt(6) lgkmcnt(6)
    v_mfma_f32_16x16x32_bf16 v[176:179], v[216:219], v[148:151], v[176:179]
    ds_read_b128 v[208:211], v238 offset:13312
    v_mfma_f32_16x16x32_bf16 v[180:183], v[220:223], v[148:151], v[180:183]
    ds_read_b128 v[212:215], v238 offset:14336
    s_waitcnt lgkmcnt(6)
    v_mfma_f32_16x16x32_bf16 v[184:187], v[224:227], v[148:151], v[184:187]
    ds_read_b128 v[216:219], v238 offset:15360
    v_mfma_f32_16x16x32_bf16 v[188:191], v[228:231], v[148:151], v[188:191]
    ds_read_b128 v[220:223], v238 offset:16384
    s_waitcnt lgkmcnt(6)
    v_mfma_f32_16x16x32_bf16 v[192:195], v[232:235], v[148:151], v[192:195]
    ds_read_b128 v[224:227], v238 offset:17408
    s_waitcnt vmcnt(5) lgkmcnt(6)
    v_mfma_f32_16x16x32_bf16 v[176:179], v[196:199], v[152:155], v[176:179]
    ds_read_b128 v[228:231], v238 offset:18432
    v_mfma_f32_16x16x32_bf16 v[180:183], v[200:203], v[152:155], v[180:183]
    ds_read_b128 v[232:235], v238 offset:19456
    s_waitcnt lgkmcnt(6)
    v_mfma_f32_16x16x32_bf16 v[184:187], v[204:207], v[152:155], v[184:187]
    ds_read_b128 v[196:199], v236 offset:0
    v_mfma_f32_16x16x32_bf16 v[188:191], v[208:211], v[152:155], v[188:191]
    ds_read_b128 v[200:203], v236 offset:1024
    s_waitcnt lgkmcnt(6)
    v_mfma_f32_16x16x32_bf16 v[192:195], v[212:215], v[152:155], v[192:195]
    ds_read_b128 v[204:207], v236 offset:2048
    s_waitcnt vmcnt(4) lgkmcnt(6)
    v_mfma_f32_16x16x32_bf16 v[176:179], v[216:219], v[156:159], v[176:179]
    ds_read_b128 v[208:211], v236 offset:3072
    v_mfma_f32_16x16x32_bf16 v[180:183], v[220:223], v[156:159], v[180:183]
    ds_read_b128 v[212:215], v236 offset:4096
    s_waitcnt lgkmcnt(6)
    v_mfma_f32_16x16x32_bf16 v[184:187], v[224:227], v[156:159], v[184:187]
    ds_read_b128 v[216:219], v236 offset:5120
    v_mfma_f32_16x16x32_bf16 v[188:191], v[228:231], v[156:159], v[188:191]
    ds_read_b128 v[220:223], v236 offset:6144
    s_waitcnt lgkmcnt(6)
    v_mfma_f32_16x16x32_bf16 v[192:195], v[232:235], v[156:159], v[192:195]
    ds_read_b128 v[224:227], v236 offset:7168
    s_waitcnt vmcnt(3) lgkmcnt(6)
    v_mfma_f32_16x16x32_bf16 v[176:179], v[196:199], v[160:163], v[176:179]
    ds_read_b128 v[228:231], v236 offset:8192
    v_mfma_f32_16x16x32_bf16 v[180:183], v[200:203], v[160:163], v[180:183]
    ds_read_b128 v[232:235], v236 offset:9216
    s_waitcnt lgkmcnt(6)
    v_mfma_f32_16x16x32_bf16 v[184:187], v[204:207], v[160:163], v[184:187]
    ds_read_b128 v[196:199], v236 offset:10240
    v_mfma_f32_16x16x32_bf16 v[188:191], v[208:211], v[160:163], v[188:191]
    ds_read_b128 v[200:203], v236 offset:11264
    s_waitcnt lgkmcnt(6)
    v_mfma_f32_16x16x32_bf16 v[192:195], v[212:215], v[160:163], v[192:195]
    ds_read_b128 v[204:207], v236 offset:12288
    s_waitcnt vmcnt(2) lgkmcnt(6)
    v_mfma_f32_16x16x32_bf16 v[176:179], v[216:219], v[164:167], v[176:179]
    ds_read_b128 v[208:211], v236 offset:13312
    v_mfma_f32_16x16x32_bf16 v[180:183], v[220:223], v[164:167], v[180:183]
    ds_read_b128 v[212:215], v236 offset:14336
    s_waitcnt lgkmcnt(6)
    v_mfma_f32_16x16x32_bf16 v[184:187], v[224:227], v[164:167], v[184:187]
    ds_read_b128 v[216:219], v236 offset:15360
    v_mfma_f32_16x16x32_bf16 v[188:191], v[228:231], v[164:167], v[188:191]
    ds_read_b128 v[220:223], v236 offset:16384
    s_waitcnt lgkmcnt(6)
    v_mfma_f32_16x16x32_bf16 v[192:195], v[232:235], v[164:167], v[192:195]
    ds_read_b128 v[224:227], v236 offset:17408
    s_waitcnt vmcnt(1) lgkmcnt(6)
    v_mfma_f32_16x16x32_bf16 v[176:179], v[196:199], v[168:171], v[176:179]
    ds_read_b128 v[228:231], v236 offset:18432
    v_mfma_f32_16x16x32_bf16 v[180:183], v[200:203], v[168:171], v[180:183]
    ds_read_b128 v[232:235], v236 offset:19456
    s_waitcnt lgkmcnt(6)
    v_mfma_f32_16x16x32_bf16 v[184:187], v[204:207], v[168:171], v[184:187]
    v_mfma_f32_16x16x32_bf16 v[188:191], v[208:211], v[168:171], v[188:191]
    s_waitcnt lgkmcnt(4)
    v_mfma_f32_16x16x32_bf16 v[192:195], v[212:215], v[168:171], v[192:195]
    s_waitcnt vmcnt(0) lgkmcnt(3)
    v_mfma_f32_16x16x32_bf16 v[176:179], v[216:219], v[172:175], v[176:179]
    v_mfma_f32_16x16x32_bf16 v[180:183], v[220:223], v[172:175], v[180:183]
    s_waitcnt lgkmcnt(1)
    v_mfma_f32_16x16x32_bf16 v[184:187], v[224:227], v[172:175], v[184:187]
    v_mfma_f32_16x16x32_bf16 v[188:191], v[228:231], v[172:175], v[188:191]
    s_waitcnt lgkmcnt(0)
    v_mfma_f32_16x16x32_bf16 v[192:195], v[232:235], v[172:175], v[192:195]
    v_lshlrev_b32 v196, 16, v16
    v_and_b32 v200, s3, v16
    v_lshlrev_b32 v197, 16, v17
    v_and_b32 v201, s3, v17
    v_lshlrev_b32 v198, 16, v18
    v_and_b32 v202, s3, v18
    v_lshlrev_b32 v199, 16, v19
    v_and_b32 v203, s3, v19
    v_fmac_f32 v196, v44, v176
    v_fmac_f32 v200, v45, v180
    v_fmac_f32 v197, v46, v177
    v_fmac_f32 v201, v47, v181
    v_fmac_f32 v198, v48, v178
    v_fmac_f32 v202, v49, v182
    v_fmac_f32 v199, v50, v179
    v_fmac_f32 v203, v51, v183
    v_cvt_pk_bf16_f32 v16, v196, v200
    v_cvt_pk_bf16_f32 v17, v197, v201
    v_cvt_pk_bf16_f32 v18, v198, v202
    v_cvt_pk_bf16_f32 v19, v199, v203
    buffer_store_dwordx4 v[16:19], v239, s[16:19], s62 offen offset:0
    v_lshlrev_b32 v196, 16, v20
    v_and_b32 v200, s3, v20
    v_lshlrev_b32 v197, 16, v21
    v_and_b32 v201, s3, v21
    v_lshlrev_b32 v198, 16, v22
    v_and_b32 v202, s3, v22
    v_lshlrev_b32 v199, 16, v23
    v_and_b32 v203, s3, v23
    v_fmac_f32 v196, v52, v184
    v_fmac_f32 v200, v53, v188
    v_fmac_f32 v197, v54, v185
    v_fmac_f32 v201, v55, v189
    v_fmac_f32 v198, v56, v186
    v_fmac_f32 v202, v57, v190
    v_fmac_f32 v199, v58, v187
    v_fmac_f32 v203, v59, v191
    v_cvt_pk_bf16_f32 v20, v196, v200
    v_cvt_pk_bf16_f32 v21, v197, v201
    v_cvt_pk_bf16_f32 v22, v198, v202
    v_cvt_pk_bf16_f32 v23, v199, v203
    buffer_store_dwordx4 v[20:23], v239, s[16:19], s62 offen offset:64
    v_lshlrev_b32 v196, 16, v24
    v_and_b32 v197, s3, v24
    v_lshlrev_b32 v198, 16, v25
    v_and_b32 v199, s3, v25
    v_fmac_f32 v196, v60, v192
    v_fmac_f32 v197, v61, v193
    v_fmac_f32 v198, v62, v194
    v_fmac_f32 v199, v63, v195
    v_cvt_pk_bf16_f32 v24, v196, v197
    v_cvt_pk_bf16_f32 v25, v198, v199
    buffer_store_dwordx2 v[24:25], v3, s[16:19], s62 offen offset:128
L_adaL_end_1:
    s_endpgm
L_adaL_aux_2:
    s_sub_u32 s42, s2, 160
    v_lshrrev_b32 v1, 6, v0
    s_nop 0
    v_readfirstlane_b32 s39, v1
    s_cmp_lt_u32 s2, 248
    s_cbranch_scc1 L_adaL_notag_22
    s_getpc_b64 s[40:41]
L_adaL_pc_27:
    s_sub_u32 s40, s40, L_adaL_pc_27-adaLN_cond__ssm_conv_h3__mixer_gmlp__prompt_kernel
    s_subb_u32 s41, s41, 0
    v_lshlrev_b32 v1, 7, v0
    v_min_u32 v1, code_end-adaLN_cond__ssm_conv_h3__mixer_gmlp__prompt_kernel-4, v1
    global_load_dword v230, v1, s[40:41]
    v_lshlrev_b32 v1, 7, v0
    v_add_u32 v1, 32768, v1
    v_min_u32 v1, code_end-adaLN_cond__ssm_conv_h3__mixer_gmlp__prompt_kernel-4, v1
    global_load_dword v230, v1, s[40:41]
    s_cmp_lg_u32 s2, 252
    s_cbranch_scc1 L_adaL_notag_22
    s_memrealtime s[50:51]
    s_waitcnt lgkmcnt(0)
    s_or_b32 s48, s50, 1
    v_mov_b32 v232, s48
    v_mov_b32 v233, s48
    v_cmp_eq_u32 vcc, 0, v0
    s_nop 0
    s_and_b64 exec, exec, vcc
    buffer_store_dwordx2 v[232:233], off, s[44:47], 0 sc1
    s_mov_b64 exec, -1
L_adaL_notag_22:
    s_load_dwordx2 s[20:21], s[0:1], 56
    s_mov_b32 s22, 2211840
    s_mov_b32 s23, 0x20000
    v_lshrrev_b32 v137, 6, v0
    s_nop 0
    v_readfirstlane_b32 s24, v137
    s_lshr_b32 s25, s42, 4
    s_and_b32 s26, s42, 15
    s_lshl_b32 s30, s25, 2
    s_add_u32 s30, s30, s24
    s_lshr_b32 s28, s26, 1
    s_mul_i32 s28, s28, 216
    s_and_b32 s29, s26, 1
    s_mul_i32 s29, s29, 1728
    s_add_u32 s28, s28, s29
    s_mul_i32 s29, s30, 110592
    s_add_u32 s28, s28, s29
    v_and_b32 v136, 63, v0
    v_lshlrev_b32 v138, 2, v136
    v_mov_b32 v137, 2147483648
    v_cmp_gt_u32 vcc, 54, v136
    s_nop 1
    v_cndmask_b32 v138, v137, v138, vcc
    s_cmp_ge_u32 s2, 220
    s_cbranch_scc1 L_adaL_stats_21
    s_load_dwordx2 s[8:9], s[0:1], 96
    s_mov_b32 s10, 4915200
    s_mov_b32 s11, 0x20000
    s_load_dwordx2 s[12:13], s[0:1], 88
    s_mov_b32 s14, 1280
    s_mov_b32 s15, 0x20000
    s_sub_u32 s16, s2, 160
    v_and_b32 v1, 7, v0
    v_lshrrev_b32 v2, 3, v0
    v_mul_u32_u24 v4, 40, v2
    v_mul_u32_u24 v3, 153600, v2
    v_lshl_add_u32 v3, v1, 4, v3
    s_lshl_b32 s17, s16, 7
    s_waitcnt lgkmcnt(0)
    buffer_load_dwordx4 v[6:9], v4, s[12:15], 0 offen
    buffer_load_dwordx4 v[10:13], v4, s[12:15], 0 offen offset:16
    buffer_load_dwordx2 v[14:15], v4, s[12:15], 0 offen offset:32
    s_mov_b32 s18, 0xbfb8aa3b
    s_waitcnt vmcnt(2)
    v_lshlrev_b32 v124, 16, v6
    v_and_b32 v125, s3, v6
    v_mul_f32 v126, s18, v124
    v_mul_f32 v127, s18, v125
    v_exp_f32 v126, v126
    v_exp_f32 v127, v127
    v_add_f32 v126, 1.0, v126
    v_add_f32 v127, 1.0, v127
    v_rcp_f32 v126, v126
    v_rcp_f32 v127, v127
    v_mul_f32 v124, v124, v126
    v_mul_f32 v125, v125, v127
    v_cvt_pk_bf16_f32 v124, v124, v125
    v_lshlrev_b32 v96, 16, v124
    v_and_b32 v97, s3, v124
    v_lshlrev_b32 v124, 16, v7
    v_and_b32 v125, s3, v7
    v_mul_f32 v126, s18, v124
    v_mul_f32 v127, s18, v125
    v_exp_f32 v126, v126
    v_exp_f32 v127, v127
    v_add_f32 v126, 1.0, v126
    v_add_f32 v127, 1.0, v127
    v_rcp_f32 v126, v126
    v_rcp_f32 v127, v127
    v_mul_f32 v124, v124, v126
    v_mul_f32 v125, v125, v127
    v_cvt_pk_bf16_f32 v124, v124, v125
    v_lshlrev_b32 v98, 16, v124
    v_and_b32 v99, s3, v124
    v_lshlrev_b32 v124, 16, v8
    v_and_b32 v125, s3, v8
    v_mul_f32 v126, s18, v124
    v_mul_f32 v127, s18, v125
    v_exp_f32 v126, v126
    v_exp_f32 v127, v127
    v_add_f32 v126, 1.0, v126
    v_add_f32 v127, 1.0, v127
    v_rcp_f32 v126, v126
    v_rcp_f32 v127, v127
    v_mul_f32 v124, v124, v126
    v_mul_f32 v125, v125, v127
    v_cvt_pk_bf16_f32 v124, v124, v125
    v_lshlrev_b32 v100, 16, v124
    v_and_b32 v101, s3, v124
    v_lshlrev_b32 v124, 16, v9
    v_and_b32 v125, s3, v9
    v_mul_f32 v126, s18, v124
    v_mul_f32 v127, s18, v125
    v_exp_f32 v126, v126
    v_exp_f32 v127, v127
    v_add_f32 v126, 1.0, v126
    v_add_f32 v127, 1.0, v127
    v_rcp_f32 v126, v126
    v_rcp_f32 v127, v127
    v_mul_f32 v124, v124, v126
    v_mul_f32 v125, v125, v127
    v_cvt_pk_bf16_f32 v124, v124, v125
    v_lshlrev_b32 v102, 16, v124
    v_and_b32 v103, s3, v124
    s_waitcnt vmcnt(1)
    v_lshlrev_b32 v124, 16, v10
    v_and_b32 v125, s3, v10
    v_mul_f32 v126, s18, v124
    v_mul_f32 v127, s18, v125
    v_exp_f32 v126, v126
    v_exp_f32 v127, v127
    v_add_f32 v126, 1.0, v126
    v_add_f32 v127, 1.0, v127
    v_rcp_f32 v126, v126
    v_rcp_f32 v127, v127
    v_mul_f32 v124, v124, v126
    v_mul_f32 v125, v125, v127
    v_cvt_pk_bf16_f32 v124, v124, v125
    v_lshlrev_b32 v104, 16, v124
    v_and_b32 v105, s3, v124
    v_lshlrev_b32 v124, 16, v11
    v_and_b32 v125, s3, v11
    v_mul_f32 v126, s18, v124
    v_mul_f32 v127, s18, v125
    v_exp_f32 v126, v126
    v_exp_f32 v127, v127
    v_add_f32 v126, 1.0, v126
    v_add_f32 v127, 1.0, v127
    v_rcp_f32 v126, v126
    v_rcp_f32 v127, v127
    v_mul_f32 v124, v124, v126
    v_mul_f32 v125, v125, v127
    v_cvt_pk_bf16_f32 v124, v124, v125
    v_lshlrev_b32 v106, 16, v124
    v_and_b32 v107, s3, v124
    v_lshlrev_b32 v124, 16, v12
    v_and_b32 v125, s3, v12
    v_mul_f32 v126, s18, v124
    v_mul_f32 v127, s18, v125
    v_exp_f32 v126, v126
    v_exp_f32 v127, v127
    v_add_f32 v126, 1.0, v126
    v_add_f32 v127, 1.0, v127
    v_rcp_f32 v126, v126
    v_rcp_f32 v127, v127
    v_mul_f32 v124, v124, v126
    v_mul_f32 v125, v125, v127
    v_cvt_pk_bf16_f32 v124, v124, v125
    v_lshlrev_b32 v108, 16, v124
    v_and_b32 v109, s3, v124
    v_lshlrev_b32 v124, 16, v13
    v_and_b32 v125, s3, v13
    v_mul_f32 v126, s18, v124
    v_mul_f32 v127, s18, v125
    v_exp_f32 v126, v126
    v_exp_f32 v127, v127
    v_add_f32 v126, 1.0, v126
    v_add_f32 v127, 1.0, v127
    v_rcp_f32 v126, v126
    v_rcp_f32 v127, v127
    v_mul_f32 v124, v124, v126
    v_mul_f32 v125, v125, v127
    v_cvt_pk_bf16_f32 v124, v124, v125
    v_lshlrev_b32 v110, 16, v124
    v_and_b32 v111, s3, v124
    s_waitcnt vmcnt(0)
    v_lshlrev_b32 v124, 16, v14
    v_and_b32 v125, s3, v14
    v_mul_f32 v126, s18, v124
    v_mul_f32 v127, s18, v125
    v_exp_f32 v126, v126
    v_exp_f32 v127, v127
    v_add_f32 v126, 1.0, v126
    v_add_f32 v127, 1.0, v127
    v_rcp_f32 v126, v126
    v_rcp_f32 v127, v127
    v_mul_f32 v124, v124, v126
    v_mul_f32 v125, v125, v127
    v_cvt_pk_bf16_f32 v124, v124, v125
    v_lshlrev_b32 v112, 16, v124
    v_and_b32 v113, s3, v124
    v_lshlrev_b32 v124, 16, v15
    v_and_b32 v125, s3, v15
    v_mul_f32 v126, s18, v124
    v_mul_f32 v127, s18, v125
    v_exp_f32 v126, v126
    v_exp_f32 v127, v127
    v_add_f32 v126, 1.0, v126
    v_add_f32 v127, 1.0, v127
    v_rcp_f32 v126, v126
    v_rcp_f32 v127, v127
    v_mul_f32 v124, v124, v126
    v_mul_f32 v125, v125, v127
    v_cvt_pk_bf16_f32 v124, v124, v125
    v_lshlrev_b32 v114, 16, v124
    v_and_b32 v115, s3, v124
    buffer_load_dwordx4 v[16:19], v3, s[8:11], s17 offen
    s_add_u32 s17, s17, 7680
    buffer_load_dwordx4 v[20:23], v3, s[8:11], s17 offen
    s_add_u32 s17, s17, 7680
    buffer_load_dwordx4 v[24:27], v3, s[8:11], s17 offen
    s_add_u32 s17, s17, 7680
    buffer_load_dwordx4 v[28:31], v3, s[8:11], s17 offen
    s_add_u32 s17, s17, 7680
    buffer_load_dwordx4 v[32:35], v3, s[8:11], s17 offen
    s_add_u32 s17, s17, 7680
    buffer_load_dwordx4 v[36:39], v3, s[8:11], s17 offen
    s_add_u32 s17, s17, 7680
    buffer_load_dwordx4 v[40:43], v3, s[8:11], s17 offen
    s_add_u32 s17, s17, 7680
    buffer_load_dwordx4 v[44:47], v3, s[8:11], s17 offen
    s_add_u32 s17, s17, 7680
    buffer_load_dwordx4 v[48:51], v3, s[8:11], s17 offen
    s_add_u32 s17, s17, 7680
    buffer_load_dwordx4 v[52:55], v3, s[8:11], s17 offen
    s_add_u32 s17, s17, 7680
    buffer_load_dwordx4 v[56:59], v3, s[8:11], s17 offen
    s_add_u32 s17, s17, 7680
    buffer_load_dwordx4 v[60:63], v3, s[8:11], s17 offen
    s_add_u32 s17, s17, 7680
    buffer_load_dwordx4 v[64:67], v3, s[8:11], s17 offen
    s_add_u32 s17, s17, 7680
    buffer_load_dwordx4 v[68:71], v3, s[8:11], s17 offen
    s_add_u32 s17, s17, 7680
    buffer_load_dwordx4 v[72:75], v3, s[8:11], s17 offen
    s_add_u32 s17, s17, 7680
    buffer_load_dwordx4 v[76:79], v3, s[8:11], s17 offen
    s_add_u32 s17, s17, 7680
    buffer_load_dwordx4 v[80:83], v3, s[8:11], s17 offen
    s_add_u32 s17, s17, 7680
    buffer_load_dwordx4 v[84:87], v3, s[8:11], s17 offen
    s_add_u32 s17, s17, 7680
    buffer_load_dwordx4 v[88:91], v3, s[8:11], s17 offen
    s_add_u32 s17, s17, 7680
    buffer_load_dwordx4 v[92:95], v3, s[8:11], s17 offen
    buffer_load_dwordx2 v[232:233], off, s[44:47], 0 sc1
    s_waitcnt vmcnt(20)
    v_lshlrev_b32 v124, 16, v16
    v_and_b32 v125, s3, v16
    v_lshlrev_b32 v126, 16, v17
    v_and_b32 v127, s3, v17
    v_lshlrev_b32 v128, 16, v18
    v_and_b32 v129, s3, v18
    v_lshlrev_b32 v130, 16, v19
    v_and_b32 v131, s3, v19
    v_pk_mul_f32 v[116:117], v[124:125], v[96:97] op_sel:[0,0] op_sel_hi:[1,0]
    v_pk_mul_f32 v[118:119], v[126:127], v[96:97] op_sel:[0,0] op_sel_hi:[1,0]
    v_pk_mul_f32 v[120:121], v[128:129], v[96:97] op_sel:[0,0] op_sel_hi:[1,0]
    v_pk_mul_f32 v[122:123], v[130:131], v[96:97] op_sel:[0,0] op_sel_hi:[1,0]
    s_waitcnt vmcnt(19)
    v_lshlrev_b32 v124, 16, v20
    v_and_b32 v125, s3, v20
    v_lshlrev_b32 v126, 16, v21
    v_and_b32 v127, s3, v21
    v_lshlrev_b32 v128, 16, v22
    v_and_b32 v129, s3, v22
    v_lshlrev_b32 v130, 16, v23
    v_and_b32 v131, s3, v23
    v_pk_fma_f32 v[116:117], v[124:125], v[96:97], v[116:117] op_sel:[0,1,0] op_sel_hi:[1,1,1]
    v_pk_fma_f32 v[118:119], v[126:127], v[96:97], v[118:119] op_sel:[0,1,0] op_sel_hi:[1,1,1]
    v_pk_fma_f32 v[120:121], v[128:129], v[96:97], v[120:121] op_sel:[0,1,0] op_sel_hi:[1,1,1]
    v_pk_fma_f32 v[122:123], v[130:131], v[96:97], v[122:123] op_sel:[0,1,0] op_sel_hi:[1,1,1]
    s_waitcnt vmcnt(18)
    v_lshlrev_b32 v124, 16, v24
    v_and_b32 v125, s3, v24
    v_lshlrev_b32 v126, 16, v25
    v_and_b32 v127, s3, v25
    v_lshlrev_b32 v128, 16, v26
    v_and_b32 v129, s3, v26
    v_lshlrev_b32 v130, 16, v27
    v_and_b32 v131, s3, v27
    v_pk_fma_f32 v[116:117], v[124:125], v[98:99], v[116:117] op_sel:[0,0,0] op_sel_hi:[1,0,1]
    v_pk_fma_f32 v[118:119], v[126:127], v[98:99], v[118:119] op_sel:[0,0,0] op_sel_hi:[1,0,1]
    v_pk_fma_f32 v[120:121], v[128:129], v[98:99], v[120:121] op_sel:[0,0,0] op_sel_hi:[1,0,1]
    v_pk_fma_f32 v[122:123], v[130:131], v[98:99], v[122:123] op_sel:[0,0,0] op_sel_hi:[1,0,1]
    s_waitcnt vmcnt(17)
    v_lshlrev_b32 v124, 16, v28
    v_and_b32 v125, s3, v28
    v_lshlrev_b32 v126, 16, v29
    v_and_b32 v127, s3, v29
    v_lshlrev_b32 v128, 16, v30
    v_and_b32 v129, s3, v30
    v_lshlrev_b32 v130, 16, v31
    v_and_b32 v131, s3, v31
    v_pk_fma_f32 v[116:117], v[124:125], v[98:99], v[116:117] op_sel:[0,1,0] op_sel_hi:[1,1,1]
    v_pk_fma_f32 v[118:119], v[126:127], v[98:99], v[118:119] op_sel:[0,1,0] op_sel_hi:[1,1,1]
    v_pk_fma_f32 v[120:121], v[128:129], v[98:99], v[120:121] op_sel:[0,1,0] op_sel_hi:[1,1,1]
    v_pk_fma_f32 v[122:123], v[130:131], v[98:99], v[122:123] op_sel:[0,1,0] op_sel_hi:[1,1,1]
    s_waitcnt vmcnt(16)
    v_lshlrev_b32 v124, 16, v32
    v_and_b32 v125, s3, v32
    v_lshlrev_b32 v126, 16, v33
    v_and_b32 v127, s3, v33
    v_lshlrev_b32 v128, 16, v34
    v_and_b32 v129, s3, v34
    v_lshlrev_b32 v130, 16, v35
    v_and_b32 v131, s3, v35
    v_pk_fma_f32 v[116:117], v[124:125], v[100:101], v[116:117] op_sel:[0,0,0] op_sel_hi:[1,0,1]
    v_pk_fma_f32 v[118:119], v[126:127], v[100:101], v[118:119] op_sel:[0,0,0] op_sel_hi:[1,0,1]
    v_pk_fma_f32 v[120:121], v[128:129], v[100:101], v[120:121] op_sel:[0,0,0] op_sel_hi:[1,0,1]
    v_pk_fma_f32 v[122:123], v[130:131], v[100:101], v[122:123] op_sel:[0,0,0] op_sel_hi:[1,0,1]
    s_waitcnt vmcnt(15)
    v_lshlrev_b32 v124, 16, v36
    v_and_b32 v125, s3, v36
    v_lshlrev_b32 v126, 16, v37
    v_and_b32 v127, s3, v37
    v_lshlrev_b32 v128, 16, v38
    v_and_b32 v129, s3, v38
    v_lshlrev_b32 v130, 16, v39
    v_and_b32 v131, s3, v39
    v_pk_fma_f32 v[116:117], v[124:125], v[100:101], v[116:117] op_sel:[0,1,0] op_sel_hi:[1,1,1]
    v_pk_fma_f32 v[118:119], v[126:127], v[100:101], v[118:119] op_sel:[0,1,0] op_sel_hi:[1,1,1]
    v_pk_fma_f32 v[120:121], v[128:129], v[100:101], v[120:121] op_sel:[0,1,0] op_sel_hi:[1,1,1]
    v_pk_fma_f32 v[122:123], v[130:131], v[100:101], v[122:123] op_sel:[0,1,0] op_sel_hi:[1,1,1]
    s_waitcnt vmcnt(14)
    v_lshlrev_b32 v124, 16, v40
    v_and_b32 v125, s3, v40
    v_lshlrev_b32 v126, 16, v41
    v_and_b32 v127, s3, v41
    v_lshlrev_b32 v128, 16, v42
    v_and_b32 v129, s3, v42
    v_lshlrev_b32 v130, 16, v43
    v_and_b32 v131, s3, v43
    v_pk_fma_f32 v[116:117], v[124:125], v[102:103], v[116:117] op_sel:[0,0,0] op_sel_hi:[1,0,1]
    v_pk_fma_f32 v[118:119], v[126:127], v[102:103], v[118:119] op_sel:[0,0,0] op_sel_hi:[1,0,1]
    v_pk_fma_f32 v[120:121], v[128:129], v[102:103], v[120:121] op_sel:[0,0,0] op_sel_hi:[1,0,1]
    v_pk_fma_f32 v[122:123], v[130:131], v[102:103], v[122:123] op_sel:[0,0,0] op_sel_hi:[1,0,1]
    s_waitcnt vmcnt(13)
    v_lshlrev_b32 v124, 16, v44
    v_and_b32 v125, s3, v44
    v_lshlrev_b32 v126, 16, v45
    v_and_b32 v127, s3, v45
    v_lshlrev_b32 v128, 16, v46
    v_and_b32 v129, s3, v46
    v_lshlrev_b32 v130, 16, v47
    v_and_b32 v131, s3, v47
    v_pk_fma_f32 v[116:117], v[124:125], v[102:103], v[116:117] op_sel:[0,1,0] op_sel_hi:[1,1,1]
    v_pk_fma_f32 v[118:119], v[126:127], v[102:103], v[118:119] op_sel:[0,1,0] op_sel_hi:[1,1,1]
    v_pk_fma_f32 v[120:121], v[128:129], v[102:103], v[120:121] op_sel:[0,1,0] op_sel_hi:[1,1,1]
    v_pk_fma_f32 v[122:123], v[130:131], v[102:103], v[122:123] op_sel:[0,1,0] op_sel_hi:[1,1,1]
    s_waitcnt vmcnt(12)
    v_lshlrev_b32 v124, 16, v48
    v_and_b32 v125, s3, v48
    v_lshlrev_b32 v126, 16, v49
    v_and_b32 v127, s3, v49
    v_lshlrev_b32 v128, 16, v50
    v_and_b32 v129, s3, v50
    v_lshlrev_b32 v130, 16, v51
    v_and_b32 v131, s3, v51
    v_pk_fma_f32 v[116:117], v[124:125], v[104:105], v[116:117] op_sel:[0,0,0] op_sel_hi:[1,0,1]
    v_pk_fma_f32 v[118:119], v[126:127], v[104:105], v[118:119] op_sel:[0,0,0] op_sel_hi:[1,0,1]
    v_pk_fma_f32 v[120:121], v[128:129], v[104:105], v[120:121] op_sel:[0,0,0] op_sel_hi:[1,0,1]
    v_pk_fma_f32 v[122:123], v[130:131], v[104:105], v[122:123] op_sel:[0,0,0] op_sel_hi:[1,0,1]
    s_waitcnt vmcnt(11)
    v_lshlrev_b32 v124, 16, v52
    v_and_b32 v125, s3, v52
    v_lshlrev_b32 v126, 16, v53
    v_and_b32 v127, s3, v53
    v_lshlrev_b32 v128, 16, v54
    v_and_b32 v129, s3, v54
    v_lshlrev_b32 v130, 16, v55
    v_and_b32 v131, s3, v55
    v_pk_fma_f32 v[116:117], v[124:125], v[104:105], v[116:117] op_sel:[0,1,0] op_sel_hi:[1,1,1]
    v_pk_fma_f32 v[118:119], v[126:127], v[104:105], v[118:119] op_sel:[0,1,0] op_sel_hi:[1,1,1]
    v_pk_fma_f32 v[120:121], v[128:129], v[104:105], v[120:121] op_sel:[0,1,0] op_sel_hi:[1,1,1]
    v_pk_fma_f32 v[122:123], v[130:131], v[104:105], v[122:123] op_sel:[0,1,0] op_sel_hi:[1,1,1]
    s_waitcnt vmcnt(10)
    v_lshlrev_b32 v124, 16, v56
    v_and_b32 v125, s3, v56
    v_lshlrev_b32 v126, 16, v57
    v_and_b32 v127, s3, v57
    v_lshlrev_b32 v128, 16, v58
    v_and_b32 v129, s3, v58
    v_lshlrev_b32 v130, 16, v59
    v_and_b32 v131, s3, v59
    v_pk_fma_f32 v[116:117], v[124:125], v[106:107], v[116:117] op_sel:[0,0,0] op_sel_hi:[1,0,1]
    v_pk_fma_f32 v[118:119], v[126:127], v[106:107], v[118:119] op_sel:[0,0,0] op_sel_hi:[1,0,1]
    v_pk_fma_f32 v[120:121], v[128:129], v[106:107], v[120:121] op_sel:[0,0,0] op_sel_hi:[1,0,1]
    v_pk_fma_f32 v[122:123], v[130:131], v[106:107], v[122:123] op_sel:[0,0,0] op_sel_hi:[1,0,1]
    s_waitcnt vmcnt(9)
    v_lshlrev_b32 v124, 16, v60
    v_and_b32 v125, s3, v60
    v_lshlrev_b32 v126, 16, v61
    v_and_b32 v127, s3, v61
    v_lshlrev_b32 v128, 16, v62
    v_and_b32 v129, s3, v62
    v_lshlrev_b32 v130, 16, v63
    v_and_b32 v131, s3, v63
    v_pk_fma_f32 v[116:117], v[124:125], v[106:107], v[116:117] op_sel:[0,1,0] op_sel_hi:[1,1,1]
    v_pk_fma_f32 v[118:119], v[126:127], v[106:107], v[118:119] op_sel:[0,1,0] op_sel_hi:[1,1,1]
    v_pk_fma_f32 v[120:121], v[128:129], v[106:107], v[120:121] op_sel:[0,1,0] op_sel_hi:[1,1,1]
    v_pk_fma_f32 v[122:123], v[130:131], v[106:107], v[122:123] op_sel:[0,1,0] op_sel_hi:[1,1,1]
    s_waitcnt vmcnt(8)
    v_lshlrev_b32 v124, 16, v64
    v_and_b32 v125, s3, v64
    v_lshlrev_b32 v126, 16, v65
    v_and_b32 v127, s3, v65
    v_lshlrev_b32 v128, 16, v66
    v_and_b32 v129, s3, v66
    v_lshlrev_b32 v130, 16, v67
    v_and_b32 v131, s3, v67
    v_pk_fma_f32 v[116:117], v[124:125], v[108:109], v[116:117] op_sel:[0,0,0] op_sel_hi:[1,0,1]
    v_pk_fma_f32 v[118:119], v[126:127], v[108:109], v[118:119] op_sel:[0,0,0] op_sel_hi:[1,0,1]
    v_pk_fma_f32 v[120:121], v[128:129], v[108:109], v[120:121] op_sel:[0,0,0] op_sel_hi:[1,0,1]
    v_pk_fma_f32 v[122:123], v[130:131], v[108:109], v[122:123] op_sel:[0,0,0] op_sel_hi:[1,0,1]
    s_waitcnt vmcnt(7)
    v_lshlrev_b32 v124, 16, v68
    v_and_b32 v125, s3, v68
    v_lshlrev_b32 v126, 16, v69
    v_and_b32 v127, s3, v69
    v_lshlrev_b32 v128, 16, v70
    v_and_b32 v129, s3, v70
    v_lshlrev_b32 v130, 16, v71
    v_and_b32 v131, s3, v71
    v_pk_fma_f32 v[116:117], v[124:125], v[108:109], v[116:117] op_sel:[0,1,0] op_sel_hi:[1,1,1]
    v_pk_fma_f32 v[118:119], v[126:127], v[108:109], v[118:119] op_sel:[0,1,0] op_sel_hi:[1,1,1]
    v_pk_fma_f32 v[120:121], v[128:129], v[108:109], v[120:121] op_sel:[0,1,0] op_sel_hi:[1,1,1]
    v_pk_fma_f32 v[122:123], v[130:131], v[108:109], v[122:123] op_sel:[0,1,0] op_sel_hi:[1,1,1]
    s_waitcnt vmcnt(6)
    v_lshlrev_b32 v124, 16, v72
    v_and_b32 v125, s3, v72
    v_lshlrev_b32 v126, 16, v73
    v_and_b32 v127, s3, v73
    v_lshlrev_b32 v128, 16, v74
    v_and_b32 v129, s3, v74
    v_lshlrev_b32 v130, 16, v75
    v_and_b32 v131, s3, v75
    v_pk_fma_f32 v[116:117], v[124:125], v[110:111], v[116:117] op_sel:[0,0,0] op_sel_hi:[1,0,1]
    v_pk_fma_f32 v[118:119], v[126:127], v[110:111], v[118:119] op_sel:[0,0,0] op_sel_hi:[1,0,1]
    v_pk_fma_f32 v[120:121], v[128:129], v[110:111], v[120:121] op_sel:[0,0,0] op_sel_hi:[1,0,1]
    v_pk_fma_f32 v[122:123], v[130:131], v[110:111], v[122:123] op_sel:[0,0,0] op_sel_hi:[1,0,1]
    s_waitcnt vmcnt(5)
    v_lshlrev_b32 v124, 16, v76
    v_and_b32 v125, s3, v76
    v_lshlrev_b32 v126, 16, v77
    v_and_b32 v127, s3, v77
    v_lshlrev_b32 v128, 16, v78
    v_and_b32 v129, s3, v78
    v_lshlrev_b32 v130, 16, v79
    v_and_b32 v131, s3, v79
    v_pk_fma_f32 v[116:117], v[124:125], v[110:111], v[116:117] op_sel:[0,1,0] op_sel_hi:[1,1,1]
    v_pk_fma_f32 v[118:119], v[126:127], v[110:111], v[118:119] op_sel:[0,1,0] op_sel_hi:[1,1,1]
    v_pk_fma_f32 v[120:121], v[128:129], v[110:111], v[120:121] op_sel:[0,1,0] op_sel_hi:[1,1,1]
    v_pk_fma_f32 v[122:123], v[130:131], v[110:111], v[122:123] op_sel:[0,1,0] op_sel_hi:[1,1,1]
    s_waitcnt vmcnt(4)
    v_lshlrev_b32 v124, 16, v80
    v_and_b32 v125, s3, v80
    v_lshlrev_b32 v126, 16, v81
    v_and_b32 v127, s3, v81
    v_lshlrev_b32 v128, 16, v82
    v_and_b32 v129, s3, v82
    v_lshlrev_b32 v130, 16, v83
    v_and_b32 v131, s3, v83
    v_pk_fma_f32 v[116:117], v[124:125], v[112:113], v[116:117] op_sel:[0,0,0] op_sel_hi:[1,0,1]
    v_pk_fma_f32 v[118:119], v[126:127], v[112:113], v[118:119] op_sel:[0,0,0] op_sel_hi:[1,0,1]
    v_pk_fma_f32 v[120:121], v[128:129], v[112:113], v[120:121] op_sel:[0,0,0] op_sel_hi:[1,0,1]
    v_pk_fma_f32 v[122:123], v[130:131], v[112:113], v[122:123] op_sel:[0,0,0] op_sel_hi:[1,0,1]
    s_waitcnt vmcnt(3)
    v_lshlrev_b32 v124, 16, v84
    v_and_b32 v125, s3, v84
    v_lshlrev_b32 v126, 16, v85
    v_and_b32 v127, s3, v85
    v_lshlrev_b32 v128, 16, v86
    v_and_b32 v129, s3, v86
    v_lshlrev_b32 v130, 16, v87
    v_and_b32 v131, s3, v87
    v_pk_fma_f32 v[116:117], v[124:125], v[112:113], v[116:117] op_sel:[0,1,0] op_sel_hi:[1,1,1]
    v_pk_fma_f32 v[118:119], v[126:127], v[112:113], v[118:119] op_sel:[0,1,0] op_sel_hi:[1,1,1]
    v_pk_fma_f32 v[120:121], v[128:129], v[112:113], v[120:121] op_sel:[0,1,0] op_sel_hi:[1,1,1]
    v_pk_fma_f32 v[122:123], v[130:131], v[112:113], v[122:123] op_sel:[0,1,0] op_sel_hi:[1,1,1]
    s_waitcnt vmcnt(2)
    v_lshlrev_b32 v124, 16, v88
    v_and_b32 v125, s3, v88
    v_lshlrev_b32 v126, 16, v89
    v_and_b32 v127, s3, v89
    v_lshlrev_b32 v128, 16, v90
    v_and_b32 v129, s3, v90
    v_lshlrev_b32 v130, 16, v91
    v_and_b32 v131, s3, v91
    v_pk_fma_f32 v[116:117], v[124:125], v[114:115], v[116:117] op_sel:[0,0,0] op_sel_hi:[1,0,1]
    v_pk_fma_f32 v[118:119], v[126:127], v[114:115], v[118:119] op_sel:[0,0,0] op_sel_hi:[1,0,1]
    v_pk_fma_f32 v[120:121], v[128:129], v[114:115], v[120:121] op_sel:[0,0,0] op_sel_hi:[1,0,1]
    v_pk_fma_f32 v[122:123], v[130:131], v[114:115], v[122:123] op_sel:[0,0,0] op_sel_hi:[1,0,1]
    s_waitcnt vmcnt(1)
    v_lshlrev_b32 v124, 16, v92
    v_and_b32 v125, s3, v92
    v_lshlrev_b32 v126, 16, v93
    v_and_b32 v127, s3, v93
    v_lshlrev_b32 v128, 16, v94
    v_and_b32 v129, s3, v94
    v_lshlrev_b32 v130, 16, v95
    v_and_b32 v131, s3, v95
    v_pk_fma_f32 v[116:117], v[124:125], v[114:115], v[116:117] op_sel:[0,1,0] op_sel_hi:[1,1,1]
    v_pk_fma_f32 v[118:119], v[126:127], v[114:115], v[118:119] op_sel:[0,1,0] op_sel_hi:[1,1,1]
    v_pk_fma_f32 v[120:121], v[128:129], v[114:115], v[120:121] op_sel:[0,1,0] op_sel_hi:[1,1,1]
    v_pk_fma_f32 v[122:123], v[130:131], v[114:115], v[122:123] op_sel:[0,1,0] op_sel_hi:[1,1,1]
    buffer_load_dword v142, v138, s[20:23], s28 offen offset:0
    buffer_load_dword v143, v138, s[20:23], s28 offen offset:3456
    s_add_u32 s28, s28, 6912
    buffer_load_dword v144, v138, s[20:23], s28 offen offset:0
    buffer_load_dword v145, v138, s[20:23], s28 offen offset:3456
    s_add_u32 s28, s28, 6912
    buffer_load_dword v146, v138, s[20:23], s28 offen offset:0
    buffer_load_dword v147, v138, s[20:23], s28 offen offset:3456
    s_add_u32 s28, s28, 6912
    buffer_load_dword v148, v138, s[20:23], s28 offen offset:0
    buffer_load_dword v149, v138, s[20:23], s28 offen offset:3456
    s_add_u32 s28, s28, 6912
    buffer_load_dword v150, v138, s[20:23], s28 offen offset:0
    buffer_load_dword v151, v138, s[20:23], s28 offen offset:3456
    s_add_u32 s28, s28, 6912
    buffer_load_dword v152, v138, s[20:23], s28 offen offset:0
    buffer_load_dword v153, v138, s[20:23], s28 offen offset:3456
    s_add_u32 s28, s28, 6912
    buffer_load_dword v154, v138, s[20:23], s28 offen offset:0
    buffer_load_dword v155, v138, s[20:23], s28 offen offset:3456
    s_add_u32 s28, s28, 6912
    buffer_load_dword v156, v138, s[20:23], s28 offen offset:0
    buffer_load_dword v157, v138, s[20:23], s28 offen offset:3456
    s_add_u32 s28, s28, 6912
    buffer_load_dword v158, v138, s[20:23], s28 offen offset:0
    buffer_load_dword v159, v138, s[20:23], s28 offen offset:3456
    s_add_u32 s28, s28, 6912
    buffer_load_dword v160, v138, s[20:23], s28 offen offset:0
    buffer_load_dword v161, v138, s[20:23], s28 offen offset:3456
    s_add_u32 s28, s28, 6912
    buffer_load_dword v162, v138, s[20:23], s28 offen offset:0
    buffer_load_dword v163, v138, s[20:23], s28 offen offset:3456
    s_add_u32 s28, s28, 6912
    buffer_load_dword v164, v138, s[20:23], s28 offen offset:0
    buffer_load_dword v165, v138, s[20:23], s28 offen offset:3456
    s_add_u32 s28, s28, 6912
    buffer_load_dword v166, v138, s[20:23], s28 offen offset:0
    buffer_load_dword v167, v138, s[20:23], s28 offen offset:3456
    s_add_u32 s28, s28, 6912
    buffer_load_dword v168, v138, s[20:23], s28 offen offset:0
    buffer_load_dword v169, v138, s[20:23], s28 offen offset:3456
    s_add_u32 s28, s28, 6912
    buffer_load_dword v170, v138, s[20:23], s28 offen offset:0
    buffer_load_dword v171, v138, s[20:23], s28 offen offset:3456
    s_add_u32 s28, s28, 6912
    buffer_load_dword v172, v138, s[20:23], s28 offen offset:0
    buffer_load_dword v173, v138, s[20:23], s28 offen offset:3456
    v_lshlrev_b32 v5, 5, v0
    ds_write_b128 v5, v[116:119]
    ds_write_b128 v5, v[120:123] offset:16
    s_waitcnt lgkmcnt(0)
    s_barrier
    v_lshrrev_b32 v5, 6, v0
    s_nop 0
    v_readfirstlane_b32 s17, v5
    s_nop 0
    s_cmp_lg_u32 s17, 0
    s_cbranch_scc1 L_adaL_gemv_done_28
    v_lshlrev_b32 v5, 2, v0
    ds_read2st64_b32 v[16:17], v5 offset0:0 offset1:1
    ds_read2st64_b32 v[20:21], v5 offset0:2 offset1:3
    ds_read2st64_b32 v[24:25], v5 offset0:4 offset1:5
    ds_read2st64_b32 v[28:29], v5 offset0:6 offset1:7
    ds_read2st64_b32 v[32:33], v5 offset0:8 offset1:9
    ds_read2st64_b32 v[36:37], v5 offset0:10 offset1:11
    ds_read2st64_b32 v[40:41], v5 offset0:12 offset1:13
    ds_read2st64_b32 v[44:45], v5 offset0:14 offset1:15
    ds_read2st64_b32 v[48:49], v5 offset0:16 offset1:17
    ds_read2st64_b32 v[52:53], v5 offset0:18 offset1:19
    ds_read2st64_b32 v[56:57], v5 offset0:20 offset1:21
    ds_read2st64_b32 v[60:61], v5 offset0:22 offset1:23
    ds_read2st64_b32 v[64:65], v5 offset0:24 offset1:25
    ds_read2st64_b32 v[68:69], v5 offset0:26 offset1:27
    ds_read2st64_b32 v[72:73], v5 offset0:28 offset1:29
    ds_read2st64_b32 v[76:77], v5 offset0:30 offset1:31
    s_waitcnt lgkmcnt(14)
    v_pk_add_f32 v[16:17], v[16:17], v[20:21]
    s_waitcnt lgkmcnt(13)
    v_pk_add_f32 v[16:17], v[16:17], v[24:25]
    s_waitcnt lgkmcnt(12)
    v_pk_add_f32 v[16:17], v[16:17], v[28:29]
    s_waitcnt lgkmcnt(11)
    v_pk_add_f32 v[16:17], v[16:17], v[32:33]
    s_waitcnt lgkmcnt(10)
    v_pk_add_f32 v[16:17], v[16:17], v[36:37]
    s_waitcnt lgkmcnt(9)
    v_pk_add_f32 v[16:17], v[16:17], v[40:41]
    s_waitcnt lgkmcnt(8)
    v_pk_add_f32 v[16:17], v[16:17], v[44:45]
    s_waitcnt lgkmcnt(7)
    v_pk_add_f32 v[16:17], v[16:17], v[48:49]
    s_waitcnt lgkmcnt(6)
    v_pk_add_f32 v[16:17], v[16:17], v[52:53]
    s_waitcnt lgkmcnt(5)
    v_pk_add_f32 v[16:17], v[16:17], v[56:57]
    s_waitcnt lgkmcnt(4)
    v_pk_add_f32 v[16:17], v[16:17], v[60:61]
    s_waitcnt lgkmcnt(3)
    v_pk_add_f32 v[16:17], v[16:17], v[64:65]
    s_waitcnt lgkmcnt(2)
    v_pk_add_f32 v[16:17], v[16:17], v[68:69]
    s_waitcnt lgkmcnt(1)
    v_pk_add_f32 v[16:17], v[16:17], v[72:73]
    s_waitcnt lgkmcnt(0)
    v_pk_add_f32 v[16:17], v[16:17], v[76:77]
    v_add_f32 v124, v16, v17
    v_cvt_pk_bf16_f32 v124, v124, v124
    v_lshlrev_b32 v124, 16, v124
    s_cmp_ge_u32 s16, 30
    s_cselect_b32 s17, 30, 0
    s_sub_u32 s17, s16, s17
    s_sub_u32 s17, s17, 10
    s_cmp_lt_u32 s17, 10
    s_cselect_b32 s17, 1.0, 0
    v_add_f32 v124, s17, v124
    v_cvt_pk_bf16_f32 v124, v124, v124
    v_lshlrev_b32 v124, 16, v124
    s_lshl_b32 s17, s16, 8
    buffer_store_dword v124, v5, s[4:7], s17 offen offset:0 sc1
    s_mov_b32 s49, 65536
L_adaL_tagpoll_29:
    s_waitcnt vmcnt(33)
    v_readfirstlane_b32 s48, v232
    s_nop 0
    s_cmp_lg_u32 s48, 0
    s_cbranch_scc1 L_adaL_taggot_30
    buffer_load_dwordx2 v[232:233], off, s[44:47], 0 sc1
    s_waitcnt vmcnt(0)
    s_sub_u32 s49, s49, 1
    s_cmp_lg_u32 s49, 0
    s_cbranch_scc1 L_adaL_tagpoll_29
L_adaL_taggot_30:
    v_mov_b32 v232, v124
    v_lshlrev_b32 v5, 3, v0
    s_lshl_b32 s17, s16, 9
    s_add_u32 s17, s17, 32768
    buffer_store_dwordx2 v[232:233], v5, s[4:7], s17 offen sc1
    v_mov_b32 v232, v233
L_adaL_gemv_done_28:
    s_branch L_adaL_join_23
L_adaL_stats_21:
    s_cmp_ge_u32 s2, 252
    s_cbranch_scc1 L_adaL_reset_24
    s_waitcnt lgkmcnt(0)
    buffer_load_dwordx2 v[232:233], off, s[44:47], 0 sc1
    s_mov_b32 s49, 65536
L_adaL_tagpoll_31:
    s_waitcnt vmcnt(0)
    v_readfirstlane_b32 s48, v232
    s_nop 0
    s_cmp_lg_u32 s48, 0
    s_cbranch_scc1 L_adaL_taggot_32
    buffer_load_dwordx2 v[232:233], off, s[44:47], 0 sc1
    s_waitcnt vmcnt(0)
    s_sub_u32 s49, s49, 1
    s_cmp_lg_u32 s49, 0
    s_cbranch_scc1 L_adaL_tagpoll_31
L_adaL_taggot_32:
    s_load_dwordx2 s[8:9], s[0:1], 0
    s_mov_b32 s10, 2621440
    s_mov_b32 s11, 0x20000
    s_sub_u32 s12, s2, 220
    s_mul_i32 s13, s12, 81920
    s_add_u32 s14, s13, 5120
    s_add_u32 s15, s13, 10240
    s_add_u32 s16, s13, 15360
    s_mov_b32 s17, 0x3f803f80
    v_lshrrev_b32 v2, 6, v0
    v_bfe_u32 v4, v0, 4, 2
    v_lshl_add_u32 v1, v2, 4, v4
    v_mul_u32_u24 v1, 1280, v1
    v_and_b32 v3, 15, v0
    v_lshl_add_u32 v1, v3, 4, v1
    s_waitcnt lgkmcnt(0)
    buffer_load_dwordx4 v[6:9], v1, s[8:11], s13 offen offset:0
    buffer_load_dwordx4 v[10:13], v1, s[8:11], s13 offen offset:256
    buffer_load_dwordx4 v[14:17], v1, s[8:11], s13 offen offset:512
    buffer_load_dwordx4 v[18:21], v1, s[8:11], s13 offen offset:768
    buffer_load_dwordx4 v[22:25], v1, s[8:11], s13 offen offset:1024
    buffer_load_dwordx4 v[26:29], v1, s[8:11], s14 offen offset:0
    buffer_load_dwordx4 v[30:33], v1, s[8:11], s14 offen offset:256
    buffer_load_dwordx4 v[34:37], v1, s[8:11], s14 offen offset:512
    buffer_load_dwordx4 v[38:41], v1, s[8:11], s14 offen offset:768
    buffer_load_dwordx4 v[42:45], v1, s[8:11], s14 offen offset:1024
    buffer_load_dwordx4 v[46:49], v1, s[8:11], s15 offen offset:0
    buffer_load_dwordx4 v[50:53], v1, s[8:11], s15 offen offset:256
    buffer_load_dwordx4 v[54:57], v1, s[8:11], s15 offen offset:512
    buffer_load_dwordx4 v[58:61], v1, s[8:11], s15 offen offset:768
    buffer_load_dwordx4 v[62:65], v1, s[8:11], s15 offen offset:1024
    buffer_load_dwordx4 v[66:69], v1, s[8:11], s16 offen offset:0
    buffer_load_dwordx4 v[70:73], v1, s[8:11], s16 offen offset:256
    buffer_load_dwordx4 v[74:77], v1, s[8:11], s16 offen offset:512
    buffer_load_dwordx4 v[78:81], v1, s[8:11], s16 offen offset:768
    buffer_load_dwordx4 v[82:85], v1, s[8:11], s16 offen offset:1024
    buffer_load_dwordx2 v[232:233], off, s[44:47], 0 sc1
    v_cmp_eq_u32 vcc, 0, v3
    v_lshrrev_b32 v3, 1, v2
    v_lshlrev_b32 v3, 8, v3
    v_and_b32 v2, 1, v2
    v_lshl_add_u32 v3, v2, 6, v3
    v_and_b32 v2, 1, v4
    v_lshl_add_u32 v3, v2, 7, v3
    v_lshrrev_b32 v2, 1, v4
    v_lshl_add_u32 v3, v2, 2, v3
    s_lshl_b32 s13, s12, 9
    s_add_u32 s13, s13, 16384
    v_mov_b32 v86, 0
    v_mov_b32 v90, 0
    v_mov_b32 v87, 0
    v_mov_b32 v91, 0
    v_mov_b32 v88, 0
    v_mov_b32 v92, 0
    v_mov_b32 v89, 0
    v_mov_b32 v93, 0
    s_waitcnt vmcnt(20)
    v_dot2c_f32_bf16 v86, s17, v6
    v_dot2c_f32_bf16 v90, v6, v6
    v_dot2c_f32_bf16 v86, s17, v7
    v_dot2c_f32_bf16 v90, v7, v7
    v_dot2c_f32_bf16 v86, s17, v8
    v_dot2c_f32_bf16 v90, v8, v8
    v_dot2c_f32_bf16 v86, s17, v9
    v_dot2c_f32_bf16 v90, v9, v9
    s_waitcnt vmcnt(19)
    v_dot2c_f32_bf16 v86, s17, v10
    v_dot2c_f32_bf16 v90, v10, v10
    v_dot2c_f32_bf16 v86, s17, v11
    v_dot2c_f32_bf16 v90, v11, v11
    v_dot2c_f32_bf16 v86, s17, v12
    v_dot2c_f32_bf16 v90, v12, v12
    v_dot2c_f32_bf16 v86, s17, v13
    v_dot2c_f32_bf16 v90, v13, v13
    s_waitcnt vmcnt(18)
    v_dot2c_f32_bf16 v86, s17, v14
    v_dot2c_f32_bf16 v90, v14, v14
    v_dot2c_f32_bf16 v86, s17, v15
    v_dot2c_f32_bf16 v90, v15, v15
    v_dot2c_f32_bf16 v86, s17, v16
    v_dot2c_f32_bf16 v90, v16, v16
    v_dot2c_f32_bf16 v86, s17, v17
    v_dot2c_f32_bf16 v90, v17, v17
    s_waitcnt vmcnt(17)
    v_dot2c_f32_bf16 v86, s17, v18
    v_dot2c_f32_bf16 v90, v18, v18
    v_dot2c_f32_bf16 v86, s17, v19
    v_dot2c_f32_bf16 v90, v19, v19
    v_dot2c_f32_bf16 v86, s17, v20
    v_dot2c_f32_bf16 v90, v20, v20
    v_dot2c_f32_bf16 v86, s17, v21
    v_dot2c_f32_bf16 v90, v21, v21
    s_waitcnt vmcnt(16)
    v_dot2c_f32_bf16 v86, s17, v22
    v_dot2c_f32_bf16 v90, v22, v22
    v_dot2c_f32_bf16 v86, s17, v23
    v_dot2c_f32_bf16 v90, v23, v23
    v_dot2c_f32_bf16 v86, s17, v24
    v_dot2c_f32_bf16 v90, v24, v24
    v_dot2c_f32_bf16 v86, s17, v25
    v_dot2c_f32_bf16 v90, v25, v25
    s_waitcnt vmcnt(15)
    v_dot2c_f32_bf16 v87, s17, v26
    v_dot2c_f32_bf16 v91, v26, v26
    v_dot2c_f32_bf16 v87, s17, v27
    v_dot2c_f32_bf16 v91, v27, v27
    v_dot2c_f32_bf16 v87, s17, v28
    v_dot2c_f32_bf16 v91, v28, v28
    v_dot2c_f32_bf16 v87, s17, v29
    v_dot2c_f32_bf16 v91, v29, v29
    s_waitcnt vmcnt(14)
    v_dot2c_f32_bf16 v87, s17, v30
    v_dot2c_f32_bf16 v91, v30, v30
    v_dot2c_f32_bf16 v87, s17, v31
    v_dot2c_f32_bf16 v91, v31, v31
    v_dot2c_f32_bf16 v87, s17, v32
    v_dot2c_f32_bf16 v91, v32, v32
    v_dot2c_f32_bf16 v87, s17, v33
    v_dot2c_f32_bf16 v91, v33, v33
    s_waitcnt vmcnt(13)
    v_dot2c_f32_bf16 v87, s17, v34
    v_dot2c_f32_bf16 v91, v34, v34
    v_dot2c_f32_bf16 v87, s17, v35
    v_dot2c_f32_bf16 v91, v35, v35
    v_dot2c_f32_bf16 v87, s17, v36
    v_dot2c_f32_bf16 v91, v36, v36
    v_dot2c_f32_bf16 v87, s17, v37
    v_dot2c_f32_bf16 v91, v37, v37
    s_waitcnt vmcnt(12)
    v_dot2c_f32_bf16 v87, s17, v38
    v_dot2c_f32_bf16 v91, v38, v38
    v_dot2c_f32_bf16 v87, s17, v39
    v_dot2c_f32_bf16 v91, v39, v39
    v_dot2c_f32_bf16 v87, s17, v40
    v_dot2c_f32_bf16 v91, v40, v40
    v_dot2c_f32_bf16 v87, s17, v41
    v_dot2c_f32_bf16 v91, v41, v41
    s_waitcnt vmcnt(11)
    v_dot2c_f32_bf16 v87, s17, v42
    v_dot2c_f32_bf16 v91, v42, v42
    v_dot2c_f32_bf16 v87, s17, v43
    v_dot2c_f32_bf16 v91, v43, v43
    v_dot2c_f32_bf16 v87, s17, v44
    v_dot2c_f32_bf16 v91, v44, v44
    v_dot2c_f32_bf16 v87, s17, v45
    v_dot2c_f32_bf16 v91, v45, v45
    s_waitcnt vmcnt(10)
    v_dot2c_f32_bf16 v88, s17, v46
    v_dot2c_f32_bf16 v92, v46, v46
    v_dot2c_f32_bf16 v88, s17, v47
    v_dot2c_f32_bf16 v92, v47, v47
    v_dot2c_f32_bf16 v88, s17, v48
    v_dot2c_f32_bf16 v92, v48, v48
    v_dot2c_f32_bf16 v88, s17, v49
    v_dot2c_f32_bf16 v92, v49, v49
    s_waitcnt vmcnt(9)
    v_dot2c_f32_bf16 v88, s17, v50
    v_dot2c_f32_bf16 v92, v50, v50
    v_dot2c_f32_bf16 v88, s17, v51
    v_dot2c_f32_bf16 v92, v51, v51
    v_dot2c_f32_bf16 v88, s17, v52
    v_dot2c_f32_bf16 v92, v52, v52
    v_dot2c_f32_bf16 v88, s17, v53
    v_dot2c_f32_bf16 v92, v53, v53
    s_waitcnt vmcnt(8)
    v_dot2c_f32_bf16 v88, s17, v54
    v_dot2c_f32_bf16 v92, v54, v54
    v_dot2c_f32_bf16 v88, s17, v55
    v_dot2c_f32_bf16 v92, v55, v55
    v_dot2c_f32_bf16 v88, s17, v56
    v_dot2c_f32_bf16 v92, v56, v56
    v_dot2c_f32_bf16 v88, s17, v57
    v_dot2c_f32_bf16 v92, v57, v57
    s_waitcnt vmcnt(7)
    v_dot2c_f32_bf16 v88, s17, v58
    v_dot2c_f32_bf16 v92, v58, v58
    v_dot2c_f32_bf16 v88, s17, v59
    v_dot2c_f32_bf16 v92, v59, v59
    v_dot2c_f32_bf16 v88, s17, v60
    v_dot2c_f32_bf16 v92, v60, v60
    v_dot2c_f32_bf16 v88, s17, v61
    v_dot2c_f32_bf16 v92, v61, v61
    s_waitcnt vmcnt(6)
    v_dot2c_f32_bf16 v88, s17, v62
    v_dot2c_f32_bf16 v92, v62, v62
    v_dot2c_f32_bf16 v88, s17, v63
    v_dot2c_f32_bf16 v92, v63, v63
    v_dot2c_f32_bf16 v88, s17, v64
    v_dot2c_f32_bf16 v92, v64, v64
    v_dot2c_f32_bf16 v88, s17, v65
    v_dot2c_f32_bf16 v92, v65, v65
    s_waitcnt vmcnt(5)
    v_dot2c_f32_bf16 v89, s17, v66
    v_dot2c_f32_bf16 v93, v66, v66
    v_dot2c_f32_bf16 v89, s17, v67
    v_dot2c_f32_bf16 v93, v67, v67
    v_dot2c_f32_bf16 v89, s17, v68
    v_dot2c_f32_bf16 v93, v68, v68
    v_dot2c_f32_bf16 v89, s17, v69
    v_dot2c_f32_bf16 v93, v69, v69
    s_waitcnt vmcnt(4)
    v_dot2c_f32_bf16 v89, s17, v70
    v_dot2c_f32_bf16 v93, v70, v70
    v_dot2c_f32_bf16 v89, s17, v71
    v_dot2c_f32_bf16 v93, v71, v71
    v_dot2c_f32_bf16 v89, s17, v72
    v_dot2c_f32_bf16 v93, v72, v72
    v_dot2c_f32_bf16 v89, s17, v73
    v_dot2c_f32_bf16 v93, v73, v73
    s_waitcnt vmcnt(3)
    v_dot2c_f32_bf16 v89, s17, v74
    v_dot2c_f32_bf16 v93, v74, v74
    v_dot2c_f32_bf16 v89, s17, v75
    v_dot2c_f32_bf16 v93, v75, v75
    v_dot2c_f32_bf16 v89, s17, v76
    v_dot2c_f32_bf16 v93, v76, v76
    v_dot2c_f32_bf16 v89, s17, v77
    v_dot2c_f32_bf16 v93, v77, v77
    s_waitcnt vmcnt(2)
    v_dot2c_f32_bf16 v89, s17, v78
    v_dot2c_f32_bf16 v93, v78, v78
    v_dot2c_f32_bf16 v89, s17, v79
    v_dot2c_f32_bf16 v93, v79, v79
    v_dot2c_f32_bf16 v89, s17, v80
    v_dot2c_f32_bf16 v93, v80, v80
    v_dot2c_f32_bf16 v89, s17, v81
    v_dot2c_f32_bf16 v93, v81, v81
    s_waitcnt vmcnt(1)
    v_dot2c_f32_bf16 v89, s17, v82
    v_dot2c_f32_bf16 v93, v82, v82
    v_dot2c_f32_bf16 v89, s17, v83
    v_dot2c_f32_bf16 v93, v83, v83
    v_dot2c_f32_bf16 v89, s17, v84
    v_dot2c_f32_bf16 v93, v84, v84
    v_dot2c_f32_bf16 v89, s17, v85
    v_dot2c_f32_bf16 v93, v85, v85
    v_add_f32_dpp v86, v86, v86 row_ror:8 row_mask:0xf bank_mask:0xf
    v_add_f32_dpp v90, v90, v90 row_ror:8 row_mask:0xf bank_mask:0xf
    v_add_f32_dpp v87, v87, v87 row_ror:8 row_mask:0xf bank_mask:0xf
    v_add_f32_dpp v91, v91, v91 row_ror:8 row_mask:0xf bank_mask:0xf
    v_add_f32_dpp v88, v88, v88 row_ror:8 row_mask:0xf bank_mask:0xf
    v_add_f32_dpp v92, v92, v92 row_ror:8 row_mask:0xf bank_mask:0xf
    v_add_f32_dpp v89, v89, v89 row_ror:8 row_mask:0xf bank_mask:0xf
    v_add_f32_dpp v93, v93, v93 row_ror:8 row_mask:0xf bank_mask:0xf
    v_add_f32_dpp v86, v86, v86 row_ror:4 row_mask:0xf bank_mask:0xf
    v_add_f32_dpp v90, v90, v90 row_ror:4 row_mask:0xf bank_mask:0xf
    v_add_f32_dpp v87, v87, v87 row_ror:4 row_mask:0xf bank_mask:0xf
    v_add_f32_dpp v91, v91, v91 row_ror:4 row_mask:0xf bank_mask:0xf
    v_add_f32_dpp v88, v88, v88 row_ror:4 row_mask:0xf bank_mask:0xf
    v_add_f32_dpp v92, v92, v92 row_ror:4 row_mask:0xf bank_mask:0xf
    v_add_f32_dpp v89, v89, v89 row_ror:4 row_mask:0xf bank_mask:0xf
    v_add_f32_dpp v93, v93, v93 row_ror:4 row_mask:0xf bank_mask:0xf
    v_add_f32_dpp v86, v86, v86 row_ror:2 row_mask:0xf bank_mask:0xf
    v_add_f32_dpp v90, v90, v90 row_ror:2 row_mask:0xf bank_mask:0xf
    v_add_f32_dpp v87, v87, v87 row_ror:2 row_mask:0xf bank_mask:0xf
    v_add_f32_dpp v91, v91, v91 row_ror:2 row_mask:0xf bank_mask:0xf
    v_add_f32_dpp v88, v88, v88 row_ror:2 row_mask:0xf bank_mask:0xf
    v_add_f32_dpp v92, v92, v92 row_ror:2 row_mask:0xf bank_mask:0xf
    v_add_f32_dpp v89, v89, v89 row_ror:2 row_mask:0xf bank_mask:0xf
    v_add_f32_dpp v93, v93, v93 row_ror:2 row_mask:0xf bank_mask:0xf
    v_add_f32_dpp v86, v86, v86 row_ror:1 row_mask:0xf bank_mask:0xf
    v_add_f32_dpp v90, v90, v90 row_ror:1 row_mask:0xf bank_mask:0xf
    v_add_f32_dpp v87, v87, v87 row_ror:1 row_mask:0xf bank_mask:0xf
    v_add_f32_dpp v91, v91, v91 row_ror:1 row_mask:0xf bank_mask:0xf
    v_add_f32_dpp v88, v88, v88 row_ror:1 row_mask:0xf bank_mask:0xf
    v_add_f32_dpp v92, v92, v92 row_ror:1 row_mask:0xf bank_mask:0xf
    v_add_f32_dpp v89, v89, v89 row_ror:1 row_mask:0xf bank_mask:0xf
    v_add_f32_dpp v93, v93, v93 row_ror:1 row_mask:0xf bank_mask:0xf
    v_mul_f32 v86, 0x3acccccd, v86
    v_mul_f32 v90, 0x3acccccd, v90
    v_mul_f32 v87, 0x3acccccd, v87
    v_mul_f32 v91, 0x3acccccd, v91
    v_mul_f32 v88, 0x3acccccd, v88
    v_mul_f32 v92, 0x3acccccd, v92
    v_mul_f32 v89, 0x3acccccd, v89
    v_mul_f32 v93, 0x3acccccd, v93
    v_fma_f32 v90, -v86, v86, v90
    v_max_f32 v90, 0, v90
    v_add_f32 v90, 0x3727c5ac, v90
    v_rsq_f32 v90, v90
    v_fma_f32 v91, -v87, v87, v91
    v_max_f32 v91, 0, v91
    v_add_f32 v91, 0x3727c5ac, v91
    v_rsq_f32 v91, v91
    v_fma_f32 v92, -v88, v88, v92
    v_max_f32 v92, 0, v92
    v_add_f32 v92, 0x3727c5ac, v92
    v_rsq_f32 v92, v92
    v_fma_f32 v93, -v89, v89, v93
    v_max_f32 v93, 0, v93
    v_add_f32 v93, 0x3727c5ac, v93
    v_rsq_f32 v93, v93
    v_mul_f32 v94, -v86, v90
    v_mul_f32 v95, -v87, v91
    v_mul_f32 v96, -v88, v92
    v_mul_f32 v97, -v89, v93
    s_and_b64 exec, exec, vcc
    ds_write2_b32 v3, v90, v94 offset0:0 offset1:2
    ds_write2_b32 v3, v91, v95 offset0:4 offset1:6
    ds_write2_b32 v3, v92, v96 offset0:8 offset1:10
    ds_write2_b32 v3, v93, v97 offset0:12 offset1:14
    s_mov_b64 exec, -1
    v_lshlrev_b32 v3, 3, v0
    v_cmp_gt_u32 vcc, 64, v0
    v_mov_b32 v2, 2147483648
    s_nop 0
    v_cndmask_b32 v1, v2, v3, vcc
    s_waitcnt lgkmcnt(0)
    s_barrier
    ds_read_b64 v[94:95], v3
    s_waitcnt lgkmcnt(0)
    buffer_store_dwordx2 v[94:95], v1, s[4:7], s13 offen sc1
    s_cmp_lg_u32 s39, 0
    s_cbranch_scc1 L_adaL_nopost_33
    s_mov_b32 s49, 65536
L_adaL_tagpoll_34:
    s_waitcnt vmcnt(1)
    v_readfirstlane_b32 s48, v232
    s_nop 0
    s_cmp_lg_u32 s48, 0
    s_cbranch_scc1 L_adaL_taggot_35
    buffer_load_dwordx2 v[232:233], off, s[44:47], 0 sc1
    s_waitcnt vmcnt(0)
    s_sub_u32 s49, s49, 1
    s_cmp_lg_u32 s49, 0
    s_cbranch_scc1 L_adaL_tagpoll_34
L_adaL_taggot_35:
    s_lshl_b32 s43, s2, 3
    s_add_u32 s43, s43, 178464
    v_lshlrev_b32 v1, 8, v0
    s_waitcnt vmcnt(0)
    s_mov_b64 exec, 255
    buffer_store_dwordx2 v[232:233], v1, s[4:7], s43 offen sc1
    s_mov_b64 exec, -1
L_adaL_nopost_33:
    s_barrier
    s_cmp_ge_u32 s2, 240
    s_cbranch_scc1 L_adaL_reset_24
    buffer_load_dword v142, v138, s[20:23], s28 offen offset:0
    buffer_load_dword v143, v138, s[20:23], s28 offen offset:3456
    s_add_u32 s28, s28, 6912
    buffer_load_dword v144, v138, s[20:23], s28 offen offset:0
    buffer_load_dword v145, v138, s[20:23], s28 offen offset:3456
    s_add_u32 s28, s28, 6912
    buffer_load_dword v146, v138, s[20:23], s28 offen offset:0
    buffer_load_dword v147, v138, s[20:23], s28 offen offset:3456
    s_add_u32 s28, s28, 6912
    buffer_load_dword v148, v138, s[20:23], s28 offen offset:0
    buffer_load_dword v149, v138, s[20:23], s28 offen offset:3456
    s_add_u32 s28, s28, 6912
    buffer_load_dword v150, v138, s[20:23], s28 offen offset:0
    buffer_load_dword v151, v138, s[20:23], s28 offen offset:3456
    s_add_u32 s28, s28, 6912
    buffer_load_dword v152, v138, s[20:23], s28 offen offset:0
    buffer_load_dword v153, v138, s[20:23], s28 offen offset:3456
    s_add_u32 s28, s28, 6912
    buffer_load_dword v154, v138, s[20:23], s28 offen offset:0
    buffer_load_dword v155, v138, s[20:23], s28 offen offset:3456
    s_add_u32 s28, s28, 6912
    buffer_load_dword v156, v138, s[20:23], s28 offen offset:0
    buffer_load_dword v157, v138, s[20:23], s28 offen offset:3456
    s_add_u32 s28, s28, 6912
    buffer_load_dword v158, v138, s[20:23], s28 offen offset:0
    buffer_load_dword v159, v138, s[20:23], s28 offen offset:3456
    s_add_u32 s28, s28, 6912
    buffer_load_dword v160, v138, s[20:23], s28 offen offset:0
    buffer_load_dword v161, v138, s[20:23], s28 offen offset:3456
    s_add_u32 s28, s28, 6912
    buffer_load_dword v162, v138, s[20:23], s28 offen offset:0
    buffer_load_dword v163, v138, s[20:23], s28 offen offset:3456
    s_add_u32 s28, s28, 6912
    buffer_load_dword v164, v138, s[20:23], s28 offen offset:0
    buffer_load_dword v165, v138, s[20:23], s28 offen offset:3456
    s_add_u32 s28, s28, 6912
    buffer_load_dword v166, v138, s[20:23], s28 offen offset:0
    buffer_load_dword v167, v138, s[20:23], s28 offen offset:3456
    s_add_u32 s28, s28, 6912
    buffer_load_dword v168, v138, s[20:23], s28 offen offset:0
    buffer_load_dword v169, v138, s[20:23], s28 offen offset:3456
    s_add_u32 s28, s28, 6912
    buffer_load_dword v170, v138, s[20:23], s28 offen offset:0
    buffer_load_dword v171, v138, s[20:23], s28 offen offset:3456
    s_add_u32 s28, s28, 6912
    buffer_load_dword v172, v138, s[20:23], s28 offen offset:0
    buffer_load_dword v173, v138, s[20:23], s28 offen offset:3456
L_adaL_join_23:
    s_mov_b32 s49, 65536
L_adaL_tagpoll_36:
    s_waitcnt vmcnt(32)
    v_readfirstlane_b32 s48, v232
    s_nop 0
    s_cmp_lg_u32 s48, 0
    s_cbranch_scc1 L_adaL_taggot_37
    buffer_load_dwordx2 v[232:233], off, s[44:47], 0 sc1
    s_waitcnt vmcnt(0)
    s_sub_u32 s49, s49, 1
    s_cmp_lg_u32 s49, 0
    s_cbranch_scc1 L_adaL_tagpoll_36
L_adaL_taggot_37:
    s_lshl_b32 s28, s30, 8
    s_add_u32 s28, s28, 48128
    v_lshrrev_b32 v236, 5, v136
    v_mul_u32_u24 v236, 4864, v236
    v_lshl_add_u32 v236, v136, 3, v236
    v_add_u32 v236, s28, v236
    buffer_load_dwordx2 v[234:235], v236, s[4:7], 0 offen sc1
    s_mov_b32 s27, 0x3f803f80
    v_lshrrev_b32 v139, 4, v136
    v_lshlrev_b32 v1, 5, v139
    v_mul_u32_u24 v139, 40960, v139
    v_and_b32 v140, 15, v136
    v_lshl_add_u32 v139, v140, 4, v139
    v_add_u32 v1, v1, v140
    v_cmp_le_u32 vcc, 48, v136
    v_and_b32 v140, 8, v136
    s_nop 0
    v_cndmask_b32 v140, 0, v140, vcc
    v_add_u32 v1, v1, v140
    v_mov_b32 v137, 20480
    v_mov_b32 v140, 128
    v_cndmask_b32 v137, v137, v140, vcc
    v_cndmask_b32 v2, 16, 8, vcc
    v_add_u32 v2, v2, v1
    v_cmp_gt_u32 vcc, 56, v136
    v_mov_b32 v140, 2147483648
    s_nop 0
    v_cndmask_b32 v139, v140, v139, vcc
    v_add_u32 v140, v137, v139
    s_mul_i32 s28, s26, 143360
    s_lshl_b32 s29, s30, 10
    s_add_u32 s28, s28, s29
    s_add_u32 s28, s28, 8912896
    v_mov_b32 v4, 0
    v_mov_b32 v5, 0
    v_mov_b32 v6, 0
    v_mov_b32 v7, 0
    s_waitcnt vmcnt(32)
    v_lshlrev_b32 v8, 16, v142
    v_and_b32 v40, s3, v142
    s_waitcnt vmcnt(31)
    v_lshlrev_b32 v9, 16, v143
    v_and_b32 v41, s3, v143
    s_waitcnt vmcnt(30)
    v_lshlrev_b32 v10, 16, v144
    v_and_b32 v42, s3, v144
    s_waitcnt vmcnt(29)
    v_lshlrev_b32 v11, 16, v145
    v_and_b32 v43, s3, v145
    s_waitcnt vmcnt(28)
    v_lshlrev_b32 v12, 16, v146
    v_and_b32 v44, s3, v146
    s_waitcnt vmcnt(27)
    v_lshlrev_b32 v13, 16, v147
    v_and_b32 v45, s3, v147
    s_waitcnt vmcnt(26)
    v_lshlrev_b32 v14, 16, v148
    v_and_b32 v46, s3, v148
    s_waitcnt vmcnt(25)
    v_lshlrev_b32 v15, 16, v149
    v_and_b32 v47, s3, v149
    s_waitcnt vmcnt(24)
    v_lshlrev_b32 v16, 16, v150
    v_and_b32 v48, s3, v150
    s_waitcnt vmcnt(23)
    v_lshlrev_b32 v17, 16, v151
    v_and_b32 v49, s3, v151
    s_waitcnt vmcnt(22)
    v_lshlrev_b32 v18, 16, v152
    v_and_b32 v50, s3, v152
    s_waitcnt vmcnt(21)
    v_lshlrev_b32 v19, 16, v153
    v_and_b32 v51, s3, v153
    s_waitcnt vmcnt(20)
    v_lshlrev_b32 v20, 16, v154
    v_and_b32 v52, s3, v154
    s_waitcnt vmcnt(19)
    v_lshlrev_b32 v21, 16, v155
    v_and_b32 v53, s3, v155
    s_waitcnt vmcnt(18)
    v_lshlrev_b32 v22, 16, v156
    v_and_b32 v54, s3, v156
    s_waitcnt vmcnt(17)
    v_lshlrev_b32 v23, 16, v157
    v_and_b32 v55, s3, v157
    s_waitcnt vmcnt(16)
    v_lshlrev_b32 v24, 16, v158
    v_and_b32 v56, s3, v158
    s_waitcnt vmcnt(15)
    v_lshlrev_b32 v25, 16, v159
    v_and_b32 v57, s3, v159
    s_waitcnt vmcnt(14)
    v_lshlrev_b32 v26, 16, v160
    v_and_b32 v58, s3, v160
    s_waitcnt vmcnt(13)
    v_lshlrev_b32 v27, 16, v161
    v_and_b32 v59, s3, v161
    s_waitcnt vmcnt(12)
    v_lshlrev_b32 v28, 16, v162
    v_and_b32 v60, s3, v162
    s_waitcnt vmcnt(11)
    v_lshlrev_b32 v29, 16, v163
    v_and_b32 v61, s3, v163
    s_waitcnt vmcnt(10)
    v_lshlrev_b32 v30, 16, v164
    v_and_b32 v62, s3, v164
    s_waitcnt vmcnt(9)
    v_lshlrev_b32 v31, 16, v165
    v_and_b32 v63, s3, v165
    s_waitcnt vmcnt(8)
    v_lshlrev_b32 v32, 16, v166
    v_and_b32 v64, s3, v166
    s_waitcnt vmcnt(7)
    v_lshlrev_b32 v33, 16, v167
    v_and_b32 v65, s3, v167
    s_waitcnt vmcnt(6)
    v_lshlrev_b32 v34, 16, v168
    v_and_b32 v66, s3, v168
    s_waitcnt vmcnt(5)
    v_lshlrev_b32 v35, 16, v169
    v_and_b32 v67, s3, v169
    s_waitcnt vmcnt(4)
    v_lshlrev_b32 v36, 16, v170
    v_and_b32 v68, s3, v170
    s_waitcnt vmcnt(3)
    v_lshlrev_b32 v37, 16, v171
    v_and_b32 v69, s3, v171
    s_waitcnt vmcnt(2)
    v_lshlrev_b32 v38, 16, v172
    v_and_b32 v70, s3, v172
    s_waitcnt vmcnt(1)
    v_lshlrev_b32 v39, 16, v173
    v_and_b32 v71, s3, v173
    s_mov_b32 s49, 65536
L_adaL_poll_38:
    s_waitcnt vmcnt(0)
    v_cmp_ne_u32 vcc, s48, v235
    s_nop 0
    s_cbranch_vccz L_adaL_got_39
    buffer_load_dwordx2 v[234:235], v236, s[4:7], 0 offen sc1
    s_waitcnt vmcnt(0)
    s_sub_u32 s49, s49, 1
    s_cmp_lg_u32 s49, 0
    s_cbranch_scc1 L_adaL_poll_38
L_adaL_got_39:
    v_readlane_b32 s52, v234, 0
    v_readlane_b32 s53, v234, 1
    v_readlane_b32 s54, v234, 2
    v_readlane_b32 s55, v234, 3
    v_readlane_b32 s56, v234, 4
    v_readlane_b32 s57, v234, 5
    v_readlane_b32 s58, v234, 6
    v_readlane_b32 s59, v234, 7
    v_readlane_b32 s60, v234, 32
    v_readlane_b32 s61, v234, 33
    v_readlane_b32 s62, v234, 34
    v_readlane_b32 s63, v234, 35
    v_readlane_b32 s64, v234, 36
    v_readlane_b32 s65, v234, 37
    v_readlane_b32 s66, v234, 38
    v_readlane_b32 s67, v234, 39
    v_fmac_f32 v6, s52, v8
    v_fmac_f32 v7, s52, v40
    v_fmac_f32 v6, s53, v9
    v_fmac_f32 v7, s53, v41
    v_fmac_f32 v6, s54, v10
    v_fmac_f32 v7, s54, v42
    v_fmac_f32 v6, s55, v11
    v_fmac_f32 v7, s55, v43
    v_fmac_f32 v6, s56, v12
    v_fmac_f32 v7, s56, v44
    v_fmac_f32 v6, s57, v13
    v_fmac_f32 v7, s57, v45
    v_fmac_f32 v6, s58, v14
    v_fmac_f32 v7, s58, v46
    v_fmac_f32 v6, s59, v15
    v_fmac_f32 v7, s59, v47
    v_pk_mul_f32 v[8:9], v[8:9], s[60:61]
    v_pk_mul_f32 v[40:41], v[40:41], s[60:61]
    v_pk_mul_f32 v[10:11], v[10:11], s[62:63]
    v_pk_mul_f32 v[42:43], v[42:43], s[62:63]
    v_pk_mul_f32 v[12:13], v[12:13], s[64:65]
    v_pk_mul_f32 v[44:45], v[44:45], s[64:65]
    v_pk_mul_f32 v[14:15], v[14:15], s[66:67]
    v_pk_mul_f32 v[46:47], v[46:47], s[66:67]
    v_cvt_pk_bf16_f32 v72, v8, v9
    v_cvt_pk_bf16_f32 v80, v40, v41
    v_cvt_pk_bf16_f32 v73, v10, v11
    v_cvt_pk_bf16_f32 v81, v42, v43
    v_cvt_pk_bf16_f32 v74, v12, v13
    v_cvt_pk_bf16_f32 v82, v44, v45
    v_cvt_pk_bf16_f32 v75, v14, v15
    v_cvt_pk_bf16_f32 v83, v46, v47
    buffer_store_dwordx4 v[72:75], v139, s[4:7], s28 offen offset:0 sc1
    buffer_store_dwordx4 v[80:83], v140, s[4:7], s28 offen offset:0 sc1
    v_dot2c_f32_bf16 v4, s27, v72
    v_dot2c_f32_bf16 v5, s27, v80
    v_dot2c_f32_bf16 v4, s27, v73
    v_dot2c_f32_bf16 v5, s27, v81
    v_dot2c_f32_bf16 v4, s27, v74
    v_dot2c_f32_bf16 v5, s27, v82
    v_dot2c_f32_bf16 v4, s27, v75
    v_dot2c_f32_bf16 v5, s27, v83
    v_readlane_b32 s68, v234, 8
    v_readlane_b32 s69, v234, 9
    v_readlane_b32 s70, v234, 10
    v_readlane_b32 s71, v234, 11
    v_readlane_b32 s72, v234, 12
    v_readlane_b32 s73, v234, 13
    v_readlane_b32 s74, v234, 14
    v_readlane_b32 s75, v234, 15
    v_readlane_b32 s76, v234, 40
    v_readlane_b32 s77, v234, 41
    v_readlane_b32 s78, v234, 42
    v_readlane_b32 s79, v234, 43
    v_readlane_b32 s80, v234, 44
    v_readlane_b32 s81, v234, 45
    v_readlane_b32 s82, v234, 46
    v_readlane_b32 s83, v234, 47
    v_fmac_f32 v6, s68, v16
    v_fmac_f32 v7, s68, v48
    v_fmac_f32 v6, s69, v17
    v_fmac_f32 v7, s69, v49
    v_fmac_f32 v6, s70, v18
    v_fmac_f32 v7, s70, v50
    v_fmac_f32 v6, s71, v19
    v_fmac_f32 v7, s71, v51
    v_fmac_f32 v6, s72, v20
    v_fmac_f32 v7, s72, v52
    v_fmac_f32 v6, s73, v21
    v_fmac_f32 v7, s73, v53
    v_fmac_f32 v6, s74, v22
    v_fmac_f32 v7, s74, v54
    v_fmac_f32 v6, s75, v23
    v_fmac_f32 v7, s75, v55
    v_pk_mul_f32 v[16:17], v[16:17], s[76:77]
    v_pk_mul_f32 v[48:49], v[48:49], s[76:77]
    v_pk_mul_f32 v[18:19], v[18:19], s[78:79]
    v_pk_mul_f32 v[50:51], v[50:51], s[78:79]
    v_pk_mul_f32 v[20:21], v[20:21], s[80:81]
    v_pk_mul_f32 v[52:53], v[52:53], s[80:81]
    v_pk_mul_f32 v[22:23], v[22:23], s[82:83]
    v_pk_mul_f32 v[54:55], v[54:55], s[82:83]
    v_cvt_pk_bf16_f32 v76, v16, v17
    v_cvt_pk_bf16_f32 v84, v48, v49
    v_cvt_pk_bf16_f32 v77, v18, v19
    v_cvt_pk_bf16_f32 v85, v50, v51
    v_cvt_pk_bf16_f32 v78, v20, v21
    v_cvt_pk_bf16_f32 v86, v52, v53
    v_cvt_pk_bf16_f32 v79, v22, v23
    v_cvt_pk_bf16_f32 v87, v54, v55
    buffer_store_dwordx4 v[76:79], v139, s[4:7], s28 offen offset:256 sc1
    buffer_store_dwordx4 v[84:87], v140, s[4:7], s28 offen offset:256 sc1
    v_dot2c_f32_bf16 v4, s27, v76
    v_dot2c_f32_bf16 v5, s27, v84
    v_dot2c_f32_bf16 v4, s27, v77
    v_dot2c_f32_bf16 v5, s27, v85
    v_dot2c_f32_bf16 v4, s27, v78
    v_dot2c_f32_bf16 v5, s27, v86
    v_dot2c_f32_bf16 v4, s27, v79
    v_dot2c_f32_bf16 v5, s27, v87
    v_readlane_b32 s52, v234, 16
    v_readlane_b32 s53, v234, 17
    v_readlane_b32 s54, v234, 18
    v_readlane_b32 s55, v234, 19
    v_readlane_b32 s56, v234, 20
    v_readlane_b32 s57, v234, 21
    v_readlane_b32 s58, v234, 22
    v_readlane_b32 s59, v234, 23
    v_readlane_b32 s60, v234, 48
    v_readlane_b32 s61, v234, 49
    v_readlane_b32 s62, v234, 50
    v_readlane_b32 s63, v234, 51
    v_readlane_b32 s64, v234, 52
    v_readlane_b32 s65, v234, 53
    v_readlane_b32 s66, v234, 54
    v_readlane_b32 s67, v234, 55
    v_fmac_f32 v6, s52, v24
    v_fmac_f32 v7, s52, v56
    v_fmac_f32 v6, s53, v25
    v_fmac_f32 v7, s53, v57
    v_fmac_f32 v6, s54, v26
    v_fmac_f32 v7, s54, v58
    v_fmac_f32 v6, s55, v27
    v_fmac_f32 v7, s55, v59
    v_fmac_f32 v6, s56, v28
    v_fmac_f32 v7, s56, v60
    v_fmac_f32 v6, s57, v29
    v_fmac_f32 v7, s57, v61
    v_fmac_f32 v6, s58, v30
    v_fmac_f32 v7, s58, v62
    v_fmac_f32 v6, s59, v31
    v_fmac_f32 v7, s59, v63
    v_pk_mul_f32 v[24:25], v[24:25], s[60:61]
    v_pk_mul_f32 v[56:57], v[56:57], s[60:61]
    v_pk_mul_f32 v[26:27], v[26:27], s[62:63]
    v_pk_mul_f32 v[58:59], v[58:59], s[62:63]
    v_pk_mul_f32 v[28:29], v[28:29], s[64:65]
    v_pk_mul_f32 v[60:61], v[60:61], s[64:65]
    v_pk_mul_f32 v[30:31], v[30:31], s[66:67]
    v_pk_mul_f32 v[62:63], v[62:63], s[66:67]
    v_cvt_pk_bf16_f32 v72, v24, v25
    v_cvt_pk_bf16_f32 v80, v56, v57
    v_cvt_pk_bf16_f32 v73, v26, v27
    v_cvt_pk_bf16_f32 v81, v58, v59
    v_cvt_pk_bf16_f32 v74, v28, v29
    v_cvt_pk_bf16_f32 v82, v60, v61
    v_cvt_pk_bf16_f32 v75, v30, v31
    v_cvt_pk_bf16_f32 v83, v62, v63
    buffer_store_dwordx4 v[72:75], v139, s[4:7], s28 offen offset:512 sc1
    buffer_store_dwordx4 v[80:83], v140, s[4:7], s28 offen offset:512 sc1
    v_dot2c_f32_bf16 v4, s27, v72
    v_dot2c_f32_bf16 v5, s27, v80
    v_dot2c_f32_bf16 v4, s27, v73
    v_dot2c_f32_bf16 v5, s27, v81
    v_dot2c_f32_bf16 v4, s27, v74
    v_dot2c_f32_bf16 v5, s27, v82
    v_dot2c_f32_bf16 v4, s27, v75
    v_dot2c_f32_bf16 v5, s27, v83
    v_readlane_b32 s68, v234, 24
    v_readlane_b32 s69, v234, 25
    v_readlane_b32 s70, v234, 26
    v_readlane_b32 s71, v234, 27
    v_readlane_b32 s72, v234, 28
    v_readlane_b32 s73, v234, 29
    v_readlane_b32 s74, v234, 30
    v_readlane_b32 s75, v234, 31
    v_readlane_b32 s76, v234, 56
    v_readlane_b32 s77, v234, 57
    v_readlane_b32 s78, v234, 58
    v_readlane_b32 s79, v234, 59
    v_readlane_b32 s80, v234, 60
    v_readlane_b32 s81, v234, 61
    v_readlane_b32 s82, v234, 62
    v_readlane_b32 s83, v234, 63
    v_fmac_f32 v6, s68, v32
    v_fmac_f32 v7, s68, v64
    v_fmac_f32 v6, s69, v33
    v_fmac_f32 v7, s69, v65
    v_fmac_f32 v6, s70, v34
    v_fmac_f32 v7, s70, v66
    v_fmac_f32 v6, s71, v35
    v_fmac_f32 v7, s71, v67
    v_fmac_f32 v6, s72, v36
    v_fmac_f32 v7, s72, v68
    v_fmac_f32 v6, s73, v37
    v_fmac_f32 v7, s73, v69
    v_fmac_f32 v6, s74, v38
    v_fmac_f32 v7, s74, v70
    v_fmac_f32 v6, s75, v39
    v_fmac_f32 v7, s75, v71
    v_pk_mul_f32 v[32:33], v[32:33], s[76:77]
    v_pk_mul_f32 v[64:65], v[64:65], s[76:77]
    v_pk_mul_f32 v[34:35], v[34:35], s[78:79]
    v_pk_mul_f32 v[66:67], v[66:67], s[78:79]
    v_pk_mul_f32 v[36:37], v[36:37], s[80:81]
    v_pk_mul_f32 v[68:69], v[68:69], s[80:81]
    v_pk_mul_f32 v[38:39], v[38:39], s[82:83]
    v_pk_mul_f32 v[70:71], v[70:71], s[82:83]
    v_cvt_pk_bf16_f32 v76, v32, v33
    v_cvt_pk_bf16_f32 v84, v64, v65
    v_cvt_pk_bf16_f32 v77, v34, v35
    v_cvt_pk_bf16_f32 v85, v66, v67
    v_cvt_pk_bf16_f32 v78, v36, v37
    v_cvt_pk_bf16_f32 v86, v68, v69
    v_cvt_pk_bf16_f32 v79, v38, v39
    v_cvt_pk_bf16_f32 v87, v70, v71
    buffer_store_dwordx4 v[76:79], v139, s[4:7], s28 offen offset:768 sc1
    buffer_store_dwordx4 v[84:87], v140, s[4:7], s28 offen offset:768 sc1
    v_dot2c_f32_bf16 v4, s27, v76
    v_dot2c_f32_bf16 v5, s27, v84
    v_dot2c_f32_bf16 v4, s27, v77
    v_dot2c_f32_bf16 v5, s27, v85
    v_dot2c_f32_bf16 v4, s27, v78
    v_dot2c_f32_bf16 v5, s27, v86
    v_dot2c_f32_bf16 v4, s27, v79
    v_dot2c_f32_bf16 v5, s27, v87
    s_lshl_b32 s28, s24, 10
    s_add_u32 s28, s28, 8192
    v_lshl_add_u32 v1, v1, 2, s28
    v_lshl_add_u32 v2, v2, 2, s28
    ds_write2st64_b32 v1, v4, v6 offset0:0 offset1:2
    ds_write2st64_b32 v2, v5, v7 offset0:0 offset1:2
    v_lshlrev_b32 v137, 2, v0
    s_waitcnt lgkmcnt(0)
    s_barrier
    ds_read2st64_b32 v[8:9], v137 offset0:32 offset1:36
    ds_read2st64_b32 v[10:11], v137 offset0:40 offset1:44
    s_lshl_b32 s28, s42, 10
    s_add_u32 s28, s28, 262144
    s_waitcnt lgkmcnt(0)
    v_pk_add_f32 v[8:9], v[8:9], v[10:11]
    v_add_f32 v8, v8, v9
    buffer_store_dword v8, v137, s[4:7], s28 offen sc1
    s_waitcnt vmcnt(0)
    s_barrier
    s_cmp_lg_u32 s39, 0
    s_cbranch_scc1 L_adaL_nopub_26
    s_lshr_b32 s43, s26, 1
    s_mul_i32 s43, s43, 6
    s_add_u32 s43, s43, s25
    s_lshl_b32 s43, s43, 1
    s_and_b32 s42, s26, 1
    s_add_u32 s43, s43, s42
    s_lshl_b32 s43, s43, 5
    s_add_u32 s43, s43, 65536
    v_mul_u32_u24 v1, 3840, v0
    s_mov_b64 exec, 255
    buffer_store_dword v232, v1, s[4:7], s43 offen sc1
    s_mov_b64 exec, -1
    s_branch L_adaL_nopub_26
L_adaL_reset_24:
    s_waitcnt lgkmcnt(0)
    buffer_load_dwordx2 v[232:233], off, s[44:47], 0 sc1
    s_mov_b32 s49, 65536
L_adaL_tagpoll_40:
    s_waitcnt vmcnt(0)
    v_readfirstlane_b32 s48, v232
    s_nop 0
    s_cmp_lg_u32 s48, 0
    s_cbranch_scc1 L_adaL_taggot_41
    buffer_load_dwordx2 v[232:233], off, s[44:47], 0 sc1
    s_waitcnt vmcnt(0)
    s_sub_u32 s49, s49, 1
    s_cmp_lg_u32 s49, 0
    s_cbranch_scc1 L_adaL_tagpoll_40
L_adaL_taggot_41:
L_adaL_nopub_26:
    s_barrier
    s_mov_b32 s8, 4
    s_mov_b32 s9, -484
    s_cmp_ge_u32 s2, 220
    s_cselect_b32 s8, 2, s8
    s_cselect_b32 s9, -44, s9
    s_cmp_ge_u32 s2, 240
    s_cselect_b32 s8, 8, s8
    s_cselect_b32 s9, -1860, s9
    s_cmp_ge_u32 s2, 252
    s_cselect_b32 s8, 15, s8
    s_cselect_b32 s9, -3780, s9
    s_mul_i32 s10, s8, s2
    s_add_u32 s9, s9, s10
    s_lshl_b32 s9, s9, 14
    v_lshlrev_b32 v1, 4, v0
    s_cmp_eq_u32 s8, 0
    s_cbranch_scc1 L_adaL_nopull_43
L_adaL_pull_42:
    buffer_load_dwordx4 v[2:5], v1, s[32:35], s9 offen
    s_add_u32 s9, s9, 4096
    buffer_load_dwordx4 v[2:5], v1, s[32:35], s9 offen
    s_add_u32 s9, s9, 4096
    buffer_load_dwordx4 v[2:5], v1, s[32:35], s9 offen
    s_add_u32 s9, s9, 4096
    buffer_load_dwordx4 v[2:5], v1, s[32:35], s9 offen
    s_add_u32 s9, s9, 4096
    s_sub_u32 s8, s8, 1
    s_cmp_lg_u32 s8, 0
    s_cbranch_scc1 L_adaL_pull_42
L_adaL_nopull_43:
    v_lshrrev_b32 v240, 6, v0
    s_nop 0
    v_readfirstlane_b32 s82, v240
    s_bfe_u32 s87, s2, 0x30003
    s_and_b32 s83, s2, 6
    s_lshl_b32 s83, s83, 2
    s_add_u32 s83, s83, s87
    s_lshr_b32 s87, s2, 6
    s_and_b32 s84, s2, 1
    s_lshl_b32 s84, s84, 2
    s_add_u32 s84, s84, s87
    v_and_b32 v240, 63, v0
    v_lshlrev_b32 v241, 4, v240
    s_add_u32 s87, s82, 1
    s_lshl_b32 s87, s87, 29
    s_and_b32 s87, s87, 2147483648
    s_or_b32 s87, s87, 20480
    v_add_u32 v242, s87, v241
    s_mul_i32 s85, s84, 286720
    s_mul_i32 s87, s82, 40960
    s_add_u32 s85, s85, s87
    s_add_u32 s85, s85, 9056256
    s_and_b32 s86, s2, 7
    s_mul_i32 s86, s86, 3840
    s_mul_i32 s87, s84, 384
    s_add_u32 s86, s86, s87
    s_add_u32 s86, s86, 65536
    v_min_u32 v243, 9, v240
    v_lshlrev_b32 v243, 5, v243
    s_lshr_b32 s8, s2, 3
    s_sub_u32 s8, s8, 20
    s_and_b32 s9, s2, 1
    v_lshlrev_b32 v1, 7, v0
    buffer_load_dword v244, v243, s[4:7], s86 offen sc1
    s_branch L_adaL_join_3
code_end:
    s_endpgm
.section .rodata,"a"
.p2align 6
.amdhsa_kernel adaLN_cond__ssm_conv_h3__mixer_gmlp__prompt_kernel
  .amdhsa_next_free_vgpr 504
  .amdhsa_next_free_sgpr 88
  .amdhsa_accum_offset 248
  .amdhsa_group_segment_fixed_size 0
  .amdhsa_kernarg_size 128
  .amdhsa_user_sgpr_count 2
  .amdhsa_user_sgpr_kernarg_segment_ptr 1
  .amdhsa_system_sgpr_workgroup_id_x 1
  .amdhsa_float_denorm_mode_32 3
.end_amdhsa_kernel
```

```asm
; @launch kernel=adaLN_cond__ssm_conv_h3__mixer_gmlp__prompt_kernel grid=(256,1,1) block=(256,1,1) lds=163840
.amdgcn_target "amdgcn-amd-amdhsa--gfx950"
.text
.globl adaLN_cond__ssm_conv_h3__mixer_gmlp__prompt_kernel
.p2align 8
.type adaLN_cond__ssm_conv_h3__mixer_gmlp__prompt_kernel,@function
adaLN_cond__ssm_conv_h3__mixer_gmlp__prompt_kernel:
    s_cmp_ge_u32 s2, 256
    s_cbranch_scc1 L_adaL_end_1
    s_load_dwordx2 s[4:5], s[0:1], 120
    s_mov_b32 s6, 33554432
    s_mov_b32 s7, 0x20000
    s_load_dwordx2 s[44:45], s[0:1], 112
    s_mov_b32 s46, 256
    s_mov_b32 s47, 0x20000
    s_load_dwordx2 s[32:33], s[0:1], 64
    s_mov_b32 s34, 8388608
    s_mov_b32 s35, 0x20000
    s_mov_b32 s3, 0xffff0000
    s_cmp_ge_u32 s2, 160
    s_cbranch_scc1 L_adaL_aux_2
    s_load_dwordx2 s[8:9], s[0:1], 8
    s_mov_b32 s10, 2621440
    s_mov_b32 s11, 0x20000
    s_load_dwordx2 s[12:13], s[0:1], 16
    s_mov_b32 s14, 2621440
    s_mov_b32 s15, 0x20000
    s_load_dwordx2 s[20:21], s[0:1], 24
    s_mov_b32 s22, 5120
    s_mov_b32 s23, 0x20000
    s_load_dwordx2 s[16:17], s[0:1], 0
    s_mov_b32 s18, 2621440
    s_mov_b32 s19, 0x20000
    s_load_dwordx2 s[24:25], s[0:1], 32
    s_mov_b32 s26, 2621440
    s_mov_b32 s27, 0x20000
    s_load_dwordx2 s[28:29], s[0:1], 40
    s_mov_b32 s30, 1280
    s_mov_b32 s31, 0x20000
    s_load_dwordx2 s[36:37], s[0:1], 80
    s_mov_b32 s38, 1105920
    s_mov_b32 s39, 0x20000
    s_lshr_b32 s52, s2, 4
    s_and_b32 s53, s2, 15
    v_and_b32 v49, 31, v0
    v_lshrrev_b32 v3, 5, v0
    s_mul_i32 s60, s53, 163840
    s_lshl_b32 s61, s52, 7
    s_add_u32 s64, s60, s61
    v_mul_u32_u24 v46, 20480, v3
    v_lshl_add_u32 v46, v49, 2, v46
    s_sub_u32 s60, s64, 3840
    v_add_u32 v47, s60, v46
    s_lshl_b32 s61, s52, 9
    v_lshl_add_u32 v48, v49, 4, s61
    s_add_u32 s65, s64, 5120
    s_add_u32 s66, s64, 10240
    s_add_u32 s67, s64, 15360
    s_waitcnt lgkmcnt(0)
    buffer_load_dword v55, v46, s[8:11], s64 offen offset:0
    buffer_load_dword v56, v46, s[8:11], s64 offen offset:1280
    buffer_load_dword v57, v46, s[8:11], s64 offen offset:2560
    buffer_load_dword v58, v46, s[8:11], s64 offen offset:3840
    buffer_load_dword v59, v46, s[8:11], s65 offen offset:0
    buffer_load_dword v60, v46, s[8:11], s65 offen offset:1280
    buffer_load_dword v61, v46, s[8:11], s65 offen offset:2560
    buffer_load_dword v62, v46, s[8:11], s65 offen offset:3840
    buffer_load_dword v52, v47, s[8:11], 0 offen offset:0
    buffer_load_dword v53, v47, s[8:11], 0 offen offset:1280
    buffer_load_dword v54, v47, s[8:11], 0 offen offset:2560
    buffer_load_dwordx4 v[88:91], v48, s[20:23], 0 offen
    buffer_load_dword v72, v46, s[12:15], s64 offen offset:0
    buffer_load_dword v73, v46, s[12:15], s64 offen offset:1280
    buffer_load_dword v74, v46, s[12:15], s64 offen offset:2560
    buffer_load_dword v75, v46, s[12:15], s64 offen offset:3840
    buffer_load_dword v76, v46, s[12:15], s65 offen offset:0
    buffer_load_dword v77, v46, s[12:15], s65 offen offset:1280
    buffer_load_dword v78, v46, s[12:15], s65 offen offset:2560
    buffer_load_dword v79, v46, s[12:15], s65 offen offset:3840
    buffer_load_dword v63, v46, s[8:11], s66 offen offset:0
    buffer_load_dword v64, v46, s[8:11], s66 offen offset:1280
    buffer_load_dword v65, v46, s[8:11], s66 offen offset:2560
    buffer_load_dword v66, v46, s[8:11], s66 offen offset:3840
    buffer_load_dword v67, v46, s[8:11], s67 offen offset:0
    buffer_load_dword v68, v46, s[8:11], s67 offen offset:1280
    buffer_load_dword v69, v46, s[8:11], s67 offen offset:2560
    buffer_load_dword v70, v46, s[8:11], s67 offen offset:3840
    buffer_load_dword v80, v46, s[12:15], s66 offen offset:0
    buffer_load_dword v81, v46, s[12:15], s66 offen offset:1280
    buffer_load_dword v82, v46, s[12:15], s66 offen offset:2560
    buffer_load_dword v83, v46, s[12:15], s66 offen offset:3840
    buffer_load_dword v84, v46, s[12:15], s67 offen offset:0
    buffer_load_dword v85, v46, s[12:15], s67 offen offset:1280
    buffer_load_dword v86, v46, s[12:15], s67 offen offset:2560
    buffer_load_dword v87, v46, s[12:15], s67 offen offset:3840
    v_mul_u32_u24 v124, 528, v49
    v_lshl_add_u32 v124, v3, 4, v124
    v_add_u32 v124, 132096, v124
    v_mul_u32_u24 v125, 528, v3
    v_lshl_add_u32 v125, v49, 4, v125
    v_add_u32 v125, 132096, v125
    v_lshrrev_b32 v2, 6, v0
    s_nop 0
    v_readfirstlane_b32 s54, v2
    v_and_b32 v1, 63, v0
    s_lshl_b32 s55, s2, 2
    s_add_u32 s55, s55, s54
    s_lshl_b32 s60, s55, 12
    v_lshl_add_u32 v4, v1, 4, s60
    v_and_b32 v44, 7, v0
    v_lshrrev_b32 v45, 3, v0
    v_mul_u32_u24 v46, 5120, v45
    v_lshl_add_u32 v46, v44, 4, v46
    v_add_u32 v46, s64, v46
    s_lshl_b32 s55, s55, 1
    buffer_load_dwordx4 v[96:99], v4, s[24:27], 0 offen offset:0
    buffer_load_dwordx4 v[104:107], v4, s[24:27], 0 offen offset:1024
    buffer_load_dwordx4 v[112:115], v4, s[24:27], 0 offen offset:2048
    buffer_load_dwordx4 v[120:123], v4, s[24:27], 0 offen offset:3072
    buffer_load_ushort v5, off, s[28:31], s55
    buffer_load_dwordx4 v[28:31], v46, s[16:19], 0 offen offset:0
    buffer_load_dwordx4 v[32:35], v46, s[16:19], 0 offen offset:1280
    buffer_load_dwordx4 v[36:39], v46, s[16:19], 0 offen offset:2560
    buffer_load_dwordx4 v[40:43], v46, s[16:19], 0 offen offset:3840
    s_mul_i32 s60, s54, 2176
    s_add_u32 s60, s60, 150528
    v_mul_u32_u24 v24, 272, v44
    v_and_b32 v2, 7, v45
    v_lshl_add_u32 v24, v2, 4, v24
    v_add_u32 v24, s60, v24
    v_lshrrev_b32 v2, 4, v1
    v_and_b32 v3, 15, v1
    v_mul_u32_u24 v25, 272, v2
    v_lshl_add_u32 v25, v3, 4, v25
    v_add_u32 v25, s60, v25
    v_lshlrev_b32 v26, 15, v2
    v_lshl_add_u32 v26, v3, 4, v26
    v_lshlrev_b32 v126, 11, v45
    v_lshl_add_u32 v126, v44, 4, v126
    s_lshl_b32 s60, s52, 18
    s_lshl_b32 s61, s53, 7
    s_add_u32 s64, s60, s61
    s_add_u32 s64, s64, 1048576
    s_lshl_b32 s61, s53, 10
    s_add_u32 s68, s60, s61
    s_lshl_b32 s61, s54, 8
    s_add_u32 s68, s68, s61
    s_add_u32 s68, s68, 3670016
    s_add_u32 s65, s64, 65536
    s_add_u32 s69, s68, 131072
    s_add_u32 s66, s64, 131072
    s_add_u32 s70, s68, 16384
    s_add_u32 s67, s64, 196608
    s_add_u32 s71, s68, 147456
    s_mul_i32 s56, s54, 33024
    s_mul_i32 s57, s54, 4608
    s_add_u32 s57, s57, 132096
    v_lshrrev_b32 v127, 4, v1
    v_bfe_u32 v2, v1, 3, 1
    v_bfe_u32 v3, v1, 2, 1
    v_xor_b32 v3, v2, v3
    v_and_b32 v128, 3, v1
    v_lshl_add_u32 v128, v128, 1, v2
    v_mul_u32_u24 v6, 4128, v128
    v_lshl_add_u32 v6, v3, 4, v6
    v_lshl_add_u32 v128, v3, 3, v128
    v_and_b32 v2, 1, v127
    v_lshrrev_b32 v3, 1, v127
    v_lshl_add_u32 v129, v2, 1, v3
    v_mul_u32_u24 v7, 2304, v3
    v_and_b32 v3, 15, v1
    v_add_u32 v2, v2, v3
    v_lshl_add_u32 v7, v2, 4, v7
    s_add_u32 s61, s57, 16
    v_add_u32 v7, s61, v7
    v_sub_u32 v2, 3, v129
    v_lshl_add_u32 v6, v2, 4, v6
    v_add_u32 v6, s56, v6
    v_lshlrev_b32 v131, 3, v129
    v_sub_u32 v131, v131, v128
    v_subrev_u32 v131, 9, v131
    v_bfe_u32 v2, v1, 5, 1
    v_bfe_u32 v3, v1, 4, 1
    v_xor_b32 v3, v2, v3
    v_lshl_add_u32 v8, v2, 2, v3
    v_and_b32 v2, 1, v1
    v_lshl_add_u32 v8, v2, 1, v8
    v_bfe_u32 v2, v1, 1, 1
    v_and_b32 v3, 4, v1
    v_or_b32 v2, v2, v3
    v_xor_b32 v8, v2, v8
    v_bfe_u32 v2, v1, 1, 3
    v_lshl_add_u32 v8, v2, 3, v8
    v_lshl_add_u32 v8, v8, 4, s56
    v_lshl_add_u32 v130, v1, 4, s56
    v_lshlrev_b32 v9, 4, v0
    v_mul_u32_u24 v132, 2304, v127
    v_and_b32 v3, 15, v1
    v_lshl_add_u32 v132, v3, 4, v132
    v_add_u32 v132, s57, v132
    s_lshl_b32 s58, s2, 9
    s_add_u32 s58, s58, 786432
    v_lshlrev_b32 v10, 5, v3
    s_lshl_b32 s60, s52, 8
    s_add_u32 s60, s60, s53
    s_lshl_b32 s60, s60, 5
    s_add_u32 s63, s60, 786432
    s_cmp_lg_u32 s54, 0
    s_cselect_b32 s63, 33554432, s63
    v_lshlrev_b32 v27, 9, v1
    v_and_b32 v3, 7, v1
    v_mul_u32_u24 v3, 4128, v3
    v_add_u32 v3, s56, v3
    v_cmp_lt_u32 vcc, 31, v1
    s_nop 1
    v_cndmask_b32 v132, v132, v3, vcc
    s_waitcnt vmcnt(44)
    v_lshlrev_b32 v148, 16, v55
    v_and_b32 v149, s3, v55
    buffer_load_dwordx2 v[12:13], off, s[44:47], 0 sc1
    s_waitcnt vmcnt(44)
    v_lshlrev_b32 v150, 16, v56
    v_and_b32 v151, s3, v56
    s_waitcnt vmcnt(43)
    v_lshlrev_b32 v152, 16, v57
    v_and_b32 v153, s3, v57
    s_waitcnt vmcnt(42)
    v_lshlrev_b32 v154, 16, v58
    v_and_b32 v155, s3, v58
    s_waitcnt vmcnt(41)
    v_lshlrev_b32 v156, 16, v59
    v_and_b32 v157, s3, v59
    s_waitcnt vmcnt(40)
    v_lshlrev_b32 v158, 16, v60
    v_and_b32 v159, s3, v60
    s_waitcnt vmcnt(39)
    v_lshlrev_b32 v160, 16, v61
    v_and_b32 v161, s3, v61
    s_waitcnt vmcnt(38)
    v_lshlrev_b32 v162, 16, v62
    v_and_b32 v163, s3, v62
    s_waitcnt vmcnt(37)
    v_lshlrev_b32 v142, 16, v52
    v_and_b32 v143, s3, v52
    s_waitcnt vmcnt(36)
    v_lshlrev_b32 v144, 16, v53
    v_and_b32 v145, s3, v53
    s_waitcnt vmcnt(35)
    v_lshlrev_b32 v146, 16, v54
    v_and_b32 v147, s3, v54
    s_waitcnt vmcnt(34)
    v_lshlrev_b32 v134, 16, v88
    v_and_b32 v136, s3, v88
    v_lshlrev_b32 v138, 16, v89
    v_and_b32 v140, s3, v89
    v_lshlrev_b32 v135, 16, v90
    v_and_b32 v137, s3, v90
    v_lshlrev_b32 v139, 16, v91
    v_and_b32 v141, s3, v91
    v_pk_mul_f32 v[196:197], v[142:143], v[140:141]
    v_pk_mul_f32 v[198:199], v[144:145], v[140:141]
    v_pk_mul_f32 v[200:201], v[146:147], v[140:141]
    v_pk_mul_f32 v[202:203], v[148:149], v[140:141]
    v_pk_mul_f32 v[204:205], v[150:151], v[140:141]
    v_pk_mul_f32 v[206:207], v[152:153], v[140:141]
    v_pk_mul_f32 v[208:209], v[154:155], v[140:141]
    v_pk_mul_f32 v[210:211], v[156:157], v[140:141]
    v_pk_fma_f32 v[196:197], v[144:145], v[138:139], v[196:197]
    v_pk_fma_f32 v[198:199], v[146:147], v[138:139], v[198:199]
    v_pk_fma_f32 v[200:201], v[148:149], v[138:139], v[200:201]
    v_pk_fma_f32 v[202:203], v[150:151], v[138:139], v[202:203]
    v_pk_fma_f32 v[204:205], v[152:153], v[138:139], v[204:205]
    v_pk_fma_f32 v[206:207], v[154:155], v[138:139], v[206:207]
    v_pk_fma_f32 v[208:209], v[156:157], v[138:139], v[208:209]
    v_pk_fma_f32 v[210:211], v[158:159], v[138:139], v[210:211]
    v_pk_fma_f32 v[196:197], v[146:147], v[136:137], v[196:197]
    v_pk_fma_f32 v[198:199], v[148:149], v[136:137], v[198:199]
    v_pk_fma_f32 v[200:201], v[150:151], v[136:137], v[200:201]
    v_pk_fma_f32 v[202:203], v[152:153], v[136:137], v[202:203]
    v_pk_fma_f32 v[204:205], v[154:155], v[136:137], v[204:205]
    v_pk_fma_f32 v[206:207], v[156:157], v[136:137], v[206:207]
    v_pk_fma_f32 v[208:209], v[158:159], v[136:137], v[208:209]
    v_pk_fma_f32 v[210:211], v[160:161], v[136:137], v[210:211]
    v_pk_fma_f32 v[196:197], v[148:149], v[134:135], v[196:197]
    v_pk_fma_f32 v[198:199], v[150:151], v[134:135], v[198:199]
    v_pk_fma_f32 v[200:201], v[152:153], v[134:135], v[200:201]
    v_pk_fma_f32 v[202:203], v[154:155], v[134:135], v[202:203]
    v_pk_fma_f32 v[204:205], v[156:157], v[134:135], v[204:205]
    v_pk_fma_f32 v[206:207], v[158:159], v[134:135], v[206:207]
    v_pk_fma_f32 v[208:209], v[160:161], v[134:135], v[208:209]
    v_pk_fma_f32 v[210:211], v[162:163], v[134:135], v[210:211]
    s_waitcnt vmcnt(33)
    v_lshlrev_b32 v180, 16, v72
    v_and_b32 v181, s3, v72
    s_waitcnt vmcnt(32)
    v_lshlrev_b32 v182, 16, v73
    v_and_b32 v183, s3, v73
    s_waitcnt vmcnt(31)
    v_lshlrev_b32 v184, 16, v74
    v_and_b32 v185, s3, v74
    s_waitcnt vmcnt(30)
    v_lshlrev_b32 v186, 16, v75
    v_and_b32 v187, s3, v75
    s_waitcnt vmcnt(29)
    v_lshlrev_b32 v188, 16, v76
    v_and_b32 v189, s3, v76
    s_waitcnt vmcnt(28)
    v_lshlrev_b32 v190, 16, v77
    v_and_b32 v191, s3, v77
    s_waitcnt vmcnt(27)
    v_lshlrev_b32 v192, 16, v78
    v_and_b32 v193, s3, v78
    s_waitcnt vmcnt(26)
    v_lshlrev_b32 v194, 16, v79
    v_and_b32 v195, s3, v79
    v_pk_mul_f32 v[196:197], v[196:197], v[180:181]
    v_pk_mul_f32 v[198:199], v[198:199], v[182:183]
    v_pk_mul_f32 v[200:201], v[200:201], v[184:185]
    v_pk_mul_f32 v[202:203], v[202:203], v[186:187]
    v_pk_mul_f32 v[204:205], v[204:205], v[188:189]
    v_pk_mul_f32 v[206:207], v[206:207], v[190:191]
    v_pk_mul_f32 v[208:209], v[208:209], v[192:193]
    v_pk_mul_f32 v[210:211], v[210:211], v[194:195]
    v_cvt_pk_bf16_f32 v212, v210, v208
    v_cvt_pk_bf16_f32 v213, v206, v204
    v_cvt_pk_bf16_f32 v214, v202, v200
    v_cvt_pk_bf16_f32 v215, v198, v196
    ds_write_b128 v124, v[212:215] offset:0
    v_cvt_pk_bf16_f32 v216, v211, v209
    v_cvt_pk_bf16_f32 v217, v207, v205
    v_cvt_pk_bf16_f32 v218, v203, v201
    v_cvt_pk_bf16_f32 v219, v199, v197
    ds_write_b128 v124, v[216:219] offset:256
    s_waitcnt vmcnt(25)
    v_lshlrev_b32 v164, 16, v63
    v_and_b32 v165, s3, v63
    s_waitcnt vmcnt(24)
    v_lshlrev_b32 v166, 16, v64
    v_and_b32 v167, s3, v64
    s_waitcnt vmcnt(23)
    v_lshlrev_b32 v168, 16, v65
    v_and_b32 v169, s3, v65
    s_waitcnt vmcnt(22)
    v_lshlrev_b32 v170, 16, v66
    v_and_b32 v171, s3, v66
    s_waitcnt vmcnt(21)
    v_lshlrev_b32 v172, 16, v67
    v_and_b32 v173, s3, v67
    s_waitcnt vmcnt(20)
    v_lshlrev_b32 v174, 16, v68
    v_and_b32 v175, s3, v68
    s_waitcnt vmcnt(19)
    v_lshlrev_b32 v176, 16, v69
    v_and_b32 v177, s3, v69
    s_waitcnt vmcnt(18)
    v_lshlrev_b32 v178, 16, v70
    v_and_b32 v179, s3, v70
    v_pk_mul_f32 v[196:197], v[158:159], v[140:141]
    v_pk_mul_f32 v[198:199], v[160:161], v[140:141]
    v_pk_mul_f32 v[200:201], v[162:163], v[140:141]
    v_pk_mul_f32 v[202:203], v[164:165], v[140:141]
    v_pk_mul_f32 v[204:205], v[166:167], v[140:141]
    v_pk_mul_f32 v[206:207], v[168:169], v[140:141]
    v_pk_mul_f32 v[208:209], v[170:171], v[140:141]
    v_pk_mul_f32 v[210:211], v[172:173], v[140:141]
    v_pk_fma_f32 v[196:197], v[160:161], v[138:139], v[196:197]
    v_pk_fma_f32 v[198:199], v[162:163], v[138:139], v[198:199]
    v_pk_fma_f32 v[200:201], v[164:165], v[138:139], v[200:201]
    v_pk_fma_f32 v[202:203], v[166:167], v[138:139], v[202:203]
    v_pk_fma_f32 v[204:205], v[168:169], v[138:139], v[204:205]
    v_pk_fma_f32 v[206:207], v[170:171], v[138:139], v[206:207]
    v_pk_fma_f32 v[208:209], v[172:173], v[138:139], v[208:209]
    v_pk_fma_f32 v[210:211], v[174:175], v[138:139], v[210:211]
    v_pk_fma_f32 v[196:197], v[162:163], v[136:137], v[196:197]
    v_pk_fma_f32 v[198:199], v[164:165], v[136:137], v[198:199]
    v_pk_fma_f32 v[200:201], v[166:167], v[136:137], v[200:201]
    v_pk_fma_f32 v[202:203], v[168:169], v[136:137], v[202:203]
    v_pk_fma_f32 v[204:205], v[170:171], v[136:137], v[204:205]
    v_pk_fma_f32 v[206:207], v[172:173], v[136:137], v[206:207]
    v_pk_fma_f32 v[208:209], v[174:175], v[136:137], v[208:209]
    v_pk_fma_f32 v[210:211], v[176:177], v[136:137], v[210:211]
    v_pk_fma_f32 v[196:197], v[164:165], v[134:135], v[196:197]
    v_pk_fma_f32 v[198:199], v[166:167], v[134:135], v[198:199]
    v_pk_fma_f32 v[200:201], v[168:169], v[134:135], v[200:201]
    v_pk_fma_f32 v[202:203], v[170:171], v[134:135], v[202:203]
    v_pk_fma_f32 v[204:205], v[172:173], v[134:135], v[204:205]
    v_pk_fma_f32 v[206:207], v[174:175], v[134:135], v[206:207]
    v_pk_fma_f32 v[208:209], v[176:177], v[134:135], v[208:209]
    v_pk_fma_f32 v[210:211], v[178:179], v[134:135], v[210:211]
    s_waitcnt vmcnt(17)
    v_lshlrev_b32 v180, 16, v80
    v_and_b32 v181, s3, v80
    s_waitcnt vmcnt(16)
    v_lshlrev_b32 v182, 16, v81
    v_and_b32 v183, s3, v81
    s_waitcnt vmcnt(15)
    v_lshlrev_b32 v184, 16, v82
    v_and_b32 v185, s3, v82
    s_waitcnt vmcnt(14)
    v_lshlrev_b32 v186, 16, v83
    v_and_b32 v187, s3, v83
    s_waitcnt vmcnt(13)
    v_lshlrev_b32 v188, 16, v84
    v_and_b32 v189, s3, v84
    s_waitcnt vmcnt(12)
    v_lshlrev_b32 v190, 16, v85
    v_and_b32 v191, s3, v85
    s_waitcnt vmcnt(11)
    v_lshlrev_b32 v192, 16, v86
    v_and_b32 v193, s3, v86
    s_waitcnt vmcnt(10)
    v_lshlrev_b32 v194, 16, v87
    v_and_b32 v195, s3, v87
    v_pk_mul_f32 v[196:197], v[196:197], v[180:181]
    v_pk_mul_f32 v[198:199], v[198:199], v[182:183]
    v_pk_mul_f32 v[200:201], v[200:201], v[184:185]
    v_pk_mul_f32 v[202:203], v[202:203], v[186:187]
    v_pk_mul_f32 v[204:205], v[204:205], v[188:189]
    v_pk_mul_f32 v[206:207], v[206:207], v[190:191]
    v_pk_mul_f32 v[208:209], v[208:209], v[192:193]
    v_pk_mul_f32 v[210:211], v[210:211], v[194:195]
    v_cvt_pk_bf16_f32 v212, v210, v208
    v_cvt_pk_bf16_f32 v213, v206, v204
    v_cvt_pk_bf16_f32 v214, v202, v200
    v_cvt_pk_bf16_f32 v215, v198, v196
    ds_write_b128 v124, v[212:215] offset:128
    v_cvt_pk_bf16_f32 v216, v211, v209
    v_cvt_pk_bf16_f32 v217, v207, v205
    v_cvt_pk_bf16_f32 v218, v203, v201
    v_cvt_pk_bf16_f32 v219, v199, v197
    ds_write_b128 v124, v[216:219] offset:384
    s_waitcnt lgkmcnt(0)
    s_barrier
    ds_read_b128 v[52:55], v125 offset:0
    ds_read_b128 v[56:59], v125 offset:4224
    ds_read_b128 v[60:63], v125 offset:8448
    ds_read_b128 v[64:67], v125 offset:12672
    s_waitcnt lgkmcnt(3)
    buffer_store_dwordx4 v[52:55], v126, s[4:7], s64 offen sc1
    s_waitcnt lgkmcnt(2)
    buffer_store_dwordx4 v[56:59], v126, s[4:7], s65 offen sc1
    s_waitcnt lgkmcnt(1)
    buffer_store_dwordx4 v[60:63], v126, s[4:7], s66 offen sc1
    s_waitcnt lgkmcnt(0)
    buffer_store_dwordx4 v[64:67], v126, s[4:7], s67 offen sc1
    s_mov_b32 s49, 65536
L_adaL_tagpoll_4:
    s_waitcnt vmcnt(4)
    v_readfirstlane_b32 s48, v12
    s_nop 0
    s_cmp_lg_u32 s48, 0
    s_cbranch_scc1 L_adaL_taggot_5
    buffer_load_dwordx2 v[12:13], off, s[44:47], 0 sc1
    s_waitcnt vmcnt(0)
    s_sub_u32 s49, s49, 1
    s_cmp_lg_u32 s49, 0
    s_cbranch_scc1 L_adaL_tagpoll_4
L_adaL_taggot_5:
    ds_write_b128 v130, v[96:99] offset:28912
    v_mov_b32 v92, 0
    v_mov_b32 v93, 0
    v_mov_b32 v94, 0
    v_mov_b32 v95, 0
    v_mov_b32_dpp v92, v96 wave_shr:1 row_mask:0xf bank_mask:0xf
    v_mov_b32_dpp v93, v97 wave_shr:1 row_mask:0xf bank_mask:0xf
    v_mov_b32_dpp v94, v98 wave_shr:1 row_mask:0xf bank_mask:0xf
    v_mov_b32_dpp v95, v99 wave_shr:1 row_mask:0xf bank_mask:0xf
    ds_write_b128 v130, v[94:97] offset:12400
    v_alignbit_b32 v134, v93, v92, 16
    v_alignbit_b32 v135, v94, v93, 16
    v_alignbit_b32 v136, v95, v94, 16
    v_alignbit_b32 v137, v96, v95, 16
    v_alignbit_b32 v138, v97, v96, 16
    v_alignbit_b32 v139, v98, v97, 16
    ds_write_b128 v130, v[134:137] offset:16
    v_mov_b32 v148, v93
    v_mov_b32 v149, v94
    v_mov_b32 v150, v95
    v_mov_b32 v151, v96
    v_mov_b32 v152, v97
    v_mov_b32 v153, v98
    ds_write_b128 v130, v[136:139] offset:16528
    ds_write_b128 v130, v[148:151] offset:4144
    v_alignbit_b32 v142, v94, v93, 16
    v_alignbit_b32 v143, v95, v94, 16
    v_alignbit_b32 v144, v96, v95, 16
    v_alignbit_b32 v145, v97, v96, 16
    v_alignbit_b32 v146, v98, v97, 16
    v_alignbit_b32 v147, v99, v98, 16
    ds_write_b128 v130, v[150:153] offset:20656
    ds_write_b128 v130, v[142:145] offset:8272
    ds_write_b128 v130, v[144:147] offset:24784
    s_waitcnt vmcnt(0)
    s_barrier
    s_mov_b64 exec, 65535
    buffer_store_dword v12, v27, s[4:7], s63 offen sc1
    s_mov_b64 exec, -1
    ds_write2_b64 v24, v[28:29], v[36:37] offset0:0 offset1:1
    ds_write2_b64 v24, v[32:33], v[40:41] offset0:16 offset1:17
    ds_read_b128 v[72:75], v25 offset:0
    ds_read_b128 v[76:79], v25 offset:1088
    ds_write2_b64 v24, v[30:31], v[38:39] offset0:0 offset1:1
    ds_write2_b64 v24, v[34:35], v[42:43] offset0:16 offset1:17
    ds_read_b128 v[80:83], v25 offset:0
    ds_read_b128 v[84:87], v25 offset:1088
    s_waitcnt lgkmcnt(5)
    buffer_store_dwordx4 v[72:75], v26, s[4:7], s68 offen sc1
    s_waitcnt lgkmcnt(4)
    buffer_store_dwordx4 v[76:79], v26, s[4:7], s69 offen sc1
    s_waitcnt lgkmcnt(1)
    buffer_store_dwordx4 v[80:83], v26, s[4:7], s70 offen sc1
    s_waitcnt lgkmcnt(0)
    buffer_store_dwordx4 v[84:87], v26, s[4:7], s71 offen sc1
    ds_write_b128 v130, v[104:107] offset:29936
    v_mov_b32_dpp v100, v96 wave_ror:1 row_mask:0xf bank_mask:0xf
    v_mov_b32_dpp v101, v97 wave_ror:1 row_mask:0xf bank_mask:0xf
    v_mov_b32_dpp v102, v98 wave_ror:1 row_mask:0xf bank_mask:0xf
    v_mov_b32_dpp v103, v99 wave_ror:1 row_mask:0xf bank_mask:0xf
    v_mov_b32_dpp v100, v104 wave_shr:1 row_mask:0xf bank_mask:0xf
    v_mov_b32_dpp v101, v105 wave_shr:1 row_mask:0xf bank_mask:0xf
    v_mov_b32_dpp v102, v106 wave_shr:1 row_mask:0xf bank_mask:0xf
    v_mov_b32_dpp v103, v107 wave_shr:1 row_mask:0xf bank_mask:0xf
    ds_write_b128 v130, v[102:105] offset:13424
    v_alignbit_b32 v134, v101, v100, 16
    v_alignbit_b32 v135, v102, v101, 16
    v_alignbit_b32 v136, v103, v102, 16
    v_alignbit_b32 v137, v104, v103, 16
    v_alignbit_b32 v138, v105, v104, 16
    v_alignbit_b32 v139, v106, v105, 16
    ds_write_b128 v130, v[134:137] offset:1040
    v_mov_b32 v148, v101
    v_mov_b32 v149, v102
    v_mov_b32 v150, v103
    v_mov_b32 v151, v104
    v_mov_b32 v152, v105
    v_mov_b32 v153, v106
    ds_write_b128 v130, v[136:139] offset:17552
    ds_write_b128 v130, v[148:151] offset:5168
    v_alignbit_b32 v142, v102, v101, 16
    v_alignbit_b32 v143, v103, v102, 16
    v_alignbit_b32 v144, v104, v103, 16
    v_alignbit_b32 v145, v105, v104, 16
    v_alignbit_b32 v146, v106, v105, 16
    v_alignbit_b32 v147, v107, v106, 16
    ds_write_b128 v130, v[150:153] offset:21680
    ds_write_b128 v130, v[142:145] offset:9296
    ds_write_b128 v130, v[144:147] offset:25808
    ds_write_b128 v130, v[112:115] offset:30960
    v_mov_b32_dpp v108, v104 wave_ror:1 row_mask:0xf bank_mask:0xf
    v_mov_b32_dpp v109, v105 wave_ror:1 row_mask:0xf bank_mask:0xf
    v_mov_b32_dpp v110, v106 wave_ror:1 row_mask:0xf bank_mask:0xf
    v_mov_b32_dpp v111, v107 wave_ror:1 row_mask:0xf bank_mask:0xf
    v_mov_b32_dpp v108, v112 wave_shr:1 row_mask:0xf bank_mask:0xf
    v_mov_b32_dpp v109, v113 wave_shr:1 row_mask:0xf bank_mask:0xf
    v_mov_b32_dpp v110, v114 wave_shr:1 row_mask:0xf bank_mask:0xf
    v_mov_b32_dpp v111, v115 wave_shr:1 row_mask:0xf bank_mask:0xf
    ds_write_b128 v130, v[110:113] offset:14448
    v_alignbit_b32 v134, v109, v108, 16
    v_alignbit_b32 v135, v110, v109, 16
    v_alignbit_b32 v136, v111, v110, 16
    v_alignbit_b32 v137, v112, v111, 16
    v_alignbit_b32 v138, v113, v112, 16
    v_alignbit_b32 v139, v114, v113, 16
    ds_write_b128 v130, v[134:137] offset:2064
    v_mov_b32 v148, v109
    v_mov_b32 v149, v110
    v_mov_b32 v150, v111
    v_mov_b32 v151, v112
    v_mov_b32 v152, v113
    v_mov_b32 v153, v114
    ds_write_b128 v130, v[136:139] offset:18576
    ds_write_b128 v130, v[148:151] offset:6192
    v_alignbit_b32 v142, v110, v109, 16
    v_alignbit_b32 v143, v111, v110, 16
    v_alignbit_b32 v144, v112, v111, 16
    v_alignbit_b32 v145, v113, v112, 16
    v_alignbit_b32 v146, v114, v113, 16
    v_alignbit_b32 v147, v115, v114, 16
    ds_write_b128 v130, v[150:153] offset:22704
    ds_write_b128 v130, v[142:145] offset:10320
    ds_write_b128 v130, v[144:147] offset:26832
    buffer_load_dword v14, v10, s[4:7], s58 offen sc1
    ds_write_b128 v130, v[120:123] offset:31984
    v_mov_b32_dpp v116, v112 wave_ror:1 row_mask:0xf bank_mask:0xf
    v_mov_b32_dpp v117, v113 wave_ror:1 row_mask:0xf bank_mask:0xf
    v_mov_b32_dpp v118, v114 wave_ror:1 row_mask:0xf bank_mask:0xf
    v_mov_b32_dpp v119, v115 wave_ror:1 row_mask:0xf bank_mask:0xf
    v_mov_b32_dpp v116, v120 wave_shr:1 row_mask:0xf bank_mask:0xf
    v_mov_b32_dpp v117, v121 wave_shr:1 row_mask:0xf bank_mask:0xf
    v_mov_b32_dpp v118, v122 wave_shr:1 row_mask:0xf bank_mask:0xf
    v_mov_b32_dpp v119, v123 wave_shr:1 row_mask:0xf bank_mask:0xf
    ds_write_b128 v130, v[118:121] offset:15472
    v_alignbit_b32 v134, v117, v116, 16
    v_alignbit_b32 v135, v118, v117, 16
    v_alignbit_b32 v136, v119, v118, 16
    v_alignbit_b32 v137, v120, v119, 16
    v_alignbit_b32 v138, v121, v120, 16
    v_alignbit_b32 v139, v122, v121, 16
    ds_write_b128 v130, v[134:137] offset:3088
    v_mov_b32 v148, v117
    v_mov_b32 v149, v118
    v_mov_b32 v150, v119
    v_mov_b32 v151, v120
    v_mov_b32 v152, v121
    v_mov_b32 v153, v122
    ds_write_b128 v130, v[136:139] offset:19600
    ds_write_b128 v130, v[148:151] offset:7216
    v_alignbit_b32 v142, v118, v117, 16
    v_alignbit_b32 v143, v119, v118, 16
    v_alignbit_b32 v144, v120, v119, 16
    v_alignbit_b32 v145, v121, v120, 16
    v_alignbit_b32 v146, v122, v121, 16
    v_alignbit_b32 v147, v123, v122, 16
    ds_write_b128 v130, v[150:153] offset:23728
    ds_write_b128 v130, v[142:145] offset:11344
    ds_write_b128 v130, v[144:147] offset:27856
    v_mov_b32 v180, 0
    v_mov_b32 v181, 0
    v_mov_b32 v182, 0
    v_mov_b32 v183, 0
    ds_write_b128 v132, v[180:183]
    v_and_b32 v3, 1, v131
    v_lshlrev_b32 v3, 4, v3
    v_lshlrev_b32 v5, v3, v5
    v_ashrrev_i32 v131, 1, v131
    v_cmp_eq_u32 vcc, 0, v131
    s_nop 1
    v_cndmask_b32 v20, 0, v5, vcc
    v_cmp_eq_u32 vcc, 1, v131
    s_nop 1
    v_cndmask_b32 v21, 0, v5, vcc
    v_cmp_eq_u32 vcc, 2, v131
    s_nop 1
    v_cndmask_b32 v22, 0, v5, vcc
    v_cmp_eq_u32 vcc, 3, v131
    s_nop 1
    v_cndmask_b32 v23, 0, v5, vcc
    ds_read_b128 v[72:75], v6 offset:3584
    ds_read_b128 v[68:71], v6 offset:3072
    ds_read_b128 v[64:67], v6 offset:2560
    ds_read_b128 v[60:63], v6 offset:2048
    ds_read_b128 v[56:59], v6 offset:1536
    ds_read_b128 v[52:55], v6 offset:1024
    ds_read_b128 v[48:51], v6 offset:512
    ds_read_b128 v[44:47], v6 offset:0
    s_mov_b32 s49, 65536
L_adaL_poll_6:
    s_waitcnt vmcnt(0)
    v_cmp_ne_u32 vcc, s48, v14
    s_nop 0
    s_cbranch_vccz L_adaL_got_7
    buffer_load_dword v14, v10, s[4:7], s58 offen sc1
    s_waitcnt vmcnt(0)
    s_sub_u32 s49, s49, 1
    s_cmp_lg_u32 s49, 0
    s_cbranch_scc1 L_adaL_poll_6
L_adaL_got_7:
    s_mov_b32 s61, 1048576
    s_add_u32 m0, s57, 256
    s_nop 0
    buffer_load_dwordx4 v4, s[4:7], s61 offen offset:0 sc1 lds
    buffer_load_dwordx4 v4, s[4:7], s61 offen offset:1024 sc1 lds
    s_add_u32 m0, s57, 512
    s_nop 0
    buffer_load_dwordx4 v4, s[4:7], s61 offen offset:2048 sc1 lds
    buffer_load_dwordx4 v4, s[4:7], s61 offen offset:3072 sc1 lds
    s_lshl_b32 s61, s2, 14
    s_add_u32 s68, s61, 3670016
    s_add_u32 s64, s61, 6291456
    s_add_u32 s69, s61, 3674112
    s_add_u32 s65, s61, 6295552
    s_add_u32 s70, s61, 3678208
    s_add_u32 s66, s61, 6299648
    s_add_u32 s71, s61, 3682304
    s_add_u32 s67, s61, 6303744
    s_and_b32 s62, s2, 7
    s_cmp_lg_u32 s54, 0
    s_cselect_b32 s61, 0, 393216
    s_sub_u32 s63, s63, s61
    s_sub_u32 s58, s58, 393216
    v_mov_b32 v24, v10
    v_lshrrev_b32 v2, 2, v1
    v_min_u32 v2, 2, v2
    v_mul_u32_u24 v2, 5120, v2
    v_and_b32 v3, 3, v1
    v_lshl_add_u32 v2, v3, 3, v2
    s_lshl_b32 s61, s2, 5
    s_add_u32 s61, s61, 32768
    v_add_u32 v25, s61, v2
    s_lshl_b32 s62, s62, 8
    s_add_u32 s62, s62, 180224
    v_and_b32 v2, 31, v1
    v_lshl_add_u32 v10, v2, 3, s62
    v_bfe_u32 v2, v0, 4, 1
    v_bfe_u32 v3, v0, 5, 1
    v_lshl_add_u32 v2, v3, 2, v2
    v_lshlrev_b32 v2, 1, v2
    v_xor_b32 v2, v0, v2
    v_lshlrev_b32 v228, 3, v2
    v_add_u32 v229, 66048, v228
    s_lshr_b32 s60, s2, 3
    s_mul_i32 s60, s60, 8192
    s_and_b32 s61, s2, 7
    s_lshl_b32 s61, s61, 20
    s_add_u32 s60, s60, s61
    s_add_u32 s60, s60, 884736
    v_lshlrev_b32 v230, 5, v0
    s_barrier
    s_mov_b64 exec, 65535
    buffer_store_dword v12, v27, s[4:7], s63 offen sc1
    s_mov_b64 exec, -1
    v_lshrrev_b32 v240, 6, v0
    s_nop 0
    v_readfirstlane_b32 s82, v240
    s_bfe_u32 s87, s2, 0x30003
    s_and_b32 s83, s2, 6
    s_lshl_b32 s83, s83, 2
    s_add_u32 s83, s83, s87
    s_lshr_b32 s87, s2, 6
    s_and_b32 s84, s2, 1
    s_lshl_b32 s84, s84, 2
    s_add_u32 s84, s84, s87
    v_and_b32 v240, 63, v0
    v_lshlrev_b32 v241, 4, v240
    s_add_u32 s87, s82, 1
    s_lshl_b32 s87, s87, 29
    s_and_b32 s87, s87, 2147483648
    s_or_b32 s87, s87, 20480
    v_add_u32 v242, s87, v241
    s_mul_i32 s85, s84, 286720
    s_mul_i32 s87, s82, 40960
    s_add_u32 s85, s85, s87
    s_add_u32 s85, s85, 9056256
    s_and_b32 s86, s2, 7
    s_mul_i32 s86, s86, 3840
    s_mul_i32 s87, s84, 384
    s_add_u32 s86, s86, s87
    s_add_u32 s86, s86, 65536
    v_min_u32 v243, 9, v240
    v_lshlrev_b32 v243, 5, v243
    v_lshrrev_b32 v246, 3, v240
    v_lshlrev_b32 v245, 13, v246
    v_lshrrev_b32 v246, 4, v240
    v_and_b32 v247, 7, v0
    v_xor_b32 v246, v246, v247
    v_lshl_add_u32 v245, v246, 4, v245
    s_mul_i32 s87, s84, 0
    v_add_u32 v245, s87, v245
    v_xor_b32 v246, 64, v245
    v_add_u32 v246, 65536, v246
    s_lshl_b32 s88, s83, 18
    s_lshl_b32 s87, s82, 10
    s_add_u32 s88, s88, s87
    s_add_u32 s89, s88, 4096
    s_add_u32 s90, s88, 131072
    s_add_u32 s91, s88, 135168
    s_movk_i32 s40, 0x380
    s_waitcnt vmcnt(1) lgkmcnt(0)
    ds_read_b128 v[76:79], v7 offset:224
    ds_read_b128 v[80:83], v7 offset:480
    ds_read_b128 v[84:87], v7 offset:736
    ds_read_b128 v[88:91], v7 offset:992
    ds_read_b128 v[92:95], v7 offset:1248
    ds_read_b128 v[96:99], v7 offset:1504
    ds_read_b128 v[100:103], v7 offset:1760
    ds_read_b128 v[104:107], v7 offset:2016
    s_waitcnt lgkmcnt(7)
    v_mfma_f32_16x16x32_bf16 v[140:143], v[20:23], v[76:79], 0
    s_waitcnt lgkmcnt(6)
    v_mfma_f32_16x16x32_bf16 v[144:147], v[20:23], v[80:83], 0
    s_waitcnt lgkmcnt(5)
    v_mfma_f32_16x16x32_bf16 v[148:151], v[20:23], v[84:87], 0
    s_waitcnt lgkmcnt(4)
    v_mfma_f32_16x16x32_bf16 v[152:155], v[20:23], v[88:91], 0
    s_waitcnt lgkmcnt(3)
    v_mfma_f32_16x16x32_bf16 v[156:159], v[20:23], v[92:95], 0
    s_waitcnt lgkmcnt(2)
    v_mfma_f32_16x16x32_bf16 v[160:163], v[20:23], v[96:99], 0
    s_waitcnt lgkmcnt(0)
    v_mfma_f32_16x16x32_bf16 v[164:167], v[20:23], v[100:103], 0
    v_mfma_f32_16x16x32_bf16 v[168:171], v[20:23], v[104:107], 0
    v_mfma_f32_16x16x32_bf16 v[168:171], v[72:75], v[76:79], v[168:171]
    ds_read_b128 v[72:75], v6 offset:3648
    s_mul_i32 s78, s2, 52429
    v_mfma_f32_16x16x32_bf16 v[164:167], v[68:71], v[76:79], v[164:167]
    buffer_load_dword v2, v230, s[32:35], s60 offen
    s_add_u32 s60, s60, 8192
    s_lshr_b32 s78, s78, 18
    v_mfma_f32_16x16x32_bf16 v[168:171], v[68:71], v[80:83], v[168:171]
    ds_read_b128 v[68:71], v6 offset:3136
    s_lshr_b32 s79, s78, 1
    v_mfma_f32_16x16x32_bf16 v[160:163], v[64:67], v[76:79], v[160:163]
    s_mul_i32 s79, s79, 44
    s_lshl_b32 s80, s78, 5
    s_add_u32 s79, s79, s80
    v_mfma_f32_16x16x32_bf16 v[164:167], v[64:67], v[80:83], v[164:167]
    ds_read_b128 v[108:111], v7 offset:192
    s_mul_i32 s80, s78, 108
    v_mfma_f32_16x16x32_bf16 v[168:171], v[64:67], v[84:87], v[168:171]
    ds_read_b128 v[64:67], v6 offset:2624
    s_sub_u32 s80, s80, 1664
    v_mfma_f32_16x16x32_bf16 v[156:159], v[60:63], v[76:79], v[156:159]
    s_cmp_ge_u32 s78, 16
    s_cselect_b32 s79, s80, s79
    s_lshl_b32 s80, s54, 3
    v_mfma_f32_16x16x32_bf16 v[160:163], v[60:63], v[80:83], v[160:163]
    s_add_u32 s79, s79, s80
    s_mul_i32 s80, s78, 216
    s_and_b32 s81, s54, 1
    v_mfma_f32_16x16x32_bf16 v[164:167], v[60:63], v[84:87], v[164:167]
    ds_read_b128 v[112:115], v7 offset:448
    s_lshl_b32 s81, s81, 3
    v_mfma_f32_16x16x32_bf16 v[168:171], v[60:63], v[88:91], v[168:171]
    ds_read_b128 v[60:63], v6 offset:2112
    s_add_u32 s80, s80, s81
    v_mfma_f32_16x16x32_bf16 v[152:155], v[56:59], v[76:79], v[152:155]
    s_lshr_b32 s81, s54, 1
    s_add_u32 s80, s80, s81
    s_sub_u32 s80, s80, 5088
    v_mfma_f32_16x16x32_bf16 v[156:159], v[56:59], v[80:83], v[156:159]
    s_cmp_ge_u32 s78, 24
    s_cselect_b32 s72, s80, s79
    s_cselect_b32 s73, 129280, 0
    s_cselect_b32 s81, 1280, 0
    v_mfma_f32_16x16x32_bf16 v[160:163], v[56:59], v[84:87], v[160:163]
    ds_read_b128 v[116:119], v7 offset:704
    s_add_u32 s73, s73, 1280
    v_mfma_f32_16x16x32_bf16 v[164:167], v[56:59], v[88:91], v[164:167]
    s_add_u32 s81, s81, 1280
    s_mul_i32 s72, s72, 1280
    s_mul_i32 s79, s78, 5
    v_mfma_f32_16x16x32_bf16 v[168:171], v[56:59], v[92:95], v[168:171]
    ds_read_b128 v[56:59], v6 offset:1600
    s_sub_u32 s79, s2, s79
    v_mfma_f32_16x16x32_bf16 v[148:151], v[52:55], v[76:79], v[148:151]
    s_lshl_b32 s79, s79, 6
    v_add_u32 v196, s79, v1
    v_lshlrev_b32 v197, 2, v196
    v_mfma_f32_16x16x32_bf16 v[152:155], v[52:55], v[80:83], v[152:155]
    ds_read_b128 v[120:123], v7 offset:960
    v_mfma_f32_16x16x32_bf16 v[156:159], v[52:55], v[84:87], v[156:159]
    buffer_load_dword v200, v197, s[36:39], s72 offen
    s_add_u32 s72, s72, s81
    v_mfma_f32_16x16x32_bf16 v[160:163], v[52:55], v[88:91], v[160:163]
    buffer_load_dword v201, v197, s[36:39], s72 offen
    s_add_u32 s72, s72, s81
    v_mfma_f32_16x16x32_bf16 v[164:167], v[52:55], v[92:95], v[164:167]
    ds_read_b128 v[124:127], v7 offset:1216
    v_mfma_f32_16x16x32_bf16 v[168:171], v[52:55], v[96:99], v[168:171]
    ds_read_b128 v[52:55], v6 offset:1088
    v_mfma_f32_16x16x32_bf16 v[144:147], v[48:51], v[76:79], v[144:147]
    buffer_load_dword v202, v197, s[36:39], s72 offen
    s_add_u32 s72, s72, s81
    v_mfma_f32_16x16x32_bf16 v[148:151], v[48:51], v[80:83], v[148:151]
    buffer_load_dword v203, v197, s[36:39], s72 offen
    s_add_u32 s72, s72, s73
    v_mfma_f32_16x16x32_bf16 v[152:155], v[48:51], v[84:87], v[152:155]
    ds_read_b128 v[128:131], v7 offset:1472
    v_mfma_f32_16x16x32_bf16 v[156:159], v[48:51], v[88:91], v[156:159]
    buffer_load_dword v204, v197, s[36:39], s72 offen
    s_add_u32 s72, s72, s81
    v_mfma_f32_16x16x32_bf16 v[160:163], v[48:51], v[92:95], v[160:163]
    buffer_load_dword v205, v197, s[36:39], s72 offen
    s_add_u32 s72, s72, s81
    v_mfma_f32_16x16x32_bf16 v[164:167], v[48:51], v[96:99], v[164:167]
    ds_read_b128 v[132:135], v7 offset:1728
    v_mfma_f32_16x16x32_bf16 v[168:171], v[48:51], v[100:103], v[168:171]
    ds_read_b128 v[48:51], v6 offset:576
    v_mfma_f32_16x16x32_bf16 v[140:143], v[44:47], v[76:79], v[140:143]
    buffer_load_dword v206, v197, s[36:39], s72 offen
    s_add_u32 s72, s72, s81
    v_mfma_f32_16x16x32_bf16 v[144:147], v[44:47], v[80:83], v[144:147]
    buffer_load_dword v207, v197, s[36:39], s72 offen
    v_mfma_f32_16x16x32_bf16 v[148:151], v[44:47], v[84:87], v[148:151]
    ds_read_b128 v[136:139], v7 offset:1984
    v_mfma_f32_16x16x32_bf16 v[152:155], v[44:47], v[88:91], v[152:155]
    v_mfma_f32_16x16x32_bf16 v[156:159], v[44:47], v[92:95], v[156:159]
    v_mfma_f32_16x16x32_bf16 v[160:163], v[44:47], v[96:99], v[160:163]
    v_mfma_f32_16x16x32_bf16 v[164:167], v[44:47], v[100:103], v[164:167]
    v_mfma_f32_16x16x32_bf16 v[168:171], v[44:47], v[104:107], v[168:171]
    ds_read_b128 v[44:47], v6 offset:64
    s_waitcnt lgkmcnt(2)
    v_mfma_f32_16x16x32_bf16 v[168:171], v[72:75], v[108:111], v[168:171]
    ds_read_b128 v[72:75], v6 offset:3712
    v_mfma_f32_16x16x32_bf16 v[164:167], v[68:71], v[108:111], v[164:167]
    v_mfma_f32_16x16x32_bf16 v[168:171], v[68:71], v[112:115], v[168:171]
    ds_read_b128 v[68:71], v6 offset:3200
    v_mfma_f32_16x16x32_bf16 v[160:163], v[64:67], v[108:111], v[160:163]
    v_mfma_f32_16x16x32_bf16 v[164:167], v[64:67], v[112:115], v[164:167]
    ds_read_b128 v[76:79], v7 offset:160
    v_mfma_f32_16x16x32_bf16 v[168:171], v[64:67], v[116:119], v[168:171]
    ds_read_b128 v[64:67], v6 offset:2688
    v_mfma_f32_16x16x32_bf16 v[156:159], v[60:63], v[108:111], v[156:159]
    v_mfma_f32_16x16x32_bf16 v[160:163], v[60:63], v[112:115], v[160:163]
    v_mfma_f32_16x16x32_bf16 v[164:167], v[60:63], v[116:119], v[164:167]
    ds_read_b128 v[80:83], v7 offset:416
    v_mfma_f32_16x16x32_bf16 v[168:171], v[60:63], v[120:123], v[168:171]
    ds_read_b128 v[60:63], v6 offset:2176
    v_mfma_f32_16x16x32_bf16 v[152:155], v[56:59], v[108:111], v[152:155]
    v_mfma_f32_16x16x32_bf16 v[156:159], v[56:59], v[112:115], v[156:159]
    v_mfma_f32_16x16x32_bf16 v[160:163], v[56:59], v[116:119], v[160:163]
    ds_read_b128 v[84:87], v7 offset:672
    v_mfma_f32_16x16x32_bf16 v[164:167], v[56:59], v[120:123], v[164:167]
    v_mfma_f32_16x16x32_bf16 v[168:171], v[56:59], v[124:127], v[168:171]
    ds_read_b128 v[56:59], v6 offset:1664
    v_mfma_f32_16x16x32_bf16 v[148:151], v[52:55], v[108:111], v[148:151]
    v_mfma_f32_16x16x32_bf16 v[152:155], v[52:55], v[112:115], v[152:155]
    ds_read_b128 v[88:91], v7 offset:928
    v_mfma_f32_16x16x32_bf16 v[156:159], v[52:55], v[116:119], v[156:159]
    v_mfma_f32_16x16x32_bf16 v[160:163], v[52:55], v[120:123], v[160:163]
    v_mfma_f32_16x16x32_bf16 v[164:167], v[52:55], v[124:127], v[164:167]
    ds_read_b128 v[92:95], v7 offset:1184
    v_mfma_f32_16x16x32_bf16 v[168:171], v[52:55], v[128:131], v[168:171]
    ds_read_b128 v[52:55], v6 offset:1152
    v_mfma_f32_16x16x32_bf16 v[144:147], v[48:51], v[108:111], v[144:147]
    v_mfma_f32_16x16x32_bf16 v[148:151], v[48:51], v[112:115], v[148:151]
    v_mfma_f32_16x16x32_bf16 v[152:155], v[48:51], v[116:119], v[152:155]
    ds_read_b128 v[96:99], v7 offset:1440
    v_mfma_f32_16x16x32_bf16 v[156:159], v[48:51], v[120:123], v[156:159]
    v_mfma_f32_16x16x32_bf16 v[160:163], v[48:51], v[124:127], v[160:163]
    v_mfma_f32_16x16x32_bf16 v[164:167], v[48:51], v[128:131], v[164:167]
    ds_read_b128 v[100:103], v7 offset:1696
    v_mfma_f32_16x16x32_bf16 v[168:171], v[48:51], v[132:135], v[168:171]
    ds_read_b128 v[48:51], v6 offset:640
    s_waitcnt lgkmcnt(3)
    v_mfma_f32_16x16x32_bf16 v[140:143], v[44:47], v[108:111], v[140:143]
    v_mfma_f32_16x16x32_bf16 v[144:147], v[44:47], v[112:115], v[144:147]
    v_mfma_f32_16x16x32_bf16 v[148:151], v[44:47], v[116:119], v[148:151]
    ds_read_b128 v[104:107], v7 offset:1952
    v_mfma_f32_16x16x32_bf16 v[152:155], v[44:47], v[120:123], v[152:155]
    v_mfma_f32_16x16x32_bf16 v[156:159], v[44:47], v[124:127], v[156:159]
    v_mfma_f32_16x16x32_bf16 v[160:163], v[44:47], v[128:131], v[160:163]
    v_mfma_f32_16x16x32_bf16 v[164:167], v[44:47], v[132:135], v[164:167]
    v_mfma_f32_16x16x32_bf16 v[168:171], v[44:47], v[136:139], v[168:171]
    ds_read_b128 v[44:47], v6 offset:128
    buffer_load_dwordx2 v[14:15], v10, s[4:7], 0 offen sc1
    buffer_load_dword v16, v24, s[4:7], s58 offen sc1
    v_mfma_f32_16x16x32_bf16 v[168:171], v[72:75], v[76:79], v[168:171]
    ds_read_b128 v[72:75], v6 offset:3776
    v_mfma_f32_16x16x32_bf16 v[164:167], v[68:71], v[76:79], v[164:167]
    v_mfma_f32_16x16x32_bf16 v[168:171], v[68:71], v[80:83], v[168:171]
    ds_read_b128 v[68:71], v6 offset:3264
    v_mfma_f32_16x16x32_bf16 v[160:163], v[64:67], v[76:79], v[160:163]
    v_mfma_f32_16x16x32_bf16 v[164:167], v[64:67], v[80:83], v[164:167]
    ds_read_b128 v[108:111], v7 offset:128
    v_mfma_f32_16x16x32_bf16 v[168:171], v[64:67], v[84:87], v[168:171]
    ds_read_b128 v[64:67], v6 offset:2752
    v_mfma_f32_16x16x32_bf16 v[156:159], v[60:63], v[76:79], v[156:159]
    v_mfma_f32_16x16x32_bf16 v[160:163], v[60:63], v[80:83], v[160:163]
    v_mfma_f32_16x16x32_bf16 v[164:167], v[60:63], v[84:87], v[164:167]
    ds_read_b128 v[112:115], v7 offset:384
    v_mfma_f32_16x16x32_bf16 v[168:171], v[60:63], v[88:91], v[168:171]
    ds_read_b128 v[60:63], v6 offset:2240
    v_mfma_f32_16x16x32_bf16 v[152:155], v[56:59], v[76:79], v[152:155]
    v_mfma_f32_16x16x32_bf16 v[156:159], v[56:59], v[80:83], v[156:159]
    v_mfma_f32_16x16x32_bf16 v[160:163], v[56:59], v[84:87], v[160:163]
    ds_read_b128 v[116:119], v7 offset:640
    v_mfma_f32_16x16x32_bf16 v[164:167], v[56:59], v[88:91], v[164:167]
    v_mfma_f32_16x16x32_bf16 v[168:171], v[56:59], v[92:95], v[168:171]
    ds_read_b128 v[56:59], v6 offset:1728
    v_mfma_f32_16x16x32_bf16 v[148:151], v[52:55], v[76:79], v[148:151]
    v_mfma_f32_16x16x32_bf16 v[152:155], v[52:55], v[80:83], v[152:155]
    ds_read_b128 v[120:123], v7 offset:896
    v_mfma_f32_16x16x32_bf16 v[156:159], v[52:55], v[84:87], v[156:159]
    v_mfma_f32_16x16x32_bf16 v[160:163], v[52:55], v[88:91], v[160:163]
    v_mfma_f32_16x16x32_bf16 v[164:167], v[52:55], v[92:95], v[164:167]
    ds_read_b128 v[124:127], v7 offset:1152
    s_waitcnt lgkmcnt(3)
    v_mfma_f32_16x16x32_bf16 v[168:171], v[52:55], v[96:99], v[168:171]
    ds_read_b128 v[52:55], v6 offset:1216
    v_mfma_f32_16x16x32_bf16 v[144:147], v[48:51], v[76:79], v[144:147]
    v_mfma_f32_16x16x32_bf16 v[148:151], v[48:51], v[80:83], v[148:151]
    v_mfma_f32_16x16x32_bf16 v[152:155], v[48:51], v[84:87], v[152:155]
    ds_read_b128 v[128:131], v7 offset:1408
    v_mfma_f32_16x16x32_bf16 v[156:159], v[48:51], v[88:91], v[156:159]
    v_mfma_f32_16x16x32_bf16 v[160:163], v[48:51], v[92:95], v[160:163]
    v_mfma_f32_16x16x32_bf16 v[164:167], v[48:51], v[96:99], v[164:167]
    ds_read_b128 v[132:135], v7 offset:1664
    v_mfma_f32_16x16x32_bf16 v[168:171], v[48:51], v[100:103], v[168:171]
    ds_read_b128 v[48:51], v6 offset:704
    v_mfma_f32_16x16x32_bf16 v[140:143], v[44:47], v[76:79], v[140:143]
    v_mfma_f32_16x16x32_bf16 v[144:147], v[44:47], v[80:83], v[144:147]
    v_mfma_f32_16x16x32_bf16 v[148:151], v[44:47], v[84:87], v[148:151]
    ds_read_b128 v[136:139], v7 offset:1920
    v_mfma_f32_16x16x32_bf16 v[152:155], v[44:47], v[88:91], v[152:155]
    v_mfma_f32_16x16x32_bf16 v[156:159], v[44:47], v[92:95], v[156:159]
    v_mfma_f32_16x16x32_bf16 v[160:163], v[44:47], v[96:99], v[160:163]
    v_mfma_f32_16x16x32_bf16 v[164:167], v[44:47], v[100:103], v[164:167]
    v_mfma_f32_16x16x32_bf16 v[168:171], v[44:47], v[104:107], v[168:171]
    ds_read_b128 v[44:47], v6 offset:192
    v_mfma_f32_16x16x32_bf16 v[168:171], v[72:75], v[108:111], v[168:171]
    ds_read_b128 v[72:75], v6 offset:3840
    v_mfma_f32_16x16x32_bf16 v[164:167], v[68:71], v[108:111], v[164:167]
    v_mfma_f32_16x16x32_bf16 v[168:171], v[68:71], v[112:115], v[168:171]
    ds_read_b128 v[68:71], v6 offset:3328
    v_mfma_f32_16x16x32_bf16 v[160:163], v[64:67], v[108:111], v[160:163]
    v_mfma_f32_16x16x32_bf16 v[164:167], v[64:67], v[112:115], v[164:167]
    ds_read_b128 v[76:79], v7 offset:96
    v_mfma_f32_16x16x32_bf16 v[168:171], v[64:67], v[116:119], v[168:171]
    ds_read_b128 v[64:67], v6 offset:2816
    v_mfma_f32_16x16x32_bf16 v[156:159], v[60:63], v[108:111], v[156:159]
    v_mfma_f32_16x16x32_bf16 v[160:163], v[60:63], v[112:115], v[160:163]
    v_mfma_f32_16x16x32_bf16 v[164:167], v[60:63], v[116:119], v[164:167]
    ds_read_b128 v[80:83], v7 offset:352
    s_waitcnt lgkmcnt(3)
    v_mfma_f32_16x16x32_bf16 v[168:171], v[60:63], v[120:123], v[168:171]
    ds_read_b128 v[60:63], v6 offset:2304
    v_mfma_f32_16x16x32_bf16 v[152:155], v[56:59], v[108:111], v[152:155]
    v_mfma_f32_16x16x32_bf16 v[156:159], v[56:59], v[112:115], v[156:159]
    v_mfma_f32_16x16x32_bf16 v[160:163], v[56:59], v[116:119], v[160:163]
    ds_read_b128 v[84:87], v7 offset:608
    v_mfma_f32_16x16x32_bf16 v[164:167], v[56:59], v[120:123], v[164:167]
    v_mfma_f32_16x16x32_bf16 v[168:171], v[56:59], v[124:127], v[168:171]
    ds_read_b128 v[56:59], v6 offset:1792
    v_mfma_f32_16x16x32_bf16 v[148:151], v[52:55], v[108:111], v[148:151]
    v_mfma_f32_16x16x32_bf16 v[152:155], v[52:55], v[112:115], v[152:155]
    ds_read_b128 v[88:91], v7 offset:864
    v_mfma_f32_16x16x32_bf16 v[156:159], v[52:55], v[116:119], v[156:159]
    v_mfma_f32_16x16x32_bf16 v[160:163], v[52:55], v[120:123], v[160:163]
    v_mfma_f32_16x16x32_bf16 v[164:167], v[52:55], v[124:127], v[164:167]
    ds_read_b128 v[92:95], v7 offset:1120
    v_mfma_f32_16x16x32_bf16 v[168:171], v[52:55], v[128:131], v[168:171]
    ds_read_b128 v[52:55], v6 offset:1280
    v_mfma_f32_16x16x32_bf16 v[144:147], v[48:51], v[108:111], v[144:147]
    v_mfma_f32_16x16x32_bf16 v[148:151], v[48:51], v[112:115], v[148:151]
    v_mfma_f32_16x16x32_bf16 v[152:155], v[48:51], v[116:119], v[152:155]
    ds_read_b128 v[96:99], v7 offset:1376
    v_mfma_f32_16x16x32_bf16 v[156:159], v[48:51], v[120:123], v[156:159]
    v_mfma_f32_16x16x32_bf16 v[160:163], v[48:51], v[124:127], v[160:163]
    v_mfma_f32_16x16x32_bf16 v[164:167], v[48:51], v[128:131], v[164:167]
    ds_read_b128 v[100:103], v7 offset:1632
    v_mfma_f32_16x16x32_bf16 v[168:171], v[48:51], v[132:135], v[168:171]
    ds_read_b128 v[48:51], v6 offset:768
    v_mfma_f32_16x16x32_bf16 v[140:143], v[44:47], v[108:111], v[140:143]
    v_mfma_f32_16x16x32_bf16 v[144:147], v[44:47], v[112:115], v[144:147]
    v_mfma_f32_16x16x32_bf16 v[148:151], v[44:47], v[116:119], v[148:151]
    ds_read_b128 v[104:107], v7 offset:1888
    v_mfma_f32_16x16x32_bf16 v[152:155], v[44:47], v[120:123], v[152:155]
    v_mfma_f32_16x16x32_bf16 v[156:159], v[44:47], v[124:127], v[156:159]
    v_mfma_f32_16x16x32_bf16 v[160:163], v[44:47], v[128:131], v[160:163]
    v_mfma_f32_16x16x32_bf16 v[164:167], v[44:47], v[132:135], v[164:167]
    v_mfma_f32_16x16x32_bf16 v[168:171], v[44:47], v[136:139], v[168:171]
    ds_read_b128 v[44:47], v6 offset:256
    s_mov_b32 s49, 65536
L_adaL_poll_8:
    s_waitcnt vmcnt(1) lgkmcnt(2)
    v_cmp_ne_u32 vcc, s48, v15
    s_waitcnt vmcnt(0)
    v_cmp_ne_u32 s[50:51], s48, v16
    s_nop 0
    s_or_b64 vcc, vcc, s[50:51]
    s_cbranch_vccz L_adaL_got_9
    buffer_load_dwordx2 v[14:15], v10, s[4:7], 0 offen sc1
    buffer_load_dword v16, v24, s[4:7], s58 offen sc1
    s_waitcnt vmcnt(0)
    s_sub_u32 s49, s49, 1
    s_cmp_lg_u32 s49, 0
    s_cbranch_scc1 L_adaL_poll_8
L_adaL_got_9:
    v_mfma_f32_16x16x32_bf16 v[168:171], v[72:75], v[76:79], v[168:171]
    ds_read_b128 v[72:75], v6 offset:3904
    v_mfma_f32_16x16x32_bf16 v[164:167], v[68:71], v[76:79], v[164:167]
    buffer_load_dwordx4 v[28:31], v9, s[4:7], s68 offen sc1
    v_mfma_f32_16x16x32_bf16 v[168:171], v[68:71], v[80:83], v[168:171]
    ds_read_b128 v[68:71], v6 offset:3392
    v_mfma_f32_16x16x32_bf16 v[160:163], v[64:67], v[76:79], v[160:163]
    buffer_load_dwordx4 v[32:35], v9, s[4:7], s69 offen sc1
    v_mfma_f32_16x16x32_bf16 v[164:167], v[64:67], v[80:83], v[164:167]
    ds_read_b128 v[108:111], v7 offset:64
    v_mfma_f32_16x16x32_bf16 v[168:171], v[64:67], v[84:87], v[168:171]
    ds_read_b128 v[64:67], v6 offset:2880
    v_mfma_f32_16x16x32_bf16 v[156:159], v[60:63], v[76:79], v[156:159]
    buffer_load_dwordx4 v[36:39], v9, s[4:7], s70 offen sc1
    v_mfma_f32_16x16x32_bf16 v[160:163], v[60:63], v[80:83], v[160:163]
    buffer_load_dwordx4 v[40:43], v9, s[4:7], s71 offen sc1
    s_mov_b32 s61, 16384
    v_mfma_f32_16x16x32_bf16 v[164:167], v[60:63], v[84:87], v[164:167]
    ds_read_b128 v[112:115], v7 offset:320
    v_mfma_f32_16x16x32_bf16 v[168:171], v[60:63], v[88:91], v[168:171]
    ds_read_b128 v[60:63], v6 offset:2368
    v_mfma_f32_16x16x32_bf16 v[152:155], v[56:59], v[76:79], v[152:155]
    buffer_load_dwordx4 v[172:175], v9, s[4:7], s61 offen sc1
    s_add_u32 s61, s61, 4096
    v_mfma_f32_16x16x32_bf16 v[156:159], v[56:59], v[80:83], v[156:159]
    buffer_load_dwordx4 v[176:179], v9, s[4:7], s61 offen sc1
    s_add_u32 s61, s61, 4096
    v_mfma_f32_16x16x32_bf16 v[160:163], v[56:59], v[84:87], v[160:163]
    ds_read_b128 v[116:119], v7 offset:576
    v_mfma_f32_16x16x32_bf16 v[164:167], v[56:59], v[88:91], v[164:167]
    buffer_load_dwordx4 v[180:183], v9, s[4:7], s61 offen sc1
    s_add_u32 s61, s61, 4096
    v_mfma_f32_16x16x32_bf16 v[168:171], v[56:59], v[92:95], v[168:171]
    ds_read_b128 v[56:59], v6 offset:1856
    v_mfma_f32_16x16x32_bf16 v[148:151], v[52:55], v[76:79], v[148:151]
    buffer_load_dwordx4 v[184:187], v9, s[4:7], s61 offen sc1
    s_add_u32 s61, s61, 4096
    v_mfma_f32_16x16x32_bf16 v[152:155], v[52:55], v[80:83], v[152:155]
    ds_read_b128 v[120:123], v7 offset:832
    v_mfma_f32_16x16x32_bf16 v[156:159], v[52:55], v[84:87], v[156:159]
    v_mfma_f32_16x16x32_bf16 v[160:163], v[52:55], v[88:91], v[160:163]
    v_mfma_f32_16x16x32_bf16 v[164:167], v[52:55], v[92:95], v[164:167]
    ds_read_b128 v[124:127], v7 offset:1088
    v_mfma_f32_16x16x32_bf16 v[168:171], v[52:55], v[96:99], v[168:171]
    ds_read_b128 v[52:55], v6 offset:1344
    v_mfma_f32_16x16x32_bf16 v[144:147], v[48:51], v[76:79], v[144:147]
    v_mfma_f32_16x16x32_bf16 v[148:151], v[48:51], v[80:83], v[148:151]
    v_mfma_f32_16x16x32_bf16 v[152:155], v[48:51], v[84:87], v[152:155]
    ds_read_b128 v[128:131], v7 offset:1344
    v_mfma_f32_16x16x32_bf16 v[156:159], v[48:51], v[88:91], v[156:159]
    v_mfma_f32_16x16x32_bf16 v[160:163], v[48:51], v[92:95], v[160:163]
    v_mfma_f32_16x16x32_bf16 v[164:167], v[48:51], v[96:99], v[164:167]
    ds_read_b128 v[132:135], v7 offset:1600
    v_mfma_f32_16x16x32_bf16 v[168:171], v[48:51], v[100:103], v[168:171]
    ds_read_b128 v[48:51], v6 offset:832
    s_waitcnt lgkmcnt(3)
    v_mfma_f32_16x16x32_bf16 v[140:143], v[44:47], v[76:79], v[140:143]
    v_mfma_f32_16x16x32_bf16 v[144:147], v[44:47], v[80:83], v[144:147]
    v_mfma_f32_16x16x32_bf16 v[148:151], v[44:47], v[84:87], v[148:151]
    ds_read_b128 v[136:139], v7 offset:1856
    v_mfma_f32_16x16x32_bf16 v[152:155], v[44:47], v[88:91], v[152:155]
    v_mfma_f32_16x16x32_bf16 v[156:159], v[44:47], v[92:95], v[156:159]
    v_mfma_f32_16x16x32_bf16 v[160:163], v[44:47], v[96:99], v[160:163]
    v_mfma_f32_16x16x32_bf16 v[164:167], v[44:47], v[100:103], v[164:167]
    v_mfma_f32_16x16x32_bf16 v[168:171], v[44:47], v[104:107], v[168:171]
    ds_read_b128 v[44:47], v6 offset:320
    v_mfma_f32_16x16x32_bf16 v[168:171], v[72:75], v[108:111], v[168:171]
    ds_read_b128 v[72:75], v6 offset:3968
    s_mov_b32 s75, 0x05040100
    v_mfma_f32_16x16x32_bf16 v[164:167], v[68:71], v[108:111], v[164:167]
    s_mov_b32 s76, 0x07060302
    s_mul_i32 s74, s78, 5120
    s_lshl_b32 s79, s54, 8
    v_mfma_f32_16x16x32_bf16 v[168:171], v[68:71], v[112:115], v[168:171]
    ds_read_b128 v[68:71], v6 offset:3456
    s_add_u32 s74, s74, s79
    v_mfma_f32_16x16x32_bf16 v[160:163], v[64:67], v[108:111], v[160:163]
    s_add_u32 s74, s74, 11206656
    s_cmp_ge_u32 s78, 28
    s_cselect_b32 s74, 33554432, s74
    v_mfma_f32_16x16x32_bf16 v[164:167], v[64:67], v[112:115], v[164:167]
    ds_read_b128 v[76:79], v7 offset:32
    v_mul_u32_u24 v197, 1639, v196
    v_mfma_f32_16x16x32_bf16 v[168:171], v[64:67], v[116:119], v[168:171]
    ds_read_b128 v[64:67], v6 offset:2944
    v_lshrrev_b32 v197, 16, v197
    v_mfma_f32_16x16x32_bf16 v[156:159], v[60:63], v[108:111], v[156:159]
    v_mul_u32_u24 v198, 143360, v197
    v_mul_u32_u24 v197, 40, v197
    v_mfma_f32_16x16x32_bf16 v[160:163], v[60:63], v[112:115], v[160:163]
    v_sub_u32 v196, v196, v197
    v_lshrrev_b32 v197, 4, v196
    v_mfma_f32_16x16x32_bf16 v[164:167], v[60:63], v[116:119], v[164:167]
    ds_read_b128 v[80:83], v7 offset:288
    v_lshl_add_u32 v198, v197, 11, v198
    v_mfma_f32_16x16x32_bf16 v[168:171], v[60:63], v[120:123], v[168:171]
    ds_read_b128 v[60:63], v6 offset:2432
    v_cmp_le_u32 vcc, 32, v196
    v_mfma_f32_16x16x32_bf16 v[152:155], v[56:59], v[108:111], v[152:155]
    v_and_b32 v196, 15, v196
    v_mov_b32 v199, 1024
    v_mfma_f32_16x16x32_bf16 v[156:159], v[56:59], v[112:115], v[156:159]
    v_cndmask_b32 v197, 0, v196, vcc
    v_cndmask_b32 v199, v199, 16, vcc
    v_mfma_f32_16x16x32_bf16 v[160:163], v[56:59], v[116:119], v[160:163]
    ds_read_b128 v[84:87], v7 offset:544
    v_add_u32 v196, v196, v197
    v_mfma_f32_16x16x32_bf16 v[164:167], v[56:59], v[120:123], v[164:167]
    v_lshl_add_u32 v198, v196, 4, v198
    v_add_u32 v199, v198, v199
    v_mfma_f32_16x16x32_bf16 v[168:171], v[56:59], v[124:127], v[168:171]
    ds_read_b128 v[56:59], v6 offset:1920
    v_perm_b32 v208, v201, v200, s75
    v_mfma_f32_16x16x32_bf16 v[148:151], v[52:55], v[108:111], v[148:151]
    v_perm_b32 v209, v203, v202, s75
    v_perm_b32 v210, v205, v204, s75
    v_mfma_f32_16x16x32_bf16 v[152:155], v[52:55], v[112:115], v[152:155]
    ds_read_b128 v[88:91], v7 offset:800
    v_perm_b32 v211, v207, v206, s75
    v_mfma_f32_16x16x32_bf16 v[156:159], v[52:55], v[116:119], v[156:159]
    v_perm_b32 v212, v201, v200, s76
    v_perm_b32 v213, v203, v202, s76
    v_mfma_f32_16x16x32_bf16 v[160:163], v[52:55], v[120:123], v[160:163]
    v_perm_b32 v214, v205, v204, s76
    v_perm_b32 v215, v207, v206, s76
    v_mfma_f32_16x16x32_bf16 v[164:167], v[52:55], v[124:127], v[164:167]
    ds_read_b128 v[92:95], v7 offset:1056
    s_waitcnt lgkmcnt(2)
    v_mfma_f32_16x16x32_bf16 v[168:171], v[52:55], v[128:131], v[168:171]
    ds_read_b128 v[52:55], v6 offset:1408
    v_mfma_f32_16x16x32_bf16 v[144:147], v[48:51], v[108:111], v[144:147]
    buffer_store_dwordx4 v[208:211], v198, s[4:7], s74 offen sc1
    v_mfma_f32_16x16x32_bf16 v[148:151], v[48:51], v[112:115], v[148:151]
    buffer_store_dwordx4 v[212:215], v199, s[4:7], s74 offen sc1
    v_mfma_f32_16x16x32_bf16 v[152:155], v[48:51], v[116:119], v[152:155]
    ds_read_b128 v[96:99], v7 offset:1312
    v_mfma_f32_16x16x32_bf16 v[156:159], v[48:51], v[120:123], v[156:159]
    v_mfma_f32_16x16x32_bf16 v[160:163], v[48:51], v[124:127], v[160:163]
    v_mfma_f32_16x16x32_bf16 v[164:167], v[48:51], v[128:131], v[164:167]
    ds_read_b128 v[100:103], v7 offset:1568
    v_mfma_f32_16x16x32_bf16 v[168:171], v[48:51], v[132:135], v[168:171]
    ds_read_b128 v[48:51], v6 offset:896
    v_mfma_f32_16x16x32_bf16 v[140:143], v[44:47], v[108:111], v[140:143]
    v_mfma_f32_16x16x32_bf16 v[144:147], v[44:47], v[112:115], v[144:147]
    v_mfma_f32_16x16x32_bf16 v[148:151], v[44:47], v[116:119], v[148:151]
    ds_read_b128 v[104:107], v7 offset:1824
    v_mfma_f32_16x16x32_bf16 v[152:155], v[44:47], v[120:123], v[152:155]
    v_mfma_f32_16x16x32_bf16 v[156:159], v[44:47], v[124:127], v[156:159]
    v_mfma_f32_16x16x32_bf16 v[160:163], v[44:47], v[128:131], v[160:163]
    v_mfma_f32_16x16x32_bf16 v[164:167], v[44:47], v[132:135], v[164:167]
    v_mfma_f32_16x16x32_bf16 v[168:171], v[44:47], v[136:139], v[168:171]
    ds_read_b128 v[44:47], v6 offset:384
    v_mfma_f32_16x16x32_bf16 v[168:171], v[72:75], v[76:79], v[168:171]
    ds_read_b128 v[72:75], v6 offset:4032
    v_mfma_f32_16x16x32_bf16 v[164:167], v[68:71], v[76:79], v[164:167]
    buffer_load_dwordx2 v[14:15], v25, s[4:7], 0 offen sc1
    v_mfma_f32_16x16x32_bf16 v[168:171], v[68:71], v[80:83], v[168:171]
    ds_read_b128 v[68:71], v6 offset:3520
    v_mfma_f32_16x16x32_bf16 v[160:163], v[64:67], v[76:79], v[160:163]
    v_mfma_f32_16x16x32_bf16 v[164:167], v[64:67], v[80:83], v[164:167]
    ds_read_b128 v[108:111], v7 offset:0
    v_mfma_f32_16x16x32_bf16 v[168:171], v[64:67], v[84:87], v[168:171]
    ds_read_b128 v[64:67], v6 offset:3008
    v_mfma_f32_16x16x32_bf16 v[156:159], v[60:63], v[76:79], v[156:159]
    v_mfma_f32_16x16x32_bf16 v[160:163], v[60:63], v[80:83], v[160:163]
    v_mfma_f32_16x16x32_bf16 v[164:167], v[60:63], v[84:87], v[164:167]
    ds_read_b128 v[112:115], v7 offset:256
    s_waitcnt lgkmcnt(3)
    v_mfma_f32_16x16x32_bf16 v[168:171], v[60:63], v[88:91], v[168:171]
    ds_read_b128 v[60:63], v6 offset:2496
    v_mfma_f32_16x16x32_bf16 v[152:155], v[56:59], v[76:79], v[152:155]
    v_mfma_f32_16x16x32_bf16 v[156:159], v[56:59], v[80:83], v[156:159]
    v_mfma_f32_16x16x32_bf16 v[160:163], v[56:59], v[84:87], v[160:163]
    ds_read_b128 v[116:119], v7 offset:512
    v_mfma_f32_16x16x32_bf16 v[164:167], v[56:59], v[88:91], v[164:167]
    v_mfma_f32_16x16x32_bf16 v[168:171], v[56:59], v[92:95], v[168:171]
    ds_read_b128 v[56:59], v6 offset:1984
    v_mfma_f32_16x16x32_bf16 v[148:151], v[52:55], v[76:79], v[148:151]
    v_mfma_f32_16x16x32_bf16 v[152:155], v[52:55], v[80:83], v[152:155]
    ds_read_b128 v[120:123], v7 offset:768
    v_mfma_f32_16x16x32_bf16 v[156:159], v[52:55], v[84:87], v[156:159]
    v_mfma_f32_16x16x32_bf16 v[160:163], v[52:55], v[88:91], v[160:163]
    v_mfma_f32_16x16x32_bf16 v[164:167], v[52:55], v[92:95], v[164:167]
    ds_read_b128 v[124:127], v7 offset:1024
    v_mfma_f32_16x16x32_bf16 v[168:171], v[52:55], v[96:99], v[168:171]
    ds_read_b128 v[52:55], v6 offset:1472
    v_mfma_f32_16x16x32_bf16 v[144:147], v[48:51], v[76:79], v[144:147]
    v_mfma_f32_16x16x32_bf16 v[148:151], v[48:51], v[80:83], v[148:151]
    v_mfma_f32_16x16x32_bf16 v[152:155], v[48:51], v[84:87], v[152:155]
    ds_read_b128 v[128:131], v7 offset:1280
    v_mfma_f32_16x16x32_bf16 v[156:159], v[48:51], v[88:91], v[156:159]
    v_mfma_f32_16x16x32_bf16 v[160:163], v[48:51], v[92:95], v[160:163]
    v_mfma_f32_16x16x32_bf16 v[164:167], v[48:51], v[96:99], v[164:167]
    ds_read_b128 v[132:135], v7 offset:1536
    v_mfma_f32_16x16x32_bf16 v[168:171], v[48:51], v[100:103], v[168:171]
    ds_read_b128 v[48:51], v6 offset:960
    v_mfma_f32_16x16x32_bf16 v[140:143], v[44:47], v[76:79], v[140:143]
    v_mfma_f32_16x16x32_bf16 v[144:147], v[44:47], v[80:83], v[144:147]
    v_mfma_f32_16x16x32_bf16 v[148:151], v[44:47], v[84:87], v[148:151]
    ds_read_b128 v[136:139], v7 offset:1792
    v_mfma_f32_16x16x32_bf16 v[152:155], v[44:47], v[88:91], v[152:155]
    v_mfma_f32_16x16x32_bf16 v[156:159], v[44:47], v[92:95], v[156:159]
    v_mfma_f32_16x16x32_bf16 v[160:163], v[44:47], v[96:99], v[160:163]
    v_mfma_f32_16x16x32_bf16 v[164:167], v[44:47], v[100:103], v[164:167]
    v_mfma_f32_16x16x32_bf16 v[168:171], v[44:47], v[104:107], v[168:171]
    ds_read_b128 v[44:47], v6 offset:448
    s_waitcnt lgkmcnt(2)
    v_mfma_f32_16x16x32_bf16 v[168:171], v[72:75], v[108:111], v[168:171]
    s_waitcnt vmcnt(4) lgkmcnt(1)
    v_lshlrev_b32 v76, 16, v28
    v_and_b32 v78, s3, v28
    v_mfma_f32_16x16x32_bf16 v[164:167], v[68:71], v[108:111], v[164:167]
    v_lshlrev_b32 v80, 16, v29
    v_and_b32 v82, s3, v29
    v_mfma_f32_16x16x32_bf16 v[168:171], v[68:71], v[112:115], v[168:171]
    v_lshlrev_b32 v77, 16, v30
    v_and_b32 v79, s3, v30
    v_mfma_f32_16x16x32_bf16 v[160:163], v[64:67], v[108:111], v[160:163]
    v_lshlrev_b32 v81, 16, v31
    v_and_b32 v83, s3, v31
    v_mfma_f32_16x16x32_bf16 v[164:167], v[64:67], v[112:115], v[164:167]
    v_fma_f32 v196, v76, v172, v174
    v_fma_f32 v197, v77, v173, v175
    v_mfma_f32_16x16x32_bf16 v[168:171], v[64:67], v[116:119], v[168:171]
    v_fma_f32 v198, v78, v172, v174
    v_fma_f32 v199, v79, v173, v175
    v_mfma_f32_16x16x32_bf16 v[156:159], v[60:63], v[108:111], v[156:159]
    v_fma_f32 v200, v80, v172, v174
    v_fma_f32 v201, v81, v173, v175
    v_mfma_f32_16x16x32_bf16 v[160:163], v[60:63], v[112:115], v[160:163]
    v_fma_f32 v202, v82, v172, v174
    v_fma_f32 v203, v83, v173, v175
    v_mfma_f32_16x16x32_bf16 v[164:167], v[60:63], v[116:119], v[164:167]
    v_lshlrev_b32 v84, 16, v32
    v_and_b32 v86, s3, v32
    v_mfma_f32_16x16x32_bf16 v[168:171], v[60:63], v[120:123], v[168:171]
    v_lshlrev_b32 v88, 16, v33
    v_and_b32 v90, s3, v33
    v_mfma_f32_16x16x32_bf16 v[152:155], v[56:59], v[108:111], v[152:155]
    v_lshlrev_b32 v85, 16, v34
    v_and_b32 v87, s3, v34
    v_mfma_f32_16x16x32_bf16 v[156:159], v[56:59], v[112:115], v[156:159]
    v_lshlrev_b32 v89, 16, v35
    v_and_b32 v91, s3, v35
    v_mfma_f32_16x16x32_bf16 v[160:163], v[56:59], v[116:119], v[160:163]
    v_fma_f32 v204, v84, v176, v178
    v_fma_f32 v205, v85, v177, v179
    v_mfma_f32_16x16x32_bf16 v[164:167], v[56:59], v[120:123], v[164:167]
    v_fma_f32 v206, v86, v176, v178
    v_fma_f32 v207, v87, v177, v179
    v_mfma_f32_16x16x32_bf16 v[168:171], v[56:59], v[124:127], v[168:171]
    v_fma_f32 v208, v88, v176, v178
    v_fma_f32 v209, v89, v177, v179
    v_mfma_f32_16x16x32_bf16 v[148:151], v[52:55], v[108:111], v[148:151]
    v_fma_f32 v210, v90, v176, v178
    v_fma_f32 v211, v91, v177, v179
    v_mfma_f32_16x16x32_bf16 v[152:155], v[52:55], v[112:115], v[152:155]
    v_lshlrev_b32 v92, 16, v36
    v_and_b32 v94, s3, v36
    v_mfma_f32_16x16x32_bf16 v[156:159], v[52:55], v[116:119], v[156:159]
    v_lshlrev_b32 v96, 16, v37
    v_and_b32 v98, s3, v37
    v_mfma_f32_16x16x32_bf16 v[160:163], v[52:55], v[120:123], v[160:163]
    v_lshlrev_b32 v93, 16, v38
    v_and_b32 v95, s3, v38
    v_mfma_f32_16x16x32_bf16 v[164:167], v[52:55], v[124:127], v[164:167]
    v_lshlrev_b32 v97, 16, v39
    v_and_b32 v99, s3, v39
    v_mfma_f32_16x16x32_bf16 v[168:171], v[52:55], v[128:131], v[168:171]
    v_fma_f32 v212, v92, v180, v182
    v_fma_f32 v213, v93, v181, v183
    v_mfma_f32_16x16x32_bf16 v[144:147], v[48:51], v[108:111], v[144:147]
    v_fma_f32 v214, v94, v180, v182
    v_fma_f32 v215, v95, v181, v183
    v_mfma_f32_16x16x32_bf16 v[148:151], v[48:51], v[112:115], v[148:151]
    v_fma_f32 v216, v96, v180, v182
    v_fma_f32 v217, v97, v181, v183
    v_mfma_f32_16x16x32_bf16 v[152:155], v[48:51], v[116:119], v[152:155]
    v_fma_f32 v218, v98, v180, v182
    v_fma_f32 v219, v99, v181, v183
    v_mfma_f32_16x16x32_bf16 v[156:159], v[48:51], v[120:123], v[156:159]
    v_lshlrev_b32 v100, 16, v40
    v_and_b32 v102, s3, v40
    v_mfma_f32_16x16x32_bf16 v[160:163], v[48:51], v[124:127], v[160:163]
    v_lshlrev_b32 v104, 16, v41
    v_and_b32 v106, s3, v41
    v_mfma_f32_16x16x32_bf16 v[164:167], v[48:51], v[128:131], v[164:167]
    v_lshlrev_b32 v101, 16, v42
    v_and_b32 v103, s3, v42
    v_mfma_f32_16x16x32_bf16 v[168:171], v[48:51], v[132:135], v[168:171]
    v_lshlrev_b32 v105, 16, v43
    v_and_b32 v107, s3, v43
    s_waitcnt lgkmcnt(0)
    v_mfma_f32_16x16x32_bf16 v[140:143], v[44:47], v[108:111], v[140:143]
    s_waitcnt vmcnt(3)
    v_fma_f32 v220, v100, v184, v186
    v_fma_f32 v221, v101, v185, v187
    v_mfma_f32_16x16x32_bf16 v[144:147], v[44:47], v[112:115], v[144:147]
    v_fma_f32 v222, v102, v184, v186
    v_fma_f32 v223, v103, v185, v187
    v_mfma_f32_16x16x32_bf16 v[148:151], v[44:47], v[116:119], v[148:151]
    v_fma_f32 v224, v104, v184, v186
    v_fma_f32 v225, v105, v185, v187
    v_mfma_f32_16x16x32_bf16 v[152:155], v[44:47], v[120:123], v[152:155]
    v_fma_f32 v226, v106, v184, v186
    v_fma_f32 v227, v107, v185, v187
    v_mfma_f32_16x16x32_bf16 v[156:159], v[44:47], v[124:127], v[156:159]
    v_mfma_f32_16x16x32_bf16 v[160:163], v[44:47], v[128:131], v[160:163]
    v_mfma_f32_16x16x32_bf16 v[164:167], v[44:47], v[132:135], v[164:167]
    v_mfma_f32_16x16x32_bf16 v[168:171], v[44:47], v[136:139], v[168:171]
    buffer_load_dword v244, v243, s[4:7], s86 offen sc1
    ds_write_b128 v8, v[140:143] offset:0
    ds_write_b128 v8, v[144:147] offset:1024
    ds_write_b128 v8, v[148:151] offset:2048
    ds_write_b128 v8, v[152:155] offset:3072
    s_mov_b32 s49, 65536
L_adaL_poll_10:
    s_waitcnt vmcnt(1)
    v_cmp_ne_u32 vcc, s48, v15
    s_nop 0
    s_cbranch_vccz L_adaL_got_11
    buffer_load_dwordx2 v[14:15], v25, s[4:7], 0 offen sc1
    s_waitcnt vmcnt(0)
    s_sub_u32 s49, s49, 1
    s_cmp_lg_u32 s49, 0
    s_cbranch_scc1 L_adaL_poll_10
L_adaL_got_11:
    v_readlane_b32 s20, v14, 0
    ds_write_b128 v8, v[156:159] offset:4096
    v_readlane_b32 s21, v14, 1
    v_readlane_b32 s22, v14, 2
    v_readlane_b32 s23, v14, 3
    v_readlane_b32 s24, v14, 4
    v_readlane_b32 s25, v14, 5
    v_readlane_b32 s26, v14, 6
    v_readlane_b32 s27, v14, 7
    v_readlane_b32 s28, v14, 8
    ds_write_b128 v8, v[160:163] offset:5120
    v_readlane_b32 s29, v14, 9
    v_readlane_b32 s30, v14, 10
    v_readlane_b32 s31, v14, 11
    v_mov_b32 v192, s28
    v_mov_b32 v193, s29
    v_mov_b32 v194, s30
    v_mov_b32 v195, s31
    v_mul_f32 v188, s20, v192
    ds_write_b128 v8, v[164:167] offset:6144
    v_mul_f32 v192, s24, v192
    v_mul_f32 v189, s21, v193
    v_mul_f32 v193, s25, v193
    v_mul_f32 v190, s22, v194
    v_mul_f32 v194, s26, v194
    v_mul_f32 v191, s23, v195
    v_mul_f32 v195, s27, v195
    v_pk_fma_f32 v[196:197], v[192:193], v[196:197], v[188:189] op_sel:[0,0,0] op_sel_hi:[0,1,0]
    ds_write_b128 v8, v[168:171] offset:7168
    v_pk_fma_f32 v[198:199], v[192:193], v[198:199], v[188:189] op_sel:[1,0,1] op_sel_hi:[1,1,1]
    v_pk_fma_f32 v[200:201], v[194:195], v[200:201], v[190:191] op_sel:[0,0,0] op_sel_hi:[0,1,0]
    v_pk_fma_f32 v[202:203], v[194:195], v[202:203], v[190:191] op_sel:[1,0,1] op_sel_hi:[1,1,1]
    v_pk_fma_f32 v[204:205], v[192:193], v[204:205], v[188:189] op_sel:[0,0,0] op_sel_hi:[0,1,0]
    v_pk_fma_f32 v[206:207], v[192:193], v[206:207], v[188:189] op_sel:[1,0,1] op_sel_hi:[1,1,1]
    v_pk_fma_f32 v[208:209], v[194:195], v[208:209], v[190:191] op_sel:[0,0,0] op_sel_hi:[0,1,0]
    v_pk_fma_f32 v[210:211], v[194:195], v[210:211], v[190:191] op_sel:[1,0,1] op_sel_hi:[1,1,1]
    v_pk_fma_f32 v[212:213], v[192:193], v[212:213], v[188:189] op_sel:[0,0,0] op_sel_hi:[0,1,0]
    v_pk_fma_f32 v[214:215], v[192:193], v[214:215], v[188:189] op_sel:[1,0,1] op_sel_hi:[1,1,1]
    v_pk_fma_f32 v[216:217], v[194:195], v[216:217], v[190:191] op_sel:[0,0,0] op_sel_hi:[0,1,0]
    v_pk_fma_f32 v[218:219], v[194:195], v[218:219], v[190:191] op_sel:[1,0,1] op_sel_hi:[1,1,1]
    v_pk_fma_f32 v[220:221], v[192:193], v[220:221], v[188:189] op_sel:[0,0,0] op_sel_hi:[0,1,0]
    v_pk_fma_f32 v[222:223], v[192:193], v[222:223], v[188:189] op_sel:[1,0,1] op_sel_hi:[1,1,1]
    v_pk_fma_f32 v[224:225], v[194:195], v[224:225], v[190:191] op_sel:[0,0,0] op_sel_hi:[0,1,0]
    v_pk_fma_f32 v[226:227], v[194:195], v[226:227], v[190:191] op_sel:[1,0,1] op_sel_hi:[1,1,1]
    s_waitcnt lgkmcnt(0)
    s_barrier
    ds_read_b64 v[44:45], v228 offset:0
    ds_read_b64 v[46:47], v228 offset:33024
    ds_read_b64 v[48:49], v229 offset:0
    ds_read_b64 v[50:51], v229 offset:33024
    ds_read_b64 v[52:53], v228 offset:2048
    ds_read_b64 v[54:55], v228 offset:35072
    ds_read_b64 v[56:57], v229 offset:2048
    ds_read_b64 v[58:59], v229 offset:35072
    ds_read_b64 v[60:61], v228 offset:4096
    ds_read_b64 v[62:63], v228 offset:37120
    ds_read_b64 v[64:65], v229 offset:4096
    ds_read_b64 v[66:67], v229 offset:37120
    ds_read_b64 v[68:69], v228 offset:6144
    ds_read_b64 v[70:71], v228 offset:39168
    ds_read_b64 v[72:73], v229 offset:6144
    ds_read_b64 v[74:75], v229 offset:39168
    s_waitcnt lgkmcnt(15)
    v_pk_fma_f32 v[196:197], v[196:197], v[44:45], v[76:77]
    s_waitcnt lgkmcnt(14)
    v_pk_fma_f32 v[198:199], v[198:199], v[46:47], v[78:79]
    s_waitcnt lgkmcnt(13)
    v_pk_fma_f32 v[200:201], v[200:201], v[48:49], v[80:81]
    s_waitcnt lgkmcnt(12)
    v_pk_fma_f32 v[202:203], v[202:203], v[50:51], v[82:83]
    v_cvt_pk_bf16_f32 v28, v196, v198
    v_cvt_pk_bf16_f32 v29, v200, v202
    v_cvt_pk_bf16_f32 v30, v197, v199
    v_cvt_pk_bf16_f32 v31, v201, v203
    buffer_store_dwordx4 v[28:31], v9, s[4:7], s64 offen sc1
    s_waitcnt lgkmcnt(11)
    v_pk_fma_f32 v[204:205], v[204:205], v[52:53], v[84:85]
    s_waitcnt lgkmcnt(10)
    v_pk_fma_f32 v[206:207], v[206:207], v[54:55], v[86:87]
    s_waitcnt lgkmcnt(9)
    v_pk_fma_f32 v[208:209], v[208:209], v[56:57], v[88:89]
    s_waitcnt lgkmcnt(8)
    v_pk_fma_f32 v[210:211], v[210:211], v[58:59], v[90:91]
    v_cvt_pk_bf16_f32 v32, v204, v206
    v_cvt_pk_bf16_f32 v33, v208, v210
    v_cvt_pk_bf16_f32 v34, v205, v207
    v_cvt_pk_bf16_f32 v35, v209, v211
    buffer_store_dwordx4 v[32:35], v9, s[4:7], s65 offen sc1
    s_waitcnt lgkmcnt(7)
    v_pk_fma_f32 v[212:213], v[212:213], v[60:61], v[92:93]
    s_waitcnt lgkmcnt(6)
    v_pk_fma_f32 v[214:215], v[214:215], v[62:63], v[94:95]
    s_waitcnt lgkmcnt(5)
    v_pk_fma_f32 v[216:217], v[216:217], v[64:65], v[96:97]
    s_waitcnt lgkmcnt(4)
    v_pk_fma_f32 v[218:219], v[218:219], v[66:67], v[98:99]
    v_cvt_pk_bf16_f32 v36, v212, v214
    v_cvt_pk_bf16_f32 v37, v216, v218
    v_cvt_pk_bf16_f32 v38, v213, v215
    v_cvt_pk_bf16_f32 v39, v217, v219
    buffer_store_dwordx4 v[36:39], v9, s[4:7], s66 offen sc1
    s_waitcnt lgkmcnt(0)
    v_pk_fma_f32 v[220:221], v[220:221], v[68:69], v[100:101]
    v_pk_fma_f32 v[222:223], v[222:223], v[70:71], v[102:103]
    v_pk_fma_f32 v[224:225], v[224:225], v[72:73], v[104:105]
    v_pk_fma_f32 v[226:227], v[226:227], v[74:75], v[106:107]
    v_cvt_pk_bf16_f32 v40, v220, v222
    v_cvt_pk_bf16_f32 v41, v224, v226
    v_cvt_pk_bf16_f32 v42, v221, v223
    v_cvt_pk_bf16_f32 v43, v225, v227
    buffer_store_dwordx4 v[40:43], v9, s[4:7], s67 offen sc1
L_adaL_join_3:
    s_load_dwordx2 s[12:13], s[0:1], 72
    s_mov_b32 s14, 4096
    s_mov_b32 s15, 0x20000
    s_load_dwordx2 s[16:17], s[0:1], 104
    s_mov_b32 s18, 2621440
    s_mov_b32 s19, 0x20000
    v_mov_b32 v13, s48
    s_lshl_b32 s62, s82, 8
    s_add_u32 s62, s62, s2
    s_lshl_b32 s55, s62, 5
    s_add_u32 s55, s55, 131072
    s_cmp_ge_u32 s62, 160
    s_cselect_b32 s55, 33554432, s55
    v_mul_u32_u24 v14, 5376, v240
    s_and_b32 s60, s2, 7
    s_mul_i32 s60, s60, 5376
    s_mul_i32 s62, s82, 1280
    s_add_u32 s60, s60, s62
    s_add_u32 s60, s60, 131072
    v_min_u32 v26, 39, v240
    v_lshlrev_b32 v26, 5, v26
    v_and_b32 v1, 15, v0
    s_waitcnt vmcnt(1)
    v_lshrrev_b32 v2, 4, v240
    s_mul_i32 s54, s82, 33024
    s_add_u32 s54, s54, 8192
    v_add_u32 v8, s54, v241
    v_lshrrev_b32 v3, 1, v1
    v_xor_b32 v3, v3, v2
    v_lshlrev_b32 v10, 7, v1
    v_lshl_add_u32 v10, v3, 4, v10
    v_add_u32 v10, s54, v10
    v_xor_b32 v11, 64, v10
    s_waitcnt vmcnt(0)
    s_barrier
    s_mov_b64 exec, 255
    buffer_store_dword v13, v14, s[4:7], s55 offen sc1
    s_mov_b64 exec, -1
    s_mov_b32 s49, 65536
L_adaL_poll_12:
    v_cmp_ne_u32 vcc, s48, v244
    s_nop 0
    s_cbranch_vccz L_adaL_got_13
    buffer_load_dword v244, v243, s[4:7], s86 offen sc1
    s_waitcnt vmcnt(0)
    s_sub_u32 s49, s49, 1
    s_cmp_lg_u32 s49, 0
    s_cbranch_scc1 L_adaL_poll_12
L_adaL_got_13:
    s_cmp_eq_u32 s82, 3
    s_cbranch_scc1 L_adaL_w3_23
    buffer_load_dwordx4 a[96:99], v241, s[4:7], s85 offen offset:0 sc1
    v_bfe_u32 v3, v0, 3, 2
    v_bfe_u32 v4, v0, 5, 1
    v_lshl_add_u32 v3, v3, 1, v4
    v_lshlrev_b32 v15, 14, v3
    buffer_load_dwordx4 a[100:103], v242, s[4:7], s85 offen offset:0 sc1
    v_and_b32 v3, 7, v0
    v_lshl_add_u32 v15, v3, 4, v15
    s_lshl_b32 s52, s83, 9
    s_lshl_b32 s62, s82, 7
    buffer_load_dwordx4 a[104:107], v241, s[4:7], s85 offen offset:1024 sc1
    s_add_u32 s52, s52, s62
    s_add_u32 s52, s52, 6291456
    s_mul_i32 s53, s82, 20480
    v_lshlrev_b32 v5, 3, v240
    buffer_load_dwordx4 a[108:111], v242, s[4:7], s85 offen offset:1024 sc1
    v_add_u32 v6, 40960, v5
    v_add_u32 v14, s53, v5
    v_lshlrev_b32 v7, 4, v2
    s_mov_b32 s66, 0xbdd2d3e8
    buffer_load_dwordx4 a[112:115], v241, s[4:7], s85 offen offset:2048 sc1
    s_mov_b32 s67, 0xc0135761
    s_mov_b32 s68, 1.0
    s_mov_b32 s69, 1.0
    v_mov_b32 v132, 0x3f803f80
    buffer_load_dwordx4 a[116:119], v242, s[4:7], s85 offen offset:2048 sc1
    v_mov_b32 v133, 0x3f803f80
    v_mov_b32 v134, 0x3f803f80
    v_mov_b32 v135, 0x3f803f80
    v_lshlrev_b32 v12, 2, v1
    buffer_load_dwordx4 a[120:123], v241, s[4:7], s85 offen offset:3072 sc1
    s_lshl_b32 s62, s84, 11
    s_add_u32 s62, s62, 262144
    v_lshlrev_b32 v4, 3, v0
    buffer_load_dwordx4 a[124:127], v242, s[4:7], s85 offen offset:3072 sc1
    s_add_u32 s85, s85, 4096
    buffer_load_dwordx4 a[128:131], v241, s[4:7], s85 offen offset:0 sc1
    buffer_load_dwordx4 a[132:135], v242, s[4:7], s85 offen offset:0 sc1
    buffer_load_dwordx4 a[136:139], v241, s[4:7], s85 offen offset:1024 sc1
    buffer_load_dwordx4 a[140:143], v242, s[4:7], s85 offen offset:1024 sc1
    buffer_load_dwordx4 a[144:147], v241, s[4:7], s85 offen offset:2048 sc1
    buffer_load_dwordx4 a[148:151], v242, s[4:7], s85 offen offset:2048 sc1
    buffer_load_dwordx4 a[152:155], v241, s[4:7], s85 offen offset:3072 sc1
    buffer_load_dwordx4 a[156:159], v242, s[4:7], s85 offen offset:3072 sc1
    s_add_u32 s85, s85, 4096
    buffer_load_dwordx4 a[160:163], v241, s[4:7], s85 offen offset:0 sc1
    buffer_load_dwordx4 a[164:167], v242, s[4:7], s85 offen offset:0 sc1
    buffer_load_dwordx4 a[168:171], v241, s[4:7], s85 offen offset:1024 sc1
    buffer_load_dwordx4 a[172:175], v242, s[4:7], s85 offen offset:1024 sc1
    buffer_load_dwordx4 a[176:179], v241, s[4:7], s85 offen offset:2048 sc1
    buffer_load_dwordx4 a[180:183], v242, s[4:7], s85 offen offset:2048 sc1
    buffer_load_dwordx4 a[184:187], v241, s[4:7], s85 offen offset:3072 sc1
    buffer_load_dwordx4 a[188:191], v242, s[4:7], s85 offen offset:3072 sc1
    s_add_u32 s85, s85, 4096
    buffer_load_dwordx2 v[180:181], v4, s[4:7], s62 offen sc1
    s_add_u32 s62, s62, 16384
    buffer_load_dwordx2 v[182:183], v4, s[4:7], s62 offen sc1
    s_add_u32 s62, s62, 16384
    buffer_load_dwordx2 v[184:185], v4, s[4:7], s62 offen sc1
    s_add_u32 s62, s62, 16384
    buffer_load_dwordx2 v[186:187], v4, s[4:7], s62 offen sc1
    s_add_u32 s62, s62, 16384
    buffer_load_dwordx2 v[188:189], v4, s[4:7], s62 offen sc1
    s_add_u32 s62, s62, 16384
    s_mul_i32 s62, s84, 640
    s_add_u32 s62, s62, 58368
    v_min_u32 v3, 79, v0
    v_lshl_add_u32 v166, v3, 3, s62
    buffer_load_dwordx2 v[164:165], v166, s[4:7], 0 offen sc1
    buffer_load_dword v27, v26, s[4:7], s60 offen sc1
    v_lshlrev_b32 v3, 2, v3
    v_add_u32 v3, 88576, v3
    s_waitcnt vmcnt(5)
    v_pk_add_f32 v[180:181], v[180:181], v[182:183]
    s_waitcnt vmcnt(4)
    v_pk_add_f32 v[180:181], v[180:181], v[184:185]
    s_waitcnt vmcnt(3)
    v_pk_add_f32 v[180:181], v[180:181], v[186:187]
    s_waitcnt vmcnt(2)
    v_pk_add_f32 v[180:181], v[180:181], v[188:189]
    v_add_u32 v4, 86528, v4
    s_mul_i32 s63, s82, 14336
    s_add_u32 s63, s63, 102912
    s_sub_u32 s64, s63, s54
    s_mov_b32 s54, s63
    v_add_u32 v10, s64, v10
    v_add_u32 v11, s64, v11
    s_mov_b32 s49, 65536
L_adaL_poll_14:
    s_waitcnt vmcnt(1)
    v_cmp_ne_u32 vcc, s48, v165
    s_nop 0
    s_cbranch_vccz L_adaL_got_15
    buffer_load_dwordx2 v[164:165], v166, s[4:7], 0 offen sc1
    s_waitcnt vmcnt(0)
    s_sub_u32 s49, s49, 1
    s_cmp_lg_u32 s49, 0
    s_cbranch_scc1 L_adaL_poll_14
L_adaL_got_15:
    s_mov_b32 s49, 65536
L_adaL_poll_16:
    s_waitcnt vmcnt(0)
    v_cmp_ne_u32 vcc, s48, v27
    s_nop 0
    s_cbranch_vccz L_adaL_got_17
    buffer_load_dword v27, v26, s[4:7], s60 offen sc1
    s_waitcnt vmcnt(0)
    s_sub_u32 s49, s49, 1
    s_cmp_lg_u32 s49, 0
    s_cbranch_scc1 L_adaL_poll_16
L_adaL_got_17:
    s_barrier
    s_mov_b32 m0, s53
    s_nop 0
    buffer_load_dwordx4 v15, s[4:7], s52 offen sc1 lds
    s_add_u32 m0, m0, 1024
    s_add_u32 s52, s52, 131072
    buffer_load_dwordx4 v15, s[4:7], s52 offen sc1 lds
    s_add_u32 m0, m0, 1024
    s_add_u32 s52, s52, 131072
    buffer_load_dwordx4 v15, s[4:7], s52 offen sc1 lds
    s_add_u32 m0, m0, 1024
    s_add_u32 s52, s52, 131072
    buffer_load_dwordx4 v15, s[4:7], s52 offen sc1 lds
    s_add_u32 m0, m0, 1024
    s_add_u32 s52, s52, 131072
    buffer_load_dwordx4 v15, s[4:7], s52 offen sc1 lds
    s_add_u32 m0, m0, 1024
    s_add_u32 s52, s52, 131072
    buffer_load_dwordx4 v15, s[4:7], s52 offen sc1 lds
    s_add_u32 m0, m0, 1024
    s_add_u32 s52, s52, 131072
    buffer_load_dwordx4 v15, s[4:7], s52 offen sc1 lds
    s_add_u32 m0, m0, 1024
    s_add_u32 s52, s52, 131072
    buffer_load_dwordx4 v15, s[4:7], s52 offen sc1 lds
    s_add_u32 m0, m0, 1024
    s_add_u32 s52, s52, 131072
    buffer_load_dwordx4 v15, s[4:7], s52 offen sc1 lds
    s_add_u32 m0, m0, 1024
    s_add_u32 s52, s52, 131072
    buffer_load_dwordx4 v15, s[4:7], s52 offen sc1 lds
    s_add_u32 m0, m0, 1024
    s_add_u32 s52, s52, 131072
    ds_write_b64 v4, v[180:181]
    ds_write_b32 v3, v164
    s_lshl_b32 s60, s83, 3
    s_add_u32 s60, s60, s84
    s_lshl_b32 s60, s60, 15
    v_lshlrev_b32 v26, 5, v0
    s_waitcnt vmcnt(9)
    ds_read_b64 v[92:93], v14 offset:0
    ds_read_b64 v[94:95], v14 offset:512
    buffer_load_dwordx4 v15, s[4:7], s52 offen sc1 lds
    s_add_u32 m0, m0, 1024
    s_add_u32 s52, s52, 131072
    s_waitcnt lgkmcnt(0)
    v_mfma_f32_16x16x32_bf16 v[136:139], v[92:95], v[92:95], 0
    s_waitcnt vmcnt(9)
    ds_read_b64 v[96:97], v14 offset:1024
    v_mfma_f32_16x16x32_bf16 v[140:143], v[132:135], v[92:95], 0
    ds_read_b64 v[98:99], v14 offset:1536
    buffer_load_dwordx4 v15, s[4:7], s52 offen sc1 lds
    s_add_u32 m0, m0, 1024
    s_add_u32 s52, s52, 131072
    s_waitcnt lgkmcnt(0)
    v_mfma_f32_16x16x32_bf16 v[136:139], v[96:99], v[96:99], v[136:139]
    s_waitcnt vmcnt(9)
    ds_read_b64 v[92:93], v14 offset:2048
    v_mfma_f32_16x16x32_bf16 v[140:143], v[132:135], v[96:99], v[140:143]
    ds_read_b64 v[94:95], v14 offset:2560
    buffer_load_dwordx4 v15, s[4:7], s52 offen sc1 lds
    s_add_u32 m0, m0, 1024
    s_add_u32 s52, s52, 131072
    s_waitcnt lgkmcnt(0)
    v_mfma_f32_16x16x32_bf16 v[136:139], v[92:95], v[92:95], v[136:139]
    s_waitcnt vmcnt(9)
    ds_read_b64 v[96:97], v14 offset:3072
    v_mfma_f32_16x16x32_bf16 v[140:143], v[132:135], v[92:95], v[140:143]
    ds_read_b64 v[98:99], v14 offset:3584
    s_waitcnt lgkmcnt(0)
    s_barrier
    ds_read_b64 v[44:45], v5 offset:0
    ds_read_b64 v[46:47], v5 offset:512
    ds_read_b64 v[48:49], v5 offset:20480
    ds_read_b64 v[50:51], v5 offset:20992
    ds_read_b64 v[52:53], v6 offset:0
    ds_read_b64 v[54:55], v6 offset:512
    ds_read_b64 v[56:57], v6 offset:20480
    ds_read_b64 v[58:59], v6 offset:20992
    ds_read_b64 v[60:61], v5 offset:1024
    ds_read_b64 v[62:63], v5 offset:1536
    ds_read_b64 v[64:65], v5 offset:21504
    ds_read_b64 v[66:67], v5 offset:22016
    ds_read_b64 v[68:69], v6 offset:1024
    ds_read_b64 v[70:71], v6 offset:1536
    ds_read_b64 v[72:73], v6 offset:21504
    ds_read_b64 v[74:75], v6 offset:22016
    v_mfma_f32_16x16x32_bf16 v[136:139], v[96:99], v[96:99], v[136:139]
    s_waitcnt vmcnt(8)
    ds_read_b64 v[92:93], v14 offset:4096
    v_mfma_f32_16x16x32_bf16 v[140:143], v[132:135], v[96:99], v[140:143]
    ds_read_b64 v[94:95], v14 offset:4608
    s_waitcnt lgkmcnt(10)
    v_mfma_f32_16x16x32_bf16 v[100:103], v[44:47], a[96:99], 0
    ds_read2st64_b64 v[76:79], v5 offset0:4 offset1:5
    v_mfma_f32_16x16x32_bf16 v[104:107], v[48:51], a[96:99], 0
    ds_read_b64 v[80:81], v5 offset:22528
    v_mfma_f32_16x16x32_bf16 v[108:111], v[52:55], a[96:99], 0
    ds_read_b64 v[82:83], v5 offset:23040
    v_mfma_f32_16x16x32_bf16 v[112:115], v[56:59], a[96:99], 0
    buffer_load_dwordx4 v15, s[4:7], s52 offen sc1 lds
    s_add_u32 m0, m0, 1024
    s_add_u32 s52, s52, 131072
    v_mfma_f32_16x16x32_bf16 v[116:119], v[44:47], a[100:103], 0
    ds_read2st64_b64 v[84:87], v5 offset0:84 offset1:85
    v_mfma_f32_16x16x32_bf16 v[120:123], v[48:51], a[100:103], 0
    ds_read_b64 v[88:89], v6 offset:22528
    v_mfma_f32_16x16x32_bf16 v[124:127], v[52:55], a[100:103], 0
    ds_read_b64 v[90:91], v6 offset:23040
    v_mfma_f32_16x16x32_bf16 v[128:131], v[56:59], a[100:103], 0
    buffer_load_dwordx4 v15, s[4:7], s52 offen sc1 lds
    s_add_u32 m0, m0, 1024
    s_add_u32 s52, s52, 131072
    s_waitcnt lgkmcnt(4)
    v_mfma_f32_16x16x32_bf16 v[136:139], v[92:95], v[92:95], v[136:139]
    s_waitcnt vmcnt(9) lgkmcnt(3)
    ds_read_b64 v[96:97], v14 offset:5120
    v_mfma_f32_16x16x32_bf16 v[140:143], v[132:135], v[92:95], v[140:143]
    ds_read_b64 v[98:99], v14 offset:5632
    v_mfma_f32_16x16x32_bf16 v[100:103], v[60:63], a[104:107], v[100:103]
    ds_read2st64_b64 v[44:47], v5 offset0:6 offset1:7
    v_mfma_f32_16x16x32_bf16 v[104:107], v[64:67], a[104:107], v[104:107]
    ds_read_b64 v[48:49], v5 offset:23552
    v_mfma_f32_16x16x32_bf16 v[108:111], v[68:71], a[104:107], v[108:111]
    ds_read_b64 v[50:51], v5 offset:24064
    v_mfma_f32_16x16x32_bf16 v[112:115], v[72:75], a[104:107], v[112:115]
    buffer_load_dwordx4 v15, s[4:7], s52 offen sc1 lds
    s_add_u32 m0, m0, 1024
    s_add_u32 s52, s52, 131072
    v_mfma_f32_16x16x32_bf16 v[116:119], v[60:63], a[108:111], v[116:119]
    ds_read2st64_b64 v[52:55], v5 offset0:86 offset1:87
    v_mfma_f32_16x16x32_bf16 v[120:123], v[64:67], a[108:111], v[120:123]
    ds_read_b64 v[56:57], v6 offset:23552
    v_mfma_f32_16x16x32_bf16 v[124:127], v[68:71], a[108:111], v[124:127]
    ds_read_b64 v[58:59], v6 offset:24064
    v_mfma_f32_16x16x32_bf16 v[128:131], v[72:75], a[108:111], v[128:131]
    buffer_load_dwordx4 v15, s[4:7], s52 offen sc1 lds
    s_add_u32 m0, m0, 1024
    s_add_u32 s52, s52, 131072
    s_waitcnt lgkmcnt(4)
    v_mfma_f32_16x16x32_bf16 v[136:139], v[96:99], v[96:99], v[136:139]
    s_waitcnt vmcnt(10) lgkmcnt(3)
    ds_read_b64 v[92:93], v14 offset:6144
    v_mfma_f32_16x16x32_bf16 v[140:143], v[132:135], v[96:99], v[140:143]
    ds_read_b64 v[94:95], v14 offset:6656
    s_waitcnt vmcnt(9)
    s_barrier
    v_mfma_f32_16x16x32_bf16 v[100:103], v[76:79], a[112:115], v[100:103]
    ds_read2st64_b64 v[60:63], v5 offset0:8 offset1:9
    v_mfma_f32_16x16x32_bf16 v[104:107], v[80:83], a[112:115], v[104:107]
    ds_read_b64 v[64:65], v5 offset:24576
    v_mfma_f32_16x16x32_bf16 v[108:111], v[84:87], a[112:115], v[108:111]
    ds_read_b64 v[66:67], v5 offset:25088
    v_mfma_f32_16x16x32_bf16 v[112:115], v[88:91], a[112:115], v[112:115]
    buffer_load_dwordx4 v15, s[4:7], s52 offen sc1 lds
    s_add_u32 m0, m0, 1024
    s_add_u32 s52, s52, 131072
    v_mfma_f32_16x16x32_bf16 v[116:119], v[76:79], a[116:119], v[116:119]
    ds_read2st64_b64 v[68:71], v5 offset0:88 offset1:89
    v_mfma_f32_16x16x32_bf16 v[120:123], v[80:83], a[116:119], v[120:123]
    ds_read_b64 v[72:73], v6 offset:24576
    v_mfma_f32_16x16x32_bf16 v[124:127], v[84:87], a[116:119], v[124:127]
    ds_read_b64 v[74:75], v6 offset:25088
    v_mfma_f32_16x16x32_bf16 v[128:131], v[88:91], a[116:119], v[128:131]
    buffer_load_dwordx4 v15, s[4:7], s52 offen sc1 lds
    s_add_u32 m0, m0, 1024
    s_add_u32 s52, s52, 131072
    s_waitcnt lgkmcnt(4)
    v_mfma_f32_16x16x32_bf16 v[136:139], v[92:95], v[92:95], v[136:139]
    ds_read_b64 v[96:97], v14 offset:7168
    v_mfma_f32_16x16x32_bf16 v[140:143], v[132:135], v[92:95], v[140:143]
    ds_read_b64 v[98:99], v14 offset:7680
    v_mfma_f32_16x16x32_bf16 v[100:103], v[44:47], a[120:123], v[100:103]
    ds_read2st64_b64 v[76:79], v5 offset0:10 offset1:11
    v_mfma_f32_16x16x32_bf16 v[104:107], v[48:51], a[120:123], v[104:107]
    ds_read_b64 v[80:81], v5 offset:25600
    v_mfma_f32_16x16x32_bf16 v[108:111], v[52:55], a[120:123], v[108:111]
    ds_read_b64 v[82:83], v5 offset:26112
    v_mfma_f32_16x16x32_bf16 v[112:115], v[56:59], a[120:123], v[112:115]
    buffer_load_dwordx4 v15, s[4:7], s52 offen sc1 lds
    v_mfma_f32_16x16x32_bf16 v[116:119], v[44:47], a[124:127], v[116:119]
    ds_read2st64_b64 v[84:87], v5 offset0:90 offset1:91
    v_mfma_f32_16x16x32_bf16 v[120:123], v[48:51], a[124:127], v[120:123]
    ds_read_b64 v[88:89], v6 offset:25600
    v_mfma_f32_16x16x32_bf16 v[124:127], v[52:55], a[124:127], v[124:127]
    ds_read_b64 v[90:91], v6 offset:26112
    v_mfma_f32_16x16x32_bf16 v[128:131], v[56:59], a[124:127], v[128:131]
    buffer_load_dwordx4 a[192:195], v241, s[4:7], s85 offen offset:0 sc1
    s_waitcnt lgkmcnt(4)
    v_mfma_f32_16x16x32_bf16 v[136:139], v[96:99], v[96:99], v[136:139]
    s_waitcnt vmcnt(12) lgkmcnt(3)
    ds_read_b64 v[92:93], v14 offset:8192
    v_mfma_f32_16x16x32_bf16 v[140:143], v[132:135], v[96:99], v[140:143]
    ds_read_b64 v[94:95], v14 offset:8704
    v_mfma_f32_16x16x32_bf16 v[100:103], v[60:63], a[128:131], v[100:103]
    ds_read2st64_b64 v[44:47], v5 offset0:12 offset1:13
    v_mfma_f32_16x16x32_bf16 v[104:107], v[64:67], a[128:131], v[104:107]
    ds_read_b64 v[48:49], v5 offset:26624
    v_mfma_f32_16x16x32_bf16 v[108:111], v[68:71], a[128:131], v[108:111]
    ds_read_b64 v[50:51], v5 offset:27136
    v_mfma_f32_16x16x32_bf16 v[112:115], v[72:75], a[128:131], v[112:115]
    buffer_load_dwordx4 a[196:199], v242, s[4:7], s85 offen offset:0 sc1
    v_mfma_f32_16x16x32_bf16 v[116:119], v[60:63], a[132:135], v[116:119]
    ds_read2st64_b64 v[52:55], v5 offset0:92 offset1:93
    v_mfma_f32_16x16x32_bf16 v[120:123], v[64:67], a[132:135], v[120:123]
    ds_read_b64 v[56:57], v6 offset:26624
    v_mfma_f32_16x16x32_bf16 v[124:127], v[68:71], a[132:135], v[124:127]
    ds_read_b64 v[58:59], v6 offset:27136
    v_mfma_f32_16x16x32_bf16 v[128:131], v[72:75], a[132:135], v[128:131]
    buffer_load_dwordx4 a[200:203], v241, s[4:7], s85 offen offset:1024 sc1
    s_waitcnt lgkmcnt(4)
    v_mfma_f32_16x16x32_bf16 v[136:139], v[92:95], v[92:95], v[136:139]
    s_waitcnt vmcnt(13) lgkmcnt(3)
    ds_read_b64 v[96:97], v14 offset:9216
    v_mfma_f32_16x16x32_bf16 v[140:143], v[132:135], v[92:95], v[140:143]
    ds_read_b64 v[98:99], v14 offset:9728
    v_mfma_f32_16x16x32_bf16 v[100:103], v[76:79], a[136:139], v[100:103]
    ds_read2st64_b64 v[60:63], v5 offset0:14 offset1:15
    v_mfma_f32_16x16x32_bf16 v[104:107], v[80:83], a[136:139], v[104:107]
    ds_read_b64 v[64:65], v5 offset:27648
    v_mfma_f32_16x16x32_bf16 v[108:111], v[84:87], a[136:139], v[108:111]
    ds_read_b64 v[66:67], v5 offset:28160
    v_mfma_f32_16x16x32_bf16 v[112:115], v[88:91], a[136:139], v[112:115]
    buffer_load_dwordx4 a[204:207], v242, s[4:7], s85 offen offset:1024 sc1
    v_mfma_f32_16x16x32_bf16 v[116:119], v[76:79], a[140:143], v[116:119]
    ds_read2st64_b64 v[68:71], v5 offset0:94 offset1:95
    v_mfma_f32_16x16x32_bf16 v[120:123], v[80:83], a[140:143], v[120:123]
    ds_read_b64 v[72:73], v6 offset:27648
    v_mfma_f32_16x16x32_bf16 v[124:127], v[84:87], a[140:143], v[124:127]
    ds_read_b64 v[74:75], v6 offset:28160
    v_mfma_f32_16x16x32_bf16 v[128:131], v[88:91], a[140:143], v[128:131]
    buffer_load_dwordx4 a[208:211], v241, s[4:7], s85 offen offset:2048 sc1
    s_waitcnt lgkmcnt(4)
    v_mfma_f32_16x16x32_bf16 v[136:139], v[96:99], v[96:99], v[136:139]
    s_waitcnt vmcnt(14) lgkmcnt(3)
    ds_read_b64 v[92:93], v14 offset:10240
    v_mfma_f32_16x16x32_bf16 v[140:143], v[132:135], v[96:99], v[140:143]
    ds_read_b64 v[94:95], v14 offset:10752
    s_waitcnt vmcnt(13)
    s_barrier
    v_mfma_f32_16x16x32_bf16 v[100:103], v[44:47], a[144:147], v[100:103]
    ds_read2st64_b64 v[76:79], v5 offset0:16 offset1:17
    v_mfma_f32_16x16x32_bf16 v[104:107], v[48:51], a[144:147], v[104:107]
    ds_read_b64 v[80:81], v5 offset:28672
    v_mfma_f32_16x16x32_bf16 v[108:111], v[52:55], a[144:147], v[108:111]
    ds_read_b64 v[82:83], v5 offset:29184
    v_mfma_f32_16x16x32_bf16 v[112:115], v[56:59], a[144:147], v[112:115]
    buffer_load_dwordx4 a[212:215], v242, s[4:7], s85 offen offset:2048 sc1
    v_mfma_f32_16x16x32_bf16 v[116:119], v[44:47], a[148:151], v[116:119]
    ds_read2st64_b64 v[84:87], v5 offset0:96 offset1:97
    v_mfma_f32_16x16x32_bf16 v[120:123], v[48:51], a[148:151], v[120:123]
    ds_read_b64 v[88:89], v6 offset:28672
    v_mfma_f32_16x16x32_bf16 v[124:127], v[52:55], a[148:151], v[124:127]
    ds_read_b64 v[90:91], v6 offset:29184
    v_mfma_f32_16x16x32_bf16 v[128:131], v[56:59], a[148:151], v[128:131]
    buffer_load_dwordx4 a[216:219], v241, s[4:7], s85 offen offset:3072 sc1
    s_waitcnt lgkmcnt(4)
    v_mfma_f32_16x16x32_bf16 v[136:139], v[92:95], v[92:95], v[136:139]
    ds_read_b64 v[96:97], v14 offset:11264
    v_mfma_f32_16x16x32_bf16 v[140:143], v[132:135], v[92:95], v[140:143]
    ds_read_b64 v[98:99], v14 offset:11776
    v_mfma_f32_16x16x32_bf16 v[100:103], v[60:63], a[152:155], v[100:103]
    ds_read2st64_b64 v[44:47], v5 offset0:18 offset1:19
    v_mfma_f32_16x16x32_bf16 v[104:107], v[64:67], a[152:155], v[104:107]
    ds_read_b64 v[48:49], v5 offset:29696
    v_mfma_f32_16x16x32_bf16 v[108:111], v[68:71], a[152:155], v[108:111]
    ds_read_b64 v[50:51], v5 offset:30208
    v_mfma_f32_16x16x32_bf16 v[112:115], v[72:75], a[152:155], v[112:115]
    buffer_load_dwordx4 a[220:223], v242, s[4:7], s85 offen offset:3072 sc1
    s_add_u32 s85, s85, 4096
    v_mfma_f32_16x16x32_bf16 v[116:119], v[60:63], a[156:159], v[116:119]
    ds_read2st64_b64 v[52:55], v5 offset0:98 offset1:99
    v_mfma_f32_16x16x32_bf16 v[120:123], v[64:67], a[156:159], v[120:123]
    ds_read_b64 v[56:57], v6 offset:29696
    v_mfma_f32_16x16x32_bf16 v[124:127], v[68:71], a[156:159], v[124:127]
    ds_read_b64 v[58:59], v6 offset:30208
    v_mfma_f32_16x16x32_bf16 v[128:131], v[72:75], a[156:159], v[128:131]
    buffer_load_dwordx4 a[224:227], v241, s[4:7], s85 offen offset:0 sc1
    s_waitcnt lgkmcnt(4)
    v_mfma_f32_16x16x32_bf16 v[136:139], v[96:99], v[96:99], v[136:139]
    s_waitcnt vmcnt(16) lgkmcnt(3)
    ds_read_b64 v[92:93], v14 offset:12288
    v_mfma_f32_16x16x32_bf16 v[140:143], v[132:135], v[96:99], v[140:143]
    ds_read_b64 v[94:95], v14 offset:12800
    v_mfma_f32_16x16x32_bf16 v[100:103], v[76:79], a[160:163], v[100:103]
    ds_read2st64_b64 v[60:63], v5 offset0:20 offset1:21
    v_mfma_f32_16x16x32_bf16 v[104:107], v[80:83], a[160:163], v[104:107]
    ds_read_b64 v[64:65], v5 offset:30720
    v_mfma_f32_16x16x32_bf16 v[108:111], v[84:87], a[160:163], v[108:111]
    ds_read_b64 v[66:67], v5 offset:31232
    v_mfma_f32_16x16x32_bf16 v[112:115], v[88:91], a[160:163], v[112:115]
    buffer_load_dwordx4 a[228:231], v242, s[4:7], s85 offen offset:0 sc1
    v_mfma_f32_16x16x32_bf16 v[116:119], v[76:79], a[164:167], v[116:119]
    ds_read2st64_b64 v[68:71], v5 offset0:100 offset1:101
    v_mfma_f32_16x16x32_bf16 v[120:123], v[80:83], a[164:167], v[120:123]
    ds_read_b64 v[72:73], v6 offset:30720
    v_mfma_f32_16x16x32_bf16 v[124:127], v[84:87], a[164:167], v[124:127]
    ds_read_b64 v[74:75], v6 offset:31232
    v_mfma_f32_16x16x32_bf16 v[128:131], v[88:91], a[164:167], v[128:131]
    buffer_load_dwordx4 a[232:235], v241, s[4:7], s85 offen offset:1024 sc1
    s_waitcnt lgkmcnt(4)
    v_mfma_f32_16x16x32_bf16 v[136:139], v[92:95], v[92:95], v[136:139]
    s_waitcnt vmcnt(17) lgkmcnt(3)
    ds_read_b64 v[96:97], v14 offset:13312
    v_mfma_f32_16x16x32_bf16 v[140:143], v[132:135], v[92:95], v[140:143]
    ds_read_b64 v[98:99], v14 offset:13824
    v_mfma_f32_16x16x32_bf16 v[100:103], v[44:47], a[168:171], v[100:103]
    ds_read2st64_b64 v[76:79], v5 offset0:22 offset1:23
    v_mfma_f32_16x16x32_bf16 v[104:107], v[48:51], a[168:171], v[104:107]
    ds_read_b64 v[80:81], v5 offset:31744
    v_mfma_f32_16x16x32_bf16 v[108:111], v[52:55], a[168:171], v[108:111]
    ds_read_b64 v[82:83], v5 offset:32256
    v_mfma_f32_16x16x32_bf16 v[112:115], v[56:59], a[168:171], v[112:115]
    buffer_load_dwordx4 a[236:239], v242, s[4:7], s85 offen offset:1024 sc1
    v_mfma_f32_16x16x32_bf16 v[116:119], v[44:47], a[172:175], v[116:119]
    ds_read2st64_b64 v[84:87], v5 offset0:102 offset1:103
    v_mfma_f32_16x16x32_bf16 v[120:123], v[48:51], a[172:175], v[120:123]
    ds_read_b64 v[88:89], v6 offset:31744
    v_mfma_f32_16x16x32_bf16 v[124:127], v[52:55], a[172:175], v[124:127]
    ds_read_b64 v[90:91], v6 offset:32256
    v_mfma_f32_16x16x32_bf16 v[128:131], v[56:59], a[172:175], v[128:131]
    buffer_load_dwordx4 a[240:243], v241, s[4:7], s85 offen offset:2048 sc1
    s_waitcnt lgkmcnt(4)
    v_mfma_f32_16x16x32_bf16 v[136:139], v[96:99], v[96:99], v[136:139]
    s_waitcnt vmcnt(18) lgkmcnt(3)
    ds_read_b64 v[92:93], v14 offset:14336
    v_mfma_f32_16x16x32_bf16 v[140:143], v[132:135], v[96:99], v[140:143]
    ds_read_b64 v[94:95], v14 offset:14848
    s_waitcnt vmcnt(17)
    s_barrier
    v_mfma_f32_16x16x32_bf16 v[100:103], v[60:63], a[176:179], v[100:103]
    ds_read2st64_b64 v[44:47], v5 offset0:24 offset1:25
    v_mfma_f32_16x16x32_bf16 v[104:107], v[64:67], a[176:179], v[104:107]
    ds_read_b64 v[48:49], v5 offset:32768
    v_mfma_f32_16x16x32_bf16 v[108:111], v[68:71], a[176:179], v[108:111]
    ds_read_b64 v[50:51], v5 offset:33280
    v_mfma_f32_16x16x32_bf16 v[112:115], v[72:75], a[176:179], v[112:115]
    buffer_load_dwordx4 a[244:247], v242, s[4:7], s85 offen offset:2048 sc1
    v_mfma_f32_16x16x32_bf16 v[116:119], v[60:63], a[180:183], v[116:119]
    ds_read2st64_b64 v[52:55], v5 offset0:104 offset1:105
    v_mfma_f32_16x16x32_bf16 v[120:123], v[64:67], a[180:183], v[120:123]
    ds_read_b64 v[56:57], v6 offset:32768
    v_mfma_f32_16x16x32_bf16 v[124:127], v[68:71], a[180:183], v[124:127]
    ds_read_b64 v[58:59], v6 offset:33280
    v_mfma_f32_16x16x32_bf16 v[128:131], v[72:75], a[180:183], v[128:131]
    buffer_load_dwordx4 a[248:251], v241, s[4:7], s85 offen offset:3072 sc1
    s_waitcnt lgkmcnt(4)
    v_mfma_f32_16x16x32_bf16 v[136:139], v[92:95], v[92:95], v[136:139]
    ds_read_b64 v[96:97], v14 offset:15360
    v_mfma_f32_16x16x32_bf16 v[140:143], v[132:135], v[92:95], v[140:143]
    ds_read_b64 v[98:99], v14 offset:15872
    v_mfma_f32_16x16x32_bf16 v[100:103], v[76:79], a[184:187], v[100:103]
    ds_read2st64_b64 v[60:63], v5 offset0:26 offset1:27
    v_mfma_f32_16x16x32_bf16 v[104:107], v[80:83], a[184:187], v[104:107]
    ds_read_b64 v[64:65], v5 offset:33792
    v_mfma_f32_16x16x32_bf16 v[108:111], v[84:87], a[184:187], v[108:111]
    ds_read_b64 v[66:67], v5 offset:34304
    v_mfma_f32_16x16x32_bf16 v[112:115], v[88:91], a[184:187], v[112:115]
    buffer_load_dwordx4 a[252:255], v242, s[4:7], s85 offen offset:3072 sc1
    s_sub_u32 s85, s85, 159744
    v_mfma_f32_16x16x32_bf16 v[116:119], v[76:79], a[188:191], v[116:119]
    ds_read2st64_b64 v[68:71], v5 offset0:106 offset1:107
    v_mfma_f32_16x16x32_bf16 v[120:123], v[80:83], a[188:191], v[120:123]
    ds_read_b64 v[72:73], v6 offset:33792
    v_mfma_f32_16x16x32_bf16 v[124:127], v[84:87], a[188:191], v[124:127]
    ds_read_b64 v[74:75], v6 offset:34304
    v_mfma_f32_16x16x32_bf16 v[128:131], v[88:91], a[188:191], v[128:131]
    buffer_load_dwordx4 a[96:99], v241, s[4:7], s85 offen offset:0 sc1
    s_waitcnt lgkmcnt(4)
    v_mfma_f32_16x16x32_bf16 v[136:139], v[96:99], v[96:99], v[136:139]
    s_waitcnt vmcnt(20) lgkmcnt(3)
    ds_read_b64 v[92:93], v14 offset:16384
    v_mfma_f32_16x16x32_bf16 v[140:143], v[132:135], v[96:99], v[140:143]
    ds_read_b64 v[94:95], v14 offset:16896
    s_waitcnt vmcnt(15)
    v_mfma_f32_16x16x32_bf16 v[100:103], v[44:47], a[192:195], v[100:103]
    ds_read2st64_b64 v[76:79], v5 offset0:28 offset1:29
    v_mfma_f32_16x16x32_bf16 v[104:107], v[48:51], a[192:195], v[104:107]
    ds_read_b64 v[80:81], v5 offset:34816
    v_mfma_f32_16x16x32_bf16 v[108:111], v[52:55], a[192:195], v[108:111]
    ds_read_b64 v[82:83], v5 offset:35328
    v_mfma_f32_16x16x32_bf16 v[112:115], v[56:59], a[192:195], v[112:115]
    buffer_load_dwordx4 a[100:103], v242, s[4:7], s85 offen offset:0 sc1
    v_mfma_f32_16x16x32_bf16 v[116:119], v[44:47], a[196:199], v[116:119]
    ds_read2st64_b64 v[84:87], v5 offset0:108 offset1:109
    v_mfma_f32_16x16x32_bf16 v[120:123], v[48:51], a[196:199], v[120:123]
    ds_read_b64 v[88:89], v6 offset:34816
    v_mfma_f32_16x16x32_bf16 v[124:127], v[52:55], a[196:199], v[124:127]
    ds_read_b64 v[90:91], v6 offset:35328
    v_mfma_f32_16x16x32_bf16 v[128:131], v[56:59], a[196:199], v[128:131]
    buffer_load_dwordx4 a[104:107], v241, s[4:7], s85 offen offset:1024 sc1
    s_waitcnt lgkmcnt(4)
    v_mfma_f32_16x16x32_bf16 v[136:139], v[92:95], v[92:95], v[136:139]
    ds_read_b64 v[96:97], v14 offset:17408
    v_mfma_f32_16x16x32_bf16 v[140:143], v[132:135], v[92:95], v[140:143]
    ds_read_b64 v[98:99], v14 offset:17920
    s_waitcnt vmcnt(15) lgkmcnt(5)
    v_mfma_f32_16x16x32_bf16 v[100:103], v[60:63], a[200:203], v[100:103]
    ds_read2st64_b64 v[44:47], v5 offset0:30 offset1:31
    v_mfma_f32_16x16x32_bf16 v[104:107], v[64:67], a[200:203], v[104:107]
    ds_read_b64 v[48:49], v5 offset:35840
    v_mfma_f32_16x16x32_bf16 v[108:111], v[68:71], a[200:203], v[108:111]
    ds_read_b64 v[50:51], v5 offset:36352
    v_mfma_f32_16x16x32_bf16 v[112:115], v[72:75], a[200:203], v[112:115]
    buffer_load_dwordx4 a[108:111], v242, s[4:7], s85 offen offset:1024 sc1
    v_mfma_f32_16x16x32_bf16 v[116:119], v[60:63], a[204:207], v[116:119]
    ds_read2st64_b64 v[52:55], v5 offset0:110 offset1:111
    v_mfma_f32_16x16x32_bf16 v[120:123], v[64:67], a[204:207], v[120:123]
    ds_read_b64 v[56:57], v6 offset:35840
    v_mfma_f32_16x16x32_bf16 v[124:127], v[68:71], a[204:207], v[124:127]
    ds_read_b64 v[58:59], v6 offset:36352
    v_mfma_f32_16x16x32_bf16 v[128:131], v[72:75], a[204:207], v[128:131]
    buffer_load_dwordx4 a[112:115], v241, s[4:7], s85 offen offset:2048 sc1
    s_waitcnt lgkmcnt(4)
    v_mfma_f32_16x16x32_bf16 v[136:139], v[96:99], v[96:99], v[136:139]
    ds_read_b64 v[92:93], v14 offset:18432
    v_mfma_f32_16x16x32_bf16 v[140:143], v[132:135], v[96:99], v[140:143]
    ds_read_b64 v[94:95], v14 offset:18944
    s_barrier
    s_waitcnt vmcnt(15) lgkmcnt(5)
    v_mfma_f32_16x16x32_bf16 v[100:103], v[76:79], a[208:211], v[100:103]
    ds_read2st64_b64 v[60:63], v5 offset0:32 offset1:33
    v_mfma_f32_16x16x32_bf16 v[104:107], v[80:83], a[208:211], v[104:107]
    ds_read_b64 v[64:65], v5 offset:36864
    v_mfma_f32_16x16x32_bf16 v[108:111], v[84:87], a[208:211], v[108:111]
    ds_read_b64 v[66:67], v5 offset:37376
    v_mfma_f32_16x16x32_bf16 v[112:115], v[88:91], a[208:211], v[112:115]
    buffer_load_dwordx4 a[116:119], v242, s[4:7], s85 offen offset:2048 sc1
    v_mfma_f32_16x16x32_bf16 v[116:119], v[76:79], a[212:215], v[116:119]
    ds_read2st64_b64 v[68:71], v5 offset0:112 offset1:113
    v_mfma_f32_16x16x32_bf16 v[120:123], v[80:83], a[212:215], v[120:123]
    ds_read_b64 v[72:73], v6 offset:36864
    v_mfma_f32_16x16x32_bf16 v[124:127], v[84:87], a[212:215], v[124:127]
    ds_read_b64 v[74:75], v6 offset:37376
    v_mfma_f32_16x16x32_bf16 v[128:131], v[88:91], a[212:215], v[128:131]
    buffer_load_dwordx4 a[120:123], v241, s[4:7], s85 offen offset:3072 sc1
    s_waitcnt lgkmcnt(4)
    v_mfma_f32_16x16x32_bf16 v[136:139], v[92:95], v[92:95], v[136:139]
    ds_read_b64 v[96:97], v14 offset:19456
    v_mfma_f32_16x16x32_bf16 v[140:143], v[132:135], v[92:95], v[140:143]
    ds_read_b64 v[98:99], v14 offset:19968
    s_waitcnt vmcnt(15) lgkmcnt(5)
    v_mfma_f32_16x16x32_bf16 v[100:103], v[44:47], a[216:219], v[100:103]
    ds_read2st64_b64 v[76:79], v5 offset0:34 offset1:35
    v_mfma_f32_16x16x32_bf16 v[104:107], v[48:51], a[216:219], v[104:107]
    ds_read_b64 v[80:81], v5 offset:37888
    v_mfma_f32_16x16x32_bf16 v[108:111], v[52:55], a[216:219], v[108:111]
    ds_read_b64 v[82:83], v5 offset:38400
    v_mfma_f32_16x16x32_bf16 v[112:115], v[56:59], a[216:219], v[112:115]
    buffer_load_dwordx4 a[124:127], v242, s[4:7], s85 offen offset:3072 sc1
    s_add_u32 s85, s85, 4096
    v_mfma_f32_16x16x32_bf16 v[116:119], v[44:47], a[220:223], v[116:119]
    ds_read2st64_b64 v[84:87], v5 offset0:114 offset1:115
    v_mfma_f32_16x16x32_bf16 v[120:123], v[48:51], a[220:223], v[120:123]
    ds_read_b64 v[88:89], v6 offset:37888
    v_mfma_f32_16x16x32_bf16 v[124:127], v[52:55], a[220:223], v[124:127]
    ds_read_b64 v[90:91], v6 offset:38400
    v_mfma_f32_16x16x32_bf16 v[128:131], v[56:59], a[220:223], v[128:131]
    buffer_load_dwordx4 a[128:131], v241, s[4:7], s85 offen offset:0 sc1
    s_waitcnt lgkmcnt(4)
    v_mfma_f32_16x16x32_bf16 v[136:139], v[96:99], v[96:99], v[136:139]
    v_mfma_f32_16x16x32_bf16 v[140:143], v[132:135], v[96:99], v[140:143]
    s_waitcnt vmcnt(15) lgkmcnt(3)
    v_mfma_f32_16x16x32_bf16 v[100:103], v[60:63], a[224:227], v[100:103]
    ds_read2st64_b64 v[44:47], v5 offset0:36 offset1:37
    v_mfma_f32_16x16x32_bf16 v[104:107], v[64:67], a[224:227], v[104:107]
    ds_read_b64 v[48:49], v5 offset:38912
    v_mfma_f32_16x16x32_bf16 v[108:111], v[68:71], a[224:227], v[108:111]
    ds_read_b64 v[50:51], v5 offset:39424
    v_mfma_f32_16x16x32_bf16 v[112:115], v[72:75], a[224:227], v[112:115]
    buffer_load_dwordx4 a[132:135], v242, s[4:7], s85 offen offset:0 sc1
    v_mfma_f32_16x16x32_bf16 v[116:119], v[60:63], a[228:231], v[116:119]
    ds_read2st64_b64 v[52:55], v5 offset0:116 offset1:117
    v_mfma_f32_16x16x32_bf16 v[120:123], v[64:67], a[228:231], v[120:123]
    ds_read_b64 v[56:57], v6 offset:38912
    v_mfma_f32_16x16x32_bf16 v[124:127], v[68:71], a[228:231], v[124:127]
    ds_read_b64 v[58:59], v6 offset:39424
    v_mfma_f32_16x16x32_bf16 v[128:131], v[72:75], a[228:231], v[128:131]
    buffer_load_dwordx4 a[136:139], v241, s[4:7], s85 offen offset:1024 sc1
    s_waitcnt vmcnt(15) lgkmcnt(4)
    v_mfma_f32_16x16x32_bf16 v[100:103], v[76:79], a[232:235], v[100:103]
    ds_read2st64_b64 v[60:63], v5 offset0:38 offset1:39
    v_and_b32 v3, 3, v0
    v_mfma_f32_16x16x32_bf16 v[104:107], v[80:83], a[232:235], v[104:107]
    ds_read_b64 v[64:65], v5 offset:39936
    v_cmp_eq_u32 vcc, 1, v3
    v_mfma_f32_16x16x32_bf16 v[108:111], v[84:87], a[232:235], v[108:111]
    ds_read_b64 v[66:67], v5 offset:40448
    v_cndmask_b32 v136, v136, v137, vcc
    v_mfma_f32_16x16x32_bf16 v[112:115], v[88:91], a[232:235], v[112:115]
    buffer_load_dwordx4 a[140:143], v242, s[4:7], s85 offen offset:1024 sc1
    v_mfma_f32_16x16x32_bf16 v[116:119], v[76:79], a[236:239], v[116:119]
    ds_read2st64_b64 v[68:71], v5 offset0:118 offset1:119
    v_cmp_eq_u32 vcc, 2, v3
    v_mfma_f32_16x16x32_bf16 v[120:123], v[80:83], a[236:239], v[120:123]
    ds_read_b64 v[72:73], v6 offset:39936
    v_cndmask_b32 v136, v136, v138, vcc
    v_mfma_f32_16x16x32_bf16 v[124:127], v[84:87], a[236:239], v[124:127]
    ds_read_b64 v[74:75], v6 offset:40448
    v_cmp_eq_u32 vcc, 3, v3
    v_mfma_f32_16x16x32_bf16 v[128:131], v[88:91], a[236:239], v[128:131]
    buffer_load_dwordx4 a[144:147], v241, s[4:7], s85 offen offset:2048 sc1
    v_cndmask_b32 v136, v136, v139, vcc
    v_mul_f32 v140, 0xbacccccd, v140
    v_mul_f32 v136, 0x3acccccd, v136
    v_fma_f32 v136, -v140, v140, v136
    v_max_f32 v136, 0, v136
    v_add_f32 v136, 0x3727c5ac, v136
    v_rsq_f32 v136, v136
    v_lshrrev_b32 v3, 2, v1
    v_cmp_eq_u32 vcc, v3, v2
    s_lshl_b32 s62, s82, 6
    s_add_u32 s62, s62, 81920
    v_lshl_add_u32 v3, v1, 2, s62
    s_mov_b64 exec, vcc
    ds_write2st64_b32 v3, v136, v140 offset0:0 offset1:1
    s_mov_b64 exec, -1
    s_waitcnt vmcnt(15) lgkmcnt(3)
    v_mfma_f32_16x16x32_bf16 v[100:103], v[44:47], a[240:243], v[100:103]
    s_lshl_b32 s62, s82, 7
    s_add_u32 s62, s62, 86528
    v_add_u32 v3, s62, v12
    v_mfma_f32_16x16x32_bf16 v[104:107], v[48:51], a[240:243], v[104:107]
    v_add_u32 v4, s62, v7
    v_mfma_f32_16x16x32_bf16 v[108:111], v[52:55], a[240:243], v[108:111]
    ds_read_b32 v212, v3 offset:1024
    v_mfma_f32_16x16x32_bf16 v[112:115], v[56:59], a[240:243], v[112:115]
    ds_read_b32 v213, v3 offset:1536
    v_mfma_f32_16x16x32_bf16 v[116:119], v[44:47], a[244:247], v[116:119]
    ds_read_b128 v[196:199], v4 offset:0
    v_mfma_f32_16x16x32_bf16 v[120:123], v[48:51], a[244:247], v[120:123]
    ds_read_b128 v[204:207], v4 offset:512
    v_mfma_f32_16x16x32_bf16 v[124:127], v[52:55], a[244:247], v[124:127]
    ds_read_b32 v214, v3 offset:1088
    v_mfma_f32_16x16x32_bf16 v[128:131], v[56:59], a[244:247], v[128:131]
    ds_read_b32 v215, v3 offset:1600
    s_waitcnt vmcnt(13) lgkmcnt(6)
    v_mfma_f32_16x16x32_bf16 v[100:103], v[60:63], a[248:251], v[100:103]
    ds_read_b128 v[200:203], v4 offset:64
    v_mfma_f32_16x16x32_bf16 v[104:107], v[64:67], a[248:251], v[104:107]
    ds_read_b128 v[208:211], v4 offset:576
    v_mfma_f32_16x16x32_bf16 v[108:111], v[68:71], a[248:251], v[108:111]
    v_mfma_f32_16x16x32_bf16 v[112:115], v[72:75], a[248:251], v[112:115]
    buffer_load_dwordx4 a[148:151], v242, s[4:7], s85 offen offset:2048 sc1
    v_mfma_f32_16x16x32_bf16 v[116:119], v[60:63], a[252:255], v[116:119]
    v_mfma_f32_16x16x32_bf16 v[120:123], v[64:67], a[252:255], v[120:123]
    v_mfma_f32_16x16x32_bf16 v[124:127], v[68:71], a[252:255], v[124:127]
    v_mfma_f32_16x16x32_bf16 v[128:131], v[72:75], a[252:255], v[128:131]
    buffer_load_dwordx4 a[152:155], v241, s[4:7], s85 offen offset:3072 sc1
    s_barrier
    v_add_u32 v3, 81920, v7
    ds_read_b128 v[180:183], v3 offset:256
    ds_read_b128 v[164:167], v3 offset:0
    ds_read_b128 v[184:187], v3 offset:320
    ds_read_b128 v[168:171], v3 offset:64
    ds_read_b128 v[188:191], v3 offset:384
    ds_read_b128 v[172:175], v3 offset:128
    ds_read_b128 v[192:195], v3 offset:448
    ds_read_b128 v[176:179], v3 offset:192
    s_waitcnt lgkmcnt(7)
    v_pk_fma_f32 v[100:101], v[180:181], v[212:213], v[100:101] op_sel:[0,0,0] op_sel_hi:[1,0,1]
    v_pk_fma_f32 v[102:103], v[182:183], v[212:213], v[102:103] op_sel:[0,0,0] op_sel_hi:[1,0,1]
    buffer_load_dwordx4 a[156:159], v242, s[4:7], s85 offen offset:3072 sc1
    s_add_u32 s85, s85, 4096
    v_pk_fma_f32 v[116:117], v[180:181], v[214:215], v[116:117] op_sel:[0,0,0] op_sel_hi:[1,0,1]
    v_pk_fma_f32 v[118:119], v[182:183], v[214:215], v[118:119] op_sel:[0,0,0] op_sel_hi:[1,0,1]
    s_waitcnt lgkmcnt(6)
    v_pk_fma_f32 v[100:101], v[100:101], v[164:165], v[212:213] op_sel:[0,0,1] op_sel_hi:[1,1,1]
    v_pk_fma_f32 v[102:103], v[102:103], v[166:167], v[212:213] op_sel:[0,0,1] op_sel_hi:[1,1,1]
    v_pk_fma_f32 v[116:117], v[116:117], v[164:165], v[214:215] op_sel:[0,0,1] op_sel_hi:[1,1,1]
    v_pk_fma_f32 v[118:119], v[118:119], v[166:167], v[214:215] op_sel:[0,0,1] op_sel_hi:[1,1,1]
    v_pk_mul_f32 v[216:217], v[100:101], v[100:101]
    v_pk_mul_f32 v[218:219], v[102:103], v[102:103]
    v_pk_mul_f32 v[220:221], v[116:117], v[116:117]
    v_pk_mul_f32 v[222:223], v[118:119], v[118:119]
    v_pk_fma_f32 v[216:217], v[216:217], s[66:67], s[66:67] op_sel:[0,0,1] op_sel_hi:[1,0,1]
    buffer_load_dwordx4 a[160:163], v241, s[4:7], s85 offen offset:0 sc1
    v_pk_fma_f32 v[218:219], v[218:219], s[66:67], s[66:67] op_sel:[0,0,1] op_sel_hi:[1,0,1]
    v_pk_fma_f32 v[220:221], v[220:221], s[66:67], s[66:67] op_sel:[0,0,1] op_sel_hi:[1,0,1]
    v_pk_fma_f32 v[222:223], v[222:223], s[66:67], s[66:67] op_sel:[0,0,1] op_sel_hi:[1,0,1]
    v_pk_mul_f32 v[216:217], v[216:217], v[100:101]
    v_pk_mul_f32 v[218:219], v[218:219], v[102:103]
    v_pk_mul_f32 v[220:221], v[220:221], v[116:117]
    v_pk_mul_f32 v[222:223], v[222:223], v[118:119]
    v_exp_f32 v216, v216
    v_exp_f32 v217, v217
    v_exp_f32 v218, v218
    v_exp_f32 v219, v219
    buffer_load_dwordx4 a[164:167], v242, s[4:7], s85 offen offset:0 sc1
    v_exp_f32 v220, v220
    v_exp_f32 v221, v221
    v_exp_f32 v222, v222
    v_exp_f32 v223, v223
    v_pk_add_f32 v[216:217], v[216:217], s[68:69]
    v_pk_add_f32 v[218:219], v[218:219], s[68:69]
    v_pk_add_f32 v[220:221], v[220:221], s[68:69]
    v_pk_add_f32 v[222:223], v[222:223], s[68:69]
    v_rcp_f32 v216, v216
    v_rcp_f32 v217, v217
    v_rcp_f32 v218, v218
    buffer_load_dwordx4 a[168:171], v241, s[4:7], s85 offen offset:1024 sc1
    v_rcp_f32 v219, v219
    v_rcp_f32 v220, v220
    v_rcp_f32 v221, v221
    v_rcp_f32 v222, v222
    v_rcp_f32 v223, v223
    v_pk_mul_f32 v[100:101], v[100:101], v[216:217]
    v_pk_mul_f32 v[102:103], v[102:103], v[218:219]
    v_pk_mul_f32 v[116:117], v[116:117], v[220:221]
    v_pk_mul_f32 v[118:119], v[118:119], v[222:223]
    v_pk_add_f32 v[164:165], v[100:101], v[116:117]
    v_pk_mul_f32 v[180:181], v[100:101], v[100:101]
    buffer_load_dwordx4 a[172:175], v242, s[4:7], s85 offen offset:1024 sc1
    v_pk_add_f32 v[166:167], v[102:103], v[118:119]
    v_pk_mul_f32 v[182:183], v[102:103], v[102:103]
    v_pk_fma_f32 v[180:181], v[116:117], v[116:117], v[180:181]
    v_pk_fma_f32 v[182:183], v[118:119], v[118:119], v[182:183]
    s_waitcnt lgkmcnt(0)
    v_pk_fma_f32 v[104:105], v[184:185], v[212:213], v[104:105] op_sel:[0,0,0] op_sel_hi:[1,0,1]
    v_pk_fma_f32 v[106:107], v[186:187], v[212:213], v[106:107] op_sel:[0,0,0] op_sel_hi:[1,0,1]
    v_pk_fma_f32 v[120:121], v[184:185], v[214:215], v[120:121] op_sel:[0,0,0] op_sel_hi:[1,0,1]
    v_pk_fma_f32 v[122:123], v[186:187], v[214:215], v[122:123] op_sel:[0,0,0] op_sel_hi:[1,0,1]
    v_pk_fma_f32 v[104:105], v[104:105], v[168:169], v[212:213] op_sel:[0,0,1] op_sel_hi:[1,1,1]
    v_pk_fma_f32 v[106:107], v[106:107], v[170:171], v[212:213] op_sel:[0,0,1] op_sel_hi:[1,1,1]
    v_pk_fma_f32 v[120:121], v[120:121], v[168:169], v[214:215] op_sel:[0,0,1] op_sel_hi:[1,1,1]
    buffer_load_dwordx4 a[176:179], v241, s[4:7], s85 offen offset:2048 sc1
    v_pk_fma_f32 v[122:123], v[122:123], v[170:171], v[214:215] op_sel:[0,0,1] op_sel_hi:[1,1,1]
    v_pk_mul_f32 v[216:217], v[104:105], v[104:105]
    v_pk_mul_f32 v[218:219], v[106:107], v[106:107]
    v_pk_mul_f32 v[220:221], v[120:121], v[120:121]
    v_pk_mul_f32 v[222:223], v[122:123], v[122:123]
    v_pk_fma_f32 v[216:217], v[216:217], s[66:67], s[66:67] op_sel:[0,0,1] op_sel_hi:[1,0,1]
    v_pk_fma_f32 v[218:219], v[218:219], s[66:67], s[66:67] op_sel:[0,0,1] op_sel_hi:[1,0,1]
    v_pk_fma_f32 v[220:221], v[220:221], s[66:67], s[66:67] op_sel:[0,0,1] op_sel_hi:[1,0,1]
    v_pk_fma_f32 v[222:223], v[222:223], s[66:67], s[66:67] op_sel:[0,0,1] op_sel_hi:[1,0,1]
    v_pk_mul_f32 v[216:217], v[216:217], v[104:105]
    v_pk_mul_f32 v[218:219], v[218:219], v[106:107]
    buffer_load_dwordx4 a[180:183], v242, s[4:7], s85 offen offset:2048 sc1
    v_pk_mul_f32 v[220:221], v[220:221], v[120:121]
    v_pk_mul_f32 v[222:223], v[222:223], v[122:123]
    v_exp_f32 v216, v216
    v_exp_f32 v217, v217
    v_exp_f32 v218, v218
    v_exp_f32 v219, v219
    v_exp_f32 v220, v220
    v_exp_f32 v221, v221
    v_exp_f32 v222, v222
    v_exp_f32 v223, v223
    v_pk_add_f32 v[216:217], v[216:217], s[68:69]
    buffer_load_dwordx4 a[184:187], v241, s[4:7], s85 offen offset:3072 sc1
    v_pk_add_f32 v[218:219], v[218:219], s[68:69]
    v_pk_add_f32 v[220:221], v[220:221], s[68:69]
    v_pk_add_f32 v[222:223], v[222:223], s[68:69]
    v_rcp_f32 v216, v216
    v_rcp_f32 v217, v217
    v_rcp_f32 v218, v218
    v_rcp_f32 v219, v219
    v_rcp_f32 v220, v220
    v_rcp_f32 v221, v221
    v_rcp_f32 v222, v222
    v_rcp_f32 v223, v223
    buffer_load_dwordx4 a[188:191], v242, s[4:7], s85 offen offset:3072 sc1
    s_add_u32 s85, s85, 4096
    v_pk_mul_f32 v[104:105], v[104:105], v[216:217]
    v_pk_mul_f32 v[106:107], v[106:107], v[218:219]
    v_pk_mul_f32 v[120:121], v[120:121], v[220:221]
    v_pk_mul_f32 v[122:123], v[122:123], v[222:223]
    v_pk_add_f32 v[168:169], v[104:105], v[120:121]
    v_pk_mul_f32 v[184:185], v[104:105], v[104:105]
    v_pk_add_f32 v[170:171], v[106:107], v[122:123]
    v_pk_mul_f32 v[186:187], v[106:107], v[106:107]
    v_pk_fma_f32 v[184:185], v[120:121], v[120:121], v[184:185]
    v_pk_fma_f32 v[186:187], v[122:123], v[122:123], v[186:187]
    v_pk_fma_f32 v[108:109], v[188:189], v[212:213], v[108:109] op_sel:[0,0,0] op_sel_hi:[1,0,1]
    buffer_load_dwordx4 a[192:195], v241, s[4:7], s85 offen offset:0 sc1
    v_pk_fma_f32 v[110:111], v[190:191], v[212:213], v[110:111] op_sel:[0,0,0] op_sel_hi:[1,0,1]
    v_pk_fma_f32 v[124:125], v[188:189], v[214:215], v[124:125] op_sel:[0,0,0] op_sel_hi:[1,0,1]
    v_pk_fma_f32 v[126:127], v[190:191], v[214:215], v[126:127] op_sel:[0,0,0] op_sel_hi:[1,0,1]
    v_pk_fma_f32 v[108:109], v[108:109], v[172:173], v[212:213] op_sel:[0,0,1] op_sel_hi:[1,1,1]
    v_pk_fma_f32 v[110:111], v[110:111], v[174:175], v[212:213] op_sel:[0,0,1] op_sel_hi:[1,1,1]
    v_pk_fma_f32 v[124:125], v[124:125], v[172:173], v[214:215] op_sel:[0,0,1] op_sel_hi:[1,1,1]
    v_pk_fma_f32 v[126:127], v[126:127], v[174:175], v[214:215] op_sel:[0,0,1] op_sel_hi:[1,1,1]
    v_pk_mul_f32 v[216:217], v[108:109], v[108:109]
    v_pk_mul_f32 v[218:219], v[110:111], v[110:111]
    v_pk_mul_f32 v[220:221], v[124:125], v[124:125]
    v_pk_mul_f32 v[222:223], v[126:127], v[126:127]
    buffer_load_dwordx4 a[196:199], v242, s[4:7], s85 offen offset:0 sc1
    v_pk_fma_f32 v[216:217], v[216:217], s[66:67], s[66:67] op_sel:[0,0,1] op_sel_hi:[1,0,1]
    v_pk_fma_f32 v[218:219], v[218:219], s[66:67], s[66:67] op_sel:[0,0,1] op_sel_hi:[1,0,1]
    v_pk_fma_f32 v[220:221], v[220:221], s[66:67], s[66:67] op_sel:[0,0,1] op_sel_hi:[1,0,1]
    v_pk_fma_f32 v[222:223], v[222:223], s[66:67], s[66:67] op_sel:[0,0,1] op_sel_hi:[1,0,1]
    v_pk_mul_f32 v[216:217], v[216:217], v[108:109]
    v_pk_mul_f32 v[218:219], v[218:219], v[110:111]
    v_pk_mul_f32 v[220:221], v[220:221], v[124:125]
    v_pk_mul_f32 v[222:223], v[222:223], v[126:127]
    v_exp_f32 v216, v216
    v_exp_f32 v217, v217
    v_exp_f32 v218, v218
    buffer_load_dwordx4 a[200:203], v241, s[4:7], s85 offen offset:1024 sc1
    v_exp_f32 v219, v219
    v_exp_f32 v220, v220
    v_exp_f32 v221, v221
    v_exp_f32 v222, v222
    v_exp_f32 v223, v223
    v_pk_add_f32 v[216:217], v[216:217], s[68:69]
    v_pk_add_f32 v[218:219], v[218:219], s[68:69]
    v_pk_add_f32 v[220:221], v[220:221], s[68:69]
    v_pk_add_f32 v[222:223], v[222:223], s[68:69]
    v_rcp_f32 v216, v216
    v_rcp_f32 v217, v217
    buffer_load_dwordx4 a[204:207], v242, s[4:7], s85 offen offset:1024 sc1
    v_rcp_f32 v218, v218
    v_rcp_f32 v219, v219
    v_rcp_f32 v220, v220
    v_rcp_f32 v221, v221
    v_rcp_f32 v222, v222
    v_rcp_f32 v223, v223
    v_pk_mul_f32 v[108:109], v[108:109], v[216:217]
    v_pk_mul_f32 v[110:111], v[110:111], v[218:219]
    v_pk_mul_f32 v[124:125], v[124:125], v[220:221]
    v_pk_mul_f32 v[126:127], v[126:127], v[222:223]
    v_pk_add_f32 v[172:173], v[108:109], v[124:125]
    buffer_load_dwordx4 a[208:211], v241, s[4:7], s85 offen offset:2048 sc1
    v_pk_mul_f32 v[188:189], v[108:109], v[108:109]
    v_pk_add_f32 v[174:175], v[110:111], v[126:127]
    v_pk_mul_f32 v[190:191], v[110:111], v[110:111]
    v_pk_fma_f32 v[188:189], v[124:125], v[124:125], v[188:189]
    v_pk_fma_f32 v[190:191], v[126:127], v[126:127], v[190:191]
    v_pk_fma_f32 v[112:113], v[192:193], v[212:213], v[112:113] op_sel:[0,0,0] op_sel_hi:[1,0,1]
    v_pk_fma_f32 v[114:115], v[194:195], v[212:213], v[114:115] op_sel:[0,0,0] op_sel_hi:[1,0,1]
    v_pk_fma_f32 v[128:129], v[192:193], v[214:215], v[128:129] op_sel:[0,0,0] op_sel_hi:[1,0,1]
    v_pk_fma_f32 v[130:131], v[194:195], v[214:215], v[130:131] op_sel:[0,0,0] op_sel_hi:[1,0,1]
    v_pk_fma_f32 v[112:113], v[112:113], v[176:177], v[212:213] op_sel:[0,0,1] op_sel_hi:[1,1,1]
    v_pk_fma_f32 v[114:115], v[114:115], v[178:179], v[212:213] op_sel:[0,0,1] op_sel_hi:[1,1,1]
    buffer_load_dwordx4 a[212:215], v242, s[4:7], s85 offen offset:2048 sc1
    v_pk_fma_f32 v[128:129], v[128:129], v[176:177], v[214:215] op_sel:[0,0,1] op_sel_hi:[1,1,1]
    v_pk_fma_f32 v[130:131], v[130:131], v[178:179], v[214:215] op_sel:[0,0,1] op_sel_hi:[1,1,1]
    v_pk_mul_f32 v[216:217], v[112:113], v[112:113]
    v_pk_mul_f32 v[218:219], v[114:115], v[114:115]
    v_pk_mul_f32 v[220:221], v[128:129], v[128:129]
    v_pk_mul_f32 v[222:223], v[130:131], v[130:131]
    v_pk_fma_f32 v[216:217], v[216:217], s[66:67], s[66:67] op_sel:[0,0,1] op_sel_hi:[1,0,1]
    v_pk_fma_f32 v[218:219], v[218:219], s[66:67], s[66:67] op_sel:[0,0,1] op_sel_hi:[1,0,1]
    v_pk_fma_f32 v[220:221], v[220:221], s[66:67], s[66:67] op_sel:[0,0,1] op_sel_hi:[1,0,1]
    v_pk_fma_f32 v[222:223], v[222:223], s[66:67], s[66:67] op_sel:[0,0,1] op_sel_hi:[1,0,1]
    v_pk_mul_f32 v[216:217], v[216:217], v[112:113]
    buffer_load_dwordx4 a[216:219], v241, s[4:7], s85 offen offset:3072 sc1
    v_pk_mul_f32 v[218:219], v[218:219], v[114:115]
    v_pk_mul_f32 v[220:221], v[220:221], v[128:129]
    v_pk_mul_f32 v[222:223], v[222:223], v[130:131]
    v_exp_f32 v216, v216
    v_exp_f32 v217, v217
    v_exp_f32 v218, v218
    v_exp_f32 v219, v219
    v_exp_f32 v220, v220
    v_exp_f32 v221, v221
    v_exp_f32 v222, v222
    v_exp_f32 v223, v223
    buffer_load_dwordx4 a[220:223], v242, s[4:7], s85 offen offset:3072 sc1
    s_add_u32 s85, s85, 4096
    v_pk_add_f32 v[216:217], v[216:217], s[68:69]
    v_pk_add_f32 v[218:219], v[218:219], s[68:69]
    v_pk_add_f32 v[220:221], v[220:221], s[68:69]
    v_pk_add_f32 v[222:223], v[222:223], s[68:69]
    v_rcp_f32 v216, v216
    v_rcp_f32 v217, v217
    v_rcp_f32 v218, v218
    v_rcp_f32 v219, v219
    v_rcp_f32 v220, v220
    v_rcp_f32 v221, v221
    v_rcp_f32 v222, v222
    buffer_load_dwordx4 a[224:227], v241, s[4:7], s85 offen offset:0 sc1
    v_rcp_f32 v223, v223
    v_pk_mul_f32 v[112:113], v[112:113], v[216:217]
    v_pk_mul_f32 v[114:115], v[114:115], v[218:219]
    v_pk_mul_f32 v[128:129], v[128:129], v[220:221]
    v_pk_mul_f32 v[130:131], v[130:131], v[222:223]
    v_pk_add_f32 v[176:177], v[112:113], v[128:129]
    v_pk_mul_f32 v[192:193], v[112:113], v[112:113]
    v_pk_add_f32 v[178:179], v[114:115], v[130:131]
    v_pk_mul_f32 v[194:195], v[114:115], v[114:115]
    v_pk_fma_f32 v[192:193], v[128:129], v[128:129], v[192:193]
    v_pk_fma_f32 v[194:195], v[130:131], v[130:131], v[194:195]
    buffer_load_dwordx4 a[228:231], v242, s[4:7], s85 offen offset:0 sc1
    v_add_f32_dpp v164, v164, v164 row_ror:8 row_mask:0xf bank_mask:3
    v_add_f32_dpp v165, v165, v165 row_ror:8 row_mask:0xf bank_mask:3
    v_add_f32_dpp v166, v166, v166 row_ror:8 row_mask:0xf bank_mask:3
    v_add_f32_dpp v167, v167, v167 row_ror:8 row_mask:0xf bank_mask:3
    v_add_f32_dpp v168, v168, v168 row_ror:8 row_mask:0xf bank_mask:3
    v_add_f32_dpp v169, v169, v169 row_ror:8 row_mask:0xf bank_mask:3
    v_add_f32_dpp v170, v170, v170 row_ror:8 row_mask:0xf bank_mask:3
    v_add_f32_dpp v171, v171, v171 row_ror:8 row_mask:0xf bank_mask:3
    v_add_f32_dpp v172, v172, v172 row_ror:8 row_mask:0xf bank_mask:3
    v_add_f32_dpp v173, v173, v173 row_ror:8 row_mask:0xf bank_mask:3
    v_add_f32_dpp v174, v174, v174 row_ror:8 row_mask:0xf bank_mask:3
    buffer_load_dwordx4 a[232:235], v241, s[4:7], s85 offen offset:1024 sc1
    v_add_f32_dpp v175, v175, v175 row_ror:8 row_mask:0xf bank_mask:3
    v_add_f32_dpp v176, v176, v176 row_ror:8 row_mask:0xf bank_mask:3
    v_add_f32_dpp v177, v177, v177 row_ror:8 row_mask:0xf bank_mask:3
    v_add_f32_dpp v178, v178, v178 row_ror:8 row_mask:0xf bank_mask:3
    v_add_f32_dpp v179, v179, v179 row_ror:8 row_mask:0xf bank_mask:3
    v_add_f32_dpp v164, v180, v180 row_ror:8 row_mask:0xf bank_mask:12
    v_add_f32_dpp v165, v181, v181 row_ror:8 row_mask:0xf bank_mask:12
    v_add_f32_dpp v166, v182, v182 row_ror:8 row_mask:0xf bank_mask:12
    v_add_f32_dpp v167, v183, v183 row_ror:8 row_mask:0xf bank_mask:12
    v_add_f32_dpp v168, v184, v184 row_ror:8 row_mask:0xf bank_mask:12
    v_add_f32_dpp v169, v185, v185 row_ror:8 row_mask:0xf bank_mask:12
    buffer_load_dwordx4 a[236:239], v242, s[4:7], s85 offen offset:1024 sc1
    v_add_f32_dpp v170, v186, v186 row_ror:8 row_mask:0xf bank_mask:12
    v_add_f32_dpp v171, v187, v187 row_ror:8 row_mask:0xf bank_mask:12
    v_add_f32_dpp v172, v188, v188 row_ror:8 row_mask:0xf bank_mask:12
    v_add_f32_dpp v173, v189, v189 row_ror:8 row_mask:0xf bank_mask:12
    v_add_f32_dpp v174, v190, v190 row_ror:8 row_mask:0xf bank_mask:12
    v_add_f32_dpp v175, v191, v191 row_ror:8 row_mask:0xf bank_mask:12
    v_add_f32_dpp v176, v192, v192 row_ror:8 row_mask:0xf bank_mask:12
    v_add_f32_dpp v177, v193, v193 row_ror:8 row_mask:0xf bank_mask:12
    v_add_f32_dpp v178, v194, v194 row_ror:8 row_mask:0xf bank_mask:12
    v_add_f32_dpp v179, v195, v195 row_ror:8 row_mask:0xf bank_mask:12
    v_add_f32_dpp v164, v164, v164 row_half_mirror row_mask:0xf bank_mask:5
    buffer_load_dwordx4 a[240:243], v241, s[4:7], s85 offen offset:2048 sc1
    v_add_f32_dpp v165, v165, v165 row_half_mirror row_mask:0xf bank_mask:5
    v_add_f32_dpp v166, v166, v166 row_half_mirror row_mask:0xf bank_mask:5
    v_add_f32_dpp v167, v167, v167 row_half_mirror row_mask:0xf bank_mask:5
    v_add_f32_dpp v168, v168, v168 row_half_mirror row_mask:0xf bank_mask:5
    v_add_f32_dpp v169, v169, v169 row_half_mirror row_mask:0xf bank_mask:5
    v_add_f32_dpp v170, v170, v170 row_half_mirror row_mask:0xf bank_mask:5
    v_add_f32_dpp v171, v171, v171 row_half_mirror row_mask:0xf bank_mask:5
    v_add_f32_dpp v164, v172, v172 row_half_mirror row_mask:0xf bank_mask:10
    v_add_f32_dpp v165, v173, v173 row_half_mirror row_mask:0xf bank_mask:10
    v_add_f32_dpp v166, v174, v174 row_half_mirror row_mask:0xf bank_mask:10
    v_add_f32_dpp v167, v175, v175 row_half_mirror row_mask:0xf bank_mask:10
    buffer_load_dwordx4 a[244:247], v242, s[4:7], s85 offen offset:2048 sc1
    v_add_f32_dpp v168, v176, v176 row_half_mirror row_mask:0xf bank_mask:10
    v_add_f32_dpp v169, v177, v177 row_half_mirror row_mask:0xf bank_mask:10
    v_add_f32_dpp v170, v178, v178 row_half_mirror row_mask:0xf bank_mask:10
    v_add_f32_dpp v171, v179, v179 row_half_mirror row_mask:0xf bank_mask:10
    v_add_f32_dpp v164, v164, v164 quad_perm:[1,0,3,2] row_mask:0xf bank_mask:0xf
    v_add_f32_dpp v165, v165, v165 quad_perm:[1,0,3,2] row_mask:0xf bank_mask:0xf
    v_add_f32_dpp v166, v166, v166 quad_perm:[1,0,3,2] row_mask:0xf bank_mask:0xf
    v_add_f32_dpp v167, v167, v167 quad_perm:[1,0,3,2] row_mask:0xf bank_mask:0xf
    v_add_f32_dpp v168, v168, v168 quad_perm:[1,0,3,2] row_mask:0xf bank_mask:0xf
    v_add_f32_dpp v169, v169, v169 quad_perm:[1,0,3,2] row_mask:0xf bank_mask:0xf
    v_add_f32_dpp v170, v170, v170 quad_perm:[1,0,3,2] row_mask:0xf bank_mask:0xf
    buffer_load_dwordx4 a[248:251], v241, s[4:7], s85 offen offset:3072 sc1
    v_add_f32_dpp v171, v171, v171 quad_perm:[1,0,3,2] row_mask:0xf bank_mask:0xf
    v_add_f32_dpp v164, v164, v164 quad_perm:[2,3,0,1] row_mask:0xf bank_mask:0xf
    v_add_f32_dpp v165, v165, v165 quad_perm:[2,3,0,1] row_mask:0xf bank_mask:0xf
    v_add_f32_dpp v166, v166, v166 quad_perm:[2,3,0,1] row_mask:0xf bank_mask:0xf
    v_add_f32_dpp v167, v167, v167 quad_perm:[2,3,0,1] row_mask:0xf bank_mask:0xf
    v_add_f32_dpp v168, v168, v168 quad_perm:[2,3,0,1] row_mask:0xf bank_mask:0xf
    v_add_f32_dpp v169, v169, v169 quad_perm:[2,3,0,1] row_mask:0xf bank_mask:0xf
    v_add_f32_dpp v170, v170, v170 quad_perm:[2,3,0,1] row_mask:0xf bank_mask:0xf
    v_add_f32_dpp v171, v171, v171 quad_perm:[2,3,0,1] row_mask:0xf bank_mask:0xf
    v_bfe_u32 v3, v0, 2, 2
    v_lshl_add_u32 v3, v3, 7, v7
    s_lshl_b32 s62, s82, 9
    s_add_u32 s64, s62, 82432
    v_add_u32 v3, s64, v3
    ds_write_b128 v3, v[164:167]
    ds_write_b128 v3, v[168:171] offset:64
    s_lshl_b32 s55, s83, 13
    s_add_u32 s55, s55, 524288
    s_waitcnt lgkmcnt(0)
    s_barrier
    s_cmp_lg_u32 s82, 3
    s_cbranch_scc1 L_adaL_nopub_18
    v_lshlrev_b32 v3, 2, v240
    v_add_u32 v3, 82432, v3
    ds_read2st64_b32 v[216:217], v3 offset0:0 offset1:1
    ds_read2st64_b32 v[218:219], v3 offset0:2 offset1:3
    ds_read2st64_b32 v[220:221], v3 offset0:4 offset1:5
    ds_read2st64_b32 v[222:223], v3 offset0:6 offset1:7
    s_lshl_b32 s64, s84, 10
    s_add_u32 s64, s64, s55
    s_waitcnt lgkmcnt(2)
    v_pk_add_f32 v[216:217], v[216:217], v[218:219]
    s_waitcnt lgkmcnt(0)
    v_pk_add_f32 v[220:221], v[220:221], v[222:223]
    v_pk_add_f32 v[216:217], v[216:217], v[220:221]
    v_mov_b32 v219, v13
    v_mov_b32 v218, v217
    v_mov_b32 v217, v13
    buffer_store_dwordx4 v[216:219], v241, s[4:7], s64 offen sc1
L_adaL_nopub_18:
    ds_read_b64 v[44:45], v5 offset:0
    ds_read_b64 v[46:47], v5 offset:512
    ds_read_b64 v[48:49], v5 offset:20480
    ds_read_b64 v[50:51], v5 offset:20992
    ds_read_b64 v[52:53], v6 offset:0
    ds_read_b64 v[54:55], v6 offset:512
    ds_read_b64 v[56:57], v6 offset:20480
    ds_read_b64 v[58:59], v6 offset:20992
    ds_read_b64 v[60:61], v5 offset:1024
    ds_read_b64 v[62:63], v5 offset:1536
    ds_read_b64 v[64:65], v5 offset:21504
    ds_read_b64 v[66:67], v5 offset:22016
    ds_read_b64 v[68:69], v6 offset:1024
    ds_read_b64 v[70:71], v6 offset:1536
    ds_read_b64 v[72:73], v6 offset:21504
    ds_read_b64 v[74:75], v6 offset:22016
    s_waitcnt vmcnt(30) lgkmcnt(8)
    v_mfma_f32_16x16x32_bf16 v[132:135], a[96:99], v[44:47], 0
    ds_read2st64_b64 v[76:79], v5 offset0:4 offset1:5
    s_lshl_b32 s64, s82, 8
    v_mfma_f32_16x16x32_bf16 v[136:139], a[96:99], v[48:51], 0
    ds_read_b64 v[80:81], v5 offset:22528
    s_add_u32 s55, s55, s64
    v_mfma_f32_16x16x32_bf16 v[140:143], a[96:99], v[52:55], 0
    ds_read_b64 v[82:83], v5 offset:23040
    v_lshlrev_b32 v172, 4, v1
    v_mfma_f32_16x16x32_bf16 v[144:147], a[96:99], v[56:59], 0
    buffer_load_dwordx4 a[252:255], v242, s[4:7], s85 offen offset:3072 sc1
    s_add_u32 s85, s85, 4096
    v_mfma_f32_16x16x32_bf16 v[148:151], a[100:103], v[44:47], 0
    ds_read2st64_b64 v[84:87], v5 offset0:84 offset1:85
    v_lshl_add_u32 v172, v2, 11, v172
    v_mfma_f32_16x16x32_bf16 v[152:155], a[100:103], v[48:51], 0
    ds_read_b64 v[88:89], v6 offset:22528
    v_lshlrev_b32 v92, 1, v7
    v_mfma_f32_16x16x32_bf16 v[156:159], a[100:103], v[52:55], 0
    ds_read_b64 v[90:91], v6 offset:23040
    v_add_u32 v92, 88576, v92
    v_mfma_f32_16x16x32_bf16 v[160:163], a[100:103], v[56:59], 0
    v_add_u32 v93, 88832, v7
    s_waitcnt lgkmcnt(3)
    v_mfma_f32_16x16x32_bf16 v[132:135], a[104:107], v[60:63], v[132:135]
    ds_read_b64 v[44:45], v5 offset:3072
    s_add_u32 m0, s54, 0
    v_mfma_f32_16x16x32_bf16 v[136:139], a[104:107], v[64:67], v[136:139]
    ds_read_b64 v[46:47], v5 offset:3584
    ds_read_b128 v[176:179], v92 offset:0
    v_mfma_f32_16x16x32_bf16 v[140:143], a[104:107], v[68:71], v[140:143]
    ds_read_b64 v[48:49], v5 offset:23552
    v_mfma_f32_16x16x32_bf16 v[144:147], a[104:107], v[72:75], v[144:147]
    ds_read_b64 v[50:51], v5 offset:24064
    ds_read_b128 v[180:183], v92 offset:16
    v_mfma_f32_16x16x32_bf16 v[148:151], a[108:111], v[60:63], v[148:151]
    ds_read_b64 v[52:53], v6 offset:3072
    v_mfma_f32_16x16x32_bf16 v[152:155], a[108:111], v[64:67], v[152:155]
    ds_read_b64 v[54:55], v6 offset:3584
    ds_read_b128 v[184:187], v92 offset:128
    v_mfma_f32_16x16x32_bf16 v[156:159], a[108:111], v[68:71], v[156:159]
    ds_read_b64 v[56:57], v6 offset:23552
    v_mfma_f32_16x16x32_bf16 v[160:163], a[108:111], v[72:75], v[160:163]
    ds_read_b64 v[58:59], v6 offset:24064
    ds_read_b128 v[188:191], v92 offset:144
    s_waitcnt lgkmcnt(9)
    v_mfma_f32_16x16x32_bf16 v[132:135], a[112:115], v[76:79], v[132:135]
    ds_read_b64 v[60:61], v5 offset:4096
    v_mfma_f32_16x16x32_bf16 v[136:139], a[112:115], v[80:83], v[136:139]
    ds_read_b64 v[62:63], v5 offset:4608
    ds_read_b128 v[192:195], v93
    v_mfma_f32_16x16x32_bf16 v[140:143], a[112:115], v[84:87], v[140:143]
    ds_read_b64 v[64:65], v5 offset:24576
    s_mov_b32 s57, 0x07060302
    v_mfma_f32_16x16x32_bf16 v[144:147], a[112:115], v[88:91], v[144:147]
    ds_read_b64 v[66:67], v5 offset:25088
    buffer_load_dwordx4 v245, s[32:35], s88 offen lds
    v_mfma_f32_16x16x32_bf16 v[148:151], a[116:119], v[76:79], v[148:151]
    ds_read_b64 v[68:69], v6 offset:4096
    s_add_u32 m0, s54, 1024
    v_mfma_f32_16x16x32_bf16 v[152:155], a[116:119], v[80:83], v[152:155]
    ds_read_b64 v[70:71], v6 offset:4608
    buffer_load_dwordx4 v246, s[32:35], s88 offen lds
    v_mfma_f32_16x16x32_bf16 v[156:159], a[116:119], v[84:87], v[156:159]
    ds_read_b64 v[72:73], v6 offset:24576
    s_add_u32 m0, s54, 2048
    v_mfma_f32_16x16x32_bf16 v[160:163], a[116:119], v[88:91], v[160:163]
    ds_read_b64 v[74:75], v6 offset:25088
    buffer_load_dwordx4 v245, s[32:35], s89 offen lds
    s_waitcnt lgkmcnt(6)
    v_mfma_f32_16x16x32_bf16 v[132:135], a[120:123], v[44:47], v[132:135]
    ds_read_b64 v[76:77], v5 offset:5120
    s_add_u32 m0, s54, 3072
    v_mfma_f32_16x16x32_bf16 v[136:139], a[120:123], v[48:51], v[136:139]
    ds_read_b64 v[78:79], v5 offset:5632
    buffer_load_dwordx4 v246, s[32:35], s89 offen lds
    v_mfma_f32_16x16x32_bf16 v[140:143], a[120:123], v[52:55], v[140:143]
    ds_read_b64 v[80:81], v5 offset:25600
    s_add_u32 m0, s54, 4096
    v_mfma_f32_16x16x32_bf16 v[144:147], a[120:123], v[56:59], v[144:147]
    ds_read_b64 v[82:83], v5 offset:26112
    buffer_load_dwordx4 v245, s[32:35], s90 offen lds
    v_mfma_f32_16x16x32_bf16 v[148:151], a[124:127], v[44:47], v[148:151]
    ds_read_b64 v[84:85], v6 offset:5120
    s_add_u32 m0, s54, 5120
    v_mfma_f32_16x16x32_bf16 v[152:155], a[124:127], v[48:51], v[152:155]
    ds_read_b64 v[86:87], v6 offset:5632
    buffer_load_dwordx4 v246, s[32:35], s90 offen lds
    v_mfma_f32_16x16x32_bf16 v[156:159], a[124:127], v[52:55], v[156:159]
    ds_read_b64 v[88:89], v6 offset:25600
    s_add_u32 m0, s54, 6144
    v_mfma_f32_16x16x32_bf16 v[160:163], a[124:127], v[56:59], v[160:163]
    ds_read_b64 v[90:91], v6 offset:26112
    buffer_load_dwordx4 v245, s[32:35], s91 offen lds
    s_waitcnt vmcnt(32) lgkmcnt(6)
    v_mfma_f32_16x16x32_bf16 v[132:135], a[128:131], v[60:63], v[132:135]
    ds_read_b64 v[44:45], v5 offset:6144
    s_add_u32 m0, s54, 7168
    v_mfma_f32_16x16x32_bf16 v[136:139], a[128:131], v[64:67], v[136:139]
    ds_read_b64 v[46:47], v5 offset:6656
    buffer_load_dwordx4 v246, s[32:35], s91 offen lds
    v_mfma_f32_16x16x32_bf16 v[140:143], a[128:131], v[68:71], v[140:143]
    ds_read_b64 v[48:49], v5 offset:26624
    v_add_u32 v247, 128, v245
    v_mfma_f32_16x16x32_bf16 v[144:147], a[128:131], v[72:75], v[144:147]
    ds_read_b64 v[50:51], v5 offset:27136
    v_bfi_b32 v245, s40, v247, v245
    v_bfi_b32 v246, s40, v247, v246
    v_mfma_f32_16x16x32_bf16 v[148:151], a[132:135], v[60:63], v[148:151]
    ds_read_b64 v[52:53], v6 offset:6144
    s_add_u32 m0, s54, 8192
    v_mfma_f32_16x16x32_bf16 v[152:155], a[132:135], v[64:67], v[152:155]
    ds_read_b64 v[54:55], v6 offset:6656
    buffer_load_dwordx4 v245, s[32:35], s88 offen lds
    v_mfma_f32_16x16x32_bf16 v[156:159], a[132:135], v[68:71], v[156:159]
    ds_read_b64 v[56:57], v6 offset:26624
    s_add_u32 m0, s54, 9216
    v_mfma_f32_16x16x32_bf16 v[160:163], a[132:135], v[72:75], v[160:163]
    ds_read_b64 v[58:59], v6 offset:27136
    buffer_load_dwordx4 v246, s[32:35], s88 offen lds
    s_waitcnt lgkmcnt(6)
    v_mfma_f32_16x16x32_bf16 v[132:135], a[136:139], v[76:79], v[132:135]
    ds_read_b64 v[60:61], v5 offset:7168
    s_add_u32 m0, s54, 10240
    v_mfma_f32_16x16x32_bf16 v[136:139], a[136:139], v[80:83], v[136:139]
    ds_read_b64 v[62:63], v5 offset:7680
    buffer_load_dwordx4 v245, s[32:35], s89 offen lds
    v_mfma_f32_16x16x32_bf16 v[140:143], a[136:139], v[84:87], v[140:143]
    ds_read_b64 v[64:65], v5 offset:27648
    s_add_u32 m0, s54, 11264
    v_mfma_f32_16x16x32_bf16 v[144:147], a[136:139], v[88:91], v[144:147]
    ds_read_b64 v[66:67], v5 offset:28160
    buffer_load_dwordx4 v246, s[32:35], s89 offen lds
    v_mfma_f32_16x16x32_bf16 v[148:151], a[140:143], v[76:79], v[148:151]
    ds_read_b64 v[68:69], v6 offset:7168
    s_add_u32 m0, s54, 12288
    v_mfma_f32_16x16x32_bf16 v[152:155], a[140:143], v[80:83], v[152:155]
    ds_read_b64 v[70:71], v6 offset:7680
    buffer_load_dwordx4 v245, s[32:35], s90 offen lds
    v_mfma_f32_16x16x32_bf16 v[156:159], a[140:143], v[84:87], v[156:159]
    ds_read_b64 v[72:73], v6 offset:27648
    s_add_u32 m0, s54, 13312
    v_mfma_f32_16x16x32_bf16 v[160:163], a[140:143], v[88:91], v[160:163]
    ds_read_b64 v[74:75], v6 offset:28160
    buffer_load_dwordx4 v246, s[32:35], s90 offen lds
    s_waitcnt lgkmcnt(6)
    v_mfma_f32_16x16x32_bf16 v[132:135], a[144:147], v[44:47], v[132:135]
    ds_read_b64 v[76:77], v5 offset:8192
    s_waitcnt vmcnt(12) lgkmcnt(6)
    v_mfma_f32_16x16x32_bf16 v[136:139], a[144:147], v[48:51], v[136:139]
    ds_read_b64 v[78:79], v5 offset:8704
    ds_read_b128 a[0:3], v10 offset:0
    v_mfma_f32_16x16x32_bf16 v[140:143], a[144:147], v[52:55], v[140:143]
    ds_read_b64 v[80:81], v5 offset:28672
    v_perm_b32 v230, v177, v176, s57
    v_mfma_f32_16x16x32_bf16 v[144:147], a[144:147], v[56:59], v[144:147]
    ds_read_b64 v[82:83], v5 offset:29184
    ds_read_b128 a[4:7], v11 offset:0
    v_mfma_f32_16x16x32_bf16 v[148:151], a[148:151], v[44:47], v[148:151]
    ds_read_b64 v[84:85], v6 offset:8192
    s_waitcnt vmcnt(10) lgkmcnt(8)
    v_mfma_f32_16x16x32_bf16 v[152:155], a[148:151], v[48:51], v[152:155]
    ds_read_b64 v[86:87], v6 offset:8704
    ds_read_b128 a[8:11], v10 offset:2048
    v_mfma_f32_16x16x32_bf16 v[156:159], a[148:151], v[52:55], v[156:159]
    ds_read_b64 v[88:89], v6 offset:28672
    v_perm_b32 v231, v179, v178, s57
    v_mfma_f32_16x16x32_bf16 v[160:163], a[148:151], v[56:59], v[160:163]
    ds_read_b64 v[90:91], v6 offset:29184
    ds_read_b128 a[12:15], v11 offset:2048
    s_waitcnt lgkmcnt(9)
    v_mfma_f32_16x16x32_bf16 v[132:135], a[152:155], v[60:63], v[132:135]
    ds_read_b64 v[44:45], v5 offset:9216
    s_waitcnt lgkmcnt(7)
    v_mfma_f32_16x16x32_bf16 v[136:139], a[152:155], v[64:67], v[136:139]
    ds_read_b64 v[46:47], v5 offset:9728
    s_add_u32 m0, s54, 0
    v_mfma_f32_16x16x32_bf16 v[140:143], a[152:155], v[68:71], v[140:143]
    ds_read_b64 v[48:49], v5 offset:29696
    v_perm_b32 v232, v181, v180, s57
    v_mfma_f32_16x16x32_bf16 v[144:147], a[152:155], v[72:75], v[144:147]
    ds_read_b64 v[50:51], v5 offset:30208
    buffer_load_dwordx4 v245, s[32:35], s91 offen lds
    v_mfma_f32_16x16x32_bf16 v[148:151], a[156:159], v[60:63], v[148:151]
    ds_read_b64 v[52:53], v6 offset:9216
    s_add_u32 m0, s54, 1024
    v_mfma_f32_16x16x32_bf16 v[152:155], a[156:159], v[64:67], v[152:155]
    ds_read_b64 v[54:55], v6 offset:9728
    buffer_load_dwordx4 v246, s[32:35], s91 offen lds
    v_mfma_f32_16x16x32_bf16 v[156:159], a[156:159], v[68:71], v[156:159]
    ds_read_b64 v[56:57], v6 offset:29696
    v_add_u32 v247, 128, v245
    v_mfma_f32_16x16x32_bf16 v[160:163], a[156:159], v[72:75], v[160:163]
    ds_read_b64 v[58:59], v6 offset:30208
    v_bfi_b32 v245, s40, v247, v245
    v_bfi_b32 v246, s40, v247, v246
    s_waitcnt lgkmcnt(5)
    v_mfma_f32_16x16x32_bf16 v[132:135], a[160:163], v[76:79], v[132:135]
    ds_read_b64 v[60:61], v5 offset:10240
    v_perm_b32 v233, v183, v182, s57
    v_mfma_f32_16x16x32_bf16 v[136:139], a[160:163], v[80:83], v[136:139]
    ds_read_b64 v[62:63], v5 offset:10752
    buffer_load_dwordx4 v[164:167], v172, s[4:7], s55 offen offset:0 sc1
    v_mfma_f32_16x16x32_bf16 v[140:143], a[160:163], v[84:87], v[140:143]
    ds_read_b64 v[64:65], v5 offset:30720
    v_perm_b32 v234, v185, v184, s57
    v_mfma_f32_16x16x32_bf16 v[144:147], a[160:163], v[88:91], v[144:147]
    ds_read_b64 v[66:67], v5 offset:31232
    buffer_load_dwordx4 v[168:171], v172, s[4:7], s55 offen offset:1024 sc1
    v_mfma_f32_16x16x32_bf16 v[148:151], a[164:167], v[76:79], v[148:151]
    ds_read_b64 v[68:69], v6 offset:10240
    s_waitcnt vmcnt(12) lgkmcnt(5)
    v_mfma_f32_16x16x32_bf16 v[152:155], a[164:167], v[80:83], v[152:155]
    ds_read_b64 v[70:71], v6 offset:10752
    ds_read_b128 a[16:19], v10 offset:4096
    v_mfma_f32_16x16x32_bf16 v[156:159], a[164:167], v[84:87], v[156:159]
    ds_read_b64 v[72:73], v6 offset:30720
    v_perm_b32 v235, v187, v186, s57
    v_mfma_f32_16x16x32_bf16 v[160:163], a[164:167], v[88:91], v[160:163]
    ds_read_b64 v[74:75], v6 offset:31232
    ds_read_b128 a[20:23], v11 offset:4096
    v_mfma_f32_16x16x32_bf16 v[132:135], a[168:171], v[44:47], v[132:135]
    ds_read_b64 v[76:77], v5 offset:11264
    v_mfma_f32_16x16x32_bf16 v[136:139], a[168:171], v[48:51], v[136:139]
    ds_read_b64 v[78:79], v5 offset:11776
    s_add_u32 m0, s54, 2048
    v_mfma_f32_16x16x32_bf16 v[140:143], a[168:171], v[52:55], v[140:143]
    ds_read_b64 v[80:81], v5 offset:31744
    v_perm_b32 v236, v189, v188, s57
    v_mfma_f32_16x16x32_bf16 v[144:147], a[168:171], v[56:59], v[144:147]
    ds_read_b64 v[82:83], v5 offset:32256
    buffer_load_dwordx4 v245, s[32:35], s88 offen lds
    v_mfma_f32_16x16x32_bf16 v[148:151], a[172:175], v[44:47], v[148:151]
    ds_read_b64 v[84:85], v6 offset:11264
    s_add_u32 m0, s54, 3072
    v_mfma_f32_16x16x32_bf16 v[152:155], a[172:175], v[48:51], v[152:155]
    ds_read_b64 v[86:87], v6 offset:11776
    buffer_load_dwordx4 v246, s[32:35], s88 offen lds
    v_mfma_f32_16x16x32_bf16 v[156:159], a[172:175], v[52:55], v[156:159]
    ds_read_b64 v[88:89], v6 offset:31744
    s_waitcnt vmcnt(12) lgkmcnt(6)
    v_mfma_f32_16x16x32_bf16 v[160:163], a[172:175], v[56:59], v[160:163]
    ds_read_b64 v[90:91], v6 offset:32256
    ds_read_b128 a[24:27], v10 offset:6144
    v_mfma_f32_16x16x32_bf16 v[132:135], a[176:179], v[60:63], v[132:135]
    ds_read_b64 v[44:45], v5 offset:12288
    v_perm_b32 v237, v191, v190, s57
    v_mfma_f32_16x16x32_bf16 v[136:139], a[176:179], v[64:67], v[136:139]
    ds_read_b64 v[46:47], v5 offset:12800
    ds_read_b128 a[28:31], v11 offset:6144
    v_mfma_f32_16x16x32_bf16 v[140:143], a[176:179], v[68:71], v[140:143]
    ds_read_b64 v[48:49], v5 offset:32768
    v_mfma_f32_16x16x32_bf16 v[144:147], a[176:179], v[72:75], v[144:147]
    ds_read_b64 v[50:51], v5 offset:33280
    s_add_u32 m0, s54, 4096
    v_mfma_f32_16x16x32_bf16 v[148:151], a[180:183], v[60:63], v[148:151]
    ds_read_b64 v[52:53], v6 offset:12288
    v_perm_b32 v238, v193, v192, s57
    v_mfma_f32_16x16x32_bf16 v[152:155], a[180:183], v[64:67], v[152:155]
    ds_read_b64 v[54:55], v6 offset:12800
    buffer_load_dwordx4 v245, s[32:35], s89 offen lds
    v_mfma_f32_16x16x32_bf16 v[156:159], a[180:183], v[68:71], v[156:159]
    ds_read_b64 v[56:57], v6 offset:32768
    s_add_u32 m0, s54, 5120
    v_mfma_f32_16x16x32_bf16 v[160:163], a[180:183], v[72:75], v[160:163]
    ds_read_b64 v[58:59], v6 offset:33280
    buffer_load_dwordx4 v246, s[32:35], s89 offen lds
    s_waitcnt lgkmcnt(6)
    v_mfma_f32_16x16x32_bf16 v[132:135], a[184:187], v[76:79], v[132:135]
    ds_read_b64 v[60:61], v5 offset:13312
    s_waitcnt vmcnt(12) lgkmcnt(6)
    v_mfma_f32_16x16x32_bf16 v[136:139], a[184:187], v[80:83], v[136:139]
    ds_read_b64 v[62:63], v5 offset:13824
    ds_read_b128 a[32:35], v10 offset:8192
    v_mfma_f32_16x16x32_bf16 v[140:143], a[184:187], v[84:87], v[140:143]
    ds_read_b64 v[64:65], v5 offset:33792
    v_perm_b32 v239, v195, v194, s57
    v_mfma_f32_16x16x32_bf16 v[144:147], a[184:187], v[88:91], v[144:147]
    ds_read_b64 v[66:67], v5 offset:34304
    ds_read_b128 a[36:39], v11 offset:8192
    v_mfma_f32_16x16x32_bf16 v[148:151], a[188:191], v[76:79], v[148:151]
    ds_read_b64 v[68:69], v6 offset:13312
    v_mfma_f32_16x16x32_bf16 v[152:155], a[188:191], v[80:83], v[152:155]
    ds_read_b64 v[70:71], v6 offset:13824
    s_add_u32 m0, s54, 6144
    v_mfma_f32_16x16x32_bf16 v[156:159], a[188:191], v[84:87], v[156:159]
    ds_read_b64 v[72:73], v6 offset:33792
    v_mfma_f32_16x16x32_bf16 v[160:163], a[188:191], v[88:91], v[160:163]
    ds_read_b64 v[74:75], v6 offset:34304
    buffer_load_dwordx4 v245, s[32:35], s90 offen lds
    s_waitcnt lgkmcnt(7)
    v_mfma_f32_16x16x32_bf16 v[132:135], a[192:195], v[44:47], v[132:135]
    ds_read_b64 v[76:77], v5 offset:14336
    s_add_u32 m0, s54, 7168
    v_mfma_f32_16x16x32_bf16 v[136:139], a[192:195], v[48:51], v[136:139]
    ds_read_b64 v[78:79], v5 offset:14848
    buffer_load_dwordx4 v246, s[32:35], s90 offen lds
    v_mfma_f32_16x16x32_bf16 v[140:143], a[192:195], v[52:55], v[140:143]
    ds_read_b64 v[80:81], v5 offset:34816
    s_waitcnt vmcnt(12) lgkmcnt(6)
    v_mfma_f32_16x16x32_bf16 v[144:147], a[192:195], v[56:59], v[144:147]
    ds_read_b64 v[82:83], v5 offset:35328
    ds_read_b128 a[40:43], v10 offset:10240
    v_mfma_f32_16x16x32_bf16 v[148:151], a[196:199], v[44:47], v[148:151]
    ds_read_b64 v[84:85], v6 offset:14336
    v_mfma_f32_16x16x32_bf16 v[152:155], a[196:199], v[48:51], v[152:155]
    ds_read_b64 v[86:87], v6 offset:14848
    ds_read_b128 a[44:47], v11 offset:10240
    v_mfma_f32_16x16x32_bf16 v[156:159], a[196:199], v[52:55], v[156:159]
    ds_read_b64 v[88:89], v6 offset:34816
    v_mfma_f32_16x16x32_bf16 v[160:163], a[196:199], v[56:59], v[160:163]
    ds_read_b64 v[90:91], v6 offset:35328
    s_add_u32 m0, s54, 8192
    s_nop 0
    buffer_load_dwordx4 v245, s[32:35], s91 offen lds
    s_mov_b32 s49, 65536
L_adaL_poll_19:
    s_waitcnt vmcnt(8) lgkmcnt(8)
    v_min3_u32 v3, v165, v167, v13
    s_waitcnt vmcnt(7)
    v_min3_u32 v3, v3, v169, v171
    v_max3_u32 v4, v165, v167, v13
    v_max3_u32 v4, v4, v169, v171
    v_cmp_ne_u32 vcc, v3, v4
    s_nop 0
    s_cbranch_vccz L_adaL_got_20
    buffer_load_dwordx4 v[164:167], v172, s[4:7], s55 offen offset:0 sc1
    buffer_load_dwordx4 v[168:171], v172, s[4:7], s55 offen offset:1024 sc1
    s_waitcnt vmcnt(0)
    s_sub_u32 s49, s49, 1
    s_cmp_lg_u32 s49, 0
    s_cbranch_scc1 L_adaL_poll_19
L_adaL_got_20:
    v_add_f32 v164, v164, v168
    v_add_f32 v166, v166, v170
    v_mov_b32 v165, v164
    v_mov_b32 v167, v166
    s_nop 0
    v_permlane16_swap_b32 v164, v165
    s_add_u32 m0, s54, 9216
    s_nop 0
    buffer_load_dwordx4 v246, s[32:35], s91 offen lds
    v_add_u32 v247, 128, v245
    v_bfi_b32 v245, s40, v247, v245
    v_bfi_b32 v246, s40, v247, v246
    v_permlane16_swap_b32 v166, v167
    v_add_f32 v164, v164, v165
    v_add_f32 v166, v166, v167
    v_mov_b32 v165, v164
    v_mov_b32 v167, v166
    ds_read_b128 a[48:51], v10 offset:12288
    ds_read_b128 a[52:55], v11 offset:12288
    s_waitcnt lgkmcnt(4)
    s_add_u32 m0, s54, 10240
    s_nop 0
    buffer_load_dwordx4 v245, s[32:35], s88 offen lds
    v_permlane32_swap_b32 v164, v165
    v_permlane32_swap_b32 v166, v167
    v_add_f32 v164, v164, v165
    v_add_f32 v166, v166, v167
    v_mul_f32 v216, 0xba97b426, v164
    s_add_u32 m0, s54, 11264
    s_nop 0
    buffer_load_dwordx4 v246, s[32:35], s88 offen lds
    v_mul_f32 v217, 0x3a97b426, v166
    v_fma_f32 v217, -v216, v216, v217
    v_max_f32 v217, 0, v217
    v_add_f32 v217, 0x3727c5ac, v217
    v_rsq_f32 v217, v217
    ds_read_b128 a[56:59], v10 offset:0
    ds_read_b128 a[60:63], v11 offset:0
    s_waitcnt lgkmcnt(2)
    s_add_u32 m0, s54, 12288
    s_nop 0
    buffer_load_dwordx4 v245, s[32:35], s89 offen lds
    s_lshl_b32 s64, s82, 6
    s_add_u32 s64, s64, 84480
    v_add_u32 v3, s64, v12
    v_mul_f32 v216, v216, v217
    ds_write2st64_b32 v3, v217, v216 offset0:0 offset1:1
    v_add_u32 v3, 84480, v7
    s_waitcnt lgkmcnt(0)
    s_barrier
    ds_read_b128 v[164:167], v3 offset:0
    s_add_u32 m0, s54, 13312
    s_nop 0
    buffer_load_dwordx4 v246, s[32:35], s89 offen lds
    ds_read_b128 v[180:183], v3 offset:256
    ds_read_b128 v[168:171], v3 offset:64
    ds_read_b128 v[184:187], v3 offset:320
    ds_read_b128 v[172:175], v3 offset:128
    ds_read_b128 v[188:191], v3 offset:384
    s_waitcnt vmcnt(10)
    ds_read_b128 a[64:67], v10 offset:2048
    ds_read_b128 a[68:71], v11 offset:2048
    s_add_u32 m0, s54, 0
    s_nop 0
    buffer_load_dwordx4 v245, s[32:35], s90 offen lds
    ds_read_b128 v[176:179], v3 offset:192
    ds_read_b128 v[192:195], v3 offset:448
    s_mul_i32 s56, s84, 458752
    s_add_u32 s56, s56, 12582912
    s_lshl_b32 s64, s82, 17
    s_add_u32 s64, s64, s56
    s_lshl_b32 s65, s83, 11
    s_add_u32 s64, s64, s65
    v_add_u32 v4, 45056, v242
    s_waitcnt lgkmcnt(8)
    v_pk_fma_f32 v[100:101], v[100:101], v[164:165], v[180:181]
    v_pk_fma_f32 v[102:103], v[102:103], v[166:167], v[182:183]
    s_add_u32 m0, s54, 1024
    s_nop 0
    buffer_load_dwordx4 v246, s[32:35], s90 offen lds
    s_waitcnt lgkmcnt(6)
    v_pk_fma_f32 v[104:105], v[104:105], v[168:169], v[184:185]
    v_pk_fma_f32 v[106:107], v[106:107], v[170:171], v[186:187]
    v_cvt_pk_bf16_f32 v216, v100, v104
    v_cvt_pk_bf16_f32 v217, v101, v105
    v_cvt_pk_bf16_f32 v218, v102, v106
    s_waitcnt vmcnt(10)
    ds_read_b128 a[72:75], v10 offset:4096
    ds_read_b128 a[76:79], v11 offset:4096
    s_waitcnt lgkmcnt(4)
    s_add_u32 m0, s54, 2048
    s_nop 0
    buffer_load_dwordx4 v245, s[32:35], s91 offen lds
    v_cvt_pk_bf16_f32 v219, v103, v107
    buffer_store_dwordx4 v[216:219], v241, s[4:7], s64 offen offset:0 sc1
    v_pk_fma_f32 v[116:117], v[116:117], v[164:165], v[180:181]
    v_pk_fma_f32 v[118:119], v[118:119], v[166:167], v[182:183]
    v_pk_fma_f32 v[120:121], v[120:121], v[168:169], v[184:185]
    s_add_u32 m0, s54, 3072
    s_nop 0
    buffer_load_dwordx4 v246, s[32:35], s91 offen lds
    v_add_u32 v247, 128, v245
    v_bfi_b32 v245, s40, v247, v245
    v_bfi_b32 v246, s40, v247, v246
    v_pk_fma_f32 v[122:123], v[122:123], v[170:171], v[186:187]
    v_cvt_pk_bf16_f32 v220, v116, v120
    v_cvt_pk_bf16_f32 v221, v117, v121
    v_cvt_pk_bf16_f32 v222, v118, v122
    v_cvt_pk_bf16_f32 v223, v119, v123
    s_waitcnt vmcnt(11)
    ds_read_b128 a[80:83], v10 offset:6144
    ds_read_b128 a[84:87], v11 offset:6144
    s_waitcnt lgkmcnt(2)
    s_add_u32 m0, s54, 4096
    s_nop 0
    buffer_load_dwordx4 v245, s[32:35], s88 offen lds
    buffer_store_dwordx4 v[220:223], v4, s[4:7], s64 offen offset:0 sc1
    v_pk_fma_f32 v[108:109], v[108:109], v[172:173], v[188:189]
    v_pk_fma_f32 v[110:111], v[110:111], v[174:175], v[190:191]
    v_pk_fma_f32 v[112:113], v[112:113], v[176:177], v[192:193]
    v_pk_fma_f32 v[114:115], v[114:115], v[178:179], v[194:195]
    s_add_u32 m0, s54, 5120
    s_nop 0
    buffer_load_dwordx4 v246, s[32:35], s88 offen lds
    v_cvt_pk_bf16_f32 v216, v108, v112
    v_cvt_pk_bf16_f32 v217, v109, v113
    v_cvt_pk_bf16_f32 v218, v110, v114
    v_cvt_pk_bf16_f32 v219, v111, v115
    buffer_store_dwordx4 v[216:219], v241, s[4:7], s64 offen offset:1024 sc1
    s_waitcnt vmcnt(13)
    ds_read_b128 a[88:91], v10 offset:8192
    ds_read_b128 a[92:95], v11 offset:8192
    s_waitcnt lgkmcnt(2)
    s_add_u32 m0, s54, 6144
    s_nop 0
    buffer_load_dwordx4 v245, s[32:35], s89 offen lds
    v_pk_fma_f32 v[124:125], v[124:125], v[172:173], v[188:189]
    v_pk_fma_f32 v[126:127], v[126:127], v[174:175], v[190:191]
    v_pk_fma_f32 v[128:129], v[128:129], v[176:177], v[192:193]
    v_pk_fma_f32 v[130:131], v[130:131], v[178:179], v[194:195]
    v_cvt_pk_bf16_f32 v220, v124, v128
    s_add_u32 m0, s54, 7168
    s_nop 0
    buffer_load_dwordx4 v246, s[32:35], s89 offen lds
    v_cvt_pk_bf16_f32 v221, v125, v129
    v_cvt_pk_bf16_f32 v222, v126, v130
    v_cvt_pk_bf16_f32 v223, v127, v131
    buffer_store_dwordx4 v[220:223], v4, s[4:7], s64 offen offset:1024 sc1
    v_mfma_f32_16x16x32_bf16 v[132:135], a[200:203], v[60:63], v[132:135]
    ds_read_b64 v[44:45], v5 offset:15360
    s_waitcnt vmcnt(14)
    v_mfma_f32_16x16x32_bf16 v[136:139], a[200:203], v[64:67], v[136:139]
    ds_read_b64 v[46:47], v5 offset:15872
    ds_read_b128 a[96:99], v10 offset:10240
    v_mfma_f32_16x16x32_bf16 v[140:143], a[200:203], v[68:71], v[140:143]
    ds_read_b64 v[48:49], v5 offset:35840
    s_mul_i32 s57, s84, 10
    v_mfma_f32_16x16x32_bf16 v[144:147], a[200:203], v[72:75], v[144:147]
    ds_read_b64 v[50:51], v5 offset:36352
    ds_read_b128 a[100:103], v11 offset:10240
    v_mfma_f32_16x16x32_bf16 v[148:151], a[204:207], v[60:63], v[148:151]
    ds_read_b64 v[52:53], v6 offset:15360
    s_waitcnt lgkmcnt(7)
    v_mfma_f32_16x16x32_bf16 v[152:155], a[204:207], v[64:67], v[152:155]
    ds_read_b64 v[54:55], v6 offset:15872
    s_add_u32 m0, s54, 8192
    v_mfma_f32_16x16x32_bf16 v[156:159], a[204:207], v[68:71], v[156:159]
    ds_read_b64 v[56:57], v6 offset:35840
    v_add_u32 v92, s57, v2
    v_mfma_f32_16x16x32_bf16 v[160:163], a[204:207], v[72:75], v[160:163]
    ds_read_b64 v[58:59], v6 offset:36352
    buffer_load_dwordx4 v245, s[32:35], s90 offen lds
    v_mfma_f32_16x16x32_bf16 v[132:135], a[208:211], v[76:79], v[132:135]
    ds_read_b64 v[60:61], v5 offset:16384
    s_add_u32 m0, s54, 9216
    v_mfma_f32_16x16x32_bf16 v[136:139], a[208:211], v[80:83], v[136:139]
    ds_read_b64 v[62:63], v5 offset:16896
    buffer_load_dwordx4 v246, s[32:35], s90 offen lds
    v_mfma_f32_16x16x32_bf16 v[140:143], a[208:211], v[84:87], v[140:143]
    ds_read_b64 v[64:65], v5 offset:36864
    s_waitcnt vmcnt(14) lgkmcnt(6)
    v_mfma_f32_16x16x32_bf16 v[144:147], a[208:211], v[88:91], v[144:147]
    ds_read_b64 v[66:67], v5 offset:37376
    ds_read_b128 a[104:107], v10 offset:12288
    v_mfma_f32_16x16x32_bf16 v[148:151], a[212:215], v[76:79], v[148:151]
    ds_read_b64 v[68:69], v6 offset:16384
    v_lshrrev_b32 v93, 2, v92
    v_mfma_f32_16x16x32_bf16 v[152:155], a[212:215], v[80:83], v[152:155]
    ds_read_b64 v[70:71], v6 offset:16896
    ds_read_b128 a[108:111], v11 offset:12288
    v_mfma_f32_16x16x32_bf16 v[156:159], a[212:215], v[84:87], v[156:159]
    ds_read_b64 v[72:73], v6 offset:36864
    v_mfma_f32_16x16x32_bf16 v[160:163], a[212:215], v[88:91], v[160:163]
    ds_read_b64 v[74:75], v6 offset:37376
    s_add_u32 m0, s54, 10240
    s_waitcnt lgkmcnt(8)
    v_mfma_f32_16x16x32_bf16 v[132:135], a[216:219], v[44:47], v[132:135]
    ds_read_b64 v[76:77], v5 offset:17408
    v_and_b32 v92, 3, v92
    v_mfma_f32_16x16x32_bf16 v[136:139], a[216:219], v[48:51], v[136:139]
    ds_read_b64 v[78:79], v5 offset:17920
    buffer_load_dwordx4 v245, s[32:35], s91 offen lds
    v_mfma_f32_16x16x32_bf16 v[140:143], a[216:219], v[52:55], v[140:143]
    ds_read_b64 v[80:81], v5 offset:37888
    s_add_u32 m0, s54, 11264
    v_mfma_f32_16x16x32_bf16 v[144:147], a[216:219], v[56:59], v[144:147]
    ds_read_b64 v[82:83], v5 offset:38400
    buffer_load_dwordx4 v246, s[32:35], s91 offen lds
    v_mfma_f32_16x16x32_bf16 v[148:151], a[220:223], v[44:47], v[148:151]
    ds_read_b64 v[84:85], v6 offset:17408
    v_add_u32 v247, 128, v245
    v_mfma_f32_16x16x32_bf16 v[152:155], a[220:223], v[48:51], v[152:155]
    ds_read_b64 v[86:87], v6 offset:17920
    v_bfi_b32 v245, s40, v247, v245
    v_bfi_b32 v246, s40, v247, v246
    v_mfma_f32_16x16x32_bf16 v[156:159], a[220:223], v[52:55], v[156:159]
    ds_read_b64 v[88:89], v6 offset:37888
    s_waitcnt vmcnt(14) lgkmcnt(6)
    v_mfma_f32_16x16x32_bf16 v[160:163], a[220:223], v[56:59], v[160:163]
    ds_read_b64 v[90:91], v6 offset:38400
    ds_read_b128 a[112:115], v10 offset:0
    v_mfma_f32_16x16x32_bf16 v[132:135], a[224:227], v[60:63], v[132:135]
    ds_read_b64 v[44:45], v5 offset:18432
    v_lshlrev_b32 v92, 7, v92
    v_mfma_f32_16x16x32_bf16 v[136:139], a[224:227], v[64:67], v[136:139]
    ds_read_b64 v[46:47], v5 offset:18944
    ds_read_b128 a[116:119], v11 offset:0
    v_mfma_f32_16x16x32_bf16 v[140:143], a[224:227], v[68:71], v[140:143]
    ds_read_b64 v[48:49], v5 offset:38912
    v_mfma_f32_16x16x32_bf16 v[144:147], a[224:227], v[72:75], v[144:147]
    ds_read_b64 v[50:51], v5 offset:39424
    s_add_u32 m0, s54, 12288
    v_mfma_f32_16x16x32_bf16 v[148:151], a[228:231], v[60:63], v[148:151]
    ds_read_b64 v[52:53], v6 offset:18432
    v_lshl_add_u32 v92, v93, 10, v92
    v_mfma_f32_16x16x32_bf16 v[152:155], a[228:231], v[64:67], v[152:155]
    ds_read_b64 v[54:55], v6 offset:18944
    buffer_load_dwordx4 v245, s[32:35], s88 offen lds
    v_mfma_f32_16x16x32_bf16 v[156:159], a[228:231], v[68:71], v[156:159]
    ds_read_b64 v[56:57], v6 offset:38912
    s_add_u32 m0, s54, 13312
    v_mfma_f32_16x16x32_bf16 v[160:163], a[228:231], v[72:75], v[160:163]
    ds_read_b64 v[58:59], v6 offset:39424
    buffer_load_dwordx4 v246, s[32:35], s88 offen lds
    s_waitcnt lgkmcnt(6)
    v_mfma_f32_16x16x32_bf16 v[132:135], a[232:235], v[76:79], v[132:135]
    ds_read_b64 v[60:61], v5 offset:19456
    s_waitcnt vmcnt(13) lgkmcnt(6)
    v_mfma_f32_16x16x32_bf16 v[136:139], a[232:235], v[80:83], v[136:139]
    ds_read_b64 v[62:63], v5 offset:19968
    ds_read_b128 a[120:123], v10 offset:2048
    v_mfma_f32_16x16x32_bf16 v[140:143], a[232:235], v[84:87], v[140:143]
    ds_read_b64 v[64:65], v5 offset:39936
    v_lshl_add_u32 v92, v1, 3, v92
    v_mfma_f32_16x16x32_bf16 v[144:147], a[232:235], v[88:91], v[144:147]
    ds_read_b64 v[66:67], v5 offset:40448
    ds_read_b128 a[124:127], v11 offset:2048
    v_mfma_f32_16x16x32_bf16 v[148:151], a[236:239], v[76:79], v[148:151]
    ds_read_b64 v[68:69], v6 offset:19456
    v_mfma_f32_16x16x32_bf16 v[152:155], a[236:239], v[80:83], v[152:155]
    ds_read_b64 v[70:71], v6 offset:19968
    s_add_u32 m0, s54, 0
    v_mfma_f32_16x16x32_bf16 v[156:159], a[236:239], v[84:87], v[156:159]
    ds_read_b64 v[72:73], v6 offset:39936
    v_add_u32 v92, s53, v92
    v_mfma_f32_16x16x32_bf16 v[160:163], a[236:239], v[88:91], v[160:163]
    ds_read_b64 v[74:75], v6 offset:40448
    ds_read_b64 v[16:17], v92 offset:0
    s_waitcnt lgkmcnt(8)
    v_mfma_f32_16x16x32_bf16 v[132:135], a[240:243], v[44:47], v[132:135]
    ds_read_b64 v[18:19], v92 offset:512
    v_mfma_f32_16x16x32_bf16 v[136:139], a[240:243], v[48:51], v[136:139]
    ds_read_b64 v[20:21], v92 offset:1024
    v_mfma_f32_16x16x32_bf16 v[140:143], a[240:243], v[52:55], v[140:143]
    ds_read_b64 v[22:23], v92 offset:1536
    v_mfma_f32_16x16x32_bf16 v[144:147], a[240:243], v[56:59], v[144:147]
    buffer_load_dwordx4 v245, s[32:35], s89 offen lds
    s_add_u32 m0, s54, 1024
    v_mfma_f32_16x16x32_bf16 v[148:151], a[244:247], v[44:47], v[148:151]
    buffer_load_dwordx4 v246, s[32:35], s89 offen lds
    s_waitcnt vmcnt(12) lgkmcnt(5)
    v_mfma_f32_16x16x32_bf16 v[152:155], a[244:247], v[48:51], v[152:155]
    ds_read_b128 a[128:131], v10 offset:4096
    v_mfma_f32_16x16x32_bf16 v[156:159], a[244:247], v[52:55], v[156:159]
    ds_read_b128 a[132:135], v11 offset:4096
    v_mfma_f32_16x16x32_bf16 v[160:163], a[244:247], v[56:59], v[160:163]
    s_add_u32 m0, s54, 2048
    s_waitcnt lgkmcnt(3)
    v_mfma_f32_16x16x32_bf16 v[132:135], a[248:251], v[60:63], v[132:135]
    buffer_load_dwordx4 v245, s[32:35], s90 offen lds
    s_add_u32 m0, s54, 3072
    v_mfma_f32_16x16x32_bf16 v[136:139], a[248:251], v[64:67], v[136:139]
    buffer_load_dwordx4 v246, s[32:35], s90 offen lds
    s_waitcnt vmcnt(11) lgkmcnt(2)
    v_mfma_f32_16x16x32_bf16 v[140:143], a[248:251], v[68:71], v[140:143]
    ds_read_b128 a[136:139], v10 offset:6144
    v_mfma_f32_16x16x32_bf16 v[144:147], a[248:251], v[72:75], v[144:147]
    ds_read_b128 a[140:143], v11 offset:6144
    s_waitcnt lgkmcnt(2)
    v_mfma_f32_16x16x32_bf16 v[148:151], a[252:255], v[60:63], v[148:151]
    s_add_u32 m0, s54, 4096
    s_nop 0
    buffer_load_dwordx4 v245, s[32:35], s91 offen lds
    v_mfma_f32_16x16x32_bf16 v[152:155], a[252:255], v[64:67], v[152:155]
    v_lshrrev_b32 v92, 1, v2
    v_add3_u32 v92, v92, s57, 8
    v_mfma_f32_16x16x32_bf16 v[156:159], a[252:255], v[68:71], v[156:159]
    v_lshrrev_b32 v93, 2, v92
    v_and_b32 v92, 3, v92
    v_mfma_f32_16x16x32_bf16 v[160:163], a[252:255], v[72:75], v[160:163]
    v_lshlrev_b32 v92, 7, v92
    s_lshl_b32 s64, s84, 5
    s_add_u32 s64, s64, s83
    s_lshl_b32 s64, s64, 5
    s_add_u32 s64, s64, 196608
    s_cmp_lg_u32 s82, 0
    s_cselect_b32 s64, 33554432, s64
    v_mul_u32_u24 v3, 8448, v240
    s_waitcnt vmcnt(11) lgkmcnt(1)
    s_barrier
    s_mov_b64 exec, 15
    buffer_store_dword v13, v3, s[4:7], s64 offen sc1
    s_mov_b64 exec, -1
    v_lshl_add_u32 v92, v93, 10, v92
    v_and_b32 v93, 1, v2
    v_lshl_add_u32 v92, v93, 9, v92
    v_lshl_add_u32 v92, v1, 3, v92
    v_add_u32 v92, s53, v92
    ds_read_b64 v[24:25], v92
    s_lshl_b32 s57, s84, 2
    s_add_u32 s57, s57, s82
    s_lshl_b32 s57, s57, 8
    s_lshr_b32 s58, s83, 3
    s_mul_i32 s58, s58, 8448
    s_add_u32 s57, s57, s58
    s_add_u32 s60, s57, 196608
    v_and_b32 v26, 7, v0
    v_lshlrev_b32 v26, 5, v26
    s_lshl_b32 s57, s82, 14
    s_add_u32 s57, s57, s56
    v_add_u32 v9, s57, v241
    s_mul_i32 s20, s84, 0
    s_add_u32 s21, s20, 2048
    s_and_b32 s21, s21, 0x3fff
    s_add_u32 s22, s21, 2048
    s_and_b32 s22, s22, 0x3fff
    s_add_u32 s23, s22, 2048
    s_and_b32 s23, s23, 0x3fff
    s_add_u32 s24, s23, 2048
    s_and_b32 s24, s24, 0x3fff
    s_add_u32 s25, s24, 2048
    s_and_b32 s25, s25, 0x3fff
    s_add_u32 s26, s25, 2048
    s_and_b32 s26, s26, 0x3fff
    s_add_u32 s27, s26, 2048
    s_and_b32 s27, s27, 0x3fff
    v_lshlrev_b32 v3, 2, v1
    v_add_u32 v3, 81920, v3
    ds_read2_b32 v[164:165], v3 offset0:0 offset1:64
    ds_read2_b32 v[166:167], v3 offset0:16 offset1:80
    ds_read2_b32 v[168:169], v3 offset0:32 offset1:96
    ds_read2_b32 v[170:171], v3 offset0:48 offset1:112
    s_lshl_b32 s64, s82, 10
    s_add_u32 s64, s64, 86528
    v_add_u32 v3, s64, v241
    s_waitcnt lgkmcnt(3)
    v_pk_fma_f32 v[132:133], v[196:197], v[164:165], v[132:133] op_sel:[0,1,0] op_sel_hi:[1,1,1]
    v_pk_fma_f32 v[134:135], v[198:199], v[164:165], v[134:135] op_sel:[0,1,0] op_sel_hi:[1,1,1]
    v_pk_fma_f32 v[148:149], v[200:201], v[164:165], v[148:149] op_sel:[0,1,0] op_sel_hi:[1,1,1]
    v_pk_fma_f32 v[150:151], v[202:203], v[164:165], v[150:151] op_sel:[0,1,0] op_sel_hi:[1,1,1]
    v_pk_fma_f32 v[132:133], v[132:133], v[164:165], v[204:205] op_sel:[0,0,0] op_sel_hi:[1,0,1]
    s_add_u32 m0, s54, 5120
    s_nop 0
    buffer_load_dwordx4 v246, s[32:35], s91 offen lds
    v_add_u32 v247, 128, v245
    v_bfi_b32 v245, s40, v247, v245
    v_bfi_b32 v246, s40, v247, v246
    v_pk_fma_f32 v[134:135], v[134:135], v[164:165], v[206:207] op_sel:[0,0,0] op_sel_hi:[1,0,1]
    v_pk_fma_f32 v[148:149], v[148:149], v[164:165], v[208:209] op_sel:[0,0,0] op_sel_hi:[1,0,1]
    v_pk_fma_f32 v[150:151], v[150:151], v[164:165], v[210:211] op_sel:[0,0,0] op_sel_hi:[1,0,1]
    v_pk_mul_f32 v[216:217], v[132:133], v[132:133]
    v_pk_mul_f32 v[218:219], v[134:135], v[134:135]
    v_pk_mul_f32 v[220:221], v[148:149], v[148:149]
    v_pk_mul_f32 v[222:223], v[150:151], v[150:151]
    v_pk_fma_f32 v[216:217], v[216:217], s[66:67], s[66:67] op_sel:[0,0,1] op_sel_hi:[1,0,1]
    v_pk_fma_f32 v[218:219], v[218:219], s[66:67], s[66:67] op_sel:[0,0,1] op_sel_hi:[1,0,1]
    v_pk_fma_f32 v[220:221], v[220:221], s[66:67], s[66:67] op_sel:[0,0,1] op_sel_hi:[1,0,1]
    v_pk_fma_f32 v[222:223], v[222:223], s[66:67], s[66:67] op_sel:[0,0,1] op_sel_hi:[1,0,1]
    v_pk_mul_f32 v[216:217], v[216:217], v[132:133]
    s_waitcnt vmcnt(11)
    ds_read_b128 a[144:147], v10 offset:8192
    ds_read_b128 a[148:151], v11 offset:8192
    s_add_u32 m0, s54, 6144
    s_nop 0
    buffer_load_dwordx4 v245, s[32:35], s88 offen lds
    v_pk_mul_f32 v[218:219], v[218:219], v[134:135]
    v_pk_mul_f32 v[220:221], v[220:221], v[148:149]
    v_pk_mul_f32 v[222:223], v[222:223], v[150:151]
    v_exp_f32 v216, v216
    v_exp_f32 v217, v217
    v_exp_f32 v218, v218
    v_exp_f32 v219, v219
    v_exp_f32 v220, v220
    v_exp_f32 v221, v221
    v_exp_f32 v222, v222
    v_exp_f32 v223, v223
    v_pk_add_f32 v[216:217], v[216:217], s[68:69]
    s_add_u32 m0, s54, 7168
    s_nop 0
    buffer_load_dwordx4 v246, s[32:35], s88 offen lds
    v_pk_add_f32 v[218:219], v[218:219], s[68:69]
    v_pk_add_f32 v[220:221], v[220:221], s[68:69]
    v_pk_add_f32 v[222:223], v[222:223], s[68:69]
    v_rcp_f32 v216, v216
    v_rcp_f32 v217, v217
    v_rcp_f32 v218, v218
    v_rcp_f32 v219, v219
    v_rcp_f32 v220, v220
    v_rcp_f32 v221, v221
    v_rcp_f32 v222, v222
    v_rcp_f32 v223, v223
    v_pk_mul_f32 v[132:133], v[132:133], v[216:217]
    s_waitcnt vmcnt(11) lgkmcnt(0)
    ds_read_b128 a[152:155], v10 offset:10240
    ds_read_b128 a[156:159], v11 offset:10240
    s_add_u32 m0, s54, 8192
    s_nop 0
    buffer_load_dwordx4 v245, s[32:35], s89 offen lds
    v_pk_mul_f32 v[134:135], v[134:135], v[218:219]
    v_pk_mul_f32 v[148:149], v[148:149], v[220:221]
    v_pk_mul_f32 v[150:151], v[150:151], v[222:223]
    v_cvt_pk_bf16_f32 v180, v132, v148
    v_cvt_pk_bf16_f32 v181, v133, v149
    v_cvt_pk_bf16_f32 v182, v134, v150
    v_cvt_pk_bf16_f32 v183, v135, v151
    ds_write_b128 v3, v[180:183] offset:0
    v_pk_fma_f32 v[136:137], v[196:197], v[166:167], v[136:137] op_sel:[0,1,0] op_sel_hi:[1,1,1]
    v_pk_fma_f32 v[138:139], v[198:199], v[166:167], v[138:139] op_sel:[0,1,0] op_sel_hi:[1,1,1]
    v_pk_fma_f32 v[152:153], v[200:201], v[166:167], v[152:153] op_sel:[0,1,0] op_sel_hi:[1,1,1]
    v_pk_fma_f32 v[154:155], v[202:203], v[166:167], v[154:155] op_sel:[0,1,0] op_sel_hi:[1,1,1]
    s_add_u32 m0, s54, 9216
    s_nop 0
    buffer_load_dwordx4 v246, s[32:35], s89 offen lds
    v_pk_fma_f32 v[136:137], v[136:137], v[166:167], v[204:205] op_sel:[0,0,0] op_sel_hi:[1,0,1]
    v_pk_fma_f32 v[138:139], v[138:139], v[166:167], v[206:207] op_sel:[0,0,0] op_sel_hi:[1,0,1]
    v_pk_fma_f32 v[152:153], v[152:153], v[166:167], v[208:209] op_sel:[0,0,0] op_sel_hi:[1,0,1]
    v_pk_fma_f32 v[154:155], v[154:155], v[166:167], v[210:211] op_sel:[0,0,0] op_sel_hi:[1,0,1]
    v_pk_mul_f32 v[216:217], v[136:137], v[136:137]
    v_pk_mul_f32 v[218:219], v[138:139], v[138:139]
    v_pk_mul_f32 v[220:221], v[152:153], v[152:153]
    v_pk_mul_f32 v[222:223], v[154:155], v[154:155]
    v_pk_fma_f32 v[216:217], v[216:217], s[66:67], s[66:67] op_sel:[0,0,1] op_sel_hi:[1,0,1]
    v_pk_fma_f32 v[218:219], v[218:219], s[66:67], s[66:67] op_sel:[0,0,1] op_sel_hi:[1,0,1]
    v_pk_fma_f32 v[220:221], v[220:221], s[66:67], s[66:67] op_sel:[0,0,1] op_sel_hi:[1,0,1]
    v_pk_fma_f32 v[222:223], v[222:223], s[66:67], s[66:67] op_sel:[0,0,1] op_sel_hi:[1,0,1]
    s_waitcnt vmcnt(11)
    ds_read_b128 a[160:163], v10 offset:12288
    ds_read_b128 a[164:167], v11 offset:12288
    s_waitcnt lgkmcnt(3)
    s_add_u32 m0, s54, 10240
    s_nop 0
    buffer_load_dwordx4 v245, s[32:35], s90 offen lds
    v_pk_mul_f32 v[216:217], v[216:217], v[136:137]
    v_pk_mul_f32 v[218:219], v[218:219], v[138:139]
    v_pk_mul_f32 v[220:221], v[220:221], v[152:153]
    v_pk_mul_f32 v[222:223], v[222:223], v[154:155]
    v_exp_f32 v216, v216
    v_exp_f32 v217, v217
    v_exp_f32 v218, v218
    v_exp_f32 v219, v219
    v_exp_f32 v220, v220
    v_exp_f32 v221, v221
    v_exp_f32 v222, v222
    v_exp_f32 v223, v223
    s_add_u32 m0, s54, 11264
    s_nop 0
    buffer_load_dwordx4 v246, s[32:35], s90 offen lds
    v_pk_add_f32 v[216:217], v[216:217], s[68:69]
    v_pk_add_f32 v[218:219], v[218:219], s[68:69]
    v_pk_add_f32 v[220:221], v[220:221], s[68:69]
    v_pk_add_f32 v[222:223], v[222:223], s[68:69]
    v_rcp_f32 v216, v216
    v_rcp_f32 v217, v217
    v_rcp_f32 v218, v218
    v_rcp_f32 v219, v219
    v_rcp_f32 v220, v220
    v_rcp_f32 v221, v221
    v_rcp_f32 v222, v222
    v_rcp_f32 v223, v223
    s_waitcnt vmcnt(11) lgkmcnt(0)
    ds_read_b128 a[168:171], v10 offset:0
    ds_read_b128 a[172:175], v11 offset:0
    s_add_u32 m0, s54, 12288
    s_nop 0
    buffer_load_dwordx4 v245, s[32:35], s91 offen lds
    v_pk_mul_f32 v[136:137], v[136:137], v[216:217]
    v_pk_mul_f32 v[138:139], v[138:139], v[218:219]
    v_pk_mul_f32 v[152:153], v[152:153], v[220:221]
    v_pk_mul_f32 v[154:155], v[154:155], v[222:223]
    v_cvt_pk_bf16_f32 v184, v136, v152
    v_cvt_pk_bf16_f32 v185, v137, v153
    v_cvt_pk_bf16_f32 v186, v138, v154
    v_cvt_pk_bf16_f32 v187, v139, v155
    ds_write_b128 v3, v[184:187] offset:4096
    v_pk_fma_f32 v[140:141], v[196:197], v[168:169], v[140:141] op_sel:[0,1,0] op_sel_hi:[1,1,1]
    v_pk_fma_f32 v[142:143], v[198:199], v[168:169], v[142:143] op_sel:[0,1,0] op_sel_hi:[1,1,1]
    v_pk_fma_f32 v[156:157], v[200:201], v[168:169], v[156:157] op_sel:[0,1,0] op_sel_hi:[1,1,1]
    s_add_u32 m0, s54, 13312
    s_nop 0
    buffer_load_dwordx4 v246, s[32:35], s91 offen lds
    v_add_u32 v247, 128, v245
    v_bfi_b32 v245, s40, v247, v245
    v_bfi_b32 v246, s40, v247, v246
    v_pk_fma_f32 v[158:159], v[202:203], v[168:169], v[158:159] op_sel:[0,1,0] op_sel_hi:[1,1,1]
    v_pk_fma_f32 v[140:141], v[140:141], v[168:169], v[204:205] op_sel:[0,0,0] op_sel_hi:[1,0,1]
    v_pk_fma_f32 v[142:143], v[142:143], v[168:169], v[206:207] op_sel:[0,0,0] op_sel_hi:[1,0,1]
    v_pk_fma_f32 v[156:157], v[156:157], v[168:169], v[208:209] op_sel:[0,0,0] op_sel_hi:[1,0,1]
    v_pk_fma_f32 v[158:159], v[158:159], v[168:169], v[210:211] op_sel:[0,0,0] op_sel_hi:[1,0,1]
    v_pk_mul_f32 v[216:217], v[140:141], v[140:141]
    v_pk_mul_f32 v[218:219], v[142:143], v[142:143]
    v_pk_mul_f32 v[220:221], v[156:157], v[156:157]
    v_pk_mul_f32 v[222:223], v[158:159], v[158:159]
    v_pk_fma_f32 v[216:217], v[216:217], s[66:67], s[66:67] op_sel:[0,0,1] op_sel_hi:[1,0,1]
    v_pk_fma_f32 v[218:219], v[218:219], s[66:67], s[66:67] op_sel:[0,0,1] op_sel_hi:[1,0,1]
    v_pk_fma_f32 v[220:221], v[220:221], s[66:67], s[66:67] op_sel:[0,0,1] op_sel_hi:[1,0,1]
    s_waitcnt vmcnt(11) lgkmcnt(1)
    ds_read_b128 a[176:179], v10 offset:2048
    ds_read_b128 a[180:183], v11 offset:2048
    s_add_u32 m0, s54, 0
    s_nop 0
    buffer_load_dwordx4 v245, s[32:35], s88 offen lds
    v_pk_fma_f32 v[222:223], v[222:223], s[66:67], s[66:67] op_sel:[0,0,1] op_sel_hi:[1,0,1]
    v_pk_mul_f32 v[216:217], v[216:217], v[140:141]
    v_pk_mul_f32 v[218:219], v[218:219], v[142:143]
    v_pk_mul_f32 v[220:221], v[220:221], v[156:157]
    v_pk_mul_f32 v[222:223], v[222:223], v[158:159]
    v_exp_f32 v216, v216
    v_exp_f32 v217, v217
    v_exp_f32 v218, v218
    v_exp_f32 v219, v219
    v_exp_f32 v220, v220
    v_exp_f32 v221, v221
    v_exp_f32 v222, v222
    s_add_u32 m0, s54, 1024
    s_nop 0
    buffer_load_dwordx4 v246, s[32:35], s88 offen lds
    v_exp_f32 v223, v223
    v_pk_add_f32 v[216:217], v[216:217], s[68:69]
    v_pk_add_f32 v[218:219], v[218:219], s[68:69]
    v_pk_add_f32 v[220:221], v[220:221], s[68:69]
    v_pk_add_f32 v[222:223], v[222:223], s[68:69]
    v_rcp_f32 v216, v216
    v_rcp_f32 v217, v217
    v_rcp_f32 v218, v218
    v_rcp_f32 v219, v219
    v_rcp_f32 v220, v220
    v_rcp_f32 v221, v221
    v_rcp_f32 v222, v222
    s_waitcnt vmcnt(10) lgkmcnt(0)
    ds_read_b128 a[184:187], v10 offset:4096
    ds_read_b128 a[188:191], v11 offset:4096
    s_add_u32 m0, s54, 2048
    s_nop 0
    buffer_load_dwordx4 v245, s[32:35], s89 offen lds
    v_rcp_f32 v223, v223
    v_pk_mul_f32 v[140:141], v[140:141], v[216:217]
    v_pk_mul_f32 v[142:143], v[142:143], v[218:219]
    v_pk_mul_f32 v[156:157], v[156:157], v[220:221]
    v_pk_mul_f32 v[158:159], v[158:159], v[222:223]
    v_cvt_pk_bf16_f32 v188, v140, v156
    v_cvt_pk_bf16_f32 v189, v141, v157
    v_cvt_pk_bf16_f32 v190, v142, v158
    v_cvt_pk_bf16_f32 v191, v143, v159
    ds_write_b128 v3, v[188:191] offset:8192
    buffer_load_dword v27, v26, s[4:7], s60 offen sc1
    v_pk_fma_f32 v[144:145], v[196:197], v[170:171], v[144:145] op_sel:[0,1,0] op_sel_hi:[1,1,1]
    s_add_u32 m0, s54, 3072
    s_nop 0
    buffer_load_dwordx4 v246, s[32:35], s89 offen lds
    v_pk_fma_f32 v[146:147], v[198:199], v[170:171], v[146:147] op_sel:[0,1,0] op_sel_hi:[1,1,1]
    v_pk_fma_f32 v[160:161], v[200:201], v[170:171], v[160:161] op_sel:[0,1,0] op_sel_hi:[1,1,1]
    v_pk_fma_f32 v[162:163], v[202:203], v[170:171], v[162:163] op_sel:[0,1,0] op_sel_hi:[1,1,1]
    v_pk_fma_f32 v[144:145], v[144:145], v[170:171], v[204:205] op_sel:[0,0,0] op_sel_hi:[1,0,1]
    v_pk_fma_f32 v[146:147], v[146:147], v[170:171], v[206:207] op_sel:[0,0,0] op_sel_hi:[1,0,1]
    v_pk_fma_f32 v[160:161], v[160:161], v[170:171], v[208:209] op_sel:[0,0,0] op_sel_hi:[1,0,1]
    v_pk_fma_f32 v[162:163], v[162:163], v[170:171], v[210:211] op_sel:[0,0,0] op_sel_hi:[1,0,1]
    v_pk_mul_f32 v[216:217], v[144:145], v[144:145]
    v_pk_mul_f32 v[218:219], v[146:147], v[146:147]
    v_pk_mul_f32 v[220:221], v[160:161], v[160:161]
    v_pk_mul_f32 v[222:223], v[162:163], v[162:163]
    v_pk_fma_f32 v[216:217], v[216:217], s[66:67], s[66:67] op_sel:[0,0,1] op_sel_hi:[1,0,1]
    s_waitcnt vmcnt(11)
    ds_read_b128 a[192:195], v10 offset:6144
    ds_read_b128 a[196:199], v11 offset:6144
    s_waitcnt lgkmcnt(3)
    s_add_u32 m0, s54, 4096
    s_nop 0
    buffer_load_dwordx4 v245, s[32:35], s90 offen lds
    v_pk_fma_f32 v[218:219], v[218:219], s[66:67], s[66:67] op_sel:[0,0,1] op_sel_hi:[1,0,1]
    v_pk_fma_f32 v[220:221], v[220:221], s[66:67], s[66:67] op_sel:[0,0,1] op_sel_hi:[1,0,1]
    v_pk_fma_f32 v[222:223], v[222:223], s[66:67], s[66:67] op_sel:[0,0,1] op_sel_hi:[1,0,1]
    v_pk_mul_f32 v[216:217], v[216:217], v[144:145]
    v_pk_mul_f32 v[218:219], v[218:219], v[146:147]
    v_pk_mul_f32 v[220:221], v[220:221], v[160:161]
    v_pk_mul_f32 v[222:223], v[222:223], v[162:163]
    v_exp_f32 v216, v216
    v_exp_f32 v217, v217
    v_exp_f32 v218, v218
    v_exp_f32 v219, v219
    v_exp_f32 v220, v220
    s_add_u32 m0, s54, 5120
    s_nop 0
    buffer_load_dwordx4 v246, s[32:35], s90 offen lds
    v_exp_f32 v221, v221
    v_exp_f32 v222, v222
    v_exp_f32 v223, v223
    v_pk_add_f32 v[216:217], v[216:217], s[68:69]
    v_pk_add_f32 v[218:219], v[218:219], s[68:69]
    v_pk_add_f32 v[220:221], v[220:221], s[68:69]
    v_pk_add_f32 v[222:223], v[222:223], s[68:69]
    v_rcp_f32 v216, v216
    v_rcp_f32 v217, v217
    v_rcp_f32 v218, v218
    v_rcp_f32 v219, v219
    v_rcp_f32 v220, v220
    s_waitcnt vmcnt(11) lgkmcnt(0)
    ds_read_b128 a[200:203], v10 offset:8192
    ds_read_b128 a[204:207], v11 offset:8192
    s_add_u32 m0, s54, 6144
    s_nop 0
    buffer_load_dwordx4 v245, s[32:35], s91 offen lds
    v_rcp_f32 v221, v221
    v_rcp_f32 v222, v222
    v_rcp_f32 v223, v223
    v_pk_mul_f32 v[144:145], v[144:145], v[216:217]
    v_pk_mul_f32 v[146:147], v[146:147], v[218:219]
    v_pk_mul_f32 v[160:161], v[160:161], v[220:221]
    v_pk_mul_f32 v[162:163], v[162:163], v[222:223]
    v_cvt_pk_bf16_f32 v192, v144, v160
    v_cvt_pk_bf16_f32 v193, v145, v161
    v_cvt_pk_bf16_f32 v194, v146, v162
    v_cvt_pk_bf16_f32 v195, v147, v163
    ds_write_b128 v3, v[192:195] offset:12288
    s_add_u32 m0, s54, 7168
    s_nop 0
    buffer_load_dwordx4 v246, s[32:35], s91 offen lds
    s_mov_b32 s49, 65536
L_adaL_poll_21:
    s_waitcnt vmcnt(5)
    v_cmp_ne_u32 vcc, s48, v27
    s_nop 0
    s_cbranch_vccz L_adaL_got_22
    buffer_load_dword v27, v26, s[4:7], s60 offen sc1
    s_waitcnt vmcnt(0)
    s_sub_u32 s49, s49, 1
    s_cmp_lg_u32 s49, 0
    s_cbranch_scc1 L_adaL_poll_21
L_adaL_got_22:
    buffer_load_dwordx4 v[44:47], v9, s[4:7], s20 offen offset:0 sc1
    ds_read_b128 a[208:211], v10 offset:10240
    ds_read_b128 a[212:215], v11 offset:10240
    buffer_load_dwordx4 v[48:51], v9, s[4:7], s20 offen offset:1024 sc1
    ds_read_b128 a[216:219], v10 offset:12288
    ds_read_b128 a[220:223], v11 offset:12288
    buffer_load_dwordx4 v[52:55], v9, s[4:7], s21 offen offset:0 sc1
    ds_read_b128 a[224:227], v10 offset:0
    ds_read_b128 a[228:231], v11 offset:0
    buffer_load_dwordx4 v[56:59], v9, s[4:7], s21 offen offset:1024 sc1
    s_waitcnt vmcnt(8)
    ds_read_b128 a[232:235], v10 offset:2048
    ds_read_b128 a[236:239], v11 offset:2048
    buffer_load_dwordx4 v[60:63], v9, s[4:7], s22 offen offset:0 sc1
    s_waitcnt vmcnt(7)
    ds_read_b128 a[240:243], v10 offset:4096
    ds_read_b128 a[244:247], v11 offset:4096
    buffer_load_dwordx4 v[64:67], v9, s[4:7], s22 offen offset:1024 sc1
    s_waitcnt vmcnt(6)
    ds_read_b128 a[248:251], v10 offset:6144
    ds_read_b128 a[252:255], v11 offset:6144
    buffer_load_dwordx4 v[68:71], v9, s[4:7], s23 offen offset:0 sc1
    buffer_load_dwordx4 v[72:75], v9, s[4:7], s23 offen offset:1024 sc1
    buffer_load_dwordx4 v[76:79], v9, s[4:7], s24 offen offset:0 sc1
    buffer_load_dwordx4 v[80:83], v9, s[4:7], s24 offen offset:1024 sc1
    buffer_load_dwordx4 v[84:87], v9, s[4:7], s25 offen offset:0 sc1
    buffer_load_dwordx4 v[88:91], v9, s[4:7], s25 offen offset:1024 sc1
    buffer_load_dwordx4 v[92:95], v9, s[4:7], s26 offen offset:0 sc1
    buffer_load_dwordx4 v[96:99], v9, s[4:7], s26 offen offset:1024 sc1
    buffer_load_dwordx4 v[100:103], v9, s[4:7], s27 offen offset:0 sc1
    buffer_load_dwordx4 v[104:107], v9, s[4:7], s27 offen offset:1024 sc1
    v_add_u32 v9, 65536, v9
L_adaL_w3back_24:
    s_waitcnt lgkmcnt(12)
    s_barrier
    s_waitcnt vmcnt(15)
    v_mfma_f32_16x16x32_bf16 v[144:147], v[44:47], a[0:3], 0
    s_lshl_b32 s64, s82, 12
    v_add_u32 v14, s64, v241
    v_add_u32 v3, 86528, v14
    v_mfma_f32_16x16x32_bf16 v[148:151], v[44:47], a[8:11], 0
    ds_read_b128 v[28:31], v3 offset:0
    v_mfma_f32_16x16x32_bf16 v[152:155], v[44:47], a[16:19], 0
    ds_read_b128 v[32:35], v3 offset:1024
    v_mfma_f32_16x16x32_bf16 v[156:159], v[44:47], a[24:27], 0
    buffer_load_dwordx4 v[44:47], v9, s[4:7], s20 offen offset:0 sc1
    s_waitcnt vmcnt(15)
    v_mfma_f32_16x16x32_bf16 v[144:147], v[48:51], a[4:7], v[144:147]
    ds_read_b128 v[36:39], v3 offset:2048
    v_mfma_f32_16x16x32_bf16 v[148:151], v[48:51], a[12:15], v[148:151]
    ds_read_b128 v[40:43], v3 offset:3072
    s_lshl_b32 s64, s82, 10
    v_mfma_f32_16x16x32_bf16 v[152:155], v[48:51], a[20:23], v[152:155]
    v_add_u32 v15, s64, v241
    s_lshl_b32 s62, s83, 6
    v_mfma_f32_16x16x32_bf16 v[156:159], v[48:51], a[28:31], v[156:159]
    buffer_load_dwordx4 v[48:51], v9, s[4:7], s20 offen offset:1024 sc1
    s_waitcnt vmcnt(15) lgkmcnt(3)
    v_mfma_f32_16x16x32_bf16 v[144:147], v[52:55], a[32:35], v[144:147]
    s_lshr_b32 s63, s82, 1
    s_lshl_b32 s63, s63, 5
    s_add_u32 s62, s62, s63
    v_mfma_f32_16x16x32_bf16 v[148:151], v[52:55], a[40:43], v[148:151]
    s_and_b32 s63, s82, 1
    s_add_u32 s52, s62, s63
    s_lshl_b32 s62, s52, 1
    v_mfma_f32_16x16x32_bf16 v[152:155], v[52:55], a[48:51], v[152:155]
    buffer_load_ushort v12, v12, s[12:15], s62 offen
    s_lshl_b32 s62, s83, 2
    v_mfma_f32_16x16x32_bf16 v[156:159], v[52:55], a[56:59], v[156:159]
    buffer_load_dwordx4 v[52:55], v9, s[4:7], s21 offen offset:0 sc1
    s_waitcnt vmcnt(16) lgkmcnt(0)
    v_mfma_f32_16x16x32_bf16 v[144:147], v[56:59], a[36:39], v[144:147]
    s_add_u32 s62, s62, s82
    s_mul_i32 s55, s62, 768
    s_add_u32 s55, s55, 24117248
    v_mfma_f32_16x16x32_bf16 v[148:151], v[56:59], a[44:47], v[148:151]
    s_mul_i32 s62, s62, 28672
    s_add_u32 s85, s62, 20447232
    s_lshl_b32 s57, s84, 11
    v_mfma_f32_16x16x32_bf16 v[152:155], v[56:59], a[52:55], v[152:155]
    s_add_u32 s57, s57, s85
    s_lshl_b32 s70, s84, 10
    s_add_u32 s70, s70, s85
    v_mfma_f32_16x16x32_bf16 v[156:159], v[56:59], a[60:63], v[156:159]
    buffer_load_dwordx4 v[56:59], v9, s[4:7], s21 offen offset:1024 sc1
    s_waitcnt vmcnt(16)
    v_mfma_f32_16x16x32_bf16 v[144:147], v[60:63], a[64:67], v[144:147]
    s_add_u32 s70, s70, 16384
    s_lshl_b32 s58, s84, 9
    s_add_u32 s58, s58, s85
    v_mfma_f32_16x16x32_bf16 v[148:151], v[60:63], a[72:75], v[148:151]
    s_add_u32 s58, s58, 24576
    s_mul_i32 s53, s82, 5120
    s_mul_i32 s59, s84, 143360
    v_mfma_f32_16x16x32_bf16 v[152:155], v[60:63], a[80:83], v[152:155]
    s_add_u32 s59, s59, s53
    s_add_u32 s59, s59, 11206656
    s_lshl_b32 s71, s84, 5
    v_mfma_f32_16x16x32_bf16 v[156:159], v[60:63], a[88:91], v[156:159]
    buffer_load_dwordx4 v[60:63], v9, s[4:7], s22 offen offset:0 sc1
    s_waitcnt vmcnt(16)
    v_mfma_f32_16x16x32_bf16 v[144:147], v[64:67], a[68:71], v[144:147]
    s_add_u32 s71, s71, s55
    v_mul_u32_u24 v133, 98560, v240
    s_lshr_b32 s62, s84, 2
    v_mfma_f32_16x16x32_bf16 v[148:151], v[64:67], a[76:79], v[148:151]
    s_mul_i32 s62, s62, 98560
    s_add_u32 s55, s55, s62
    v_add_u32 v128, 20480, v241
    v_mfma_f32_16x16x32_bf16 v[152:155], v[64:67], a[84:87], v[152:155]
    v_add_u32 v129, 81920, v241
    v_add_u32 v130, 143360, v241
    v_mfma_f32_16x16x32_bf16 v[156:159], v[64:67], a[92:95], v[156:159]
    buffer_load_dwordx4 v[64:67], v9, s[4:7], s22 offen offset:1024 sc1
    s_waitcnt vmcnt(16)
    v_mfma_f32_16x16x32_bf16 v[144:147], v[68:71], a[96:99], v[144:147]
    s_lshl_b32 s63, s82, 12
    v_add_u32 v131, 0, v240
    v_mul_u32_u24 v132, 205, v131
    v_mfma_f32_16x16x32_bf16 v[148:151], v[68:71], a[104:107], v[148:151]
    v_lshrrev_b32 v132, 11, v132
    v_add_u32 v134, v131, v132
    v_mfma_f32_16x16x32_bf16 v[152:155], v[68:71], a[112:115], v[152:155]
    v_lshl_add_u32 v134, v134, 4, s63
    v_mul_u32_u24 v132, 150, v132
    v_mfma_f32_16x16x32_bf16 v[156:159], v[68:71], a[120:123], v[156:159]
    buffer_load_dwordx4 v[68:71], v9, s[4:7], s23 offen offset:0 sc1
    s_waitcnt vmcnt(16)
    v_mfma_f32_16x16x32_bf16 v[144:147], v[72:75], a[100:103], v[144:147]
    v_add_lshl_u32 v138, v131, v132, 4
    v_add_u32 v131, 64, v240
    v_mfma_f32_16x16x32_bf16 v[148:151], v[72:75], a[108:111], v[148:151]
    v_mul_u32_u24 v132, 205, v131
    v_lshrrev_b32 v132, 11, v132
    v_mfma_f32_16x16x32_bf16 v[152:155], v[72:75], a[116:119], v[152:155]
    v_add_u32 v135, v131, v132
    v_lshl_add_u32 v135, v135, 4, s63
    v_mfma_f32_16x16x32_bf16 v[156:159], v[72:75], a[124:127], v[156:159]
    buffer_load_dwordx4 v[72:75], v9, s[4:7], s23 offen offset:1024 sc1
    s_waitcnt vmcnt(16)
    v_mfma_f32_16x16x32_bf16 v[144:147], v[76:79], a[128:131], v[144:147]
    v_mul_u32_u24 v132, 150, v132
    v_add_lshl_u32 v139, v131, v132, 4
    v_mfma_f32_16x16x32_bf16 v[148:151], v[76:79], a[136:139], v[148:151]
    v_add_u32 v131, 128, v240
    v_mul_u32_u24 v132, 205, v131
    v_mfma_f32_16x16x32_bf16 v[152:155], v[76:79], a[144:147], v[152:155]
    v_lshrrev_b32 v132, 11, v132
    v_add_u32 v136, v131, v132
    v_mfma_f32_16x16x32_bf16 v[156:159], v[76:79], a[152:155], v[156:159]
    buffer_load_dwordx4 v[76:79], v9, s[4:7], s24 offen offset:0 sc1
    s_waitcnt vmcnt(16)
    v_mfma_f32_16x16x32_bf16 v[144:147], v[80:83], a[132:135], v[144:147]
    v_lshl_add_u32 v136, v136, 4, s63
    v_mul_u32_u24 v132, 150, v132
    v_mfma_f32_16x16x32_bf16 v[148:151], v[80:83], a[140:143], v[148:151]
    v_add_lshl_u32 v140, v131, v132, 4
    v_lshlrev_b32 v131, 26, v240
    v_mfma_f32_16x16x32_bf16 v[152:155], v[80:83], a[148:151], v[152:155]
    v_and_b32 v131, 2147483648, v131
    v_or_b32 v140, v131, v140
    v_mfma_f32_16x16x32_bf16 v[156:159], v[80:83], a[156:159], v[156:159]
    buffer_load_dwordx4 v[80:83], v9, s[4:7], s24 offen offset:1024 sc1
    s_waitcnt vmcnt(16)
    v_mfma_f32_16x16x32_bf16 v[144:147], v[84:87], a[160:163], v[144:147]
    v_mul_u32_u24 v131, 176, v1
    v_add_u32 v131, s63, v131
    v_mfma_f32_16x16x32_bf16 v[148:151], v[84:87], a[168:171], v[148:151]
    s_mul_i32 s72, s52, 1280
    s_mul_i32 s63, s84, 160
    s_add_u32 s72, s72, s63
    v_mfma_f32_16x16x32_bf16 v[152:155], v[84:87], a[176:179], v[152:155]
    v_lshl_add_u32 v132, v2, 3, v131
    v_lshl_add_u32 v131, v2, 4, v131
    v_mfma_f32_16x16x32_bf16 v[156:159], v[84:87], a[184:187], v[156:159]
    buffer_load_dwordx4 v[84:87], v9, s[4:7], s25 offen offset:0 sc1
    s_waitcnt vmcnt(16)
    v_mfma_f32_16x16x32_bf16 v[144:147], v[88:91], a[164:167], v[144:147]
    v_mfma_f32_16x16x32_bf16 v[148:151], v[88:91], a[172:175], v[148:151]
    v_mfma_f32_16x16x32_bf16 v[152:155], v[88:91], a[180:183], v[152:155]
    v_mfma_f32_16x16x32_bf16 v[156:159], v[88:91], a[188:191], v[156:159]
    buffer_load_dwordx4 v[88:91], v9, s[4:7], s25 offen offset:1024 sc1
    s_waitcnt vmcnt(16)
    v_mfma_f32_16x16x32_bf16 v[144:147], v[92:95], a[192:195], v[144:147]
    v_mfma_f32_16x16x32_bf16 v[148:151], v[92:95], a[200:203], v[148:151]
    v_mfma_f32_16x16x32_bf16 v[152:155], v[92:95], a[208:211], v[152:155]
    v_mfma_f32_16x16x32_bf16 v[156:159], v[92:95], a[216:219], v[156:159]
    buffer_load_dwordx4 v[92:95], v9, s[4:7], s26 offen offset:0 sc1
    s_waitcnt vmcnt(16)
    v_mfma_f32_16x16x32_bf16 v[144:147], v[96:99], a[196:199], v[144:147]
    v_mfma_f32_16x16x32_bf16 v[148:151], v[96:99], a[204:207], v[148:151]
    v_mfma_f32_16x16x32_bf16 v[152:155], v[96:99], a[212:215], v[152:155]
    v_mfma_f32_16x16x32_bf16 v[156:159], v[96:99], a[220:223], v[156:159]
    buffer_load_dwordx4 v[96:99], v9, s[4:7], s26 offen offset:1024 sc1
    s_waitcnt vmcnt(16)
    v_mfma_f32_16x16x32_bf16 v[144:147], v[100:103], a[224:227], v[144:147]
    v_mfma_f32_16x16x32_bf16 v[148:151], v[100:103], a[232:235], v[148:151]
    v_mfma_f32_16x16x32_bf16 v[152:155], v[100:103], a[240:243], v[152:155]
    v_mfma_f32_16x16x32_bf16 v[156:159], v[100:103], a[248:251], v[156:159]
    buffer_load_dwordx4 v[100:103], v9, s[4:7], s27 offen offset:0 sc1
    s_waitcnt vmcnt(16)
    v_mfma_f32_16x16x32_bf16 v[144:147], v[104:107], a[228:231], v[144:147]
    v_mfma_f32_16x16x32_bf16 v[148:151], v[104:107], a[236:239], v[148:151]
    v_mfma_f32_16x16x32_bf16 v[152:155], v[104:107], a[244:247], v[152:155]
    v_mfma_f32_16x16x32_bf16 v[156:159], v[104:107], a[252:255], v[156:159]
    buffer_load_dwordx4 v[104:107], v9, s[4:7], s27 offen offset:1024 sc1
    v_add_u32 v9, 65536, v9
    s_waitcnt vmcnt(16)
    v_mfma_f32_16x16x32_bf16 v[160:163], v[44:47], a[0:3], 0
    v_mfma_f32_16x16x32_bf16 v[164:167], v[44:47], a[8:11], 0
    v_mfma_f32_16x16x32_bf16 v[168:171], v[44:47], a[16:19], 0
    v_mfma_f32_16x16x32_bf16 v[172:175], v[44:47], a[24:27], 0
    buffer_load_dwordx4 v[44:47], v9, s[4:7], s20 offen offset:0 sc1
    s_waitcnt vmcnt(16)
    v_mfma_f32_16x16x32_bf16 v[160:163], v[48:51], a[4:7], v[160:163]
    v_mfma_f32_16x16x32_bf16 v[164:167], v[48:51], a[12:15], v[164:167]
    v_mfma_f32_16x16x32_bf16 v[168:171], v[48:51], a[20:23], v[168:171]
    v_mfma_f32_16x16x32_bf16 v[172:175], v[48:51], a[28:31], v[172:175]
    buffer_load_dwordx4 v[48:51], v9, s[4:7], s20 offen offset:1024 sc1
    s_waitcnt vmcnt(15)
    v_mfma_f32_16x16x32_bf16 v[160:163], v[52:55], a[32:35], v[160:163]
    ds_write_b128 v14, v[144:147] offset:0
    v_mfma_f32_16x16x32_bf16 v[164:167], v[52:55], a[40:43], v[164:167]
    ds_write_b128 v14, v[148:151] offset:1024
    v_mfma_f32_16x16x32_bf16 v[168:171], v[52:55], a[48:51], v[168:171]
    ds_write_b128 v14, v[152:155] offset:2048
    v_mfma_f32_16x16x32_bf16 v[172:175], v[52:55], a[56:59], v[172:175]
    buffer_load_dwordx4 v[52:55], v9, s[4:7], s21 offen offset:0 sc1
    s_waitcnt vmcnt(15)
    v_mfma_f32_16x16x32_bf16 v[160:163], v[56:59], a[36:39], v[160:163]
    ds_write_b128 v14, v[156:159] offset:3072
    v_mfma_f32_16x16x32_bf16 v[164:167], v[56:59], a[44:47], v[164:167]
    v_mfma_f32_16x16x32_bf16 v[168:171], v[56:59], a[52:55], v[168:171]
    v_mfma_f32_16x16x32_bf16 v[172:175], v[56:59], a[60:63], v[172:175]
    buffer_load_dwordx4 v[56:59], v9, s[4:7], s21 offen offset:1024 sc1
    s_waitcnt vmcnt(15)
    v_mfma_f32_16x16x32_bf16 v[160:163], v[60:63], a[64:67], v[160:163]
    v_mfma_f32_16x16x32_bf16 v[164:167], v[60:63], a[72:75], v[164:167]
    v_mfma_f32_16x16x32_bf16 v[168:171], v[60:63], a[80:83], v[168:171]
    v_mfma_f32_16x16x32_bf16 v[172:175], v[60:63], a[88:91], v[172:175]
    buffer_load_dwordx4 v[60:63], v9, s[4:7], s22 offen offset:0 sc1
    s_waitcnt vmcnt(15) lgkmcnt(0)
    v_mfma_f32_16x16x32_bf16 v[160:163], v[64:67], a[68:71], v[160:163]
    s_barrier
    v_mfma_f32_16x16x32_bf16 v[164:167], v[64:67], a[76:79], v[164:167]
    ds_read_b128 v[176:179], v15 offset:0
    v_mfma_f32_16x16x32_bf16 v[168:171], v[64:67], a[84:87], v[168:171]
    ds_read_b128 v[180:183], v15 offset:4096
    v_mfma_f32_16x16x32_bf16 v[172:175], v[64:67], a[92:95], v[172:175]
    buffer_load_dwordx4 v[64:67], v9, s[4:7], s22 offen offset:1024 sc1
    s_waitcnt vmcnt(15)
    v_mfma_f32_16x16x32_bf16 v[160:163], v[68:71], a[96:99], v[160:163]
    ds_read_b128 v[184:187], v15 offset:8192
    v_mfma_f32_16x16x32_bf16 v[164:167], v[68:71], a[104:107], v[164:167]
    ds_read_b128 v[188:191], v15 offset:12288
    v_mfma_f32_16x16x32_bf16 v[168:171], v[68:71], a[112:115], v[168:171]
    v_mfma_f32_16x16x32_bf16 v[172:175], v[68:71], a[120:123], v[172:175]
    buffer_load_dwordx4 v[68:71], v9, s[4:7], s23 offen offset:0 sc1
    s_waitcnt vmcnt(15) lgkmcnt(3)
    v_mfma_f32_16x16x32_bf16 v[160:163], v[72:75], a[100:103], v[160:163]
    v_mfma_f32_16x16x32_bf16 v[164:167], v[72:75], a[108:111], v[164:167]
    v_mfma_f32_16x16x32_bf16 v[168:171], v[72:75], a[116:119], v[168:171]
    v_mfma_f32_16x16x32_bf16 v[172:175], v[72:75], a[124:127], v[172:175]
    buffer_load_dwordx4 v[72:75], v9, s[4:7], s23 offen offset:1024 sc1
    s_waitcnt vmcnt(15) lgkmcnt(0)
    v_mfma_f32_16x16x32_bf16 v[160:163], v[76:79], a[128:131], v[160:163]
    v_lshlrev_b32 v12, 16, v12
    v_lshlrev_b32 v200, 16, v28
    v_mfma_f32_16x16x32_bf16 v[164:167], v[76:79], a[136:139], v[164:167]
    v_lshlrev_b32 v201, 16, v29
    v_lshlrev_b32 v202, 16, v30
    v_mfma_f32_16x16x32_bf16 v[168:171], v[76:79], a[144:147], v[168:171]
    v_lshlrev_b32 v203, 16, v31
    v_add_f32 v176, v176, v12
    v_mfma_f32_16x16x32_bf16 v[172:175], v[76:79], a[152:155], v[172:175]
    buffer_load_dwordx4 v[76:79], v9, s[4:7], s24 offen offset:0 sc1
    s_waitcnt vmcnt(15)
    v_mfma_f32_16x16x32_bf16 v[160:163], v[80:83], a[132:135], v[160:163]
    v_add_f32 v177, v177, v12
    v_add_f32 v178, v178, v12
    v_mfma_f32_16x16x32_bf16 v[164:167], v[80:83], a[140:143], v[164:167]
    v_add_f32 v179, v179, v12
    v_add_f32 v176, v176, v180
    v_mfma_f32_16x16x32_bf16 v[168:171], v[80:83], a[148:151], v[168:171]
    v_add_f32 v177, v177, v181
    v_add_f32 v178, v178, v182
    v_mfma_f32_16x16x32_bf16 v[172:175], v[80:83], a[156:159], v[172:175]
    buffer_load_dwordx4 v[80:83], v9, s[4:7], s24 offen offset:1024 sc1
    s_waitcnt vmcnt(15)
    v_mfma_f32_16x16x32_bf16 v[160:163], v[84:87], a[160:163], v[160:163]
    v_add_f32 v179, v179, v183
    v_add_f32 v184, v184, v188
    v_mfma_f32_16x16x32_bf16 v[164:167], v[84:87], a[168:171], v[164:167]
    v_add_f32 v185, v185, v189
    v_add_f32 v186, v186, v190
    v_mfma_f32_16x16x32_bf16 v[168:171], v[84:87], a[176:179], v[168:171]
    v_add_f32 v187, v187, v191
    v_add_f32 v176, v176, v184
    v_mfma_f32_16x16x32_bf16 v[172:175], v[84:87], a[184:187], v[172:175]
    buffer_load_dwordx4 v[84:87], v9, s[4:7], s25 offen offset:0 sc1
    s_waitcnt vmcnt(15)
    v_mfma_f32_16x16x32_bf16 v[160:163], v[88:91], a[164:167], v[160:163]
    v_add_f32 v177, v177, v185
    v_add_f32 v178, v178, v186
    v_mfma_f32_16x16x32_bf16 v[164:167], v[88:91], a[172:175], v[164:167]
    v_add_f32 v179, v179, v187
    v_mul_f32 v192, v176, v200
    v_mfma_f32_16x16x32_bf16 v[168:171], v[88:91], a[180:183], v[168:171]
    v_mul_f32 v193, v177, v201
    v_mul_f32 v194, v178, v202
    v_mfma_f32_16x16x32_bf16 v[172:175], v[88:91], a[188:191], v[172:175]
    buffer_load_dwordx4 v[88:91], v9, s[4:7], s25 offen offset:1024 sc1
    s_waitcnt vmcnt(15)
    v_mfma_f32_16x16x32_bf16 v[160:163], v[92:95], a[192:195], v[160:163]
    v_mul_f32 v195, v179, v203
    v_mfma_f32_16x16x32_bf16 v[164:167], v[92:95], a[200:203], v[164:167]
    v_mfma_f32_16x16x32_bf16 v[168:171], v[92:95], a[208:211], v[168:171]
    v_mfma_f32_16x16x32_bf16 v[172:175], v[92:95], a[216:219], v[172:175]
    buffer_load_dwordx4 v[92:95], v9, s[4:7], s26 offen offset:0 sc1
    s_waitcnt vmcnt(15)
    v_mfma_f32_16x16x32_bf16 v[160:163], v[96:99], a[196:199], v[160:163]
    v_mfma_f32_16x16x32_bf16 v[164:167], v[96:99], a[204:207], v[164:167]
    v_mfma_f32_16x16x32_bf16 v[168:171], v[96:99], a[212:215], v[168:171]
    v_mfma_f32_16x16x32_bf16 v[172:175], v[96:99], a[220:223], v[172:175]
    buffer_load_dwordx4 v[96:99], v9, s[4:7], s26 offen offset:1024 sc1
    s_waitcnt vmcnt(15)
    v_mfma_f32_16x16x32_bf16 v[160:163], v[100:103], a[224:227], v[160:163]
    v_mfma_f32_16x16x32_bf16 v[164:167], v[100:103], a[232:235], v[164:167]
    v_mfma_f32_16x16x32_bf16 v[168:171], v[100:103], a[240:243], v[168:171]
    v_mfma_f32_16x16x32_bf16 v[172:175], v[100:103], a[248:251], v[172:175]
    buffer_load_dwordx4 v[100:103], v9, s[4:7], s27 offen offset:0 sc1
    s_waitcnt vmcnt(15)
    v_mfma_f32_16x16x32_bf16 v[160:163], v[104:107], a[228:231], v[160:163]
    v_mfma_f32_16x16x32_bf16 v[164:167], v[104:107], a[236:239], v[164:167]
    v_mfma_f32_16x16x32_bf16 v[168:171], v[104:107], a[244:247], v[168:171]
    v_mfma_f32_16x16x32_bf16 v[172:175], v[104:107], a[252:255], v[172:175]
    buffer_load_dwordx4 v[104:107], v9, s[4:7], s27 offen offset:1024 sc1
    v_add_u32 v9, 65536, v9
    s_waitcnt vmcnt(15)
    v_mfma_f32_16x16x32_bf16 v[144:147], v[44:47], a[0:3], 0
    v_mfma_f32_16x16x32_bf16 v[148:151], v[44:47], a[8:11], 0
    v_mfma_f32_16x16x32_bf16 v[152:155], v[44:47], a[16:19], 0
    v_mfma_f32_16x16x32_bf16 v[156:159], v[44:47], a[24:27], 0
    buffer_load_dwordx4 v[44:47], v9, s[4:7], s20 offen offset:0 sc1
    s_waitcnt vmcnt(15)
    v_mfma_f32_16x16x32_bf16 v[144:147], v[48:51], a[4:7], v[144:147]
    v_mfma_f32_16x16x32_bf16 v[148:151], v[48:51], a[12:15], v[148:151]
    v_mfma_f32_16x16x32_bf16 v[152:155], v[48:51], a[20:23], v[152:155]
    v_mfma_f32_16x16x32_bf16 v[156:159], v[48:51], a[28:31], v[156:159]
    buffer_load_dwordx4 v[48:51], v9, s[4:7], s20 offen offset:1024 sc1
    s_waitcnt vmcnt(15)
    v_mfma_f32_16x16x32_bf16 v[144:147], v[52:55], a[32:35], v[144:147]
    ds_write_b128 v14, v[160:163] offset:16384
    v_mfma_f32_16x16x32_bf16 v[148:151], v[52:55], a[40:43], v[148:151]
    ds_write_b128 v14, v[164:167] offset:17408
    v_mfma_f32_16x16x32_bf16 v[152:155], v[52:55], a[48:51], v[152:155]
    ds_write_b128 v14, v[168:171] offset:18432
    v_mfma_f32_16x16x32_bf16 v[156:159], v[52:55], a[56:59], v[156:159]
    buffer_load_dwordx4 v[52:55], v9, s[4:7], s21 offen offset:0 sc1
    s_waitcnt vmcnt(15)
    v_mfma_f32_16x16x32_bf16 v[144:147], v[56:59], a[36:39], v[144:147]
    ds_write_b128 v14, v[172:175] offset:19456
    v_mfma_f32_16x16x32_bf16 v[148:151], v[56:59], a[44:47], v[148:151]
    v_mfma_f32_16x16x32_bf16 v[152:155], v[56:59], a[52:55], v[152:155]
    v_mfma_f32_16x16x32_bf16 v[156:159], v[56:59], a[60:63], v[156:159]
    buffer_load_dwordx4 v[56:59], v9, s[4:7], s21 offen offset:1024 sc1
    s_waitcnt vmcnt(15)
    v_mfma_f32_16x16x32_bf16 v[144:147], v[60:63], a[64:67], v[144:147]
    v_mfma_f32_16x16x32_bf16 v[148:151], v[60:63], a[72:75], v[148:151]
    v_mfma_f32_16x16x32_bf16 v[152:155], v[60:63], a[80:83], v[152:155]
    v_mfma_f32_16x16x32_bf16 v[156:159], v[60:63], a[88:91], v[156:159]
    buffer_load_dwordx4 v[60:63], v9, s[4:7], s22 offen offset:0 sc1
    s_waitcnt vmcnt(15) lgkmcnt(0)
    v_mfma_f32_16x16x32_bf16 v[144:147], v[64:67], a[68:71], v[144:147]
    s_barrier
    v_mfma_f32_16x16x32_bf16 v[148:151], v[64:67], a[76:79], v[148:151]
    ds_read_b128 v[176:179], v15 offset:16384
    v_mfma_f32_16x16x32_bf16 v[152:155], v[64:67], a[84:87], v[152:155]
    ds_read_b128 v[180:183], v15 offset:20480
    v_mfma_f32_16x16x32_bf16 v[156:159], v[64:67], a[92:95], v[156:159]
    buffer_load_dwordx4 v[64:67], v9, s[4:7], s22 offen offset:1024 sc1
    s_waitcnt vmcnt(15)
    v_mfma_f32_16x16x32_bf16 v[144:147], v[68:71], a[96:99], v[144:147]
    ds_read_b128 v[184:187], v15 offset:24576
    v_mfma_f32_16x16x32_bf16 v[148:151], v[68:71], a[104:107], v[148:151]
    ds_read_b128 v[188:191], v15 offset:28672
    v_mfma_f32_16x16x32_bf16 v[152:155], v[68:71], a[112:115], v[152:155]
    v_mfma_f32_16x16x32_bf16 v[156:159], v[68:71], a[120:123], v[156:159]
    buffer_load_dwordx4 v[68:71], v9, s[4:7], s23 offen offset:0 sc1
    s_waitcnt vmcnt(15) lgkmcnt(3)
    v_mfma_f32_16x16x32_bf16 v[144:147], v[72:75], a[100:103], v[144:147]
    v_mfma_f32_16x16x32_bf16 v[148:151], v[72:75], a[108:111], v[148:151]
    v_mfma_f32_16x16x32_bf16 v[152:155], v[72:75], a[116:119], v[152:155]
    v_mfma_f32_16x16x32_bf16 v[156:159], v[72:75], a[124:127], v[156:159]
    buffer_load_dwordx4 v[72:75], v9, s[4:7], s23 offen offset:1024 sc1
    s_waitcnt vmcnt(15) lgkmcnt(0)
    v_mfma_f32_16x16x32_bf16 v[144:147], v[76:79], a[128:131], v[144:147]
    v_and_b32 v200, s3, v28
    v_and_b32 v201, s3, v29
    v_mfma_f32_16x16x32_bf16 v[148:151], v[76:79], a[136:139], v[148:151]
    v_and_b32 v202, s3, v30
    v_and_b32 v203, s3, v31
    v_mfma_f32_16x16x32_bf16 v[152:155], v[76:79], a[144:147], v[152:155]
    v_add_f32 v176, v176, v12
    v_add_f32 v177, v177, v12
    v_mfma_f32_16x16x32_bf16 v[156:159], v[76:79], a[152:155], v[156:159]
    buffer_load_dwordx4 v[76:79], v9, s[4:7], s24 offen offset:0 sc1
    s_waitcnt vmcnt(15)
    v_mfma_f32_16x16x32_bf16 v[144:147], v[80:83], a[132:135], v[144:147]
    v_add_f32 v178, v178, v12
    v_add_f32 v179, v179, v12
    v_mfma_f32_16x16x32_bf16 v[148:151], v[80:83], a[140:143], v[148:151]
    v_add_f32 v176, v176, v180
    v_add_f32 v177, v177, v181
    v_mfma_f32_16x16x32_bf16 v[152:155], v[80:83], a[148:151], v[152:155]
    v_add_f32 v178, v178, v182
    v_add_f32 v179, v179, v183
    v_mfma_f32_16x16x32_bf16 v[156:159], v[80:83], a[156:159], v[156:159]
    buffer_load_dwordx4 v[80:83], v9, s[4:7], s24 offen offset:1024 sc1
    s_waitcnt vmcnt(15)
    v_mfma_f32_16x16x32_bf16 v[144:147], v[84:87], a[160:163], v[144:147]
    v_add_f32 v184, v184, v188
    v_add_f32 v185, v185, v189
    v_mfma_f32_16x16x32_bf16 v[148:151], v[84:87], a[168:171], v[148:151]
    v_add_f32 v186, v186, v190
    v_add_f32 v187, v187, v191
    v_mfma_f32_16x16x32_bf16 v[152:155], v[84:87], a[176:179], v[152:155]
    v_add_f32 v176, v176, v184
    v_add_f32 v177, v177, v185
    v_mfma_f32_16x16x32_bf16 v[156:159], v[84:87], a[184:187], v[156:159]
    buffer_load_dwordx4 v[84:87], v9, s[4:7], s25 offen offset:0 sc1
    s_waitcnt vmcnt(15)
    v_mfma_f32_16x16x32_bf16 v[144:147], v[88:91], a[164:167], v[144:147]
    v_add_f32 v178, v178, v186
    v_add_f32 v179, v179, v187
    v_mfma_f32_16x16x32_bf16 v[148:151], v[88:91], a[172:175], v[148:151]
    v_mul_f32 v196, v176, v200
    v_mul_f32 v197, v177, v201
    v_mfma_f32_16x16x32_bf16 v[152:155], v[88:91], a[180:183], v[152:155]
    v_mul_f32 v198, v178, v202
    v_mul_f32 v199, v179, v203
    v_mfma_f32_16x16x32_bf16 v[156:159], v[88:91], a[188:191], v[156:159]
    buffer_load_dwordx4 v[88:91], v9, s[4:7], s25 offen offset:1024 sc1
    s_waitcnt vmcnt(15)
    v_mfma_f32_16x16x32_bf16 v[144:147], v[92:95], a[192:195], v[144:147]
    v_cvt_pk_bf16_f32 v28, v192, v196
    v_cvt_pk_bf16_f32 v29, v193, v197
    v_mfma_f32_16x16x32_bf16 v[148:151], v[92:95], a[200:203], v[148:151]
    v_cvt_pk_bf16_f32 v30, v194, v198
    v_cvt_pk_bf16_f32 v31, v195, v199
    v_mfma_f32_16x16x32_bf16 v[152:155], v[92:95], a[208:211], v[152:155]
    buffer_store_dwordx4 v[28:31], v241, s[4:7], s57 offen offset:0 sc1
    v_mfma_f32_16x16x32_bf16 v[156:159], v[92:95], a[216:219], v[156:159]
    buffer_load_dwordx4 v[92:95], v9, s[4:7], s26 offen offset:0 sc1
    s_waitcnt vmcnt(16)
    v_mfma_f32_16x16x32_bf16 v[144:147], v[96:99], a[196:199], v[144:147]
    v_mfma_f32_16x16x32_bf16 v[148:151], v[96:99], a[204:207], v[148:151]
    v_mfma_f32_16x16x32_bf16 v[152:155], v[96:99], a[212:215], v[152:155]
    v_mfma_f32_16x16x32_bf16 v[156:159], v[96:99], a[220:223], v[156:159]
    buffer_load_dwordx4 v[96:99], v9, s[4:7], s26 offen offset:1024 sc1
    s_waitcnt vmcnt(16)
    v_mfma_f32_16x16x32_bf16 v[144:147], v[100:103], a[224:227], v[144:147]
    v_mfma_f32_16x16x32_bf16 v[148:151], v[100:103], a[232:235], v[148:151]
    v_mfma_f32_16x16x32_bf16 v[152:155], v[100:103], a[240:243], v[152:155]
    v_mfma_f32_16x16x32_bf16 v[156:159], v[100:103], a[248:251], v[156:159]
    buffer_load_dwordx4 v[100:103], v9, s[4:7], s27 offen offset:0 sc1
    s_waitcnt vmcnt(16)
    v_mfma_f32_16x16x32_bf16 v[144:147], v[104:107], a[228:231], v[144:147]
    v_mfma_f32_16x16x32_bf16 v[148:151], v[104:107], a[236:239], v[148:151]
    v_mfma_f32_16x16x32_bf16 v[152:155], v[104:107], a[244:247], v[152:155]
    v_mfma_f32_16x16x32_bf16 v[156:159], v[104:107], a[252:255], v[156:159]
    buffer_load_dwordx4 v[104:107], v9, s[4:7], s27 offen offset:1024 sc1
    v_add_u32 v9, 65536, v9
    s_waitcnt vmcnt(16)
    v_mfma_f32_16x16x32_bf16 v[160:163], v[44:47], a[0:3], 0
    v_mfma_f32_16x16x32_bf16 v[164:167], v[44:47], a[8:11], 0
    v_mfma_f32_16x16x32_bf16 v[168:171], v[44:47], a[16:19], 0
    v_mfma_f32_16x16x32_bf16 v[172:175], v[44:47], a[24:27], 0
    buffer_load_dwordx4 v[44:47], v9, s[4:7], s20 offen offset:0 sc1
    s_waitcnt vmcnt(16)
    v_mfma_f32_16x16x32_bf16 v[160:163], v[48:51], a[4:7], v[160:163]
    v_mfma_f32_16x16x32_bf16 v[164:167], v[48:51], a[12:15], v[164:167]
    v_mfma_f32_16x16x32_bf16 v[168:171], v[48:51], a[20:23], v[168:171]
    v_mfma_f32_16x16x32_bf16 v[172:175], v[48:51], a[28:31], v[172:175]
    buffer_load_dwordx4 v[48:51], v9, s[4:7], s20 offen offset:1024 sc1
    s_waitcnt vmcnt(16)
    v_mfma_f32_16x16x32_bf16 v[160:163], v[52:55], a[32:35], v[160:163]
    ds_write_b128 v14, v[144:147] offset:0
    v_mfma_f32_16x16x32_bf16 v[164:167], v[52:55], a[40:43], v[164:167]
    ds_write_b128 v14, v[148:151] offset:1024
    v_mfma_f32_16x16x32_bf16 v[168:171], v[52:55], a[48:51], v[168:171]
    ds_write_b128 v14, v[152:155] offset:2048
    v_mfma_f32_16x16x32_bf16 v[172:175], v[52:55], a[56:59], v[172:175]
    buffer_load_dwordx4 v[52:55], v9, s[4:7], s21 offen offset:0 sc1
    s_waitcnt vmcnt(16)
    v_mfma_f32_16x16x32_bf16 v[160:163], v[56:59], a[36:39], v[160:163]
    ds_write_b128 v14, v[156:159] offset:3072
    v_mfma_f32_16x16x32_bf16 v[164:167], v[56:59], a[44:47], v[164:167]
    v_mfma_f32_16x16x32_bf16 v[168:171], v[56:59], a[52:55], v[168:171]
    v_mfma_f32_16x16x32_bf16 v[172:175], v[56:59], a[60:63], v[172:175]
    buffer_load_dwordx4 v[56:59], v9, s[4:7], s21 offen offset:1024 sc1
    s_waitcnt vmcnt(16)
    v_mfma_f32_16x16x32_bf16 v[160:163], v[60:63], a[64:67], v[160:163]
    v_mfma_f32_16x16x32_bf16 v[164:167], v[60:63], a[72:75], v[164:167]
    v_mfma_f32_16x16x32_bf16 v[168:171], v[60:63], a[80:83], v[168:171]
    v_mfma_f32_16x16x32_bf16 v[172:175], v[60:63], a[88:91], v[172:175]
    buffer_load_dwordx4 v[60:63], v9, s[4:7], s22 offen offset:0 sc1
    s_waitcnt vmcnt(16) lgkmcnt(0)
    v_mfma_f32_16x16x32_bf16 v[160:163], v[64:67], a[68:71], v[160:163]
    s_barrier
    v_mfma_f32_16x16x32_bf16 v[164:167], v[64:67], a[76:79], v[164:167]
    ds_read_b128 v[176:179], v15 offset:0
    v_mfma_f32_16x16x32_bf16 v[168:171], v[64:67], a[84:87], v[168:171]
    ds_read_b128 v[180:183], v15 offset:4096
    v_mfma_f32_16x16x32_bf16 v[172:175], v[64:67], a[92:95], v[172:175]
    buffer_load_dwordx4 v[64:67], v9, s[4:7], s22 offen offset:1024 sc1
    s_waitcnt vmcnt(16)
    v_mfma_f32_16x16x32_bf16 v[160:163], v[68:71], a[96:99], v[160:163]
    ds_read_b128 v[184:187], v15 offset:8192
    v_mfma_f32_16x16x32_bf16 v[164:167], v[68:71], a[104:107], v[164:167]
    ds_read_b128 v[188:191], v15 offset:12288
    v_mfma_f32_16x16x32_bf16 v[168:171], v[68:71], a[112:115], v[168:171]
    v_mfma_f32_16x16x32_bf16 v[172:175], v[68:71], a[120:123], v[172:175]
    buffer_load_dwordx4 v[68:71], v9, s[4:7], s23 offen offset:0 sc1
    s_waitcnt vmcnt(16) lgkmcnt(3)
    v_mfma_f32_16x16x32_bf16 v[160:163], v[72:75], a[100:103], v[160:163]
    v_mfma_f32_16x16x32_bf16 v[164:167], v[72:75], a[108:111], v[164:167]
    v_mfma_f32_16x16x32_bf16 v[168:171], v[72:75], a[116:119], v[168:171]
    v_mfma_f32_16x16x32_bf16 v[172:175], v[72:75], a[124:127], v[172:175]
    buffer_load_dwordx4 v[72:75], v9, s[4:7], s23 offen offset:1024 sc1
    s_waitcnt vmcnt(16) lgkmcnt(0)
    v_mfma_f32_16x16x32_bf16 v[160:163], v[76:79], a[128:131], v[160:163]
    v_lshlrev_b32 v200, 16, v32
    v_lshlrev_b32 v201, 16, v33
    v_mfma_f32_16x16x32_bf16 v[164:167], v[76:79], a[136:139], v[164:167]
    v_lshlrev_b32 v202, 16, v34
    v_lshlrev_b32 v203, 16, v35
    v_mfma_f32_16x16x32_bf16 v[168:171], v[76:79], a[144:147], v[168:171]
    v_add_f32 v176, v176, v12
    v_add_f32 v177, v177, v12
    v_mfma_f32_16x16x32_bf16 v[172:175], v[76:79], a[152:155], v[172:175]
    buffer_load_dwordx4 v[76:79], v9, s[4:7], s24 offen offset:0 sc1
    s_waitcnt vmcnt(16)
    v_mfma_f32_16x16x32_bf16 v[160:163], v[80:83], a[132:135], v[160:163]
    v_add_f32 v178, v178, v12
    v_add_f32 v179, v179, v12
    v_mfma_f32_16x16x32_bf16 v[164:167], v[80:83], a[140:143], v[164:167]
    v_add_f32 v176, v176, v180
    v_add_f32 v177, v177, v181
    v_mfma_f32_16x16x32_bf16 v[168:171], v[80:83], a[148:151], v[168:171]
    v_add_f32 v178, v178, v182
    v_add_f32 v179, v179, v183
    v_mfma_f32_16x16x32_bf16 v[172:175], v[80:83], a[156:159], v[172:175]
    buffer_load_dwordx4 v[80:83], v9, s[4:7], s24 offen offset:1024 sc1
    s_waitcnt vmcnt(16)
    v_mfma_f32_16x16x32_bf16 v[160:163], v[84:87], a[160:163], v[160:163]
    v_add_f32 v184, v184, v188
    v_add_f32 v185, v185, v189
    v_mfma_f32_16x16x32_bf16 v[164:167], v[84:87], a[168:171], v[164:167]
    v_add_f32 v186, v186, v190
    v_add_f32 v187, v187, v191
    v_mfma_f32_16x16x32_bf16 v[168:171], v[84:87], a[176:179], v[168:171]
    v_add_f32 v176, v176, v184
    v_add_f32 v177, v177, v185
    v_mfma_f32_16x16x32_bf16 v[172:175], v[84:87], a[184:187], v[172:175]
    buffer_load_dwordx4 v[84:87], v9, s[4:7], s25 offen offset:0 sc1
    s_waitcnt vmcnt(16)
    v_mfma_f32_16x16x32_bf16 v[160:163], v[88:91], a[164:167], v[160:163]
    v_add_f32 v178, v178, v186
    v_add_f32 v179, v179, v187
    v_mfma_f32_16x16x32_bf16 v[164:167], v[88:91], a[172:175], v[164:167]
    v_mul_f32 v192, v176, v200
    v_mul_f32 v193, v177, v201
    v_mfma_f32_16x16x32_bf16 v[168:171], v[88:91], a[180:183], v[168:171]
    v_mul_f32 v194, v178, v202
    v_mul_f32 v195, v179, v203
    v_mfma_f32_16x16x32_bf16 v[172:175], v[88:91], a[188:191], v[172:175]
    buffer_load_dwordx4 v[88:91], v9, s[4:7], s25 offen offset:1024 sc1
    s_waitcnt vmcnt(15)
    v_mfma_f32_16x16x32_bf16 v[160:163], v[92:95], a[192:195], v[160:163]
    v_mfma_f32_16x16x32_bf16 v[164:167], v[92:95], a[200:203], v[164:167]
    v_mfma_f32_16x16x32_bf16 v[168:171], v[92:95], a[208:211], v[168:171]
    v_mfma_f32_16x16x32_bf16 v[172:175], v[92:95], a[216:219], v[172:175]
    buffer_load_dwordx4 v[92:95], v9, s[4:7], s26 offen offset:0 sc1
    s_waitcnt vmcnt(15)
    v_mfma_f32_16x16x32_bf16 v[160:163], v[96:99], a[196:199], v[160:163]
    v_mfma_f32_16x16x32_bf16 v[164:167], v[96:99], a[204:207], v[164:167]
    v_mfma_f32_16x16x32_bf16 v[168:171], v[96:99], a[212:215], v[168:171]
    v_mfma_f32_16x16x32_bf16 v[172:175], v[96:99], a[220:223], v[172:175]
    buffer_load_dwordx4 v[96:99], v9, s[4:7], s26 offen offset:1024 sc1
    s_waitcnt vmcnt(15)
    v_mfma_f32_16x16x32_bf16 v[160:163], v[100:103], a[224:227], v[160:163]
    v_mfma_f32_16x16x32_bf16 v[164:167], v[100:103], a[232:235], v[164:167]
    v_mfma_f32_16x16x32_bf16 v[168:171], v[100:103], a[240:243], v[168:171]
    v_mfma_f32_16x16x32_bf16 v[172:175], v[100:103], a[248:251], v[172:175]
    buffer_load_dwordx4 v[100:103], v9, s[4:7], s27 offen offset:0 sc1
    s_waitcnt vmcnt(15)
    v_mfma_f32_16x16x32_bf16 v[160:163], v[104:107], a[228:231], v[160:163]
    v_mfma_f32_16x16x32_bf16 v[164:167], v[104:107], a[236:239], v[164:167]
    v_mfma_f32_16x16x32_bf16 v[168:171], v[104:107], a[244:247], v[168:171]
    v_mfma_f32_16x16x32_bf16 v[172:175], v[104:107], a[252:255], v[172:175]
    buffer_load_dwordx4 v[104:107], v9, s[4:7], s27 offen offset:1024 sc1
    v_add_u32 v9, 65536, v9
    s_waitcnt vmcnt(15)
    v_mfma_f32_16x16x32_bf16 v[144:147], v[44:47], a[0:3], 0
    v_mfma_f32_16x16x32_bf16 v[148:151], v[44:47], a[8:11], 0
    v_mfma_f32_16x16x32_bf16 v[152:155], v[44:47], a[16:19], 0
    v_mfma_f32_16x16x32_bf16 v[156:159], v[44:47], a[24:27], 0
    buffer_load_dwordx4 v[44:47], v9, s[4:7], s20 offen offset:0 sc1
    s_waitcnt vmcnt(15)
    v_mfma_f32_16x16x32_bf16 v[144:147], v[48:51], a[4:7], v[144:147]
    v_mfma_f32_16x16x32_bf16 v[148:151], v[48:51], a[12:15], v[148:151]
    v_mfma_f32_16x16x32_bf16 v[152:155], v[48:51], a[20:23], v[152:155]
    v_mfma_f32_16x16x32_bf16 v[156:159], v[48:51], a[28:31], v[156:159]
    buffer_load_dwordx4 v[48:51], v9, s[4:7], s20 offen offset:1024 sc1
    s_waitcnt vmcnt(15)
    v_mfma_f32_16x16x32_bf16 v[144:147], v[52:55], a[32:35], v[144:147]
    ds_write_b128 v14, v[160:163] offset:16384
    v_mfma_f32_16x16x32_bf16 v[148:151], v[52:55], a[40:43], v[148:151]
    ds_write_b128 v14, v[164:167] offset:17408
    v_mfma_f32_16x16x32_bf16 v[152:155], v[52:55], a[48:51], v[152:155]
    ds_write_b128 v14, v[168:171] offset:18432
    v_mfma_f32_16x16x32_bf16 v[156:159], v[52:55], a[56:59], v[156:159]
    buffer_load_dwordx4 v[52:55], v9, s[4:7], s21 offen offset:0 sc1
    s_waitcnt vmcnt(15)
    v_mfma_f32_16x16x32_bf16 v[144:147], v[56:59], a[36:39], v[144:147]
    ds_write_b128 v14, v[172:175] offset:19456
    v_mfma_f32_16x16x32_bf16 v[148:151], v[56:59], a[44:47], v[148:151]
    v_mfma_f32_16x16x32_bf16 v[152:155], v[56:59], a[52:55], v[152:155]
    v_mfma_f32_16x16x32_bf16 v[156:159], v[56:59], a[60:63], v[156:159]
    buffer_load_dwordx4 v[56:59], v9, s[4:7], s21 offen offset:1024 sc1
    s_waitcnt vmcnt(15)
    v_mfma_f32_16x16x32_bf16 v[144:147], v[60:63], a[64:67], v[144:147]
    v_mfma_f32_16x16x32_bf16 v[148:151], v[60:63], a[72:75], v[148:151]
    v_mfma_f32_16x16x32_bf16 v[152:155], v[60:63], a[80:83], v[152:155]
    v_mfma_f32_16x16x32_bf16 v[156:159], v[60:63], a[88:91], v[156:159]
    buffer_load_dwordx4 v[60:63], v9, s[4:7], s22 offen offset:0 sc1
    s_waitcnt vmcnt(15) lgkmcnt(0)
    v_mfma_f32_16x16x32_bf16 v[144:147], v[64:67], a[68:71], v[144:147]
    s_barrier
    v_mfma_f32_16x16x32_bf16 v[148:151], v[64:67], a[76:79], v[148:151]
    ds_read_b128 v[176:179], v15 offset:16384
    v_mfma_f32_16x16x32_bf16 v[152:155], v[64:67], a[84:87], v[152:155]
    ds_read_b128 v[180:183], v15 offset:20480
    v_mfma_f32_16x16x32_bf16 v[156:159], v[64:67], a[92:95], v[156:159]
    buffer_load_dwordx4 v[64:67], v9, s[4:7], s22 offen offset:1024 sc1
    s_waitcnt vmcnt(15)
    v_mfma_f32_16x16x32_bf16 v[144:147], v[68:71], a[96:99], v[144:147]
    ds_read_b128 v[184:187], v15 offset:24576
    v_mfma_f32_16x16x32_bf16 v[148:151], v[68:71], a[104:107], v[148:151]
    ds_read_b128 v[188:191], v15 offset:28672
    v_mfma_f32_16x16x32_bf16 v[152:155], v[68:71], a[112:115], v[152:155]
    v_mfma_f32_16x16x32_bf16 v[156:159], v[68:71], a[120:123], v[156:159]
    buffer_load_dwordx4 v[68:71], v9, s[4:7], s23 offen offset:0 sc1
    s_waitcnt vmcnt(15) lgkmcnt(3)
    v_mfma_f32_16x16x32_bf16 v[144:147], v[72:75], a[100:103], v[144:147]
    v_mfma_f32_16x16x32_bf16 v[148:151], v[72:75], a[108:111], v[148:151]
    v_mfma_f32_16x16x32_bf16 v[152:155], v[72:75], a[116:119], v[152:155]
    v_mfma_f32_16x16x32_bf16 v[156:159], v[72:75], a[124:127], v[156:159]
    buffer_load_dwordx4 v[72:75], v9, s[4:7], s23 offen offset:1024 sc1
    s_waitcnt vmcnt(15) lgkmcnt(0)
    v_mfma_f32_16x16x32_bf16 v[144:147], v[76:79], a[128:131], v[144:147]
    v_and_b32 v200, s3, v32
    v_and_b32 v201, s3, v33
    v_mfma_f32_16x16x32_bf16 v[148:151], v[76:79], a[136:139], v[148:151]
    v_and_b32 v202, s3, v34
    v_and_b32 v203, s3, v35
    v_mfma_f32_16x16x32_bf16 v[152:155], v[76:79], a[144:147], v[152:155]
    v_add_f32 v176, v176, v12
    v_add_f32 v177, v177, v12
    v_mfma_f32_16x16x32_bf16 v[156:159], v[76:79], a[152:155], v[156:159]
    buffer_load_dwordx4 v[76:79], v9, s[4:7], s24 offen offset:0 sc1
    s_waitcnt vmcnt(15)
    v_mfma_f32_16x16x32_bf16 v[144:147], v[80:83], a[132:135], v[144:147]
    v_add_f32 v178, v178, v12
    v_add_f32 v179, v179, v12
    v_mfma_f32_16x16x32_bf16 v[148:151], v[80:83], a[140:143], v[148:151]
    v_add_f32 v176, v176, v180
    v_add_f32 v177, v177, v181
    v_mfma_f32_16x16x32_bf16 v[152:155], v[80:83], a[148:151], v[152:155]
    v_add_f32 v178, v178, v182
    v_add_f32 v179, v179, v183
    v_mfma_f32_16x16x32_bf16 v[156:159], v[80:83], a[156:159], v[156:159]
    buffer_load_dwordx4 v[80:83], v9, s[4:7], s24 offen offset:1024 sc1
    s_waitcnt vmcnt(15)
    v_mfma_f32_16x16x32_bf16 v[144:147], v[84:87], a[160:163], v[144:147]
    v_add_f32 v184, v184, v188
    v_add_f32 v185, v185, v189
    v_mfma_f32_16x16x32_bf16 v[148:151], v[84:87], a[168:171], v[148:151]
    v_add_f32 v186, v186, v190
    v_add_f32 v187, v187, v191
    v_mfma_f32_16x16x32_bf16 v[152:155], v[84:87], a[176:179], v[152:155]
    v_add_f32 v176, v176, v184
    v_add_f32 v177, v177, v185
    v_mfma_f32_16x16x32_bf16 v[156:159], v[84:87], a[184:187], v[156:159]
    buffer_load_dwordx4 v[84:87], v9, s[4:7], s25 offen offset:0 sc1
    s_waitcnt vmcnt(15)
    v_mfma_f32_16x16x32_bf16 v[144:147], v[88:91], a[164:167], v[144:147]
    v_add_f32 v178, v178, v186
    v_add_f32 v179, v179, v187
    v_mfma_f32_16x16x32_bf16 v[148:151], v[88:91], a[172:175], v[148:151]
    v_mul_f32 v196, v176, v200
    v_mul_f32 v197, v177, v201
    v_mfma_f32_16x16x32_bf16 v[152:155], v[88:91], a[180:183], v[152:155]
    v_mul_f32 v198, v178, v202
    v_mul_f32 v199, v179, v203
    v_mfma_f32_16x16x32_bf16 v[156:159], v[88:91], a[188:191], v[156:159]
    buffer_load_dwordx4 v[88:91], v9, s[4:7], s25 offen offset:1024 sc1
    s_waitcnt vmcnt(15)
    v_mfma_f32_16x16x32_bf16 v[144:147], v[92:95], a[192:195], v[144:147]
    v_cvt_pk_bf16_f32 v32, v192, v196
    v_cvt_pk_bf16_f32 v33, v193, v197
    v_mfma_f32_16x16x32_bf16 v[148:151], v[92:95], a[200:203], v[148:151]
    v_cvt_pk_bf16_f32 v34, v194, v198
    v_cvt_pk_bf16_f32 v35, v195, v199
    v_mfma_f32_16x16x32_bf16 v[152:155], v[92:95], a[208:211], v[152:155]
    buffer_store_dwordx4 v[32:35], v241, s[4:7], s57 offen offset:1024 sc1
    v_mfma_f32_16x16x32_bf16 v[156:159], v[92:95], a[216:219], v[156:159]
    buffer_load_dwordx4 v[92:95], v9, s[4:7], s26 offen offset:0 sc1
    s_waitcnt vmcnt(16)
    v_mfma_f32_16x16x32_bf16 v[144:147], v[96:99], a[196:199], v[144:147]
    v_mfma_f32_16x16x32_bf16 v[148:151], v[96:99], a[204:207], v[148:151]
    v_mfma_f32_16x16x32_bf16 v[152:155], v[96:99], a[212:215], v[152:155]
    v_mfma_f32_16x16x32_bf16 v[156:159], v[96:99], a[220:223], v[156:159]
    buffer_load_dwordx4 v[96:99], v9, s[4:7], s26 offen offset:1024 sc1
    s_waitcnt vmcnt(16)
    v_mfma_f32_16x16x32_bf16 v[144:147], v[100:103], a[224:227], v[144:147]
    v_mfma_f32_16x16x32_bf16 v[148:151], v[100:103], a[232:235], v[148:151]
    v_mfma_f32_16x16x32_bf16 v[152:155], v[100:103], a[240:243], v[152:155]
    v_mfma_f32_16x16x32_bf16 v[156:159], v[100:103], a[248:251], v[156:159]
    buffer_load_dwordx4 v[100:103], v9, s[4:7], s27 offen offset:0 sc1
    s_waitcnt vmcnt(16)
    v_mfma_f32_16x16x32_bf16 v[144:147], v[104:107], a[228:231], v[144:147]
    v_mfma_f32_16x16x32_bf16 v[148:151], v[104:107], a[236:239], v[148:151]
    v_mfma_f32_16x16x32_bf16 v[152:155], v[104:107], a[244:247], v[152:155]
    v_mfma_f32_16x16x32_bf16 v[156:159], v[104:107], a[252:255], v[156:159]
    buffer_load_dwordx4 v[104:107], v9, s[4:7], s27 offen offset:1024 sc1
    v_add_u32 v9, 65536, v9
    s_waitcnt vmcnt(16)
    v_mfma_f32_16x16x32_bf16 v[160:163], v[44:47], a[0:3], 0
    v_mfma_f32_16x16x32_bf16 v[164:167], v[44:47], a[8:11], 0
    v_mfma_f32_16x16x32_bf16 v[168:171], v[44:47], a[16:19], 0
    v_mfma_f32_16x16x32_bf16 v[172:175], v[44:47], a[24:27], 0
    buffer_load_dwordx4 v[44:47], v9, s[4:7], s20 offen offset:0 sc1
    s_waitcnt vmcnt(16)
    v_mfma_f32_16x16x32_bf16 v[160:163], v[48:51], a[4:7], v[160:163]
    v_mfma_f32_16x16x32_bf16 v[164:167], v[48:51], a[12:15], v[164:167]
    v_mfma_f32_16x16x32_bf16 v[168:171], v[48:51], a[20:23], v[168:171]
    v_mfma_f32_16x16x32_bf16 v[172:175], v[48:51], a[28:31], v[172:175]
    buffer_load_dwordx4 v[48:51], v9, s[4:7], s20 offen offset:1024 sc1
    s_waitcnt vmcnt(16)
    v_mfma_f32_16x16x32_bf16 v[160:163], v[52:55], a[32:35], v[160:163]
    ds_write_b128 v14, v[144:147] offset:0
    v_mfma_f32_16x16x32_bf16 v[164:167], v[52:55], a[40:43], v[164:167]
    ds_write_b128 v14, v[148:151] offset:1024
    v_mfma_f32_16x16x32_bf16 v[168:171], v[52:55], a[48:51], v[168:171]
    ds_write_b128 v14, v[152:155] offset:2048
    v_mfma_f32_16x16x32_bf16 v[172:175], v[52:55], a[56:59], v[172:175]
    buffer_load_dwordx4 v[52:55], v9, s[4:7], s21 offen offset:0 sc1
    s_waitcnt vmcnt(16)
    v_mfma_f32_16x16x32_bf16 v[160:163], v[56:59], a[36:39], v[160:163]
    ds_write_b128 v14, v[156:159] offset:3072
    v_mfma_f32_16x16x32_bf16 v[164:167], v[56:59], a[44:47], v[164:167]
    v_mfma_f32_16x16x32_bf16 v[168:171], v[56:59], a[52:55], v[168:171]
    v_mfma_f32_16x16x32_bf16 v[172:175], v[56:59], a[60:63], v[172:175]
    buffer_load_dwordx4 v[56:59], v9, s[4:7], s21 offen offset:1024 sc1
    s_waitcnt vmcnt(8)
    s_mov_b64 exec, 3
    buffer_store_dword v13, v133, s[4:7], s71 offen sc1
    s_mov_b64 exec, -1
    s_add_u32 s71, s71, 256
    v_mfma_f32_16x16x32_bf16 v[160:163], v[60:63], a[64:67], v[160:163]
    v_mfma_f32_16x16x32_bf16 v[164:167], v[60:63], a[72:75], v[164:167]
    v_mfma_f32_16x16x32_bf16 v[168:171], v[60:63], a[80:83], v[168:171]
    v_mfma_f32_16x16x32_bf16 v[172:175], v[60:63], a[88:91], v[172:175]
    buffer_load_dwordx4 v[60:63], v9, s[4:7], s22 offen offset:0 sc1
    v_mfma_f32_16x16x32_bf16 v[160:163], v[64:67], a[68:71], v[160:163]
    s_waitcnt lgkmcnt(0)
    s_barrier
    v_mfma_f32_16x16x32_bf16 v[164:167], v[64:67], a[76:79], v[164:167]
    ds_read_b128 v[176:179], v15 offset:0
    v_mfma_f32_16x16x32_bf16 v[168:171], v[64:67], a[84:87], v[168:171]
    ds_read_b128 v[180:183], v15 offset:4096
    v_mfma_f32_16x16x32_bf16 v[172:175], v[64:67], a[92:95], v[172:175]
    buffer_load_dwordx4 v[64:67], v9, s[4:7], s22 offen offset:1024 sc1
    v_mfma_f32_16x16x32_bf16 v[160:163], v[68:71], a[96:99], v[160:163]
    ds_read_b128 v[184:187], v15 offset:8192
    v_mfma_f32_16x16x32_bf16 v[164:167], v[68:71], a[104:107], v[164:167]
    ds_read_b128 v[188:191], v15 offset:12288
    v_mfma_f32_16x16x32_bf16 v[168:171], v[68:71], a[112:115], v[168:171]
    v_mfma_f32_16x16x32_bf16 v[172:175], v[68:71], a[120:123], v[172:175]
    buffer_load_dwordx4 v[68:71], v9, s[4:7], s23 offen offset:0 sc1
    v_mfma_f32_16x16x32_bf16 v[160:163], v[72:75], a[100:103], v[160:163]
    v_mfma_f32_16x16x32_bf16 v[164:167], v[72:75], a[108:111], v[164:167]
    v_mfma_f32_16x16x32_bf16 v[168:171], v[72:75], a[116:119], v[168:171]
    v_mfma_f32_16x16x32_bf16 v[172:175], v[72:75], a[124:127], v[172:175]
    buffer_load_dwordx4 v[72:75], v9, s[4:7], s23 offen offset:1024 sc1
    v_mfma_f32_16x16x32_bf16 v[160:163], v[76:79], a[128:131], v[160:163]
    v_lshlrev_b32 v200, 16, v36
    v_lshlrev_b32 v201, 16, v37
    v_mfma_f32_16x16x32_bf16 v[164:167], v[76:79], a[136:139], v[164:167]
    v_lshlrev_b32 v202, 16, v38
    v_lshlrev_b32 v203, 16, v39
    v_mfma_f32_16x16x32_bf16 v[168:171], v[76:79], a[144:147], v[168:171]
    s_waitcnt lgkmcnt(0)
    v_add_f32 v176, v176, v12
    v_add_f32 v177, v177, v12
    v_mfma_f32_16x16x32_bf16 v[172:175], v[76:79], a[152:155], v[172:175]
    buffer_load_dwordx4 v[76:79], v9, s[4:7], s24 offen offset:0 sc1
    v_mfma_f32_16x16x32_bf16 v[160:163], v[80:83], a[132:135], v[160:163]
    v_add_f32 v178, v178, v12
    v_add_f32 v179, v179, v12
    v_mfma_f32_16x16x32_bf16 v[164:167], v[80:83], a[140:143], v[164:167]
    v_add_f32 v176, v176, v180
    v_add_f32 v177, v177, v181
    v_mfma_f32_16x16x32_bf16 v[168:171], v[80:83], a[148:151], v[168:171]
    v_add_f32 v178, v178, v182
    v_add_f32 v179, v179, v183
    v_mfma_f32_16x16x32_bf16 v[172:175], v[80:83], a[156:159], v[172:175]
    buffer_load_dwordx4 v[80:83], v9, s[4:7], s24 offen offset:1024 sc1
    v_mfma_f32_16x16x32_bf16 v[160:163], v[84:87], a[160:163], v[160:163]
    v_add_f32 v184, v184, v188
    v_add_f32 v185, v185, v189
    v_mfma_f32_16x16x32_bf16 v[164:167], v[84:87], a[168:171], v[164:167]
    v_add_f32 v186, v186, v190
    v_add_f32 v187, v187, v191
    v_mfma_f32_16x16x32_bf16 v[168:171], v[84:87], a[176:179], v[168:171]
    v_add_f32 v176, v176, v184
    v_add_f32 v177, v177, v185
    v_mfma_f32_16x16x32_bf16 v[172:175], v[84:87], a[184:187], v[172:175]
    buffer_load_dwordx4 v[84:87], v9, s[4:7], s25 offen offset:0 sc1
    v_mfma_f32_16x16x32_bf16 v[160:163], v[88:91], a[164:167], v[160:163]
    v_add_f32 v178, v178, v186
    v_add_f32 v179, v179, v187
    v_mfma_f32_16x16x32_bf16 v[164:167], v[88:91], a[172:175], v[164:167]
    v_mul_f32 v192, v176, v200
    v_mul_f32 v193, v177, v201
    v_mfma_f32_16x16x32_bf16 v[168:171], v[88:91], a[180:183], v[168:171]
    v_mul_f32 v194, v178, v202
    v_mul_f32 v195, v179, v203
    v_mfma_f32_16x16x32_bf16 v[172:175], v[88:91], a[188:191], v[172:175]
    buffer_load_dwordx4 v[88:91], v9, s[4:7], s25 offen offset:1024 sc1
    s_waitcnt vmcnt(16)
    v_mfma_f32_16x16x32_bf16 v[160:163], v[92:95], a[192:195], v[160:163]
    v_mfma_f32_16x16x32_bf16 v[164:167], v[92:95], a[200:203], v[164:167]
    v_mfma_f32_16x16x32_bf16 v[168:171], v[92:95], a[208:211], v[168:171]
    v_mfma_f32_16x16x32_bf16 v[172:175], v[92:95], a[216:219], v[172:175]
    buffer_load_dwordx4 v[92:95], v9, s[4:7], s26 offen offset:0 sc1
    s_waitcnt vmcnt(16)
    v_mfma_f32_16x16x32_bf16 v[160:163], v[96:99], a[196:199], v[160:163]
    v_mfma_f32_16x16x32_bf16 v[164:167], v[96:99], a[204:207], v[164:167]
    v_mfma_f32_16x16x32_bf16 v[168:171], v[96:99], a[212:215], v[168:171]
    v_mfma_f32_16x16x32_bf16 v[172:175], v[96:99], a[220:223], v[172:175]
    buffer_load_dwordx4 v[96:99], v9, s[4:7], s26 offen offset:1024 sc1
    s_waitcnt vmcnt(16)
    v_mfma_f32_16x16x32_bf16 v[160:163], v[100:103], a[224:227], v[160:163]
    v_mfma_f32_16x16x32_bf16 v[164:167], v[100:103], a[232:235], v[164:167]
    v_mfma_f32_16x16x32_bf16 v[168:171], v[100:103], a[240:243], v[168:171]
    v_mfma_f32_16x16x32_bf16 v[172:175], v[100:103], a[248:251], v[172:175]
    buffer_load_dwordx4 v[100:103], v9, s[4:7], s27 offen offset:0 sc1
    s_waitcnt vmcnt(16)
    v_mfma_f32_16x16x32_bf16 v[160:163], v[104:107], a[228:231], v[160:163]
    v_mfma_f32_16x16x32_bf16 v[164:167], v[104:107], a[236:239], v[164:167]
    v_mfma_f32_16x16x32_bf16 v[168:171], v[104:107], a[244:247], v[168:171]
    v_mfma_f32_16x16x32_bf16 v[172:175], v[104:107], a[252:255], v[172:175]
    buffer_load_dwordx4 v[104:107], v9, s[4:7], s27 offen offset:1024 sc1
    v_add_u32 v9, 65536, v9
    s_waitcnt vmcnt(16)
    v_mfma_f32_16x16x32_bf16 v[144:147], v[44:47], a[0:3], 0
    v_mfma_f32_16x16x32_bf16 v[148:151], v[44:47], a[8:11], 0
    v_mfma_f32_16x16x32_bf16 v[152:155], v[44:47], a[16:19], 0
    v_mfma_f32_16x16x32_bf16 v[156:159], v[44:47], a[24:27], 0
    s_add_u32 m0, s53, 40960
    s_nop 0
    buffer_load_dwordx4 v241, s[4:7], s59 offen offset:0 sc1 lds
    s_waitcnt vmcnt(16)
    v_mfma_f32_16x16x32_bf16 v[144:147], v[48:51], a[4:7], v[144:147]
    v_mfma_f32_16x16x32_bf16 v[148:151], v[48:51], a[12:15], v[148:151]
    v_mfma_f32_16x16x32_bf16 v[152:155], v[48:51], a[20:23], v[152:155]
    v_mfma_f32_16x16x32_bf16 v[156:159], v[48:51], a[28:31], v[156:159]
    buffer_load_dwordx4 v241, s[4:7], s59 offen offset:1024 sc1 lds
    buffer_load_dword v27, v26, s[4:7], s55 offen sc1
    s_waitcnt vmcnt(17)
    v_mfma_f32_16x16x32_bf16 v[144:147], v[52:55], a[32:35], v[144:147]
    ds_write_b128 v14, v[160:163] offset:16384
    v_mfma_f32_16x16x32_bf16 v[148:151], v[52:55], a[40:43], v[148:151]
    ds_write_b128 v14, v[164:167] offset:17408
    v_mfma_f32_16x16x32_bf16 v[152:155], v[52:55], a[48:51], v[152:155]
    ds_write_b128 v14, v[168:171] offset:18432
    v_mfma_f32_16x16x32_bf16 v[156:159], v[52:55], a[56:59], v[156:159]
    buffer_load_dwordx4 v241, s[4:7], s59 offen offset:2048 sc1 lds
    s_waitcnt vmcnt(17)
    v_mfma_f32_16x16x32_bf16 v[144:147], v[56:59], a[36:39], v[144:147]
    ds_write_b128 v14, v[172:175] offset:19456
    v_mfma_f32_16x16x32_bf16 v[148:151], v[56:59], a[44:47], v[148:151]
    v_mfma_f32_16x16x32_bf16 v[152:155], v[56:59], a[52:55], v[152:155]
    v_mfma_f32_16x16x32_bf16 v[156:159], v[56:59], a[60:63], v[156:159]
    buffer_load_dwordx4 v241, s[4:7], s59 offen offset:3072 sc1 lds
    s_add_u32 s59, s59, 4096
    s_waitcnt vmcnt(16)
    v_mfma_f32_16x16x32_bf16 v[144:147], v[60:63], a[64:67], v[144:147]
    v_mfma_f32_16x16x32_bf16 v[148:151], v[60:63], a[72:75], v[148:151]
    v_mfma_f32_16x16x32_bf16 v[152:155], v[60:63], a[80:83], v[152:155]
    v_mfma_f32_16x16x32_bf16 v[156:159], v[60:63], a[88:91], v[156:159]
    s_add_u32 m0, s53, 45056
    s_nop 0
    buffer_load_dwordx4 v241, s[4:7], s59 offen offset:0 sc1 lds
    s_add_u32 s59, s59, 16384
    s_waitcnt vmcnt(16) lgkmcnt(0)
    v_mfma_f32_16x16x32_bf16 v[144:147], v[64:67], a[68:71], v[144:147]
    s_barrier
    v_mfma_f32_16x16x32_bf16 v[148:151], v[64:67], a[76:79], v[148:151]
    ds_read_b128 v[176:179], v15 offset:16384
    v_mfma_f32_16x16x32_bf16 v[152:155], v[64:67], a[84:87], v[152:155]
    ds_read_b128 v[180:183], v15 offset:20480
    v_mfma_f32_16x16x32_bf16 v[156:159], v[64:67], a[92:95], v[156:159]
    s_add_u32 m0, s53, 61440
    s_nop 0
    buffer_load_dwordx4 v241, s[4:7], s59 offen offset:0 sc1 lds
    s_waitcnt vmcnt(16)
    v_mfma_f32_16x16x32_bf16 v[144:147], v[68:71], a[96:99], v[144:147]
    ds_read_b128 v[184:187], v15 offset:24576
    v_mfma_f32_16x16x32_bf16 v[148:151], v[68:71], a[104:107], v[148:151]
    ds_read_b128 v[188:191], v15 offset:28672
    v_mfma_f32_16x16x32_bf16 v[152:155], v[68:71], a[112:115], v[152:155]
    v_mfma_f32_16x16x32_bf16 v[156:159], v[68:71], a[120:123], v[156:159]
    buffer_load_dwordx4 v241, s[4:7], s59 offen offset:1024 sc1 lds
    s_waitcnt vmcnt(16) lgkmcnt(3)
    v_mfma_f32_16x16x32_bf16 v[144:147], v[72:75], a[100:103], v[144:147]
    v_mfma_f32_16x16x32_bf16 v[148:151], v[72:75], a[108:111], v[148:151]
    v_mfma_f32_16x16x32_bf16 v[152:155], v[72:75], a[116:119], v[152:155]
    v_mfma_f32_16x16x32_bf16 v[156:159], v[72:75], a[124:127], v[156:159]
    buffer_load_dwordx4 v241, s[4:7], s59 offen offset:2048 sc1 lds
    s_waitcnt vmcnt(16) lgkmcnt(0)
    v_mfma_f32_16x16x32_bf16 v[144:147], v[76:79], a[128:131], v[144:147]
    v_and_b32 v200, s3, v36
    v_and_b32 v201, s3, v37
    v_mfma_f32_16x16x32_bf16 v[148:151], v[76:79], a[136:139], v[148:151]
    v_and_b32 v202, s3, v38
    v_and_b32 v203, s3, v39
    v_mfma_f32_16x16x32_bf16 v[152:155], v[76:79], a[144:147], v[152:155]
    v_add_f32 v176, v176, v12
    v_add_f32 v177, v177, v12
    v_mfma_f32_16x16x32_bf16 v[156:159], v[76:79], a[152:155], v[156:159]
    buffer_load_dwordx4 v241, s[4:7], s59 offen offset:3072 sc1 lds
    s_add_u32 s59, s59, 4096
    s_waitcnt vmcnt(16)
    v_mfma_f32_16x16x32_bf16 v[144:147], v[80:83], a[132:135], v[144:147]
    v_add_f32 v178, v178, v12
    v_add_f32 v179, v179, v12
    v_mfma_f32_16x16x32_bf16 v[148:151], v[80:83], a[140:143], v[148:151]
    v_add_f32 v176, v176, v180
    v_add_f32 v177, v177, v181
    v_mfma_f32_16x16x32_bf16 v[152:155], v[80:83], a[148:151], v[152:155]
    v_add_f32 v178, v178, v182
    v_add_f32 v179, v179, v183
    v_mfma_f32_16x16x32_bf16 v[156:159], v[80:83], a[156:159], v[156:159]
    s_add_u32 m0, s53, 65536
    s_nop 0
    buffer_load_dwordx4 v241, s[4:7], s59 offen offset:0 sc1 lds
    s_add_u32 s59, s59, 16384
    s_waitcnt vmcnt(16)
    v_mfma_f32_16x16x32_bf16 v[144:147], v[84:87], a[160:163], v[144:147]
    v_add_f32 v184, v184, v188
    v_add_f32 v185, v185, v189
    v_mfma_f32_16x16x32_bf16 v[148:151], v[84:87], a[168:171], v[148:151]
    v_add_f32 v186, v186, v190
    v_add_f32 v187, v187, v191
    v_mfma_f32_16x16x32_bf16 v[152:155], v[84:87], a[176:179], v[152:155]
    v_add_f32 v176, v176, v184
    v_add_f32 v177, v177, v185
    v_mfma_f32_16x16x32_bf16 v[156:159], v[84:87], a[184:187], v[156:159]
    s_mov_b32 s49, 65536
L_adaL_poll_25:
    s_waitcnt vmcnt(8)
    v_cmp_ne_u32 vcc, s48, v27
    s_nop 0
    s_cbranch_vccz L_adaL_got_26
    buffer_load_dword v27, v26, s[4:7], s55 offen sc1
    s_waitcnt vmcnt(0)
    s_sub_u32 s49, s49, 1
    s_cmp_lg_u32 s49, 0
    s_cbranch_scc1 L_adaL_poll_25
L_adaL_got_26:
    s_add_u32 s55, s55, 256
    buffer_load_dwordx4 a[0:3], v241, s[4:7], s85 offen offset:0 sc1
    v_mfma_f32_16x16x32_bf16 v[144:147], v[88:91], a[164:167], v[144:147]
    v_add_f32 v178, v178, v186
    v_add_f32 v179, v179, v187
    v_mfma_f32_16x16x32_bf16 v[148:151], v[88:91], a[172:175], v[148:151]
    v_mul_f32 v196, v176, v200
    v_mul_f32 v197, v177, v201
    v_mfma_f32_16x16x32_bf16 v[152:155], v[88:91], a[180:183], v[152:155]
    v_mul_f32 v198, v178, v202
    v_mul_f32 v199, v179, v203
    v_mfma_f32_16x16x32_bf16 v[156:159], v[88:91], a[188:191], v[156:159]
    buffer_load_dwordx4 a[4:7], v241, s[4:7], s85 offen offset:1024 sc1
    v_mfma_f32_16x16x32_bf16 v[144:147], v[92:95], a[192:195], v[144:147]
    v_cvt_pk_bf16_f32 v36, v192, v196
    v_cvt_pk_bf16_f32 v37, v193, v197
    v_mfma_f32_16x16x32_bf16 v[148:151], v[92:95], a[200:203], v[148:151]
    v_cvt_pk_bf16_f32 v38, v194, v198
    v_cvt_pk_bf16_f32 v39, v195, v199
    v_mfma_f32_16x16x32_bf16 v[152:155], v[92:95], a[208:211], v[152:155]
    buffer_store_dwordx4 v[36:39], v241, s[4:7], s70 offen sc1
    v_mfma_f32_16x16x32_bf16 v[156:159], v[92:95], a[216:219], v[156:159]
    buffer_load_dwordx4 a[8:11], v241, s[4:7], s85 offen offset:2048 sc1
    v_mfma_f32_16x16x32_bf16 v[144:147], v[96:99], a[196:199], v[144:147]
    v_mfma_f32_16x16x32_bf16 v[148:151], v[96:99], a[204:207], v[148:151]
    v_mfma_f32_16x16x32_bf16 v[152:155], v[96:99], a[212:215], v[152:155]
    v_mfma_f32_16x16x32_bf16 v[156:159], v[96:99], a[220:223], v[156:159]
    buffer_load_dwordx4 a[12:15], v241, s[4:7], s85 offen offset:3072 sc1
    s_add_u32 s85, s85, 4096
    v_mfma_f32_16x16x32_bf16 v[144:147], v[100:103], a[224:227], v[144:147]
    v_mfma_f32_16x16x32_bf16 v[148:151], v[100:103], a[232:235], v[148:151]
    v_mfma_f32_16x16x32_bf16 v[152:155], v[100:103], a[240:243], v[152:155]
    v_mfma_f32_16x16x32_bf16 v[156:159], v[100:103], a[248:251], v[156:159]
    buffer_load_dwordx4 a[16:19], v241, s[4:7], s85 offen offset:0 sc1
    v_mfma_f32_16x16x32_bf16 v[144:147], v[104:107], a[228:231], v[144:147]
    v_mfma_f32_16x16x32_bf16 v[148:151], v[104:107], a[236:239], v[148:151]
    v_mfma_f32_16x16x32_bf16 v[152:155], v[104:107], a[244:247], v[152:155]
    v_mfma_f32_16x16x32_bf16 v[156:159], v[104:107], a[252:255], v[156:159]
    buffer_load_dwordx4 a[20:23], v241, s[4:7], s85 offen offset:1024 sc1
    s_nop 3
    ds_write_b128 v14, v[144:147] offset:0
    ds_write_b128 v14, v[148:151] offset:1024
    ds_write_b128 v14, v[152:155] offset:2048
    ds_write_b128 v14, v[156:159] offset:3072
    buffer_load_dwordx4 a[24:27], v241, s[4:7], s85 offen offset:2048 sc1
    buffer_load_dwordx4 a[28:31], v241, s[4:7], s85 offen offset:3072 sc1
    s_add_u32 s85, s85, 4096
    s_waitcnt vmcnt(9)
    s_waitcnt lgkmcnt(0)
    s_barrier
    ds_read_b128 v[176:179], v15 offset:0
    ds_read_b128 v[180:183], v15 offset:4096
    ds_read_b128 v[184:187], v15 offset:8192
    ds_read_b128 v[188:191], v15 offset:12288
    s_add_u32 m0, s53, 81920
    s_nop 0
    buffer_load_dwordx4 v241, s[4:7], s59 offen offset:0 sc1 lds
    buffer_load_dwordx4 v241, s[4:7], s59 offen offset:1024 sc1 lds
    ds_read_b128 v[64:67], v128 offset:20480
    ds_read_b128 v[68:71], v128 offset:21504
    ds_read_b128 v[72:75], v128 offset:22528
    ds_read_b128 v[76:79], v128 offset:23552
    ds_read_b128 v[80:83], v128 offset:24576
    ds_read_b128 v[84:87], v128 offset:25600
    ds_read_b128 v[88:91], v128 offset:26624
    ds_read_b128 v[92:95], v128 offset:27648
    v_lshlrev_b32 v200, 16, v40
    v_lshlrev_b32 v201, 16, v41
    v_lshlrev_b32 v202, 16, v42
    v_lshlrev_b32 v203, 16, v43
    s_waitcnt lgkmcnt(11)
    v_add_f32 v176, v176, v12
    v_add_f32 v177, v177, v12
    v_add_f32 v178, v178, v12
    v_add_f32 v179, v179, v12
    s_waitcnt lgkmcnt(10)
    v_add_f32 v176, v176, v180
    v_add_f32 v177, v177, v181
    v_add_f32 v178, v178, v182
    v_add_f32 v179, v179, v183
    s_waitcnt lgkmcnt(8)
    v_add_f32 v184, v184, v188
    v_add_f32 v185, v185, v189
    v_add_f32 v186, v186, v190
    v_add_f32 v187, v187, v191
    v_add_f32 v176, v176, v184
    v_add_f32 v177, v177, v185
    v_add_f32 v178, v178, v186
    v_add_f32 v179, v179, v187
    v_mul_f32 v192, v176, v200
    v_mul_f32 v193, v177, v201
    v_mul_f32 v194, v178, v202
    v_mul_f32 v195, v179, v203
    v_cvt_pk_bf16_f32 v204, v192, v193
    v_cvt_pk_bf16_f32 v205, v194, v195
    buffer_store_dwordx2 v[204:205], v5, s[4:7], s58 offen sc1
    s_waitcnt vmcnt(9) lgkmcnt(0)
    s_mov_b64 exec, 3
    buffer_store_dword v13, v133, s[4:7], s71 offen sc1
    s_mov_b64 exec, -1
    s_add_u32 s71, s71, 256
    v_mfma_f32_16x16x32_bf16 v[44:47], v[64:67], a[0:3], 0
    ds_read_b128 v[96:99], v128 offset:28672
    v_mfma_f32_16x16x32_bf16 v[48:51], v[68:71], a[0:3], 0
    ds_read_b128 v[100:103], v128 offset:29696
    buffer_load_dwordx4 v241, s[4:7], s59 offen offset:2048 sc1 lds
    v_mfma_f32_16x16x32_bf16 v[52:55], v[72:75], a[0:3], 0
    ds_read_b128 v[64:67], v128 offset:30720
    v_mfma_f32_16x16x32_bf16 v[56:59], v[76:79], a[0:3], 0
    ds_read_b128 v[68:71], v128 offset:31744
    buffer_load_dwordx4 v241, s[4:7], s59 offen offset:3072 sc1 lds
    s_add_u32 s59, s59, 4096
    v_mfma_f32_16x16x32_bf16 v[60:63], v[80:83], a[0:3], 0
    ds_read_b128 v[72:75], v128 offset:32768
    v_mfma_f32_16x16x32_bf16 v[44:47], v[84:87], a[4:7], v[44:47]
    ds_read_b128 v[76:79], v128 offset:33792
    v_mfma_f32_16x16x32_bf16 v[48:51], v[88:91], a[4:7], v[48:51]
    ds_read_b128 v[80:83], v128 offset:34816
    s_add_u32 m0, s53, 86016
    s_nop 0
    buffer_load_dwordx4 v241, s[4:7], s59 offen offset:0 sc1 lds
    s_add_u32 s59, s59, 16384
    v_mfma_f32_16x16x32_bf16 v[52:55], v[92:95], a[4:7], v[52:55]
    ds_read_b128 v[84:87], v128 offset:35840
    s_waitcnt lgkmcnt(6)
    v_mfma_f32_16x16x32_bf16 v[56:59], v[96:99], a[4:7], v[56:59]
    ds_read_b128 v[88:91], v128 offset:36864
    s_add_u32 m0, s53, 102400
    s_nop 0
    buffer_load_dwordx4 v241, s[4:7], s59 offen offset:0 sc1 lds
    v_mfma_f32_16x16x32_bf16 v[60:63], v[100:103], a[4:7], v[60:63]
    ds_read_b128 v[92:95], v128 offset:37888
    s_waitcnt vmcnt(13) lgkmcnt(6)
    v_mfma_f32_16x16x32_bf16 v[44:47], v[64:67], a[8:11], v[44:47]
    ds_read_b128 v[96:99], v128 offset:38912
    v_mfma_f32_16x16x32_bf16 v[48:51], v[68:71], a[8:11], v[48:51]
    ds_read_b128 v[100:103], v128 offset:39936
    buffer_load_dwordx4 v241, s[4:7], s59 offen offset:1024 sc1 lds
    s_waitcnt lgkmcnt(6)
    v_mfma_f32_16x16x32_bf16 v[52:55], v[72:75], a[8:11], v[52:55]
    ds_read_b128 v[64:67], v128 offset:40960
    v_mfma_f32_16x16x32_bf16 v[56:59], v[76:79], a[8:11], v[56:59]
    ds_read_b128 v[68:71], v128 offset:41984
    buffer_load_dwordx4 v241, s[4:7], s59 offen offset:2048 sc1 lds
    s_waitcnt lgkmcnt(6)
    v_mfma_f32_16x16x32_bf16 v[60:63], v[80:83], a[8:11], v[60:63]
    ds_read_b128 v[72:75], v128 offset:43008
    s_waitcnt vmcnt(14) lgkmcnt(6)
    v_mfma_f32_16x16x32_bf16 v[44:47], v[84:87], a[12:15], v[44:47]
    ds_read_b128 v[76:79], v128 offset:44032
    v_mfma_f32_16x16x32_bf16 v[48:51], v[88:91], a[12:15], v[48:51]
    ds_read_b128 v[80:83], v128 offset:45056
    buffer_load_dwordx4 v241, s[4:7], s59 offen offset:3072 sc1 lds
    s_add_u32 s59, s59, 4096
    s_waitcnt lgkmcnt(6)
    v_mfma_f32_16x16x32_bf16 v[52:55], v[92:95], a[12:15], v[52:55]
    ds_read_b128 v[84:87], v128 offset:46080
    v_mfma_f32_16x16x32_bf16 v[56:59], v[96:99], a[12:15], v[56:59]
    ds_read_b128 v[88:91], v128 offset:47104
    s_add_u32 m0, s53, 106496
    s_nop 0
    buffer_load_dwordx4 v241, s[4:7], s59 offen offset:0 sc1 lds
    s_add_u32 s59, s59, 16384
    s_waitcnt lgkmcnt(6)
    v_mfma_f32_16x16x32_bf16 v[60:63], v[100:103], a[12:15], v[60:63]
    ds_read_b128 v[92:95], v128 offset:48128
    s_waitcnt vmcnt(15) lgkmcnt(6)
    v_mfma_f32_16x16x32_bf16 v[44:47], v[64:67], a[16:19], v[44:47]
    ds_read_b128 v[96:99], v128 offset:49152
    v_mfma_f32_16x16x32_bf16 v[48:51], v[68:71], a[16:19], v[48:51]
    ds_read_b128 v[100:103], v128 offset:50176
    buffer_load_dwordx4 a[32:35], v241, s[4:7], s85 offen offset:0 sc1
    s_waitcnt lgkmcnt(6)
    v_mfma_f32_16x16x32_bf16 v[52:55], v[72:75], a[16:19], v[52:55]
    ds_read_b128 v[64:67], v128 offset:51200
    v_mfma_f32_16x16x32_bf16 v[56:59], v[76:79], a[16:19], v[56:59]
    ds_read_b128 v[68:71], v128 offset:52224
    buffer_load_dwordx4 a[36:39], v241, s[4:7], s85 offen offset:1024 sc1
    s_waitcnt lgkmcnt(6)
    v_mfma_f32_16x16x32_bf16 v[60:63], v[80:83], a[16:19], v[60:63]
    ds_read_b128 v[72:75], v128 offset:53248
    s_waitcnt vmcnt(16) lgkmcnt(6)
    v_mfma_f32_16x16x32_bf16 v[44:47], v[84:87], a[20:23], v[44:47]
    ds_read_b128 v[76:79], v128 offset:54272
    v_mfma_f32_16x16x32_bf16 v[48:51], v[88:91], a[20:23], v[48:51]
    ds_read_b128 v[80:83], v128 offset:55296
    buffer_load_dwordx4 a[40:43], v241, s[4:7], s85 offen offset:2048 sc1
    s_waitcnt lgkmcnt(6)
    v_mfma_f32_16x16x32_bf16 v[52:55], v[92:95], a[20:23], v[52:55]
    ds_read_b128 v[84:87], v128 offset:56320
    v_mfma_f32_16x16x32_bf16 v[56:59], v[96:99], a[20:23], v[56:59]
    ds_read_b128 v[88:91], v128 offset:57344
    buffer_load_dwordx4 a[44:47], v241, s[4:7], s85 offen offset:3072 sc1
    s_add_u32 s85, s85, 4096
    s_waitcnt lgkmcnt(6)
    v_mfma_f32_16x16x32_bf16 v[60:63], v[100:103], a[20:23], v[60:63]
    ds_read_b128 v[92:95], v128 offset:58368
    s_waitcnt vmcnt(13) lgkmcnt(6)
    s_mov_b64 exec, 3
    buffer_store_dword v13, v133, s[4:7], s71 offen sc1
    s_mov_b64 exec, -1
    v_mfma_f32_16x16x32_bf16 v[44:47], v[64:67], a[24:27], v[44:47]
    ds_read_b128 v[96:99], v128 offset:59392
    v_mfma_f32_16x16x32_bf16 v[48:51], v[68:71], a[24:27], v[48:51]
    ds_read_b128 v[100:103], v128 offset:60416
    buffer_load_dwordx4 a[48:51], v241, s[4:7], s85 offen offset:0 sc1
    s_waitcnt vmcnt(6) lgkmcnt(6)
    s_barrier
    v_mfma_f32_16x16x32_bf16 v[52:55], v[72:75], a[24:27], v[52:55]
    ds_read_b128 v[64:67], v129 offset:0
    v_mfma_f32_16x16x32_bf16 v[56:59], v[76:79], a[24:27], v[56:59]
    ds_read_b128 v[68:71], v129 offset:1024
    buffer_load_dwordx4 a[52:55], v241, s[4:7], s85 offen offset:1024 sc1
    s_waitcnt lgkmcnt(6)
    v_mfma_f32_16x16x32_bf16 v[60:63], v[80:83], a[24:27], v[60:63]
    ds_read_b128 v[72:75], v129 offset:2048
    v_mfma_f32_16x16x32_bf16 v[44:47], v[84:87], a[28:31], v[44:47]
    ds_read_b128 v[76:79], v129 offset:3072
    s_waitcnt lgkmcnt(6)
    v_mfma_f32_16x16x32_bf16 v[48:51], v[88:91], a[28:31], v[48:51]
    ds_read_b128 v[80:83], v129 offset:4096
    buffer_load_dwordx4 a[56:59], v241, s[4:7], s85 offen offset:2048 sc1
    v_mfma_f32_16x16x32_bf16 v[52:55], v[92:95], a[28:31], v[52:55]
    ds_read_b128 v[84:87], v129 offset:5120
    s_waitcnt lgkmcnt(6)
    v_mfma_f32_16x16x32_bf16 v[56:59], v[96:99], a[28:31], v[56:59]
    ds_read_b128 v[88:91], v129 offset:6144
    buffer_load_dwordx4 a[60:63], v241, s[4:7], s85 offen offset:3072 sc1
    s_add_u32 s85, s85, 4096
    v_mfma_f32_16x16x32_bf16 v[60:63], v[100:103], a[28:31], v[60:63]
    ds_read_b128 v[92:95], v129 offset:7168
    s_waitcnt vmcnt(8) lgkmcnt(6)
    v_mfma_f32_16x16x32_bf16 v[44:47], v[64:67], a[32:35], v[44:47]
    ds_read_b128 v[96:99], v129 offset:8192
    v_mfma_f32_16x16x32_bf16 v[48:51], v[68:71], a[32:35], v[48:51]
    ds_read_b128 v[100:103], v129 offset:9216
    s_add_u32 m0, s53, 122880
    s_nop 0
    buffer_load_dwordx4 v241, s[4:7], s59 offen offset:0 sc1 lds
    s_waitcnt lgkmcnt(6)
    v_mfma_f32_16x16x32_bf16 v[52:55], v[72:75], a[32:35], v[52:55]
    ds_read_b128 v[64:67], v129 offset:10240
    v_mfma_f32_16x16x32_bf16 v[56:59], v[76:79], a[32:35], v[56:59]
    ds_read_b128 v[68:71], v129 offset:11264
    buffer_load_dwordx4 v241, s[4:7], s59 offen offset:1024 sc1 lds
    s_waitcnt lgkmcnt(6)
    v_mfma_f32_16x16x32_bf16 v[60:63], v[80:83], a[32:35], v[60:63]
    ds_read_b128 v[72:75], v129 offset:12288
    buffer_load_dword v27, v26, s[4:7], s55 offen sc1
    s_waitcnt vmcnt(10) lgkmcnt(6)
    v_mfma_f32_16x16x32_bf16 v[44:47], v[84:87], a[36:39], v[44:47]
    ds_read_b128 v[76:79], v129 offset:13312
    v_mfma_f32_16x16x32_bf16 v[48:51], v[88:91], a[36:39], v[48:51]
    ds_read_b128 v[80:83], v129 offset:14336
    buffer_load_dwordx4 v241, s[4:7], s59 offen offset:2048 sc1 lds
    s_waitcnt lgkmcnt(6)
    v_mfma_f32_16x16x32_bf16 v[52:55], v[92:95], a[36:39], v[52:55]
    ds_read_b128 v[84:87], v129 offset:15360
    v_mfma_f32_16x16x32_bf16 v[56:59], v[96:99], a[36:39], v[56:59]
    ds_read_b128 v[88:91], v129 offset:16384
    buffer_load_dwordx4 v241, s[4:7], s59 offen offset:3072 sc1 lds
    s_add_u32 s59, s59, 4096
    s_waitcnt lgkmcnt(6)
    v_mfma_f32_16x16x32_bf16 v[60:63], v[100:103], a[36:39], v[60:63]
    ds_read_b128 v[92:95], v129 offset:17408
    s_waitcnt vmcnt(11) lgkmcnt(6)
    v_mfma_f32_16x16x32_bf16 v[44:47], v[64:67], a[40:43], v[44:47]
    ds_read_b128 v[96:99], v129 offset:18432
    v_mfma_f32_16x16x32_bf16 v[48:51], v[68:71], a[40:43], v[48:51]
    ds_read_b128 v[100:103], v129 offset:19456
    s_add_u32 m0, s53, 126976
    s_nop 0
    buffer_load_dwordx4 v241, s[4:7], s59 offen offset:0 sc1 lds
    s_add_u32 s59, s59, 16384
    s_waitcnt lgkmcnt(6)
    v_mfma_f32_16x16x32_bf16 v[52:55], v[72:75], a[40:43], v[52:55]
    ds_read_b128 v[64:67], v129 offset:20480
    v_mfma_f32_16x16x32_bf16 v[56:59], v[76:79], a[40:43], v[56:59]
    ds_read_b128 v[68:71], v129 offset:21504
    s_add_u32 m0, s53, 143360
    s_nop 0
    buffer_load_dwordx4 v241, s[4:7], s59 offen offset:0 sc1 lds
    s_waitcnt lgkmcnt(6)
    v_mfma_f32_16x16x32_bf16 v[60:63], v[80:83], a[40:43], v[60:63]
    ds_read_b128 v[72:75], v129 offset:22528
    s_waitcnt vmcnt(12) lgkmcnt(6)
    v_mfma_f32_16x16x32_bf16 v[44:47], v[84:87], a[44:47], v[44:47]
    ds_read_b128 v[76:79], v129 offset:23552
    v_mfma_f32_16x16x32_bf16 v[48:51], v[88:91], a[44:47], v[48:51]
    ds_read_b128 v[80:83], v129 offset:24576
    buffer_load_dwordx4 v241, s[4:7], s59 offen offset:1024 sc1 lds
    s_waitcnt lgkmcnt(6)
    v_mfma_f32_16x16x32_bf16 v[52:55], v[92:95], a[44:47], v[52:55]
    ds_read_b128 v[84:87], v129 offset:25600
    v_mfma_f32_16x16x32_bf16 v[56:59], v[96:99], a[44:47], v[56:59]
    ds_read_b128 v[88:91], v129 offset:26624
    buffer_load_dwordx4 v241, s[4:7], s59 offen offset:2048 sc1 lds
    s_waitcnt lgkmcnt(6)
    v_mfma_f32_16x16x32_bf16 v[60:63], v[100:103], a[44:47], v[60:63]
    ds_read_b128 v[92:95], v129 offset:27648
    buffer_load_dwordx4 v241, s[4:7], s59 offen offset:3072 sc1 lds
    s_add_u32 s59, s59, 4096
    s_add_u32 m0, s53, 147456
    s_nop 0
    buffer_load_dwordx4 v241, s[4:7], s59 offen offset:0 sc1 lds
    s_add_u32 s59, s59, 16384
    s_mov_b32 s49, 65536
L_adaL_poll_27:
    s_waitcnt vmcnt(8) lgkmcnt(6)
    v_cmp_ne_u32 vcc, s48, v27
    s_nop 0
    s_cbranch_vccz L_adaL_got_28
    buffer_load_dword v27, v26, s[4:7], s55 offen sc1
    s_waitcnt vmcnt(0)
    s_sub_u32 s49, s49, 1
    s_cmp_lg_u32 s49, 0
    s_cbranch_scc1 L_adaL_poll_27
L_adaL_got_28:
    s_add_u32 s55, s55, 256
    v_mfma_f32_16x16x32_bf16 v[44:47], v[64:67], a[48:51], v[44:47]
    ds_read_b128 v[96:99], v129 offset:28672
    v_mfma_f32_16x16x32_bf16 v[48:51], v[68:71], a[48:51], v[48:51]
    ds_read_b128 v[100:103], v129 offset:29696
    buffer_load_dwordx4 a[64:67], v241, s[4:7], s85 offen offset:0 sc1
    s_waitcnt lgkmcnt(6)
    v_mfma_f32_16x16x32_bf16 v[52:55], v[72:75], a[48:51], v[52:55]
    ds_read_b128 v[64:67], v129 offset:30720
    v_mfma_f32_16x16x32_bf16 v[56:59], v[76:79], a[48:51], v[56:59]
    ds_read_b128 v[68:71], v129 offset:31744
    buffer_load_dwordx4 a[68:71], v241, s[4:7], s85 offen offset:1024 sc1
    s_waitcnt lgkmcnt(6)
    v_mfma_f32_16x16x32_bf16 v[60:63], v[80:83], a[48:51], v[60:63]
    ds_read_b128 v[72:75], v129 offset:32768
    v_mfma_f32_16x16x32_bf16 v[44:47], v[84:87], a[52:55], v[44:47]
    ds_read_b128 v[76:79], v129 offset:33792
    s_waitcnt lgkmcnt(6)
    v_mfma_f32_16x16x32_bf16 v[48:51], v[88:91], a[52:55], v[48:51]
    ds_read_b128 v[80:83], v129 offset:34816
    buffer_load_dwordx4 a[72:75], v241, s[4:7], s85 offen offset:2048 sc1
    v_mfma_f32_16x16x32_bf16 v[52:55], v[92:95], a[52:55], v[52:55]
    ds_read_b128 v[84:87], v129 offset:35840
    s_waitcnt lgkmcnt(6)
    v_mfma_f32_16x16x32_bf16 v[56:59], v[96:99], a[52:55], v[56:59]
    ds_read_b128 v[88:91], v129 offset:36864
    buffer_load_dwordx4 a[76:79], v241, s[4:7], s85 offen offset:3072 sc1
    s_add_u32 s85, s85, 4096
    v_mfma_f32_16x16x32_bf16 v[60:63], v[100:103], a[52:55], v[60:63]
    ds_read_b128 v[92:95], v129 offset:37888
    s_waitcnt lgkmcnt(6)
    v_mfma_f32_16x16x32_bf16 v[44:47], v[64:67], a[56:59], v[44:47]
    ds_read_b128 v[96:99], v129 offset:38912
    v_mfma_f32_16x16x32_bf16 v[48:51], v[68:71], a[56:59], v[48:51]
    ds_read_b128 v[100:103], v129 offset:39936
    buffer_load_dwordx4 a[80:83], v241, s[4:7], s85 offen offset:0 sc1
    s_waitcnt vmcnt(5) lgkmcnt(6)
    s_barrier
    v_mfma_f32_16x16x32_bf16 v[52:55], v[72:75], a[56:59], v[52:55]
    ds_read_b128 v[64:67], v129 offset:40960
    v_mfma_f32_16x16x32_bf16 v[56:59], v[76:79], a[56:59], v[56:59]
    ds_read_b128 v[68:71], v129 offset:41984
    buffer_load_dwordx4 a[84:87], v241, s[4:7], s85 offen offset:1024 sc1
    s_waitcnt lgkmcnt(6)
    v_mfma_f32_16x16x32_bf16 v[60:63], v[80:83], a[56:59], v[60:63]
    ds_read_b128 v[72:75], v129 offset:43008
    buffer_load_dword v27, v26, s[4:7], s55 offen sc1
    v_mfma_f32_16x16x32_bf16 v[44:47], v[84:87], a[60:63], v[44:47]
    ds_read_b128 v[76:79], v129 offset:44032
    s_waitcnt lgkmcnt(6)
    v_mfma_f32_16x16x32_bf16 v[48:51], v[88:91], a[60:63], v[48:51]
    ds_read_b128 v[80:83], v129 offset:45056
    buffer_load_dwordx4 a[88:91], v241, s[4:7], s85 offen offset:2048 sc1
    v_mfma_f32_16x16x32_bf16 v[52:55], v[92:95], a[60:63], v[52:55]
    ds_read_b128 v[84:87], v129 offset:46080
    s_waitcnt lgkmcnt(6)
    v_mfma_f32_16x16x32_bf16 v[56:59], v[96:99], a[60:63], v[56:59]
    ds_read_b128 v[88:91], v129 offset:47104
    buffer_load_dwordx4 a[92:95], v241, s[4:7], s85 offen offset:3072 sc1
    s_add_u32 s85, s85, 4096
    v_mfma_f32_16x16x32_bf16 v[60:63], v[100:103], a[60:63], v[60:63]
    ds_read_b128 v[92:95], v129 offset:48128
    s_waitcnt vmcnt(8) lgkmcnt(6)
    v_mfma_f32_16x16x32_bf16 v[44:47], v[64:67], a[64:67], v[44:47]
    ds_read_b128 v[96:99], v129 offset:49152
    v_lshlrev_b32 v108, 16, v230
    v_mfma_f32_16x16x32_bf16 v[48:51], v[68:71], a[64:67], v[48:51]
    ds_read_b128 v[100:103], v129 offset:50176
    s_add_u32 m0, s53, 20480
    s_nop 0
    buffer_load_dwordx4 v241, s[4:7], s59 offen offset:0 sc1 lds
    s_waitcnt lgkmcnt(6)
    v_mfma_f32_16x16x32_bf16 v[52:55], v[72:75], a[64:67], v[52:55]
    ds_read_b128 v[64:67], v129 offset:51200
    v_and_b32 v109, s3, v230
    v_mfma_f32_16x16x32_bf16 v[56:59], v[76:79], a[64:67], v[56:59]
    ds_read_b128 v[68:71], v129 offset:52224
    buffer_load_dwordx4 v241, s[4:7], s59 offen offset:1024 sc1 lds
    s_waitcnt lgkmcnt(6)
    v_mfma_f32_16x16x32_bf16 v[60:63], v[80:83], a[64:67], v[60:63]
    ds_read_b128 v[72:75], v129 offset:53248
    v_lshlrev_b32 v110, 16, v231
    s_waitcnt vmcnt(9) lgkmcnt(6)
    v_mfma_f32_16x16x32_bf16 v[44:47], v[84:87], a[68:71], v[44:47]
    ds_read_b128 v[76:79], v129 offset:54272
    v_and_b32 v111, s3, v231
    v_mfma_f32_16x16x32_bf16 v[48:51], v[88:91], a[68:71], v[48:51]
    ds_read_b128 v[80:83], v129 offset:55296
    buffer_load_dwordx4 v241, s[4:7], s59 offen offset:2048 sc1 lds
    s_waitcnt lgkmcnt(6)
    v_mfma_f32_16x16x32_bf16 v[52:55], v[92:95], a[68:71], v[52:55]
    ds_read_b128 v[84:87], v129 offset:56320
    v_lshlrev_b32 v112, 16, v232
    v_mfma_f32_16x16x32_bf16 v[56:59], v[96:99], a[68:71], v[56:59]
    ds_read_b128 v[88:91], v129 offset:57344
    buffer_load_dwordx4 v241, s[4:7], s59 offen offset:3072 sc1 lds
    s_add_u32 s59, s59, 4096
    s_waitcnt lgkmcnt(6)
    v_mfma_f32_16x16x32_bf16 v[60:63], v[100:103], a[68:71], v[60:63]
    ds_read_b128 v[92:95], v129 offset:58368
    v_and_b32 v113, s3, v232
    s_waitcnt vmcnt(10) lgkmcnt(5)
    v_mfma_f32_16x16x32_bf16 v[44:47], v[64:67], a[72:75], v[44:47]
    ds_read_b128 v[96:99], v129 offset:59392
    v_lshlrev_b32 v114, 16, v233
    v_mfma_f32_16x16x32_bf16 v[48:51], v[68:71], a[72:75], v[48:51]
    ds_read_b128 v[100:103], v129 offset:60416
    s_add_u32 m0, s53, 24576
    s_nop 0
    buffer_load_dwordx4 v241, s[4:7], s59 offen offset:0 sc1 lds
    s_add_u32 s59, s59, 16384
    v_mfma_f32_16x16x32_bf16 v[52:55], v[72:75], a[72:75], v[52:55]
    ds_read_b128 v[64:67], v130 offset:0
    v_and_b32 v115, s3, v233
    s_waitcnt lgkmcnt(5)
    v_mfma_f32_16x16x32_bf16 v[56:59], v[76:79], a[72:75], v[56:59]
    ds_read_b128 v[68:71], v130 offset:1024
    v_lshlrev_b32 v116, 16, v234
    v_mfma_f32_16x16x32_bf16 v[60:63], v[80:83], a[72:75], v[60:63]
    ds_read_b128 v[72:75], v130 offset:2048
    v_and_b32 v117, s3, v234
    s_mov_b32 s49, 65536
L_adaL_poll_29:
    s_waitcnt vmcnt(7) lgkmcnt(5)
    v_cmp_ne_u32 vcc, s48, v27
    s_nop 0
    s_cbranch_vccz L_adaL_got_30
    buffer_load_dword v27, v26, s[4:7], s55 offen sc1
    s_waitcnt vmcnt(0)
    s_sub_u32 s49, s49, 1
    s_cmp_lg_u32 s49, 0
    s_cbranch_scc1 L_adaL_poll_29
L_adaL_got_30:
    s_add_u32 s55, s55, 256
    v_mfma_f32_16x16x32_bf16 v[44:47], v[84:87], a[76:79], v[44:47]
    ds_read_b128 v[76:79], v130 offset:3072
    v_lshlrev_b32 v118, 16, v235
    v_mfma_f32_16x16x32_bf16 v[48:51], v[88:91], a[76:79], v[48:51]
    ds_read_b128 v[80:83], v130 offset:4096
    buffer_load_dwordx2 a[96:97], v5, s[4:7], s85 offen offset:0 sc1
    buffer_load_dwordx2 a[98:99], v5, s[4:7], s85 offen offset:512 sc1
    v_mfma_f32_16x16x32_bf16 v[52:55], v[92:95], a[76:79], v[52:55]
    ds_read_b128 v[84:87], v130 offset:5120
    v_and_b32 v119, s3, v235
    s_waitcnt lgkmcnt(5)
    v_mfma_f32_16x16x32_bf16 v[56:59], v[96:99], a[76:79], v[56:59]
    ds_read_b128 v[88:91], v130 offset:6144
    buffer_load_dwordx2 a[100:101], v5, s[4:7], s85 offen offset:1024 sc1
    buffer_load_dwordx2 a[102:103], v5, s[4:7], s85 offen offset:1536 sc1
    v_mfma_f32_16x16x32_bf16 v[60:63], v[100:103], a[76:79], v[60:63]
    ds_read_b128 v[92:95], v130 offset:7168
    v_lshlrev_b32 v120, 16, v236
    v_mfma_f32_16x16x32_bf16 v[44:47], v[64:67], a[80:83], v[44:47]
    ds_read_b128 v[96:99], v130 offset:8192
    v_and_b32 v121, s3, v236
    s_waitcnt lgkmcnt(5)
    v_mfma_f32_16x16x32_bf16 v[48:51], v[68:71], a[80:83], v[48:51]
    ds_read_b128 v[100:103], v130 offset:9216
    buffer_load_dwordx2 a[104:105], v5, s[4:7], s85 offen offset:2048 sc1
    buffer_load_dwordx2 a[106:107], v5, s[4:7], s85 offen offset:2560 sc1
    v_mfma_f32_16x16x32_bf16 v[52:55], v[72:75], a[80:83], v[52:55]
    ds_read_b128 v[64:67], v130 offset:10240
    v_lshlrev_b32 v122, 16, v237
    v_mfma_f32_16x16x32_bf16 v[56:59], v[76:79], a[80:83], v[56:59]
    ds_read_b128 v[68:71], v130 offset:11264
    buffer_load_dwordx2 a[108:109], v5, s[4:7], s85 offen offset:3072 sc1
    buffer_load_dwordx2 a[110:111], v5, s[4:7], s85 offen offset:3584 sc1
    s_add_u32 s85, s85, 4096
    s_waitcnt lgkmcnt(6)
    v_mfma_f32_16x16x32_bf16 v[60:63], v[80:83], a[80:83], v[60:63]
    ds_read_b128 v[72:75], v130 offset:12288
    v_and_b32 v123, s3, v237
    v_mfma_f32_16x16x32_bf16 v[44:47], v[84:87], a[84:87], v[44:47]
    ds_read_b128 v[76:79], v130 offset:13312
    v_lshlrev_b32 v124, 16, v238
    s_waitcnt lgkmcnt(5)
    v_mfma_f32_16x16x32_bf16 v[48:51], v[88:91], a[84:87], v[48:51]
    ds_read_b128 v[80:83], v130 offset:14336
    v_and_b32 v125, s3, v238
    v_mfma_f32_16x16x32_bf16 v[52:55], v[92:95], a[84:87], v[52:55]
    ds_read_b128 v[84:87], v130 offset:15360
    v_lshlrev_b32 v126, 16, v239
    v_mfma_f32_16x16x32_bf16 v[56:59], v[96:99], a[84:87], v[56:59]
    ds_read_b128 v[88:91], v130 offset:16384
    v_and_b32 v127, s3, v239
    s_waitcnt lgkmcnt(5)
    v_mfma_f32_16x16x32_bf16 v[60:63], v[100:103], a[84:87], v[60:63]
    ds_read_b128 v[92:95], v130 offset:17408
    v_lshlrev_b32 v144, 16, v16
    s_waitcnt vmcnt(14) lgkmcnt(5)
    v_mfma_f32_16x16x32_bf16 v[44:47], v[64:67], a[88:91], v[44:47]
    ds_read_b128 v[96:99], v130 offset:18432
    v_and_b32 v145, s3, v16
    v_mfma_f32_16x16x32_bf16 v[48:51], v[68:71], a[88:91], v[48:51]
    ds_read_b128 v[100:103], v130 offset:19456
    v_lshlrev_b32 v146, 16, v17
    s_waitcnt vmcnt(8) lgkmcnt(5)
    s_barrier
    v_mfma_f32_16x16x32_bf16 v[52:55], v[72:75], a[88:91], v[52:55]
    ds_read_b128 v[64:67], v128 offset:0
    v_and_b32 v147, s3, v17
    v_mfma_f32_16x16x32_bf16 v[56:59], v[76:79], a[88:91], v[56:59]
    ds_read_b128 v[68:71], v128 offset:1024
    v_lshlrev_b32 v148, 16, v18
    v_mfma_f32_16x16x32_bf16 v[60:63], v[80:83], a[88:91], v[60:63]
    ds_read_b128 v[72:75], v128 offset:2048
    v_and_b32 v149, s3, v18
    s_waitcnt lgkmcnt(5)
    v_mfma_f32_16x16x32_bf16 v[44:47], v[84:87], a[92:95], v[44:47]
    ds_read_b128 v[76:79], v128 offset:3072
    v_lshlrev_b32 v150, 16, v19
    v_mfma_f32_16x16x32_bf16 v[48:51], v[88:91], a[92:95], v[48:51]
    ds_read_b128 v[80:83], v128 offset:4096
    v_and_b32 v151, s3, v19
    v_mfma_f32_16x16x32_bf16 v[52:55], v[92:95], a[92:95], v[52:55]
    ds_read_b128 v[84:87], v128 offset:5120
    v_lshlrev_b32 v152, 16, v20
    s_waitcnt lgkmcnt(5)
    v_mfma_f32_16x16x32_bf16 v[56:59], v[96:99], a[92:95], v[56:59]
    ds_read_b128 v[88:91], v128 offset:6144
    v_and_b32 v153, s3, v20
    v_mfma_f32_16x16x32_bf16 v[60:63], v[100:103], a[92:95], v[60:63]
    ds_read_b128 v[92:95], v128 offset:7168
    v_lshlrev_b32 v154, 16, v21
    s_waitcnt vmcnt(6) lgkmcnt(5)
    v_mfma_f32_16x16x32_bf16 v[44:47], v[64:67], a[96:99], v[44:47]
    ds_read_b128 v[96:99], v128 offset:8192
    v_and_b32 v155, s3, v21
    v_mfma_f32_16x16x32_bf16 v[48:51], v[68:71], a[96:99], v[48:51]
    ds_read_b128 v[100:103], v128 offset:9216
    v_lshlrev_b32 v156, 16, v22
    v_mfma_f32_16x16x32_bf16 v[52:55], v[72:75], a[96:99], v[52:55]
    ds_read_b128 v[64:67], v128 offset:10240
    v_and_b32 v157, s3, v22
    s_waitcnt lgkmcnt(5)
    v_mfma_f32_16x16x32_bf16 v[56:59], v[76:79], a[96:99], v[56:59]
    ds_read_b128 v[68:71], v128 offset:11264
    v_lshlrev_b32 v158, 16, v23
    v_mfma_f32_16x16x32_bf16 v[60:63], v[80:83], a[96:99], v[60:63]
    ds_read_b128 v[72:75], v128 offset:12288
    v_and_b32 v159, s3, v23
    s_waitcnt vmcnt(4) lgkmcnt(5)
    v_mfma_f32_16x16x32_bf16 v[44:47], v[84:87], a[100:103], v[44:47]
    ds_read_b128 v[76:79], v128 offset:13312
    v_lshlrev_b32 v160, 16, v24
    v_mfma_f32_16x16x32_bf16 v[48:51], v[88:91], a[100:103], v[48:51]
    ds_read_b128 v[80:83], v128 offset:14336
    v_and_b32 v161, s3, v24
    v_mfma_f32_16x16x32_bf16 v[52:55], v[92:95], a[100:103], v[52:55]
    ds_read_b128 v[84:87], v128 offset:15360
    v_lshlrev_b32 v162, 16, v25
    s_waitcnt lgkmcnt(5)
    v_mfma_f32_16x16x32_bf16 v[56:59], v[96:99], a[100:103], v[56:59]
    ds_read_b128 v[88:91], v128 offset:16384
    v_and_b32 v163, s3, v25
    v_mfma_f32_16x16x32_bf16 v[60:63], v[100:103], a[100:103], v[60:63]
    ds_read_b128 v[92:95], v128 offset:17408
    s_waitcnt vmcnt(2) lgkmcnt(5)
    v_mfma_f32_16x16x32_bf16 v[44:47], v[64:67], a[104:107], v[44:47]
    ds_read_b128 v[96:99], v128 offset:18432
    v_mfma_f32_16x16x32_bf16 v[48:51], v[68:71], a[104:107], v[48:51]
    ds_read_b128 v[100:103], v128 offset:19456
    v_mfma_f32_16x16x32_bf16 v[52:55], v[72:75], a[104:107], v[52:55]
    s_waitcnt lgkmcnt(5)
    v_mfma_f32_16x16x32_bf16 v[56:59], v[76:79], a[104:107], v[56:59]
    v_mfma_f32_16x16x32_bf16 v[60:63], v[80:83], a[104:107], v[60:63]
    s_waitcnt vmcnt(0) lgkmcnt(3)
    v_mfma_f32_16x16x32_bf16 v[44:47], v[84:87], a[108:111], v[44:47]
    v_mfma_f32_16x16x32_bf16 v[48:51], v[88:91], a[108:111], v[48:51]
    s_waitcnt lgkmcnt(1)
    v_mfma_f32_16x16x32_bf16 v[52:55], v[92:95], a[108:111], v[52:55]
    v_mfma_f32_16x16x32_bf16 v[56:59], v[96:99], a[108:111], v[56:59]
    s_waitcnt lgkmcnt(0)
    v_mfma_f32_16x16x32_bf16 v[60:63], v[100:103], a[108:111], v[60:63]
    s_nop 1
    v_fmac_f32 v144, v108, v44
    v_fmac_f32 v145, v109, v48
    v_fmac_f32 v146, v110, v45
    v_fmac_f32 v147, v111, v49
    v_fmac_f32 v148, v112, v46
    v_fmac_f32 v149, v113, v50
    v_fmac_f32 v150, v114, v47
    v_fmac_f32 v151, v115, v51
    v_cvt_pk_bf16_f32 v16, v144, v145
    v_cvt_pk_bf16_f32 v17, v146, v147
    v_cvt_pk_bf16_f32 v18, v148, v149
    v_cvt_pk_bf16_f32 v19, v150, v151
    ds_write_b128 v131, v[16:19] offset:0
    v_fmac_f32 v152, v116, v52
    v_fmac_f32 v153, v117, v56
    v_fmac_f32 v154, v118, v53
    v_fmac_f32 v155, v119, v57
    v_fmac_f32 v156, v120, v54
    v_fmac_f32 v157, v121, v58
    v_fmac_f32 v158, v122, v55
    v_fmac_f32 v159, v123, v59
    v_cvt_pk_bf16_f32 v20, v152, v153
    v_cvt_pk_bf16_f32 v21, v154, v155
    v_cvt_pk_bf16_f32 v22, v156, v157
    v_cvt_pk_bf16_f32 v23, v158, v159
    ds_write_b128 v131, v[20:23] offset:64
    v_fmac_f32 v160, v124, v60
    v_fmac_f32 v161, v125, v61
    v_fmac_f32 v162, v126, v62
    v_fmac_f32 v163, v127, v63
    v_cvt_pk_bf16_f32 v24, v160, v161
    v_cvt_pk_bf16_f32 v25, v162, v163
    ds_write_b64 v132, v[24:25] offset:128
    ds_read_b128 v[64:67], v134
    ds_read_b128 v[68:71], v135
    ds_read_b128 v[72:75], v136
    s_waitcnt lgkmcnt(2)
    buffer_store_dwordx4 v[64:67], v138, s[16:19], s72 offen nt
    s_waitcnt lgkmcnt(1)
    buffer_store_dwordx4 v[68:71], v139, s[16:19], s72 offen nt
    s_waitcnt lgkmcnt(0)
    buffer_store_dwordx4 v[72:75], v140, s[16:19], s72 offen nt
    s_cmp_lg_u32 s2, 252
    s_cbranch_scc1 L_adaL_end_1
    v_mov_b32 v2, 0
    v_mov_b32 v3, 0
    buffer_store_dwordx2 v[2:3], off, s[44:47], 0 sc1
L_adaL_end_1:
    s_endpgm
L_adaL_w3_23:
    buffer_load_dwordx4 a[96:99], v241, s[4:7], s85 offen offset:0 sc1
    v_bfe_u32 v3, v0, 3, 2
    v_bfe_u32 v4, v0, 5, 1
    v_lshl_add_u32 v3, v3, 1, v4
    v_lshlrev_b32 v15, 14, v3
    v_and_b32 v3, 7, v0
    v_lshl_add_u32 v15, v3, 4, v15
    s_lshl_b32 s52, s83, 9
    s_lshl_b32 s62, s82, 7
    buffer_load_dwordx4 a[104:107], v241, s[4:7], s85 offen offset:1024 sc1
    s_add_u32 s52, s52, s62
    s_add_u32 s52, s52, 6291456
    s_mul_i32 s53, s82, 20480
    v_lshlrev_b32 v5, 3, v240
    v_add_u32 v6, 40960, v5
    v_add_u32 v14, s53, v5
    v_lshlrev_b32 v7, 4, v2
    s_mov_b32 s66, 0xbdd2d3e8
    buffer_load_dwordx4 a[112:115], v241, s[4:7], s85 offen offset:2048 sc1
    s_mov_b32 s67, 0xc0135761
    s_mov_b32 s68, 1.0
    s_mov_b32 s69, 1.0
    v_mov_b32 v132, 0x3f803f80
    v_mov_b32 v133, 0x3f803f80
    v_mov_b32 v134, 0x3f803f80
    v_mov_b32 v135, 0x3f803f80
    v_lshlrev_b32 v12, 2, v1
    buffer_load_dwordx4 a[120:123], v241, s[4:7], s85 offen offset:3072 sc1
    s_lshl_b32 s62, s84, 11
    s_add_u32 s62, s62, 262144
    v_lshlrev_b32 v4, 3, v0
    s_add_u32 s85, s85, 4096
    buffer_load_dwordx4 a[128:131], v241, s[4:7], s85 offen offset:0 sc1
    buffer_load_dwordx4 a[136:139], v241, s[4:7], s85 offen offset:1024 sc1
    buffer_load_dwordx4 a[144:147], v241, s[4:7], s85 offen offset:2048 sc1
    buffer_load_dwordx4 a[152:155], v241, s[4:7], s85 offen offset:3072 sc1
    s_add_u32 s85, s85, 4096
    buffer_load_dwordx4 a[160:163], v241, s[4:7], s85 offen offset:0 sc1
    buffer_load_dwordx4 a[168:171], v241, s[4:7], s85 offen offset:1024 sc1
    buffer_load_dwordx4 a[176:179], v241, s[4:7], s85 offen offset:2048 sc1
    buffer_load_dwordx4 a[184:187], v241, s[4:7], s85 offen offset:3072 sc1
    s_add_u32 s85, s85, 4096
    buffer_load_dwordx2 v[180:181], v4, s[4:7], s62 offen sc1
    s_add_u32 s62, s62, 16384
    buffer_load_dwordx2 v[182:183], v4, s[4:7], s62 offen sc1
    s_add_u32 s62, s62, 16384
    buffer_load_dwordx2 v[184:185], v4, s[4:7], s62 offen sc1
    s_add_u32 s62, s62, 16384
    buffer_load_dwordx2 v[186:187], v4, s[4:7], s62 offen sc1
    s_add_u32 s62, s62, 16384
    buffer_load_dwordx2 v[188:189], v4, s[4:7], s62 offen sc1
    s_add_u32 s62, s62, 16384
    s_mul_i32 s62, s84, 640
    s_add_u32 s62, s62, 58368
    v_min_u32 v3, 79, v0
    v_lshl_add_u32 v166, v3, 3, s62
    buffer_load_dwordx2 v[164:165], v166, s[4:7], 0 offen sc1
    buffer_load_dword v27, v26, s[4:7], s60 offen sc1
    v_lshlrev_b32 v3, 2, v3
    v_add_u32 v3, 88576, v3
    s_waitcnt vmcnt(5)
    v_pk_add_f32 v[180:181], v[180:181], v[182:183]
    s_waitcnt vmcnt(4)
    v_pk_add_f32 v[180:181], v[180:181], v[184:185]
    s_waitcnt vmcnt(3)
    v_pk_add_f32 v[180:181], v[180:181], v[186:187]
    s_waitcnt vmcnt(2)
    v_pk_add_f32 v[180:181], v[180:181], v[188:189]
    v_add_u32 v4, 86528, v4
    s_mul_i32 s63, s82, 14336
    s_add_u32 s63, s63, 102912
    s_sub_u32 s64, s63, s54
    s_mov_b32 s54, s63
    v_add_u32 v10, s64, v10
    v_add_u32 v11, s64, v11
    s_mov_b32 s49, 65536
L_adaL_poll_14_w3:
    s_waitcnt vmcnt(1)
    v_cmp_ne_u32 vcc, s48, v165
    s_nop 0
    s_cbranch_vccz L_adaL_got_15_w3
    buffer_load_dwordx2 v[164:165], v166, s[4:7], 0 offen sc1
    s_waitcnt vmcnt(0)
    s_sub_u32 s49, s49, 1
    s_cmp_lg_u32 s49, 0
    s_cbranch_scc1 L_adaL_poll_14_w3
L_adaL_got_15_w3:
    s_mov_b32 s49, 65536
L_adaL_poll_16_w3:
    s_waitcnt vmcnt(0)
    v_cmp_ne_u32 vcc, s48, v27
    s_nop 0
    s_cbranch_vccz L_adaL_got_17_w3
    buffer_load_dword v27, v26, s[4:7], s60 offen sc1
    s_waitcnt vmcnt(0)
    s_sub_u32 s49, s49, 1
    s_cmp_lg_u32 s49, 0
    s_cbranch_scc1 L_adaL_poll_16_w3
L_adaL_got_17_w3:
    s_barrier
    s_mov_b32 m0, s53
    s_nop 0
    buffer_load_dwordx4 v15, s[4:7], s52 offen sc1 lds
    s_add_u32 m0, m0, 1024
    s_add_u32 s52, s52, 131072
    buffer_load_dwordx4 v15, s[4:7], s52 offen sc1 lds
    s_add_u32 m0, m0, 1024
    s_add_u32 s52, s52, 131072
    buffer_load_dwordx4 v15, s[4:7], s52 offen sc1 lds
    s_add_u32 m0, m0, 1024
    s_add_u32 s52, s52, 131072
    buffer_load_dwordx4 v15, s[4:7], s52 offen sc1 lds
    s_add_u32 m0, m0, 1024
    s_add_u32 s52, s52, 131072
    buffer_load_dwordx4 v15, s[4:7], s52 offen sc1 lds
    s_add_u32 m0, m0, 1024
    s_add_u32 s52, s52, 131072
    buffer_load_dwordx4 v15, s[4:7], s52 offen sc1 lds
    s_add_u32 m0, m0, 1024
    s_add_u32 s52, s52, 131072
    buffer_load_dwordx4 v15, s[4:7], s52 offen sc1 lds
    s_add_u32 m0, m0, 1024
    s_add_u32 s52, s52, 131072
    buffer_load_dwordx4 v15, s[4:7], s52 offen sc1 lds
    s_add_u32 m0, m0, 1024
    s_add_u32 s52, s52, 131072
    buffer_load_dwordx4 v15, s[4:7], s52 offen sc1 lds
    s_add_u32 m0, m0, 1024
    s_add_u32 s52, s52, 131072
    buffer_load_dwordx4 v15, s[4:7], s52 offen sc1 lds
    s_add_u32 m0, m0, 1024
    s_add_u32 s52, s52, 131072
    ds_write_b64 v4, v[180:181]
    ds_write_b32 v3, v164
    s_lshl_b32 s60, s83, 3
    s_add_u32 s60, s60, s84
    s_lshl_b32 s60, s60, 15
    v_lshlrev_b32 v26, 5, v0
    s_waitcnt vmcnt(9)
    ds_read_b64 v[92:93], v14 offset:0
    ds_read_b64 v[94:95], v14 offset:512
    buffer_load_dwordx4 v15, s[4:7], s52 offen sc1 lds
    s_add_u32 m0, m0, 1024
    s_add_u32 s52, s52, 131072
    s_waitcnt lgkmcnt(0)
    v_mfma_f32_16x16x32_bf16 v[136:139], v[92:95], v[92:95], 0
    s_waitcnt vmcnt(9)
    ds_read_b64 v[96:97], v14 offset:1024
    v_mfma_f32_16x16x32_bf16 v[140:143], v[132:135], v[92:95], 0
    ds_read_b64 v[98:99], v14 offset:1536
    buffer_load_dwordx4 v15, s[4:7], s52 offen sc1 lds
    s_add_u32 m0, m0, 1024
    s_add_u32 s52, s52, 131072
    s_waitcnt lgkmcnt(0)
    v_mfma_f32_16x16x32_bf16 v[136:139], v[96:99], v[96:99], v[136:139]
    s_waitcnt vmcnt(9)
    ds_read_b64 v[92:93], v14 offset:2048
    v_mfma_f32_16x16x32_bf16 v[140:143], v[132:135], v[96:99], v[140:143]
    ds_read_b64 v[94:95], v14 offset:2560
    buffer_load_dwordx4 v15, s[4:7], s52 offen sc1 lds
    s_add_u32 m0, m0, 1024
    s_add_u32 s52, s52, 131072
    s_waitcnt lgkmcnt(0)
    v_mfma_f32_16x16x32_bf16 v[136:139], v[92:95], v[92:95], v[136:139]
    s_waitcnt vmcnt(9)
    ds_read_b64 v[96:97], v14 offset:3072
    v_mfma_f32_16x16x32_bf16 v[140:143], v[132:135], v[92:95], v[140:143]
    ds_read_b64 v[98:99], v14 offset:3584
    s_waitcnt lgkmcnt(0)
    s_barrier
    ds_read_b64 v[44:45], v5 offset:0
    ds_read_b64 v[46:47], v5 offset:512
    ds_read_b64 v[48:49], v5 offset:20480
    ds_read_b64 v[50:51], v5 offset:20992
    ds_read_b64 v[52:53], v6 offset:0
    ds_read_b64 v[54:55], v6 offset:512
    ds_read_b64 v[56:57], v6 offset:20480
    ds_read_b64 v[58:59], v6 offset:20992
    ds_read_b64 v[60:61], v5 offset:1024
    ds_read_b64 v[62:63], v5 offset:1536
    ds_read_b64 v[64:65], v5 offset:21504
    ds_read_b64 v[66:67], v5 offset:22016
    ds_read_b64 v[68:69], v6 offset:1024
    ds_read_b64 v[70:71], v6 offset:1536
    ds_read_b64 v[72:73], v6 offset:21504
    ds_read_b64 v[74:75], v6 offset:22016
    v_mfma_f32_16x16x32_bf16 v[136:139], v[96:99], v[96:99], v[136:139]
    s_waitcnt vmcnt(8)
    ds_read_b64 v[92:93], v14 offset:4096
    v_mfma_f32_16x16x32_bf16 v[140:143], v[132:135], v[96:99], v[140:143]
    ds_read_b64 v[94:95], v14 offset:4608
    s_waitcnt lgkmcnt(10)
    v_mfma_f32_16x16x32_bf16 v[100:103], v[44:47], a[96:99], 0
    ds_read2st64_b64 v[76:79], v5 offset0:4 offset1:5
    v_mfma_f32_16x16x32_bf16 v[104:107], v[48:51], a[96:99], 0
    ds_read_b64 v[80:81], v5 offset:22528
    v_mfma_f32_16x16x32_bf16 v[108:111], v[52:55], a[96:99], 0
    ds_read_b64 v[82:83], v5 offset:23040
    v_mfma_f32_16x16x32_bf16 v[112:115], v[56:59], a[96:99], 0
    buffer_load_dwordx4 v15, s[4:7], s52 offen sc1 lds
    s_add_u32 m0, m0, 1024
    s_add_u32 s52, s52, 131072
    v_mov_b32 v116, 0
    v_mov_b32 v117, 0
    v_mov_b32 v118, 0
    v_mov_b32 v119, 0
    ds_read2st64_b64 v[84:87], v5 offset0:84 offset1:85
    v_mov_b32 v120, 0
    v_mov_b32 v121, 0
    v_mov_b32 v122, 0
    v_mov_b32 v123, 0
    ds_read_b64 v[88:89], v6 offset:22528
    v_mov_b32 v124, 0
    v_mov_b32 v125, 0
    v_mov_b32 v126, 0
    v_mov_b32 v127, 0
    ds_read_b64 v[90:91], v6 offset:23040
    v_mov_b32 v128, 0
    v_mov_b32 v129, 0
    v_mov_b32 v130, 0
    v_mov_b32 v131, 0
    buffer_load_dwordx4 v15, s[4:7], s52 offen sc1 lds
    s_add_u32 m0, m0, 1024
    s_add_u32 s52, s52, 131072
    s_waitcnt lgkmcnt(4)
    v_mfma_f32_16x16x32_bf16 v[136:139], v[92:95], v[92:95], v[136:139]
    s_waitcnt vmcnt(9) lgkmcnt(3)
    ds_read_b64 v[96:97], v14 offset:5120
    v_mfma_f32_16x16x32_bf16 v[140:143], v[132:135], v[92:95], v[140:143]
    ds_read_b64 v[98:99], v14 offset:5632
    v_mfma_f32_16x16x32_bf16 v[100:103], v[60:63], a[104:107], v[100:103]
    ds_read2st64_b64 v[44:47], v5 offset0:6 offset1:7
    v_mfma_f32_16x16x32_bf16 v[104:107], v[64:67], a[104:107], v[104:107]
    ds_read_b64 v[48:49], v5 offset:23552
    v_mfma_f32_16x16x32_bf16 v[108:111], v[68:71], a[104:107], v[108:111]
    ds_read_b64 v[50:51], v5 offset:24064
    v_mfma_f32_16x16x32_bf16 v[112:115], v[72:75], a[104:107], v[112:115]
    buffer_load_dwordx4 v15, s[4:7], s52 offen sc1 lds
    s_add_u32 m0, m0, 1024
    s_add_u32 s52, s52, 131072
    ds_read2st64_b64 v[52:55], v5 offset0:86 offset1:87
    ds_read_b64 v[56:57], v6 offset:23552
    ds_read_b64 v[58:59], v6 offset:24064
    buffer_load_dwordx4 v15, s[4:7], s52 offen sc1 lds
    s_add_u32 m0, m0, 1024
    s_add_u32 s52, s52, 131072
    s_waitcnt lgkmcnt(6)
    v_mfma_f32_16x16x32_bf16 v[136:139], v[96:99], v[96:99], v[136:139]
    s_waitcnt vmcnt(10)
    ds_read_b64 v[92:93], v14 offset:6144
    v_mfma_f32_16x16x32_bf16 v[140:143], v[132:135], v[96:99], v[140:143]
    ds_read_b64 v[94:95], v14 offset:6656
    s_waitcnt vmcnt(9)
    s_barrier
    v_mfma_f32_16x16x32_bf16 v[100:103], v[76:79], a[112:115], v[100:103]
    ds_read2st64_b64 v[60:63], v5 offset0:8 offset1:9
    v_mfma_f32_16x16x32_bf16 v[104:107], v[80:83], a[112:115], v[104:107]
    ds_read_b64 v[64:65], v5 offset:24576
    v_mfma_f32_16x16x32_bf16 v[108:111], v[84:87], a[112:115], v[108:111]
    ds_read_b64 v[66:67], v5 offset:25088
    v_mfma_f32_16x16x32_bf16 v[112:115], v[88:91], a[112:115], v[112:115]
    buffer_load_dwordx4 v15, s[4:7], s52 offen sc1 lds
    s_add_u32 m0, m0, 1024
    s_add_u32 s52, s52, 131072
    ds_read2st64_b64 v[68:71], v5 offset0:88 offset1:89
    ds_read_b64 v[72:73], v6 offset:24576
    ds_read_b64 v[74:75], v6 offset:25088
    buffer_load_dwordx4 v15, s[4:7], s52 offen sc1 lds
    s_add_u32 m0, m0, 1024
    s_add_u32 s52, s52, 131072
    s_waitcnt lgkmcnt(6)
    v_mfma_f32_16x16x32_bf16 v[136:139], v[92:95], v[92:95], v[136:139]
    ds_read_b64 v[96:97], v14 offset:7168
    v_mfma_f32_16x16x32_bf16 v[140:143], v[132:135], v[92:95], v[140:143]
    ds_read_b64 v[98:99], v14 offset:7680
    v_mfma_f32_16x16x32_bf16 v[100:103], v[44:47], a[120:123], v[100:103]
    ds_read2st64_b64 v[76:79], v5 offset0:10 offset1:11
    v_mfma_f32_16x16x32_bf16 v[104:107], v[48:51], a[120:123], v[104:107]
    ds_read_b64 v[80:81], v5 offset:25600
    v_mfma_f32_16x16x32_bf16 v[108:111], v[52:55], a[120:123], v[108:111]
    ds_read_b64 v[82:83], v5 offset:26112
    v_mfma_f32_16x16x32_bf16 v[112:115], v[56:59], a[120:123], v[112:115]
    buffer_load_dwordx4 v15, s[4:7], s52 offen sc1 lds
    ds_read2st64_b64 v[84:87], v5 offset0:90 offset1:91
    ds_read_b64 v[88:89], v6 offset:25600
    ds_read_b64 v[90:91], v6 offset:26112
    buffer_load_dwordx4 a[192:195], v241, s[4:7], s85 offen offset:0 sc1
    s_waitcnt lgkmcnt(6)
    v_mfma_f32_16x16x32_bf16 v[136:139], v[96:99], v[96:99], v[136:139]
    s_waitcnt vmcnt(12)
    ds_read_b64 v[92:93], v14 offset:8192
    v_mfma_f32_16x16x32_bf16 v[140:143], v[132:135], v[96:99], v[140:143]
    ds_read_b64 v[94:95], v14 offset:8704
    v_mfma_f32_16x16x32_bf16 v[100:103], v[60:63], a[128:131], v[100:103]
    ds_read2st64_b64 v[44:47], v5 offset0:12 offset1:13
    v_mfma_f32_16x16x32_bf16 v[104:107], v[64:67], a[128:131], v[104:107]
    ds_read_b64 v[48:49], v5 offset:26624
    v_mfma_f32_16x16x32_bf16 v[108:111], v[68:71], a[128:131], v[108:111]
    ds_read_b64 v[50:51], v5 offset:27136
    v_mfma_f32_16x16x32_bf16 v[112:115], v[72:75], a[128:131], v[112:115]
    ds_read2st64_b64 v[52:55], v5 offset0:92 offset1:93
    ds_read_b64 v[56:57], v6 offset:26624
    ds_read_b64 v[58:59], v6 offset:27136
    buffer_load_dwordx4 a[200:203], v241, s[4:7], s85 offen offset:1024 sc1
    s_waitcnt lgkmcnt(6)
    v_mfma_f32_16x16x32_bf16 v[136:139], v[92:95], v[92:95], v[136:139]
    s_waitcnt vmcnt(12)
    ds_read_b64 v[96:97], v14 offset:9216
    v_mfma_f32_16x16x32_bf16 v[140:143], v[132:135], v[92:95], v[140:143]
    ds_read_b64 v[98:99], v14 offset:9728
    v_mfma_f32_16x16x32_bf16 v[100:103], v[76:79], a[136:139], v[100:103]
    ds_read2st64_b64 v[60:63], v5 offset0:14 offset1:15
    v_mfma_f32_16x16x32_bf16 v[104:107], v[80:83], a[136:139], v[104:107]
    ds_read_b64 v[64:65], v5 offset:27648
    v_mfma_f32_16x16x32_bf16 v[108:111], v[84:87], a[136:139], v[108:111]
    ds_read_b64 v[66:67], v5 offset:28160
    v_mfma_f32_16x16x32_bf16 v[112:115], v[88:91], a[136:139], v[112:115]
    ds_read2st64_b64 v[68:71], v5 offset0:94 offset1:95
    ds_read_b64 v[72:73], v6 offset:27648
    ds_read_b64 v[74:75], v6 offset:28160
    buffer_load_dwordx4 a[208:211], v241, s[4:7], s85 offen offset:2048 sc1
    s_waitcnt lgkmcnt(6)
    v_mfma_f32_16x16x32_bf16 v[136:139], v[96:99], v[96:99], v[136:139]
    s_waitcnt vmcnt(12)
    ds_read_b64 v[92:93], v14 offset:10240
    v_mfma_f32_16x16x32_bf16 v[140:143], v[132:135], v[96:99], v[140:143]
    ds_read_b64 v[94:95], v14 offset:10752
    s_waitcnt vmcnt(11)
    s_barrier
    v_mfma_f32_16x16x32_bf16 v[100:103], v[44:47], a[144:147], v[100:103]
    ds_read2st64_b64 v[76:79], v5 offset0:16 offset1:17
    v_mfma_f32_16x16x32_bf16 v[104:107], v[48:51], a[144:147], v[104:107]
    ds_read_b64 v[80:81], v5 offset:28672
    v_mfma_f32_16x16x32_bf16 v[108:111], v[52:55], a[144:147], v[108:111]
    ds_read_b64 v[82:83], v5 offset:29184
    v_mfma_f32_16x16x32_bf16 v[112:115], v[56:59], a[144:147], v[112:115]
    ds_read2st64_b64 v[84:87], v5 offset0:96 offset1:97
    ds_read_b64 v[88:89], v6 offset:28672
    ds_read_b64 v[90:91], v6 offset:29184
    buffer_load_dwordx4 a[216:219], v241, s[4:7], s85 offen offset:3072 sc1
    s_waitcnt lgkmcnt(6)
    v_mfma_f32_16x16x32_bf16 v[136:139], v[92:95], v[92:95], v[136:139]
    ds_read_b64 v[96:97], v14 offset:11264
    v_mfma_f32_16x16x32_bf16 v[140:143], v[132:135], v[92:95], v[140:143]
    ds_read_b64 v[98:99], v14 offset:11776
    v_mfma_f32_16x16x32_bf16 v[100:103], v[60:63], a[152:155], v[100:103]
    ds_read2st64_b64 v[44:47], v5 offset0:18 offset1:19
    v_mfma_f32_16x16x32_bf16 v[104:107], v[64:67], a[152:155], v[104:107]
    ds_read_b64 v[48:49], v5 offset:29696
    v_mfma_f32_16x16x32_bf16 v[108:111], v[68:71], a[152:155], v[108:111]
    ds_read_b64 v[50:51], v5 offset:30208
    v_mfma_f32_16x16x32_bf16 v[112:115], v[72:75], a[152:155], v[112:115]
    s_add_u32 s85, s85, 4096
    ds_read2st64_b64 v[52:55], v5 offset0:98 offset1:99
    ds_read_b64 v[56:57], v6 offset:29696
    ds_read_b64 v[58:59], v6 offset:30208
    buffer_load_dwordx4 a[224:227], v241, s[4:7], s85 offen offset:0 sc1
    s_waitcnt lgkmcnt(6)
    v_mfma_f32_16x16x32_bf16 v[136:139], v[96:99], v[96:99], v[136:139]
    s_waitcnt vmcnt(12)
    ds_read_b64 v[92:93], v14 offset:12288
    v_mfma_f32_16x16x32_bf16 v[140:143], v[132:135], v[96:99], v[140:143]
    ds_read_b64 v[94:95], v14 offset:12800
    v_mfma_f32_16x16x32_bf16 v[100:103], v[76:79], a[160:163], v[100:103]
    ds_read2st64_b64 v[60:63], v5 offset0:20 offset1:21
    v_mfma_f32_16x16x32_bf16 v[104:107], v[80:83], a[160:163], v[104:107]
    ds_read_b64 v[64:65], v5 offset:30720
    v_mfma_f32_16x16x32_bf16 v[108:111], v[84:87], a[160:163], v[108:111]
    ds_read_b64 v[66:67], v5 offset:31232
    v_mfma_f32_16x16x32_bf16 v[112:115], v[88:91], a[160:163], v[112:115]
    ds_read2st64_b64 v[68:71], v5 offset0:100 offset1:101
    ds_read_b64 v[72:73], v6 offset:30720
    ds_read_b64 v[74:75], v6 offset:31232
    buffer_load_dwordx4 a[232:235], v241, s[4:7], s85 offen offset:1024 sc1
    s_waitcnt lgkmcnt(6)
    v_mfma_f32_16x16x32_bf16 v[136:139], v[92:95], v[92:95], v[136:139]
    s_waitcnt vmcnt(12)
    ds_read_b64 v[96:97], v14 offset:13312
    v_mfma_f32_16x16x32_bf16 v[140:143], v[132:135], v[92:95], v[140:143]
    ds_read_b64 v[98:99], v14 offset:13824
    v_mfma_f32_16x16x32_bf16 v[100:103], v[44:47], a[168:171], v[100:103]
    ds_read2st64_b64 v[76:79], v5 offset0:22 offset1:23
    v_mfma_f32_16x16x32_bf16 v[104:107], v[48:51], a[168:171], v[104:107]
    ds_read_b64 v[80:81], v5 offset:31744
    v_mfma_f32_16x16x32_bf16 v[108:111], v[52:55], a[168:171], v[108:111]
    ds_read_b64 v[82:83], v5 offset:32256
    v_mfma_f32_16x16x32_bf16 v[112:115], v[56:59], a[168:171], v[112:115]
    ds_read2st64_b64 v[84:87], v5 offset0:102 offset1:103
    ds_read_b64 v[88:89], v6 offset:31744
    ds_read_b64 v[90:91], v6 offset:32256
    buffer_load_dwordx4 a[240:243], v241, s[4:7], s85 offen offset:2048 sc1
    s_waitcnt lgkmcnt(6)
    v_mfma_f32_16x16x32_bf16 v[136:139], v[96:99], v[96:99], v[136:139]
    s_waitcnt vmcnt(12)
    ds_read_b64 v[92:93], v14 offset:14336
    v_mfma_f32_16x16x32_bf16 v[140:143], v[132:135], v[96:99], v[140:143]
    ds_read_b64 v[94:95], v14 offset:14848
    s_waitcnt vmcnt(11)
    s_barrier
    v_mfma_f32_16x16x32_bf16 v[100:103], v[60:63], a[176:179], v[100:103]
    ds_read2st64_b64 v[44:47], v5 offset0:24 offset1:25
    v_mfma_f32_16x16x32_bf16 v[104:107], v[64:67], a[176:179], v[104:107]
    ds_read_b64 v[48:49], v5 offset:32768
    v_mfma_f32_16x16x32_bf16 v[108:111], v[68:71], a[176:179], v[108:111]
    ds_read_b64 v[50:51], v5 offset:33280
    v_mfma_f32_16x16x32_bf16 v[112:115], v[72:75], a[176:179], v[112:115]
    ds_read2st64_b64 v[52:55], v5 offset0:104 offset1:105
    ds_read_b64 v[56:57], v6 offset:32768
    ds_read_b64 v[58:59], v6 offset:33280
    buffer_load_dwordx4 a[248:251], v241, s[4:7], s85 offen offset:3072 sc1
    s_waitcnt lgkmcnt(6)
    v_mfma_f32_16x16x32_bf16 v[136:139], v[92:95], v[92:95], v[136:139]
    ds_read_b64 v[96:97], v14 offset:15360
    v_mfma_f32_16x16x32_bf16 v[140:143], v[132:135], v[92:95], v[140:143]
    ds_read_b64 v[98:99], v14 offset:15872
    v_mfma_f32_16x16x32_bf16 v[100:103], v[76:79], a[184:187], v[100:103]
    ds_read2st64_b64 v[60:63], v5 offset0:26 offset1:27
    v_mfma_f32_16x16x32_bf16 v[104:107], v[80:83], a[184:187], v[104:107]
    ds_read_b64 v[64:65], v5 offset:33792
    v_mfma_f32_16x16x32_bf16 v[108:111], v[84:87], a[184:187], v[108:111]
    ds_read_b64 v[66:67], v5 offset:34304
    v_mfma_f32_16x16x32_bf16 v[112:115], v[88:91], a[184:187], v[112:115]
    s_sub_u32 s85, s85, 159744
    ds_read2st64_b64 v[68:71], v5 offset0:106 offset1:107
    ds_read_b64 v[72:73], v6 offset:33792
    ds_read_b64 v[74:75], v6 offset:34304
    buffer_load_dwordx4 a[96:99], v241, s[4:7], s85 offen offset:0 sc1
    s_waitcnt lgkmcnt(6)
    v_mfma_f32_16x16x32_bf16 v[136:139], v[96:99], v[96:99], v[136:139]
    s_waitcnt vmcnt(12)
    ds_read_b64 v[92:93], v14 offset:16384
    v_mfma_f32_16x16x32_bf16 v[140:143], v[132:135], v[96:99], v[140:143]
    ds_read_b64 v[94:95], v14 offset:16896
    s_waitcnt vmcnt(8)
    v_mfma_f32_16x16x32_bf16 v[100:103], v[44:47], a[192:195], v[100:103]
    ds_read2st64_b64 v[76:79], v5 offset0:28 offset1:29
    v_mfma_f32_16x16x32_bf16 v[104:107], v[48:51], a[192:195], v[104:107]
    ds_read_b64 v[80:81], v5 offset:34816
    v_mfma_f32_16x16x32_bf16 v[108:111], v[52:55], a[192:195], v[108:111]
    ds_read_b64 v[82:83], v5 offset:35328
    v_mfma_f32_16x16x32_bf16 v[112:115], v[56:59], a[192:195], v[112:115]
    ds_read2st64_b64 v[84:87], v5 offset0:108 offset1:109
    ds_read_b64 v[88:89], v6 offset:34816
    ds_read_b64 v[90:91], v6 offset:35328
    buffer_load_dwordx4 a[104:107], v241, s[4:7], s85 offen offset:1024 sc1
    s_waitcnt lgkmcnt(6)
    v_mfma_f32_16x16x32_bf16 v[136:139], v[92:95], v[92:95], v[136:139]
    ds_read_b64 v[96:97], v14 offset:17408
    v_mfma_f32_16x16x32_bf16 v[140:143], v[132:135], v[92:95], v[140:143]
    ds_read_b64 v[98:99], v14 offset:17920
    s_waitcnt vmcnt(8)
    v_mfma_f32_16x16x32_bf16 v[100:103], v[60:63], a[200:203], v[100:103]
    ds_read2st64_b64 v[44:47], v5 offset0:30 offset1:31
    v_mfma_f32_16x16x32_bf16 v[104:107], v[64:67], a[200:203], v[104:107]
    ds_read_b64 v[48:49], v5 offset:35840
    v_mfma_f32_16x16x32_bf16 v[108:111], v[68:71], a[200:203], v[108:111]
    ds_read_b64 v[50:51], v5 offset:36352
    v_mfma_f32_16x16x32_bf16 v[112:115], v[72:75], a[200:203], v[112:115]
    ds_read2st64_b64 v[52:55], v5 offset0:110 offset1:111
    ds_read_b64 v[56:57], v6 offset:35840
    ds_read_b64 v[58:59], v6 offset:36352
    buffer_load_dwordx4 a[112:115], v241, s[4:7], s85 offen offset:2048 sc1
    s_waitcnt lgkmcnt(6)
    v_mfma_f32_16x16x32_bf16 v[136:139], v[96:99], v[96:99], v[136:139]
    ds_read_b64 v[92:93], v14 offset:18432
    v_mfma_f32_16x16x32_bf16 v[140:143], v[132:135], v[96:99], v[140:143]
    ds_read_b64 v[94:95], v14 offset:18944
    s_barrier
    s_waitcnt vmcnt(8)
    v_mfma_f32_16x16x32_bf16 v[100:103], v[76:79], a[208:211], v[100:103]
    ds_read2st64_b64 v[60:63], v5 offset0:32 offset1:33
    v_mfma_f32_16x16x32_bf16 v[104:107], v[80:83], a[208:211], v[104:107]
    ds_read_b64 v[64:65], v5 offset:36864
    v_mfma_f32_16x16x32_bf16 v[108:111], v[84:87], a[208:211], v[108:111]
    ds_read_b64 v[66:67], v5 offset:37376
    v_mfma_f32_16x16x32_bf16 v[112:115], v[88:91], a[208:211], v[112:115]
    ds_read2st64_b64 v[68:71], v5 offset0:112 offset1:113
    ds_read_b64 v[72:73], v6 offset:36864
    ds_read_b64 v[74:75], v6 offset:37376
    buffer_load_dwordx4 a[120:123], v241, s[4:7], s85 offen offset:3072 sc1
    s_waitcnt lgkmcnt(6)
    v_mfma_f32_16x16x32_bf16 v[136:139], v[92:95], v[92:95], v[136:139]
    ds_read_b64 v[96:97], v14 offset:19456
    v_mfma_f32_16x16x32_bf16 v[140:143], v[132:135], v[92:95], v[140:143]
    ds_read_b64 v[98:99], v14 offset:19968
    s_waitcnt vmcnt(8)
    v_mfma_f32_16x16x32_bf16 v[100:103], v[44:47], a[216:219], v[100:103]
    ds_read2st64_b64 v[76:79], v5 offset0:34 offset1:35
    v_mfma_f32_16x16x32_bf16 v[104:107], v[48:51], a[216:219], v[104:107]
    ds_read_b64 v[80:81], v5 offset:37888
    v_mfma_f32_16x16x32_bf16 v[108:111], v[52:55], a[216:219], v[108:111]
    ds_read_b64 v[82:83], v5 offset:38400
    v_mfma_f32_16x16x32_bf16 v[112:115], v[56:59], a[216:219], v[112:115]
    s_add_u32 s85, s85, 4096
    ds_read2st64_b64 v[84:87], v5 offset0:114 offset1:115
    ds_read_b64 v[88:89], v6 offset:37888
    ds_read_b64 v[90:91], v6 offset:38400
    buffer_load_dwordx4 a[128:131], v241, s[4:7], s85 offen offset:0 sc1
    s_waitcnt lgkmcnt(6)
    v_mfma_f32_16x16x32_bf16 v[136:139], v[96:99], v[96:99], v[136:139]
    v_mfma_f32_16x16x32_bf16 v[140:143], v[132:135], v[96:99], v[140:143]
    s_waitcnt vmcnt(8)
    v_mfma_f32_16x16x32_bf16 v[100:103], v[60:63], a[224:227], v[100:103]
    ds_read2st64_b64 v[44:47], v5 offset0:36 offset1:37
    v_mfma_f32_16x16x32_bf16 v[104:107], v[64:67], a[224:227], v[104:107]
    ds_read_b64 v[48:49], v5 offset:38912
    v_mfma_f32_16x16x32_bf16 v[108:111], v[68:71], a[224:227], v[108:111]
    ds_read_b64 v[50:51], v5 offset:39424
    v_mfma_f32_16x16x32_bf16 v[112:115], v[72:75], a[224:227], v[112:115]
    ds_read2st64_b64 v[52:55], v5 offset0:116 offset1:117
    ds_read_b64 v[56:57], v6 offset:38912
    ds_read_b64 v[58:59], v6 offset:39424
    buffer_load_dwordx4 a[136:139], v241, s[4:7], s85 offen offset:1024 sc1
    s_waitcnt vmcnt(8) lgkmcnt(6)
    v_mfma_f32_16x16x32_bf16 v[100:103], v[76:79], a[232:235], v[100:103]
    ds_read2st64_b64 v[60:63], v5 offset0:38 offset1:39
    v_and_b32 v3, 3, v0
    v_mfma_f32_16x16x32_bf16 v[104:107], v[80:83], a[232:235], v[104:107]
    ds_read_b64 v[64:65], v5 offset:39936
    v_cmp_eq_u32 vcc, 1, v3
    v_mfma_f32_16x16x32_bf16 v[108:111], v[84:87], a[232:235], v[108:111]
    ds_read_b64 v[66:67], v5 offset:40448
    v_cndmask_b32 v136, v136, v137, vcc
    v_mfma_f32_16x16x32_bf16 v[112:115], v[88:91], a[232:235], v[112:115]
    ds_read2st64_b64 v[68:71], v5 offset0:118 offset1:119
    v_cmp_eq_u32 vcc, 2, v3
    ds_read_b64 v[72:73], v6 offset:39936
    s_nop 0
    v_cndmask_b32 v136, v136, v138, vcc
    ds_read_b64 v[74:75], v6 offset:40448
    v_cmp_eq_u32 vcc, 3, v3
    buffer_load_dwordx4 a[144:147], v241, s[4:7], s85 offen offset:2048 sc1
    s_nop 0
    v_cndmask_b32 v136, v136, v139, vcc
    v_mul_f32 v140, 0xbacccccd, v140
    v_mul_f32 v136, 0x3acccccd, v136
    v_fma_f32 v136, -v140, v140, v136
    v_max_f32 v136, 0, v136
    v_add_f32 v136, 0x3727c5ac, v136
    v_rsq_f32 v136, v136
    v_lshrrev_b32 v3, 2, v1
    v_cmp_eq_u32 vcc, v3, v2
    s_lshl_b32 s62, s82, 6
    s_add_u32 s62, s62, 81920
    v_lshl_add_u32 v3, v1, 2, s62
    s_mov_b64 exec, vcc
    ds_write2st64_b32 v3, v136, v140 offset0:0 offset1:1
    s_mov_b64 exec, -1
    s_waitcnt vmcnt(8) lgkmcnt(6)
    v_mfma_f32_16x16x32_bf16 v[100:103], v[44:47], a[240:243], v[100:103]
    s_lshl_b32 s62, s82, 7
    s_add_u32 s62, s62, 86528
    v_add_u32 v3, s62, v12
    v_mfma_f32_16x16x32_bf16 v[104:107], v[48:51], a[240:243], v[104:107]
    v_add_u32 v4, s62, v7
    v_mfma_f32_16x16x32_bf16 v[108:111], v[52:55], a[240:243], v[108:111]
    ds_read_b32 v212, v3 offset:1024
    v_mfma_f32_16x16x32_bf16 v[112:115], v[56:59], a[240:243], v[112:115]
    ds_read_b32 v213, v3 offset:1536
    ds_read_b128 v[196:199], v4 offset:0
    ds_read_b128 v[204:207], v4 offset:512
    ds_read_b32 v214, v3 offset:1088
    ds_read_b32 v215, v3 offset:1600
    s_waitcnt vmcnt(7) lgkmcnt(7)
    v_mfma_f32_16x16x32_bf16 v[100:103], v[60:63], a[248:251], v[100:103]
    ds_read_b128 v[200:203], v4 offset:64
    v_mfma_f32_16x16x32_bf16 v[104:107], v[64:67], a[248:251], v[104:107]
    ds_read_b128 v[208:211], v4 offset:576
    v_mfma_f32_16x16x32_bf16 v[108:111], v[68:71], a[248:251], v[108:111]
    v_mfma_f32_16x16x32_bf16 v[112:115], v[72:75], a[248:251], v[112:115]
    buffer_load_dwordx4 a[152:155], v241, s[4:7], s85 offen offset:3072 sc1
    s_waitcnt lgkmcnt(8)
    s_barrier
    v_add_u32 v3, 81920, v7
    ds_read_b128 v[180:183], v3 offset:256
    ds_read_b128 v[164:167], v3 offset:0
    ds_read_b128 v[184:187], v3 offset:320
    ds_read_b128 v[168:171], v3 offset:64
    ds_read_b128 v[188:191], v3 offset:384
    ds_read_b128 v[172:175], v3 offset:128
    ds_read_b128 v[192:195], v3 offset:448
    ds_read_b128 v[176:179], v3 offset:192
    s_waitcnt lgkmcnt(7)
    v_pk_fma_f32 v[100:101], v[180:181], v[212:213], v[100:101] op_sel:[0,0,0] op_sel_hi:[1,0,1]
    v_pk_fma_f32 v[102:103], v[182:183], v[212:213], v[102:103] op_sel:[0,0,0] op_sel_hi:[1,0,1]
    s_add_u32 s85, s85, 4096
    v_pk_fma_f32 v[116:117], v[180:181], v[214:215], v[116:117] op_sel:[0,0,0] op_sel_hi:[1,0,1]
    v_pk_fma_f32 v[118:119], v[182:183], v[214:215], v[118:119] op_sel:[0,0,0] op_sel_hi:[1,0,1]
    s_waitcnt lgkmcnt(6)
    v_pk_fma_f32 v[100:101], v[100:101], v[164:165], v[212:213] op_sel:[0,0,1] op_sel_hi:[1,1,1]
    v_pk_fma_f32 v[102:103], v[102:103], v[166:167], v[212:213] op_sel:[0,0,1] op_sel_hi:[1,1,1]
    v_pk_fma_f32 v[116:117], v[116:117], v[164:165], v[214:215] op_sel:[0,0,1] op_sel_hi:[1,1,1]
    v_pk_fma_f32 v[118:119], v[118:119], v[166:167], v[214:215] op_sel:[0,0,1] op_sel_hi:[1,1,1]
    v_pk_mul_f32 v[216:217], v[100:101], v[100:101]
    v_pk_mul_f32 v[218:219], v[102:103], v[102:103]
    v_pk_mul_f32 v[220:221], v[116:117], v[116:117]
    v_pk_mul_f32 v[222:223], v[118:119], v[118:119]
    v_pk_fma_f32 v[216:217], v[216:217], s[66:67], s[66:67] op_sel:[0,0,1] op_sel_hi:[1,0,1]
    buffer_load_dwordx4 a[160:163], v241, s[4:7], s85 offen offset:0 sc1
    v_pk_fma_f32 v[218:219], v[218:219], s[66:67], s[66:67] op_sel:[0,0,1] op_sel_hi:[1,0,1]
    v_pk_fma_f32 v[220:221], v[220:221], s[66:67], s[66:67] op_sel:[0,0,1] op_sel_hi:[1,0,1]
    v_pk_fma_f32 v[222:223], v[222:223], s[66:67], s[66:67] op_sel:[0,0,1] op_sel_hi:[1,0,1]
    v_pk_mul_f32 v[216:217], v[216:217], v[100:101]
    v_pk_mul_f32 v[218:219], v[218:219], v[102:103]
    v_pk_mul_f32 v[220:221], v[220:221], v[116:117]
    v_pk_mul_f32 v[222:223], v[222:223], v[118:119]
    v_exp_f32 v216, v216
    v_exp_f32 v217, v217
    v_exp_f32 v218, v218
    v_exp_f32 v219, v219
    v_exp_f32 v220, v220
    v_exp_f32 v221, v221
    v_exp_f32 v222, v222
    v_exp_f32 v223, v223
    v_pk_add_f32 v[216:217], v[216:217], s[68:69]
    v_pk_add_f32 v[218:219], v[218:219], s[68:69]
    v_pk_add_f32 v[220:221], v[220:221], s[68:69]
    v_pk_add_f32 v[222:223], v[222:223], s[68:69]
    v_rcp_f32 v216, v216
    v_rcp_f32 v217, v217
    v_rcp_f32 v218, v218
    buffer_load_dwordx4 a[168:171], v241, s[4:7], s85 offen offset:1024 sc1
    v_rcp_f32 v219, v219
    v_rcp_f32 v220, v220
    v_rcp_f32 v221, v221
    v_rcp_f32 v222, v222
    v_rcp_f32 v223, v223
    v_pk_mul_f32 v[100:101], v[100:101], v[216:217]
    v_pk_mul_f32 v[102:103], v[102:103], v[218:219]
    v_pk_mul_f32 v[116:117], v[116:117], v[220:221]
    v_pk_mul_f32 v[118:119], v[118:119], v[222:223]
    v_pk_add_f32 v[164:165], v[100:101], v[116:117]
    v_pk_mul_f32 v[180:181], v[100:101], v[100:101]
    v_pk_add_f32 v[166:167], v[102:103], v[118:119]
    v_pk_mul_f32 v[182:183], v[102:103], v[102:103]
    v_pk_fma_f32 v[180:181], v[116:117], v[116:117], v[180:181]
    v_pk_fma_f32 v[182:183], v[118:119], v[118:119], v[182:183]
    s_waitcnt lgkmcnt(0)
    v_pk_fma_f32 v[104:105], v[184:185], v[212:213], v[104:105] op_sel:[0,0,0] op_sel_hi:[1,0,1]
    v_pk_fma_f32 v[106:107], v[186:187], v[212:213], v[106:107] op_sel:[0,0,0] op_sel_hi:[1,0,1]
    v_pk_fma_f32 v[120:121], v[184:185], v[214:215], v[120:121] op_sel:[0,0,0] op_sel_hi:[1,0,1]
    v_pk_fma_f32 v[122:123], v[186:187], v[214:215], v[122:123] op_sel:[0,0,0] op_sel_hi:[1,0,1]
    v_pk_fma_f32 v[104:105], v[104:105], v[168:169], v[212:213] op_sel:[0,0,1] op_sel_hi:[1,1,1]
    v_pk_fma_f32 v[106:107], v[106:107], v[170:171], v[212:213] op_sel:[0,0,1] op_sel_hi:[1,1,1]
    v_pk_fma_f32 v[120:121], v[120:121], v[168:169], v[214:215] op_sel:[0,0,1] op_sel_hi:[1,1,1]
    buffer_load_dwordx4 a[176:179], v241, s[4:7], s85 offen offset:2048 sc1
    v_pk_fma_f32 v[122:123], v[122:123], v[170:171], v[214:215] op_sel:[0,0,1] op_sel_hi:[1,1,1]
    v_pk_mul_f32 v[216:217], v[104:105], v[104:105]
    v_pk_mul_f32 v[218:219], v[106:107], v[106:107]
    v_pk_mul_f32 v[220:221], v[120:121], v[120:121]
    v_pk_mul_f32 v[222:223], v[122:123], v[122:123]
    v_pk_fma_f32 v[216:217], v[216:217], s[66:67], s[66:67] op_sel:[0,0,1] op_sel_hi:[1,0,1]
    v_pk_fma_f32 v[218:219], v[218:219], s[66:67], s[66:67] op_sel:[0,0,1] op_sel_hi:[1,0,1]
    v_pk_fma_f32 v[220:221], v[220:221], s[66:67], s[66:67] op_sel:[0,0,1] op_sel_hi:[1,0,1]
    v_pk_fma_f32 v[222:223], v[222:223], s[66:67], s[66:67] op_sel:[0,0,1] op_sel_hi:[1,0,1]
    v_pk_mul_f32 v[216:217], v[216:217], v[104:105]
    v_pk_mul_f32 v[218:219], v[218:219], v[106:107]
    v_pk_mul_f32 v[220:221], v[220:221], v[120:121]
    v_pk_mul_f32 v[222:223], v[222:223], v[122:123]
    v_exp_f32 v216, v216
    v_exp_f32 v217, v217
    v_exp_f32 v218, v218
    v_exp_f32 v219, v219
    v_exp_f32 v220, v220
    v_exp_f32 v221, v221
    v_exp_f32 v222, v222
    v_exp_f32 v223, v223
    v_pk_add_f32 v[216:217], v[216:217], s[68:69]
    buffer_load_dwordx4 a[184:187], v241, s[4:7], s85 offen offset:3072 sc1
    v_pk_add_f32 v[218:219], v[218:219], s[68:69]
    v_pk_add_f32 v[220:221], v[220:221], s[68:69]
    v_pk_add_f32 v[222:223], v[222:223], s[68:69]
    v_rcp_f32 v216, v216
    v_rcp_f32 v217, v217
    v_rcp_f32 v218, v218
    v_rcp_f32 v219, v219
    v_rcp_f32 v220, v220
    v_rcp_f32 v221, v221
    v_rcp_f32 v222, v222
    v_rcp_f32 v223, v223
    s_add_u32 s85, s85, 4096
    v_pk_mul_f32 v[104:105], v[104:105], v[216:217]
    v_pk_mul_f32 v[106:107], v[106:107], v[218:219]
    v_pk_mul_f32 v[120:121], v[120:121], v[220:221]
    v_pk_mul_f32 v[122:123], v[122:123], v[222:223]
    v_pk_add_f32 v[168:169], v[104:105], v[120:121]
    v_pk_mul_f32 v[184:185], v[104:105], v[104:105]
    v_pk_add_f32 v[170:171], v[106:107], v[122:123]
    v_pk_mul_f32 v[186:187], v[106:107], v[106:107]
    v_pk_fma_f32 v[184:185], v[120:121], v[120:121], v[184:185]
    v_pk_fma_f32 v[186:187], v[122:123], v[122:123], v[186:187]
    v_pk_fma_f32 v[108:109], v[188:189], v[212:213], v[108:109] op_sel:[0,0,0] op_sel_hi:[1,0,1]
    buffer_load_dwordx4 a[192:195], v241, s[4:7], s85 offen offset:0 sc1
    v_pk_fma_f32 v[110:111], v[190:191], v[212:213], v[110:111] op_sel:[0,0,0] op_sel_hi:[1,0,1]
    v_pk_fma_f32 v[124:125], v[188:189], v[214:215], v[124:125] op_sel:[0,0,0] op_sel_hi:[1,0,1]
    v_pk_fma_f32 v[126:127], v[190:191], v[214:215], v[126:127] op_sel:[0,0,0] op_sel_hi:[1,0,1]
    v_pk_fma_f32 v[108:109], v[108:109], v[172:173], v[212:213] op_sel:[0,0,1] op_sel_hi:[1,1,1]
    v_pk_fma_f32 v[110:111], v[110:111], v[174:175], v[212:213] op_sel:[0,0,1] op_sel_hi:[1,1,1]
    v_pk_fma_f32 v[124:125], v[124:125], v[172:173], v[214:215] op_sel:[0,0,1] op_sel_hi:[1,1,1]
    v_pk_fma_f32 v[126:127], v[126:127], v[174:175], v[214:215] op_sel:[0,0,1] op_sel_hi:[1,1,1]
    v_pk_mul_f32 v[216:217], v[108:109], v[108:109]
    v_pk_mul_f32 v[218:219], v[110:111], v[110:111]
    v_pk_mul_f32 v[220:221], v[124:125], v[124:125]
    v_pk_mul_f32 v[222:223], v[126:127], v[126:127]
    v_pk_fma_f32 v[216:217], v[216:217], s[66:67], s[66:67] op_sel:[0,0,1] op_sel_hi:[1,0,1]
    v_pk_fma_f32 v[218:219], v[218:219], s[66:67], s[66:67] op_sel:[0,0,1] op_sel_hi:[1,0,1]
    v_pk_fma_f32 v[220:221], v[220:221], s[66:67], s[66:67] op_sel:[0,0,1] op_sel_hi:[1,0,1]
    v_pk_fma_f32 v[222:223], v[222:223], s[66:67], s[66:67] op_sel:[0,0,1] op_sel_hi:[1,0,1]
    v_pk_mul_f32 v[216:217], v[216:217], v[108:109]
    v_pk_mul_f32 v[218:219], v[218:219], v[110:111]
    v_pk_mul_f32 v[220:221], v[220:221], v[124:125]
    v_pk_mul_f32 v[222:223], v[222:223], v[126:127]
    v_exp_f32 v216, v216
    v_exp_f32 v217, v217
    v_exp_f32 v218, v218
    buffer_load_dwordx4 a[200:203], v241, s[4:7], s85 offen offset:1024 sc1
    v_exp_f32 v219, v219
    v_exp_f32 v220, v220
    v_exp_f32 v221, v221
    v_exp_f32 v222, v222
    v_exp_f32 v223, v223
    v_pk_add_f32 v[216:217], v[216:217], s[68:69]
    v_pk_add_f32 v[218:219], v[218:219], s[68:69]
    v_pk_add_f32 v[220:221], v[220:221], s[68:69]
    v_pk_add_f32 v[222:223], v[222:223], s[68:69]
    v_rcp_f32 v216, v216
    v_rcp_f32 v217, v217
    v_rcp_f32 v218, v218
    v_rcp_f32 v219, v219
    v_rcp_f32 v220, v220
    v_rcp_f32 v221, v221
    v_rcp_f32 v222, v222
    v_rcp_f32 v223, v223
    v_pk_mul_f32 v[108:109], v[108:109], v[216:217]
    v_pk_mul_f32 v[110:111], v[110:111], v[218:219]
    v_pk_mul_f32 v[124:125], v[124:125], v[220:221]
    v_pk_mul_f32 v[126:127], v[126:127], v[222:223]
    v_pk_add_f32 v[172:173], v[108:109], v[124:125]
    buffer_load_dwordx4 a[208:211], v241, s[4:7], s85 offen offset:2048 sc1
    v_pk_mul_f32 v[188:189], v[108:109], v[108:109]
    v_pk_add_f32 v[174:175], v[110:111], v[126:127]
    v_pk_mul_f32 v[190:191], v[110:111], v[110:111]
    v_pk_fma_f32 v[188:189], v[124:125], v[124:125], v[188:189]
    v_pk_fma_f32 v[190:191], v[126:127], v[126:127], v[190:191]
    v_pk_fma_f32 v[112:113], v[192:193], v[212:213], v[112:113] op_sel:[0,0,0] op_sel_hi:[1,0,1]
    v_pk_fma_f32 v[114:115], v[194:195], v[212:213], v[114:115] op_sel:[0,0,0] op_sel_hi:[1,0,1]
    v_pk_fma_f32 v[128:129], v[192:193], v[214:215], v[128:129] op_sel:[0,0,0] op_sel_hi:[1,0,1]
    v_pk_fma_f32 v[130:131], v[194:195], v[214:215], v[130:131] op_sel:[0,0,0] op_sel_hi:[1,0,1]
    v_pk_fma_f32 v[112:113], v[112:113], v[176:177], v[212:213] op_sel:[0,0,1] op_sel_hi:[1,1,1]
    v_pk_fma_f32 v[114:115], v[114:115], v[178:179], v[212:213] op_sel:[0,0,1] op_sel_hi:[1,1,1]
    v_pk_fma_f32 v[128:129], v[128:129], v[176:177], v[214:215] op_sel:[0,0,1] op_sel_hi:[1,1,1]
    v_pk_fma_f32 v[130:131], v[130:131], v[178:179], v[214:215] op_sel:[0,0,1] op_sel_hi:[1,1,1]
    v_pk_mul_f32 v[216:217], v[112:113], v[112:113]
    v_pk_mul_f32 v[218:219], v[114:115], v[114:115]
    v_pk_mul_f32 v[220:221], v[128:129], v[128:129]
    v_pk_mul_f32 v[222:223], v[130:131], v[130:131]
    v_pk_fma_f32 v[216:217], v[216:217], s[66:67], s[66:67] op_sel:[0,0,1] op_sel_hi:[1,0,1]
    v_pk_fma_f32 v[218:219], v[218:219], s[66:67], s[66:67] op_sel:[0,0,1] op_sel_hi:[1,0,1]
    v_pk_fma_f32 v[220:221], v[220:221], s[66:67], s[66:67] op_sel:[0,0,1] op_sel_hi:[1,0,1]
    v_pk_fma_f32 v[222:223], v[222:223], s[66:67], s[66:67] op_sel:[0,0,1] op_sel_hi:[1,0,1]
    v_pk_mul_f32 v[216:217], v[216:217], v[112:113]
    buffer_load_dwordx4 a[216:219], v241, s[4:7], s85 offen offset:3072 sc1
    v_pk_mul_f32 v[218:219], v[218:219], v[114:115]
    v_pk_mul_f32 v[220:221], v[220:221], v[128:129]
    v_pk_mul_f32 v[222:223], v[222:223], v[130:131]
    v_exp_f32 v216, v216
    v_exp_f32 v217, v217
    v_exp_f32 v218, v218
    v_exp_f32 v219, v219
    v_exp_f32 v220, v220
    v_exp_f32 v221, v221
    v_exp_f32 v222, v222
    v_exp_f32 v223, v223
    s_add_u32 s85, s85, 4096
    v_pk_add_f32 v[216:217], v[216:217], s[68:69]
    v_pk_add_f32 v[218:219], v[218:219], s[68:69]
    v_pk_add_f32 v[220:221], v[220:221], s[68:69]
    v_pk_add_f32 v[222:223], v[222:223], s[68:69]
    v_rcp_f32 v216, v216
    v_rcp_f32 v217, v217
    v_rcp_f32 v218, v218
    v_rcp_f32 v219, v219
    v_rcp_f32 v220, v220
    v_rcp_f32 v221, v221
    v_rcp_f32 v222, v222
    buffer_load_dwordx4 a[224:227], v241, s[4:7], s85 offen offset:0 sc1
    v_rcp_f32 v223, v223
    v_pk_mul_f32 v[112:113], v[112:113], v[216:217]
    v_pk_mul_f32 v[114:115], v[114:115], v[218:219]
    v_pk_mul_f32 v[128:129], v[128:129], v[220:221]
    v_pk_mul_f32 v[130:131], v[130:131], v[222:223]
    v_pk_add_f32 v[176:177], v[112:113], v[128:129]
    v_pk_mul_f32 v[192:193], v[112:113], v[112:113]
    v_pk_add_f32 v[178:179], v[114:115], v[130:131]
    v_pk_mul_f32 v[194:195], v[114:115], v[114:115]
    v_pk_fma_f32 v[192:193], v[128:129], v[128:129], v[192:193]
    v_pk_fma_f32 v[194:195], v[130:131], v[130:131], v[194:195]
    v_add_f32_dpp v164, v164, v164 row_ror:8 row_mask:0xf bank_mask:3
    v_add_f32_dpp v165, v165, v165 row_ror:8 row_mask:0xf bank_mask:3
    v_add_f32_dpp v166, v166, v166 row_ror:8 row_mask:0xf bank_mask:3
    v_add_f32_dpp v167, v167, v167 row_ror:8 row_mask:0xf bank_mask:3
    v_add_f32_dpp v168, v168, v168 row_ror:8 row_mask:0xf bank_mask:3
    v_add_f32_dpp v169, v169, v169 row_ror:8 row_mask:0xf bank_mask:3
    v_add_f32_dpp v170, v170, v170 row_ror:8 row_mask:0xf bank_mask:3
    v_add_f32_dpp v171, v171, v171 row_ror:8 row_mask:0xf bank_mask:3
    v_add_f32_dpp v172, v172, v172 row_ror:8 row_mask:0xf bank_mask:3
    v_add_f32_dpp v173, v173, v173 row_ror:8 row_mask:0xf bank_mask:3
    v_add_f32_dpp v174, v174, v174 row_ror:8 row_mask:0xf bank_mask:3
    buffer_load_dwordx4 a[232:235], v241, s[4:7], s85 offen offset:1024 sc1
    v_add_f32_dpp v175, v175, v175 row_ror:8 row_mask:0xf bank_mask:3
    v_add_f32_dpp v176, v176, v176 row_ror:8 row_mask:0xf bank_mask:3
    v_add_f32_dpp v177, v177, v177 row_ror:8 row_mask:0xf bank_mask:3
    v_add_f32_dpp v178, v178, v178 row_ror:8 row_mask:0xf bank_mask:3
    v_add_f32_dpp v179, v179, v179 row_ror:8 row_mask:0xf bank_mask:3
    v_add_f32_dpp v164, v180, v180 row_ror:8 row_mask:0xf bank_mask:12
    v_add_f32_dpp v165, v181, v181 row_ror:8 row_mask:0xf bank_mask:12
    v_add_f32_dpp v166, v182, v182 row_ror:8 row_mask:0xf bank_mask:12
    v_add_f32_dpp v167, v183, v183 row_ror:8 row_mask:0xf bank_mask:12
    v_add_f32_dpp v168, v184, v184 row_ror:8 row_mask:0xf bank_mask:12
    v_add_f32_dpp v169, v185, v185 row_ror:8 row_mask:0xf bank_mask:12
    v_add_f32_dpp v170, v186, v186 row_ror:8 row_mask:0xf bank_mask:12
    v_add_f32_dpp v171, v187, v187 row_ror:8 row_mask:0xf bank_mask:12
    v_add_f32_dpp v172, v188, v188 row_ror:8 row_mask:0xf bank_mask:12
    v_add_f32_dpp v173, v189, v189 row_ror:8 row_mask:0xf bank_mask:12
    v_add_f32_dpp v174, v190, v190 row_ror:8 row_mask:0xf bank_mask:12
    v_add_f32_dpp v175, v191, v191 row_ror:8 row_mask:0xf bank_mask:12
    v_add_f32_dpp v176, v192, v192 row_ror:8 row_mask:0xf bank_mask:12
    v_add_f32_dpp v177, v193, v193 row_ror:8 row_mask:0xf bank_mask:12
    v_add_f32_dpp v178, v194, v194 row_ror:8 row_mask:0xf bank_mask:12
    v_add_f32_dpp v179, v195, v195 row_ror:8 row_mask:0xf bank_mask:12
    v_add_f32_dpp v164, v164, v164 row_half_mirror row_mask:0xf bank_mask:5
    buffer_load_dwordx4 a[240:243], v241, s[4:7], s85 offen offset:2048 sc1
    v_add_f32_dpp v165, v165, v165 row_half_mirror row_mask:0xf bank_mask:5
    v_add_f32_dpp v166, v166, v166 row_half_mirror row_mask:0xf bank_mask:5
    v_add_f32_dpp v167, v167, v167 row_half_mirror row_mask:0xf bank_mask:5
    v_add_f32_dpp v168, v168, v168 row_half_mirror row_mask:0xf bank_mask:5
    v_add_f32_dpp v169, v169, v169 row_half_mirror row_mask:0xf bank_mask:5
    v_add_f32_dpp v170, v170, v170 row_half_mirror row_mask:0xf bank_mask:5
    v_add_f32_dpp v171, v171, v171 row_half_mirror row_mask:0xf bank_mask:5
    v_add_f32_dpp v164, v172, v172 row_half_mirror row_mask:0xf bank_mask:10
    v_add_f32_dpp v165, v173, v173 row_half_mirror row_mask:0xf bank_mask:10
    v_add_f32_dpp v166, v174, v174 row_half_mirror row_mask:0xf bank_mask:10
    v_add_f32_dpp v167, v175, v175 row_half_mirror row_mask:0xf bank_mask:10
    v_add_f32_dpp v168, v176, v176 row_half_mirror row_mask:0xf bank_mask:10
    v_add_f32_dpp v169, v177, v177 row_half_mirror row_mask:0xf bank_mask:10
    v_add_f32_dpp v170, v178, v178 row_half_mirror row_mask:0xf bank_mask:10
    v_add_f32_dpp v171, v179, v179 row_half_mirror row_mask:0xf bank_mask:10
    v_add_f32_dpp v164, v164, v164 quad_perm:[1,0,3,2] row_mask:0xf bank_mask:0xf
    v_add_f32_dpp v165, v165, v165 quad_perm:[1,0,3,2] row_mask:0xf bank_mask:0xf
    v_add_f32_dpp v166, v166, v166 quad_perm:[1,0,3,2] row_mask:0xf bank_mask:0xf
    v_add_f32_dpp v167, v167, v167 quad_perm:[1,0,3,2] row_mask:0xf bank_mask:0xf
    v_add_f32_dpp v168, v168, v168 quad_perm:[1,0,3,2] row_mask:0xf bank_mask:0xf
    v_add_f32_dpp v169, v169, v169 quad_perm:[1,0,3,2] row_mask:0xf bank_mask:0xf
    v_add_f32_dpp v170, v170, v170 quad_perm:[1,0,3,2] row_mask:0xf bank_mask:0xf
    buffer_load_dwordx4 a[248:251], v241, s[4:7], s85 offen offset:3072 sc1
    v_add_f32_dpp v171, v171, v171 quad_perm:[1,0,3,2] row_mask:0xf bank_mask:0xf
    v_add_f32_dpp v164, v164, v164 quad_perm:[2,3,0,1] row_mask:0xf bank_mask:0xf
    v_add_f32_dpp v165, v165, v165 quad_perm:[2,3,0,1] row_mask:0xf bank_mask:0xf
    v_add_f32_dpp v166, v166, v166 quad_perm:[2,3,0,1] row_mask:0xf bank_mask:0xf
    v_add_f32_dpp v167, v167, v167 quad_perm:[2,3,0,1] row_mask:0xf bank_mask:0xf
    v_add_f32_dpp v168, v168, v168 quad_perm:[2,3,0,1] row_mask:0xf bank_mask:0xf
    v_add_f32_dpp v169, v169, v169 quad_perm:[2,3,0,1] row_mask:0xf bank_mask:0xf
    v_add_f32_dpp v170, v170, v170 quad_perm:[2,3,0,1] row_mask:0xf bank_mask:0xf
    v_add_f32_dpp v171, v171, v171 quad_perm:[2,3,0,1] row_mask:0xf bank_mask:0xf
    v_bfe_u32 v3, v0, 2, 2
    v_lshl_add_u32 v3, v3, 7, v7
    s_lshl_b32 s62, s82, 9
    s_add_u32 s64, s62, 82432
    v_add_u32 v3, s64, v3
    ds_write_b128 v3, v[164:167]
    ds_write_b128 v3, v[168:171] offset:64
    s_lshl_b32 s55, s83, 13
    s_add_u32 s55, s55, 524288
    s_waitcnt lgkmcnt(0)
    s_barrier
    s_cmp_lg_u32 s82, 3
    s_cbranch_scc1 L_adaL_nopub_18_w3
    v_lshlrev_b32 v3, 2, v240
    v_add_u32 v3, 82432, v3
    ds_read2st64_b32 v[216:217], v3 offset0:0 offset1:1
    ds_read2st64_b32 v[218:219], v3 offset0:2 offset1:3
    ds_read2st64_b32 v[220:221], v3 offset0:4 offset1:5
    ds_read2st64_b32 v[222:223], v3 offset0:6 offset1:7
    s_lshl_b32 s64, s84, 10
    s_add_u32 s64, s64, s55
    s_waitcnt lgkmcnt(2)
    v_pk_add_f32 v[216:217], v[216:217], v[218:219]
    s_waitcnt lgkmcnt(0)
    v_pk_add_f32 v[220:221], v[220:221], v[222:223]
    v_pk_add_f32 v[216:217], v[216:217], v[220:221]
    v_mov_b32 v219, v13
    v_mov_b32 v218, v217
    v_mov_b32 v217, v13
    buffer_store_dwordx4 v[216:219], v241, s[4:7], s64 offen sc1
L_adaL_nopub_18_w3:
    ds_read_b64 v[44:45], v5 offset:0
    ds_read_b64 v[46:47], v5 offset:512
    ds_read_b64 v[48:49], v5 offset:20480
    ds_read_b64 v[50:51], v5 offset:20992
    ds_read_b64 v[52:53], v6 offset:0
    ds_read_b64 v[54:55], v6 offset:512
    ds_read_b64 v[56:57], v6 offset:20480
    ds_read_b64 v[58:59], v6 offset:20992
    ds_read_b64 v[60:61], v5 offset:1024
    ds_read_b64 v[62:63], v5 offset:1536
    ds_read_b64 v[64:65], v5 offset:21504
    ds_read_b64 v[66:67], v5 offset:22016
    ds_read_b64 v[68:69], v6 offset:1024
    ds_read_b64 v[70:71], v6 offset:1536
    ds_read_b64 v[72:73], v6 offset:21504
    ds_read_b64 v[74:75], v6 offset:22016
    s_waitcnt vmcnt(17) lgkmcnt(8)
    v_mfma_f32_16x16x32_bf16 v[132:135], a[96:99], v[44:47], 0
    ds_read2st64_b64 v[76:79], v5 offset0:4 offset1:5
    s_lshl_b32 s64, s82, 8
    v_mfma_f32_16x16x32_bf16 v[136:139], a[96:99], v[48:51], 0
    ds_read_b64 v[80:81], v5 offset:22528
    s_add_u32 s55, s55, s64
    v_mfma_f32_16x16x32_bf16 v[140:143], a[96:99], v[52:55], 0
    ds_read_b64 v[82:83], v5 offset:23040
    v_lshlrev_b32 v172, 4, v1
    v_mfma_f32_16x16x32_bf16 v[144:147], a[96:99], v[56:59], 0
    s_add_u32 s85, s85, 4096
    v_mov_b32 v148, 0
    v_mov_b32 v149, 0
    v_mov_b32 v150, 0
    v_mov_b32 v151, 0
    ds_read2st64_b64 v[84:87], v5 offset0:84 offset1:85
    v_lshl_add_u32 v172, v2, 11, v172
    v_mov_b32 v152, 0
    v_mov_b32 v153, 0
    v_mov_b32 v154, 0
    v_mov_b32 v155, 0
    ds_read_b64 v[88:89], v6 offset:22528
    v_lshlrev_b32 v92, 1, v7
    v_mov_b32 v156, 0
    v_mov_b32 v157, 0
    v_mov_b32 v158, 0
    v_mov_b32 v159, 0
    ds_read_b64 v[90:91], v6 offset:23040
    v_add_u32 v92, 88576, v92
    v_mov_b32 v160, 0
    v_mov_b32 v161, 0
    v_mov_b32 v162, 0
    v_mov_b32 v163, 0
    v_add_u32 v93, 88832, v7
    s_waitcnt lgkmcnt(3)
    v_mfma_f32_16x16x32_bf16 v[132:135], a[104:107], v[60:63], v[132:135]
    ds_read_b64 v[44:45], v5 offset:3072
    s_add_u32 m0, s54, 0
    v_mfma_f32_16x16x32_bf16 v[136:139], a[104:107], v[64:67], v[136:139]
    ds_read_b64 v[46:47], v5 offset:3584
    ds_read_b128 v[176:179], v92 offset:0
    v_mfma_f32_16x16x32_bf16 v[140:143], a[104:107], v[68:71], v[140:143]
    ds_read_b64 v[48:49], v5 offset:23552
    v_mfma_f32_16x16x32_bf16 v[144:147], a[104:107], v[72:75], v[144:147]
    ds_read_b64 v[50:51], v5 offset:24064
    ds_read_b128 v[180:183], v92 offset:16
    ds_read_b64 v[52:53], v6 offset:3072
    ds_read_b64 v[54:55], v6 offset:3584
    ds_read_b128 v[184:187], v92 offset:128
    ds_read_b64 v[56:57], v6 offset:23552
    ds_read_b64 v[58:59], v6 offset:24064
    ds_read_b128 v[188:191], v92 offset:144
    s_waitcnt lgkmcnt(12)
    v_mfma_f32_16x16x32_bf16 v[132:135], a[112:115], v[76:79], v[132:135]
    ds_read_b64 v[60:61], v5 offset:4096
    v_mfma_f32_16x16x32_bf16 v[136:139], a[112:115], v[80:83], v[136:139]
    ds_read_b64 v[62:63], v5 offset:4608
    ds_read_b128 v[192:195], v93
    v_mfma_f32_16x16x32_bf16 v[140:143], a[112:115], v[84:87], v[140:143]
    ds_read_b64 v[64:65], v5 offset:24576
    s_mov_b32 s57, 0x07060302
    v_mfma_f32_16x16x32_bf16 v[144:147], a[112:115], v[88:91], v[144:147]
    ds_read_b64 v[66:67], v5 offset:25088
    buffer_load_dwordx4 v245, s[32:35], s88 offen lds
    ds_read_b64 v[68:69], v6 offset:4096
    s_add_u32 m0, s54, 1024
    ds_read_b64 v[70:71], v6 offset:4608
    buffer_load_dwordx4 v246, s[32:35], s88 offen lds
    ds_read_b64 v[72:73], v6 offset:24576
    s_add_u32 m0, s54, 2048
    ds_read_b64 v[74:75], v6 offset:25088
    buffer_load_dwordx4 v245, s[32:35], s89 offen lds
    s_waitcnt vmcnt(17) lgkmcnt(10)
    v_mfma_f32_16x16x32_bf16 v[132:135], a[120:123], v[44:47], v[132:135]
    ds_read_b64 v[76:77], v5 offset:5120
    s_add_u32 m0, s54, 3072
    v_mfma_f32_16x16x32_bf16 v[136:139], a[120:123], v[48:51], v[136:139]
    ds_read_b64 v[78:79], v5 offset:5632
    buffer_load_dwordx4 v246, s[32:35], s89 offen lds
    v_mfma_f32_16x16x32_bf16 v[140:143], a[120:123], v[52:55], v[140:143]
    ds_read_b64 v[80:81], v5 offset:25600
    s_add_u32 m0, s54, 4096
    v_mfma_f32_16x16x32_bf16 v[144:147], a[120:123], v[56:59], v[144:147]
    ds_read_b64 v[82:83], v5 offset:26112
    buffer_load_dwordx4 v245, s[32:35], s90 offen lds
    ds_read_b64 v[84:85], v6 offset:5120
    s_add_u32 m0, s54, 5120
    ds_read_b64 v[86:87], v6 offset:5632
    buffer_load_dwordx4 v246, s[32:35], s90 offen lds
    ds_read_b64 v[88:89], v6 offset:25600
    s_add_u32 m0, s54, 6144
    ds_read_b64 v[90:91], v6 offset:26112
    buffer_load_dwordx4 v245, s[32:35], s91 offen lds
    s_waitcnt lgkmcnt(8)
    v_mfma_f32_16x16x32_bf16 v[132:135], a[128:131], v[60:63], v[132:135]
    ds_read_b64 v[44:45], v5 offset:6144
    s_add_u32 m0, s54, 7168
    v_mfma_f32_16x16x32_bf16 v[136:139], a[128:131], v[64:67], v[136:139]
    ds_read_b64 v[46:47], v5 offset:6656
    buffer_load_dwordx4 v246, s[32:35], s91 offen lds
    v_mfma_f32_16x16x32_bf16 v[140:143], a[128:131], v[68:71], v[140:143]
    ds_read_b64 v[48:49], v5 offset:26624
    v_add_u32 v247, 128, v245
    v_mfma_f32_16x16x32_bf16 v[144:147], a[128:131], v[72:75], v[144:147]
    ds_read_b64 v[50:51], v5 offset:27136
    v_bfi_b32 v245, s40, v247, v245
    v_bfi_b32 v246, s40, v247, v246
    ds_read_b64 v[52:53], v6 offset:6144
    s_add_u32 m0, s54, 8192
    ds_read_b64 v[54:55], v6 offset:6656
    buffer_load_dwordx4 v245, s[32:35], s88 offen lds
    ds_read_b64 v[56:57], v6 offset:26624
    s_add_u32 m0, s54, 9216
    ds_read_b64 v[58:59], v6 offset:27136
    buffer_load_dwordx4 v246, s[32:35], s88 offen lds
    s_waitcnt lgkmcnt(8)
    v_mfma_f32_16x16x32_bf16 v[132:135], a[136:139], v[76:79], v[132:135]
    ds_read_b64 v[60:61], v5 offset:7168
    s_add_u32 m0, s54, 10240
    v_mfma_f32_16x16x32_bf16 v[136:139], a[136:139], v[80:83], v[136:139]
    ds_read_b64 v[62:63], v5 offset:7680
    buffer_load_dwordx4 v245, s[32:35], s89 offen lds
    v_mfma_f32_16x16x32_bf16 v[140:143], a[136:139], v[84:87], v[140:143]
    ds_read_b64 v[64:65], v5 offset:27648
    s_add_u32 m0, s54, 11264
    v_mfma_f32_16x16x32_bf16 v[144:147], a[136:139], v[88:91], v[144:147]
    ds_read_b64 v[66:67], v5 offset:28160
    buffer_load_dwordx4 v246, s[32:35], s89 offen lds
    ds_read_b64 v[68:69], v6 offset:7168
    s_add_u32 m0, s54, 12288
    ds_read_b64 v[70:71], v6 offset:7680
    buffer_load_dwordx4 v245, s[32:35], s90 offen lds
    ds_read_b64 v[72:73], v6 offset:27648
    s_add_u32 m0, s54, 13312
    ds_read_b64 v[74:75], v6 offset:28160
    buffer_load_dwordx4 v246, s[32:35], s90 offen lds
    s_waitcnt vmcnt(27) lgkmcnt(8)
    v_mfma_f32_16x16x32_bf16 v[132:135], a[144:147], v[44:47], v[132:135]
    ds_read_b64 v[76:77], v5 offset:8192
    s_waitcnt vmcnt(12)
    v_mfma_f32_16x16x32_bf16 v[136:139], a[144:147], v[48:51], v[136:139]
    ds_read_b64 v[78:79], v5 offset:8704
    ds_read_b128 a[0:3], v10 offset:0
    v_mfma_f32_16x16x32_bf16 v[140:143], a[144:147], v[52:55], v[140:143]
    ds_read_b64 v[80:81], v5 offset:28672
    v_perm_b32 v230, v177, v176, s57
    v_mfma_f32_16x16x32_bf16 v[144:147], a[144:147], v[56:59], v[144:147]
    ds_read_b64 v[82:83], v5 offset:29184
    ds_read_b128 a[4:7], v11 offset:0
    ds_read_b64 v[84:85], v6 offset:8192
    s_waitcnt vmcnt(10) lgkmcnt(13)
    ds_read_b64 v[86:87], v6 offset:8704
    ds_read_b128 a[8:11], v10 offset:2048
    ds_read_b64 v[88:89], v6 offset:28672
    v_perm_b32 v231, v179, v178, s57
    ds_read_b64 v[90:91], v6 offset:29184
    ds_read_b128 a[12:15], v11 offset:2048
    s_waitcnt lgkmcnt(12)
    v_mfma_f32_16x16x32_bf16 v[132:135], a[152:155], v[60:63], v[132:135]
    ds_read_b64 v[44:45], v5 offset:9216
    s_waitcnt lgkmcnt(7)
    v_mfma_f32_16x16x32_bf16 v[136:139], a[152:155], v[64:67], v[136:139]
    ds_read_b64 v[46:47], v5 offset:9728
    s_add_u32 m0, s54, 0
    v_mfma_f32_16x16x32_bf16 v[140:143], a[152:155], v[68:71], v[140:143]
    ds_read_b64 v[48:49], v5 offset:29696
    v_perm_b32 v232, v181, v180, s57
    v_mfma_f32_16x16x32_bf16 v[144:147], a[152:155], v[72:75], v[144:147]
    ds_read_b64 v[50:51], v5 offset:30208
    buffer_load_dwordx4 v245, s[32:35], s91 offen lds
    ds_read_b64 v[52:53], v6 offset:9216
    s_add_u32 m0, s54, 1024
    ds_read_b64 v[54:55], v6 offset:9728
    buffer_load_dwordx4 v246, s[32:35], s91 offen lds
    ds_read_b64 v[56:57], v6 offset:29696
    v_add_u32 v247, 128, v245
    ds_read_b64 v[58:59], v6 offset:30208
    v_bfi_b32 v245, s40, v247, v245
    v_bfi_b32 v246, s40, v247, v246
    s_waitcnt lgkmcnt(9)
    v_mfma_f32_16x16x32_bf16 v[132:135], a[160:163], v[76:79], v[132:135]
    ds_read_b64 v[60:61], v5 offset:10240
    v_perm_b32 v233, v183, v182, s57
    v_mfma_f32_16x16x32_bf16 v[136:139], a[160:163], v[80:83], v[136:139]
    ds_read_b64 v[62:63], v5 offset:10752
    buffer_load_dwordx4 v[164:167], v172, s[4:7], s55 offen offset:0 sc1
    v_mfma_f32_16x16x32_bf16 v[140:143], a[160:163], v[84:87], v[140:143]
    ds_read_b64 v[64:65], v5 offset:30720
    v_perm_b32 v234, v185, v184, s57
    v_mfma_f32_16x16x32_bf16 v[144:147], a[160:163], v[88:91], v[144:147]
    ds_read_b64 v[66:67], v5 offset:31232
    buffer_load_dwordx4 v[168:171], v172, s[4:7], s55 offen offset:1024 sc1
    ds_read_b64 v[68:69], v6 offset:10240
    s_waitcnt vmcnt(12) lgkmcnt(10)
    ds_read_b64 v[70:71], v6 offset:10752
    ds_read_b128 a[16:19], v10 offset:4096
    ds_read_b64 v[72:73], v6 offset:30720
    v_perm_b32 v235, v187, v186, s57
    ds_read_b64 v[74:75], v6 offset:31232
    ds_read_b128 a[20:23], v11 offset:4096
    s_waitcnt lgkmcnt(10)
    v_mfma_f32_16x16x32_bf16 v[132:135], a[168:171], v[44:47], v[132:135]
    ds_read_b64 v[76:77], v5 offset:11264
    v_mfma_f32_16x16x32_bf16 v[136:139], a[168:171], v[48:51], v[136:139]
    ds_read_b64 v[78:79], v5 offset:11776
    s_add_u32 m0, s54, 2048
    v_mfma_f32_16x16x32_bf16 v[140:143], a[168:171], v[52:55], v[140:143]
    ds_read_b64 v[80:81], v5 offset:31744
    v_perm_b32 v236, v189, v188, s57
    v_mfma_f32_16x16x32_bf16 v[144:147], a[168:171], v[56:59], v[144:147]
    ds_read_b64 v[82:83], v5 offset:32256
    buffer_load_dwordx4 v245, s[32:35], s88 offen lds
    ds_read_b64 v[84:85], v6 offset:11264
    s_add_u32 m0, s54, 3072
    ds_read_b64 v[86:87], v6 offset:11776
    buffer_load_dwordx4 v246, s[32:35], s88 offen lds
    ds_read_b64 v[88:89], v6 offset:31744
    s_waitcnt vmcnt(12) lgkmcnt(15)
    ds_read_b64 v[90:91], v6 offset:32256
    ds_read_b128 a[24:27], v10 offset:6144
    s_waitcnt lgkmcnt(10)
    v_mfma_f32_16x16x32_bf16 v[132:135], a[176:179], v[60:63], v[132:135]
    ds_read_b64 v[44:45], v5 offset:12288
    v_perm_b32 v237, v191, v190, s57
    v_mfma_f32_16x16x32_bf16 v[136:139], a[176:179], v[64:67], v[136:139]
    ds_read_b64 v[46:47], v5 offset:12800
    ds_read_b128 a[28:31], v11 offset:6144
    v_mfma_f32_16x16x32_bf16 v[140:143], a[176:179], v[68:71], v[140:143]
    ds_read_b64 v[48:49], v5 offset:32768
    s_waitcnt lgkmcnt(12)
    v_mfma_f32_16x16x32_bf16 v[144:147], a[176:179], v[72:75], v[144:147]
    ds_read_b64 v[50:51], v5 offset:33280
    s_add_u32 m0, s54, 4096
    ds_read_b64 v[52:53], v6 offset:12288
    v_perm_b32 v238, v193, v192, s57
    ds_read_b64 v[54:55], v6 offset:12800
    buffer_load_dwordx4 v245, s[32:35], s89 offen lds
    ds_read_b64 v[56:57], v6 offset:32768
    s_add_u32 m0, s54, 5120
    ds_read_b64 v[58:59], v6 offset:33280
    buffer_load_dwordx4 v246, s[32:35], s89 offen lds
    s_waitcnt lgkmcnt(10)
    v_mfma_f32_16x16x32_bf16 v[132:135], a[184:187], v[76:79], v[132:135]
    ds_read_b64 v[60:61], v5 offset:13312
    s_waitcnt vmcnt(12)
    v_mfma_f32_16x16x32_bf16 v[136:139], a[184:187], v[80:83], v[136:139]
    ds_read_b64 v[62:63], v5 offset:13824
    ds_read_b128 a[32:35], v10 offset:8192
    v_mfma_f32_16x16x32_bf16 v[140:143], a[184:187], v[84:87], v[140:143]
    ds_read_b64 v[64:65], v5 offset:33792
    v_perm_b32 v239, v195, v194, s57
    v_mfma_f32_16x16x32_bf16 v[144:147], a[184:187], v[88:91], v[144:147]
    ds_read_b64 v[66:67], v5 offset:34304
    ds_read_b128 a[36:39], v11 offset:8192
    ds_read_b64 v[68:69], v6 offset:13312
    s_waitcnt lgkmcnt(13)
    ds_read_b64 v[70:71], v6 offset:13824
    s_add_u32 m0, s54, 6144
    ds_read_b64 v[72:73], v6 offset:33792
    ds_read_b64 v[74:75], v6 offset:34304
    buffer_load_dwordx4 v245, s[32:35], s90 offen lds
    s_waitcnt lgkmcnt(10)
    v_mfma_f32_16x16x32_bf16 v[132:135], a[192:195], v[44:47], v[132:135]
    ds_read_b64 v[76:77], v5 offset:14336
    s_add_u32 m0, s54, 7168
    v_mfma_f32_16x16x32_bf16 v[136:139], a[192:195], v[48:51], v[136:139]
    ds_read_b64 v[78:79], v5 offset:14848
    buffer_load_dwordx4 v246, s[32:35], s90 offen lds
    v_mfma_f32_16x16x32_bf16 v[140:143], a[192:195], v[52:55], v[140:143]
    ds_read_b64 v[80:81], v5 offset:34816
    s_waitcnt vmcnt(12) lgkmcnt(12)
    v_mfma_f32_16x16x32_bf16 v[144:147], a[192:195], v[56:59], v[144:147]
    ds_read_b64 v[82:83], v5 offset:35328
    ds_read_b128 a[40:43], v10 offset:10240
    ds_read_b64 v[84:85], v6 offset:14336
    ds_read_b64 v[86:87], v6 offset:14848
    ds_read_b128 a[44:47], v11 offset:10240
    ds_read_b64 v[88:89], v6 offset:34816
    s_waitcnt lgkmcnt(13)
    ds_read_b64 v[90:91], v6 offset:35328
    s_add_u32 m0, s54, 8192
    s_nop 0
    buffer_load_dwordx4 v245, s[32:35], s91 offen lds
    s_mov_b32 s49, 65536
L_adaL_poll_19_w3:
    s_waitcnt vmcnt(8)
    v_min3_u32 v3, v165, v167, v13
    s_waitcnt vmcnt(7)
    v_min3_u32 v3, v3, v169, v171
    v_max3_u32 v4, v165, v167, v13
    v_max3_u32 v4, v4, v169, v171
    v_cmp_ne_u32 vcc, v3, v4
    s_nop 0
    s_cbranch_vccz L_adaL_got_20_w3
    buffer_load_dwordx4 v[164:167], v172, s[4:7], s55 offen offset:0 sc1
    buffer_load_dwordx4 v[168:171], v172, s[4:7], s55 offen offset:1024 sc1
    s_waitcnt vmcnt(0)
    s_sub_u32 s49, s49, 1
    s_cmp_lg_u32 s49, 0
    s_cbranch_scc1 L_adaL_poll_19_w3
L_adaL_got_20_w3:
    v_add_f32 v164, v164, v168
    v_add_f32 v166, v166, v170
    v_mov_b32 v165, v164
    v_mov_b32 v167, v166
    s_nop 0
    v_permlane16_swap_b32 v164, v165
    s_add_u32 m0, s54, 9216
    s_nop 0
    buffer_load_dwordx4 v246, s[32:35], s91 offen lds
    v_add_u32 v247, 128, v245
    v_bfi_b32 v245, s40, v247, v245
    v_bfi_b32 v246, s40, v247, v246
    v_permlane16_swap_b32 v166, v167
    v_add_f32 v164, v164, v165
    v_add_f32 v166, v166, v167
    v_mov_b32 v165, v164
    v_mov_b32 v167, v166
    ds_read_b128 a[48:51], v10 offset:12288
    ds_read_b128 a[52:55], v11 offset:12288
    s_waitcnt lgkmcnt(4)
    s_add_u32 m0, s54, 10240
    s_nop 0
    buffer_load_dwordx4 v245, s[32:35], s88 offen lds
    v_permlane32_swap_b32 v164, v165
    v_permlane32_swap_b32 v166, v167
    v_add_f32 v164, v164, v165
    v_add_f32 v166, v166, v167
    v_mul_f32 v216, 0xba97b426, v164
    s_add_u32 m0, s54, 11264
    s_nop 0
    buffer_load_dwordx4 v246, s[32:35], s88 offen lds
    v_mul_f32 v217, 0x3a97b426, v166
    v_fma_f32 v217, -v216, v216, v217
    v_max_f32 v217, 0, v217
    v_add_f32 v217, 0x3727c5ac, v217
    v_rsq_f32 v217, v217
    ds_read_b128 a[56:59], v10 offset:0
    ds_read_b128 a[60:63], v11 offset:0
    s_waitcnt lgkmcnt(2)
    s_add_u32 m0, s54, 12288
    s_nop 0
    buffer_load_dwordx4 v245, s[32:35], s89 offen lds
    s_lshl_b32 s64, s82, 6
    s_add_u32 s64, s64, 84480
    v_add_u32 v3, s64, v12
    v_mul_f32 v216, v216, v217
    ds_write2st64_b32 v3, v217, v216 offset0:0 offset1:1
    v_add_u32 v3, 84480, v7
    s_waitcnt lgkmcnt(0)
    s_barrier
    ds_read_b128 v[164:167], v3 offset:0
    s_add_u32 m0, s54, 13312
    s_nop 0
    buffer_load_dwordx4 v246, s[32:35], s89 offen lds
    ds_read_b128 v[180:183], v3 offset:256
    ds_read_b128 v[168:171], v3 offset:64
    ds_read_b128 v[184:187], v3 offset:320
    ds_read_b128 v[172:175], v3 offset:128
    ds_read_b128 v[188:191], v3 offset:384
    s_waitcnt vmcnt(10)
    ds_read_b128 a[64:67], v10 offset:2048
    ds_read_b128 a[68:71], v11 offset:2048
    s_add_u32 m0, s54, 0
    s_nop 0
    buffer_load_dwordx4 v245, s[32:35], s90 offen lds
    ds_read_b128 v[176:179], v3 offset:192
    ds_read_b128 v[192:195], v3 offset:448
    s_mul_i32 s56, s84, 458752
    s_add_u32 s56, s56, 12582912
    s_lshl_b32 s64, s82, 17
    s_add_u32 s64, s64, s56
    s_lshl_b32 s65, s83, 11
    s_add_u32 s64, s64, s65
    v_add_u32 v4, 45056, v242
    s_waitcnt lgkmcnt(8)
    v_pk_fma_f32 v[100:101], v[100:101], v[164:165], v[180:181]
    v_pk_fma_f32 v[102:103], v[102:103], v[166:167], v[182:183]
    s_add_u32 m0, s54, 1024
    s_nop 0
    buffer_load_dwordx4 v246, s[32:35], s90 offen lds
    s_waitcnt lgkmcnt(6)
    v_pk_fma_f32 v[104:105], v[104:105], v[168:169], v[184:185]
    v_pk_fma_f32 v[106:107], v[106:107], v[170:171], v[186:187]
    v_cvt_pk_bf16_f32 v216, v100, v104
    v_cvt_pk_bf16_f32 v217, v101, v105
    v_cvt_pk_bf16_f32 v218, v102, v106
    s_waitcnt vmcnt(10)
    ds_read_b128 a[72:75], v10 offset:4096
    ds_read_b128 a[76:79], v11 offset:4096
    s_waitcnt lgkmcnt(4)
    s_add_u32 m0, s54, 2048
    s_nop 0
    buffer_load_dwordx4 v245, s[32:35], s91 offen lds
    v_cvt_pk_bf16_f32 v219, v103, v107
    buffer_store_dwordx4 v[216:219], v241, s[4:7], s64 offen offset:0 sc1
    v_pk_fma_f32 v[116:117], v[116:117], v[164:165], v[180:181]
    v_pk_fma_f32 v[118:119], v[118:119], v[166:167], v[182:183]
    v_pk_fma_f32 v[120:121], v[120:121], v[168:169], v[184:185]
    s_add_u32 m0, s54, 3072
    s_nop 0
    buffer_load_dwordx4 v246, s[32:35], s91 offen lds
    v_add_u32 v247, 128, v245
    v_bfi_b32 v245, s40, v247, v245
    v_bfi_b32 v246, s40, v247, v246
    v_pk_fma_f32 v[122:123], v[122:123], v[170:171], v[186:187]
    v_cvt_pk_bf16_f32 v220, v116, v120
    v_cvt_pk_bf16_f32 v221, v117, v121
    v_cvt_pk_bf16_f32 v222, v118, v122
    v_cvt_pk_bf16_f32 v223, v119, v123
    s_waitcnt vmcnt(11)
    ds_read_b128 a[80:83], v10 offset:6144
    ds_read_b128 a[84:87], v11 offset:6144
    s_waitcnt lgkmcnt(2)
    s_add_u32 m0, s54, 4096
    s_nop 0
    buffer_load_dwordx4 v245, s[32:35], s88 offen lds
    v_pk_fma_f32 v[108:109], v[108:109], v[172:173], v[188:189]
    v_pk_fma_f32 v[110:111], v[110:111], v[174:175], v[190:191]
    v_pk_fma_f32 v[112:113], v[112:113], v[176:177], v[192:193]
    v_pk_fma_f32 v[114:115], v[114:115], v[178:179], v[194:195]
    s_add_u32 m0, s54, 5120
    s_nop 0
    buffer_load_dwordx4 v246, s[32:35], s88 offen lds
    v_cvt_pk_bf16_f32 v216, v108, v112
    v_cvt_pk_bf16_f32 v217, v109, v113
    v_cvt_pk_bf16_f32 v218, v110, v114
    v_cvt_pk_bf16_f32 v219, v111, v115
    buffer_store_dwordx4 v[216:219], v241, s[4:7], s64 offen offset:1024 sc1
    s_waitcnt vmcnt(12)
    ds_read_b128 a[88:91], v10 offset:8192
    ds_read_b128 a[92:95], v11 offset:8192
    s_waitcnt lgkmcnt(2)
    s_add_u32 m0, s54, 6144
    s_nop 0
    buffer_load_dwordx4 v245, s[32:35], s89 offen lds
    v_pk_fma_f32 v[124:125], v[124:125], v[172:173], v[188:189]
    v_pk_fma_f32 v[126:127], v[126:127], v[174:175], v[190:191]
    v_pk_fma_f32 v[128:129], v[128:129], v[176:177], v[192:193]
    v_pk_fma_f32 v[130:131], v[130:131], v[178:179], v[194:195]
    v_cvt_pk_bf16_f32 v220, v124, v128
    s_add_u32 m0, s54, 7168
    s_nop 0
    buffer_load_dwordx4 v246, s[32:35], s89 offen lds
    v_cvt_pk_bf16_f32 v221, v125, v129
    v_cvt_pk_bf16_f32 v222, v126, v130
    v_cvt_pk_bf16_f32 v223, v127, v131
    v_mfma_f32_16x16x32_bf16 v[132:135], a[200:203], v[60:63], v[132:135]
    ds_read_b64 v[44:45], v5 offset:15360
    s_waitcnt vmcnt(12)
    v_mfma_f32_16x16x32_bf16 v[136:139], a[200:203], v[64:67], v[136:139]
    ds_read_b64 v[46:47], v5 offset:15872
    ds_read_b128 a[96:99], v10 offset:10240
    v_mfma_f32_16x16x32_bf16 v[140:143], a[200:203], v[68:71], v[140:143]
    ds_read_b64 v[48:49], v5 offset:35840
    s_mul_i32 s57, s84, 10
    v_mfma_f32_16x16x32_bf16 v[144:147], a[200:203], v[72:75], v[144:147]
    ds_read_b64 v[50:51], v5 offset:36352
    ds_read_b128 a[100:103], v11 offset:10240
    ds_read_b64 v[52:53], v6 offset:15360
    s_waitcnt lgkmcnt(7)
    ds_read_b64 v[54:55], v6 offset:15872
    s_add_u32 m0, s54, 8192
    ds_read_b64 v[56:57], v6 offset:35840
    v_add_u32 v92, s57, v2
    ds_read_b64 v[58:59], v6 offset:36352
    buffer_load_dwordx4 v245, s[32:35], s90 offen lds
    v_mfma_f32_16x16x32_bf16 v[132:135], a[208:211], v[76:79], v[132:135]
    ds_read_b64 v[60:61], v5 offset:16384
    s_add_u32 m0, s54, 9216
    v_mfma_f32_16x16x32_bf16 v[136:139], a[208:211], v[80:83], v[136:139]
    ds_read_b64 v[62:63], v5 offset:16896
    buffer_load_dwordx4 v246, s[32:35], s90 offen lds
    v_mfma_f32_16x16x32_bf16 v[140:143], a[208:211], v[84:87], v[140:143]
    ds_read_b64 v[64:65], v5 offset:36864
    s_waitcnt vmcnt(12) lgkmcnt(12)
    v_mfma_f32_16x16x32_bf16 v[144:147], a[208:211], v[88:91], v[144:147]
    ds_read_b64 v[66:67], v5 offset:37376
    ds_read_b128 a[104:107], v10 offset:12288
    ds_read_b64 v[68:69], v6 offset:16384
    v_lshrrev_b32 v93, 2, v92
    ds_read_b64 v[70:71], v6 offset:16896
    ds_read_b128 a[108:111], v11 offset:12288
    ds_read_b64 v[72:73], v6 offset:36864
    s_waitcnt lgkmcnt(13)
    ds_read_b64 v[74:75], v6 offset:37376
    s_add_u32 m0, s54, 10240
    s_waitcnt lgkmcnt(10)
    v_mfma_f32_16x16x32_bf16 v[132:135], a[216:219], v[44:47], v[132:135]
    ds_read_b64 v[76:77], v5 offset:17408
    v_and_b32 v92, 3, v92
    v_mfma_f32_16x16x32_bf16 v[136:139], a[216:219], v[48:51], v[136:139]
    ds_read_b64 v[78:79], v5 offset:17920
    buffer_load_dwordx4 v245, s[32:35], s91 offen lds
    v_mfma_f32_16x16x32_bf16 v[140:143], a[216:219], v[52:55], v[140:143]
    ds_read_b64 v[80:81], v5 offset:37888
    s_add_u32 m0, s54, 11264
    v_mfma_f32_16x16x32_bf16 v[144:147], a[216:219], v[56:59], v[144:147]
    ds_read_b64 v[82:83], v5 offset:38400
    buffer_load_dwordx4 v246, s[32:35], s91 offen lds
    ds_read_b64 v[84:85], v6 offset:17408
    v_add_u32 v247, 128, v245
    ds_read_b64 v[86:87], v6 offset:17920
    v_bfi_b32 v245, s40, v247, v245
    v_bfi_b32 v246, s40, v247, v246
    ds_read_b64 v[88:89], v6 offset:37888
    s_waitcnt vmcnt(12) lgkmcnt(14)
    ds_read_b64 v[90:91], v6 offset:38400
    ds_read_b128 a[112:115], v10 offset:0
    s_waitcnt lgkmcnt(9)
    v_mfma_f32_16x16x32_bf16 v[132:135], a[224:227], v[60:63], v[132:135]
    ds_read_b64 v[44:45], v5 offset:18432
    v_lshlrev_b32 v92, 7, v92
    v_mfma_f32_16x16x32_bf16 v[136:139], a[224:227], v[64:67], v[136:139]
    ds_read_b64 v[46:47], v5 offset:18944
    ds_read_b128 a[116:119], v11 offset:0
    v_mfma_f32_16x16x32_bf16 v[140:143], a[224:227], v[68:71], v[140:143]
    ds_read_b64 v[48:49], v5 offset:38912
    v_mfma_f32_16x16x32_bf16 v[144:147], a[224:227], v[72:75], v[144:147]
    ds_read_b64 v[50:51], v5 offset:39424
    s_add_u32 m0, s54, 12288
    ds_read_b64 v[52:53], v6 offset:18432
    v_lshl_add_u32 v92, v93, 10, v92
    ds_read_b64 v[54:55], v6 offset:18944
    buffer_load_dwordx4 v245, s[32:35], s88 offen lds
    ds_read_b64 v[56:57], v6 offset:38912
    s_add_u32 m0, s54, 13312
    ds_read_b64 v[58:59], v6 offset:39424
    buffer_load_dwordx4 v246, s[32:35], s88 offen lds
    s_waitcnt lgkmcnt(10)
    v_mfma_f32_16x16x32_bf16 v[132:135], a[232:235], v[76:79], v[132:135]
    ds_read_b64 v[60:61], v5 offset:19456
    s_waitcnt vmcnt(11)
    v_mfma_f32_16x16x32_bf16 v[136:139], a[232:235], v[80:83], v[136:139]
    ds_read_b64 v[62:63], v5 offset:19968
    ds_read_b128 a[120:123], v10 offset:2048
    v_mfma_f32_16x16x32_bf16 v[140:143], a[232:235], v[84:87], v[140:143]
    ds_read_b64 v[64:65], v5 offset:39936
    v_lshl_add_u32 v92, v1, 3, v92
    v_mfma_f32_16x16x32_bf16 v[144:147], a[232:235], v[88:91], v[144:147]
    ds_read_b64 v[66:67], v5 offset:40448
    ds_read_b128 a[124:127], v11 offset:2048
    ds_read_b64 v[68:69], v6 offset:19456
    s_waitcnt lgkmcnt(13)
    ds_read_b64 v[70:71], v6 offset:19968
    s_add_u32 m0, s54, 0
    ds_read_b64 v[72:73], v6 offset:39936
    v_add_u32 v92, s53, v92
    ds_read_b64 v[74:75], v6 offset:40448
    ds_read_b64 v[16:17], v92 offset:0
    s_waitcnt lgkmcnt(11)
    v_mfma_f32_16x16x32_bf16 v[132:135], a[240:243], v[44:47], v[132:135]
    ds_read_b64 v[18:19], v92 offset:512
    v_mfma_f32_16x16x32_bf16 v[136:139], a[240:243], v[48:51], v[136:139]
    ds_read_b64 v[20:21], v92 offset:1024
    v_mfma_f32_16x16x32_bf16 v[140:143], a[240:243], v[52:55], v[140:143]
    ds_read_b64 v[22:23], v92 offset:1536
    v_mfma_f32_16x16x32_bf16 v[144:147], a[240:243], v[56:59], v[144:147]
    buffer_load_dwordx4 v245, s[32:35], s89 offen lds
    s_add_u32 m0, s54, 1024
    s_nop 0
    buffer_load_dwordx4 v246, s[32:35], s89 offen lds
    s_waitcnt vmcnt(11) lgkmcnt(11)
    ds_read_b128 a[128:131], v10 offset:4096
    ds_read_b128 a[132:135], v11 offset:4096
    s_waitcnt lgkmcnt(10)
    s_add_u32 m0, s54, 2048
    s_waitcnt lgkmcnt(6)
    v_mfma_f32_16x16x32_bf16 v[132:135], a[248:251], v[60:63], v[132:135]
    buffer_load_dwordx4 v245, s[32:35], s90 offen lds
    s_add_u32 m0, s54, 3072
    v_mfma_f32_16x16x32_bf16 v[136:139], a[248:251], v[64:67], v[136:139]
    buffer_load_dwordx4 v246, s[32:35], s90 offen lds
    s_waitcnt vmcnt(10) lgkmcnt(5)
    v_mfma_f32_16x16x32_bf16 v[140:143], a[248:251], v[68:71], v[140:143]
    ds_read_b128 a[136:139], v10 offset:6144
    v_mfma_f32_16x16x32_bf16 v[144:147], a[248:251], v[72:75], v[144:147]
    ds_read_b128 a[140:143], v11 offset:6144
    s_waitcnt lgkmcnt(2)
    s_add_u32 m0, s54, 4096
    s_nop 0
    buffer_load_dwordx4 v245, s[32:35], s91 offen lds
    v_lshrrev_b32 v92, 1, v2
    v_add3_u32 v92, v92, s57, 8
    v_lshrrev_b32 v93, 2, v92
    v_and_b32 v92, 3, v92
    v_lshlrev_b32 v92, 7, v92
    s_lshl_b32 s64, s84, 5
    s_add_u32 s64, s64, s83
    s_lshl_b32 s64, s64, 5
    s_add_u32 s64, s64, 196608
    s_cmp_lg_u32 s82, 0
    s_cselect_b32 s64, 33554432, s64
    v_mul_u32_u24 v3, 8448, v240
    s_barrier
    s_mov_b64 exec, 15
    buffer_store_dword v13, v3, s[4:7], s64 offen sc1
    s_mov_b64 exec, -1
    v_lshl_add_u32 v92, v93, 10, v92
    v_and_b32 v93, 1, v2
    v_lshl_add_u32 v92, v93, 9, v92
    v_lshl_add_u32 v92, v1, 3, v92
    v_add_u32 v92, s53, v92
    ds_read_b64 v[24:25], v92
    s_lshl_b32 s57, s84, 2
    s_add_u32 s57, s57, s82
    s_lshl_b32 s57, s57, 8
    s_lshr_b32 s58, s83, 3
    s_mul_i32 s58, s58, 8448
    s_add_u32 s57, s57, s58
    s_add_u32 s60, s57, 196608
    v_and_b32 v26, 7, v0
    v_lshlrev_b32 v26, 5, v26
    s_lshl_b32 s57, s82, 14
    s_add_u32 s57, s57, s56
    v_add_u32 v9, s57, v241
    s_mul_i32 s20, s84, 0
    s_add_u32 s21, s20, 2048
    s_and_b32 s21, s21, 0x3fff
    s_add_u32 s22, s21, 2048
    s_and_b32 s22, s22, 0x3fff
    s_add_u32 s23, s22, 2048
    s_and_b32 s23, s23, 0x3fff
    s_add_u32 s24, s23, 2048
    s_and_b32 s24, s24, 0x3fff
    s_add_u32 s25, s24, 2048
    s_and_b32 s25, s25, 0x3fff
    s_add_u32 s26, s25, 2048
    s_and_b32 s26, s26, 0x3fff
    s_add_u32 s27, s26, 2048
    s_and_b32 s27, s27, 0x3fff
    v_lshlrev_b32 v3, 2, v1
    v_add_u32 v3, 81920, v3
    ds_read2_b32 v[164:165], v3 offset0:0 offset1:64
    ds_read2_b32 v[166:167], v3 offset0:16 offset1:80
    ds_read2_b32 v[168:169], v3 offset0:32 offset1:96
    ds_read2_b32 v[170:171], v3 offset0:48 offset1:112
    s_lshl_b32 s64, s82, 10
    s_add_u32 s64, s64, 86528
    v_add_u32 v3, s64, v241
    s_waitcnt lgkmcnt(3)
    v_pk_fma_f32 v[132:133], v[196:197], v[164:165], v[132:133] op_sel:[0,1,0] op_sel_hi:[1,1,1]
    v_pk_fma_f32 v[134:135], v[198:199], v[164:165], v[134:135] op_sel:[0,1,0] op_sel_hi:[1,1,1]
    v_pk_fma_f32 v[148:149], v[200:201], v[164:165], v[148:149] op_sel:[0,1,0] op_sel_hi:[1,1,1]
    v_pk_fma_f32 v[150:151], v[202:203], v[164:165], v[150:151] op_sel:[0,1,0] op_sel_hi:[1,1,1]
    v_pk_fma_f32 v[132:133], v[132:133], v[164:165], v[204:205] op_sel:[0,0,0] op_sel_hi:[1,0,1]
    s_add_u32 m0, s54, 5120
    s_nop 0
    buffer_load_dwordx4 v246, s[32:35], s91 offen lds
    v_add_u32 v247, 128, v245
    v_bfi_b32 v245, s40, v247, v245
    v_bfi_b32 v246, s40, v247, v246
    v_pk_fma_f32 v[134:135], v[134:135], v[164:165], v[206:207] op_sel:[0,0,0] op_sel_hi:[1,0,1]
    v_pk_fma_f32 v[148:149], v[148:149], v[164:165], v[208:209] op_sel:[0,0,0] op_sel_hi:[1,0,1]
    v_pk_fma_f32 v[150:151], v[150:151], v[164:165], v[210:211] op_sel:[0,0,0] op_sel_hi:[1,0,1]
    v_pk_mul_f32 v[216:217], v[132:133], v[132:133]
    v_pk_mul_f32 v[218:219], v[134:135], v[134:135]
    v_pk_mul_f32 v[220:221], v[148:149], v[148:149]
    v_pk_mul_f32 v[222:223], v[150:151], v[150:151]
    v_pk_fma_f32 v[216:217], v[216:217], s[66:67], s[66:67] op_sel:[0,0,1] op_sel_hi:[1,0,1]
    v_pk_fma_f32 v[218:219], v[218:219], s[66:67], s[66:67] op_sel:[0,0,1] op_sel_hi:[1,0,1]
    v_pk_fma_f32 v[220:221], v[220:221], s[66:67], s[66:67] op_sel:[0,0,1] op_sel_hi:[1,0,1]
    v_pk_fma_f32 v[222:223], v[222:223], s[66:67], s[66:67] op_sel:[0,0,1] op_sel_hi:[1,0,1]
    v_pk_mul_f32 v[216:217], v[216:217], v[132:133]
    s_waitcnt vmcnt(11)
    ds_read_b128 a[144:147], v10 offset:8192
    ds_read_b128 a[148:151], v11 offset:8192
    s_add_u32 m0, s54, 6144
    s_nop 0
    buffer_load_dwordx4 v245, s[32:35], s88 offen lds
    v_pk_mul_f32 v[218:219], v[218:219], v[134:135]
    v_pk_mul_f32 v[220:221], v[220:221], v[148:149]
    v_pk_mul_f32 v[222:223], v[222:223], v[150:151]
    v_exp_f32 v216, v216
    v_exp_f32 v217, v217
    v_exp_f32 v218, v218
    v_exp_f32 v219, v219
    v_exp_f32 v220, v220
    v_exp_f32 v221, v221
    v_exp_f32 v222, v222
    v_exp_f32 v223, v223
    v_pk_add_f32 v[216:217], v[216:217], s[68:69]
    s_add_u32 m0, s54, 7168
    s_nop 0
    buffer_load_dwordx4 v246, s[32:35], s88 offen lds
    v_pk_add_f32 v[218:219], v[218:219], s[68:69]
    v_pk_add_f32 v[220:221], v[220:221], s[68:69]
    v_pk_add_f32 v[222:223], v[222:223], s[68:69]
    v_rcp_f32 v216, v216
    v_rcp_f32 v217, v217
    v_rcp_f32 v218, v218
    v_rcp_f32 v219, v219
    v_rcp_f32 v220, v220
    v_rcp_f32 v221, v221
    v_rcp_f32 v222, v222
    v_rcp_f32 v223, v223
    v_pk_mul_f32 v[132:133], v[132:133], v[216:217]
    s_waitcnt vmcnt(11) lgkmcnt(0)
    ds_read_b128 a[152:155], v10 offset:10240
    ds_read_b128 a[156:159], v11 offset:10240
    s_add_u32 m0, s54, 8192
    s_nop 0
    buffer_load_dwordx4 v245, s[32:35], s89 offen lds
    v_pk_mul_f32 v[134:135], v[134:135], v[218:219]
    v_pk_mul_f32 v[148:149], v[148:149], v[220:221]
    v_pk_mul_f32 v[150:151], v[150:151], v[222:223]
    v_cvt_pk_bf16_f32 v180, v132, v148
    v_cvt_pk_bf16_f32 v181, v133, v149
    v_cvt_pk_bf16_f32 v182, v134, v150
    v_cvt_pk_bf16_f32 v183, v135, v151
    ds_write_b128 v3, v[180:183] offset:0
    v_pk_fma_f32 v[136:137], v[196:197], v[166:167], v[136:137] op_sel:[0,1,0] op_sel_hi:[1,1,1]
    v_pk_fma_f32 v[138:139], v[198:199], v[166:167], v[138:139] op_sel:[0,1,0] op_sel_hi:[1,1,1]
    v_pk_fma_f32 v[152:153], v[200:201], v[166:167], v[152:153] op_sel:[0,1,0] op_sel_hi:[1,1,1]
    v_pk_fma_f32 v[154:155], v[202:203], v[166:167], v[154:155] op_sel:[0,1,0] op_sel_hi:[1,1,1]
    s_add_u32 m0, s54, 9216
    s_nop 0
    buffer_load_dwordx4 v246, s[32:35], s89 offen lds
    v_pk_fma_f32 v[136:137], v[136:137], v[166:167], v[204:205] op_sel:[0,0,0] op_sel_hi:[1,0,1]
    v_pk_fma_f32 v[138:139], v[138:139], v[166:167], v[206:207] op_sel:[0,0,0] op_sel_hi:[1,0,1]
    v_pk_fma_f32 v[152:153], v[152:153], v[166:167], v[208:209] op_sel:[0,0,0] op_sel_hi:[1,0,1]
    v_pk_fma_f32 v[154:155], v[154:155], v[166:167], v[210:211] op_sel:[0,0,0] op_sel_hi:[1,0,1]
    v_pk_mul_f32 v[216:217], v[136:137], v[136:137]
    v_pk_mul_f32 v[218:219], v[138:139], v[138:139]
    v_pk_mul_f32 v[220:221], v[152:153], v[152:153]
    v_pk_mul_f32 v[222:223], v[154:155], v[154:155]
    v_pk_fma_f32 v[216:217], v[216:217], s[66:67], s[66:67] op_sel:[0,0,1] op_sel_hi:[1,0,1]
    v_pk_fma_f32 v[218:219], v[218:219], s[66:67], s[66:67] op_sel:[0,0,1] op_sel_hi:[1,0,1]
    v_pk_fma_f32 v[220:221], v[220:221], s[66:67], s[66:67] op_sel:[0,0,1] op_sel_hi:[1,0,1]
    v_pk_fma_f32 v[222:223], v[222:223], s[66:67], s[66:67] op_sel:[0,0,1] op_sel_hi:[1,0,1]
    s_waitcnt vmcnt(11)
    ds_read_b128 a[160:163], v10 offset:12288
    ds_read_b128 a[164:167], v11 offset:12288
    s_waitcnt lgkmcnt(3)
    s_add_u32 m0, s54, 10240
    s_nop 0
    buffer_load_dwordx4 v245, s[32:35], s90 offen lds
    v_pk_mul_f32 v[216:217], v[216:217], v[136:137]
    v_pk_mul_f32 v[218:219], v[218:219], v[138:139]
    v_pk_mul_f32 v[220:221], v[220:221], v[152:153]
    v_pk_mul_f32 v[222:223], v[222:223], v[154:155]
    v_exp_f32 v216, v216
    v_exp_f32 v217, v217
    v_exp_f32 v218, v218
    v_exp_f32 v219, v219
    v_exp_f32 v220, v220
    v_exp_f32 v221, v221
    v_exp_f32 v222, v222
    v_exp_f32 v223, v223
    s_add_u32 m0, s54, 11264
    s_nop 0
    buffer_load_dwordx4 v246, s[32:35], s90 offen lds
    v_pk_add_f32 v[216:217], v[216:217], s[68:69]
    v_pk_add_f32 v[218:219], v[218:219], s[68:69]
    v_pk_add_f32 v[220:221], v[220:221], s[68:69]
    v_pk_add_f32 v[222:223], v[222:223], s[68:69]
    v_rcp_f32 v216, v216
    v_rcp_f32 v217, v217
    v_rcp_f32 v218, v218
    v_rcp_f32 v219, v219
    v_rcp_f32 v220, v220
    v_rcp_f32 v221, v221
    v_rcp_f32 v222, v222
    v_rcp_f32 v223, v223
    s_waitcnt vmcnt(11) lgkmcnt(0)
    ds_read_b128 a[168:171], v10 offset:0
    ds_read_b128 a[172:175], v11 offset:0
    s_add_u32 m0, s54, 12288
    s_nop 0
    buffer_load_dwordx4 v245, s[32:35], s91 offen lds
    v_pk_mul_f32 v[136:137], v[136:137], v[216:217]
    v_pk_mul_f32 v[138:139], v[138:139], v[218:219]
    v_pk_mul_f32 v[152:153], v[152:153], v[220:221]
    v_pk_mul_f32 v[154:155], v[154:155], v[222:223]
    v_cvt_pk_bf16_f32 v184, v136, v152
    v_cvt_pk_bf16_f32 v185, v137, v153
    v_cvt_pk_bf16_f32 v186, v138, v154
    v_cvt_pk_bf16_f32 v187, v139, v155
    ds_write_b128 v3, v[184:187] offset:4096
    v_pk_fma_f32 v[140:141], v[196:197], v[168:169], v[140:141] op_sel:[0,1,0] op_sel_hi:[1,1,1]
    v_pk_fma_f32 v[142:143], v[198:199], v[168:169], v[142:143] op_sel:[0,1,0] op_sel_hi:[1,1,1]
    v_pk_fma_f32 v[156:157], v[200:201], v[168:169], v[156:157] op_sel:[0,1,0] op_sel_hi:[1,1,1]
    s_add_u32 m0, s54, 13312
    s_nop 0
    buffer_load_dwordx4 v246, s[32:35], s91 offen lds
    v_add_u32 v247, 128, v245
    v_bfi_b32 v245, s40, v247, v245
    v_bfi_b32 v246, s40, v247, v246
    v_pk_fma_f32 v[158:159], v[202:203], v[168:169], v[158:159] op_sel:[0,1,0] op_sel_hi:[1,1,1]
    v_pk_fma_f32 v[140:141], v[140:141], v[168:169], v[204:205] op_sel:[0,0,0] op_sel_hi:[1,0,1]
    v_pk_fma_f32 v[142:143], v[142:143], v[168:169], v[206:207] op_sel:[0,0,0] op_sel_hi:[1,0,1]
    v_pk_fma_f32 v[156:157], v[156:157], v[168:169], v[208:209] op_sel:[0,0,0] op_sel_hi:[1,0,1]
    v_pk_fma_f32 v[158:159], v[158:159], v[168:169], v[210:211] op_sel:[0,0,0] op_sel_hi:[1,0,1]
    v_pk_mul_f32 v[216:217], v[140:141], v[140:141]
    v_pk_mul_f32 v[218:219], v[142:143], v[142:143]
    v_pk_mul_f32 v[220:221], v[156:157], v[156:157]
    v_pk_mul_f32 v[222:223], v[158:159], v[158:159]
    v_pk_fma_f32 v[216:217], v[216:217], s[66:67], s[66:67] op_sel:[0,0,1] op_sel_hi:[1,0,1]
    v_pk_fma_f32 v[218:219], v[218:219], s[66:67], s[66:67] op_sel:[0,0,1] op_sel_hi:[1,0,1]
    v_pk_fma_f32 v[220:221], v[220:221], s[66:67], s[66:67] op_sel:[0,0,1] op_sel_hi:[1,0,1]
    s_waitcnt vmcnt(11) lgkmcnt(1)
    ds_read_b128 a[176:179], v10 offset:2048
    ds_read_b128 a[180:183], v11 offset:2048
    s_add_u32 m0, s54, 0
    s_nop 0
    buffer_load_dwordx4 v245, s[32:35], s88 offen lds
    v_pk_fma_f32 v[222:223], v[222:223], s[66:67], s[66:67] op_sel:[0,0,1] op_sel_hi:[1,0,1]
    v_pk_mul_f32 v[216:217], v[216:217], v[140:141]
    v_pk_mul_f32 v[218:219], v[218:219], v[142:143]
    v_pk_mul_f32 v[220:221], v[220:221], v[156:157]
    v_pk_mul_f32 v[222:223], v[222:223], v[158:159]
    v_exp_f32 v216, v216
    v_exp_f32 v217, v217
    v_exp_f32 v218, v218
    v_exp_f32 v219, v219
    v_exp_f32 v220, v220
    v_exp_f32 v221, v221
    v_exp_f32 v222, v222
    s_add_u32 m0, s54, 1024
    s_nop 0
    buffer_load_dwordx4 v246, s[32:35], s88 offen lds
    v_exp_f32 v223, v223
    v_pk_add_f32 v[216:217], v[216:217], s[68:69]
    v_pk_add_f32 v[218:219], v[218:219], s[68:69]
    v_pk_add_f32 v[220:221], v[220:221], s[68:69]
    v_pk_add_f32 v[222:223], v[222:223], s[68:69]
    v_rcp_f32 v216, v216
    v_rcp_f32 v217, v217
    v_rcp_f32 v218, v218
    v_rcp_f32 v219, v219
    v_rcp_f32 v220, v220
    v_rcp_f32 v221, v221
    v_rcp_f32 v222, v222
    s_waitcnt vmcnt(10) lgkmcnt(0)
    ds_read_b128 a[184:187], v10 offset:4096
    ds_read_b128 a[188:191], v11 offset:4096
    s_add_u32 m0, s54, 2048
    s_nop 0
    buffer_load_dwordx4 v245, s[32:35], s89 offen lds
    v_rcp_f32 v223, v223
    v_pk_mul_f32 v[140:141], v[140:141], v[216:217]
    v_pk_mul_f32 v[142:143], v[142:143], v[218:219]
    v_pk_mul_f32 v[156:157], v[156:157], v[220:221]
    v_pk_mul_f32 v[158:159], v[158:159], v[222:223]
    v_cvt_pk_bf16_f32 v188, v140, v156
    v_cvt_pk_bf16_f32 v189, v141, v157
    v_cvt_pk_bf16_f32 v190, v142, v158
    v_cvt_pk_bf16_f32 v191, v143, v159
    ds_write_b128 v3, v[188:191] offset:8192
    buffer_load_dword v27, v26, s[4:7], s60 offen sc1
    v_pk_fma_f32 v[144:145], v[196:197], v[170:171], v[144:145] op_sel:[0,1,0] op_sel_hi:[1,1,1]
    s_add_u32 m0, s54, 3072
    s_nop 0
    buffer_load_dwordx4 v246, s[32:35], s89 offen lds
    v_pk_fma_f32 v[146:147], v[198:199], v[170:171], v[146:147] op_sel:[0,1,0] op_sel_hi:[1,1,1]
    v_pk_fma_f32 v[160:161], v[200:201], v[170:171], v[160:161] op_sel:[0,1,0] op_sel_hi:[1,1,1]
    v_pk_fma_f32 v[162:163], v[202:203], v[170:171], v[162:163] op_sel:[0,1,0] op_sel_hi:[1,1,1]
    v_pk_fma_f32 v[144:145], v[144:145], v[170:171], v[204:205] op_sel:[0,0,0] op_sel_hi:[1,0,1]
    v_pk_fma_f32 v[146:147], v[146:147], v[170:171], v[206:207] op_sel:[0,0,0] op_sel_hi:[1,0,1]
    v_pk_fma_f32 v[160:161], v[160:161], v[170:171], v[208:209] op_sel:[0,0,0] op_sel_hi:[1,0,1]
    v_pk_fma_f32 v[162:163], v[162:163], v[170:171], v[210:211] op_sel:[0,0,0] op_sel_hi:[1,0,1]
    v_pk_mul_f32 v[216:217], v[144:145], v[144:145]
    v_pk_mul_f32 v[218:219], v[146:147], v[146:147]
    v_pk_mul_f32 v[220:221], v[160:161], v[160:161]
    v_pk_mul_f32 v[222:223], v[162:163], v[162:163]
    v_pk_fma_f32 v[216:217], v[216:217], s[66:67], s[66:67] op_sel:[0,0,1] op_sel_hi:[1,0,1]
    s_waitcnt vmcnt(11)
    ds_read_b128 a[192:195], v10 offset:6144
    ds_read_b128 a[196:199], v11 offset:6144
    s_waitcnt lgkmcnt(3)
    s_add_u32 m0, s54, 4096
    s_nop 0
    buffer_load_dwordx4 v245, s[32:35], s90 offen lds
    v_pk_fma_f32 v[218:219], v[218:219], s[66:67], s[66:67] op_sel:[0,0,1] op_sel_hi:[1,0,1]
    v_pk_fma_f32 v[220:221], v[220:221], s[66:67], s[66:67] op_sel:[0,0,1] op_sel_hi:[1,0,1]
    v_pk_fma_f32 v[222:223], v[222:223], s[66:67], s[66:67] op_sel:[0,0,1] op_sel_hi:[1,0,1]
    v_pk_mul_f32 v[216:217], v[216:217], v[144:145]
    v_pk_mul_f32 v[218:219], v[218:219], v[146:147]
    v_pk_mul_f32 v[220:221], v[220:221], v[160:161]
    v_pk_mul_f32 v[222:223], v[222:223], v[162:163]
    v_exp_f32 v216, v216
    v_exp_f32 v217, v217
    v_exp_f32 v218, v218
    v_exp_f32 v219, v219
    v_exp_f32 v220, v220
    s_add_u32 m0, s54, 5120
    s_nop 0
    buffer_load_dwordx4 v246, s[32:35], s90 offen lds
    v_exp_f32 v221, v221
    v_exp_f32 v222, v222
    v_exp_f32 v223, v223
    v_pk_add_f32 v[216:217], v[216:217], s[68:69]
    v_pk_add_f32 v[218:219], v[218:219], s[68:69]
    v_pk_add_f32 v[220:221], v[220:221], s[68:69]
    v_pk_add_f32 v[222:223], v[222:223], s[68:69]
    v_rcp_f32 v216, v216
    v_rcp_f32 v217, v217
    v_rcp_f32 v218, v218
    v_rcp_f32 v219, v219
    v_rcp_f32 v220, v220
    s_waitcnt vmcnt(11) lgkmcnt(0)
    ds_read_b128 a[200:203], v10 offset:8192
    ds_read_b128 a[204:207], v11 offset:8192
    s_add_u32 m0, s54, 6144
    s_nop 0
    buffer_load_dwordx4 v245, s[32:35], s91 offen lds
    v_rcp_f32 v221, v221
    v_rcp_f32 v222, v222
    v_rcp_f32 v223, v223
    v_pk_mul_f32 v[144:145], v[144:145], v[216:217]
    v_pk_mul_f32 v[146:147], v[146:147], v[218:219]
    v_pk_mul_f32 v[160:161], v[160:161], v[220:221]
    v_pk_mul_f32 v[162:163], v[162:163], v[222:223]
    v_cvt_pk_bf16_f32 v192, v144, v160
    v_cvt_pk_bf16_f32 v193, v145, v161
    v_cvt_pk_bf16_f32 v194, v146, v162
    v_cvt_pk_bf16_f32 v195, v147, v163
    ds_write_b128 v3, v[192:195] offset:12288
    s_add_u32 m0, s54, 7168
    s_nop 0
    buffer_load_dwordx4 v246, s[32:35], s91 offen lds
    s_mov_b32 s49, 65536
L_adaL_poll_21_w3:
    s_waitcnt vmcnt(5)
    v_cmp_ne_u32 vcc, s48, v27
    s_nop 0
    s_cbranch_vccz L_adaL_got_22_w3
    buffer_load_dword v27, v26, s[4:7], s60 offen sc1
    s_waitcnt vmcnt(0)
    s_sub_u32 s49, s49, 1
    s_cmp_lg_u32 s49, 0
    s_cbranch_scc1 L_adaL_poll_21_w3
L_adaL_got_22_w3:
    buffer_load_dwordx4 v[44:47], v9, s[4:7], s20 offen offset:0 sc1
    ds_read_b128 a[208:211], v10 offset:10240
    ds_read_b128 a[212:215], v11 offset:10240
    buffer_load_dwordx4 v[48:51], v9, s[4:7], s20 offen offset:1024 sc1
    ds_read_b128 a[216:219], v10 offset:12288
    ds_read_b128 a[220:223], v11 offset:12288
    buffer_load_dwordx4 v[52:55], v9, s[4:7], s21 offen offset:0 sc1
    ds_read_b128 a[224:227], v10 offset:0
    ds_read_b128 a[228:231], v11 offset:0
    buffer_load_dwordx4 v[56:59], v9, s[4:7], s21 offen offset:1024 sc1
    s_waitcnt vmcnt(8)
    ds_read_b128 a[232:235], v10 offset:2048
    ds_read_b128 a[236:239], v11 offset:2048
    buffer_load_dwordx4 v[60:63], v9, s[4:7], s22 offen offset:0 sc1
    s_waitcnt vmcnt(7)
    ds_read_b128 a[240:243], v10 offset:4096
    ds_read_b128 a[244:247], v11 offset:4096
    buffer_load_dwordx4 v[64:67], v9, s[4:7], s22 offen offset:1024 sc1
    s_waitcnt vmcnt(6)
    ds_read_b128 a[248:251], v10 offset:6144
    ds_read_b128 a[252:255], v11 offset:6144
    buffer_load_dwordx4 v[68:71], v9, s[4:7], s23 offen offset:0 sc1
    buffer_load_dwordx4 v[72:75], v9, s[4:7], s23 offen offset:1024 sc1
    buffer_load_dwordx4 v[76:79], v9, s[4:7], s24 offen offset:0 sc1
    buffer_load_dwordx4 v[80:83], v9, s[4:7], s24 offen offset:1024 sc1
    buffer_load_dwordx4 v[84:87], v9, s[4:7], s25 offen offset:0 sc1
    buffer_load_dwordx4 v[88:91], v9, s[4:7], s25 offen offset:1024 sc1
    buffer_load_dwordx4 v[92:95], v9, s[4:7], s26 offen offset:0 sc1
    buffer_load_dwordx4 v[96:99], v9, s[4:7], s26 offen offset:1024 sc1
    buffer_load_dwordx4 v[100:103], v9, s[4:7], s27 offen offset:0 sc1
    buffer_load_dwordx4 v[104:107], v9, s[4:7], s27 offen offset:1024 sc1
    v_add_u32 v9, 65536, v9
    s_branch L_adaL_w3back_24
L_adaL_aux_2:
    s_sub_u32 s42, s2, 160
    v_lshrrev_b32 v1, 6, v0
    s_nop 0
    v_readfirstlane_b32 s39, v1
    s_cmp_lt_u32 s2, 248
    s_cbranch_scc1 L_adaL_notag_32
    s_getpc_b64 s[40:41]
L_adaL_pc_37:
    s_sub_u32 s40, s40, L_adaL_pc_37-adaLN_cond__ssm_conv_h3__mixer_gmlp__prompt_kernel
    s_subb_u32 s41, s41, 0
    v_lshlrev_b32 v1, 7, v0
    v_min_u32 v1, code_end-adaLN_cond__ssm_conv_h3__mixer_gmlp__prompt_kernel-4, v1
    global_load_dword v230, v1, s[40:41]
    v_lshlrev_b32 v1, 7, v0
    v_add_u32 v1, 32768, v1
    v_min_u32 v1, code_end-adaLN_cond__ssm_conv_h3__mixer_gmlp__prompt_kernel-4, v1
    global_load_dword v230, v1, s[40:41]
    s_cmp_lg_u32 s2, 252
    s_cbranch_scc1 L_adaL_notag_32
    s_memrealtime s[50:51]
    s_waitcnt lgkmcnt(0)
    s_or_b32 s48, s50, 1
    v_mov_b32 v232, s48
    v_mov_b32 v233, s48
    v_cmp_eq_u32 vcc, 0, v0
    s_nop 0
    s_and_b64 exec, exec, vcc
    buffer_store_dwordx2 v[232:233], off, s[44:47], 0 sc1
    s_mov_b64 exec, -1
L_adaL_notag_32:
    s_load_dwordx2 s[20:21], s[0:1], 56
    s_mov_b32 s22, 2211840
    s_mov_b32 s23, 0x20000
    v_lshrrev_b32 v137, 6, v0
    s_nop 0
    v_readfirstlane_b32 s24, v137
    s_lshr_b32 s25, s42, 4
    s_and_b32 s26, s42, 15
    s_lshl_b32 s30, s25, 2
    s_add_u32 s30, s30, s24
    s_lshr_b32 s28, s26, 1
    s_mul_i32 s28, s28, 216
    s_and_b32 s29, s26, 1
    s_mul_i32 s29, s29, 1728
    s_add_u32 s28, s28, s29
    s_mul_i32 s29, s30, 110592
    s_add_u32 s28, s28, s29
    v_and_b32 v136, 63, v0
    v_lshlrev_b32 v138, 2, v136
    v_mov_b32 v137, 2147483648
    v_cmp_gt_u32 vcc, 54, v136
    s_nop 1
    v_cndmask_b32 v138, v137, v138, vcc
    s_cmp_ge_u32 s2, 220
    s_cbranch_scc1 L_adaL_stats_31
    s_load_dwordx2 s[8:9], s[0:1], 96
    s_mov_b32 s10, 4915200
    s_mov_b32 s11, 0x20000
    s_load_dwordx2 s[12:13], s[0:1], 88
    s_mov_b32 s14, 1280
    s_mov_b32 s15, 0x20000
    s_sub_u32 s16, s2, 160
    v_and_b32 v1, 7, v0
    v_lshrrev_b32 v2, 3, v0
    v_mul_u32_u24 v4, 40, v2
    v_mul_u32_u24 v3, 153600, v2
    v_lshl_add_u32 v3, v1, 4, v3
    s_lshl_b32 s17, s16, 7
    s_waitcnt lgkmcnt(0)
    buffer_load_dwordx4 v[6:9], v4, s[12:15], 0 offen
    buffer_load_dwordx4 v[10:13], v4, s[12:15], 0 offen offset:16
    buffer_load_dwordx2 v[14:15], v4, s[12:15], 0 offen offset:32
    buffer_load_dwordx4 v[16:19], v3, s[8:11], s17 offen
    s_add_u32 s17, s17, 7680
    buffer_load_dwordx4 v[20:23], v3, s[8:11], s17 offen
    s_add_u32 s17, s17, 7680
    buffer_load_dwordx4 v[24:27], v3, s[8:11], s17 offen
    s_add_u32 s17, s17, 7680
    buffer_load_dwordx4 v[28:31], v3, s[8:11], s17 offen
    s_add_u32 s17, s17, 7680
    buffer_load_dwordx4 v[32:35], v3, s[8:11], s17 offen
    s_add_u32 s17, s17, 7680
    buffer_load_dwordx4 v[36:39], v3, s[8:11], s17 offen
    s_add_u32 s17, s17, 7680
    buffer_load_dwordx4 v[40:43], v3, s[8:11], s17 offen
    s_add_u32 s17, s17, 7680
    buffer_load_dwordx4 v[44:47], v3, s[8:11], s17 offen
    s_add_u32 s17, s17, 7680
    buffer_load_dwordx4 v[48:51], v3, s[8:11], s17 offen
    s_add_u32 s17, s17, 7680
    buffer_load_dwordx4 v[52:55], v3, s[8:11], s17 offen
    s_add_u32 s17, s17, 7680
    buffer_load_dwordx4 v[56:59], v3, s[8:11], s17 offen
    s_add_u32 s17, s17, 7680
    buffer_load_dwordx4 v[60:63], v3, s[8:11], s17 offen
    s_add_u32 s17, s17, 7680
    buffer_load_dwordx4 v[64:67], v3, s[8:11], s17 offen
    s_add_u32 s17, s17, 7680
    buffer_load_dwordx4 v[68:71], v3, s[8:11], s17 offen
    s_add_u32 s17, s17, 7680
    buffer_load_dwordx4 v[72:75], v3, s[8:11], s17 offen
    s_add_u32 s17, s17, 7680
    buffer_load_dwordx4 v[76:79], v3, s[8:11], s17 offen
    s_add_u32 s17, s17, 7680
    buffer_load_dwordx4 v[80:83], v3, s[8:11], s17 offen
    s_add_u32 s17, s17, 7680
    buffer_load_dwordx4 v[84:87], v3, s[8:11], s17 offen
    s_add_u32 s17, s17, 7680
    buffer_load_dwordx4 v[88:91], v3, s[8:11], s17 offen
    s_add_u32 s17, s17, 7680
    buffer_load_dwordx4 v[92:95], v3, s[8:11], s17 offen
    s_mov_b32 s18, 0xbfb8aa3b
    s_waitcnt vmcnt(22)
    v_lshlrev_b32 v124, 16, v6
    v_and_b32 v125, s3, v6
    v_mul_f32 v126, s18, v124
    v_mul_f32 v127, s18, v125
    v_exp_f32 v126, v126
    v_exp_f32 v127, v127
    v_add_f32 v126, 1.0, v126
    v_add_f32 v127, 1.0, v127
    v_rcp_f32 v126, v126
    v_rcp_f32 v127, v127
    v_mul_f32 v124, v124, v126
    v_mul_f32 v125, v125, v127
    v_cvt_pk_bf16_f32 v124, v124, v125
    v_lshlrev_b32 v96, 16, v124
    v_and_b32 v97, s3, v124
    v_lshlrev_b32 v124, 16, v7
    v_and_b32 v125, s3, v7
    v_mul_f32 v126, s18, v124
    v_mul_f32 v127, s18, v125
    v_exp_f32 v126, v126
    v_exp_f32 v127, v127
    v_add_f32 v126, 1.0, v126
    v_add_f32 v127, 1.0, v127
    v_rcp_f32 v126, v126
    v_rcp_f32 v127, v127
    v_mul_f32 v124, v124, v126
    v_mul_f32 v125, v125, v127
    v_cvt_pk_bf16_f32 v124, v124, v125
    v_lshlrev_b32 v98, 16, v124
    v_and_b32 v99, s3, v124
    v_lshlrev_b32 v124, 16, v8
    v_and_b32 v125, s3, v8
    v_mul_f32 v126, s18, v124
    v_mul_f32 v127, s18, v125
    v_exp_f32 v126, v126
    v_exp_f32 v127, v127
    v_add_f32 v126, 1.0, v126
    v_add_f32 v127, 1.0, v127
    v_rcp_f32 v126, v126
    v_rcp_f32 v127, v127
    v_mul_f32 v124, v124, v126
    v_mul_f32 v125, v125, v127
    v_cvt_pk_bf16_f32 v124, v124, v125
    v_lshlrev_b32 v100, 16, v124
    v_and_b32 v101, s3, v124
    v_lshlrev_b32 v124, 16, v9
    v_and_b32 v125, s3, v9
    v_mul_f32 v126, s18, v124
    v_mul_f32 v127, s18, v125
    v_exp_f32 v126, v126
    v_exp_f32 v127, v127
    v_add_f32 v126, 1.0, v126
    v_add_f32 v127, 1.0, v127
    v_rcp_f32 v126, v126
    v_rcp_f32 v127, v127
    v_mul_f32 v124, v124, v126
    v_mul_f32 v125, v125, v127
    v_cvt_pk_bf16_f32 v124, v124, v125
    v_lshlrev_b32 v102, 16, v124
    v_and_b32 v103, s3, v124
    s_waitcnt vmcnt(21)
    v_lshlrev_b32 v124, 16, v10
    v_and_b32 v125, s3, v10
    v_mul_f32 v126, s18, v124
    v_mul_f32 v127, s18, v125
    v_exp_f32 v126, v126
    v_exp_f32 v127, v127
    v_add_f32 v126, 1.0, v126
    v_add_f32 v127, 1.0, v127
    v_rcp_f32 v126, v126
    v_rcp_f32 v127, v127
    v_mul_f32 v124, v124, v126
    v_mul_f32 v125, v125, v127
    v_cvt_pk_bf16_f32 v124, v124, v125
    v_lshlrev_b32 v104, 16, v124
    v_and_b32 v105, s3, v124
    v_lshlrev_b32 v124, 16, v11
    v_and_b32 v125, s3, v11
    v_mul_f32 v126, s18, v124
    v_mul_f32 v127, s18, v125
    v_exp_f32 v126, v126
    v_exp_f32 v127, v127
    v_add_f32 v126, 1.0, v126
    v_add_f32 v127, 1.0, v127
    v_rcp_f32 v126, v126
    v_rcp_f32 v127, v127
    v_mul_f32 v124, v124, v126
    v_mul_f32 v125, v125, v127
    v_cvt_pk_bf16_f32 v124, v124, v125
    v_lshlrev_b32 v106, 16, v124
    v_and_b32 v107, s3, v124
    v_lshlrev_b32 v124, 16, v12
    v_and_b32 v125, s3, v12
    v_mul_f32 v126, s18, v124
    v_mul_f32 v127, s18, v125
    v_exp_f32 v126, v126
    v_exp_f32 v127, v127
    v_add_f32 v126, 1.0, v126
    v_add_f32 v127, 1.0, v127
    v_rcp_f32 v126, v126
    v_rcp_f32 v127, v127
    v_mul_f32 v124, v124, v126
    v_mul_f32 v125, v125, v127
    v_cvt_pk_bf16_f32 v124, v124, v125
    v_lshlrev_b32 v108, 16, v124
    v_and_b32 v109, s3, v124
    v_lshlrev_b32 v124, 16, v13
    v_and_b32 v125, s3, v13
    v_mul_f32 v126, s18, v124
    v_mul_f32 v127, s18, v125
    v_exp_f32 v126, v126
    v_exp_f32 v127, v127
    v_add_f32 v126, 1.0, v126
    v_add_f32 v127, 1.0, v127
    v_rcp_f32 v126, v126
    v_rcp_f32 v127, v127
    v_mul_f32 v124, v124, v126
    v_mul_f32 v125, v125, v127
    v_cvt_pk_bf16_f32 v124, v124, v125
    v_lshlrev_b32 v110, 16, v124
    v_and_b32 v111, s3, v124
    s_waitcnt vmcnt(20)
    v_lshlrev_b32 v124, 16, v14
    v_and_b32 v125, s3, v14
    v_mul_f32 v126, s18, v124
    v_mul_f32 v127, s18, v125
    v_exp_f32 v126, v126
    v_exp_f32 v127, v127
    v_add_f32 v126, 1.0, v126
    v_add_f32 v127, 1.0, v127
    v_rcp_f32 v126, v126
    v_rcp_f32 v127, v127
    v_mul_f32 v124, v124, v126
    v_mul_f32 v125, v125, v127
    v_cvt_pk_bf16_f32 v124, v124, v125
    v_lshlrev_b32 v112, 16, v124
    v_and_b32 v113, s3, v124
    v_lshlrev_b32 v124, 16, v15
    v_and_b32 v125, s3, v15
    v_mul_f32 v126, s18, v124
    v_mul_f32 v127, s18, v125
    v_exp_f32 v126, v126
    v_exp_f32 v127, v127
    v_add_f32 v126, 1.0, v126
    v_add_f32 v127, 1.0, v127
    v_rcp_f32 v126, v126
    v_rcp_f32 v127, v127
    v_mul_f32 v124, v124, v126
    v_mul_f32 v125, v125, v127
    v_cvt_pk_bf16_f32 v124, v124, v125
    v_lshlrev_b32 v114, 16, v124
    v_and_b32 v115, s3, v124
    buffer_load_dwordx2 v[232:233], off, s[44:47], 0 sc1
    s_waitcnt vmcnt(20)
    v_lshlrev_b32 v124, 16, v16
    v_and_b32 v125, s3, v16
    v_lshlrev_b32 v126, 16, v17
    v_and_b32 v127, s3, v17
    v_lshlrev_b32 v128, 16, v18
    v_and_b32 v129, s3, v18
    v_lshlrev_b32 v130, 16, v19
    v_and_b32 v131, s3, v19
    v_pk_mul_f32 v[116:117], v[124:125], v[96:97] op_sel:[0,0] op_sel_hi:[1,0]
    v_pk_mul_f32 v[118:119], v[126:127], v[96:97] op_sel:[0,0] op_sel_hi:[1,0]
    v_pk_mul_f32 v[120:121], v[128:129], v[96:97] op_sel:[0,0] op_sel_hi:[1,0]
    v_pk_mul_f32 v[122:123], v[130:131], v[96:97] op_sel:[0,0] op_sel_hi:[1,0]
    s_waitcnt vmcnt(19)
    v_lshlrev_b32 v124, 16, v20
    v_and_b32 v125, s3, v20
    v_lshlrev_b32 v126, 16, v21
    v_and_b32 v127, s3, v21
    v_lshlrev_b32 v128, 16, v22
    v_and_b32 v129, s3, v22
    v_lshlrev_b32 v130, 16, v23
    v_and_b32 v131, s3, v23
    v_pk_fma_f32 v[116:117], v[124:125], v[96:97], v[116:117] op_sel:[0,1,0] op_sel_hi:[1,1,1]
    v_pk_fma_f32 v[118:119], v[126:127], v[96:97], v[118:119] op_sel:[0,1,0] op_sel_hi:[1,1,1]
    v_pk_fma_f32 v[120:121], v[128:129], v[96:97], v[120:121] op_sel:[0,1,0] op_sel_hi:[1,1,1]
    v_pk_fma_f32 v[122:123], v[130:131], v[96:97], v[122:123] op_sel:[0,1,0] op_sel_hi:[1,1,1]
    s_waitcnt vmcnt(18)
    v_lshlrev_b32 v124, 16, v24
    v_and_b32 v125, s3, v24
    v_lshlrev_b32 v126, 16, v25
    v_and_b32 v127, s3, v25
    v_lshlrev_b32 v128, 16, v26
    v_and_b32 v129, s3, v26
    v_lshlrev_b32 v130, 16, v27
    v_and_b32 v131, s3, v27
    v_pk_fma_f32 v[116:117], v[124:125], v[98:99], v[116:117] op_sel:[0,0,0] op_sel_hi:[1,0,1]
    v_pk_fma_f32 v[118:119], v[126:127], v[98:99], v[118:119] op_sel:[0,0,0] op_sel_hi:[1,0,1]
    v_pk_fma_f32 v[120:121], v[128:129], v[98:99], v[120:121] op_sel:[0,0,0] op_sel_hi:[1,0,1]
    v_pk_fma_f32 v[122:123], v[130:131], v[98:99], v[122:123] op_sel:[0,0,0] op_sel_hi:[1,0,1]
    s_waitcnt vmcnt(17)
    v_lshlrev_b32 v124, 16, v28
    v_and_b32 v125, s3, v28
    v_lshlrev_b32 v126, 16, v29
    v_and_b32 v127, s3, v29
    v_lshlrev_b32 v128, 16, v30
    v_and_b32 v129, s3, v30
    v_lshlrev_b32 v130, 16, v31
    v_and_b32 v131, s3, v31
    v_pk_fma_f32 v[116:117], v[124:125], v[98:99], v[116:117] op_sel:[0,1,0] op_sel_hi:[1,1,1]
    v_pk_fma_f32 v[118:119], v[126:127], v[98:99], v[118:119] op_sel:[0,1,0] op_sel_hi:[1,1,1]
    v_pk_fma_f32 v[120:121], v[128:129], v[98:99], v[120:121] op_sel:[0,1,0] op_sel_hi:[1,1,1]
    v_pk_fma_f32 v[122:123], v[130:131], v[98:99], v[122:123] op_sel:[0,1,0] op_sel_hi:[1,1,1]
    s_waitcnt vmcnt(16)
    v_lshlrev_b32 v124, 16, v32
    v_and_b32 v125, s3, v32
    v_lshlrev_b32 v126, 16, v33
    v_and_b32 v127, s3, v33
    v_lshlrev_b32 v128, 16, v34
    v_and_b32 v129, s3, v34
    v_lshlrev_b32 v130, 16, v35
    v_and_b32 v131, s3, v35
    v_pk_fma_f32 v[116:117], v[124:125], v[100:101], v[116:117] op_sel:[0,0,0] op_sel_hi:[1,0,1]
    v_pk_fma_f32 v[118:119], v[126:127], v[100:101], v[118:119] op_sel:[0,0,0] op_sel_hi:[1,0,1]
    v_pk_fma_f32 v[120:121], v[128:129], v[100:101], v[120:121] op_sel:[0,0,0] op_sel_hi:[1,0,1]
    v_pk_fma_f32 v[122:123], v[130:131], v[100:101], v[122:123] op_sel:[0,0,0] op_sel_hi:[1,0,1]
    buffer_load_dword v142, v138, s[20:23], s28 offen offset:0
    buffer_load_dword v143, v138, s[20:23], s28 offen offset:3456
    s_add_u32 s28, s28, 6912
    s_waitcnt vmcnt(17)
    v_lshlrev_b32 v124, 16, v36
    v_and_b32 v125, s3, v36
    v_lshlrev_b32 v126, 16, v37
    v_and_b32 v127, s3, v37
    v_lshlrev_b32 v128, 16, v38
    v_and_b32 v129, s3, v38
    v_lshlrev_b32 v130, 16, v39
    v_and_b32 v131, s3, v39
    v_pk_fma_f32 v[116:117], v[124:125], v[100:101], v[116:117] op_sel:[0,1,0] op_sel_hi:[1,1,1]
    v_pk_fma_f32 v[118:119], v[126:127], v[100:101], v[118:119] op_sel:[0,1,0] op_sel_hi:[1,1,1]
    v_pk_fma_f32 v[120:121], v[128:129], v[100:101], v[120:121] op_sel:[0,1,0] op_sel_hi:[1,1,1]
    v_pk_fma_f32 v[122:123], v[130:131], v[100:101], v[122:123] op_sel:[0,1,0] op_sel_hi:[1,1,1]
    buffer_load_dword v144, v138, s[20:23], s28 offen offset:0
    buffer_load_dword v145, v138, s[20:23], s28 offen offset:3456
    s_add_u32 s28, s28, 6912
    s_waitcnt vmcnt(18)
    v_lshlrev_b32 v124, 16, v40
    v_and_b32 v125, s3, v40
    v_lshlrev_b32 v126, 16, v41
    v_and_b32 v127, s3, v41
    v_lshlrev_b32 v128, 16, v42
    v_and_b32 v129, s3, v42
    v_lshlrev_b32 v130, 16, v43
    v_and_b32 v131, s3, v43
    v_pk_fma_f32 v[116:117], v[124:125], v[102:103], v[116:117] op_sel:[0,0,0] op_sel_hi:[1,0,1]
    v_pk_fma_f32 v[118:119], v[126:127], v[102:103], v[118:119] op_sel:[0,0,0] op_sel_hi:[1,0,1]
    v_pk_fma_f32 v[120:121], v[128:129], v[102:103], v[120:121] op_sel:[0,0,0] op_sel_hi:[1,0,1]
    v_pk_fma_f32 v[122:123], v[130:131], v[102:103], v[122:123] op_sel:[0,0,0] op_sel_hi:[1,0,1]
    buffer_load_dword v146, v138, s[20:23], s28 offen offset:0
    buffer_load_dword v147, v138, s[20:23], s28 offen offset:3456
    s_add_u32 s28, s28, 6912
    s_waitcnt vmcnt(19)
    v_lshlrev_b32 v124, 16, v44
    v_and_b32 v125, s3, v44
    v_lshlrev_b32 v126, 16, v45
    v_and_b32 v127, s3, v45
    v_lshlrev_b32 v128, 16, v46
    v_and_b32 v129, s3, v46
    v_lshlrev_b32 v130, 16, v47
    v_and_b32 v131, s3, v47
    v_pk_fma_f32 v[116:117], v[124:125], v[102:103], v[116:117] op_sel:[0,1,0] op_sel_hi:[1,1,1]
    v_pk_fma_f32 v[118:119], v[126:127], v[102:103], v[118:119] op_sel:[0,1,0] op_sel_hi:[1,1,1]
    v_pk_fma_f32 v[120:121], v[128:129], v[102:103], v[120:121] op_sel:[0,1,0] op_sel_hi:[1,1,1]
    v_pk_fma_f32 v[122:123], v[130:131], v[102:103], v[122:123] op_sel:[0,1,0] op_sel_hi:[1,1,1]
    buffer_load_dword v148, v138, s[20:23], s28 offen offset:0
    buffer_load_dword v149, v138, s[20:23], s28 offen offset:3456
    s_add_u32 s28, s28, 6912
    s_waitcnt vmcnt(20)
    v_lshlrev_b32 v124, 16, v48
    v_and_b32 v125, s3, v48
    v_lshlrev_b32 v126, 16, v49
    v_and_b32 v127, s3, v49
    v_lshlrev_b32 v128, 16, v50
    v_and_b32 v129, s3, v50
    v_lshlrev_b32 v130, 16, v51
    v_and_b32 v131, s3, v51
    v_pk_fma_f32 v[116:117], v[124:125], v[104:105], v[116:117] op_sel:[0,0,0] op_sel_hi:[1,0,1]
    v_pk_fma_f32 v[118:119], v[126:127], v[104:105], v[118:119] op_sel:[0,0,0] op_sel_hi:[1,0,1]
    v_pk_fma_f32 v[120:121], v[128:129], v[104:105], v[120:121] op_sel:[0,0,0] op_sel_hi:[1,0,1]
    v_pk_fma_f32 v[122:123], v[130:131], v[104:105], v[122:123] op_sel:[0,0,0] op_sel_hi:[1,0,1]
    buffer_load_dword v150, v138, s[20:23], s28 offen offset:0
    buffer_load_dword v151, v138, s[20:23], s28 offen offset:3456
    s_add_u32 s28, s28, 6912
    s_waitcnt vmcnt(21)
    v_lshlrev_b32 v124, 16, v52
    v_and_b32 v125, s3, v52
    v_lshlrev_b32 v126, 16, v53
    v_and_b32 v127, s3, v53
    v_lshlrev_b32 v128, 16, v54
    v_and_b32 v129, s3, v54
    v_lshlrev_b32 v130, 16, v55
    v_and_b32 v131, s3, v55
    v_pk_fma_f32 v[116:117], v[124:125], v[104:105], v[116:117] op_sel:[0,1,0] op_sel_hi:[1,1,1]
    v_pk_fma_f32 v[118:119], v[126:127], v[104:105], v[118:119] op_sel:[0,1,0] op_sel_hi:[1,1,1]
    v_pk_fma_f32 v[120:121], v[128:129], v[104:105], v[120:121] op_sel:[0,1,0] op_sel_hi:[1,1,1]
    v_pk_fma_f32 v[122:123], v[130:131], v[104:105], v[122:123] op_sel:[0,1,0] op_sel_hi:[1,1,1]
    buffer_load_dword v152, v138, s[20:23], s28 offen offset:0
    buffer_load_dword v153, v138, s[20:23], s28 offen offset:3456
    s_add_u32 s28, s28, 6912
    s_waitcnt vmcnt(22)
    v_lshlrev_b32 v124, 16, v56
    v_and_b32 v125, s3, v56
    v_lshlrev_b32 v126, 16, v57
    v_and_b32 v127, s3, v57
    v_lshlrev_b32 v128, 16, v58
    v_and_b32 v129, s3, v58
    v_lshlrev_b32 v130, 16, v59
    v_and_b32 v131, s3, v59
    v_pk_fma_f32 v[116:117], v[124:125], v[106:107], v[116:117] op_sel:[0,0,0] op_sel_hi:[1,0,1]
    v_pk_fma_f32 v[118:119], v[126:127], v[106:107], v[118:119] op_sel:[0,0,0] op_sel_hi:[1,0,1]
    v_pk_fma_f32 v[120:121], v[128:129], v[106:107], v[120:121] op_sel:[0,0,0] op_sel_hi:[1,0,1]
    v_pk_fma_f32 v[122:123], v[130:131], v[106:107], v[122:123] op_sel:[0,0,0] op_sel_hi:[1,0,1]
    buffer_load_dword v154, v138, s[20:23], s28 offen offset:0
    buffer_load_dword v155, v138, s[20:23], s28 offen offset:3456
    s_add_u32 s28, s28, 6912
    s_waitcnt vmcnt(23)
    v_lshlrev_b32 v124, 16, v60
    v_and_b32 v125, s3, v60
    v_lshlrev_b32 v126, 16, v61
    v_and_b32 v127, s3, v61
    v_lshlrev_b32 v128, 16, v62
    v_and_b32 v129, s3, v62
    v_lshlrev_b32 v130, 16, v63
    v_and_b32 v131, s3, v63
    v_pk_fma_f32 v[116:117], v[124:125], v[106:107], v[116:117] op_sel:[0,1,0] op_sel_hi:[1,1,1]
    v_pk_fma_f32 v[118:119], v[126:127], v[106:107], v[118:119] op_sel:[0,1,0] op_sel_hi:[1,1,1]
    v_pk_fma_f32 v[120:121], v[128:129], v[106:107], v[120:121] op_sel:[0,1,0] op_sel_hi:[1,1,1]
    v_pk_fma_f32 v[122:123], v[130:131], v[106:107], v[122:123] op_sel:[0,1,0] op_sel_hi:[1,1,1]
    buffer_load_dword v156, v138, s[20:23], s28 offen offset:0
    buffer_load_dword v157, v138, s[20:23], s28 offen offset:3456
    s_add_u32 s28, s28, 6912
    s_waitcnt vmcnt(24)
    v_lshlrev_b32 v124, 16, v64
    v_and_b32 v125, s3, v64
    v_lshlrev_b32 v126, 16, v65
    v_and_b32 v127, s3, v65
    v_lshlrev_b32 v128, 16, v66
    v_and_b32 v129, s3, v66
    v_lshlrev_b32 v130, 16, v67
    v_and_b32 v131, s3, v67
    v_pk_fma_f32 v[116:117], v[124:125], v[108:109], v[116:117] op_sel:[0,0,0] op_sel_hi:[1,0,1]
    v_pk_fma_f32 v[118:119], v[126:127], v[108:109], v[118:119] op_sel:[0,0,0] op_sel_hi:[1,0,1]
    v_pk_fma_f32 v[120:121], v[128:129], v[108:109], v[120:121] op_sel:[0,0,0] op_sel_hi:[1,0,1]
    v_pk_fma_f32 v[122:123], v[130:131], v[108:109], v[122:123] op_sel:[0,0,0] op_sel_hi:[1,0,1]
    buffer_load_dword v158, v138, s[20:23], s28 offen offset:0
    buffer_load_dword v159, v138, s[20:23], s28 offen offset:3456
    s_add_u32 s28, s28, 6912
    s_waitcnt vmcnt(25)
    v_lshlrev_b32 v124, 16, v68
    v_and_b32 v125, s3, v68
    v_lshlrev_b32 v126, 16, v69
    v_and_b32 v127, s3, v69
    v_lshlrev_b32 v128, 16, v70
    v_and_b32 v129, s3, v70
    v_lshlrev_b32 v130, 16, v71
    v_and_b32 v131, s3, v71
    v_pk_fma_f32 v[116:117], v[124:125], v[108:109], v[116:117] op_sel:[0,1,0] op_sel_hi:[1,1,1]
    v_pk_fma_f32 v[118:119], v[126:127], v[108:109], v[118:119] op_sel:[0,1,0] op_sel_hi:[1,1,1]
    v_pk_fma_f32 v[120:121], v[128:129], v[108:109], v[120:121] op_sel:[0,1,0] op_sel_hi:[1,1,1]
    v_pk_fma_f32 v[122:123], v[130:131], v[108:109], v[122:123] op_sel:[0,1,0] op_sel_hi:[1,1,1]
    buffer_load_dword v160, v138, s[20:23], s28 offen offset:0
    buffer_load_dword v161, v138, s[20:23], s28 offen offset:3456
    s_add_u32 s28, s28, 6912
    s_waitcnt vmcnt(26)
    v_lshlrev_b32 v124, 16, v72
    v_and_b32 v125, s3, v72
    v_lshlrev_b32 v126, 16, v73
    v_and_b32 v127, s3, v73
    v_lshlrev_b32 v128, 16, v74
    v_and_b32 v129, s3, v74
    v_lshlrev_b32 v130, 16, v75
    v_and_b32 v131, s3, v75
    v_pk_fma_f32 v[116:117], v[124:125], v[110:111], v[116:117] op_sel:[0,0,0] op_sel_hi:[1,0,1]
    v_pk_fma_f32 v[118:119], v[126:127], v[110:111], v[118:119] op_sel:[0,0,0] op_sel_hi:[1,0,1]
    v_pk_fma_f32 v[120:121], v[128:129], v[110:111], v[120:121] op_sel:[0,0,0] op_sel_hi:[1,0,1]
    v_pk_fma_f32 v[122:123], v[130:131], v[110:111], v[122:123] op_sel:[0,0,0] op_sel_hi:[1,0,1]
    buffer_load_dword v162, v138, s[20:23], s28 offen offset:0
    buffer_load_dword v163, v138, s[20:23], s28 offen offset:3456
    s_add_u32 s28, s28, 6912
    s_waitcnt vmcnt(27)
    v_lshlrev_b32 v124, 16, v76
    v_and_b32 v125, s3, v76
    v_lshlrev_b32 v126, 16, v77
    v_and_b32 v127, s3, v77
    v_lshlrev_b32 v128, 16, v78
    v_and_b32 v129, s3, v78
    v_lshlrev_b32 v130, 16, v79
    v_and_b32 v131, s3, v79
    v_pk_fma_f32 v[116:117], v[124:125], v[110:111], v[116:117] op_sel:[0,1,0] op_sel_hi:[1,1,1]
    v_pk_fma_f32 v[118:119], v[126:127], v[110:111], v[118:119] op_sel:[0,1,0] op_sel_hi:[1,1,1]
    v_pk_fma_f32 v[120:121], v[128:129], v[110:111], v[120:121] op_sel:[0,1,0] op_sel_hi:[1,1,1]
    v_pk_fma_f32 v[122:123], v[130:131], v[110:111], v[122:123] op_sel:[0,1,0] op_sel_hi:[1,1,1]
    buffer_load_dword v164, v138, s[20:23], s28 offen offset:0
    buffer_load_dword v165, v138, s[20:23], s28 offen offset:3456
    s_add_u32 s28, s28, 6912
    s_waitcnt vmcnt(28)
    v_lshlrev_b32 v124, 16, v80
    v_and_b32 v125, s3, v80
    v_lshlrev_b32 v126, 16, v81
    v_and_b32 v127, s3, v81
    v_lshlrev_b32 v128, 16, v82
    v_and_b32 v129, s3, v82
    v_lshlrev_b32 v130, 16, v83
    v_and_b32 v131, s3, v83
    v_pk_fma_f32 v[116:117], v[124:125], v[112:113], v[116:117] op_sel:[0,0,0] op_sel_hi:[1,0,1]
    v_pk_fma_f32 v[118:119], v[126:127], v[112:113], v[118:119] op_sel:[0,0,0] op_sel_hi:[1,0,1]
    v_pk_fma_f32 v[120:121], v[128:129], v[112:113], v[120:121] op_sel:[0,0,0] op_sel_hi:[1,0,1]
    v_pk_fma_f32 v[122:123], v[130:131], v[112:113], v[122:123] op_sel:[0,0,0] op_sel_hi:[1,0,1]
    buffer_load_dword v166, v138, s[20:23], s28 offen offset:0
    buffer_load_dword v167, v138, s[20:23], s28 offen offset:3456
    s_add_u32 s28, s28, 6912
    s_waitcnt vmcnt(29)
    v_lshlrev_b32 v124, 16, v84
    v_and_b32 v125, s3, v84
    v_lshlrev_b32 v126, 16, v85
    v_and_b32 v127, s3, v85
    v_lshlrev_b32 v128, 16, v86
    v_and_b32 v129, s3, v86
    v_lshlrev_b32 v130, 16, v87
    v_and_b32 v131, s3, v87
    v_pk_fma_f32 v[116:117], v[124:125], v[112:113], v[116:117] op_sel:[0,1,0] op_sel_hi:[1,1,1]
    v_pk_fma_f32 v[118:119], v[126:127], v[112:113], v[118:119] op_sel:[0,1,0] op_sel_hi:[1,1,1]
    v_pk_fma_f32 v[120:121], v[128:129], v[112:113], v[120:121] op_sel:[0,1,0] op_sel_hi:[1,1,1]
    v_pk_fma_f32 v[122:123], v[130:131], v[112:113], v[122:123] op_sel:[0,1,0] op_sel_hi:[1,1,1]
    buffer_load_dword v168, v138, s[20:23], s28 offen offset:0
    buffer_load_dword v169, v138, s[20:23], s28 offen offset:3456
    s_add_u32 s28, s28, 6912
    s_waitcnt vmcnt(30)
    v_lshlrev_b32 v124, 16, v88
    v_and_b32 v125, s3, v88
    v_lshlrev_b32 v126, 16, v89
    v_and_b32 v127, s3, v89
    v_lshlrev_b32 v128, 16, v90
    v_and_b32 v129, s3, v90
    v_lshlrev_b32 v130, 16, v91
    v_and_b32 v131, s3, v91
    v_pk_fma_f32 v[116:117], v[124:125], v[114:115], v[116:117] op_sel:[0,0,0] op_sel_hi:[1,0,1]
    v_pk_fma_f32 v[118:119], v[126:127], v[114:115], v[118:119] op_sel:[0,0,0] op_sel_hi:[1,0,1]
    v_pk_fma_f32 v[120:121], v[128:129], v[114:115], v[120:121] op_sel:[0,0,0] op_sel_hi:[1,0,1]
    v_pk_fma_f32 v[122:123], v[130:131], v[114:115], v[122:123] op_sel:[0,0,0] op_sel_hi:[1,0,1]
    buffer_load_dword v170, v138, s[20:23], s28 offen offset:0
    buffer_load_dword v171, v138, s[20:23], s28 offen offset:3456
    s_add_u32 s28, s28, 6912
    s_waitcnt vmcnt(31)
    v_lshlrev_b32 v124, 16, v92
    v_and_b32 v125, s3, v92
    v_lshlrev_b32 v126, 16, v93
    v_and_b32 v127, s3, v93
    v_lshlrev_b32 v128, 16, v94
    v_and_b32 v129, s3, v94
    v_lshlrev_b32 v130, 16, v95
    v_and_b32 v131, s3, v95
    v_pk_fma_f32 v[116:117], v[124:125], v[114:115], v[116:117] op_sel:[0,1,0] op_sel_hi:[1,1,1]
    v_pk_fma_f32 v[118:119], v[126:127], v[114:115], v[118:119] op_sel:[0,1,0] op_sel_hi:[1,1,1]
    v_pk_fma_f32 v[120:121], v[128:129], v[114:115], v[120:121] op_sel:[0,1,0] op_sel_hi:[1,1,1]
    v_pk_fma_f32 v[122:123], v[130:131], v[114:115], v[122:123] op_sel:[0,1,0] op_sel_hi:[1,1,1]
    buffer_load_dword v172, v138, s[20:23], s28 offen offset:0
    buffer_load_dword v173, v138, s[20:23], s28 offen offset:3456
    v_lshlrev_b32 v5, 5, v0
    ds_write_b128 v5, v[116:119]
    ds_write_b128 v5, v[120:123] offset:16
    s_waitcnt lgkmcnt(0)
    s_barrier
    v_lshrrev_b32 v5, 6, v0
    s_nop 0
    v_readfirstlane_b32 s17, v5
    s_nop 0
    s_cmp_lg_u32 s17, 0
    s_cbranch_scc1 L_adaL_gemv_done_38
    v_lshlrev_b32 v5, 2, v0
    ds_read2st64_b32 v[16:17], v5 offset0:0 offset1:1
    ds_read2st64_b32 v[20:21], v5 offset0:2 offset1:3
    ds_read2st64_b32 v[24:25], v5 offset0:4 offset1:5
    ds_read2st64_b32 v[28:29], v5 offset0:6 offset1:7
    ds_read2st64_b32 v[32:33], v5 offset0:8 offset1:9
    ds_read2st64_b32 v[36:37], v5 offset0:10 offset1:11
    ds_read2st64_b32 v[40:41], v5 offset0:12 offset1:13
    ds_read2st64_b32 v[44:45], v5 offset0:14 offset1:15
    ds_read2st64_b32 v[48:49], v5 offset0:16 offset1:17
    ds_read2st64_b32 v[52:53], v5 offset0:18 offset1:19
    ds_read2st64_b32 v[56:57], v5 offset0:20 offset1:21
    ds_read2st64_b32 v[60:61], v5 offset0:22 offset1:23
    ds_read2st64_b32 v[64:65], v5 offset0:24 offset1:25
    ds_read2st64_b32 v[68:69], v5 offset0:26 offset1:27
    ds_read2st64_b32 v[72:73], v5 offset0:28 offset1:29
    ds_read2st64_b32 v[76:77], v5 offset0:30 offset1:31
    s_waitcnt lgkmcnt(14)
    v_pk_add_f32 v[16:17], v[16:17], v[20:21]
    s_waitcnt lgkmcnt(13)
    v_pk_add_f32 v[16:17], v[16:17], v[24:25]
    s_waitcnt lgkmcnt(12)
    v_pk_add_f32 v[16:17], v[16:17], v[28:29]
    s_waitcnt lgkmcnt(11)
    v_pk_add_f32 v[16:17], v[16:17], v[32:33]
    s_waitcnt lgkmcnt(10)
    v_pk_add_f32 v[16:17], v[16:17], v[36:37]
    s_waitcnt lgkmcnt(9)
    v_pk_add_f32 v[16:17], v[16:17], v[40:41]
    s_waitcnt lgkmcnt(8)
    v_pk_add_f32 v[16:17], v[16:17], v[44:45]
    s_waitcnt lgkmcnt(7)
    v_pk_add_f32 v[16:17], v[16:17], v[48:49]
    s_waitcnt lgkmcnt(6)
    v_pk_add_f32 v[16:17], v[16:17], v[52:53]
    s_waitcnt lgkmcnt(5)
    v_pk_add_f32 v[16:17], v[16:17], v[56:57]
    s_waitcnt lgkmcnt(4)
    v_pk_add_f32 v[16:17], v[16:17], v[60:61]
    s_waitcnt lgkmcnt(3)
    v_pk_add_f32 v[16:17], v[16:17], v[64:65]
    s_waitcnt lgkmcnt(2)
    v_pk_add_f32 v[16:17], v[16:17], v[68:69]
    s_waitcnt lgkmcnt(1)
    v_pk_add_f32 v[16:17], v[16:17], v[72:73]
    s_waitcnt lgkmcnt(0)
    v_pk_add_f32 v[16:17], v[16:17], v[76:77]
    v_add_f32 v124, v16, v17
    v_cvt_pk_bf16_f32 v124, v124, v124
    v_lshlrev_b32 v124, 16, v124
    s_cmp_ge_u32 s16, 30
    s_cselect_b32 s17, 30, 0
    s_sub_u32 s17, s16, s17
    s_sub_u32 s17, s17, 10
    s_cmp_lt_u32 s17, 10
    s_cselect_b32 s17, 1.0, 0
    v_add_f32 v124, s17, v124
    v_cvt_pk_bf16_f32 v124, v124, v124
    v_lshlrev_b32 v124, 16, v124
    s_lshl_b32 s17, s16, 8
    buffer_store_dword v124, v5, s[4:7], s17 offen offset:0 sc1
    s_mov_b32 s49, 65536
L_adaL_tagpoll_39:
    s_waitcnt vmcnt(33)
    v_readfirstlane_b32 s48, v232
    s_nop 0
    s_cmp_lg_u32 s48, 0
    s_cbranch_scc1 L_adaL_taggot_40
    buffer_load_dwordx2 v[232:233], off, s[44:47], 0 sc1
    s_waitcnt vmcnt(0)
    s_sub_u32 s49, s49, 1
    s_cmp_lg_u32 s49, 0
    s_cbranch_scc1 L_adaL_tagpoll_39
L_adaL_taggot_40:
    v_mov_b32 v232, v124
    v_lshlrev_b32 v5, 3, v0
    s_lshl_b32 s17, s16, 9
    s_add_u32 s17, s17, 32768
    buffer_store_dwordx2 v[232:233], v5, s[4:7], s17 offen sc1
    v_mov_b32 v232, v233
L_adaL_gemv_done_38:
    s_branch L_adaL_join_33
L_adaL_stats_31:
    s_cmp_ge_u32 s2, 252
    s_cbranch_scc1 L_adaL_reset_34
    s_load_dwordx2 s[8:9], s[0:1], 0
    s_mov_b32 s10, 2621440
    s_mov_b32 s11, 0x20000
    s_sub_u32 s12, s2, 220
    s_mul_i32 s13, s12, 81920
    s_add_u32 s14, s13, 5120
    s_add_u32 s15, s13, 10240
    s_add_u32 s16, s13, 15360
    s_mov_b32 s17, 0x3f803f80
    v_lshrrev_b32 v2, 6, v0
    v_bfe_u32 v4, v0, 4, 2
    v_lshl_add_u32 v1, v2, 4, v4
    v_mul_u32_u24 v1, 1280, v1
    v_and_b32 v3, 15, v0
    v_lshl_add_u32 v1, v3, 4, v1
    s_waitcnt lgkmcnt(0)
    buffer_load_dwordx4 v[6:9], v1, s[8:11], s13 offen offset:0
    buffer_load_dwordx4 v[10:13], v1, s[8:11], s13 offen offset:256
    buffer_load_dwordx4 v[14:17], v1, s[8:11], s13 offen offset:512
    buffer_load_dwordx4 v[18:21], v1, s[8:11], s13 offen offset:768
    buffer_load_dwordx4 v[22:25], v1, s[8:11], s13 offen offset:1024
    buffer_load_dwordx4 v[26:29], v1, s[8:11], s14 offen offset:0
    buffer_load_dwordx4 v[30:33], v1, s[8:11], s14 offen offset:256
    buffer_load_dwordx4 v[34:37], v1, s[8:11], s14 offen offset:512
    buffer_load_dwordx4 v[38:41], v1, s[8:11], s14 offen offset:768
    buffer_load_dwordx4 v[42:45], v1, s[8:11], s14 offen offset:1024
    buffer_load_dwordx4 v[46:49], v1, s[8:11], s15 offen offset:0
    buffer_load_dwordx4 v[50:53], v1, s[8:11], s15 offen offset:256
    buffer_load_dwordx4 v[54:57], v1, s[8:11], s15 offen offset:512
    buffer_load_dwordx4 v[58:61], v1, s[8:11], s15 offen offset:768
    buffer_load_dwordx4 v[62:65], v1, s[8:11], s15 offen offset:1024
    buffer_load_dwordx4 v[66:69], v1, s[8:11], s16 offen offset:0
    buffer_load_dwordx4 v[70:73], v1, s[8:11], s16 offen offset:256
    buffer_load_dwordx4 v[74:77], v1, s[8:11], s16 offen offset:512
    buffer_load_dwordx4 v[78:81], v1, s[8:11], s16 offen offset:768
    buffer_load_dwordx4 v[82:85], v1, s[8:11], s16 offen offset:1024
    buffer_load_dwordx2 v[232:233], off, s[44:47], 0 sc1
    v_cmp_eq_u32 vcc, 0, v3
    v_lshrrev_b32 v3, 1, v2
    v_lshlrev_b32 v3, 8, v3
    v_and_b32 v2, 1, v2
    v_lshl_add_u32 v3, v2, 6, v3
    v_and_b32 v2, 1, v4
    v_lshl_add_u32 v3, v2, 7, v3
    v_lshrrev_b32 v2, 1, v4
    v_lshl_add_u32 v3, v2, 2, v3
    s_lshl_b32 s13, s12, 9
    s_add_u32 s13, s13, 16384
    v_mov_b32 v86, 0
    v_mov_b32 v90, 0
    v_mov_b32 v87, 0
    v_mov_b32 v91, 0
    v_mov_b32 v88, 0
    v_mov_b32 v92, 0
    v_mov_b32 v89, 0
    v_mov_b32 v93, 0
    s_waitcnt vmcnt(20)
    v_dot2c_f32_bf16 v86, s17, v6
    v_dot2c_f32_bf16 v90, v6, v6
    v_dot2c_f32_bf16 v86, s17, v7
    v_dot2c_f32_bf16 v90, v7, v7
    v_dot2c_f32_bf16 v86, s17, v8
    v_dot2c_f32_bf16 v90, v8, v8
    v_dot2c_f32_bf16 v86, s17, v9
    v_dot2c_f32_bf16 v90, v9, v9
    s_waitcnt vmcnt(19)
    v_dot2c_f32_bf16 v86, s17, v10
    v_dot2c_f32_bf16 v90, v10, v10
    v_dot2c_f32_bf16 v86, s17, v11
    v_dot2c_f32_bf16 v90, v11, v11
    v_dot2c_f32_bf16 v86, s17, v12
    v_dot2c_f32_bf16 v90, v12, v12
    v_dot2c_f32_bf16 v86, s17, v13
    v_dot2c_f32_bf16 v90, v13, v13
    s_waitcnt vmcnt(18)
    v_dot2c_f32_bf16 v86, s17, v14
    v_dot2c_f32_bf16 v90, v14, v14
    v_dot2c_f32_bf16 v86, s17, v15
    v_dot2c_f32_bf16 v90, v15, v15
    v_dot2c_f32_bf16 v86, s17, v16
    v_dot2c_f32_bf16 v90, v16, v16
    v_dot2c_f32_bf16 v86, s17, v17
    v_dot2c_f32_bf16 v90, v17, v17
    s_waitcnt vmcnt(17)
    v_dot2c_f32_bf16 v86, s17, v18
    v_dot2c_f32_bf16 v90, v18, v18
    v_dot2c_f32_bf16 v86, s17, v19
    v_dot2c_f32_bf16 v90, v19, v19
    v_dot2c_f32_bf16 v86, s17, v20
    v_dot2c_f32_bf16 v90, v20, v20
    v_dot2c_f32_bf16 v86, s17, v21
    v_dot2c_f32_bf16 v90, v21, v21
    s_waitcnt vmcnt(16)
    v_dot2c_f32_bf16 v86, s17, v22
    v_dot2c_f32_bf16 v90, v22, v22
    v_dot2c_f32_bf16 v86, s17, v23
    v_dot2c_f32_bf16 v90, v23, v23
    v_dot2c_f32_bf16 v86, s17, v24
    v_dot2c_f32_bf16 v90, v24, v24
    v_dot2c_f32_bf16 v86, s17, v25
    v_dot2c_f32_bf16 v90, v25, v25
    s_waitcnt vmcnt(15)
    v_dot2c_f32_bf16 v87, s17, v26
    v_dot2c_f32_bf16 v91, v26, v26
    v_dot2c_f32_bf16 v87, s17, v27
    v_dot2c_f32_bf16 v91, v27, v27
    v_dot2c_f32_bf16 v87, s17, v28
    v_dot2c_f32_bf16 v91, v28, v28
    v_dot2c_f32_bf16 v87, s17, v29
    v_dot2c_f32_bf16 v91, v29, v29
    s_waitcnt vmcnt(14)
    v_dot2c_f32_bf16 v87, s17, v30
    v_dot2c_f32_bf16 v91, v30, v30
    v_dot2c_f32_bf16 v87, s17, v31
    v_dot2c_f32_bf16 v91, v31, v31
    v_dot2c_f32_bf16 v87, s17, v32
    v_dot2c_f32_bf16 v91, v32, v32
    v_dot2c_f32_bf16 v87, s17, v33
    v_dot2c_f32_bf16 v91, v33, v33
    s_waitcnt vmcnt(13)
    v_dot2c_f32_bf16 v87, s17, v34
    v_dot2c_f32_bf16 v91, v34, v34
    v_dot2c_f32_bf16 v87, s17, v35
    v_dot2c_f32_bf16 v91, v35, v35
    v_dot2c_f32_bf16 v87, s17, v36
    v_dot2c_f32_bf16 v91, v36, v36
    v_dot2c_f32_bf16 v87, s17, v37
    v_dot2c_f32_bf16 v91, v37, v37
    s_waitcnt vmcnt(12)
    v_dot2c_f32_bf16 v87, s17, v38
    v_dot2c_f32_bf16 v91, v38, v38
    v_dot2c_f32_bf16 v87, s17, v39
    v_dot2c_f32_bf16 v91, v39, v39
    v_dot2c_f32_bf16 v87, s17, v40
    v_dot2c_f32_bf16 v91, v40, v40
    v_dot2c_f32_bf16 v87, s17, v41
    v_dot2c_f32_bf16 v91, v41, v41
    s_waitcnt vmcnt(11)
    v_dot2c_f32_bf16 v87, s17, v42
    v_dot2c_f32_bf16 v91, v42, v42
    v_dot2c_f32_bf16 v87, s17, v43
    v_dot2c_f32_bf16 v91, v43, v43
    v_dot2c_f32_bf16 v87, s17, v44
    v_dot2c_f32_bf16 v91, v44, v44
    v_dot2c_f32_bf16 v87, s17, v45
    v_dot2c_f32_bf16 v91, v45, v45
    s_waitcnt vmcnt(10)
    v_dot2c_f32_bf16 v88, s17, v46
    v_dot2c_f32_bf16 v92, v46, v46
    v_dot2c_f32_bf16 v88, s17, v47
    v_dot2c_f32_bf16 v92, v47, v47
    v_dot2c_f32_bf16 v88, s17, v48
    v_dot2c_f32_bf16 v92, v48, v48
    v_dot2c_f32_bf16 v88, s17, v49
    v_dot2c_f32_bf16 v92, v49, v49
    s_waitcnt vmcnt(9)
    v_dot2c_f32_bf16 v88, s17, v50
    v_dot2c_f32_bf16 v92, v50, v50
    v_dot2c_f32_bf16 v88, s17, v51
    v_dot2c_f32_bf16 v92, v51, v51
    v_dot2c_f32_bf16 v88, s17, v52
    v_dot2c_f32_bf16 v92, v52, v52
    v_dot2c_f32_bf16 v88, s17, v53
    v_dot2c_f32_bf16 v92, v53, v53
    s_waitcnt vmcnt(8)
    v_dot2c_f32_bf16 v88, s17, v54
    v_dot2c_f32_bf16 v92, v54, v54
    v_dot2c_f32_bf16 v88, s17, v55
    v_dot2c_f32_bf16 v92, v55, v55
    v_dot2c_f32_bf16 v88, s17, v56
    v_dot2c_f32_bf16 v92, v56, v56
    v_dot2c_f32_bf16 v88, s17, v57
    v_dot2c_f32_bf16 v92, v57, v57
    s_waitcnt vmcnt(7)
    v_dot2c_f32_bf16 v88, s17, v58
    v_dot2c_f32_bf16 v92, v58, v58
    v_dot2c_f32_bf16 v88, s17, v59
    v_dot2c_f32_bf16 v92, v59, v59
    v_dot2c_f32_bf16 v88, s17, v60
    v_dot2c_f32_bf16 v92, v60, v60
    v_dot2c_f32_bf16 v88, s17, v61
    v_dot2c_f32_bf16 v92, v61, v61
    s_waitcnt vmcnt(6)
    v_dot2c_f32_bf16 v88, s17, v62
    v_dot2c_f32_bf16 v92, v62, v62
    v_dot2c_f32_bf16 v88, s17, v63
    v_dot2c_f32_bf16 v92, v63, v63
    v_dot2c_f32_bf16 v88, s17, v64
    v_dot2c_f32_bf16 v92, v64, v64
    v_dot2c_f32_bf16 v88, s17, v65
    v_dot2c_f32_bf16 v92, v65, v65
    s_waitcnt vmcnt(5)
    v_dot2c_f32_bf16 v89, s17, v66
    v_dot2c_f32_bf16 v93, v66, v66
    v_dot2c_f32_bf16 v89, s17, v67
    v_dot2c_f32_bf16 v93, v67, v67
    v_dot2c_f32_bf16 v89, s17, v68
    v_dot2c_f32_bf16 v93, v68, v68
    v_dot2c_f32_bf16 v89, s17, v69
    v_dot2c_f32_bf16 v93, v69, v69
    s_waitcnt vmcnt(4)
    v_dot2c_f32_bf16 v89, s17, v70
    v_dot2c_f32_bf16 v93, v70, v70
    v_dot2c_f32_bf16 v89, s17, v71
    v_dot2c_f32_bf16 v93, v71, v71
    v_dot2c_f32_bf16 v89, s17, v72
    v_dot2c_f32_bf16 v93, v72, v72
    v_dot2c_f32_bf16 v89, s17, v73
    v_dot2c_f32_bf16 v93, v73, v73
    s_waitcnt vmcnt(3)
    v_dot2c_f32_bf16 v89, s17, v74
    v_dot2c_f32_bf16 v93, v74, v74
    v_dot2c_f32_bf16 v89, s17, v75
    v_dot2c_f32_bf16 v93, v75, v75
    v_dot2c_f32_bf16 v89, s17, v76
    v_dot2c_f32_bf16 v93, v76, v76
    v_dot2c_f32_bf16 v89, s17, v77
    v_dot2c_f32_bf16 v93, v77, v77
    s_waitcnt vmcnt(2)
    v_dot2c_f32_bf16 v89, s17, v78
    v_dot2c_f32_bf16 v93, v78, v78
    v_dot2c_f32_bf16 v89, s17, v79
    v_dot2c_f32_bf16 v93, v79, v79
    v_dot2c_f32_bf16 v89, s17, v80
    v_dot2c_f32_bf16 v93, v80, v80
    v_dot2c_f32_bf16 v89, s17, v81
    v_dot2c_f32_bf16 v93, v81, v81
    s_waitcnt vmcnt(1)
    v_dot2c_f32_bf16 v89, s17, v82
    v_dot2c_f32_bf16 v93, v82, v82
    v_dot2c_f32_bf16 v89, s17, v83
    v_dot2c_f32_bf16 v93, v83, v83
    v_dot2c_f32_bf16 v89, s17, v84
    v_dot2c_f32_bf16 v93, v84, v84
    v_dot2c_f32_bf16 v89, s17, v85
    v_dot2c_f32_bf16 v93, v85, v85
    v_add_f32_dpp v86, v86, v86 row_ror:8 row_mask:0xf bank_mask:0xf
    v_add_f32_dpp v90, v90, v90 row_ror:8 row_mask:0xf bank_mask:0xf
    v_add_f32_dpp v87, v87, v87 row_ror:8 row_mask:0xf bank_mask:0xf
    v_add_f32_dpp v91, v91, v91 row_ror:8 row_mask:0xf bank_mask:0xf
    v_add_f32_dpp v88, v88, v88 row_ror:8 row_mask:0xf bank_mask:0xf
    v_add_f32_dpp v92, v92, v92 row_ror:8 row_mask:0xf bank_mask:0xf
    v_add_f32_dpp v89, v89, v89 row_ror:8 row_mask:0xf bank_mask:0xf
    v_add_f32_dpp v93, v93, v93 row_ror:8 row_mask:0xf bank_mask:0xf
    v_add_f32_dpp v86, v86, v86 row_ror:4 row_mask:0xf bank_mask:0xf
    v_add_f32_dpp v90, v90, v90 row_ror:4 row_mask:0xf bank_mask:0xf
    v_add_f32_dpp v87, v87, v87 row_ror:4 row_mask:0xf bank_mask:0xf
    v_add_f32_dpp v91, v91, v91 row_ror:4 row_mask:0xf bank_mask:0xf
    v_add_f32_dpp v88, v88, v88 row_ror:4 row_mask:0xf bank_mask:0xf
    v_add_f32_dpp v92, v92, v92 row_ror:4 row_mask:0xf bank_mask:0xf
    v_add_f32_dpp v89, v89, v89 row_ror:4 row_mask:0xf bank_mask:0xf
    v_add_f32_dpp v93, v93, v93 row_ror:4 row_mask:0xf bank_mask:0xf
    v_add_f32_dpp v86, v86, v86 row_ror:2 row_mask:0xf bank_mask:0xf
    v_add_f32_dpp v90, v90, v90 row_ror:2 row_mask:0xf bank_mask:0xf
    v_add_f32_dpp v87, v87, v87 row_ror:2 row_mask:0xf bank_mask:0xf
    v_add_f32_dpp v91, v91, v91 row_ror:2 row_mask:0xf bank_mask:0xf
    v_add_f32_dpp v88, v88, v88 row_ror:2 row_mask:0xf bank_mask:0xf
    v_add_f32_dpp v92, v92, v92 row_ror:2 row_mask:0xf bank_mask:0xf
    v_add_f32_dpp v89, v89, v89 row_ror:2 row_mask:0xf bank_mask:0xf
    v_add_f32_dpp v93, v93, v93 row_ror:2 row_mask:0xf bank_mask:0xf
    v_add_f32_dpp v86, v86, v86 row_ror:1 row_mask:0xf bank_mask:0xf
    v_add_f32_dpp v90, v90, v90 row_ror:1 row_mask:0xf bank_mask:0xf
    v_add_f32_dpp v87, v87, v87 row_ror:1 row_mask:0xf bank_mask:0xf
    v_add_f32_dpp v91, v91, v91 row_ror:1 row_mask:0xf bank_mask:0xf
    v_add_f32_dpp v88, v88, v88 row_ror:1 row_mask:0xf bank_mask:0xf
    v_add_f32_dpp v92, v92, v92 row_ror:1 row_mask:0xf bank_mask:0xf
    v_add_f32_dpp v89, v89, v89 row_ror:1 row_mask:0xf bank_mask:0xf
    v_add_f32_dpp v93, v93, v93 row_ror:1 row_mask:0xf bank_mask:0xf
    v_mul_f32 v86, 0x3acccccd, v86
    v_mul_f32 v90, 0x3acccccd, v90
    v_mul_f32 v87, 0x3acccccd, v87
    v_mul_f32 v91, 0x3acccccd, v91
    v_mul_f32 v88, 0x3acccccd, v88
    v_mul_f32 v92, 0x3acccccd, v92
    v_mul_f32 v89, 0x3acccccd, v89
    v_mul_f32 v93, 0x3acccccd, v93
    v_fma_f32 v90, -v86, v86, v90
    v_max_f32 v90, 0, v90
    v_add_f32 v90, 0x3727c5ac, v90
    v_rsq_f32 v90, v90
    v_fma_f32 v91, -v87, v87, v91
    v_max_f32 v91, 0, v91
    v_add_f32 v91, 0x3727c5ac, v91
    v_rsq_f32 v91, v91
    v_fma_f32 v92, -v88, v88, v92
    v_max_f32 v92, 0, v92
    v_add_f32 v92, 0x3727c5ac, v92
    v_rsq_f32 v92, v92
    v_fma_f32 v93, -v89, v89, v93
    v_max_f32 v93, 0, v93
    v_add_f32 v93, 0x3727c5ac, v93
    v_rsq_f32 v93, v93
    v_mul_f32 v94, -v86, v90
    v_mul_f32 v95, -v87, v91
    v_mul_f32 v96, -v88, v92
    v_mul_f32 v97, -v89, v93
    s_and_b64 exec, exec, vcc
    ds_write2_b32 v3, v90, v94 offset0:0 offset1:2
    ds_write2_b32 v3, v91, v95 offset0:4 offset1:6
    ds_write2_b32 v3, v92, v96 offset0:8 offset1:10
    ds_write2_b32 v3, v93, v97 offset0:12 offset1:14
    s_mov_b64 exec, -1
    v_lshlrev_b32 v3, 3, v0
    v_cmp_gt_u32 vcc, 64, v0
    v_mov_b32 v2, 2147483648
    s_nop 0
    v_cndmask_b32 v1, v2, v3, vcc
    s_waitcnt lgkmcnt(0)
    s_barrier
    ds_read_b64 v[94:95], v3
    s_waitcnt lgkmcnt(0)
    buffer_store_dwordx2 v[94:95], v1, s[4:7], s13 offen sc1
    s_cmp_lg_u32 s39, 0
    s_cbranch_scc1 L_adaL_nopost_41
    s_mov_b32 s49, 65536
L_adaL_tagpoll_42:
    s_waitcnt vmcnt(1)
    v_readfirstlane_b32 s48, v232
    s_nop 0
    s_cmp_lg_u32 s48, 0
    s_cbranch_scc1 L_adaL_taggot_43
    buffer_load_dwordx2 v[232:233], off, s[44:47], 0 sc1
    s_waitcnt vmcnt(0)
    s_sub_u32 s49, s49, 1
    s_cmp_lg_u32 s49, 0
    s_cbranch_scc1 L_adaL_tagpoll_42
L_adaL_taggot_43:
    s_lshl_b32 s43, s2, 3
    s_add_u32 s43, s43, 178464
    v_lshlrev_b32 v1, 8, v0
    s_waitcnt vmcnt(0)
    s_mov_b64 exec, 255
    buffer_store_dwordx2 v[232:233], v1, s[4:7], s43 offen sc1
    s_mov_b64 exec, -1
L_adaL_nopost_41:
    s_barrier
    s_cmp_ge_u32 s2, 240
    s_cbranch_scc1 L_adaL_reset_34
    buffer_load_dword v142, v138, s[20:23], s28 offen offset:0
    buffer_load_dword v143, v138, s[20:23], s28 offen offset:3456
    s_add_u32 s28, s28, 6912
    buffer_load_dword v144, v138, s[20:23], s28 offen offset:0
    buffer_load_dword v145, v138, s[20:23], s28 offen offset:3456
    s_add_u32 s28, s28, 6912
    buffer_load_dword v146, v138, s[20:23], s28 offen offset:0
    buffer_load_dword v147, v138, s[20:23], s28 offen offset:3456
    s_add_u32 s28, s28, 6912
    buffer_load_dword v148, v138, s[20:23], s28 offen offset:0
    buffer_load_dword v149, v138, s[20:23], s28 offen offset:3456
    s_add_u32 s28, s28, 6912
    buffer_load_dword v150, v138, s[20:23], s28 offen offset:0
    buffer_load_dword v151, v138, s[20:23], s28 offen offset:3456
    s_add_u32 s28, s28, 6912
    buffer_load_dword v152, v138, s[20:23], s28 offen offset:0
    buffer_load_dword v153, v138, s[20:23], s28 offen offset:3456
    s_add_u32 s28, s28, 6912
    buffer_load_dword v154, v138, s[20:23], s28 offen offset:0
    buffer_load_dword v155, v138, s[20:23], s28 offen offset:3456
    s_add_u32 s28, s28, 6912
    buffer_load_dword v156, v138, s[20:23], s28 offen offset:0
    buffer_load_dword v157, v138, s[20:23], s28 offen offset:3456
    s_add_u32 s28, s28, 6912
    buffer_load_dword v158, v138, s[20:23], s28 offen offset:0
    buffer_load_dword v159, v138, s[20:23], s28 offen offset:3456
    s_add_u32 s28, s28, 6912
    buffer_load_dword v160, v138, s[20:23], s28 offen offset:0
    buffer_load_dword v161, v138, s[20:23], s28 offen offset:3456
    s_add_u32 s28, s28, 6912
    buffer_load_dword v162, v138, s[20:23], s28 offen offset:0
    buffer_load_dword v163, v138, s[20:23], s28 offen offset:3456
    s_add_u32 s28, s28, 6912
    buffer_load_dword v164, v138, s[20:23], s28 offen offset:0
    buffer_load_dword v165, v138, s[20:23], s28 offen offset:3456
    s_add_u32 s28, s28, 6912
    buffer_load_dword v166, v138, s[20:23], s28 offen offset:0
    buffer_load_dword v167, v138, s[20:23], s28 offen offset:3456
    s_add_u32 s28, s28, 6912
    buffer_load_dword v168, v138, s[20:23], s28 offen offset:0
    buffer_load_dword v169, v138, s[20:23], s28 offen offset:3456
    s_add_u32 s28, s28, 6912
    buffer_load_dword v170, v138, s[20:23], s28 offen offset:0
    buffer_load_dword v171, v138, s[20:23], s28 offen offset:3456
    s_add_u32 s28, s28, 6912
    buffer_load_dword v172, v138, s[20:23], s28 offen offset:0
    buffer_load_dword v173, v138, s[20:23], s28 offen offset:3456
L_adaL_join_33:
    s_mov_b32 s49, 65536
L_adaL_tagpoll_44:
    s_waitcnt vmcnt(32)
    v_readfirstlane_b32 s48, v232
    s_nop 0
    s_cmp_lg_u32 s48, 0
    s_cbranch_scc1 L_adaL_taggot_45
    buffer_load_dwordx2 v[232:233], off, s[44:47], 0 sc1
    s_waitcnt vmcnt(0)
    s_sub_u32 s49, s49, 1
    s_cmp_lg_u32 s49, 0
    s_cbranch_scc1 L_adaL_tagpoll_44
L_adaL_taggot_45:
    s_lshl_b32 s28, s30, 8
    s_add_u32 s28, s28, 48128
    v_lshrrev_b32 v236, 5, v136
    v_mul_u32_u24 v236, 4864, v236
    v_lshl_add_u32 v236, v136, 3, v236
    v_add_u32 v236, s28, v236
    buffer_load_dwordx2 v[234:235], v236, s[4:7], 0 offen sc1
    s_mov_b32 s27, 0x3f803f80
    v_lshrrev_b32 v139, 4, v136
    v_lshlrev_b32 v1, 5, v139
    v_mul_u32_u24 v139, 40960, v139
    v_and_b32 v140, 15, v136
    v_lshl_add_u32 v139, v140, 4, v139
    v_add_u32 v1, v1, v140
    v_cmp_le_u32 vcc, 48, v136
    v_and_b32 v140, 8, v136
    s_nop 0
    v_cndmask_b32 v140, 0, v140, vcc
    v_add_u32 v1, v1, v140
    v_mov_b32 v137, 20480
    v_mov_b32 v140, 128
    v_cndmask_b32 v137, v137, v140, vcc
    v_cndmask_b32 v2, 16, 8, vcc
    v_add_u32 v2, v2, v1
    v_cmp_gt_u32 vcc, 56, v136
    v_mov_b32 v140, 2147483648
    s_nop 0
    v_cndmask_b32 v139, v140, v139, vcc
    v_add_u32 v140, v137, v139
    s_mul_i32 s28, s26, 143360
    s_lshl_b32 s29, s30, 10
    s_add_u32 s28, s28, s29
    s_add_u32 s28, s28, 8912896
    v_mov_b32 v4, 0
    v_mov_b32 v5, 0
    v_mov_b32 v6, 0
    v_mov_b32 v7, 0
    s_waitcnt vmcnt(32)
    v_lshlrev_b32 v8, 16, v142
    v_and_b32 v40, s3, v142
    s_waitcnt vmcnt(31)
    v_lshlrev_b32 v9, 16, v143
    v_and_b32 v41, s3, v143
    s_waitcnt vmcnt(30)
    v_lshlrev_b32 v10, 16, v144
    v_and_b32 v42, s3, v144
    s_waitcnt vmcnt(29)
    v_lshlrev_b32 v11, 16, v145
    v_and_b32 v43, s3, v145
    s_waitcnt vmcnt(28)
    v_lshlrev_b32 v12, 16, v146
    v_and_b32 v44, s3, v146
    s_waitcnt vmcnt(27)
    v_lshlrev_b32 v13, 16, v147
    v_and_b32 v45, s3, v147
    s_waitcnt vmcnt(26)
    v_lshlrev_b32 v14, 16, v148
    v_and_b32 v46, s3, v148
    s_waitcnt vmcnt(25)
    v_lshlrev_b32 v15, 16, v149
    v_and_b32 v47, s3, v149
    s_waitcnt vmcnt(24)
    v_lshlrev_b32 v16, 16, v150
    v_and_b32 v48, s3, v150
    s_waitcnt vmcnt(23)
    v_lshlrev_b32 v17, 16, v151
    v_and_b32 v49, s3, v151
    s_waitcnt vmcnt(22)
    v_lshlrev_b32 v18, 16, v152
    v_and_b32 v50, s3, v152
    s_waitcnt vmcnt(21)
    v_lshlrev_b32 v19, 16, v153
    v_and_b32 v51, s3, v153
    s_waitcnt vmcnt(20)
    v_lshlrev_b32 v20, 16, v154
    v_and_b32 v52, s3, v154
    s_waitcnt vmcnt(19)
    v_lshlrev_b32 v21, 16, v155
    v_and_b32 v53, s3, v155
    s_waitcnt vmcnt(18)
    v_lshlrev_b32 v22, 16, v156
    v_and_b32 v54, s3, v156
    s_waitcnt vmcnt(17)
    v_lshlrev_b32 v23, 16, v157
    v_and_b32 v55, s3, v157
    s_waitcnt vmcnt(16)
    v_lshlrev_b32 v24, 16, v158
    v_and_b32 v56, s3, v158
    s_waitcnt vmcnt(15)
    v_lshlrev_b32 v25, 16, v159
    v_and_b32 v57, s3, v159
    s_waitcnt vmcnt(14)
    v_lshlrev_b32 v26, 16, v160
    v_and_b32 v58, s3, v160
    s_waitcnt vmcnt(13)
    v_lshlrev_b32 v27, 16, v161
    v_and_b32 v59, s3, v161
    s_waitcnt vmcnt(12)
    v_lshlrev_b32 v28, 16, v162
    v_and_b32 v60, s3, v162
    s_waitcnt vmcnt(11)
    v_lshlrev_b32 v29, 16, v163
    v_and_b32 v61, s3, v163
    s_waitcnt vmcnt(10)
    v_lshlrev_b32 v30, 16, v164
    v_and_b32 v62, s3, v164
    s_waitcnt vmcnt(9)
    v_lshlrev_b32 v31, 16, v165
    v_and_b32 v63, s3, v165
    s_waitcnt vmcnt(8)
    v_lshlrev_b32 v32, 16, v166
    v_and_b32 v64, s3, v166
    s_waitcnt vmcnt(7)
    v_lshlrev_b32 v33, 16, v167
    v_and_b32 v65, s3, v167
    s_waitcnt vmcnt(6)
    v_lshlrev_b32 v34, 16, v168
    v_and_b32 v66, s3, v168
    s_waitcnt vmcnt(5)
    v_lshlrev_b32 v35, 16, v169
    v_and_b32 v67, s3, v169
    s_waitcnt vmcnt(4)
    v_lshlrev_b32 v36, 16, v170
    v_and_b32 v68, s3, v170
    s_waitcnt vmcnt(3)
    v_lshlrev_b32 v37, 16, v171
    v_and_b32 v69, s3, v171
    s_waitcnt vmcnt(2)
    v_lshlrev_b32 v38, 16, v172
    v_and_b32 v70, s3, v172
    s_waitcnt vmcnt(1)
    v_lshlrev_b32 v39, 16, v173
    v_and_b32 v71, s3, v173
    s_mov_b32 s49, 65536
L_adaL_poll_46:
    s_waitcnt vmcnt(0)
    v_cmp_ne_u32 vcc, s48, v235
    s_nop 0
    s_cbranch_vccz L_adaL_got_47
    buffer_load_dwordx2 v[234:235], v236, s[4:7], 0 offen sc1
    s_waitcnt vmcnt(0)
    s_sub_u32 s49, s49, 1
    s_cmp_lg_u32 s49, 0
    s_cbranch_scc1 L_adaL_poll_46
L_adaL_got_47:
    v_readlane_b32 s52, v234, 0
    v_readlane_b32 s53, v234, 1
    v_readlane_b32 s54, v234, 2
    v_readlane_b32 s55, v234, 3
    v_readlane_b32 s56, v234, 4
    v_readlane_b32 s57, v234, 5
    v_readlane_b32 s58, v234, 6
    v_readlane_b32 s59, v234, 7
    v_readlane_b32 s60, v234, 32
    v_readlane_b32 s61, v234, 33
    v_readlane_b32 s62, v234, 34
    v_readlane_b32 s63, v234, 35
    v_readlane_b32 s64, v234, 36
    v_readlane_b32 s65, v234, 37
    v_readlane_b32 s66, v234, 38
    v_readlane_b32 s67, v234, 39
    v_fmac_f32 v6, s52, v8
    v_fmac_f32 v7, s52, v40
    v_fmac_f32 v6, s53, v9
    v_fmac_f32 v7, s53, v41
    v_fmac_f32 v6, s54, v10
    v_fmac_f32 v7, s54, v42
    v_fmac_f32 v6, s55, v11
    v_fmac_f32 v7, s55, v43
    v_fmac_f32 v6, s56, v12
    v_fmac_f32 v7, s56, v44
    v_fmac_f32 v6, s57, v13
    v_fmac_f32 v7, s57, v45
    v_fmac_f32 v6, s58, v14
    v_fmac_f32 v7, s58, v46
    v_fmac_f32 v6, s59, v15
    v_fmac_f32 v7, s59, v47
    v_pk_mul_f32 v[8:9], v[8:9], s[60:61]
    v_pk_mul_f32 v[40:41], v[40:41], s[60:61]
    v_pk_mul_f32 v[10:11], v[10:11], s[62:63]
    v_pk_mul_f32 v[42:43], v[42:43], s[62:63]
    v_pk_mul_f32 v[12:13], v[12:13], s[64:65]
    v_pk_mul_f32 v[44:45], v[44:45], s[64:65]
    v_pk_mul_f32 v[14:15], v[14:15], s[66:67]
    v_pk_mul_f32 v[46:47], v[46:47], s[66:67]
    v_cvt_pk_bf16_f32 v72, v8, v9
    v_cvt_pk_bf16_f32 v80, v40, v41
    v_cvt_pk_bf16_f32 v73, v10, v11
    v_cvt_pk_bf16_f32 v81, v42, v43
    v_cvt_pk_bf16_f32 v74, v12, v13
    v_cvt_pk_bf16_f32 v82, v44, v45
    v_cvt_pk_bf16_f32 v75, v14, v15
    v_cvt_pk_bf16_f32 v83, v46, v47
    buffer_store_dwordx4 v[72:75], v139, s[4:7], s28 offen offset:0 sc1
    buffer_store_dwordx4 v[80:83], v140, s[4:7], s28 offen offset:0 sc1
    v_dot2c_f32_bf16 v4, s27, v72
    v_dot2c_f32_bf16 v5, s27, v80
    v_dot2c_f32_bf16 v4, s27, v73
    v_dot2c_f32_bf16 v5, s27, v81
    v_dot2c_f32_bf16 v4, s27, v74
    v_dot2c_f32_bf16 v5, s27, v82
    v_dot2c_f32_bf16 v4, s27, v75
    v_dot2c_f32_bf16 v5, s27, v83
    v_readlane_b32 s68, v234, 8
    v_readlane_b32 s69, v234, 9
    v_readlane_b32 s70, v234, 10
    v_readlane_b32 s71, v234, 11
    v_readlane_b32 s72, v234, 12
    v_readlane_b32 s73, v234, 13
    v_readlane_b32 s74, v234, 14
    v_readlane_b32 s75, v234, 15
    v_readlane_b32 s76, v234, 40
    v_readlane_b32 s77, v234, 41
    v_readlane_b32 s78, v234, 42
    v_readlane_b32 s79, v234, 43
    v_readlane_b32 s80, v234, 44
    v_readlane_b32 s81, v234, 45
    v_readlane_b32 s82, v234, 46
    v_readlane_b32 s83, v234, 47
    v_fmac_f32 v6, s68, v16
    v_fmac_f32 v7, s68, v48
    v_fmac_f32 v6, s69, v17
    v_fmac_f32 v7, s69, v49
    v_fmac_f32 v6, s70, v18
    v_fmac_f32 v7, s70, v50
    v_fmac_f32 v6, s71, v19
    v_fmac_f32 v7, s71, v51
    v_fmac_f32 v6, s72, v20
    v_fmac_f32 v7, s72, v52
    v_fmac_f32 v6, s73, v21
    v_fmac_f32 v7, s73, v53
    v_fmac_f32 v6, s74, v22
    v_fmac_f32 v7, s74, v54
    v_fmac_f32 v6, s75, v23
    v_fmac_f32 v7, s75, v55
    v_pk_mul_f32 v[16:17], v[16:17], s[76:77]
    v_pk_mul_f32 v[48:49], v[48:49], s[76:77]
    v_pk_mul_f32 v[18:19], v[18:19], s[78:79]
    v_pk_mul_f32 v[50:51], v[50:51], s[78:79]
    v_pk_mul_f32 v[20:21], v[20:21], s[80:81]
    v_pk_mul_f32 v[52:53], v[52:53], s[80:81]
    v_pk_mul_f32 v[22:23], v[22:23], s[82:83]
    v_pk_mul_f32 v[54:55], v[54:55], s[82:83]
    v_cvt_pk_bf16_f32 v76, v16, v17
    v_cvt_pk_bf16_f32 v84, v48, v49
    v_cvt_pk_bf16_f32 v77, v18, v19
    v_cvt_pk_bf16_f32 v85, v50, v51
    v_cvt_pk_bf16_f32 v78, v20, v21
    v_cvt_pk_bf16_f32 v86, v52, v53
    v_cvt_pk_bf16_f32 v79, v22, v23
    v_cvt_pk_bf16_f32 v87, v54, v55
    buffer_store_dwordx4 v[76:79], v139, s[4:7], s28 offen offset:256 sc1
    buffer_store_dwordx4 v[84:87], v140, s[4:7], s28 offen offset:256 sc1
    v_dot2c_f32_bf16 v4, s27, v76
    v_dot2c_f32_bf16 v5, s27, v84
    v_dot2c_f32_bf16 v4, s27, v77
    v_dot2c_f32_bf16 v5, s27, v85
    v_dot2c_f32_bf16 v4, s27, v78
    v_dot2c_f32_bf16 v5, s27, v86
    v_dot2c_f32_bf16 v4, s27, v79
    v_dot2c_f32_bf16 v5, s27, v87
    v_readlane_b32 s52, v234, 16
    v_readlane_b32 s53, v234, 17
    v_readlane_b32 s54, v234, 18
    v_readlane_b32 s55, v234, 19
    v_readlane_b32 s56, v234, 20
    v_readlane_b32 s57, v234, 21
    v_readlane_b32 s58, v234, 22
    v_readlane_b32 s59, v234, 23
    v_readlane_b32 s60, v234, 48
    v_readlane_b32 s61, v234, 49
    v_readlane_b32 s62, v234, 50
    v_readlane_b32 s63, v234, 51
    v_readlane_b32 s64, v234, 52
    v_readlane_b32 s65, v234, 53
    v_readlane_b32 s66, v234, 54
    v_readlane_b32 s67, v234, 55
    v_fmac_f32 v6, s52, v24
    v_fmac_f32 v7, s52, v56
    v_fmac_f32 v6, s53, v25
    v_fmac_f32 v7, s53, v57
    v_fmac_f32 v6, s54, v26
    v_fmac_f32 v7, s54, v58
    v_fmac_f32 v6, s55, v27
    v_fmac_f32 v7, s55, v59
    v_fmac_f32 v6, s56, v28
    v_fmac_f32 v7, s56, v60
    v_fmac_f32 v6, s57, v29
    v_fmac_f32 v7, s57, v61
    v_fmac_f32 v6, s58, v30
    v_fmac_f32 v7, s58, v62
    v_fmac_f32 v6, s59, v31
    v_fmac_f32 v7, s59, v63
    v_pk_mul_f32 v[24:25], v[24:25], s[60:61]
    v_pk_mul_f32 v[56:57], v[56:57], s[60:61]
    v_pk_mul_f32 v[26:27], v[26:27], s[62:63]
    v_pk_mul_f32 v[58:59], v[58:59], s[62:63]
    v_pk_mul_f32 v[28:29], v[28:29], s[64:65]
    v_pk_mul_f32 v[60:61], v[60:61], s[64:65]
    v_pk_mul_f32 v[30:31], v[30:31], s[66:67]
    v_pk_mul_f32 v[62:63], v[62:63], s[66:67]
    v_cvt_pk_bf16_f32 v72, v24, v25
    v_cvt_pk_bf16_f32 v80, v56, v57
    v_cvt_pk_bf16_f32 v73, v26, v27
    v_cvt_pk_bf16_f32 v81, v58, v59
    v_cvt_pk_bf16_f32 v74, v28, v29
    v_cvt_pk_bf16_f32 v82, v60, v61
    v_cvt_pk_bf16_f32 v75, v30, v31
    v_cvt_pk_bf16_f32 v83, v62, v63
    buffer_store_dwordx4 v[72:75], v139, s[4:7], s28 offen offset:512 sc1
    buffer_store_dwordx4 v[80:83], v140, s[4:7], s28 offen offset:512 sc1
    v_dot2c_f32_bf16 v4, s27, v72
    v_dot2c_f32_bf16 v5, s27, v80
    v_dot2c_f32_bf16 v4, s27, v73
    v_dot2c_f32_bf16 v5, s27, v81
    v_dot2c_f32_bf16 v4, s27, v74
    v_dot2c_f32_bf16 v5, s27, v82
    v_dot2c_f32_bf16 v4, s27, v75
    v_dot2c_f32_bf16 v5, s27, v83
    v_readlane_b32 s68, v234, 24
    v_readlane_b32 s69, v234, 25
    v_readlane_b32 s70, v234, 26
    v_readlane_b32 s71, v234, 27
    v_readlane_b32 s72, v234, 28
    v_readlane_b32 s73, v234, 29
    v_readlane_b32 s74, v234, 30
    v_readlane_b32 s75, v234, 31
    v_readlane_b32 s76, v234, 56
    v_readlane_b32 s77, v234, 57
    v_readlane_b32 s78, v234, 58
    v_readlane_b32 s79, v234, 59
    v_readlane_b32 s80, v234, 60
    v_readlane_b32 s81, v234, 61
    v_readlane_b32 s82, v234, 62
    v_readlane_b32 s83, v234, 63
    v_fmac_f32 v6, s68, v32
    v_fmac_f32 v7, s68, v64
    v_fmac_f32 v6, s69, v33
    v_fmac_f32 v7, s69, v65
    v_fmac_f32 v6, s70, v34
    v_fmac_f32 v7, s70, v66
    v_fmac_f32 v6, s71, v35
    v_fmac_f32 v7, s71, v67
    v_fmac_f32 v6, s72, v36
    v_fmac_f32 v7, s72, v68
    v_fmac_f32 v6, s73, v37
    v_fmac_f32 v7, s73, v69
    v_fmac_f32 v6, s74, v38
    v_fmac_f32 v7, s74, v70
    v_fmac_f32 v6, s75, v39
    v_fmac_f32 v7, s75, v71
    v_pk_mul_f32 v[32:33], v[32:33], s[76:77]
    v_pk_mul_f32 v[64:65], v[64:65], s[76:77]
    v_pk_mul_f32 v[34:35], v[34:35], s[78:79]
    v_pk_mul_f32 v[66:67], v[66:67], s[78:79]
    v_pk_mul_f32 v[36:37], v[36:37], s[80:81]
    v_pk_mul_f32 v[68:69], v[68:69], s[80:81]
    v_pk_mul_f32 v[38:39], v[38:39], s[82:83]
    v_pk_mul_f32 v[70:71], v[70:71], s[82:83]
    v_cvt_pk_bf16_f32 v76, v32, v33
    v_cvt_pk_bf16_f32 v84, v64, v65
    v_cvt_pk_bf16_f32 v77, v34, v35
    v_cvt_pk_bf16_f32 v85, v66, v67
    v_cvt_pk_bf16_f32 v78, v36, v37
    v_cvt_pk_bf16_f32 v86, v68, v69
    v_cvt_pk_bf16_f32 v79, v38, v39
    v_cvt_pk_bf16_f32 v87, v70, v71
    buffer_store_dwordx4 v[76:79], v139, s[4:7], s28 offen offset:768 sc1
    buffer_store_dwordx4 v[84:87], v140, s[4:7], s28 offen offset:768 sc1
    v_dot2c_f32_bf16 v4, s27, v76
    v_dot2c_f32_bf16 v5, s27, v84
    v_dot2c_f32_bf16 v4, s27, v77
    v_dot2c_f32_bf16 v5, s27, v85
    v_dot2c_f32_bf16 v4, s27, v78
    v_dot2c_f32_bf16 v5, s27, v86
    v_dot2c_f32_bf16 v4, s27, v79
    v_dot2c_f32_bf16 v5, s27, v87
    s_lshl_b32 s28, s24, 10
    s_add_u32 s28, s28, 8192
    v_lshl_add_u32 v1, v1, 2, s28
    v_lshl_add_u32 v2, v2, 2, s28
    ds_write2st64_b32 v1, v4, v6 offset0:0 offset1:2
    ds_write2st64_b32 v2, v5, v7 offset0:0 offset1:2
    v_lshlrev_b32 v137, 2, v0
    s_waitcnt lgkmcnt(0)
    s_barrier
    ds_read2st64_b32 v[8:9], v137 offset0:32 offset1:36
    ds_read2st64_b32 v[10:11], v137 offset0:40 offset1:44
    s_lshl_b32 s28, s42, 10
    s_add_u32 s28, s28, 262144
    s_waitcnt lgkmcnt(0)
    v_pk_add_f32 v[8:9], v[8:9], v[10:11]
    v_add_f32 v8, v8, v9
    buffer_store_dword v8, v137, s[4:7], s28 offen sc1
    s_waitcnt vmcnt(0)
    s_barrier
    s_cmp_lg_u32 s39, 0
    s_cbranch_scc1 L_adaL_nopub_36
    s_lshr_b32 s43, s26, 1
    s_mul_i32 s43, s43, 6
    s_add_u32 s43, s43, s25
    s_lshl_b32 s43, s43, 1
    s_and_b32 s42, s26, 1
    s_add_u32 s43, s43, s42
    s_lshl_b32 s43, s43, 5
    s_add_u32 s43, s43, 65536
    v_mul_u32_u24 v1, 3840, v0
    s_mov_b64 exec, 255
    buffer_store_dword v232, v1, s[4:7], s43 offen sc1
    s_mov_b64 exec, -1
    s_branch L_adaL_nopub_36
L_adaL_reset_34:
    s_waitcnt lgkmcnt(0)
    buffer_load_dwordx2 v[232:233], off, s[44:47], 0 sc1
    s_mov_b32 s49, 65536
L_adaL_tagpoll_48:
    s_waitcnt vmcnt(0)
    v_readfirstlane_b32 s48, v232
    s_nop 0
    s_cmp_lg_u32 s48, 0
    s_cbranch_scc1 L_adaL_taggot_49
    buffer_load_dwordx2 v[232:233], off, s[44:47], 0 sc1
    s_waitcnt vmcnt(0)
    s_sub_u32 s49, s49, 1
    s_cmp_lg_u32 s49, 0
    s_cbranch_scc1 L_adaL_tagpoll_48
L_adaL_taggot_49:
L_adaL_nopub_36:
    s_barrier
    v_lshrrev_b32 v240, 6, v0
    s_nop 0
    v_readfirstlane_b32 s82, v240
    s_bfe_u32 s87, s2, 0x30003
    s_and_b32 s83, s2, 6
    s_lshl_b32 s83, s83, 2
    s_add_u32 s83, s83, s87
    s_lshr_b32 s87, s2, 6
    s_and_b32 s84, s2, 1
    s_lshl_b32 s84, s84, 2
    s_add_u32 s84, s84, s87
    v_and_b32 v240, 63, v0
    v_lshlrev_b32 v241, 4, v240
    s_add_u32 s87, s82, 1
    s_lshl_b32 s87, s87, 29
    s_and_b32 s87, s87, 2147483648
    s_or_b32 s87, s87, 20480
    v_add_u32 v242, s87, v241
    s_mul_i32 s85, s84, 286720
    s_mul_i32 s87, s82, 40960
    s_add_u32 s85, s85, s87
    s_add_u32 s85, s85, 9056256
    s_and_b32 s86, s2, 7
    s_mul_i32 s86, s86, 3840
    s_mul_i32 s87, s84, 384
    s_add_u32 s86, s86, s87
    s_add_u32 s86, s86, 65536
    v_min_u32 v243, 9, v240
    v_lshlrev_b32 v243, 5, v243
    v_lshrrev_b32 v246, 3, v240
    v_lshlrev_b32 v245, 13, v246
    v_lshrrev_b32 v246, 4, v240
    v_and_b32 v247, 7, v0
    v_xor_b32 v246, v246, v247
    v_lshl_add_u32 v245, v246, 4, v245
    s_mul_i32 s87, s84, 0
    v_add_u32 v245, s87, v245
    v_xor_b32 v246, 64, v245
    v_add_u32 v246, 65536, v246
    s_lshl_b32 s88, s83, 18
    s_lshl_b32 s87, s82, 10
    s_add_u32 s88, s88, s87
    s_add_u32 s89, s88, 4096
    s_add_u32 s90, s88, 131072
    s_add_u32 s91, s88, 135168
    s_movk_i32 s40, 0x380
    s_lshr_b32 s10, s2, 3
    s_sub_u32 s10, s10, 20
    s_mov_b32 s8, 4
    s_mul_i32 s9, s10, 4
    s_bfe_u32 s11, s2, 0x10002
    s_sub_u32 s11, 8, s11
    s_mul_i32 s12, s11, 2
    s_mul_i32 s13, s10, 2
    s_add_u32 s13, s13, s12
    s_cmp_ge_u32 s2, 220
    s_cselect_b32 s8, 2, s8
    s_cselect_b32 s9, s13, s9
    s_cmp_eq_u32 s10, 10
    s_cselect_b32 s8, 9, s8
    s_add_u32 s12, s12, 29
    s_sub_u32 s13, 54, s12
    s_max_i32 s13, s13, 0
    s_cmp_eq_u32 s10, 11
    s_cselect_b32 s8, s13, s8
    s_cselect_b32 s9, s12, s9
    s_lshl_b32 s9, s9, 14
    s_and_b32 s10, s2, 7
    s_lshl_b32 s10, s10, 20
    s_add_u32 s9, s9, s10
    v_lshlrev_b32 v1, 4, v0
    s_cmp_eq_u32 s8, 0
    s_cbranch_scc1 L_adaL_nopull_51
L_adaL_pull_50:
    buffer_load_dwordx4 v[2:5], v1, s[32:35], s9 offen
    s_add_u32 s9, s9, 4096
    buffer_load_dwordx4 v[2:5], v1, s[32:35], s9 offen
    s_add_u32 s9, s9, 4096
    buffer_load_dwordx4 v[2:5], v1, s[32:35], s9 offen
    s_add_u32 s9, s9, 4096
    buffer_load_dwordx4 v[2:5], v1, s[32:35], s9 offen
    s_add_u32 s9, s9, 4096
    s_sub_u32 s8, s8, 1
    s_cmp_lg_u32 s8, 0
    s_cbranch_scc1 L_adaL_pull_50
L_adaL_nopull_51:
    s_lshr_b32 s8, s2, 3
    s_sub_u32 s8, s8, 20
    s_and_b32 s9, s2, 1
    v_lshlrev_b32 v1, 7, v0
    buffer_load_dword v244, v243, s[4:7], s86 offen sc1
    s_branch L_adaL_join_3
code_end:
    s_endpgm
.section .rodata,"a"
.p2align 6
.amdhsa_kernel adaLN_cond__ssm_conv_h3__mixer_gmlp__prompt_kernel
  .amdhsa_next_free_vgpr 504
  .amdhsa_next_free_sgpr 92
  .amdhsa_accum_offset 248
  .amdhsa_group_segment_fixed_size 0
  .amdhsa_kernarg_size 128
  .amdhsa_user_sgpr_count 2
  .amdhsa_user_sgpr_kernarg_segment_ptr 1
  .amdhsa_system_sgpr_workgroup_id_x 1
  .amdhsa_float_denorm_mode_32 3
.end_amdhsa_kernel
```

```asm
; @launch kernel=adaLN_cond__ssm_conv_h3__mixer_gmlp__prompt_kernel grid=(256,1,1) block=(256,1,1) lds=163840
.amdgcn_target "amdgcn-amd-amdhsa--gfx950"
.text
.globl adaLN_cond__ssm_conv_h3__mixer_gmlp__prompt_kernel
.p2align 8
.type adaLN_cond__ssm_conv_h3__mixer_gmlp__prompt_kernel,@function
adaLN_cond__ssm_conv_h3__mixer_gmlp__prompt_kernel:
    s_cmp_ge_u32 s2, 256
    s_cbranch_scc1 L_adaL_end_1
    s_load_dwordx2 s[4:5], s[0:1], 120
    s_mov_b32 s6, 33554432
    s_mov_b32 s7, 0x20000
    s_load_dwordx2 s[44:45], s[0:1], 112
    s_mov_b32 s46, 256
    s_mov_b32 s47, 0x20000
    s_load_dwordx2 s[32:33], s[0:1], 64
    s_mov_b32 s34, 8388608
    s_mov_b32 s35, 0x20000
    s_mov_b32 s3, 0xffff0000
    s_cmp_ge_u32 s2, 160
    s_cbranch_scc1 L_adaL_aux_2
    s_load_dwordx2 s[8:9], s[0:1], 8
    s_mov_b32 s10, 2621440
    s_mov_b32 s11, 0x20000
    s_load_dwordx2 s[12:13], s[0:1], 16
    s_mov_b32 s14, 2621440
    s_mov_b32 s15, 0x20000
    s_load_dwordx2 s[20:21], s[0:1], 24
    s_mov_b32 s22, 5120
    s_mov_b32 s23, 0x20000
    s_load_dwordx2 s[16:17], s[0:1], 0
    s_mov_b32 s18, 2621440
    s_mov_b32 s19, 0x20000
    s_load_dwordx2 s[24:25], s[0:1], 32
    s_mov_b32 s26, 2621440
    s_mov_b32 s27, 0x20000
    s_load_dwordx2 s[28:29], s[0:1], 40
    s_mov_b32 s30, 1280
    s_mov_b32 s31, 0x20000
    s_load_dwordx2 s[36:37], s[0:1], 80
    s_mov_b32 s38, 1105920
    s_mov_b32 s39, 0x20000
    s_lshr_b32 s52, s2, 4
    s_and_b32 s53, s2, 15
    v_and_b32 v49, 31, v0
    v_lshrrev_b32 v3, 5, v0
    s_mul_i32 s60, s53, 163840
    s_lshl_b32 s61, s52, 7
    s_add_u32 s64, s60, s61
    v_mul_u32_u24 v46, 20480, v3
    v_lshl_add_u32 v46, v49, 2, v46
    s_sub_u32 s60, s64, 3840
    v_add_u32_e64 v47, s60, v46
    s_lshl_b32 s61, s52, 9
    v_lshl_add_u32 v48, v49, 4, s61
    s_add_u32 s65, s64, 5120
    s_add_u32 s66, s64, 10240
    s_add_u32 s67, s64, 15360
    s_waitcnt lgkmcnt(0)
    buffer_load_dword v55, v46, s[8:11], s64 offen offset:0
    buffer_load_dword v56, v46, s[8:11], s64 offen offset:1280
    buffer_load_dword v57, v46, s[8:11], s64 offen offset:2560
    buffer_load_dword v58, v46, s[8:11], s64 offen offset:3840
    buffer_load_dword v59, v46, s[8:11], s65 offen offset:0
    buffer_load_dword v60, v46, s[8:11], s65 offen offset:1280
    buffer_load_dword v61, v46, s[8:11], s65 offen offset:2560
    buffer_load_dword v62, v46, s[8:11], s65 offen offset:3840
    buffer_load_dword v52, v47, s[8:11], 0 offen offset:0
    buffer_load_dword v53, v47, s[8:11], 0 offen offset:1280
    buffer_load_dword v54, v47, s[8:11], 0 offen offset:2560
    buffer_load_dwordx4 v[88:91], v48, s[20:23], 0 offen
    buffer_load_dword v72, v46, s[12:15], s64 offen offset:0
    buffer_load_dword v73, v46, s[12:15], s64 offen offset:1280
    buffer_load_dword v74, v46, s[12:15], s64 offen offset:2560
    buffer_load_dword v75, v46, s[12:15], s64 offen offset:3840
    buffer_load_dword v76, v46, s[12:15], s65 offen offset:0
    buffer_load_dword v77, v46, s[12:15], s65 offen offset:1280
    buffer_load_dword v78, v46, s[12:15], s65 offen offset:2560
    buffer_load_dword v79, v46, s[12:15], s65 offen offset:3840
    buffer_load_dword v63, v46, s[8:11], s66 offen offset:0
    buffer_load_dword v64, v46, s[8:11], s66 offen offset:1280
    buffer_load_dword v65, v46, s[8:11], s66 offen offset:2560
    buffer_load_dword v66, v46, s[8:11], s66 offen offset:3840
    buffer_load_dword v67, v46, s[8:11], s67 offen offset:0
    buffer_load_dword v68, v46, s[8:11], s67 offen offset:1280
    buffer_load_dword v69, v46, s[8:11], s67 offen offset:2560
    buffer_load_dword v70, v46, s[8:11], s67 offen offset:3840
    buffer_load_dword v80, v46, s[12:15], s66 offen offset:0
    buffer_load_dword v81, v46, s[12:15], s66 offen offset:1280
    buffer_load_dword v82, v46, s[12:15], s66 offen offset:2560
    buffer_load_dword v83, v46, s[12:15], s66 offen offset:3840
    buffer_load_dword v84, v46, s[12:15], s67 offen offset:0
    buffer_load_dword v85, v46, s[12:15], s67 offen offset:1280
    buffer_load_dword v86, v46, s[12:15], s67 offen offset:2560
    buffer_load_dword v87, v46, s[12:15], s67 offen offset:3840
    v_mul_u32_u24 v124, 528, v49
    v_lshl_add_u32 v124, v3, 4, v124
    v_add_u32 v124, 66048, v124
    v_mul_u32_u24 v125, 528, v3
    v_lshl_add_u32 v125, v49, 4, v125
    v_add_u32 v125, 66048, v125
    v_lshrrev_b32 v2, 6, v0
    s_nop 0
    v_readfirstlane_b32 s54, v2
    v_and_b32 v1, 63, v0
    s_lshl_b32 s55, s2, 2
    s_add_u32 s55, s55, s54
    s_lshl_b32 s60, s55, 12
    v_lshl_add_u32 v4, v1, 4, s60
    v_and_b32 v44, 7, v0
    v_lshrrev_b32 v45, 3, v0
    v_mul_u32_u24 v46, 5120, v45
    v_lshl_add_u32 v46, v44, 4, v46
    v_add_u32_e64 v46, s64, v46
    s_lshl_b32 s55, s55, 1
    buffer_load_dwordx4 v[96:99], v4, s[24:27], 0 offen offset:0 nt
    buffer_load_dwordx4 v[104:107], v4, s[24:27], 0 offen offset:1024 nt
    buffer_load_dwordx4 v[112:115], v4, s[24:27], 0 offen offset:2048 nt
    buffer_load_dwordx4 v[120:123], v4, s[24:27], 0 offen offset:3072 nt
    buffer_load_ushort v5, off, s[28:31], s55
    buffer_load_dwordx4 v[28:31], v46, s[16:19], 0 offen offset:0
    buffer_load_dwordx4 v[32:35], v46, s[16:19], 0 offen offset:1280
    buffer_load_dwordx4 v[36:39], v46, s[16:19], 0 offen offset:2560
    buffer_load_dwordx4 v[40:43], v46, s[16:19], 0 offen offset:3840
    s_mul_i32 s60, s54, 2176
    s_add_u32 s60, s60, 84480
    v_mul_u32_u24 v24, 272, v44
    v_and_b32 v2, 7, v45
    v_lshl_add_u32 v24, v2, 4, v24
    v_add_u32 v24, s60, v24
    v_lshrrev_b32 v2, 4, v1
    v_and_b32 v3, 15, v1
    v_mul_u32_u24 v25, 272, v2
    v_lshl_add_u32 v25, v3, 4, v25
    v_add_u32 v25, s60, v25
    v_lshlrev_b32 v26, 15, v2
    v_lshl_add_u32 v26, v3, 4, v26
    v_lshlrev_b32 v126, 11, v45
    v_lshl_add_u32 v126, v44, 4, v126
    s_lshl_b32 s60, s52, 18
    s_lshl_b32 s61, s53, 7
    s_add_u32 s64, s60, s61
    s_add_u32 s64, s64, 1048576
    s_lshl_b32 s61, s53, 10
    s_add_u32 s68, s60, s61
    s_lshl_b32 s61, s54, 8
    s_add_u32 s68, s68, s61
    s_add_u32 s68, s68, 3670016
    s_add_u32 s65, s64, 65536
    s_add_u32 s69, s68, 131072
    s_add_u32 s66, s64, 131072
    s_add_u32 s70, s68, 16384
    s_add_u32 s67, s64, 196608
    s_add_u32 s71, s68, 147456
    s_mul_i32 s56, s54, 16512
    s_mul_i32 s57, s54, 4608
    s_add_u32 s57, s57, 66048
    v_lshrrev_b32 v127, 4, v1
    v_bfe_u32 v2, v1, 3, 1
    v_bfe_u32 v3, v1, 2, 1
    v_xor_b32 v3, v2, v3
    v_and_b32 v128, 3, v1
    v_lshl_add_u32 v128, v128, 1, v2
    v_lshl_add_u32 v128, v3, 3, v128
    v_and_b32 v6, 3, v128
    v_mul_u32_u24 v6, 4128, v6
    v_lshrrev_b32 v2, 2, v128
    v_lshl_add_u32 v6, v2, 3, v6
    v_and_b32 v2, 1, v127
    v_lshrrev_b32 v3, 1, v127
    v_lshl_add_u32 v129, v2, 1, v3
    v_mul_u32_u24 v7, 2304, v3
    v_and_b32 v3, 15, v1
    v_add_u32 v2, v2, v3
    v_lshl_add_u32 v7, v2, 4, v7
    s_add_u32 s61, s57, 16
    v_add_u32 v7, s61, v7
    v_sub_u32 v2, 3, v129
    v_lshl_add_u32 v6, v2, 4, v6
    v_add3_u32 v6, s56, v6, 8
    v_add_u32 v11, 2048, v6
    v_lshlrev_b32 v131, 3, v129
    v_sub_u32 v131, v131, v128
    v_subrev_u32 v131, 9, v131
    v_bfe_u32 v2, v1, 5, 1
    v_bfe_u32 v3, v1, 4, 1
    v_xor_b32 v3, v2, v3
    v_lshl_add_u32 v8, v2, 2, v3
    v_and_b32 v2, 1, v1
    v_lshl_add_u32 v8, v2, 1, v8
    v_bfe_u32 v2, v1, 1, 1
    v_and_b32 v3, 4, v1
    v_or_b32 v2, v2, v3
    v_xor_b32 v8, v2, v8
    v_bfe_u32 v2, v1, 1, 3
    v_lshl_add_u32 v8, v2, 3, v8
    v_lshl_add_u32 v8, v8, 4, s56
    v_lshl_add_u32 v130, v1, 4, s56
    v_lshlrev_b32 v9, 4, v0
    v_mul_u32_u24 v132, 2304, v127
    v_and_b32 v3, 15, v1
    v_lshl_add_u32 v132, v3, 4, v132
    v_add_u32 v132, s57, v132
    s_lshl_b32 s58, s2, 9
    s_add_u32 s58, s58, 786432
    v_lshlrev_b32 v10, 5, v3
    s_lshl_b32 s60, s52, 8
    s_add_u32 s60, s60, s53
    s_lshl_b32 s60, s60, 5
    s_add_u32 s63, s60, 786432
    s_cmp_lg_u32 s54, 0
    s_cselect_b32 s63, 33554432, s63
    v_lshlrev_b32 v27, 9, v1
    v_and_b32 v3, 3, v1
    v_mul_u32_u24 v3, 4128, v3
    v_and_b32 v2, 16, v1
    v_add3_u32 v3, s56, v3, v2
    v_cmp_lt_u32 vcc, 31, v1
    s_nop 1
    v_cndmask_b32 v132, v132, v3, vcc
    s_waitcnt vmcnt(44)
    v_lshlrev_b32 v148, 16, v55
    v_and_b32 v149, s3, v55
    buffer_load_dwordx2 v[12:13], off, s[44:47], 0 sc1
    s_waitcnt vmcnt(44)
    v_lshlrev_b32 v150, 16, v56
    v_and_b32 v151, s3, v56
    s_waitcnt vmcnt(43)
    v_lshlrev_b32 v152, 16, v57
    v_and_b32 v153, s3, v57
    s_waitcnt vmcnt(42)
    v_lshlrev_b32 v154, 16, v58
    v_and_b32 v155, s3, v58
    s_waitcnt vmcnt(41)
    v_lshlrev_b32 v156, 16, v59
    v_and_b32 v157, s3, v59
    s_waitcnt vmcnt(40)
    v_lshlrev_b32 v158, 16, v60
    v_and_b32 v159, s3, v60
    s_waitcnt vmcnt(39)
    v_lshlrev_b32 v160, 16, v61
    v_and_b32 v161, s3, v61
    s_waitcnt vmcnt(38)
    v_lshlrev_b32 v162, 16, v62
    v_and_b32 v163, s3, v62
    s_waitcnt vmcnt(37)
    v_lshlrev_b32 v142, 16, v52
    v_and_b32 v143, s3, v52
    s_waitcnt vmcnt(36)
    v_lshlrev_b32 v144, 16, v53
    v_and_b32 v145, s3, v53
    s_waitcnt vmcnt(35)
    v_lshlrev_b32 v146, 16, v54
    v_and_b32 v147, s3, v54
    s_waitcnt vmcnt(34)
    v_lshlrev_b32 v134, 16, v88
    v_and_b32 v136, s3, v88
    v_lshlrev_b32 v138, 16, v89
    v_and_b32 v140, s3, v89
    v_lshlrev_b32 v135, 16, v90
    v_and_b32 v137, s3, v90
    v_lshlrev_b32 v139, 16, v91
    v_and_b32_e64 v141, s3, v91
    v_pk_mul_f32 v[196:197], v[142:143], v[140:141]
    v_pk_mul_f32 v[198:199], v[144:145], v[140:141]
    v_pk_mul_f32 v[200:201], v[146:147], v[140:141]
    v_pk_mul_f32 v[202:203], v[148:149], v[140:141]
    v_pk_mul_f32 v[204:205], v[150:151], v[140:141]
    v_pk_mul_f32 v[206:207], v[152:153], v[140:141]
    v_pk_mul_f32 v[208:209], v[154:155], v[140:141]
    v_pk_mul_f32 v[210:211], v[156:157], v[140:141]
    v_pk_fma_f32 v[196:197], v[144:145], v[138:139], v[196:197]
    v_pk_fma_f32 v[198:199], v[146:147], v[138:139], v[198:199]
    v_pk_fma_f32 v[200:201], v[148:149], v[138:139], v[200:201]
    v_pk_fma_f32 v[202:203], v[150:151], v[138:139], v[202:203]
    v_pk_fma_f32 v[204:205], v[152:153], v[138:139], v[204:205]
    v_pk_fma_f32 v[206:207], v[154:155], v[138:139], v[206:207]
    v_pk_fma_f32 v[208:209], v[156:157], v[138:139], v[208:209]
    v_pk_fma_f32 v[210:211], v[158:159], v[138:139], v[210:211]
    v_pk_fma_f32 v[196:197], v[146:147], v[136:137], v[196:197]
    v_pk_fma_f32 v[198:199], v[148:149], v[136:137], v[198:199]
    v_pk_fma_f32 v[200:201], v[150:151], v[136:137], v[200:201]
    v_pk_fma_f32 v[202:203], v[152:153], v[136:137], v[202:203]
    v_pk_fma_f32 v[204:205], v[154:155], v[136:137], v[204:205]
    v_pk_fma_f32 v[206:207], v[156:157], v[136:137], v[206:207]
    v_pk_fma_f32 v[208:209], v[158:159], v[136:137], v[208:209]
    v_pk_fma_f32 v[210:211], v[160:161], v[136:137], v[210:211]
    v_pk_fma_f32 v[196:197], v[148:149], v[134:135], v[196:197]
    v_pk_fma_f32 v[198:199], v[150:151], v[134:135], v[198:199]
    v_pk_fma_f32 v[200:201], v[152:153], v[134:135], v[200:201]
    v_pk_fma_f32 v[202:203], v[154:155], v[134:135], v[202:203]
    v_pk_fma_f32 v[204:205], v[156:157], v[134:135], v[204:205]
    v_pk_fma_f32 v[206:207], v[158:159], v[134:135], v[206:207]
    v_pk_fma_f32 v[208:209], v[160:161], v[134:135], v[208:209]
    v_pk_fma_f32 v[210:211], v[162:163], v[134:135], v[210:211]
    s_waitcnt vmcnt(33)
    v_lshlrev_b32 v180, 16, v72
    v_and_b32 v181, s3, v72
    s_waitcnt vmcnt(32)
    v_lshlrev_b32 v182, 16, v73
    v_and_b32 v183, s3, v73
    s_waitcnt vmcnt(31)
    v_lshlrev_b32 v184, 16, v74
    v_and_b32 v185, s3, v74
    s_waitcnt vmcnt(30)
    v_lshlrev_b32 v186, 16, v75
    v_and_b32 v187, s3, v75
    s_waitcnt vmcnt(29)
    v_lshlrev_b32 v188, 16, v76
    v_and_b32 v189, s3, v76
    s_waitcnt vmcnt(28)
    v_lshlrev_b32 v190, 16, v77
    v_and_b32 v191, s3, v77
    s_waitcnt vmcnt(27)
    v_lshlrev_b32 v192, 16, v78
    v_and_b32 v193, s3, v78
    s_waitcnt vmcnt(26)
    v_lshlrev_b32 v194, 16, v79
    v_and_b32 v195, s3, v79
    v_pk_mul_f32 v[196:197], v[196:197], v[180:181]
    v_pk_mul_f32 v[198:199], v[198:199], v[182:183]
    v_pk_mul_f32 v[200:201], v[200:201], v[184:185]
    v_pk_mul_f32 v[202:203], v[202:203], v[186:187]
    v_pk_mul_f32 v[204:205], v[204:205], v[188:189]
    v_pk_mul_f32 v[206:207], v[206:207], v[190:191]
    v_pk_mul_f32 v[208:209], v[208:209], v[192:193]
    v_pk_mul_f32 v[210:211], v[210:211], v[194:195]
    v_cvt_pk_bf16_f32 v212, v210, v208
    v_cvt_pk_bf16_f32 v213, v206, v204
    v_cvt_pk_bf16_f32 v214, v202, v200
    v_cvt_pk_bf16_f32 v215, v198, v196
    ds_write_b128 v124, v[212:215] offset:0
    v_cvt_pk_bf16_f32 v216, v211, v209
    v_cvt_pk_bf16_f32 v217, v207, v205
    v_cvt_pk_bf16_f32 v218, v203, v201
    v_cvt_pk_bf16_f32 v219, v199, v197
    ds_write_b128 v124, v[216:219] offset:256
    s_waitcnt vmcnt(25)
    v_lshlrev_b32 v164, 16, v63
    v_and_b32 v165, s3, v63
    s_waitcnt vmcnt(24)
    v_lshlrev_b32 v166, 16, v64
    v_and_b32 v167, s3, v64
    s_waitcnt vmcnt(23)
    v_lshlrev_b32 v168, 16, v65
    v_and_b32 v169, s3, v65
    s_waitcnt vmcnt(22)
    v_lshlrev_b32 v170, 16, v66
    v_and_b32 v171, s3, v66
    s_waitcnt vmcnt(21)
    v_lshlrev_b32 v172, 16, v67
    v_and_b32 v173, s3, v67
    s_waitcnt vmcnt(20)
    v_lshlrev_b32 v174, 16, v68
    v_and_b32 v175, s3, v68
    s_waitcnt vmcnt(19)
    v_lshlrev_b32 v176, 16, v69
    v_and_b32 v177, s3, v69
    s_waitcnt vmcnt(18)
    v_lshlrev_b32 v178, 16, v70
    v_and_b32 v179, s3, v70
    v_pk_mul_f32 v[196:197], v[158:159], v[140:141]
    v_pk_mul_f32 v[198:199], v[160:161], v[140:141]
    v_pk_mul_f32 v[200:201], v[162:163], v[140:141]
    v_pk_mul_f32 v[202:203], v[164:165], v[140:141]
    v_pk_mul_f32 v[204:205], v[166:167], v[140:141]
    v_pk_mul_f32 v[206:207], v[168:169], v[140:141]
    v_pk_mul_f32 v[208:209], v[170:171], v[140:141]
    v_pk_mul_f32 v[210:211], v[172:173], v[140:141]
    v_pk_fma_f32 v[196:197], v[160:161], v[138:139], v[196:197]
    v_pk_fma_f32 v[198:199], v[162:163], v[138:139], v[198:199]
    v_pk_fma_f32 v[200:201], v[164:165], v[138:139], v[200:201]
    v_pk_fma_f32 v[202:203], v[166:167], v[138:139], v[202:203]
    v_pk_fma_f32 v[204:205], v[168:169], v[138:139], v[204:205]
    v_pk_fma_f32 v[206:207], v[170:171], v[138:139], v[206:207]
    v_pk_fma_f32 v[208:209], v[172:173], v[138:139], v[208:209]
    v_pk_fma_f32 v[210:211], v[174:175], v[138:139], v[210:211]
    v_pk_fma_f32 v[196:197], v[162:163], v[136:137], v[196:197]
    v_pk_fma_f32 v[198:199], v[164:165], v[136:137], v[198:199]
    v_pk_fma_f32 v[200:201], v[166:167], v[136:137], v[200:201]
    v_pk_fma_f32 v[202:203], v[168:169], v[136:137], v[202:203]
    v_pk_fma_f32 v[204:205], v[170:171], v[136:137], v[204:205]
    v_pk_fma_f32 v[206:207], v[172:173], v[136:137], v[206:207]
    v_pk_fma_f32 v[208:209], v[174:175], v[136:137], v[208:209]
    v_pk_fma_f32 v[210:211], v[176:177], v[136:137], v[210:211]
    v_pk_fma_f32 v[196:197], v[164:165], v[134:135], v[196:197]
    v_pk_fma_f32 v[198:199], v[166:167], v[134:135], v[198:199]
    v_pk_fma_f32 v[200:201], v[168:169], v[134:135], v[200:201]
    v_pk_fma_f32 v[202:203], v[170:171], v[134:135], v[202:203]
    v_pk_fma_f32 v[204:205], v[172:173], v[134:135], v[204:205]
    v_pk_fma_f32 v[206:207], v[174:175], v[134:135], v[206:207]
    v_pk_fma_f32 v[208:209], v[176:177], v[134:135], v[208:209]
    v_pk_fma_f32 v[210:211], v[178:179], v[134:135], v[210:211]
    s_waitcnt vmcnt(17)
    v_lshlrev_b32 v180, 16, v80
    v_and_b32 v181, s3, v80
    s_waitcnt vmcnt(16)
    v_lshlrev_b32 v182, 16, v81
    v_and_b32 v183, s3, v81
    s_waitcnt vmcnt(15)
    v_lshlrev_b32 v184, 16, v82
    v_and_b32 v185, s3, v82
    s_waitcnt vmcnt(14)
    v_lshlrev_b32 v186, 16, v83
    v_and_b32 v187, s3, v83
    s_waitcnt vmcnt(13)
    v_lshlrev_b32 v188, 16, v84
    v_and_b32 v189, s3, v84
    s_waitcnt vmcnt(12)
    v_lshlrev_b32 v190, 16, v85
    v_and_b32 v191, s3, v85
    s_waitcnt vmcnt(11)
    v_lshlrev_b32 v192, 16, v86
    v_and_b32 v193, s3, v86
    s_waitcnt vmcnt(10)
    v_lshlrev_b32 v194, 16, v87
    v_and_b32 v195, s3, v87
    v_pk_mul_f32 v[196:197], v[196:197], v[180:181]
    v_pk_mul_f32 v[198:199], v[198:199], v[182:183]
    v_pk_mul_f32 v[200:201], v[200:201], v[184:185]
    v_pk_mul_f32 v[202:203], v[202:203], v[186:187]
    v_pk_mul_f32 v[204:205], v[204:205], v[188:189]
    v_pk_mul_f32 v[206:207], v[206:207], v[190:191]
    v_pk_mul_f32 v[208:209], v[208:209], v[192:193]
    v_pk_mul_f32 v[210:211], v[210:211], v[194:195]
    v_cvt_pk_bf16_f32 v212, v210, v208
    v_cvt_pk_bf16_f32 v213, v206, v204
    v_cvt_pk_bf16_f32 v214, v202, v200
    v_cvt_pk_bf16_f32 v215, v198, v196
    ds_write_b128 v124, v[212:215] offset:128
    v_cvt_pk_bf16_f32 v216, v211, v209
    v_cvt_pk_bf16_f32 v217, v207, v205
    v_cvt_pk_bf16_f32 v218, v203, v201
    v_cvt_pk_bf16_f32 v219, v199, v197
    ds_write_b128 v124, v[216:219] offset:384
    s_waitcnt lgkmcnt(0)
    s_barrier
    ds_read_b128 v[52:55], v125 offset:0
    ds_read_b128 v[56:59], v125 offset:4224
    ds_read_b128 v[60:63], v125 offset:8448
    ds_read_b128 v[64:67], v125 offset:12672
    s_waitcnt lgkmcnt(3)
    buffer_store_dwordx4 v[52:55], v126, s[4:7], s64 offen sc1
    s_waitcnt lgkmcnt(2)
    buffer_store_dwordx4 v[56:59], v126, s[4:7], s65 offen sc1
    s_waitcnt lgkmcnt(1)
    buffer_store_dwordx4 v[60:63], v126, s[4:7], s66 offen sc1
    s_waitcnt lgkmcnt(0)
    buffer_store_dwordx4 v[64:67], v126, s[4:7], s67 offen sc1
    s_waitcnt vmcnt(4)
    v_readfirstlane_b32 s48, v12
    s_nop 0
    s_cmp_eq_u32 s48, 0
    s_cbranch_scc1 L_adaL_slow_4
L_adaL_got_6:
    ds_write_b128 v130, v[96:99] offset:12416
    v_mov_b32 v94, 0
    v_mov_b32 v95, 0
    v_mov_b32 v149, v96
    v_mov_b32 v150, v97
    v_mov_b32 v151, v98
    v_mov_b32_dpp v94, v98 wave_shr:1 row_mask:0xf bank_mask:0xf
    v_mov_b32_dpp v95, v99 wave_shr:1 row_mask:0xf bank_mask:0xf
    v_mov_b32_e64 v148, v95
    ds_write_b128 v130, v[148:151] offset:4160
    v_alignbit_b32 v134, v95, v94, 16
    v_alignbit_b32 v135, v96, v95, 16
    v_alignbit_b32 v136, v97, v96, 16
    v_alignbit_b32 v137, v98, v97, 16
    ds_write_b128 v130, v[134:137] offset:32
    v_alignbit_b32 v142, v96, v95, 16
    v_alignbit_b32 v143, v97, v96, 16
    v_alignbit_b32 v144, v98, v97, 16
    v_alignbit_b32 v145, v99, v98, 16
    ds_write_b128 v130, v[142:145] offset:8288
    s_waitcnt vmcnt(0)
    s_barrier
    s_mov_b64 exec, 65535
    buffer_store_dword v12, v27, s[4:7], s63 offen sc1
    s_mov_b64 exec, -1
    ds_write2_b64 v24, v[28:29], v[36:37] offset0:0 offset1:1
    ds_write2_b64 v24, v[32:33], v[40:41] offset0:16 offset1:17
    ds_read_b128 v[72:75], v25 offset:0
    ds_read_b128 v[76:79], v25 offset:1088
    ds_write2_b64 v24, v[30:31], v[38:39] offset0:0 offset1:1
    ds_write2_b64 v24, v[34:35], v[42:43] offset0:16 offset1:17
    ds_read_b128 v[80:83], v25 offset:0
    ds_read_b128 v[84:87], v25 offset:1088
    s_waitcnt lgkmcnt(5)
    buffer_store_dwordx4 v[72:75], v26, s[4:7], s68 offen sc1
    s_waitcnt lgkmcnt(4)
    buffer_store_dwordx4 v[76:79], v26, s[4:7], s69 offen sc1
    s_waitcnt lgkmcnt(1)
    buffer_store_dwordx4 v[80:83], v26, s[4:7], s70 offen sc1
    s_waitcnt lgkmcnt(0)
    buffer_store_dwordx4 v[84:87], v26, s[4:7], s71 offen sc1
    ds_write_b128 v130, v[104:107] offset:13440
    v_mov_b32_dpp v102, v98 wave_ror:1 row_mask:0xf bank_mask:0xf
    v_mov_b32_dpp v103, v99 wave_ror:1 row_mask:0xf bank_mask:0xf
    v_mov_b32 v149, v104
    v_mov_b32 v150, v105
    v_mov_b32 v151, v106
    v_mov_b32_dpp v102, v106 wave_shr:1 row_mask:0xf bank_mask:0xf
    v_mov_b32_dpp v103, v107 wave_shr:1 row_mask:0xf bank_mask:0xf
    v_mov_b32_e64 v148, v103
    ds_write_b128 v130, v[148:151] offset:5184
    v_alignbit_b32 v134, v103, v102, 16
    v_alignbit_b32 v135, v104, v103, 16
    v_alignbit_b32 v136, v105, v104, 16
    v_alignbit_b32 v137, v106, v105, 16
    ds_write_b128 v130, v[134:137] offset:1056
    v_alignbit_b32 v142, v104, v103, 16
    v_alignbit_b32 v143, v105, v104, 16
    v_alignbit_b32 v144, v106, v105, 16
    v_alignbit_b32 v145, v107, v106, 16
    ds_write_b128 v130, v[142:145] offset:9312
    ds_write_b128 v130, v[112:115] offset:14464
    v_mov_b32_dpp v110, v106 wave_ror:1 row_mask:0xf bank_mask:0xf
    v_mov_b32_dpp v111, v107 wave_ror:1 row_mask:0xf bank_mask:0xf
    v_mov_b32 v149, v112
    v_mov_b32 v150, v113
    v_mov_b32 v151, v114
    v_mov_b32_dpp v110, v114 wave_shr:1 row_mask:0xf bank_mask:0xf
    v_mov_b32_dpp v111, v115 wave_shr:1 row_mask:0xf bank_mask:0xf
    v_mov_b32 v148, v111
    ds_write_b128 v130, v[148:151] offset:6208
    v_alignbit_b32 v134, v111, v110, 16
    v_alignbit_b32 v135, v112, v111, 16
    v_alignbit_b32 v136, v113, v112, 16
    v_alignbit_b32 v137, v114, v113, 16
    ds_write_b128 v130, v[134:137] offset:2080
    v_alignbit_b32 v142, v112, v111, 16
    v_alignbit_b32 v143, v113, v112, 16
    v_alignbit_b32 v144, v114, v113, 16
    v_alignbit_b32 v145, v115, v114, 16
    ds_write_b128 v130, v[142:145] offset:10336
    buffer_load_dword v14, v10, s[4:7], s58 offen sc1
    ds_write_b128 v130, v[120:123] offset:15488
    v_mov_b32_dpp v118, v114 wave_ror:1 row_mask:0xf bank_mask:0xf
    v_mov_b32_dpp v119, v115 wave_ror:1 row_mask:0xf bank_mask:0xf
    v_mov_b32 v149, v120
    v_mov_b32 v150, v121
    v_mov_b32 v151, v122
    v_mov_b32_dpp v118, v122 wave_shr:1 row_mask:0xf bank_mask:0xf
    v_mov_b32_dpp v119, v123 wave_shr:1 row_mask:0xf bank_mask:0xf
    v_mov_b32 v148, v119
    ds_write_b128 v130, v[148:151] offset:7232
    v_alignbit_b32 v134, v119, v118, 16
    v_alignbit_b32 v135, v120, v119, 16
    v_alignbit_b32 v136, v121, v120, 16
    v_alignbit_b32 v137, v122, v121, 16
    ds_write_b128 v130, v[134:137] offset:3104
    v_alignbit_b32 v142, v120, v119, 16
    v_alignbit_b32 v143, v121, v120, 16
    v_alignbit_b32 v144, v122, v121, 16
    v_alignbit_b32 v145, v123, v122, 16
    ds_write_b128 v130, v[142:145] offset:11360
    v_mov_b32 v180, 0
    v_mov_b32 v181, 0
    v_mov_b32 v182, 0
    v_mov_b32 v183, 0
    ds_write_b128 v132, v[180:183]
    v_and_b32 v3, 1, v131
    v_lshlrev_b32 v3, 4, v3
    v_lshlrev_b32 v5, v3, v5
    v_ashrrev_i32 v131, 1, v131
    v_cmp_eq_u32 vcc, 0, v131
    s_nop 1
    v_cndmask_b32 v20, 0, v5, vcc
    v_cmp_eq_u32 vcc, 1, v131
    s_nop 1
    v_cndmask_b32 v21, 0, v5, vcc
    v_cmp_eq_u32 vcc, 2, v131
    s_nop 1
    v_cndmask_b32 v22, 0, v5, vcc
    v_cmp_eq_u32 vcc, 3, v131
    s_nop 1
    v_cndmask_b32 v23, 0, v5, vcc
    ds_read2_b64 v[72:75], v11 offset0:192 offset1:193
    ds_read2_b64 v[68:71], v11 offset0:128 offset1:129
    ds_read2_b64 v[64:67], v11 offset0:64 offset1:65
    ds_read2_b64 v[60:63], v11 offset0:0 offset1:1
    ds_read2_b64 v[56:59], v6 offset0:192 offset1:193
    ds_read2_b64 v[52:55], v6 offset0:128 offset1:129
    ds_read2_b64 v[48:51], v6 offset0:64 offset1:65
    ds_read2_b64 v[44:47], v6 offset0:0 offset1:1
    s_mov_b32 s49, 65536
    s_waitcnt vmcnt(0)
    v_cmp_ne_u32 vcc, s48, v14
    s_nop 0
    s_cbranch_vccz L_adaL_got_9
L_adaL_poll_8:
    buffer_load_dword v14, v10, s[4:7], s58 offen sc1
    s_waitcnt vmcnt(0)
    s_sub_u32 s49, s49, 1
    s_cbranch_scc1 L_adaL_got_9
    v_cmp_ne_u32 vcc, s48, v14
    s_nop 0
    s_cbranch_vccnz L_adaL_poll_8
L_adaL_got_9:
    s_mov_b32 s61, 1048576
    s_add_u32 m0, s57, 256
    s_nop 0
    buffer_load_dwordx4 v4, s[4:7], s61 offen offset:0 sc1 lds
    buffer_load_dwordx4 v4, s[4:7], s61 offen offset:1024 sc1 lds
    s_add_u32 m0, s57, 512
    s_nop 0
    buffer_load_dwordx4 v4, s[4:7], s61 offen offset:2048 sc1 lds
    buffer_load_dwordx4 v4, s[4:7], s61 offen offset:3072 sc1 lds
    s_lshl_b32 s61, s2, 14
    s_add_u32 s68, s61, 3670016
    s_add_u32 s64, s61, 6291456
    s_add_u32 s69, s61, 3674112
    s_add_u32 s65, s61, 6295552
    s_add_u32 s70, s61, 3678208
    s_add_u32 s66, s61, 6299648
    s_add_u32 s71, s61, 3682304
    s_add_u32 s67, s61, 6303744
    s_and_b32 s62, s2, 7
    s_cmp_lg_u32 s54, 0
    s_cselect_b32 s61, 0, 393216
    s_sub_u32 s63, s63, s61
    s_sub_u32 s58, s58, 393216
    v_mov_b32 v24, v10
    v_lshrrev_b32 v2, 2, v1
    v_min_u32 v2, 2, v2
    v_mul_u32_u24 v2, 5120, v2
    v_and_b32 v3, 3, v1
    v_lshl_add_u32 v2, v3, 3, v2
    s_lshl_b32 s61, s2, 5
    s_add_u32 s61, s61, 32768
    v_add_u32 v25, s61, v2
    s_lshl_b32 s62, s62, 8
    s_add_u32 s62, s62, 180224
    v_and_b32 v2, 31, v1
    v_lshl_add_u32 v10, v2, 3, s62
    v_bfe_u32 v2, v0, 4, 1
    v_bfe_u32 v3, v0, 5, 1
    v_lshl_add_u32 v2, v3, 2, v2
    v_lshlrev_b32 v2, 1, v2
    v_xor_b32 v2, v0, v2
    v_lshlrev_b32 v228, 3, v2
    v_add_u32 v229, 33024, v228
    s_lshr_b32 s60, s2, 3
    s_mul_i32 s60, s60, 0
    s_and_b32 s61, s2, 7
    s_lshl_b32 s61, s61, 20
    s_add_u32 s60, s60, s61
    s_add_u32 s60, s60, 1048576
    v_lshlrev_b32 v230, 5, v0
    s_barrier
    s_mov_b64 exec, 65535
    buffer_store_dword v12, v27, s[4:7], s63 offen sc1
    s_mov_b64 exec, -1
    v_lshrrev_b32 v240, 6, v0
    s_nop 0
    v_readfirstlane_b32 s82, v240
    s_bfe_u32 s87, s2, 0x30003
    s_and_b32 s83, s2, 6
    s_lshl_b32 s83, s83, 2
    s_add_u32 s83, s83, s87
    s_lshr_b32 s87, s2, 6
    s_and_b32 s84, s2, 1
    s_lshl_b32 s84, s84, 2
    s_add_u32 s84, s84, s87
    v_and_b32 v240, 63, v0
    v_lshlrev_b32 v241, 4, v240
    s_add_u32 s87, s82, 1
    s_lshl_b32 s87, s87, 29
    s_and_b32 s87, s87, 2147483648
    s_or_b32 s87, s87, 20480
    v_add_u32 v242, s87, v241
    s_mul_i32 s85, s84, 286720
    s_mul_i32 s87, s82, 40960
    s_add_u32 s85, s85, s87
    s_add_u32 s85, s85, 9056256
    s_and_b32 s86, s2, 7
    s_mul_i32 s86, s86, 3840
    s_mul_i32 s87, s84, 384
    s_add_u32 s86, s86, s87
    s_add_u32 s86, s86, 65536
    v_min_u32 v243, 9, v240
    v_lshlrev_b32 v243, 5, v243
    v_lshrrev_b32 v246, 3, v240
    v_lshlrev_b32 v245, 13, v246
    v_lshrrev_b32 v246, 4, v240
    v_and_b32 v247, 7, v0
    v_xor_b32 v246, v246, v247
    v_lshl_add_u32 v245, v246, 4, v245
    s_mul_i32 s87, s84, 0
    v_add_u32 v245, s87, v245
    v_xor_b32 v246, 64, v245
    v_add_u32 v246, 64512, v246
    s_lshl_b32 s88, s83, 18
    s_lshl_b32 s87, s82, 10
    s_add_u32 s88, s88, s87
    s_add_u32 s87, s82, 3
    s_and_b32 s40, s87, 1
    s_and_b32 s87, s87, 2
    s_lshl_b32 s87, s87, 4
    s_add_u32 s87, s87, s40
    s_lshl_b32 s87, s87, 12
    s_add_u32 s91, s88, s87
    s_add_u32 s87, s82, 2
    s_and_b32 s40, s87, 1
    s_and_b32 s87, s87, 2
    s_lshl_b32 s87, s87, 4
    s_add_u32 s87, s87, s40
    s_lshl_b32 s87, s87, 12
    s_add_u32 s90, s88, s87
    s_add_u32 s87, s82, 1
    s_and_b32 s40, s87, 1
    s_and_b32 s87, s87, 2
    s_lshl_b32 s87, s87, 4
    s_add_u32 s87, s87, s40
    s_lshl_b32 s87, s87, 12
    s_add_u32 s89, s88, s87
    s_add_u32 s87, s82, 0
    s_and_b32 s40, s87, 1
    s_and_b32 s87, s87, 2
    s_lshl_b32 s87, s87, 4
    s_add_u32 s87, s87, s40
    s_lshl_b32 s87, s87, 12
    s_add_u32 s88, s88, s87
    s_movk_i32 s40, 0x380
    s_mul_i32 s41, s82, 14336
    s_add_u32 s41, s41, 102912
    s_waitcnt vmcnt(1) lgkmcnt(0)
    ds_read_b128 v[76:79], v7 offset:224
    ds_read_b128 v[80:83], v7 offset:480
    ds_read_b128 v[84:87], v7 offset:736
    ds_read_b128 v[88:91], v7 offset:992
    ds_read_b128 v[92:95], v7 offset:1248
    ds_read_b128 v[96:99], v7 offset:1504
    ds_read_b128 v[100:103], v7 offset:1760
    ds_read_b128 v[104:107], v7 offset:2016
    s_waitcnt lgkmcnt(7)
    v_mfma_f32_16x16x32_bf16 v[140:143], v[20:23], v[76:79], 0
    s_waitcnt lgkmcnt(6)
    v_mfma_f32_16x16x32_bf16 v[144:147], v[20:23], v[80:83], 0
    s_waitcnt lgkmcnt(5)
    v_mfma_f32_16x16x32_bf16 v[148:151], v[20:23], v[84:87], 0
    s_waitcnt lgkmcnt(4)
    v_mfma_f32_16x16x32_bf16 v[152:155], v[20:23], v[88:91], 0
    s_waitcnt lgkmcnt(3)
    v_mfma_f32_16x16x32_bf16 v[156:159], v[20:23], v[92:95], 0
    s_waitcnt lgkmcnt(2)
    v_mfma_f32_16x16x32_bf16 v[160:163], v[20:23], v[96:99], 0
    s_waitcnt lgkmcnt(0)
    v_mfma_f32_16x16x32_bf16 v[164:167], v[20:23], v[100:103], 0
    v_mfma_f32_16x16x32_bf16 v[168:171], v[20:23], v[104:107], 0
    v_mfma_f32_16x16x32_bf16 v[168:171], v[72:75], v[76:79], v[168:171]
    ds_read2_b64 v[72:75], v11 offset0:200 offset1:201
    s_mul_i32 s78, s2, 52429
    v_mfma_f32_16x16x32_bf16 v[164:167], v[68:71], v[76:79], v[164:167]
    s_lshr_b32 s78, s78, 18
    s_lshr_b32 s79, s78, 1
    s_mul_i32 s79, s79, 44
    v_mfma_f32_16x16x32_bf16 v[168:171], v[68:71], v[80:83], v[168:171]
    ds_read2_b64 v[68:71], v11 offset0:136 offset1:137
    s_lshl_b32 s80, s78, 5
    v_mfma_f32_16x16x32_bf16 v[160:163], v[64:67], v[76:79], v[160:163]
    s_add_u32 s79, s79, s80
    s_mul_i32 s80, s78, 108
    s_sub_u32 s80, s80, 1664
    v_mfma_f32_16x16x32_bf16 v[164:167], v[64:67], v[80:83], v[164:167]
    ds_read_b128 v[108:111], v7 offset:192
    s_cmp_ge_u32 s78, 16
    s_cselect_b32 s79, s80, s79
    v_mfma_f32_16x16x32_bf16 v[168:171], v[64:67], v[84:87], v[168:171]
    ds_read2_b64 v[64:67], v11 offset0:72 offset1:73
    s_lshl_b32 s80, s54, 3
    v_mfma_f32_16x16x32_bf16 v[156:159], v[60:63], v[76:79], v[156:159]
    s_add_u32 s79, s79, s80
    s_mul_i32 s80, s78, 216
    s_and_b32 s81, s54, 1
    v_mfma_f32_16x16x32_bf16 v[160:163], v[60:63], v[80:83], v[160:163]
    s_lshl_b32 s81, s81, 3
    s_add_u32 s80, s80, s81
    s_lshr_b32 s81, s54, 1
    v_mfma_f32_16x16x32_bf16 v[164:167], v[60:63], v[84:87], v[164:167]
    ds_read_b128 v[112:115], v7 offset:448
    s_add_u32 s80, s80, s81
    v_mfma_f32_16x16x32_bf16 v[168:171], v[60:63], v[88:91], v[168:171]
    ds_read2_b64 v[60:63], v11 offset0:8 offset1:9
    s_sub_u32 s80, s80, 5088
    v_mfma_f32_16x16x32_bf16 v[152:155], v[56:59], v[76:79], v[152:155]
    s_cmp_ge_u32 s78, 24
    s_cselect_b32 s72, s80, s79
    s_cselect_b32 s73, 129280, 0
    s_cselect_b32 s81, 1280, 0
    v_mfma_f32_16x16x32_bf16 v[156:159], v[56:59], v[80:83], v[156:159]
    s_add_u32 s73, s73, 1280
    s_add_u32 s81, s81, 1280
    s_mul_i32 s72, s72, 1280
    v_mfma_f32_16x16x32_bf16 v[160:163], v[56:59], v[84:87], v[160:163]
    ds_read_b128 v[116:119], v7 offset:704
    s_mul_i32 s79, s78, 5
    v_mfma_f32_16x16x32_bf16 v[164:167], v[56:59], v[88:91], v[164:167]
    s_sub_u32 s79, s2, s79
    s_lshl_b32 s79, s79, 6
    v_add_u32 v196, s79, v1
    v_mfma_f32_16x16x32_bf16 v[168:171], v[56:59], v[92:95], v[168:171]
    ds_read2_b64 v[56:59], v6 offset0:200 offset1:201
    v_lshlrev_b32 v197, 2, v196
    v_mfma_f32_16x16x32_bf16 v[148:151], v[52:55], v[76:79], v[148:151]
    buffer_load_dword v200, v197, s[36:39], s72 offen
    s_add_u32 s72, s72, s81
    v_mfma_f32_16x16x32_bf16 v[152:155], v[52:55], v[80:83], v[152:155]
    ds_read_b128 v[120:123], v7 offset:960
    v_mfma_f32_16x16x32_bf16 v[156:159], v[52:55], v[84:87], v[156:159]
    buffer_load_dword v201, v197, s[36:39], s72 offen
    s_add_u32 s72, s72, s81
    v_mfma_f32_16x16x32_bf16 v[160:163], v[52:55], v[88:91], v[160:163]
    buffer_load_dword v202, v197, s[36:39], s72 offen
    s_add_u32 s72, s72, s81
    v_mfma_f32_16x16x32_bf16 v[164:167], v[52:55], v[92:95], v[164:167]
    ds_read_b128 v[124:127], v7 offset:1216
    v_mfma_f32_16x16x32_bf16 v[168:171], v[52:55], v[96:99], v[168:171]
    ds_read2_b64 v[52:55], v6 offset0:136 offset1:137
    v_mfma_f32_16x16x32_bf16 v[144:147], v[48:51], v[76:79], v[144:147]
    buffer_load_dword v203, v197, s[36:39], s72 offen
    s_add_u32 s72, s72, s73
    v_mfma_f32_16x16x32_bf16 v[148:151], v[48:51], v[80:83], v[148:151]
    buffer_load_dword v204, v197, s[36:39], s72 offen
    s_add_u32 s72, s72, s81
    v_mfma_f32_16x16x32_bf16 v[152:155], v[48:51], v[84:87], v[152:155]
    ds_read_b128 v[128:131], v7 offset:1472
    v_mfma_f32_16x16x32_bf16 v[156:159], v[48:51], v[88:91], v[156:159]
    buffer_load_dword v205, v197, s[36:39], s72 offen
    s_add_u32 s72, s72, s81
    v_mfma_f32_16x16x32_bf16 v[160:163], v[48:51], v[92:95], v[160:163]
    buffer_load_dword v206, v197, s[36:39], s72 offen
    s_add_u32 s72, s72, s81
    v_mfma_f32_16x16x32_bf16 v[164:167], v[48:51], v[96:99], v[164:167]
    ds_read_b128 v[132:135], v7 offset:1728
    v_mfma_f32_16x16x32_bf16 v[168:171], v[48:51], v[100:103], v[168:171]
    ds_read2_b64 v[48:51], v6 offset0:72 offset1:73
    v_mfma_f32_16x16x32_bf16 v[140:143], v[44:47], v[76:79], v[140:143]
    buffer_load_dword v207, v197, s[36:39], s72 offen
    v_mfma_f32_16x16x32_bf16 v[144:147], v[44:47], v[80:83], v[144:147]
    v_mfma_f32_16x16x32_bf16 v[148:151], v[44:47], v[84:87], v[148:151]
    ds_read_b128 v[136:139], v7 offset:1984
    v_mfma_f32_16x16x32_bf16 v[152:155], v[44:47], v[88:91], v[152:155]
    v_mfma_f32_16x16x32_bf16 v[156:159], v[44:47], v[92:95], v[156:159]
    v_mfma_f32_16x16x32_bf16 v[160:163], v[44:47], v[96:99], v[160:163]
    v_mfma_f32_16x16x32_bf16 v[164:167], v[44:47], v[100:103], v[164:167]
    v_mfma_f32_16x16x32_bf16 v[168:171], v[44:47], v[104:107], v[168:171]
    ds_read2_b64 v[44:47], v6 offset0:8 offset1:9
    s_waitcnt lgkmcnt(2)
    v_mfma_f32_16x16x32_bf16 v[168:171], v[72:75], v[108:111], v[168:171]
    ds_read2_b64 v[72:75], v11 offset0:208 offset1:209
    v_mfma_f32_16x16x32_bf16 v[164:167], v[68:71], v[108:111], v[164:167]
    v_mfma_f32_16x16x32_bf16 v[168:171], v[68:71], v[112:115], v[168:171]
    ds_read2_b64 v[68:71], v11 offset0:144 offset1:145
    v_mfma_f32_16x16x32_bf16 v[160:163], v[64:67], v[108:111], v[160:163]
    v_mfma_f32_16x16x32_bf16 v[164:167], v[64:67], v[112:115], v[164:167]
    ds_read_b128 v[76:79], v7 offset:160
    v_mfma_f32_16x16x32_bf16 v[168:171], v[64:67], v[116:119], v[168:171]
    ds_read2_b64 v[64:67], v11 offset0:80 offset1:81
    v_mfma_f32_16x16x32_bf16 v[156:159], v[60:63], v[108:111], v[156:159]
    v_mfma_f32_16x16x32_bf16 v[160:163], v[60:63], v[112:115], v[160:163]
    v_mfma_f32_16x16x32_bf16 v[164:167], v[60:63], v[116:119], v[164:167]
    ds_read_b128 v[80:83], v7 offset:416
    v_mfma_f32_16x16x32_bf16 v[168:171], v[60:63], v[120:123], v[168:171]
    ds_read2_b64 v[60:63], v11 offset0:16 offset1:17
    v_mfma_f32_16x16x32_bf16 v[152:155], v[56:59], v[108:111], v[152:155]
    v_mfma_f32_16x16x32_bf16 v[156:159], v[56:59], v[112:115], v[156:159]
    v_mfma_f32_16x16x32_bf16 v[160:163], v[56:59], v[116:119], v[160:163]
    ds_read_b128 v[84:87], v7 offset:672
    v_mfma_f32_16x16x32_bf16 v[164:167], v[56:59], v[120:123], v[164:167]
    v_mfma_f32_16x16x32_bf16 v[168:171], v[56:59], v[124:127], v[168:171]
    ds_read2_b64 v[56:59], v6 offset0:208 offset1:209
    v_mfma_f32_16x16x32_bf16 v[148:151], v[52:55], v[108:111], v[148:151]
    v_mfma_f32_16x16x32_bf16 v[152:155], v[52:55], v[112:115], v[152:155]
    ds_read_b128 v[88:91], v7 offset:928
    v_mfma_f32_16x16x32_bf16 v[156:159], v[52:55], v[116:119], v[156:159]
    v_mfma_f32_16x16x32_bf16 v[160:163], v[52:55], v[120:123], v[160:163]
    v_mfma_f32_16x16x32_bf16 v[164:167], v[52:55], v[124:127], v[164:167]
    ds_read_b128 v[92:95], v7 offset:1184
    v_mfma_f32_16x16x32_bf16 v[168:171], v[52:55], v[128:131], v[168:171]
    ds_read2_b64 v[52:55], v6 offset0:144 offset1:145
    v_mfma_f32_16x16x32_bf16 v[144:147], v[48:51], v[108:111], v[144:147]
    v_mfma_f32_16x16x32_bf16 v[148:151], v[48:51], v[112:115], v[148:151]
    v_mfma_f32_16x16x32_bf16 v[152:155], v[48:51], v[116:119], v[152:155]
    ds_read_b128 v[96:99], v7 offset:1440
    v_mfma_f32_16x16x32_bf16 v[156:159], v[48:51], v[120:123], v[156:159]
    v_mfma_f32_16x16x32_bf16 v[160:163], v[48:51], v[124:127], v[160:163]
    v_mfma_f32_16x16x32_bf16 v[164:167], v[48:51], v[128:131], v[164:167]
    ds_read_b128 v[100:103], v7 offset:1696
    v_mfma_f32_16x16x32_bf16 v[168:171], v[48:51], v[132:135], v[168:171]
    ds_read2_b64 v[48:51], v6 offset0:80 offset1:81
    s_waitcnt lgkmcnt(3)
    v_mfma_f32_16x16x32_bf16 v[140:143], v[44:47], v[108:111], v[140:143]
    v_mfma_f32_16x16x32_bf16 v[144:147], v[44:47], v[112:115], v[144:147]
    v_mfma_f32_16x16x32_bf16 v[148:151], v[44:47], v[116:119], v[148:151]
    ds_read_b128 v[104:107], v7 offset:1952
    v_mfma_f32_16x16x32_bf16 v[152:155], v[44:47], v[120:123], v[152:155]
    v_mfma_f32_16x16x32_bf16 v[156:159], v[44:47], v[124:127], v[156:159]
    v_mfma_f32_16x16x32_bf16 v[160:163], v[44:47], v[128:131], v[160:163]
    v_mfma_f32_16x16x32_bf16 v[164:167], v[44:47], v[132:135], v[164:167]
    v_mfma_f32_16x16x32_bf16 v[168:171], v[44:47], v[136:139], v[168:171]
    ds_read2_b64 v[44:47], v6 offset0:16 offset1:17
    buffer_load_dwordx2 v[14:15], v10, s[4:7], 0 offen sc1
    buffer_load_dword v16, v24, s[4:7], s58 offen sc1
    v_mfma_f32_16x16x32_bf16 v[168:171], v[72:75], v[76:79], v[168:171]
    ds_read2_b64 v[72:75], v11 offset0:216 offset1:217
    v_mfma_f32_16x16x32_bf16 v[164:167], v[68:71], v[76:79], v[164:167]
    v_mfma_f32_16x16x32_bf16 v[168:171], v[68:71], v[80:83], v[168:171]
    ds_read2_b64 v[68:71], v11 offset0:152 offset1:153
    v_mfma_f32_16x16x32_bf16 v[160:163], v[64:67], v[76:79], v[160:163]
    v_mfma_f32_16x16x32_bf16 v[164:167], v[64:67], v[80:83], v[164:167]
    ds_read_b128 v[108:111], v7 offset:128
    v_mfma_f32_16x16x32_bf16 v[168:171], v[64:67], v[84:87], v[168:171]
    ds_read2_b64 v[64:67], v11 offset0:88 offset1:89
    v_mfma_f32_16x16x32_bf16 v[156:159], v[60:63], v[76:79], v[156:159]
    v_mfma_f32_16x16x32_bf16 v[160:163], v[60:63], v[80:83], v[160:163]
    v_mfma_f32_16x16x32_bf16 v[164:167], v[60:63], v[84:87], v[164:167]
    ds_read_b128 v[112:115], v7 offset:384
    v_mfma_f32_16x16x32_bf16 v[168:171], v[60:63], v[88:91], v[168:171]
    ds_read2_b64 v[60:63], v11 offset0:24 offset1:25
    v_mfma_f32_16x16x32_bf16 v[152:155], v[56:59], v[76:79], v[152:155]
    v_mfma_f32_16x16x32_bf16 v[156:159], v[56:59], v[80:83], v[156:159]
    v_mfma_f32_16x16x32_bf16 v[160:163], v[56:59], v[84:87], v[160:163]
    ds_read_b128 v[116:119], v7 offset:640
    v_mfma_f32_16x16x32_bf16 v[164:167], v[56:59], v[88:91], v[164:167]
    v_mfma_f32_16x16x32_bf16 v[168:171], v[56:59], v[92:95], v[168:171]
    ds_read2_b64 v[56:59], v6 offset0:216 offset1:217
    v_mfma_f32_16x16x32_bf16 v[148:151], v[52:55], v[76:79], v[148:151]
    v_mfma_f32_16x16x32_bf16 v[152:155], v[52:55], v[80:83], v[152:155]
    ds_read_b128 v[120:123], v7 offset:896
    v_mfma_f32_16x16x32_bf16 v[156:159], v[52:55], v[84:87], v[156:159]
    v_mfma_f32_16x16x32_bf16 v[160:163], v[52:55], v[88:91], v[160:163]
    v_mfma_f32_16x16x32_bf16 v[164:167], v[52:55], v[92:95], v[164:167]
    ds_read_b128 v[124:127], v7 offset:1152
    s_waitcnt lgkmcnt(3)
    v_mfma_f32_16x16x32_bf16 v[168:171], v[52:55], v[96:99], v[168:171]
    ds_read2_b64 v[52:55], v6 offset0:152 offset1:153
    v_mfma_f32_16x16x32_bf16 v[144:147], v[48:51], v[76:79], v[144:147]
    v_mfma_f32_16x16x32_bf16 v[148:151], v[48:51], v[80:83], v[148:151]
    v_mfma_f32_16x16x32_bf16 v[152:155], v[48:51], v[84:87], v[152:155]
    ds_read_b128 v[128:131], v7 offset:1408
    v_mfma_f32_16x16x32_bf16 v[156:159], v[48:51], v[88:91], v[156:159]
    v_mfma_f32_16x16x32_bf16 v[160:163], v[48:51], v[92:95], v[160:163]
    v_mfma_f32_16x16x32_bf16 v[164:167], v[48:51], v[96:99], v[164:167]
    ds_read_b128 v[132:135], v7 offset:1664
    v_mfma_f32_16x16x32_bf16 v[168:171], v[48:51], v[100:103], v[168:171]
    ds_read2_b64 v[48:51], v6 offset0:88 offset1:89
    v_mfma_f32_16x16x32_bf16 v[140:143], v[44:47], v[76:79], v[140:143]
    v_mfma_f32_16x16x32_bf16 v[144:147], v[44:47], v[80:83], v[144:147]
    v_mfma_f32_16x16x32_bf16 v[148:151], v[44:47], v[84:87], v[148:151]
    ds_read_b128 v[136:139], v7 offset:1920
    v_mfma_f32_16x16x32_bf16 v[152:155], v[44:47], v[88:91], v[152:155]
    v_mfma_f32_16x16x32_bf16 v[156:159], v[44:47], v[92:95], v[156:159]
    v_mfma_f32_16x16x32_bf16 v[160:163], v[44:47], v[96:99], v[160:163]
    v_mfma_f32_16x16x32_bf16 v[164:167], v[44:47], v[100:103], v[164:167]
    v_mfma_f32_16x16x32_bf16 v[168:171], v[44:47], v[104:107], v[168:171]
    ds_read2_b64 v[44:47], v6 offset0:24 offset1:25
    v_mfma_f32_16x16x32_bf16 v[168:171], v[72:75], v[108:111], v[168:171]
    ds_read2_b64 v[72:75], v11 offset0:224 offset1:225
    v_mfma_f32_16x16x32_bf16 v[164:167], v[68:71], v[108:111], v[164:167]
    v_mfma_f32_16x16x32_bf16 v[168:171], v[68:71], v[112:115], v[168:171]
    ds_read2_b64 v[68:71], v11 offset0:160 offset1:161
    v_mfma_f32_16x16x32_bf16 v[160:163], v[64:67], v[108:111], v[160:163]
    v_mfma_f32_16x16x32_bf16 v[164:167], v[64:67], v[112:115], v[164:167]
    ds_read_b128 v[76:79], v7 offset:96
    v_mfma_f32_16x16x32_bf16 v[168:171], v[64:67], v[116:119], v[168:171]
    ds_read2_b64 v[64:67], v11 offset0:96 offset1:97
    v_mfma_f32_16x16x32_bf16 v[156:159], v[60:63], v[108:111], v[156:159]
    v_mfma_f32_16x16x32_bf16 v[160:163], v[60:63], v[112:115], v[160:163]
    v_mfma_f32_16x16x32_bf16 v[164:167], v[60:63], v[116:119], v[164:167]
    ds_read_b128 v[80:83], v7 offset:352
    s_waitcnt lgkmcnt(3)
    v_mfma_f32_16x16x32_bf16 v[168:171], v[60:63], v[120:123], v[168:171]
    ds_read2_b64 v[60:63], v11 offset0:32 offset1:33
    v_mfma_f32_16x16x32_bf16 v[152:155], v[56:59], v[108:111], v[152:155]
    v_mfma_f32_16x16x32_bf16 v[156:159], v[56:59], v[112:115], v[156:159]
    v_mfma_f32_16x16x32_bf16 v[160:163], v[56:59], v[116:119], v[160:163]
    ds_read_b128 v[84:87], v7 offset:608
    v_mfma_f32_16x16x32_bf16 v[164:167], v[56:59], v[120:123], v[164:167]
    v_mfma_f32_16x16x32_bf16 v[168:171], v[56:59], v[124:127], v[168:171]
    ds_read2_b64 v[56:59], v6 offset0:224 offset1:225
    v_mfma_f32_16x16x32_bf16 v[148:151], v[52:55], v[108:111], v[148:151]
    v_mfma_f32_16x16x32_bf16 v[152:155], v[52:55], v[112:115], v[152:155]
    ds_read_b128 v[88:91], v7 offset:864
    v_mfma_f32_16x16x32_bf16 v[156:159], v[52:55], v[116:119], v[156:159]
    v_mfma_f32_16x16x32_bf16 v[160:163], v[52:55], v[120:123], v[160:163]
    v_mfma_f32_16x16x32_bf16 v[164:167], v[52:55], v[124:127], v[164:167]
    ds_read_b128 v[92:95], v7 offset:1120
    v_mfma_f32_16x16x32_bf16 v[168:171], v[52:55], v[128:131], v[168:171]
    ds_read2_b64 v[52:55], v6 offset0:160 offset1:161
    v_mfma_f32_16x16x32_bf16 v[144:147], v[48:51], v[108:111], v[144:147]
    v_mfma_f32_16x16x32_bf16 v[148:151], v[48:51], v[112:115], v[148:151]
    v_mfma_f32_16x16x32_bf16 v[152:155], v[48:51], v[116:119], v[152:155]
    ds_read_b128 v[96:99], v7 offset:1376
    v_mfma_f32_16x16x32_bf16 v[156:159], v[48:51], v[120:123], v[156:159]
    v_mfma_f32_16x16x32_bf16 v[160:163], v[48:51], v[124:127], v[160:163]
    v_mfma_f32_16x16x32_bf16 v[164:167], v[48:51], v[128:131], v[164:167]
    ds_read_b128 v[100:103], v7 offset:1632
    v_mfma_f32_16x16x32_bf16 v[168:171], v[48:51], v[132:135], v[168:171]
    ds_read2_b64 v[48:51], v6 offset0:96 offset1:97
    v_mfma_f32_16x16x32_bf16 v[140:143], v[44:47], v[108:111], v[140:143]
    v_mfma_f32_16x16x32_bf16 v[144:147], v[44:47], v[112:115], v[144:147]
    v_mfma_f32_16x16x32_bf16 v[148:151], v[44:47], v[116:119], v[148:151]
    ds_read_b128 v[104:107], v7 offset:1888
    v_mfma_f32_16x16x32_bf16 v[152:155], v[44:47], v[120:123], v[152:155]
    v_mfma_f32_16x16x32_bf16 v[156:159], v[44:47], v[124:127], v[156:159]
    v_mfma_f32_16x16x32_bf16 v[160:163], v[44:47], v[128:131], v[160:163]
    v_mfma_f32_16x16x32_bf16 v[164:167], v[44:47], v[132:135], v[164:167]
    v_mfma_f32_16x16x32_bf16 v[168:171], v[44:47], v[136:139], v[168:171]
    ds_read2_b64 v[44:47], v6 offset0:32 offset1:33
    s_waitcnt vmcnt(1) lgkmcnt(2)
    v_cmp_ne_u32 vcc, s48, v15
    s_waitcnt vmcnt(0)
    v_cmp_ne_u32 s[50:51], s48, v16
    s_nop 0
    s_or_b64 vcc, vcc, s[50:51]
    s_cbranch_vccnz L_adaL_slow_10
L_adaL_got_12:
    v_mfma_f32_16x16x32_bf16 v[168:171], v[72:75], v[76:79], v[168:171]
    ds_read2_b64 v[72:75], v11 offset0:232 offset1:233
    v_mfma_f32_16x16x32_bf16 v[164:167], v[68:71], v[76:79], v[164:167]
    buffer_load_dwordx4 v[28:31], v9, s[4:7], s68 offen sc1
    v_mfma_f32_16x16x32_bf16 v[168:171], v[68:71], v[80:83], v[168:171]
    ds_read2_b64 v[68:71], v11 offset0:168 offset1:169
    v_mfma_f32_16x16x32_bf16 v[160:163], v[64:67], v[76:79], v[160:163]
    buffer_load_dwordx4 v[32:35], v9, s[4:7], s69 offen sc1
    v_mfma_f32_16x16x32_bf16 v[164:167], v[64:67], v[80:83], v[164:167]
    ds_read_b128 v[108:111], v7 offset:64
    v_mfma_f32_16x16x32_bf16 v[168:171], v[64:67], v[84:87], v[168:171]
    ds_read2_b64 v[64:67], v11 offset0:104 offset1:105
    v_mfma_f32_16x16x32_bf16 v[156:159], v[60:63], v[76:79], v[156:159]
    buffer_load_dwordx4 v[36:39], v9, s[4:7], s70 offen sc1
    v_mfma_f32_16x16x32_bf16 v[160:163], v[60:63], v[80:83], v[160:163]
    buffer_load_dwordx4 v[40:43], v9, s[4:7], s71 offen sc1
    s_mov_b32 s61, 16384
    v_mfma_f32_16x16x32_bf16 v[164:167], v[60:63], v[84:87], v[164:167]
    ds_read_b128 v[112:115], v7 offset:320
    v_mfma_f32_16x16x32_bf16 v[168:171], v[60:63], v[88:91], v[168:171]
    ds_read2_b64 v[60:63], v11 offset0:40 offset1:41
    v_mfma_f32_16x16x32_bf16 v[152:155], v[56:59], v[76:79], v[152:155]
    buffer_load_dwordx4 v[172:175], v9, s[4:7], s61 offen sc1
    s_add_u32 s61, s61, 4096
    v_mfma_f32_16x16x32_bf16 v[156:159], v[56:59], v[80:83], v[156:159]
    buffer_load_dwordx4 v[176:179], v9, s[4:7], s61 offen sc1
    s_add_u32 s61, s61, 4096
    v_mfma_f32_16x16x32_bf16 v[160:163], v[56:59], v[84:87], v[160:163]
    ds_read_b128 v[116:119], v7 offset:576
    v_mfma_f32_16x16x32_bf16 v[164:167], v[56:59], v[88:91], v[164:167]
    buffer_load_dwordx4 v[180:183], v9, s[4:7], s61 offen sc1
    s_add_u32 s61, s61, 4096
    v_mfma_f32_16x16x32_bf16 v[168:171], v[56:59], v[92:95], v[168:171]
    ds_read2_b64 v[56:59], v6 offset0:232 offset1:233
    v_mfma_f32_16x16x32_bf16 v[148:151], v[52:55], v[76:79], v[148:151]
    buffer_load_dwordx4 v[184:187], v9, s[4:7], s61 offen sc1
    s_add_u32 s61, s61, 4096
    v_mfma_f32_16x16x32_bf16 v[152:155], v[52:55], v[80:83], v[152:155]
    ds_read_b128 v[120:123], v7 offset:832
    v_mfma_f32_16x16x32_bf16 v[156:159], v[52:55], v[84:87], v[156:159]
    buffer_load_dwordx2 v[14:15], v25, s[4:7], 0 offen sc1
    v_mfma_f32_16x16x32_bf16 v[160:163], v[52:55], v[88:91], v[160:163]
    v_mfma_f32_16x16x32_bf16 v[164:167], v[52:55], v[92:95], v[164:167]
    ds_read_b128 v[124:127], v7 offset:1088
    v_mfma_f32_16x16x32_bf16 v[168:171], v[52:55], v[96:99], v[168:171]
    ds_read2_b64 v[52:55], v6 offset0:168 offset1:169
    v_mfma_f32_16x16x32_bf16 v[144:147], v[48:51], v[76:79], v[144:147]
    v_mfma_f32_16x16x32_bf16 v[148:151], v[48:51], v[80:83], v[148:151]
    v_mfma_f32_16x16x32_bf16 v[152:155], v[48:51], v[84:87], v[152:155]
    ds_read_b128 v[128:131], v7 offset:1344
    v_mfma_f32_16x16x32_bf16 v[156:159], v[48:51], v[88:91], v[156:159]
    v_mfma_f32_16x16x32_bf16 v[160:163], v[48:51], v[92:95], v[160:163]
    v_mfma_f32_16x16x32_bf16 v[164:167], v[48:51], v[96:99], v[164:167]
    ds_read_b128 v[132:135], v7 offset:1600
    v_mfma_f32_16x16x32_bf16 v[168:171], v[48:51], v[100:103], v[168:171]
    ds_read2_b64 v[48:51], v6 offset0:104 offset1:105
    s_waitcnt lgkmcnt(3)
    v_mfma_f32_16x16x32_bf16 v[140:143], v[44:47], v[76:79], v[140:143]
    v_mfma_f32_16x16x32_bf16 v[144:147], v[44:47], v[80:83], v[144:147]
    v_mfma_f32_16x16x32_bf16 v[148:151], v[44:47], v[84:87], v[148:151]
    ds_read_b128 v[136:139], v7 offset:1856
    v_mfma_f32_16x16x32_bf16 v[152:155], v[44:47], v[88:91], v[152:155]
    v_mfma_f32_16x16x32_bf16 v[156:159], v[44:47], v[92:95], v[156:159]
    v_mfma_f32_16x16x32_bf16 v[160:163], v[44:47], v[96:99], v[160:163]
    v_mfma_f32_16x16x32_bf16 v[164:167], v[44:47], v[100:103], v[164:167]
    v_mfma_f32_16x16x32_bf16 v[168:171], v[44:47], v[104:107], v[168:171]
    ds_read2_b64 v[44:47], v6 offset0:40 offset1:41
    v_mfma_f32_16x16x32_bf16 v[168:171], v[72:75], v[108:111], v[168:171]
    ds_read2_b64 v[72:75], v11 offset0:240 offset1:241
    s_mov_b32 s75, 0x05040100
    v_mfma_f32_16x16x32_bf16 v[164:167], v[68:71], v[108:111], v[164:167]
    s_mov_b32 s76, 0x07060302
    s_mul_i32 s74, s78, 5120
    s_lshl_b32 s79, s54, 8
    v_mfma_f32_16x16x32_bf16 v[168:171], v[68:71], v[112:115], v[168:171]
    ds_read2_b64 v[68:71], v11 offset0:176 offset1:177
    s_add_u32 s74, s74, s79
    v_mfma_f32_16x16x32_bf16 v[160:163], v[64:67], v[108:111], v[160:163]
    s_add_u32 s74, s74, 11206656
    s_cmp_ge_u32 s78, 28
    s_cselect_b32 s74, 33554432, s74
    v_mfma_f32_16x16x32_bf16 v[164:167], v[64:67], v[112:115], v[164:167]
    ds_read_b128 v[76:79], v7 offset:32
    v_mul_u32_u24 v197, 1639, v196
    v_mfma_f32_16x16x32_bf16 v[168:171], v[64:67], v[116:119], v[168:171]
    ds_read2_b64 v[64:67], v11 offset0:112 offset1:113
    v_lshrrev_b32 v197, 16, v197
    v_mfma_f32_16x16x32_bf16 v[156:159], v[60:63], v[108:111], v[156:159]
    v_mul_u32_u24 v198, 143360, v197
    v_mul_u32_u24 v197, 40, v197
    v_mfma_f32_16x16x32_bf16 v[160:163], v[60:63], v[112:115], v[160:163]
    v_sub_u32 v196, v196, v197
    v_lshrrev_b32 v197, 4, v196
    v_mfma_f32_16x16x32_bf16 v[164:167], v[60:63], v[116:119], v[164:167]
    ds_read_b128 v[80:83], v7 offset:288
    v_lshl_add_u32 v198, v197, 11, v198
    v_mfma_f32_16x16x32_bf16 v[168:171], v[60:63], v[120:123], v[168:171]
    ds_read2_b64 v[60:63], v11 offset0:48 offset1:49
    v_cmp_le_u32 vcc, 32, v196
    v_mfma_f32_16x16x32_bf16 v[152:155], v[56:59], v[108:111], v[152:155]
    v_and_b32 v196, 15, v196
    v_mov_b32 v199, 1024
    v_mfma_f32_16x16x32_bf16 v[156:159], v[56:59], v[112:115], v[156:159]
    v_cndmask_b32 v197, 0, v196, vcc
    v_cndmask_b32 v199, v199, 16, vcc
    v_mfma_f32_16x16x32_bf16 v[160:163], v[56:59], v[116:119], v[160:163]
    ds_read_b128 v[84:87], v7 offset:544
    v_add_u32 v196, v196, v197
    v_mfma_f32_16x16x32_bf16 v[164:167], v[56:59], v[120:123], v[164:167]
    v_lshl_add_u32 v198, v196, 4, v198
    v_add_u32 v199, v198, v199
    v_mfma_f32_16x16x32_bf16 v[168:171], v[56:59], v[124:127], v[168:171]
    ds_read2_b64 v[56:59], v6 offset0:240 offset1:241
    v_perm_b32 v208, v201, v200, s75
    v_mfma_f32_16x16x32_bf16 v[148:151], v[52:55], v[108:111], v[148:151]
    v_perm_b32 v209, v203, v202, s75
    v_perm_b32 v210, v205, v204, s75
    v_mfma_f32_16x16x32_bf16 v[152:155], v[52:55], v[112:115], v[152:155]
    ds_read_b128 v[88:91], v7 offset:800
    v_perm_b32 v211, v207, v206, s75
    v_mfma_f32_16x16x32_bf16 v[156:159], v[52:55], v[116:119], v[156:159]
    v_perm_b32 v212, v201, v200, s76
    v_perm_b32 v213, v203, v202, s76
    v_mfma_f32_16x16x32_bf16 v[160:163], v[52:55], v[120:123], v[160:163]
    v_perm_b32 v214, v205, v204, s76
    v_perm_b32 v215, v207, v206, s76
    v_mfma_f32_16x16x32_bf16 v[164:167], v[52:55], v[124:127], v[164:167]
    ds_read_b128 v[92:95], v7 offset:1056
    s_waitcnt lgkmcnt(2)
    v_mfma_f32_16x16x32_bf16 v[168:171], v[52:55], v[128:131], v[168:171]
    ds_read2_b64 v[52:55], v6 offset0:176 offset1:177
    v_mfma_f32_16x16x32_bf16 v[144:147], v[48:51], v[108:111], v[144:147]
    buffer_store_dwordx4 v[208:211], v198, s[4:7], s74 offen sc1
    v_mfma_f32_16x16x32_bf16 v[148:151], v[48:51], v[112:115], v[148:151]
    buffer_store_dwordx4 v[212:215], v199, s[4:7], s74 offen sc1
    v_mfma_f32_16x16x32_bf16 v[152:155], v[48:51], v[116:119], v[152:155]
    ds_read_b128 v[96:99], v7 offset:1312
    v_mfma_f32_16x16x32_bf16 v[156:159], v[48:51], v[120:123], v[156:159]
    v_mfma_f32_16x16x32_bf16 v[160:163], v[48:51], v[124:127], v[160:163]
    v_mfma_f32_16x16x32_bf16 v[164:167], v[48:51], v[128:131], v[164:167]
    ds_read_b128 v[100:103], v7 offset:1568
    v_mfma_f32_16x16x32_bf16 v[168:171], v[48:51], v[132:135], v[168:171]
    ds_read2_b64 v[48:51], v6 offset0:112 offset1:113
    v_mfma_f32_16x16x32_bf16 v[140:143], v[44:47], v[108:111], v[140:143]
    v_mfma_f32_16x16x32_bf16 v[144:147], v[44:47], v[112:115], v[144:147]
    v_mfma_f32_16x16x32_bf16 v[148:151], v[44:47], v[116:119], v[148:151]
    ds_read_b128 v[104:107], v7 offset:1824
    v_mfma_f32_16x16x32_bf16 v[152:155], v[44:47], v[120:123], v[152:155]
    v_mfma_f32_16x16x32_bf16 v[156:159], v[44:47], v[124:127], v[156:159]
    v_mfma_f32_16x16x32_bf16 v[160:163], v[44:47], v[128:131], v[160:163]
    v_mfma_f32_16x16x32_bf16 v[164:167], v[44:47], v[132:135], v[164:167]
    v_mfma_f32_16x16x32_bf16 v[168:171], v[44:47], v[136:139], v[168:171]
    ds_read2_b64 v[44:47], v6 offset0:48 offset1:49
    v_mfma_f32_16x16x32_bf16 v[168:171], v[72:75], v[76:79], v[168:171]
    ds_read2_b64 v[72:75], v11 offset0:248 offset1:249
    v_mfma_f32_16x16x32_bf16 v[164:167], v[68:71], v[76:79], v[164:167]
    v_mfma_f32_16x16x32_bf16 v[168:171], v[68:71], v[80:83], v[168:171]
    ds_read2_b64 v[68:71], v11 offset0:184 offset1:185
    v_mfma_f32_16x16x32_bf16 v[160:163], v[64:67], v[76:79], v[160:163]
    v_mfma_f32_16x16x32_bf16 v[164:167], v[64:67], v[80:83], v[164:167]
    ds_read_b128 v[108:111], v7 offset:0
    v_mfma_f32_16x16x32_bf16 v[168:171], v[64:67], v[84:87], v[168:171]
    ds_read2_b64 v[64:67], v11 offset0:120 offset1:121
    v_mfma_f32_16x16x32_bf16 v[156:159], v[60:63], v[76:79], v[156:159]
    v_mfma_f32_16x16x32_bf16 v[160:163], v[60:63], v[80:83], v[160:163]
    v_mfma_f32_16x16x32_bf16 v[164:167], v[60:63], v[84:87], v[164:167]
    ds_read_b128 v[112:115], v7 offset:256
    s_waitcnt lgkmcnt(3)
    v_mfma_f32_16x16x32_bf16 v[168:171], v[60:63], v[88:91], v[168:171]
    ds_read2_b64 v[60:63], v11 offset0:56 offset1:57
    v_mfma_f32_16x16x32_bf16 v[152:155], v[56:59], v[76:79], v[152:155]
    v_mfma_f32_16x16x32_bf16 v[156:159], v[56:59], v[80:83], v[156:159]
    v_mfma_f32_16x16x32_bf16 v[160:163], v[56:59], v[84:87], v[160:163]
    ds_read_b128 v[116:119], v7 offset:512
    v_mfma_f32_16x16x32_bf16 v[164:167], v[56:59], v[88:91], v[164:167]
    v_mfma_f32_16x16x32_bf16 v[168:171], v[56:59], v[92:95], v[168:171]
    ds_read2_b64 v[56:59], v6 offset0:248 offset1:249
    v_mfma_f32_16x16x32_bf16 v[148:151], v[52:55], v[76:79], v[148:151]
    v_mfma_f32_16x16x32_bf16 v[152:155], v[52:55], v[80:83], v[152:155]
    ds_read_b128 v[120:123], v7 offset:768
    v_mfma_f32_16x16x32_bf16 v[156:159], v[52:55], v[84:87], v[156:159]
    v_mfma_f32_16x16x32_bf16 v[160:163], v[52:55], v[88:91], v[160:163]
    v_mfma_f32_16x16x32_bf16 v[164:167], v[52:55], v[92:95], v[164:167]
    ds_read_b128 v[124:127], v7 offset:1024
    v_mfma_f32_16x16x32_bf16 v[168:171], v[52:55], v[96:99], v[168:171]
    ds_read2_b64 v[52:55], v6 offset0:184 offset1:185
    v_mfma_f32_16x16x32_bf16 v[144:147], v[48:51], v[76:79], v[144:147]
    v_mfma_f32_16x16x32_bf16 v[148:151], v[48:51], v[80:83], v[148:151]
    v_mfma_f32_16x16x32_bf16 v[152:155], v[48:51], v[84:87], v[152:155]
    ds_read_b128 v[128:131], v7 offset:1280
    v_mfma_f32_16x16x32_bf16 v[156:159], v[48:51], v[88:91], v[156:159]
    v_mfma_f32_16x16x32_bf16 v[160:163], v[48:51], v[92:95], v[160:163]
    v_mfma_f32_16x16x32_bf16 v[164:167], v[48:51], v[96:99], v[164:167]
    ds_read_b128 v[132:135], v7 offset:1536
    v_mfma_f32_16x16x32_bf16 v[168:171], v[48:51], v[100:103], v[168:171]
    ds_read2_b64 v[48:51], v6 offset0:120 offset1:121
    v_mfma_f32_16x16x32_bf16 v[140:143], v[44:47], v[76:79], v[140:143]
    v_mfma_f32_16x16x32_bf16 v[144:147], v[44:47], v[80:83], v[144:147]
    v_mfma_f32_16x16x32_bf16 v[148:151], v[44:47], v[84:87], v[148:151]
    ds_read_b128 v[136:139], v7 offset:1792
    v_mfma_f32_16x16x32_bf16 v[152:155], v[44:47], v[88:91], v[152:155]
    v_mfma_f32_16x16x32_bf16 v[156:159], v[44:47], v[92:95], v[156:159]
    v_mfma_f32_16x16x32_bf16 v[160:163], v[44:47], v[96:99], v[160:163]
    v_mfma_f32_16x16x32_bf16 v[164:167], v[44:47], v[100:103], v[164:167]
    v_mfma_f32_16x16x32_bf16 v[168:171], v[44:47], v[104:107], v[168:171]
    ds_read2_b64 v[44:47], v6 offset0:56 offset1:57
    s_waitcnt lgkmcnt(2)
    v_mfma_f32_16x16x32_bf16 v[152:155], v[56:59], v[108:111], v[152:155]
    s_waitcnt vmcnt(4) lgkmcnt(1)
    v_lshlrev_b32 v76, 16, v28
    v_and_b32 v78, s3, v28
    v_mfma_f32_16x16x32_bf16 v[148:151], v[52:55], v[108:111], v[148:151]
    v_lshlrev_b32 v80, 16, v29
    v_and_b32 v82, s3, v29
    v_mfma_f32_16x16x32_bf16 v[152:155], v[52:55], v[112:115], v[152:155]
    v_lshlrev_b32 v77, 16, v30
    v_and_b32 v79, s3, v30
    v_mfma_f32_16x16x32_bf16 v[148:151], v[48:51], v[112:115], v[148:151]
    v_lshlrev_b32 v81, 16, v31
    v_and_b32 v83, s3, v31
    v_mfma_f32_16x16x32_bf16 v[152:155], v[48:51], v[116:119], v[152:155]
    v_fma_f32 v196, v76, v172, v174
    v_fma_f32 v197, v77, v173, v175
    s_waitcnt lgkmcnt(0)
    v_mfma_f32_16x16x32_bf16 v[148:151], v[44:47], v[116:119], v[148:151]
    v_fma_f32 v198, v78, v172, v174
    v_fma_f32 v199, v79, v173, v175
    v_mfma_f32_16x16x32_bf16 v[152:155], v[44:47], v[120:123], v[152:155]
    v_fma_f32 v200, v80, v172, v174
    v_fma_f32 v201, v81, v173, v175
    v_mfma_f32_16x16x32_bf16 v[144:147], v[48:51], v[108:111], v[144:147]
    v_fma_f32 v202, v82, v172, v174
    v_fma_f32 v203, v83, v173, v175
    v_mfma_f32_16x16x32_bf16 v[140:143], v[44:47], v[108:111], v[140:143]
    v_lshlrev_b32 v84, 16, v32
    v_and_b32 v86, s3, v32
    v_mfma_f32_16x16x32_bf16 v[144:147], v[44:47], v[112:115], v[144:147]
    ds_write_b128 v8, v[148:151] offset:2048
    v_mfma_f32_16x16x32_bf16 v[160:163], v[64:67], v[108:111], v[160:163]
    v_lshlrev_b32 v88, 16, v33
    v_and_b32 v90, s3, v33
    v_mfma_f32_16x16x32_bf16 v[156:159], v[60:63], v[108:111], v[156:159]
    ds_write_b128 v8, v[152:155] offset:3072
    v_mfma_f32_16x16x32_bf16 v[160:163], v[60:63], v[112:115], v[160:163]
    v_lshlrev_b32 v85, 16, v34
    v_and_b32 v87, s3, v34
    v_mfma_f32_16x16x32_bf16 v[156:159], v[56:59], v[112:115], v[156:159]
    ds_write_b128 v8, v[140:143] offset:0
    v_mfma_f32_16x16x32_bf16 v[160:163], v[56:59], v[116:119], v[160:163]
    v_lshlrev_b32 v89, 16, v35
    v_and_b32 v91, s3, v35
    v_mfma_f32_16x16x32_bf16 v[156:159], v[52:55], v[116:119], v[156:159]
    ds_write_b128 v8, v[144:147] offset:1024
    v_mfma_f32_16x16x32_bf16 v[160:163], v[52:55], v[120:123], v[160:163]
    v_fma_f32 v204, v84, v176, v178
    v_fma_f32 v205, v85, v177, v179
    v_mfma_f32_16x16x32_bf16 v[156:159], v[48:51], v[120:123], v[156:159]
    v_fma_f32 v206, v86, v176, v178
    v_fma_f32 v207, v87, v177, v179
    v_mfma_f32_16x16x32_bf16 v[160:163], v[48:51], v[124:127], v[160:163]
    v_fma_f32 v208, v88, v176, v178
    v_fma_f32 v209, v89, v177, v179
    v_mfma_f32_16x16x32_bf16 v[156:159], v[44:47], v[124:127], v[156:159]
    v_fma_f32 v210, v90, v176, v178
    v_fma_f32 v211, v91, v177, v179
    v_mfma_f32_16x16x32_bf16 v[160:163], v[44:47], v[128:131], v[160:163]
    v_lshlrev_b32 v92, 16, v36
    v_and_b32 v94, s3, v36
    v_mfma_f32_16x16x32_bf16 v[168:171], v[72:75], v[108:111], v[168:171]
    v_lshlrev_b32 v96, 16, v37
    v_and_b32 v98, s3, v37
    v_mfma_f32_16x16x32_bf16 v[164:167], v[68:71], v[108:111], v[164:167]
    v_lshlrev_b32 v93, 16, v38
    v_and_b32 v95, s3, v38
    v_mfma_f32_16x16x32_bf16 v[168:171], v[68:71], v[112:115], v[168:171]
    ds_write_b128 v8, v[156:159] offset:4096
    v_mfma_f32_16x16x32_bf16 v[164:167], v[64:67], v[112:115], v[164:167]
    v_lshlrev_b32 v97, 16, v39
    v_and_b32 v99, s3, v39
    v_mfma_f32_16x16x32_bf16 v[168:171], v[64:67], v[116:119], v[168:171]
    ds_write_b128 v8, v[160:163] offset:5120
    v_mfma_f32_16x16x32_bf16 v[164:167], v[60:63], v[116:119], v[164:167]
    v_fma_f32 v212, v92, v180, v182
    v_fma_f32 v213, v93, v181, v183
    v_mfma_f32_16x16x32_bf16 v[168:171], v[60:63], v[120:123], v[168:171]
    v_fma_f32 v214, v94, v180, v182
    v_fma_f32 v215, v95, v181, v183
    v_mfma_f32_16x16x32_bf16 v[164:167], v[56:59], v[120:123], v[164:167]
    v_fma_f32 v216, v96, v180, v182
    v_fma_f32 v217, v97, v181, v183
    v_mfma_f32_16x16x32_bf16 v[168:171], v[56:59], v[124:127], v[168:171]
    v_fma_f32 v218, v98, v180, v182
    v_fma_f32 v219, v99, v181, v183
    v_mfma_f32_16x16x32_bf16 v[164:167], v[52:55], v[124:127], v[164:167]
    v_lshlrev_b32 v100, 16, v40
    v_and_b32 v102, s3, v40
    v_mfma_f32_16x16x32_bf16 v[168:171], v[52:55], v[128:131], v[168:171]
    v_lshlrev_b32 v104, 16, v41
    v_and_b32 v106, s3, v41
    v_mfma_f32_16x16x32_bf16 v[164:167], v[48:51], v[128:131], v[164:167]
    v_lshlrev_b32 v101, 16, v42
    v_and_b32 v103, s3, v42
    v_mfma_f32_16x16x32_bf16 v[168:171], v[48:51], v[132:135], v[168:171]
    v_lshlrev_b32 v105, 16, v43
    v_and_b32 v107, s3, v43
    v_mfma_f32_16x16x32_bf16 v[164:167], v[44:47], v[132:135], v[164:167]
    s_waitcnt vmcnt(2)
    v_fma_f32 v220, v100, v184, v186
    v_fma_f32 v221, v101, v185, v187
    v_mfma_f32_16x16x32_bf16 v[168:171], v[44:47], v[136:139], v[168:171]
    v_fma_f32 v222, v102, v184, v186
    v_fma_f32 v223, v103, v185, v187
    v_fma_f32 v224, v104, v184, v186
    v_fma_f32 v225, v105, v185, v187
    v_fma_f32 v226, v106, v184, v186
    v_fma_f32 v227, v107, v185, v187
    buffer_load_dword v244, v243, s[4:7], s86 offen sc1
    ds_write_b128 v8, v[164:167] offset:6144
    ds_write_b128 v8, v[168:171] offset:7168
    v_cmp_ne_u32 vcc, s48, v15
    s_nop 0
    s_cbranch_vccnz L_adaL_slow_13
L_adaL_got_15:
    v_readlane_b32 s20, v14, 0
    v_readlane_b32 s21, v14, 1
    v_readlane_b32 s22, v14, 2
    v_readlane_b32 s23, v14, 3
    v_readlane_b32 s24, v14, 4
    v_readlane_b32 s25, v14, 5
    v_readlane_b32 s26, v14, 6
    v_readlane_b32 s27, v14, 7
    v_readlane_b32 s28, v14, 8
    v_readlane_b32 s29, v14, 9
    v_readlane_b32 s30, v14, 10
    v_readlane_b32 s31, v14, 11
    v_mov_b32 v192, s28
    v_mov_b32 v193, s29
    v_mov_b32 v194, s30
    v_mov_b32 v195, s31
    v_mul_f32 v188, s20, v192
    v_mul_f32 v192, s24, v192
    v_mul_f32 v189, s21, v193
    v_mul_f32 v193, s25, v193
    v_mul_f32 v190, s22, v194
    v_mul_f32 v194, s26, v194
    v_mul_f32 v191, s23, v195
    v_mul_f32_e64 v195, s27, v195
    v_pk_fma_f32 v[196:197], v[192:193], v[196:197], v[188:189] op_sel:[0,0,0] op_sel_hi:[0,1,0]
    v_pk_fma_f32 v[198:199], v[192:193], v[198:199], v[188:189] op_sel:[1,0,1] op_sel_hi:[1,1,1]
    v_pk_fma_f32 v[200:201], v[194:195], v[200:201], v[190:191] op_sel:[0,0,0] op_sel_hi:[0,1,0]
    v_pk_fma_f32 v[202:203], v[194:195], v[202:203], v[190:191] op_sel:[1,0,1] op_sel_hi:[1,1,1]
    v_pk_fma_f32 v[204:205], v[192:193], v[204:205], v[188:189] op_sel:[0,0,0] op_sel_hi:[0,1,0]
    v_pk_fma_f32 v[206:207], v[192:193], v[206:207], v[188:189] op_sel:[1,0,1] op_sel_hi:[1,1,1]
    v_pk_fma_f32 v[208:209], v[194:195], v[208:209], v[190:191] op_sel:[0,0,0] op_sel_hi:[0,1,0]
    v_pk_fma_f32 v[210:211], v[194:195], v[210:211], v[190:191] op_sel:[1,0,1] op_sel_hi:[1,1,1]
    v_pk_fma_f32 v[212:213], v[192:193], v[212:213], v[188:189] op_sel:[0,0,0] op_sel_hi:[0,1,0]
    v_pk_fma_f32 v[214:215], v[192:193], v[214:215], v[188:189] op_sel:[1,0,1] op_sel_hi:[1,1,1]
    v_pk_fma_f32 v[216:217], v[194:195], v[216:217], v[190:191] op_sel:[0,0,0] op_sel_hi:[0,1,0]
    v_pk_fma_f32 v[218:219], v[194:195], v[218:219], v[190:191] op_sel:[1,0,1] op_sel_hi:[1,1,1]
    v_pk_fma_f32 v[220:221], v[192:193], v[220:221], v[188:189] op_sel:[0,0,0] op_sel_hi:[0,1,0]
    v_pk_fma_f32 v[222:223], v[192:193], v[222:223], v[188:189] op_sel:[1,0,1] op_sel_hi:[1,1,1]
    v_pk_fma_f32 v[224:225], v[194:195], v[224:225], v[190:191] op_sel:[0,0,0] op_sel_hi:[0,1,0]
    v_pk_fma_f32 v[226:227], v[194:195], v[226:227], v[190:191] op_sel:[1,0,1] op_sel_hi:[1,1,1]
    s_waitcnt vmcnt(1)
    s_waitcnt lgkmcnt(0)
    s_barrier
    ds_read_b64 v[44:45], v228 offset:0
    ds_read_b64 v[46:47], v228 offset:16512
    ds_read_b64 v[48:49], v229 offset:0
    ds_read_b64 v[50:51], v229 offset:16512
    ds_read_b64 v[52:53], v228 offset:2048
    ds_read_b64 v[54:55], v228 offset:18560
    ds_read_b64 v[56:57], v229 offset:2048
    ds_read_b64 v[58:59], v229 offset:18560
    ds_read_b64 v[60:61], v228 offset:4096
    ds_read_b64 v[62:63], v228 offset:20608
    ds_read_b64 v[64:65], v229 offset:4096
    ds_read_b64 v[66:67], v229 offset:20608
    ds_read_b64 v[68:69], v228 offset:6144
    ds_read_b64 v[70:71], v228 offset:22656
    ds_read_b64 v[72:73], v229 offset:6144
    ds_read_b64 v[74:75], v229 offset:22656
    s_waitcnt lgkmcnt(15)
    v_pk_fma_f32 v[196:197], v[196:197], v[44:45], v[76:77]
    s_waitcnt lgkmcnt(14)
    v_pk_fma_f32 v[198:199], v[198:199], v[46:47], v[78:79]
    s_waitcnt lgkmcnt(13)
    v_pk_fma_f32 v[200:201], v[200:201], v[48:49], v[80:81]
    s_waitcnt lgkmcnt(12)
    v_pk_fma_f32 v[202:203], v[202:203], v[50:51], v[82:83]
    v_cvt_pk_bf16_f32 v28, v196, v198
    v_cvt_pk_bf16_f32 v29, v200, v202
    v_cvt_pk_bf16_f32 v30, v197, v199
    v_cvt_pk_bf16_f32 v31, v201, v203
    buffer_store_dwordx4 v[28:31], v9, s[4:7], s64 offen sc1
    s_waitcnt lgkmcnt(11)
    v_pk_fma_f32 v[204:205], v[204:205], v[52:53], v[84:85]
    s_waitcnt lgkmcnt(10)
    v_pk_fma_f32 v[206:207], v[206:207], v[54:55], v[86:87]
    s_waitcnt lgkmcnt(9)
    v_pk_fma_f32 v[208:209], v[208:209], v[56:57], v[88:89]
    s_waitcnt lgkmcnt(8)
    v_pk_fma_f32 v[210:211], v[210:211], v[58:59], v[90:91]
    v_cvt_pk_bf16_f32 v32, v204, v206
    v_cvt_pk_bf16_f32 v33, v208, v210
    v_cvt_pk_bf16_f32 v34, v205, v207
    v_cvt_pk_bf16_f32 v35, v209, v211
    buffer_store_dwordx4 v[32:35], v9, s[4:7], s65 offen sc1
    s_waitcnt lgkmcnt(7)
    v_pk_fma_f32 v[212:213], v[212:213], v[60:61], v[92:93]
    s_waitcnt lgkmcnt(6)
    v_pk_fma_f32 v[214:215], v[214:215], v[62:63], v[94:95]
    s_waitcnt lgkmcnt(5)
    v_pk_fma_f32 v[216:217], v[216:217], v[64:65], v[96:97]
    s_waitcnt lgkmcnt(4)
    v_pk_fma_f32 v[218:219], v[218:219], v[66:67], v[98:99]
    v_cvt_pk_bf16_f32 v36, v212, v214
    v_cvt_pk_bf16_f32 v37, v216, v218
    v_cvt_pk_bf16_f32 v38, v213, v215
    v_cvt_pk_bf16_f32 v39, v217, v219
    buffer_store_dwordx4 v[36:39], v9, s[4:7], s66 offen sc1
    s_waitcnt lgkmcnt(0)
    v_pk_fma_f32 v[220:221], v[220:221], v[68:69], v[100:101]
    v_pk_fma_f32 v[222:223], v[222:223], v[70:71], v[102:103]
    v_pk_fma_f32 v[224:225], v[224:225], v[72:73], v[104:105]
    v_pk_fma_f32 v[226:227], v[226:227], v[74:75], v[106:107]
    v_cvt_pk_bf16_f32 v40, v220, v222
    v_cvt_pk_bf16_f32 v41, v224, v226
    v_cvt_pk_bf16_f32 v42, v221, v223
    v_cvt_pk_bf16_f32 v43, v225, v227
    buffer_store_dwordx4 v[40:43], v9, s[4:7], s67 offen sc1
L_adaL_join_3:
    s_load_dwordx2 s[12:13], s[0:1], 72
    s_mov_b32 s14, 4096
    s_mov_b32 s15, 0x20000
    s_load_dwordx2 s[16:17], s[0:1], 104
    s_mov_b32 s18, 2621440
    s_mov_b32 s19, 0x20000
    v_mov_b32 v13, s48
    s_lshl_b32 s62, s82, 8
    s_add_u32 s62, s62, s2
    s_lshl_b32 s55, s62, 5
    s_add_u32 s55, s55, 131072
    s_cmp_ge_u32 s62, 160
    s_cselect_b32 s55, 33554432, s55
    v_mul_u32_u24 v14, 5376, v240
    s_and_b32 s60, s2, 7
    s_mul_i32 s60, s60, 5376
    s_mul_i32 s62, s82, 1280
    s_add_u32 s60, s60, s62
    s_add_u32 s60, s60, 131072
    v_min_u32 v26, 39, v240
    v_lshlrev_b32 v26, 5, v26
    v_and_b32 v1, 15, v0
    s_waitcnt vmcnt(1)
    v_lshrrev_b32 v2, 4, v240
    s_mul_i32 s54, s82, 16512
    s_add_u32 s54, s54, 8192
    v_add_u32 v8, s54, v241
    v_lshrrev_b32 v3, 1, v1
    v_xor_b32 v3, v3, v2
    v_lshlrev_b32 v10, 7, v1
    v_lshl_add_u32 v10, v3, 4, v10
    v_add_u32 v10, s54, v10
    v_xor_b32 v11, 64, v10
    s_waitcnt vmcnt(0)
    s_barrier
    s_mov_b64 exec, 255
    buffer_store_dword v13, v14, s[4:7], s55 offen sc1
    s_mov_b64 exec, -1
    v_cmp_ne_u32 vcc, s48, v244
    s_nop 0
    s_cbranch_vccnz L_adaL_slow_16
L_adaL_got_18:
    s_cmp_eq_u32 s82, 3
    s_cbranch_scc1 L_adaL_w3_32
    buffer_load_dwordx4 a[96:99], v241, s[4:7], s85 offen offset:0 sc1
    v_bfe_u32 v3, v0, 3, 2
    v_bfe_u32 v4, v0, 5, 1
    v_lshl_add_u32 v3, v3, 1, v4
    v_lshlrev_b32 v15, 14, v3
    buffer_load_dwordx4 a[100:103], v242, s[4:7], s85 offen offset:0 sc1
    v_and_b32 v3, 7, v0
    v_lshl_add_u32 v15, v3, 4, v15
    s_lshl_b32 s52, s83, 9
    s_lshl_b32 s62, s82, 7
    buffer_load_dwordx4 a[104:107], v241, s[4:7], s85 offen offset:1024 sc1
    s_add_u32 s52, s52, s62
    s_add_u32 s52, s52, 6291456
    s_mul_i32 s53, s82, 20480
    v_lshlrev_b32 v5, 3, v240
    buffer_load_dwordx4 a[108:111], v242, s[4:7], s85 offen offset:1024 sc1
    v_add_u32 v6, 40960, v5
    v_add_u32 v14, s53, v5
    v_lshlrev_b32 v7, 4, v2
    s_mov_b32 s66, 0xbdd2d3e8
    buffer_load_dwordx4 a[112:115], v241, s[4:7], s85 offen offset:2048 sc1
    s_mov_b32 s67, 0xc0135761
    s_mov_b32 s68, 1.0
    s_mov_b32 s69, 1.0
    v_mov_b32 v132, 0x3f803f80
    buffer_load_dwordx4 a[116:119], v242, s[4:7], s85 offen offset:2048 sc1
    v_mov_b32 v133, 0x3f803f80
    v_mov_b32 v134, 0x3f803f80
    v_mov_b32 v135, 0x3f803f80
    v_lshlrev_b32 v12, 2, v1
    buffer_load_dwordx4 a[120:123], v241, s[4:7], s85 offen offset:3072 sc1
    s_lshl_b32 s59, s84, 12
    s_add_u32 s59, s59, 24379392
    v_lshlrev_b32 v4, 3, v0
    v_lshlrev_b32_e64 v180, 4, v0
    buffer_load_dwordx4 a[124:127], v242, s[4:7], s85 offen offset:3072 sc1
    s_add_u32 s85, s85, 4096
    buffer_load_dwordx4 a[128:131], v241, s[4:7], s85 offen offset:0 sc1
    buffer_load_dwordx4 a[132:135], v242, s[4:7], s85 offen offset:0 sc1
    buffer_load_dwordx4 a[136:139], v241, s[4:7], s85 offen offset:1024 sc1
    buffer_load_dwordx4 a[140:143], v242, s[4:7], s85 offen offset:1024 sc1
    buffer_load_dwordx4 a[144:147], v241, s[4:7], s85 offen offset:2048 sc1
    buffer_load_dwordx4 a[148:151], v242, s[4:7], s85 offen offset:2048 sc1
    buffer_load_dwordx4 a[152:155], v241, s[4:7], s85 offen offset:3072 sc1
    buffer_load_dwordx4 a[156:159], v242, s[4:7], s85 offen offset:3072 sc1
    s_add_u32 s85, s85, 4096
    buffer_load_dwordx4 a[160:163], v241, s[4:7], s85 offen offset:0 sc1
    buffer_load_dwordx4 a[164:167], v242, s[4:7], s85 offen offset:0 sc1
    buffer_load_dwordx4 a[168:171], v241, s[4:7], s85 offen offset:1024 sc1
    buffer_load_dwordx4 a[172:175], v242, s[4:7], s85 offen offset:1024 sc1
    buffer_load_dwordx4 a[176:179], v241, s[4:7], s85 offen offset:2048 sc1
    buffer_load_dwordx4 a[180:183], v242, s[4:7], s85 offen offset:2048 sc1
    buffer_load_dwordx4 a[184:187], v241, s[4:7], s85 offen offset:3072 sc1
    buffer_load_dwordx4 a[188:191], v242, s[4:7], s85 offen offset:3072 sc1
    s_add_u32 s85, s85, 4096
    s_add_u32 s63, s59, 0
    buffer_load_dwordx4 v[100:103], v180, s[4:7], s63 offen sc1
    s_add_u32 s63, s59, 32768
    buffer_load_dwordx4 v[104:107], v180, s[4:7], s63 offen sc1
    s_add_u32 s63, s59, 65536
    buffer_load_dwordx4 v[108:111], v180, s[4:7], s63 offen sc1
    s_add_u32 s63, s59, 98304
    buffer_load_dwordx4 v[112:115], v180, s[4:7], s63 offen sc1
    s_add_u32 s63, s59, 131072
    buffer_load_dwordx4 v[116:119], v180, s[4:7], s63 offen sc1
    s_mul_i32 s62, s84, 640
    s_add_u32 s62, s62, 58368
    v_min_u32 v3, 79, v0
    v_lshl_add_u32 v166, v3, 3, s62
    buffer_load_dwordx2 v[164:165], v166, s[4:7], 0 offen sc1
    buffer_load_dword v27, v26, s[4:7], s60 offen sc1
    v_lshlrev_b32 v3, 2, v3
    v_add_u32 v3, 88576, v3
    v_add_u32 v4, 86528, v4
    s_mul_i32 s63, s82, 14336
    s_add_u32 s63, s63, 102912
    s_sub_u32 s64, s63, s54
    s_mov_b32 s54, s63
    v_add_u32 v10, s64, v10
    v_add_u32_e64 v11, s64, v11
    s_waitcnt vmcnt(1)
    v_min3_u32 v181, v165, v13, v13
    v_min3_u32 v181, v181, v101, v103
    v_min3_u32 v181, v181, v105, v107
    v_min3_u32 v181, v181, v109, v111
    v_min3_u32 v181, v181, v113, v115
    v_min3_u32 v181, v181, v117, v119
    v_max3_u32 v182, v165, v13, v13
    v_max3_u32 v182, v182, v101, v103
    v_max3_u32 v182, v182, v105, v107
    v_max3_u32 v182, v182, v109, v111
    v_max3_u32 v182, v182, v113, v115
    v_max3_u32 v182, v182, v117, v119
    v_cmp_ne_u32 vcc, v181, v182
    s_nop 0
    s_cbranch_vccnz L_adaL_slow_19
L_adaL_got_21:
    v_add_f32 v100, v100, v104
    v_add_f32 v102, v102, v106
    v_add_f32 v100, v100, v108
    v_add_f32 v102, v102, v110
    v_add_f32 v100, v100, v112
    v_add_f32 v102, v102, v114
    v_add_f32 v100, v100, v116
    v_add_f32 v102, v102, v118
    s_mov_b32 s49, 65536
    s_waitcnt vmcnt(0)
    v_cmp_ne_u32 vcc, s48, v27
    s_nop 0
    s_cbranch_vccz L_adaL_got_24
L_adaL_poll_23:
    buffer_load_dword v27, v26, s[4:7], s60 offen sc1
    s_waitcnt vmcnt(0)
    s_sub_u32 s49, s49, 1
    s_cbranch_scc1 L_adaL_got_24
    v_cmp_ne_u32 vcc, s48, v27
    s_nop 0
    s_cbranch_vccnz L_adaL_poll_23
L_adaL_got_24:
    s_barrier
    s_mov_b32 m0, s53
    s_nop 0
    buffer_load_dwordx4 v15, s[4:7], s52 offen sc1 lds
    s_add_u32 m0, m0, 1024
    s_add_u32 s52, s52, 131072
    buffer_load_dwordx4 v15, s[4:7], s52 offen sc1 lds
    s_add_u32 m0, m0, 1024
    s_add_u32 s52, s52, 131072
    buffer_load_dwordx4 v15, s[4:7], s52 offen sc1 lds
    s_add_u32 m0, m0, 1024
    s_add_u32 s52, s52, 131072
    buffer_load_dwordx4 v15, s[4:7], s52 offen sc1 lds
    s_add_u32 m0, m0, 1024
    s_add_u32 s52, s52, 131072
    buffer_load_dwordx4 v15, s[4:7], s52 offen sc1 lds
    s_add_u32 m0, m0, 1024
    s_add_u32 s52, s52, 131072
    buffer_load_dwordx4 v15, s[4:7], s52 offen sc1 lds
    s_add_u32 m0, m0, 1024
    s_add_u32 s52, s52, 131072
    buffer_load_dwordx4 v15, s[4:7], s52 offen sc1 lds
    s_add_u32 m0, m0, 1024
    s_add_u32 s52, s52, 131072
    buffer_load_dwordx4 v15, s[4:7], s52 offen sc1 lds
    s_add_u32 m0, m0, 1024
    s_add_u32 s52, s52, 131072
    buffer_load_dwordx4 v15, s[4:7], s52 offen sc1 lds
    s_add_u32 m0, m0, 1024
    s_add_u32 s52, s52, 131072
    buffer_load_dwordx4 v15, s[4:7], s52 offen sc1 lds
    s_add_u32 m0, m0, 1024
    s_add_u32 s52, s52, 131072
    ds_write2_b32 v4, v100, v102 offset0:0 offset1:1
    ds_write_b32 v3, v164
    s_lshl_b32 s60, s83, 3
    s_add_u32 s60, s60, s84
    s_lshl_b32 s60, s60, 15
    v_lshlrev_b32 v26, 5, v0
    s_waitcnt vmcnt(9)
    ds_read_b64 v[92:93], v14 offset:0
    ds_read_b64 v[94:95], v14 offset:512
    buffer_load_dwordx4 v15, s[4:7], s52 offen sc1 lds
    s_add_u32 m0, m0, 1024
    s_add_u32 s52, s52, 131072
    s_waitcnt lgkmcnt(0)
    v_mfma_f32_16x16x32_bf16 v[136:139], v[92:95], v[92:95], 0
    s_waitcnt vmcnt(9)
    ds_read_b64 v[96:97], v14 offset:1024
    v_mfma_f32_16x16x32_bf16 v[140:143], v[132:135], v[92:95], 0
    ds_read_b64 v[98:99], v14 offset:1536
    buffer_load_dwordx4 v15, s[4:7], s52 offen sc1 lds
    s_add_u32 m0, m0, 1024
    s_add_u32 s52, s52, 131072
    s_waitcnt lgkmcnt(0)
    v_mfma_f32_16x16x32_bf16 v[136:139], v[96:99], v[96:99], v[136:139]
    s_waitcnt vmcnt(9)
    ds_read_b64 v[92:93], v14 offset:2048
    v_mfma_f32_16x16x32_bf16 v[140:143], v[132:135], v[96:99], v[140:143]
    ds_read_b64 v[94:95], v14 offset:2560
    buffer_load_dwordx4 v15, s[4:7], s52 offen sc1 lds
    s_add_u32 m0, m0, 1024
    s_add_u32 s52, s52, 131072
    s_waitcnt lgkmcnt(0)
    v_mfma_f32_16x16x32_bf16 v[136:139], v[92:95], v[92:95], v[136:139]
    s_waitcnt vmcnt(9)
    ds_read_b64 v[96:97], v14 offset:3072
    v_mfma_f32_16x16x32_bf16 v[140:143], v[132:135], v[92:95], v[140:143]
    ds_read_b64 v[98:99], v14 offset:3584
    s_waitcnt lgkmcnt(0)
    s_barrier
    ds_read_b64 v[44:45], v5 offset:0
    ds_read_b64 v[46:47], v5 offset:512
    ds_read_b64 v[48:49], v5 offset:20480
    ds_read_b64 v[50:51], v5 offset:20992
    ds_read_b64 v[52:53], v6 offset:0
    ds_read_b64 v[54:55], v6 offset:512
    ds_read_b64 v[56:57], v6 offset:20480
    ds_read_b64 v[58:59], v6 offset:20992
    ds_read_b64 v[60:61], v5 offset:1024
    ds_read_b64 v[62:63], v5 offset:1536
    ds_read_b64 v[64:65], v5 offset:21504
    ds_read_b64 v[66:67], v5 offset:22016
    ds_read_b64 v[68:69], v6 offset:1024
    ds_read_b64 v[70:71], v6 offset:1536
    ds_read_b64 v[72:73], v6 offset:21504
    ds_read_b64 v[74:75], v6 offset:22016
    v_mfma_f32_16x16x32_bf16 v[136:139], v[96:99], v[96:99], v[136:139]
    s_waitcnt vmcnt(8)
    ds_read_b64 v[92:93], v14 offset:4096
    v_mfma_f32_16x16x32_bf16 v[140:143], v[132:135], v[96:99], v[140:143]
    ds_read_b64 v[94:95], v14 offset:4608
    s_waitcnt lgkmcnt(10)
    v_mfma_f32_16x16x32_bf16 v[100:103], v[44:47], a[96:99], 0
    ds_read2st64_b64 v[76:79], v5 offset0:4 offset1:5
    v_mfma_f32_16x16x32_bf16 v[104:107], v[48:51], a[96:99], 0
    ds_read_b64 v[80:81], v5 offset:22528
    v_mfma_f32_16x16x32_bf16 v[108:111], v[52:55], a[96:99], 0
    ds_read_b64 v[82:83], v5 offset:23040
    v_mfma_f32_16x16x32_bf16 v[112:115], v[56:59], a[96:99], 0
    buffer_load_dwordx4 v15, s[4:7], s52 offen sc1 lds
    s_add_u32 m0, m0, 1024
    s_add_u32 s52, s52, 131072
    v_mfma_f32_16x16x32_bf16 v[116:119], v[44:47], a[100:103], 0
    ds_read2st64_b64 v[84:87], v5 offset0:84 offset1:85
    v_mfma_f32_16x16x32_bf16 v[120:123], v[48:51], a[100:103], 0
    ds_read_b64 v[88:89], v6 offset:22528
    v_mfma_f32_16x16x32_bf16 v[124:127], v[52:55], a[100:103], 0
    ds_read_b64 v[90:91], v6 offset:23040
    v_mfma_f32_16x16x32_bf16 v[128:131], v[56:59], a[100:103], 0
    buffer_load_dwordx4 v15, s[4:7], s52 offen sc1 lds
    s_add_u32 m0, m0, 1024
    s_add_u32 s52, s52, 131072
    s_waitcnt lgkmcnt(4)
    v_mfma_f32_16x16x32_bf16 v[136:139], v[92:95], v[92:95], v[136:139]
    s_waitcnt vmcnt(9) lgkmcnt(3)
    ds_read_b64 v[96:97], v14 offset:5120
    v_mfma_f32_16x16x32_bf16 v[140:143], v[132:135], v[92:95], v[140:143]
    ds_read_b64 v[98:99], v14 offset:5632
    v_mfma_f32_16x16x32_bf16 v[100:103], v[60:63], a[104:107], v[100:103]
    ds_read2st64_b64 v[44:47], v5 offset0:6 offset1:7
    v_mfma_f32_16x16x32_bf16 v[104:107], v[64:67], a[104:107], v[104:107]
    ds_read_b64 v[48:49], v5 offset:23552
    v_mfma_f32_16x16x32_bf16 v[108:111], v[68:71], a[104:107], v[108:111]
    ds_read_b64 v[50:51], v5 offset:24064
    v_mfma_f32_16x16x32_bf16 v[112:115], v[72:75], a[104:107], v[112:115]
    buffer_load_dwordx4 v15, s[4:7], s52 offen sc1 lds
    s_add_u32 m0, m0, 1024
    s_add_u32 s52, s52, 131072
    v_mfma_f32_16x16x32_bf16 v[116:119], v[60:63], a[108:111], v[116:119]
    ds_read2st64_b64 v[52:55], v5 offset0:86 offset1:87
    v_mfma_f32_16x16x32_bf16 v[120:123], v[64:67], a[108:111], v[120:123]
    ds_read_b64 v[56:57], v6 offset:23552
    v_mfma_f32_16x16x32_bf16 v[124:127], v[68:71], a[108:111], v[124:127]
    ds_read_b64 v[58:59], v6 offset:24064
    v_mfma_f32_16x16x32_bf16 v[128:131], v[72:75], a[108:111], v[128:131]
    buffer_load_dwordx4 v15, s[4:7], s52 offen sc1 lds
    s_add_u32 m0, m0, 1024
    s_add_u32 s52, s52, 131072
    s_waitcnt lgkmcnt(4)
    v_mfma_f32_16x16x32_bf16 v[136:139], v[96:99], v[96:99], v[136:139]
    s_waitcnt vmcnt(10) lgkmcnt(3)
    ds_read_b64 v[92:93], v14 offset:6144
    v_mfma_f32_16x16x32_bf16 v[140:143], v[132:135], v[96:99], v[140:143]
    ds_read_b64 v[94:95], v14 offset:6656
    s_waitcnt vmcnt(9)
    s_barrier
    v_mfma_f32_16x16x32_bf16 v[100:103], v[76:79], a[112:115], v[100:103]
    ds_read2st64_b64 v[60:63], v5 offset0:8 offset1:9
    v_mfma_f32_16x16x32_bf16 v[104:107], v[80:83], a[112:115], v[104:107]
    ds_read_b64 v[64:65], v5 offset:24576
    v_mfma_f32_16x16x32_bf16 v[108:111], v[84:87], a[112:115], v[108:111]
    ds_read_b64 v[66:67], v5 offset:25088
    v_mfma_f32_16x16x32_bf16 v[112:115], v[88:91], a[112:115], v[112:115]
    buffer_load_dwordx4 v15, s[4:7], s52 offen sc1 lds
    s_add_u32 m0, m0, 1024
    s_add_u32 s52, s52, 131072
    v_mfma_f32_16x16x32_bf16 v[116:119], v[76:79], a[116:119], v[116:119]
    ds_read2st64_b64 v[68:71], v5 offset0:88 offset1:89
    v_mfma_f32_16x16x32_bf16 v[120:123], v[80:83], a[116:119], v[120:123]
    ds_read_b64 v[72:73], v6 offset:24576
    v_mfma_f32_16x16x32_bf16 v[124:127], v[84:87], a[116:119], v[124:127]
    ds_read_b64 v[74:75], v6 offset:25088
    v_mfma_f32_16x16x32_bf16 v[128:131], v[88:91], a[116:119], v[128:131]
    buffer_load_dwordx4 v15, s[4:7], s52 offen sc1 lds
    s_add_u32 m0, m0, 1024
    s_add_u32 s52, s52, 131072
    s_waitcnt lgkmcnt(4)
    v_mfma_f32_16x16x32_bf16 v[136:139], v[92:95], v[92:95], v[136:139]
    ds_read_b64 v[96:97], v14 offset:7168
    v_mfma_f32_16x16x32_bf16 v[140:143], v[132:135], v[92:95], v[140:143]
    ds_read_b64 v[98:99], v14 offset:7680
    v_mfma_f32_16x16x32_bf16 v[100:103], v[44:47], a[120:123], v[100:103]
    ds_read2st64_b64 v[76:79], v5 offset0:10 offset1:11
    v_mfma_f32_16x16x32_bf16 v[104:107], v[48:51], a[120:123], v[104:107]
    ds_read_b64 v[80:81], v5 offset:25600
    v_mfma_f32_16x16x32_bf16 v[108:111], v[52:55], a[120:123], v[108:111]
    ds_read_b64 v[82:83], v5 offset:26112
    v_mfma_f32_16x16x32_bf16 v[112:115], v[56:59], a[120:123], v[112:115]
    buffer_load_dwordx4 v15, s[4:7], s52 offen sc1 lds
    v_mfma_f32_16x16x32_bf16 v[116:119], v[44:47], a[124:127], v[116:119]
    ds_read2st64_b64 v[84:87], v5 offset0:90 offset1:91
    v_mfma_f32_16x16x32_bf16 v[120:123], v[48:51], a[124:127], v[120:123]
    ds_read_b64 v[88:89], v6 offset:25600
    v_mfma_f32_16x16x32_bf16 v[124:127], v[52:55], a[124:127], v[124:127]
    ds_read_b64 v[90:91], v6 offset:26112
    v_mfma_f32_16x16x32_bf16 v[128:131], v[56:59], a[124:127], v[128:131]
    buffer_load_dwordx4 a[192:195], v241, s[4:7], s85 offen offset:0 sc1
    s_waitcnt lgkmcnt(4)
    v_mfma_f32_16x16x32_bf16 v[136:139], v[96:99], v[96:99], v[136:139]
    s_waitcnt vmcnt(12) lgkmcnt(3)
    ds_read_b64 v[92:93], v14 offset:8192
    v_mfma_f32_16x16x32_bf16 v[140:143], v[132:135], v[96:99], v[140:143]
    ds_read_b64 v[94:95], v14 offset:8704
    v_mfma_f32_16x16x32_bf16 v[100:103], v[60:63], a[128:131], v[100:103]
    ds_read2st64_b64 v[44:47], v5 offset0:12 offset1:13
    s_lshl_b32 s62, s82, 7
    v_mfma_f32_16x16x32_bf16 v[104:107], v[64:67], a[128:131], v[104:107]
    ds_read_b64 v[48:49], v5 offset:26624
    s_add_u32 s62, s62, 86528
    v_mfma_f32_16x16x32_bf16 v[108:111], v[68:71], a[128:131], v[108:111]
    ds_read_b64 v[50:51], v5 offset:27136
    v_add_u32 v3, s62, v12
    v_mfma_f32_16x16x32_bf16 v[112:115], v[72:75], a[128:131], v[112:115]
    buffer_load_dwordx4 a[196:199], v242, s[4:7], s85 offen offset:0 sc1
    v_mfma_f32_16x16x32_bf16 v[116:119], v[60:63], a[132:135], v[116:119]
    ds_read2st64_b64 v[52:55], v5 offset0:92 offset1:93
    v_add_u32 v4, s62, v7
    v_mfma_f32_16x16x32_bf16 v[120:123], v[64:67], a[132:135], v[120:123]
    ds_read_b64 v[56:57], v6 offset:26624
    ds_read_b32 v212, v3 offset:1024
    v_mfma_f32_16x16x32_bf16 v[124:127], v[68:71], a[132:135], v[124:127]
    ds_read_b64 v[58:59], v6 offset:27136
    ds_read_b32 v213, v3 offset:1536
    v_mfma_f32_16x16x32_bf16 v[128:131], v[72:75], a[132:135], v[128:131]
    buffer_load_dwordx4 a[200:203], v241, s[4:7], s85 offen offset:1024 sc1
    s_waitcnt lgkmcnt(6)
    v_mfma_f32_16x16x32_bf16 v[136:139], v[92:95], v[92:95], v[136:139]
    s_waitcnt vmcnt(13) lgkmcnt(5)
    ds_read_b64 v[96:97], v14 offset:9216
    v_mfma_f32_16x16x32_bf16 v[140:143], v[132:135], v[92:95], v[140:143]
    ds_read_b64 v[98:99], v14 offset:9728
    v_mfma_f32_16x16x32_bf16 v[100:103], v[76:79], a[136:139], v[100:103]
    ds_read2st64_b64 v[60:63], v5 offset0:14 offset1:15
    ds_read_b128 v[196:199], v4 offset:0
    v_mfma_f32_16x16x32_bf16 v[104:107], v[80:83], a[136:139], v[104:107]
    ds_read_b64 v[64:65], v5 offset:27648
    ds_read_b128 v[204:207], v4 offset:512
    v_mfma_f32_16x16x32_bf16 v[108:111], v[84:87], a[136:139], v[108:111]
    ds_read_b64 v[66:67], v5 offset:28160
    ds_read_b32 v214, v3 offset:1088
    v_mfma_f32_16x16x32_bf16 v[112:115], v[88:91], a[136:139], v[112:115]
    buffer_load_dwordx4 a[204:207], v242, s[4:7], s85 offen offset:1024 sc1
    v_mfma_f32_16x16x32_bf16 v[116:119], v[76:79], a[140:143], v[116:119]
    ds_read2st64_b64 v[68:71], v5 offset0:94 offset1:95
    ds_read_b32 v215, v3 offset:1600
    v_mfma_f32_16x16x32_bf16 v[120:123], v[80:83], a[140:143], v[120:123]
    ds_read_b64 v[72:73], v6 offset:27648
    ds_read_b128 v[200:203], v4 offset:64
    v_mfma_f32_16x16x32_bf16 v[124:127], v[84:87], a[140:143], v[124:127]
    ds_read_b64 v[74:75], v6 offset:28160
    ds_read_b128 v[208:211], v4 offset:576
    v_mfma_f32_16x16x32_bf16 v[128:131], v[88:91], a[140:143], v[128:131]
    buffer_load_dwordx4 a[208:211], v241, s[4:7], s85 offen offset:2048 sc1
    s_waitcnt lgkmcnt(8)
    v_mfma_f32_16x16x32_bf16 v[136:139], v[96:99], v[96:99], v[136:139]
    s_waitcnt vmcnt(14) lgkmcnt(6)
    ds_read_b64 v[92:93], v14 offset:10240
    v_mfma_f32_16x16x32_bf16 v[140:143], v[132:135], v[96:99], v[140:143]
    ds_read_b64 v[94:95], v14 offset:10752
    s_waitcnt vmcnt(13)
    s_barrier
    v_mfma_f32_16x16x32_bf16 v[100:103], v[44:47], a[144:147], v[100:103]
    ds_read2st64_b64 v[76:79], v5 offset0:16 offset1:17
    v_mfma_f32_16x16x32_bf16 v[104:107], v[48:51], a[144:147], v[104:107]
    ds_read_b64 v[80:81], v5 offset:28672
    v_mfma_f32_16x16x32_bf16 v[108:111], v[52:55], a[144:147], v[108:111]
    ds_read_b64 v[82:83], v5 offset:29184
    v_mfma_f32_16x16x32_bf16 v[112:115], v[56:59], a[144:147], v[112:115]
    buffer_load_dwordx4 a[212:215], v242, s[4:7], s85 offen offset:2048 sc1
    v_mfma_f32_16x16x32_bf16 v[116:119], v[44:47], a[148:151], v[116:119]
    ds_read2st64_b64 v[84:87], v5 offset0:96 offset1:97
    v_mfma_f32_16x16x32_bf16 v[120:123], v[48:51], a[148:151], v[120:123]
    ds_read_b64 v[88:89], v6 offset:28672
    v_mfma_f32_16x16x32_bf16 v[124:127], v[52:55], a[148:151], v[124:127]
    ds_read_b64 v[90:91], v6 offset:29184
    v_mfma_f32_16x16x32_bf16 v[128:131], v[56:59], a[148:151], v[128:131]
    buffer_load_dwordx4 a[216:219], v241, s[4:7], s85 offen offset:3072 sc1
    s_waitcnt lgkmcnt(4)
    v_mfma_f32_16x16x32_bf16 v[136:139], v[92:95], v[92:95], v[136:139]
    ds_read_b64 v[96:97], v14 offset:11264
    v_mfma_f32_16x16x32_bf16 v[140:143], v[132:135], v[92:95], v[140:143]
    ds_read_b64 v[98:99], v14 offset:11776
    v_mfma_f32_16x16x32_bf16 v[100:103], v[60:63], a[152:155], v[100:103]
    ds_read2st64_b64 v[44:47], v5 offset0:18 offset1:19
    v_mfma_f32_16x16x32_bf16 v[104:107], v[64:67], a[152:155], v[104:107]
    ds_read_b64 v[48:49], v5 offset:29696
    v_mfma_f32_16x16x32_bf16 v[108:111], v[68:71], a[152:155], v[108:111]
    ds_read_b64 v[50:51], v5 offset:30208
    v_mfma_f32_16x16x32_bf16 v[112:115], v[72:75], a[152:155], v[112:115]
    buffer_load_dwordx4 a[220:223], v242, s[4:7], s85 offen offset:3072 sc1
    s_add_u32 s85, s85, 4096
    v_mfma_f32_16x16x32_bf16 v[116:119], v[60:63], a[156:159], v[116:119]
    ds_read2st64_b64 v[52:55], v5 offset0:98 offset1:99
    v_mfma_f32_16x16x32_bf16 v[120:123], v[64:67], a[156:159], v[120:123]
    ds_read_b64 v[56:57], v6 offset:29696
    v_mfma_f32_16x16x32_bf16 v[124:127], v[68:71], a[156:159], v[124:127]
    ds_read_b64 v[58:59], v6 offset:30208
    v_mfma_f32_16x16x32_bf16 v[128:131], v[72:75], a[156:159], v[128:131]
    buffer_load_dwordx4 a[224:227], v241, s[4:7], s85 offen offset:0 sc1
    s_waitcnt lgkmcnt(4)
    v_mfma_f32_16x16x32_bf16 v[136:139], v[96:99], v[96:99], v[136:139]
    s_waitcnt vmcnt(16) lgkmcnt(3)
    ds_read_b64 v[92:93], v14 offset:12288
    v_mfma_f32_16x16x32_bf16 v[140:143], v[132:135], v[96:99], v[140:143]
    ds_read_b64 v[94:95], v14 offset:12800
    v_mfma_f32_16x16x32_bf16 v[100:103], v[76:79], a[160:163], v[100:103]
    ds_read2st64_b64 v[60:63], v5 offset0:20 offset1:21
    v_mfma_f32_16x16x32_bf16 v[104:107], v[80:83], a[160:163], v[104:107]
    ds_read_b64 v[64:65], v5 offset:30720
    v_mfma_f32_16x16x32_bf16 v[108:111], v[84:87], a[160:163], v[108:111]
    ds_read_b64 v[66:67], v5 offset:31232
    v_mfma_f32_16x16x32_bf16 v[112:115], v[88:91], a[160:163], v[112:115]
    buffer_load_dwordx4 a[228:231], v242, s[4:7], s85 offen offset:0 sc1
    v_mfma_f32_16x16x32_bf16 v[116:119], v[76:79], a[164:167], v[116:119]
    ds_read2st64_b64 v[68:71], v5 offset0:100 offset1:101
    v_mfma_f32_16x16x32_bf16 v[120:123], v[80:83], a[164:167], v[120:123]
    ds_read_b64 v[72:73], v6 offset:30720
    v_mfma_f32_16x16x32_bf16 v[124:127], v[84:87], a[164:167], v[124:127]
    ds_read_b64 v[74:75], v6 offset:31232
    v_mfma_f32_16x16x32_bf16 v[128:131], v[88:91], a[164:167], v[128:131]
    buffer_load_dwordx4 a[232:235], v241, s[4:7], s85 offen offset:1024 sc1
    s_waitcnt lgkmcnt(4)
    v_mfma_f32_16x16x32_bf16 v[136:139], v[92:95], v[92:95], v[136:139]
    s_waitcnt vmcnt(17) lgkmcnt(3)
    ds_read_b64 v[96:97], v14 offset:13312
    v_mfma_f32_16x16x32_bf16 v[140:143], v[132:135], v[92:95], v[140:143]
    ds_read_b64 v[98:99], v14 offset:13824
    v_mfma_f32_16x16x32_bf16 v[100:103], v[44:47], a[168:171], v[100:103]
    ds_read2st64_b64 v[76:79], v5 offset0:22 offset1:23
    v_mfma_f32_16x16x32_bf16 v[104:107], v[48:51], a[168:171], v[104:107]
    ds_read_b64 v[80:81], v5 offset:31744
    v_mfma_f32_16x16x32_bf16 v[108:111], v[52:55], a[168:171], v[108:111]
    ds_read_b64 v[82:83], v5 offset:32256
    v_mfma_f32_16x16x32_bf16 v[112:115], v[56:59], a[168:171], v[112:115]
    buffer_load_dwordx4 a[236:239], v242, s[4:7], s85 offen offset:1024 sc1
    v_mfma_f32_16x16x32_bf16 v[116:119], v[44:47], a[172:175], v[116:119]
    ds_read2st64_b64 v[84:87], v5 offset0:102 offset1:103
    v_mfma_f32_16x16x32_bf16 v[120:123], v[48:51], a[172:175], v[120:123]
    ds_read_b64 v[88:89], v6 offset:31744
    v_mfma_f32_16x16x32_bf16 v[124:127], v[52:55], a[172:175], v[124:127]
    ds_read_b64 v[90:91], v6 offset:32256
    v_mfma_f32_16x16x32_bf16 v[128:131], v[56:59], a[172:175], v[128:131]
    buffer_load_dwordx4 a[240:243], v241, s[4:7], s85 offen offset:2048 sc1
    s_waitcnt lgkmcnt(4)
    v_mfma_f32_16x16x32_bf16 v[136:139], v[96:99], v[96:99], v[136:139]
    s_waitcnt vmcnt(18) lgkmcnt(3)
    ds_read_b64 v[92:93], v14 offset:14336
    v_mfma_f32_16x16x32_bf16 v[140:143], v[132:135], v[96:99], v[140:143]
    ds_read_b64 v[94:95], v14 offset:14848
    s_waitcnt vmcnt(17)
    s_barrier
    v_mfma_f32_16x16x32_bf16 v[100:103], v[60:63], a[176:179], v[100:103]
    ds_read2st64_b64 v[44:47], v5 offset0:24 offset1:25
    v_mfma_f32_16x16x32_bf16 v[104:107], v[64:67], a[176:179], v[104:107]
    ds_read_b64 v[48:49], v5 offset:32768
    v_mfma_f32_16x16x32_bf16 v[108:111], v[68:71], a[176:179], v[108:111]
    ds_read_b64 v[50:51], v5 offset:33280
    v_mfma_f32_16x16x32_bf16 v[112:115], v[72:75], a[176:179], v[112:115]
    buffer_load_dwordx4 a[244:247], v242, s[4:7], s85 offen offset:2048 sc1
    v_mfma_f32_16x16x32_bf16 v[116:119], v[60:63], a[180:183], v[116:119]
    ds_read2st64_b64 v[52:55], v5 offset0:104 offset1:105
    v_mfma_f32_16x16x32_bf16 v[120:123], v[64:67], a[180:183], v[120:123]
    ds_read_b64 v[56:57], v6 offset:32768
    v_mfma_f32_16x16x32_bf16 v[124:127], v[68:71], a[180:183], v[124:127]
    ds_read_b64 v[58:59], v6 offset:33280
    v_mfma_f32_16x16x32_bf16 v[128:131], v[72:75], a[180:183], v[128:131]
    buffer_load_dwordx4 a[248:251], v241, s[4:7], s85 offen offset:3072 sc1
    s_waitcnt lgkmcnt(4)
    v_mfma_f32_16x16x32_bf16 v[136:139], v[92:95], v[92:95], v[136:139]
    ds_read_b64 v[96:97], v14 offset:15360
    v_mfma_f32_16x16x32_bf16 v[140:143], v[132:135], v[92:95], v[140:143]
    ds_read_b64 v[98:99], v14 offset:15872
    v_mfma_f32_16x16x32_bf16 v[100:103], v[76:79], a[184:187], v[100:103]
    ds_read2st64_b64 v[60:63], v5 offset0:26 offset1:27
    v_mfma_f32_16x16x32_bf16 v[104:107], v[80:83], a[184:187], v[104:107]
    ds_read_b64 v[64:65], v5 offset:33792
    v_mfma_f32_16x16x32_bf16 v[108:111], v[84:87], a[184:187], v[108:111]
    ds_read_b64 v[66:67], v5 offset:34304
    v_mfma_f32_16x16x32_bf16 v[112:115], v[88:91], a[184:187], v[112:115]
    buffer_load_dwordx4 a[252:255], v242, s[4:7], s85 offen offset:3072 sc1
    s_sub_u32 s85, s85, 159744
    v_mfma_f32_16x16x32_bf16 v[116:119], v[76:79], a[188:191], v[116:119]
    ds_read2st64_b64 v[68:71], v5 offset0:106 offset1:107
    v_mfma_f32_16x16x32_bf16 v[120:123], v[80:83], a[188:191], v[120:123]
    ds_read_b64 v[72:73], v6 offset:33792
    v_mfma_f32_16x16x32_bf16 v[124:127], v[84:87], a[188:191], v[124:127]
    ds_read_b64 v[74:75], v6 offset:34304
    v_mfma_f32_16x16x32_bf16 v[128:131], v[88:91], a[188:191], v[128:131]
    buffer_load_dwordx4 a[96:99], v241, s[4:7], s85 offen offset:0 sc1
    s_waitcnt lgkmcnt(4)
    v_mfma_f32_16x16x32_bf16 v[136:139], v[96:99], v[96:99], v[136:139]
    s_waitcnt vmcnt(20) lgkmcnt(3)
    ds_read_b64 v[92:93], v14 offset:16384
    v_mfma_f32_16x16x32_bf16 v[140:143], v[132:135], v[96:99], v[140:143]
    ds_read_b64 v[94:95], v14 offset:16896
    s_waitcnt vmcnt(15)
    v_mfma_f32_16x16x32_bf16 v[100:103], v[44:47], a[192:195], v[100:103]
    ds_read2st64_b64 v[76:79], v5 offset0:28 offset1:29
    v_mfma_f32_16x16x32_bf16 v[104:107], v[48:51], a[192:195], v[104:107]
    ds_read_b64 v[80:81], v5 offset:34816
    v_mfma_f32_16x16x32_bf16 v[108:111], v[52:55], a[192:195], v[108:111]
    ds_read_b64 v[82:83], v5 offset:35328
    v_mfma_f32_16x16x32_bf16 v[112:115], v[56:59], a[192:195], v[112:115]
    buffer_load_dwordx4 a[100:103], v242, s[4:7], s85 offen offset:0 sc1
    v_mfma_f32_16x16x32_bf16 v[116:119], v[44:47], a[196:199], v[116:119]
    ds_read2st64_b64 v[84:87], v5 offset0:108 offset1:109
    v_mfma_f32_16x16x32_bf16 v[120:123], v[48:51], a[196:199], v[120:123]
    ds_read_b64 v[88:89], v6 offset:34816
    v_mfma_f32_16x16x32_bf16 v[124:127], v[52:55], a[196:199], v[124:127]
    ds_read_b64 v[90:91], v6 offset:35328
    v_mfma_f32_16x16x32_bf16 v[128:131], v[56:59], a[196:199], v[128:131]
    buffer_load_dwordx4 a[104:107], v241, s[4:7], s85 offen offset:1024 sc1
    s_waitcnt lgkmcnt(4)
    v_mfma_f32_16x16x32_bf16 v[136:139], v[92:95], v[92:95], v[136:139]
    ds_read_b64 v[96:97], v14 offset:17408
    v_mfma_f32_16x16x32_bf16 v[140:143], v[132:135], v[92:95], v[140:143]
    ds_read_b64 v[98:99], v14 offset:17920
    s_waitcnt vmcnt(15) lgkmcnt(5)
    v_mfma_f32_16x16x32_bf16 v[100:103], v[60:63], a[200:203], v[100:103]
    ds_read2st64_b64 v[44:47], v5 offset0:30 offset1:31
    v_mfma_f32_16x16x32_bf16 v[104:107], v[64:67], a[200:203], v[104:107]
    ds_read_b64 v[48:49], v5 offset:35840
    v_mfma_f32_16x16x32_bf16 v[108:111], v[68:71], a[200:203], v[108:111]
    ds_read_b64 v[50:51], v5 offset:36352
    v_mfma_f32_16x16x32_bf16 v[112:115], v[72:75], a[200:203], v[112:115]
    buffer_load_dwordx4 a[108:111], v242, s[4:7], s85 offen offset:1024 sc1
    v_mfma_f32_16x16x32_bf16 v[116:119], v[60:63], a[204:207], v[116:119]
    ds_read2st64_b64 v[52:55], v5 offset0:110 offset1:111
    v_mfma_f32_16x16x32_bf16 v[120:123], v[64:67], a[204:207], v[120:123]
    ds_read_b64 v[56:57], v6 offset:35840
    v_mfma_f32_16x16x32_bf16 v[124:127], v[68:71], a[204:207], v[124:127]
    ds_read_b64 v[58:59], v6 offset:36352
    v_mfma_f32_16x16x32_bf16 v[128:131], v[72:75], a[204:207], v[128:131]
    buffer_load_dwordx4 a[112:115], v241, s[4:7], s85 offen offset:2048 sc1
    s_waitcnt lgkmcnt(4)
    v_mfma_f32_16x16x32_bf16 v[136:139], v[96:99], v[96:99], v[136:139]
    ds_read_b64 v[92:93], v14 offset:18432
    v_mfma_f32_16x16x32_bf16 v[140:143], v[132:135], v[96:99], v[140:143]
    ds_read_b64 v[94:95], v14 offset:18944
    s_barrier
    s_waitcnt vmcnt(15) lgkmcnt(5)
    v_mfma_f32_16x16x32_bf16 v[100:103], v[76:79], a[208:211], v[100:103]
    ds_read2st64_b64 v[60:63], v5 offset0:32 offset1:33
    v_mfma_f32_16x16x32_bf16 v[104:107], v[80:83], a[208:211], v[104:107]
    ds_read_b64 v[64:65], v5 offset:36864
    v_mfma_f32_16x16x32_bf16 v[108:111], v[84:87], a[208:211], v[108:111]
    ds_read_b64 v[66:67], v5 offset:37376
    v_mfma_f32_16x16x32_bf16 v[112:115], v[88:91], a[208:211], v[112:115]
    buffer_load_dwordx4 a[116:119], v242, s[4:7], s85 offen offset:2048 sc1
    v_mfma_f32_16x16x32_bf16 v[116:119], v[76:79], a[212:215], v[116:119]
    ds_read2st64_b64 v[68:71], v5 offset0:112 offset1:113
    v_mfma_f32_16x16x32_bf16 v[120:123], v[80:83], a[212:215], v[120:123]
    ds_read_b64 v[72:73], v6 offset:36864
    v_mfma_f32_16x16x32_bf16 v[124:127], v[84:87], a[212:215], v[124:127]
    ds_read_b64 v[74:75], v6 offset:37376
    v_mfma_f32_16x16x32_bf16 v[128:131], v[88:91], a[212:215], v[128:131]
    buffer_load_dwordx4 a[120:123], v241, s[4:7], s85 offen offset:3072 sc1
    s_waitcnt lgkmcnt(4)
    v_mfma_f32_16x16x32_bf16 v[136:139], v[92:95], v[92:95], v[136:139]
    ds_read_b64 v[96:97], v14 offset:19456
    v_mfma_f32_16x16x32_bf16 v[140:143], v[132:135], v[92:95], v[140:143]
    ds_read_b64 v[98:99], v14 offset:19968
    s_waitcnt vmcnt(15) lgkmcnt(5)
    v_mfma_f32_16x16x32_bf16 v[100:103], v[44:47], a[216:219], v[100:103]
    ds_read2st64_b64 v[76:79], v5 offset0:34 offset1:35
    v_mfma_f32_16x16x32_bf16 v[104:107], v[48:51], a[216:219], v[104:107]
    ds_read_b64 v[80:81], v5 offset:37888
    v_mfma_f32_16x16x32_bf16 v[108:111], v[52:55], a[216:219], v[108:111]
    ds_read_b64 v[82:83], v5 offset:38400
    v_mfma_f32_16x16x32_bf16 v[112:115], v[56:59], a[216:219], v[112:115]
    buffer_load_dwordx4 a[124:127], v242, s[4:7], s85 offen offset:3072 sc1
    s_add_u32 s85, s85, 4096
    v_mfma_f32_16x16x32_bf16 v[116:119], v[44:47], a[220:223], v[116:119]
    ds_read2st64_b64 v[84:87], v5 offset0:114 offset1:115
    v_mfma_f32_16x16x32_bf16 v[120:123], v[48:51], a[220:223], v[120:123]
    ds_read_b64 v[88:89], v6 offset:37888
    v_mfma_f32_16x16x32_bf16 v[124:127], v[52:55], a[220:223], v[124:127]
    ds_read_b64 v[90:91], v6 offset:38400
    v_mfma_f32_16x16x32_bf16 v[128:131], v[56:59], a[220:223], v[128:131]
    buffer_load_dwordx4 a[128:131], v241, s[4:7], s85 offen offset:0 sc1
    s_waitcnt lgkmcnt(4)
    v_mfma_f32_16x16x32_bf16 v[136:139], v[96:99], v[96:99], v[136:139]
    v_mfma_f32_16x16x32_bf16 v[140:143], v[132:135], v[96:99], v[140:143]
    s_waitcnt vmcnt(15) lgkmcnt(3)
    v_mfma_f32_16x16x32_bf16 v[100:103], v[60:63], a[224:227], v[100:103]
    ds_read2st64_b64 v[44:47], v5 offset0:36 offset1:37
    v_mfma_f32_16x16x32_bf16 v[104:107], v[64:67], a[224:227], v[104:107]
    ds_read_b64 v[48:49], v5 offset:38912
    v_mfma_f32_16x16x32_bf16 v[108:111], v[68:71], a[224:227], v[108:111]
    ds_read_b64 v[50:51], v5 offset:39424
    v_mfma_f32_16x16x32_bf16 v[112:115], v[72:75], a[224:227], v[112:115]
    buffer_load_dwordx4 a[132:135], v242, s[4:7], s85 offen offset:0 sc1
    v_mfma_f32_16x16x32_bf16 v[116:119], v[60:63], a[228:231], v[116:119]
    ds_read2st64_b64 v[52:55], v5 offset0:116 offset1:117
    v_mfma_f32_16x16x32_bf16 v[120:123], v[64:67], a[228:231], v[120:123]
    ds_read_b64 v[56:57], v6 offset:38912
    v_mfma_f32_16x16x32_bf16 v[124:127], v[68:71], a[228:231], v[124:127]
    ds_read_b64 v[58:59], v6 offset:39424
    v_mfma_f32_16x16x32_bf16 v[128:131], v[72:75], a[228:231], v[128:131]
    buffer_load_dwordx4 a[136:139], v241, s[4:7], s85 offen offset:1024 sc1
    s_waitcnt vmcnt(15) lgkmcnt(4)
    v_mfma_f32_16x16x32_bf16 v[100:103], v[76:79], a[232:235], v[100:103]
    ds_read2st64_b64 v[60:63], v5 offset0:38 offset1:39
    v_and_b32 v3, 3, v0
    v_mfma_f32_16x16x32_bf16 v[104:107], v[80:83], a[232:235], v[104:107]
    ds_read_b64 v[64:65], v5 offset:39936
    v_cmp_eq_u32 vcc, 1, v3
    v_mfma_f32_16x16x32_bf16 v[108:111], v[84:87], a[232:235], v[108:111]
    ds_read_b64 v[66:67], v5 offset:40448
    v_cndmask_b32 v136, v136, v137, vcc
    v_mfma_f32_16x16x32_bf16 v[112:115], v[88:91], a[232:235], v[112:115]
    buffer_load_dwordx4 a[140:143], v242, s[4:7], s85 offen offset:1024 sc1
    v_mfma_f32_16x16x32_bf16 v[116:119], v[76:79], a[236:239], v[116:119]
    ds_read2st64_b64 v[68:71], v5 offset0:118 offset1:119
    v_cmp_eq_u32 vcc, 2, v3
    v_mfma_f32_16x16x32_bf16 v[120:123], v[80:83], a[236:239], v[120:123]
    ds_read_b64 v[72:73], v6 offset:39936
    v_cndmask_b32 v136, v136, v138, vcc
    v_mfma_f32_16x16x32_bf16 v[124:127], v[84:87], a[236:239], v[124:127]
    ds_read_b64 v[74:75], v6 offset:40448
    v_cmp_eq_u32 vcc, 3, v3
    v_mfma_f32_16x16x32_bf16 v[128:131], v[88:91], a[236:239], v[128:131]
    buffer_load_dwordx4 a[144:147], v241, s[4:7], s85 offen offset:2048 sc1
    s_waitcnt vmcnt(15) lgkmcnt(3)
    v_mfma_f32_16x16x32_bf16 v[100:103], v[44:47], a[240:243], v[100:103]
    ds_read2st64_b64 v[76:79], v5 offset0:0 offset1:1
    v_cndmask_b32 v136, v136, v139, vcc
    v_mfma_f32_16x16x32_bf16 v[104:107], v[48:51], a[240:243], v[104:107]
    ds_read_b64 v[80:81], v5 offset:20480
    v_mul_f32 v140, 0xbacccccd, v140
    v_mfma_f32_16x16x32_bf16 v[108:111], v[52:55], a[240:243], v[108:111]
    ds_read_b64 v[82:83], v5 offset:20992
    v_mul_f32 v136, 0x3acccccd, v136
    v_mfma_f32_16x16x32_bf16 v[112:115], v[56:59], a[240:243], v[112:115]
    buffer_load_dwordx4 a[148:151], v242, s[4:7], s85 offen offset:2048 sc1
    v_mfma_f32_16x16x32_bf16 v[116:119], v[44:47], a[244:247], v[116:119]
    ds_read2st64_b64 v[84:87], v5 offset0:80 offset1:81
    v_fma_f32 v136, -v140, v140, v136
    v_mfma_f32_16x16x32_bf16 v[120:123], v[48:51], a[244:247], v[120:123]
    ds_read_b64 v[88:89], v6 offset:20480
    v_max_f32 v136, 0, v136
    v_mfma_f32_16x16x32_bf16 v[124:127], v[52:55], a[244:247], v[124:127]
    ds_read_b64 v[90:91], v6 offset:20992
    v_add_f32 v136, 0x3727c5ac, v136
    v_mfma_f32_16x16x32_bf16 v[128:131], v[56:59], a[244:247], v[128:131]
    buffer_load_dwordx4 a[152:155], v241, s[4:7], s85 offen offset:3072 sc1
    v_rsq_f32 v136, v136
    v_lshrrev_b32 v3, 2, v1
    v_cmp_eq_u32 vcc, v3, v2
    s_lshl_b32 s62, s82, 6
    s_add_u32 s62, s62, 81920
    v_lshl_add_u32 v3, v1, 2, s62
    s_mov_b64 exec, vcc
    ds_write2st64_b32 v3, v136, v140 offset0:0 offset1:1
    s_mov_b64 exec, -1
    s_waitcnt lgkmcnt(0)
    s_barrier
    s_waitcnt vmcnt(15)
    v_mfma_f32_16x16x32_bf16 v[100:103], v[60:63], a[248:251], v[100:103]
    ds_read2st64_b64 v[44:47], v5 offset0:2 offset1:3
    v_add_u32 v3, 81920, v7
    v_mfma_f32_16x16x32_bf16 v[104:107], v[64:67], a[248:251], v[104:107]
    ds_read_b64 v[48:49], v5 offset:21504
    ds_read_b128 v[180:183], v3 offset:256
    v_mfma_f32_16x16x32_bf16 v[108:111], v[68:71], a[248:251], v[108:111]
    ds_read_b64 v[50:51], v5 offset:22016
    ds_read_b128 v[164:167], v3 offset:0
    v_mfma_f32_16x16x32_bf16 v[112:115], v[72:75], a[248:251], v[112:115]
    buffer_load_dwordx4 a[156:159], v242, s[4:7], s85 offen offset:3072 sc1
    s_add_u32 s85, s85, 4096
    v_mfma_f32_16x16x32_bf16 v[116:119], v[60:63], a[252:255], v[116:119]
    ds_read2st64_b64 v[52:55], v5 offset0:82 offset1:83
    ds_read_b128 v[184:187], v3 offset:320
    v_mfma_f32_16x16x32_bf16 v[120:123], v[64:67], a[252:255], v[120:123]
    ds_read_b64 v[56:57], v6 offset:21504
    ds_read_b128 v[168:171], v3 offset:64
    v_mfma_f32_16x16x32_bf16 v[124:127], v[68:71], a[252:255], v[124:127]
    ds_read_b64 v[58:59], v6 offset:22016
    ds_read_b128 v[188:191], v3 offset:384
    v_mfma_f32_16x16x32_bf16 v[128:131], v[72:75], a[252:255], v[128:131]
    buffer_load_dwordx4 a[160:163], v241, s[4:7], s85 offen offset:0 sc1
    ds_read_b128 v[172:175], v3 offset:128
    ds_read_b128 v[192:195], v3 offset:448
    ds_read_b128 v[176:179], v3 offset:192
    s_waitcnt lgkmcnt(11)
    v_pk_fma_f32 v[100:101], v[180:181], v[212:213], v[100:101] op_sel:[0,0,0] op_sel_hi:[1,0,1]
    v_pk_fma_f32 v[102:103], v[182:183], v[212:213], v[102:103] op_sel:[0,0,0] op_sel_hi:[1,0,1]
    v_pk_fma_f32 v[116:117], v[180:181], v[214:215], v[116:117] op_sel:[0,0,0] op_sel_hi:[1,0,1]
    v_pk_fma_f32 v[118:119], v[182:183], v[214:215], v[118:119] op_sel:[0,0,0] op_sel_hi:[1,0,1]
    s_waitcnt lgkmcnt(9)
    v_pk_fma_f32 v[100:101], v[100:101], v[164:165], v[212:213] op_sel:[0,0,1] op_sel_hi:[1,1,1]
    v_pk_fma_f32 v[102:103], v[102:103], v[166:167], v[212:213] op_sel:[0,0,1] op_sel_hi:[1,1,1]
    v_pk_fma_f32 v[116:117], v[116:117], v[164:165], v[214:215] op_sel:[0,0,1] op_sel_hi:[1,1,1]
    v_pk_fma_f32 v[118:119], v[118:119], v[166:167], v[214:215] op_sel:[0,0,1] op_sel_hi:[1,1,1]
    v_pk_mul_f32 v[216:217], v[100:101], v[100:101]
    v_pk_mul_f32 v[218:219], v[102:103], v[102:103]
    v_pk_mul_f32 v[220:221], v[116:117], v[116:117]
    buffer_load_dwordx4 a[164:167], v242, s[4:7], s85 offen offset:0 sc1
    v_pk_mul_f32 v[222:223], v[118:119], v[118:119]
    v_pk_fma_f32 v[216:217], v[216:217], s[66:67], s[66:67] op_sel:[0,0,1] op_sel_hi:[1,0,1]
    v_pk_fma_f32 v[218:219], v[218:219], s[66:67], s[66:67] op_sel:[0,0,1] op_sel_hi:[1,0,1]
    v_pk_fma_f32 v[220:221], v[220:221], s[66:67], s[66:67] op_sel:[0,0,1] op_sel_hi:[1,0,1]
    v_pk_fma_f32 v[222:223], v[222:223], s[66:67], s[66:67] op_sel:[0,0,1] op_sel_hi:[1,0,1]
    v_pk_mul_f32 v[216:217], v[216:217], v[100:101]
    v_pk_mul_f32 v[218:219], v[218:219], v[102:103]
    v_pk_mul_f32 v[220:221], v[220:221], v[116:117]
    v_pk_mul_f32 v[222:223], v[222:223], v[118:119]
    v_exp_f32 v216, v216
    v_exp_f32 v217, v217
    buffer_load_dwordx4 a[168:171], v241, s[4:7], s85 offen offset:1024 sc1
    v_exp_f32 v218, v218
    v_exp_f32 v219, v219
    v_exp_f32 v220, v220
    v_exp_f32 v221, v221
    v_exp_f32 v222, v222
    v_exp_f32 v223, v223
    v_pk_add_f32 v[216:217], v[216:217], s[68:69]
    v_pk_add_f32 v[218:219], v[218:219], s[68:69]
    v_pk_add_f32 v[220:221], v[220:221], s[68:69]
    v_pk_add_f32 v[222:223], v[222:223], s[68:69]
    v_rcp_f32 v216, v216
    buffer_load_dwordx4 a[172:175], v242, s[4:7], s85 offen offset:1024 sc1
    v_rcp_f32 v217, v217
    v_rcp_f32 v218, v218
    v_rcp_f32 v219, v219
    v_rcp_f32 v220, v220
    v_rcp_f32 v221, v221
    v_rcp_f32 v222, v222
    v_rcp_f32 v223, v223
    v_pk_mul_f32 v[100:101], v[100:101], v[216:217]
    v_pk_mul_f32 v[102:103], v[102:103], v[218:219]
    v_pk_mul_f32 v[116:117], v[116:117], v[220:221]
    v_pk_mul_f32 v[118:119], v[118:119], v[222:223]
    buffer_load_dwordx4 a[176:179], v241, s[4:7], s85 offen offset:2048 sc1
    v_pk_add_f32 v[164:165], v[100:101], v[116:117]
    v_pk_mul_f32 v[180:181], v[100:101], v[100:101]
    v_pk_add_f32 v[166:167], v[102:103], v[118:119]
    v_pk_mul_f32 v[182:183], v[102:103], v[102:103]
    v_pk_fma_f32 v[180:181], v[116:117], v[116:117], v[180:181]
    v_pk_fma_f32 v[182:183], v[118:119], v[118:119], v[182:183]
    s_waitcnt lgkmcnt(0)
    v_pk_fma_f32 v[104:105], v[184:185], v[212:213], v[104:105] op_sel:[0,0,0] op_sel_hi:[1,0,1]
    v_pk_fma_f32 v[106:107], v[186:187], v[212:213], v[106:107] op_sel:[0,0,0] op_sel_hi:[1,0,1]
    v_pk_fma_f32 v[120:121], v[184:185], v[214:215], v[120:121] op_sel:[0,0,0] op_sel_hi:[1,0,1]
    v_pk_fma_f32 v[122:123], v[186:187], v[214:215], v[122:123] op_sel:[0,0,0] op_sel_hi:[1,0,1]
    v_pk_fma_f32 v[104:105], v[104:105], v[168:169], v[212:213] op_sel:[0,0,1] op_sel_hi:[1,1,1]
    buffer_load_dwordx4 a[180:183], v242, s[4:7], s85 offen offset:2048 sc1
    v_pk_fma_f32 v[106:107], v[106:107], v[170:171], v[212:213] op_sel:[0,0,1] op_sel_hi:[1,1,1]
    v_pk_fma_f32 v[120:121], v[120:121], v[168:169], v[214:215] op_sel:[0,0,1] op_sel_hi:[1,1,1]
    v_pk_fma_f32 v[122:123], v[122:123], v[170:171], v[214:215] op_sel:[0,0,1] op_sel_hi:[1,1,1]
    v_pk_mul_f32 v[216:217], v[104:105], v[104:105]
    v_pk_mul_f32 v[218:219], v[106:107], v[106:107]
    v_pk_mul_f32 v[220:221], v[120:121], v[120:121]
    v_pk_mul_f32 v[222:223], v[122:123], v[122:123]
    v_pk_fma_f32 v[216:217], v[216:217], s[66:67], s[66:67] op_sel:[0,0,1] op_sel_hi:[1,0,1]
    v_pk_fma_f32 v[218:219], v[218:219], s[66:67], s[66:67] op_sel:[0,0,1] op_sel_hi:[1,0,1]
    v_pk_fma_f32 v[220:221], v[220:221], s[66:67], s[66:67] op_sel:[0,0,1] op_sel_hi:[1,0,1]
    v_pk_fma_f32 v[222:223], v[222:223], s[66:67], s[66:67] op_sel:[0,0,1] op_sel_hi:[1,0,1]
    buffer_load_dwordx4 a[184:187], v241, s[4:7], s85 offen offset:3072 sc1
    v_pk_mul_f32 v[216:217], v[216:217], v[104:105]
    v_pk_mul_f32 v[218:219], v[218:219], v[106:107]
    v_pk_mul_f32 v[220:221], v[220:221], v[120:121]
    v_pk_mul_f32 v[222:223], v[222:223], v[122:123]
    v_exp_f32 v216, v216
    v_exp_f32 v217, v217
    v_exp_f32 v218, v218
    v_exp_f32 v219, v219
    v_exp_f32 v220, v220
    v_exp_f32 v221, v221
    v_exp_f32 v222, v222
    buffer_load_dwordx4 a[188:191], v242, s[4:7], s85 offen offset:3072 sc1
    s_add_u32 s85, s85, 4096
    v_exp_f32 v223, v223
    v_pk_add_f32 v[216:217], v[216:217], s[68:69]
    v_pk_add_f32 v[218:219], v[218:219], s[68:69]
    v_pk_add_f32 v[220:221], v[220:221], s[68:69]
    v_pk_add_f32 v[222:223], v[222:223], s[68:69]
    v_rcp_f32 v216, v216
    v_rcp_f32 v217, v217
    v_rcp_f32 v218, v218
    v_rcp_f32 v219, v219
    v_rcp_f32 v220, v220
    v_rcp_f32 v221, v221
    buffer_load_dwordx4 a[192:195], v241, s[4:7], s85 offen offset:0 sc1
    v_rcp_f32 v222, v222
    v_rcp_f32_e64 v223, v223
    v_pk_mul_f32 v[104:105], v[104:105], v[216:217]
    v_pk_mul_f32 v[106:107], v[106:107], v[218:219]
    v_pk_mul_f32 v[120:121], v[120:121], v[220:221]
    v_pk_mul_f32 v[122:123], v[122:123], v[222:223]
    v_pk_add_f32 v[168:169], v[104:105], v[120:121]
    v_pk_mul_f32 v[184:185], v[104:105], v[104:105]
    v_pk_add_f32 v[170:171], v[106:107], v[122:123]
    v_pk_mul_f32 v[186:187], v[106:107], v[106:107]
    v_pk_fma_f32 v[184:185], v[120:121], v[120:121], v[184:185]
    buffer_load_dwordx4 a[196:199], v242, s[4:7], s85 offen offset:0 sc1
    v_pk_fma_f32 v[186:187], v[122:123], v[122:123], v[186:187]
    v_pk_fma_f32 v[108:109], v[188:189], v[212:213], v[108:109] op_sel:[0,0,0] op_sel_hi:[1,0,1]
    v_pk_fma_f32 v[110:111], v[190:191], v[212:213], v[110:111] op_sel:[0,0,0] op_sel_hi:[1,0,1]
    v_pk_fma_f32 v[124:125], v[188:189], v[214:215], v[124:125] op_sel:[0,0,0] op_sel_hi:[1,0,1]
    v_pk_fma_f32 v[126:127], v[190:191], v[214:215], v[126:127] op_sel:[0,0,0] op_sel_hi:[1,0,1]
    v_pk_fma_f32 v[108:109], v[108:109], v[172:173], v[212:213] op_sel:[0,0,1] op_sel_hi:[1,1,1]
    v_pk_fma_f32 v[110:111], v[110:111], v[174:175], v[212:213] op_sel:[0,0,1] op_sel_hi:[1,1,1]
    v_pk_fma_f32 v[124:125], v[124:125], v[172:173], v[214:215] op_sel:[0,0,1] op_sel_hi:[1,1,1]
    v_pk_fma_f32 v[126:127], v[126:127], v[174:175], v[214:215] op_sel:[0,0,1] op_sel_hi:[1,1,1]
    v_pk_mul_f32 v[216:217], v[108:109], v[108:109]
    v_pk_mul_f32 v[218:219], v[110:111], v[110:111]
    buffer_load_dwordx4 a[200:203], v241, s[4:7], s85 offen offset:1024 sc1
    v_pk_mul_f32 v[220:221], v[124:125], v[124:125]
    v_pk_mul_f32 v[222:223], v[126:127], v[126:127]
    v_pk_fma_f32 v[216:217], v[216:217], s[66:67], s[66:67] op_sel:[0,0,1] op_sel_hi:[1,0,1]
    v_pk_fma_f32 v[218:219], v[218:219], s[66:67], s[66:67] op_sel:[0,0,1] op_sel_hi:[1,0,1]
    v_pk_fma_f32 v[220:221], v[220:221], s[66:67], s[66:67] op_sel:[0,0,1] op_sel_hi:[1,0,1]
    v_pk_fma_f32 v[222:223], v[222:223], s[66:67], s[66:67] op_sel:[0,0,1] op_sel_hi:[1,0,1]
    v_pk_mul_f32 v[216:217], v[216:217], v[108:109]
    v_pk_mul_f32 v[218:219], v[218:219], v[110:111]
    v_pk_mul_f32 v[220:221], v[220:221], v[124:125]
    v_pk_mul_f32 v[222:223], v[222:223], v[126:127]
    v_exp_f32 v216, v216
    buffer_load_dwordx4 a[204:207], v242, s[4:7], s85 offen offset:1024 sc1
    v_exp_f32 v217, v217
    v_exp_f32 v218, v218
    v_exp_f32 v219, v219
    v_exp_f32 v220, v220
    v_exp_f32 v221, v221
    v_exp_f32 v222, v222
    v_exp_f32 v223, v223
    v_pk_add_f32 v[216:217], v[216:217], s[68:69]
    v_pk_add_f32 v[218:219], v[218:219], s[68:69]
    v_pk_add_f32 v[220:221], v[220:221], s[68:69]
    v_pk_add_f32 v[222:223], v[222:223], s[68:69]
    buffer_load_dwordx4 a[208:211], v241, s[4:7], s85 offen offset:2048 sc1
    v_rcp_f32 v216, v216
    v_rcp_f32 v217, v217
    v_rcp_f32 v218, v218
    v_rcp_f32 v219, v219
    v_rcp_f32 v220, v220
    v_rcp_f32 v221, v221
    v_rcp_f32 v222, v222
    v_rcp_f32 v223, v223
    v_pk_mul_f32 v[108:109], v[108:109], v[216:217]
    v_pk_mul_f32 v[110:111], v[110:111], v[218:219]
    v_pk_mul_f32 v[124:125], v[124:125], v[220:221]
    buffer_load_dwordx4 a[212:215], v242, s[4:7], s85 offen offset:2048 sc1
    v_pk_mul_f32 v[126:127], v[126:127], v[222:223]
    v_pk_add_f32 v[172:173], v[108:109], v[124:125]
    v_pk_mul_f32 v[188:189], v[108:109], v[108:109]
    v_pk_add_f32 v[174:175], v[110:111], v[126:127]
    v_pk_mul_f32 v[190:191], v[110:111], v[110:111]
    v_pk_fma_f32 v[188:189], v[124:125], v[124:125], v[188:189]
    v_pk_fma_f32 v[190:191], v[126:127], v[126:127], v[190:191]
    v_pk_fma_f32 v[112:113], v[192:193], v[212:213], v[112:113] op_sel:[0,0,0] op_sel_hi:[1,0,1]
    v_pk_fma_f32 v[114:115], v[194:195], v[212:213], v[114:115] op_sel:[0,0,0] op_sel_hi:[1,0,1]
    v_pk_fma_f32 v[128:129], v[192:193], v[214:215], v[128:129] op_sel:[0,0,0] op_sel_hi:[1,0,1]
    v_pk_fma_f32 v[130:131], v[194:195], v[214:215], v[130:131] op_sel:[0,0,0] op_sel_hi:[1,0,1]
    buffer_load_dwordx4 a[216:219], v241, s[4:7], s85 offen offset:3072 sc1
    v_pk_fma_f32 v[112:113], v[112:113], v[176:177], v[212:213] op_sel:[0,0,1] op_sel_hi:[1,1,1]
    v_pk_fma_f32 v[114:115], v[114:115], v[178:179], v[212:213] op_sel:[0,0,1] op_sel_hi:[1,1,1]
    v_pk_fma_f32 v[128:129], v[128:129], v[176:177], v[214:215] op_sel:[0,0,1] op_sel_hi:[1,1,1]
    v_pk_fma_f32 v[130:131], v[130:131], v[178:179], v[214:215] op_sel:[0,0,1] op_sel_hi:[1,1,1]
    v_pk_mul_f32 v[216:217], v[112:113], v[112:113]
    v_pk_mul_f32 v[218:219], v[114:115], v[114:115]
    v_pk_mul_f32 v[220:221], v[128:129], v[128:129]
    v_pk_mul_f32 v[222:223], v[130:131], v[130:131]
    v_pk_fma_f32 v[216:217], v[216:217], s[66:67], s[66:67] op_sel:[0,0,1] op_sel_hi:[1,0,1]
    v_pk_fma_f32 v[218:219], v[218:219], s[66:67], s[66:67] op_sel:[0,0,1] op_sel_hi:[1,0,1]
    v_pk_fma_f32 v[220:221], v[220:221], s[66:67], s[66:67] op_sel:[0,0,1] op_sel_hi:[1,0,1]
    buffer_load_dwordx4 a[220:223], v242, s[4:7], s85 offen offset:3072 sc1
    s_add_u32 s85, s85, 4096
    v_pk_fma_f32 v[222:223], v[222:223], s[66:67], s[66:67] op_sel:[0,0,1] op_sel_hi:[1,0,1]
    v_pk_mul_f32 v[216:217], v[216:217], v[112:113]
    v_pk_mul_f32 v[218:219], v[218:219], v[114:115]
    v_pk_mul_f32 v[220:221], v[220:221], v[128:129]
    v_pk_mul_f32 v[222:223], v[222:223], v[130:131]
    v_exp_f32 v216, v216
    v_exp_f32 v217, v217
    v_exp_f32 v218, v218
    v_exp_f32 v219, v219
    v_exp_f32 v220, v220
    v_exp_f32 v221, v221
    buffer_load_dwordx4 a[224:227], v241, s[4:7], s85 offen offset:0 sc1
    v_exp_f32 v222, v222
    v_exp_f32 v223, v223
    v_pk_add_f32 v[216:217], v[216:217], s[68:69]
    v_pk_add_f32 v[218:219], v[218:219], s[68:69]
    v_pk_add_f32 v[220:221], v[220:221], s[68:69]
    v_pk_add_f32 v[222:223], v[222:223], s[68:69]
    v_rcp_f32 v216, v216
    v_rcp_f32 v217, v217
    v_rcp_f32 v218, v218
    v_rcp_f32 v219, v219
    v_rcp_f32 v220, v220
    buffer_load_dwordx4 a[228:231], v242, s[4:7], s85 offen offset:0 sc1
    v_rcp_f32 v221, v221
    v_rcp_f32 v222, v222
    v_rcp_f32 v223, v223
    v_pk_mul_f32 v[112:113], v[112:113], v[216:217]
    v_pk_mul_f32 v[114:115], v[114:115], v[218:219]
    v_pk_mul_f32 v[128:129], v[128:129], v[220:221]
    v_pk_mul_f32 v[130:131], v[130:131], v[222:223]
    v_pk_add_f32 v[176:177], v[112:113], v[128:129]
    v_pk_mul_f32 v[192:193], v[112:113], v[112:113]
    v_pk_add_f32 v[178:179], v[114:115], v[130:131]
    v_pk_mul_f32 v[194:195], v[114:115], v[114:115]
    buffer_load_dwordx4 a[232:235], v241, s[4:7], s85 offen offset:1024 sc1
    v_pk_fma_f32 v[192:193], v[128:129], v[128:129], v[192:193]
    v_pk_fma_f32 v[194:195], v[130:131], v[130:131], v[194:195]
    v_add_f32_dpp v164, v164, v164 row_ror:8 row_mask:0xf bank_mask:3
    v_add_f32_dpp v165, v165, v165 row_ror:8 row_mask:0xf bank_mask:3
    v_add_f32_dpp v166, v166, v166 row_ror:8 row_mask:0xf bank_mask:3
    v_add_f32_dpp v167, v167, v167 row_ror:8 row_mask:0xf bank_mask:3
    v_add_f32_dpp v168, v168, v168 row_ror:8 row_mask:0xf bank_mask:3
    v_add_f32_dpp v169, v169, v169 row_ror:8 row_mask:0xf bank_mask:3
    v_add_f32_dpp v170, v170, v170 row_ror:8 row_mask:0xf bank_mask:3
    v_add_f32_dpp v171, v171, v171 row_ror:8 row_mask:0xf bank_mask:3
    v_add_f32_dpp v172, v172, v172 row_ror:8 row_mask:0xf bank_mask:3
    buffer_load_dwordx4 a[236:239], v242, s[4:7], s85 offen offset:1024 sc1
    v_add_f32_dpp v173, v173, v173 row_ror:8 row_mask:0xf bank_mask:3
    v_add_f32_dpp v174, v174, v174 row_ror:8 row_mask:0xf bank_mask:3
    v_add_f32_dpp v175, v175, v175 row_ror:8 row_mask:0xf bank_mask:3
    v_add_f32_dpp v176, v176, v176 row_ror:8 row_mask:0xf bank_mask:3
    v_add_f32_dpp v177, v177, v177 row_ror:8 row_mask:0xf bank_mask:3
    v_add_f32_dpp v178, v178, v178 row_ror:8 row_mask:0xf bank_mask:3
    v_add_f32_dpp v179, v179, v179 row_ror:8 row_mask:0xf bank_mask:3
    v_add_f32_dpp v164, v180, v180 row_ror:8 row_mask:0xf bank_mask:12
    v_add_f32_dpp v165, v181, v181 row_ror:8 row_mask:0xf bank_mask:12
    v_add_f32_dpp v166, v182, v182 row_ror:8 row_mask:0xf bank_mask:12
    v_add_f32_dpp v167, v183, v183 row_ror:8 row_mask:0xf bank_mask:12
    buffer_load_dwordx4 a[240:243], v241, s[4:7], s85 offen offset:2048 sc1
    v_add_f32_dpp v168, v184, v184 row_ror:8 row_mask:0xf bank_mask:12
    v_add_f32_dpp v169, v185, v185 row_ror:8 row_mask:0xf bank_mask:12
    v_add_f32_dpp v170, v186, v186 row_ror:8 row_mask:0xf bank_mask:12
    v_add_f32_dpp v171, v187, v187 row_ror:8 row_mask:0xf bank_mask:12
    v_add_f32_dpp v172, v188, v188 row_ror:8 row_mask:0xf bank_mask:12
    v_add_f32_dpp v173, v189, v189 row_ror:8 row_mask:0xf bank_mask:12
    v_add_f32_dpp v174, v190, v190 row_ror:8 row_mask:0xf bank_mask:12
    v_add_f32_dpp v175, v191, v191 row_ror:8 row_mask:0xf bank_mask:12
    v_add_f32_dpp v176, v192, v192 row_ror:8 row_mask:0xf bank_mask:12
    v_add_f32_dpp v177, v193, v193 row_ror:8 row_mask:0xf bank_mask:12
    v_add_f32_dpp v178, v194, v194 row_ror:8 row_mask:0xf bank_mask:12
    buffer_load_dwordx4 a[244:247], v242, s[4:7], s85 offen offset:2048 sc1
    v_add_f32_dpp v179, v195, v195 row_ror:8 row_mask:0xf bank_mask:12
    v_add_f32_dpp v164, v164, v164 row_half_mirror row_mask:0xf bank_mask:5
    v_add_f32_dpp v165, v165, v165 row_half_mirror row_mask:0xf bank_mask:5
    v_add_f32_dpp v166, v166, v166 row_half_mirror row_mask:0xf bank_mask:5
    v_add_f32_dpp v167, v167, v167 row_half_mirror row_mask:0xf bank_mask:5
    v_add_f32_dpp v168, v168, v168 row_half_mirror row_mask:0xf bank_mask:5
    v_add_f32_dpp v169, v169, v169 row_half_mirror row_mask:0xf bank_mask:5
    v_add_f32_dpp v170, v170, v170 row_half_mirror row_mask:0xf bank_mask:5
    v_add_f32_dpp v171, v171, v171 row_half_mirror row_mask:0xf bank_mask:5
    v_add_f32_dpp v164, v172, v172 row_half_mirror row_mask:0xf bank_mask:10
    v_add_f32_dpp v165, v173, v173 row_half_mirror row_mask:0xf bank_mask:10
    buffer_load_dwordx4 a[248:251], v241, s[4:7], s85 offen offset:3072 sc1
    v_add_f32_dpp v166, v174, v174 row_half_mirror row_mask:0xf bank_mask:10
    v_add_f32_dpp v167, v175, v175 row_half_mirror row_mask:0xf bank_mask:10
    v_add_f32_dpp v168, v176, v176 row_half_mirror row_mask:0xf bank_mask:10
    v_add_f32_dpp v169, v177, v177 row_half_mirror row_mask:0xf bank_mask:10
    v_add_f32_dpp v170, v178, v178 row_half_mirror row_mask:0xf bank_mask:10
    v_add_f32_dpp v171, v179, v179 row_half_mirror row_mask:0xf bank_mask:10
    v_bfe_u32 v3, v0, 2, 2
    v_lshl_add_u32 v3, v3, 7, v7
    v_and_b32_e64 v4, 3, v0
    v_mul_u32_u24 v4, 528, v4
    s_mul_i32 s64, s82, 2112
    s_add_u32 s64, s64, 90624
    v_add3_u32 v3, s64, v3, v4
    ds_write_b128 v3, v[164:167]
    ds_write_b128 v3, v[168:171] offset:64
    s_lshl_b32 s55, s83, 13
    s_add_u32 s55, s55, 524288
    s_waitcnt lgkmcnt(0)
    s_barrier
    s_waitcnt vmcnt(30)
    v_mfma_f32_16x16x32_bf16 v[132:135], a[96:99], v[76:79], 0
    ds_read2st64_b64 v[60:63], v5 offset0:4 offset1:5
    s_lshl_b32 s64, s82, 8
    v_mfma_f32_16x16x32_bf16 v[136:139], a[96:99], v[80:83], 0
    ds_read_b64 v[64:65], v5 offset:22528
    s_add_u32 s55, s55, s64
    v_mfma_f32_16x16x32_bf16 v[140:143], a[96:99], v[84:87], 0
    ds_read_b64 v[66:67], v5 offset:23040
    v_lshlrev_b32 v172, 4, v1
    v_mfma_f32_16x16x32_bf16 v[144:147], a[96:99], v[88:91], 0
    buffer_load_dwordx4 a[252:255], v242, s[4:7], s85 offen offset:3072 sc1
    s_add_u32 s85, s85, 4096
    v_mfma_f32_16x16x32_bf16 v[148:151], a[100:103], v[76:79], 0
    ds_read2st64_b64 v[68:71], v5 offset0:84 offset1:85
    v_lshl_add_u32 v172, v2, 11, v172
    v_mfma_f32_16x16x32_bf16 v[152:155], a[100:103], v[80:83], 0
    ds_read_b64 v[72:73], v6 offset:22528
    v_lshlrev_b32 v92, 1, v7
    v_mfma_f32_16x16x32_bf16 v[156:159], a[100:103], v[84:87], 0
    ds_read_b64 v[74:75], v6 offset:23040
    v_add_u32 v92, 88576, v92
    v_mfma_f32_16x16x32_bf16 v[160:163], a[100:103], v[88:91], 0
    v_add_u32 v93, 88832, v7
    v_mfma_f32_16x16x32_bf16 v[132:135], a[104:107], v[44:47], v[132:135]
    ds_read_b64 v[76:77], v5 offset:3072
    s_add_u32 m0, s41, 0
    v_mfma_f32_16x16x32_bf16 v[136:139], a[104:107], v[48:51], v[136:139]
    ds_read_b64 v[78:79], v5 offset:3584
    ds_read_b128 v[176:179], v92 offset:0
    v_mfma_f32_16x16x32_bf16 v[140:143], a[104:107], v[52:55], v[140:143]
    ds_read_b64 v[80:81], v5 offset:23552
    v_mfma_f32_16x16x32_bf16 v[144:147], a[104:107], v[56:59], v[144:147]
    ds_read_b64 v[82:83], v5 offset:24064
    ds_read_b128 v[180:183], v92 offset:16
    v_mfma_f32_16x16x32_bf16 v[148:151], a[108:111], v[44:47], v[148:151]
    ds_read_b64 v[84:85], v6 offset:3072
    v_mfma_f32_16x16x32_bf16 v[152:155], a[108:111], v[48:51], v[152:155]
    ds_read_b64 v[86:87], v6 offset:3584
    ds_read_b128 v[184:187], v92 offset:128
    v_mfma_f32_16x16x32_bf16 v[156:159], a[108:111], v[52:55], v[156:159]
    ds_read_b64 v[88:89], v6 offset:23552
    v_mfma_f32_16x16x32_bf16 v[160:163], a[108:111], v[56:59], v[160:163]
    ds_read_b64 v[90:91], v6 offset:24064
    ds_read_b128 v[188:191], v92 offset:144
    s_waitcnt lgkmcnt(9)
    v_mfma_f32_16x16x32_bf16 v[132:135], a[112:115], v[60:63], v[132:135]
    ds_read_b64 v[44:45], v5 offset:4096
    v_mfma_f32_16x16x32_bf16 v[136:139], a[112:115], v[64:67], v[136:139]
    ds_read_b64 v[46:47], v5 offset:4608
    ds_read_b128 v[192:195], v93
    v_mfma_f32_16x16x32_bf16 v[140:143], a[112:115], v[68:71], v[140:143]
    ds_read_b64 v[48:49], v5 offset:24576
    s_mov_b32 s57, 0x07060302
    v_mfma_f32_16x16x32_bf16 v[144:147], a[112:115], v[72:75], v[144:147]
    ds_read_b64 v[50:51], v5 offset:25088
    buffer_load_dwordx4 v245, s[32:35], s88 offen offset:0 lds
    v_mfma_f32_16x16x32_bf16 v[148:151], a[116:119], v[60:63], v[148:151]
    ds_read_b64 v[52:53], v6 offset:4096
    v_perm_b32 v230, v177, v176, s57
    v_mfma_f32_16x16x32_bf16 v[152:155], a[116:119], v[64:67], v[152:155]
    ds_read_b64 v[54:55], v6 offset:4608
    buffer_load_dwordx4 v246, s[32:35], s88 offen offset:1024 lds
    v_mfma_f32_16x16x32_bf16 v[156:159], a[116:119], v[68:71], v[156:159]
    ds_read_b64 v[56:57], v6 offset:24576
    s_add_u32 m0, s41, 2048
    v_mfma_f32_16x16x32_bf16 v[160:163], a[116:119], v[72:75], v[160:163]
    ds_read_b64 v[58:59], v6 offset:25088
    buffer_load_dwordx4 v245, s[32:35], s89 offen offset:0 lds
    s_waitcnt lgkmcnt(6)
    v_mfma_f32_16x16x32_bf16 v[132:135], a[120:123], v[76:79], v[132:135]
    ds_read_b64 v[60:61], v5 offset:5120
    v_perm_b32 v231, v179, v178, s57
    v_mfma_f32_16x16x32_bf16 v[136:139], a[120:123], v[80:83], v[136:139]
    ds_read_b64 v[62:63], v5 offset:5632
    buffer_load_dwordx4 v246, s[32:35], s89 offen offset:1024 lds
    v_mfma_f32_16x16x32_bf16 v[140:143], a[120:123], v[84:87], v[140:143]
    ds_read_b64 v[64:65], v5 offset:25600
    s_add_u32 m0, s41, 4096
    v_mfma_f32_16x16x32_bf16 v[144:147], a[120:123], v[88:91], v[144:147]
    ds_read_b64 v[66:67], v5 offset:26112
    buffer_load_dwordx4 v245, s[32:35], s90 offen offset:0 lds
    v_mfma_f32_16x16x32_bf16 v[148:151], a[124:127], v[76:79], v[148:151]
    ds_read_b64 v[68:69], v6 offset:5120
    v_perm_b32 v232, v181, v180, s57
    v_mfma_f32_16x16x32_bf16 v[152:155], a[124:127], v[80:83], v[152:155]
    ds_read_b64 v[70:71], v6 offset:5632
    buffer_load_dwordx4 v246, s[32:35], s90 offen offset:1024 lds
    v_mfma_f32_16x16x32_bf16 v[156:159], a[124:127], v[84:87], v[156:159]
    ds_read_b64 v[72:73], v6 offset:25600
    s_add_u32 m0, s41, 6144
    v_mfma_f32_16x16x32_bf16 v[160:163], a[124:127], v[88:91], v[160:163]
    ds_read_b64 v[74:75], v6 offset:26112
    buffer_load_dwordx4 v245, s[32:35], s91 offen offset:0 lds
    s_waitcnt vmcnt(31) lgkmcnt(6)
    v_mfma_f32_16x16x32_bf16 v[132:135], a[128:131], v[44:47], v[132:135]
    ds_read_b64 v[76:77], v5 offset:6144
    v_perm_b32 v233, v183, v182, s57
    v_mfma_f32_16x16x32_bf16 v[136:139], a[128:131], v[48:51], v[136:139]
    ds_read_b64 v[78:79], v5 offset:6656
    buffer_load_dwordx4 v246, s[32:35], s91 offen offset:1024 lds
    v_mfma_f32_16x16x32_bf16 v[140:143], a[128:131], v[52:55], v[140:143]
    ds_read_b64 v[80:81], v5 offset:26624
    v_add_u32 v247, 128, v245
    v_mfma_f32_16x16x32_bf16 v[144:147], a[128:131], v[56:59], v[144:147]
    ds_read_b64 v[82:83], v5 offset:27136
    v_bfi_b32 v245, s40, v247, v245
    v_bfi_b32 v246, s40, v247, v246
    v_mfma_f32_16x16x32_bf16 v[148:151], a[132:135], v[44:47], v[148:151]
    ds_read_b64 v[84:85], v6 offset:6144
    s_add_u32 m0, s41, 8192
    v_mfma_f32_16x16x32_bf16 v[152:155], a[132:135], v[48:51], v[152:155]
    ds_read_b64 v[86:87], v6 offset:6656
    buffer_load_dwordx4 v245, s[32:35], s88 offen offset:0 lds
    v_mfma_f32_16x16x32_bf16 v[156:159], a[132:135], v[52:55], v[156:159]
    ds_read_b64 v[88:89], v6 offset:26624
    v_perm_b32 v234, v185, v184, s57
    v_mfma_f32_16x16x32_bf16 v[160:163], a[132:135], v[56:59], v[160:163]
    ds_read_b64 v[90:91], v6 offset:27136
    buffer_load_dwordx4 v246, s[32:35], s88 offen offset:1024 lds
    s_waitcnt lgkmcnt(5)
    v_mfma_f32_16x16x32_bf16 v[132:135], a[136:139], v[60:63], v[132:135]
    ds_read_b64 v[44:45], v5 offset:7168
    s_add_u32 m0, s41, 10240
    v_mfma_f32_16x16x32_bf16 v[136:139], a[136:139], v[64:67], v[136:139]
    ds_read_b64 v[46:47], v5 offset:7680
    buffer_load_dwordx4 v245, s[32:35], s89 offen offset:0 lds
    v_mfma_f32_16x16x32_bf16 v[140:143], a[136:139], v[68:71], v[140:143]
    ds_read_b64 v[48:49], v5 offset:27648
    v_perm_b32 v235, v187, v186, s57
    v_mfma_f32_16x16x32_bf16 v[144:147], a[136:139], v[72:75], v[144:147]
    ds_read_b64 v[50:51], v5 offset:28160
    buffer_load_dwordx4 v246, s[32:35], s89 offen offset:1024 lds
    v_mfma_f32_16x16x32_bf16 v[148:151], a[140:143], v[60:63], v[148:151]
    ds_read_b64 v[52:53], v6 offset:7168
    s_add_u32 m0, s41, 12288
    v_mfma_f32_16x16x32_bf16 v[152:155], a[140:143], v[64:67], v[152:155]
    ds_read_b64 v[54:55], v6 offset:7680
    buffer_load_dwordx4 v245, s[32:35], s90 offen offset:0 lds
    v_mfma_f32_16x16x32_bf16 v[156:159], a[140:143], v[68:71], v[156:159]
    ds_read_b64 v[56:57], v6 offset:27648
    v_perm_b32 v236, v189, v188, s57
    v_mfma_f32_16x16x32_bf16 v[160:163], a[140:143], v[72:75], v[160:163]
    ds_read_b64 v[58:59], v6 offset:28160
    buffer_load_dwordx4 v246, s[32:35], s90 offen offset:1024 lds
    s_waitcnt lgkmcnt(6)
    v_mfma_f32_16x16x32_bf16 v[132:135], a[144:147], v[76:79], v[132:135]
    ds_read_b64 v[60:61], v5 offset:8192
    v_perm_b32 v237, v191, v190, s57
    v_mfma_f32_16x16x32_bf16 v[136:139], a[144:147], v[80:83], v[136:139]
    ds_read_b64 v[62:63], v5 offset:8704
    s_waitcnt vmcnt(12) lgkmcnt(6)
    ds_read_b128 a[0:3], v10 offset:0
    v_mfma_f32_16x16x32_bf16 v[140:143], a[144:147], v[84:87], v[140:143]
    ds_read_b64 v[64:65], v5 offset:28672
    v_perm_b32 v238, v193, v192, s57
    v_mfma_f32_16x16x32_bf16 v[144:147], a[144:147], v[88:91], v[144:147]
    ds_read_b64 v[66:67], v5 offset:29184
    ds_read_b128 a[4:7], v11 offset:0
    v_mfma_f32_16x16x32_bf16 v[148:151], a[148:151], v[76:79], v[148:151]
    ds_read_b64 v[68:69], v6 offset:8192
    s_add_u32 m0, s41, 0
    v_mfma_f32_16x16x32_bf16 v[152:155], a[148:151], v[80:83], v[152:155]
    ds_read_b64 v[70:71], v6 offset:8704
    s_waitcnt vmcnt(10) lgkmcnt(2)
    v_mfma_f32_16x16x32_bf16 v[156:159], a[148:151], v[84:87], v[156:159]
    ds_read_b64 v[72:73], v6 offset:28672
    v_perm_b32 v239, v195, v194, s57
    v_mfma_f32_16x16x32_bf16 v[160:163], a[148:151], v[88:91], v[160:163]
    ds_read_b64 v[74:75], v6 offset:29184
    buffer_load_dwordx4 v245, s[32:35], s91 offen offset:0 lds
    v_mfma_f32_16x16x32_bf16 v[132:135], a[152:155], v[44:47], v[132:135]
    ds_read_b64 v[76:77], v5 offset:9216
    v_mfma_f32_16x16x32_bf16 v[136:139], a[152:155], v[48:51], v[136:139]
    ds_read_b64 v[78:79], v5 offset:9728
    ds_read_b128 a[8:11], v10 offset:2048
    v_mfma_f32_16x16x32_bf16 v[140:143], a[152:155], v[52:55], v[140:143]
    ds_read_b64 v[80:81], v5 offset:29696
    v_mfma_f32_16x16x32_bf16 v[144:147], a[152:155], v[56:59], v[144:147]
    ds_read_b64 v[82:83], v5 offset:30208
    ds_read_b128 a[12:15], v11 offset:2048
    v_mfma_f32_16x16x32_bf16 v[148:151], a[156:159], v[44:47], v[148:151]
    ds_read_b64 v[84:85], v6 offset:9216
    v_mfma_f32_16x16x32_bf16 v[152:155], a[156:159], v[48:51], v[152:155]
    ds_read_b64 v[86:87], v6 offset:9728
    buffer_load_dwordx4 v246, s[32:35], s91 offen offset:1024 lds
    v_mfma_f32_16x16x32_bf16 v[156:159], a[156:159], v[52:55], v[156:159]
    ds_read_b64 v[88:89], v6 offset:29696
    v_add_u32 v247, 128, v245
    v_mfma_f32_16x16x32_bf16 v[160:163], a[156:159], v[56:59], v[160:163]
    ds_read_b64 v[90:91], v6 offset:30208
    v_bfi_b32 v245, s40, v247, v245
    v_bfi_b32 v246, s40, v247, v246
    s_waitcnt lgkmcnt(7)
    v_mfma_f32_16x16x32_bf16 v[132:135], a[160:163], v[60:63], v[132:135]
    ds_read_b64 v[44:45], v5 offset:10240
    s_add_u32 m0, s41, 2048
    v_mfma_f32_16x16x32_bf16 v[136:139], a[160:163], v[64:67], v[136:139]
    ds_read_b64 v[46:47], v5 offset:10752
    s_waitcnt vmcnt(10) lgkmcnt(6)
    v_mfma_f32_16x16x32_bf16 v[140:143], a[160:163], v[68:71], v[140:143]
    ds_read_b64 v[48:49], v5 offset:30720
    v_mfma_f32_16x16x32_bf16 v[144:147], a[160:163], v[72:75], v[144:147]
    ds_read_b64 v[50:51], v5 offset:31232
    buffer_load_dwordx4 v245, s[32:35], s88 offen offset:0 lds
    v_mfma_f32_16x16x32_bf16 v[148:151], a[164:167], v[60:63], v[148:151]
    ds_read_b64 v[52:53], v6 offset:10240
    v_mfma_f32_16x16x32_bf16 v[152:155], a[164:167], v[64:67], v[152:155]
    ds_read_b64 v[54:55], v6 offset:10752
    ds_read_b128 a[16:19], v10 offset:4096
    v_mfma_f32_16x16x32_bf16 v[156:159], a[164:167], v[68:71], v[156:159]
    ds_read_b64 v[56:57], v6 offset:30720
    v_mfma_f32_16x16x32_bf16 v[160:163], a[164:167], v[72:75], v[160:163]
    ds_read_b64 v[58:59], v6 offset:31232
    ds_read_b128 a[20:23], v11 offset:4096
    s_waitcnt lgkmcnt(8)
    v_mfma_f32_16x16x32_bf16 v[132:135], a[168:171], v[76:79], v[132:135]
    ds_read_b64 v[60:61], v5 offset:11264
    v_mfma_f32_16x16x32_bf16 v[136:139], a[168:171], v[80:83], v[136:139]
    ds_read_b64 v[62:63], v5 offset:11776
    buffer_load_dwordx4 v246, s[32:35], s88 offen offset:1024 lds
    v_mfma_f32_16x16x32_bf16 v[140:143], a[168:171], v[84:87], v[140:143]
    ds_read_b64 v[64:65], v5 offset:31744
    s_add_u32 m0, s41, 4096
    v_mfma_f32_16x16x32_bf16 v[144:147], a[168:171], v[88:91], v[144:147]
    ds_read_b64 v[66:67], v5 offset:32256
    s_waitcnt vmcnt(10) lgkmcnt(4)
    v_mfma_f32_16x16x32_bf16 v[148:151], a[172:175], v[76:79], v[148:151]
    ds_read_b64 v[68:69], v6 offset:11264
    v_mfma_f32_16x16x32_bf16 v[152:155], a[172:175], v[80:83], v[152:155]
    ds_read_b64 v[70:71], v6 offset:11776
    buffer_load_dwordx4 v245, s[32:35], s89 offen offset:0 lds
    v_mfma_f32_16x16x32_bf16 v[156:159], a[172:175], v[84:87], v[156:159]
    ds_read_b64 v[72:73], v6 offset:31744
    v_mfma_f32_16x16x32_bf16 v[160:163], a[172:175], v[88:91], v[160:163]
    ds_read_b64 v[74:75], v6 offset:32256
    ds_read_b128 a[24:27], v10 offset:6144
    v_mfma_f32_16x16x32_bf16 v[132:135], a[176:179], v[44:47], v[132:135]
    ds_read_b64 v[76:77], v5 offset:12288
    v_mfma_f32_16x16x32_bf16 v[136:139], a[176:179], v[48:51], v[136:139]
    ds_read_b64 v[78:79], v5 offset:12800
    ds_read_b128 a[28:31], v11 offset:6144
    v_mfma_f32_16x16x32_bf16 v[140:143], a[176:179], v[52:55], v[140:143]
    ds_read_b64 v[80:81], v5 offset:32768
    v_mfma_f32_16x16x32_bf16 v[144:147], a[176:179], v[56:59], v[144:147]
    ds_read_b64 v[82:83], v5 offset:33280
    buffer_load_dwordx4 v246, s[32:35], s89 offen offset:1024 lds
    v_mfma_f32_16x16x32_bf16 v[148:151], a[180:183], v[44:47], v[148:151]
    ds_read_b64 v[84:85], v6 offset:12288
    s_add_u32 m0, s41, 6144
    v_mfma_f32_16x16x32_bf16 v[152:155], a[180:183], v[48:51], v[152:155]
    ds_read_b64 v[86:87], v6 offset:12800
    s_waitcnt vmcnt(10) lgkmcnt(4)
    v_mfma_f32_16x16x32_bf16 v[156:159], a[180:183], v[52:55], v[156:159]
    ds_read_b64 v[88:89], v6 offset:32768
    v_mfma_f32_16x16x32_bf16 v[160:163], a[180:183], v[56:59], v[160:163]
    ds_read_b64 v[90:91], v6 offset:33280
    buffer_load_dwordx4 v245, s[32:35], s90 offen offset:0 lds
    v_mfma_f32_16x16x32_bf16 v[132:135], a[184:187], v[60:63], v[132:135]
    ds_read_b64 v[44:45], v5 offset:13312
    v_mfma_f32_16x16x32_bf16 v[136:139], a[184:187], v[64:67], v[136:139]
    ds_read_b64 v[46:47], v5 offset:13824
    ds_read_b128 a[32:35], v10 offset:8192
    v_mfma_f32_16x16x32_bf16 v[140:143], a[184:187], v[68:71], v[140:143]
    ds_read_b64 v[48:49], v5 offset:33792
    v_mfma_f32_16x16x32_bf16 v[144:147], a[184:187], v[72:75], v[144:147]
    ds_read_b64 v[50:51], v5 offset:34304
    ds_read_b128 a[36:39], v11 offset:8192
    v_mfma_f32_16x16x32_bf16 v[148:151], a[188:191], v[60:63], v[148:151]
    ds_read_b64 v[52:53], v6 offset:13312
    v_mfma_f32_16x16x32_bf16 v[152:155], a[188:191], v[64:67], v[152:155]
    ds_read_b64 v[54:55], v6 offset:13824
    buffer_load_dwordx4 v[164:167], v172, s[4:7], s55 offen offset:0 sc1
    v_mfma_f32_16x16x32_bf16 v[156:159], a[188:191], v[68:71], v[156:159]
    ds_read_b64 v[56:57], v6 offset:33792
    v_mfma_f32_16x16x32_bf16 v[160:163], a[188:191], v[72:75], v[160:163]
    ds_read_b64 v[58:59], v6 offset:34304
    buffer_load_dwordx4 v[168:171], v172, s[4:7], s55 offen offset:1024 sc1
    s_waitcnt lgkmcnt(7)
    v_mfma_f32_16x16x32_bf16 v[132:135], a[192:195], v[76:79], v[132:135]
    ds_read_b64 v[60:61], v5 offset:14336
    v_mfma_f32_16x16x32_bf16 v[136:139], a[192:195], v[80:83], v[136:139]
    ds_read_b64 v[62:63], v5 offset:14848
    buffer_load_dwordx4 v246, s[32:35], s90 offen offset:1024 lds
    v_mfma_f32_16x16x32_bf16 v[140:143], a[192:195], v[84:87], v[140:143]
    ds_read_b64 v[64:65], v5 offset:34816
    s_add_u32 m0, s41, 8192
    v_mfma_f32_16x16x32_bf16 v[144:147], a[192:195], v[88:91], v[144:147]
    ds_read_b64 v[66:67], v5 offset:35328
    s_waitcnt vmcnt(12) lgkmcnt(6)
    v_mfma_f32_16x16x32_bf16 v[148:151], a[196:199], v[76:79], v[148:151]
    ds_read_b64 v[68:69], v6 offset:14336
    v_mfma_f32_16x16x32_bf16 v[152:155], a[196:199], v[80:83], v[152:155]
    ds_read_b64 v[70:71], v6 offset:14848
    buffer_load_dwordx4 v245, s[32:35], s91 offen offset:0 lds
    v_mfma_f32_16x16x32_bf16 v[156:159], a[196:199], v[84:87], v[156:159]
    ds_read_b64 v[72:73], v6 offset:34816
    v_mfma_f32_16x16x32_bf16 v[160:163], a[196:199], v[88:91], v[160:163]
    ds_read_b64 v[74:75], v6 offset:35328
    ds_read_b128 a[40:43], v10 offset:10240
    s_waitcnt lgkmcnt(7)
    v_mfma_f32_16x16x32_bf16 v[132:135], a[200:203], v[44:47], v[132:135]
    ds_read_b64 v[76:77], v5 offset:15360
    v_mfma_f32_16x16x32_bf16 v[136:139], a[200:203], v[48:51], v[136:139]
    ds_read_b64 v[78:79], v5 offset:15872
    ds_read_b128 a[44:47], v11 offset:10240
    v_mfma_f32_16x16x32_bf16 v[140:143], a[200:203], v[52:55], v[140:143]
    ds_read_b64 v[80:81], v5 offset:35840
    v_mfma_f32_16x16x32_bf16 v[144:147], a[200:203], v[56:59], v[144:147]
    ds_read_b64 v[82:83], v5 offset:36352
    buffer_load_dwordx4 v246, s[32:35], s91 offen offset:1024 lds
    v_mfma_f32_16x16x32_bf16 v[148:151], a[204:207], v[44:47], v[148:151]
    ds_read_b64 v[84:85], v6 offset:15360
    v_add_u32 v247, 128, v245
    v_mfma_f32_16x16x32_bf16 v[152:155], a[204:207], v[48:51], v[152:155]
    ds_read_b64 v[86:87], v6 offset:15872
    v_bfi_b32 v245, s40, v247, v245
    v_bfi_b32 v246, s40, v247, v246
    v_mfma_f32_16x16x32_bf16 v[156:159], a[204:207], v[52:55], v[156:159]
    ds_read_b64 v[88:89], v6 offset:35840
    s_add_u32 m0, s41, 10240
    v_mfma_f32_16x16x32_bf16 v[160:163], a[204:207], v[56:59], v[160:163]
    ds_read_b64 v[90:91], v6 offset:36352
    s_waitcnt vmcnt(12) lgkmcnt(6)
    buffer_load_dwordx4 v245, s[32:35], s88 offen offset:0 lds
    ds_read_b128 a[48:51], v10 offset:12288
    ds_read_b128 a[52:55], v11 offset:12288
    s_waitcnt vmcnt(5)
    v_min3_u32 v3, v165, v167, v13
    s_waitcnt vmcnt(4) lgkmcnt(7)
    v_min3_u32 v3, v3, v169, v171
    v_max3_u32 v4, v165, v167, v13
    v_max3_u32 v4, v4, v169, v171
    v_cmp_ne_u32 vcc, v3, v4
    s_nop 0
    s_cbranch_vccnz L_adaL_slow_26
L_adaL_got_28:
    v_add_f32 v164, v164, v168
    v_add_f32 v166, v166, v170
    v_mov_b32 v165, v164
    v_mov_b32 v167, v166
    s_nop 0
    v_permlane16_swap_b32 v164, v165
    buffer_load_dwordx4 v246, s[32:35], s88 offen offset:1024 lds
    v_permlane16_swap_b32 v166, v167
    v_add_f32 v164, v164, v165
    v_add_f32 v166, v166, v167
    v_mov_b32 v165, v164
    v_mov_b32 v167, v166
    s_add_u32 m0, s41, 12288
    s_waitcnt lgkmcnt(0)
    buffer_load_dwordx4 v245, s[32:35], s89 offen offset:0 lds
    ds_read_b128 a[56:59], v10 offset:0
    ds_read_b128 a[60:63], v11 offset:0
    v_permlane32_swap_b32 v164, v165
    v_permlane32_swap_b32 v166, v167
    v_add_f32 v164, v164, v165
    v_add_f32 v166, v166, v167
    v_mul_f32 v216, 0xba97b426, v164
    buffer_load_dwordx4 v246, s[32:35], s89 offen offset:1024 lds
    v_mul_f32 v217, 0x3a97b426, v166
    v_fma_f32 v217, -v216, v216, v217
    v_max_f32 v217, 0, v217
    v_add_f32 v217, 0x3727c5ac, v217
    v_rsq_f32 v217, v217
    s_add_u32 m0, s41, 0
    s_waitcnt lgkmcnt(0)
    buffer_load_dwordx4 v245, s[32:35], s90 offen offset:0 lds
    ds_read_b128 a[64:67], v10 offset:2048
    ds_read_b128 a[68:71], v11 offset:2048
    s_lshl_b32 s64, s82, 6
    s_add_u32 s64, s64, 82432
    v_add_u32 v3, s64, v12
    v_mul_f32 v216, v216, v217
    ds_write2st64_b32 v3, v217, v216 offset0:0 offset1:1
    v_add_u32 v3, 82432, v7
    s_waitcnt lgkmcnt(0)
    s_barrier
    ds_read_b128 v[164:167], v3 offset:0
    buffer_load_dwordx4 v246, s[32:35], s90 offen offset:1024 lds
    ds_read_b128 v[180:183], v3 offset:256
    ds_read_b128 v[168:171], v3 offset:64
    ds_read_b128 v[184:187], v3 offset:320
    ds_read_b128 v[172:175], v3 offset:128
    ds_read_b128 v[188:191], v3 offset:384
    s_add_u32 m0, s41, 2048
    s_nop 0
    buffer_load_dwordx4 v245, s[32:35], s91 offen offset:0 lds
    ds_read_b128 a[72:75], v10 offset:4096
    ds_read_b128 a[76:79], v11 offset:4096
    ds_read_b128 v[176:179], v3 offset:192
    ds_read_b128 v[192:195], v3 offset:448
    s_mul_i32 s56, s84, 458752
    s_add_u32 s56, s56, 12582912
    s_lshl_b32 s64, s82, 17
    s_add_u32 s64, s64, s56
    s_lshl_b32 s65, s83, 11
    s_add_u32 s64, s64, s65
    v_add_u32 v4, 45056, v242
    s_waitcnt lgkmcnt(8)
    v_pk_fma_f32 v[100:101], v[100:101], v[164:165], v[180:181]
    v_pk_fma_f32 v[102:103], v[102:103], v[166:167], v[182:183]
    buffer_load_dwordx4 v246, s[32:35], s91 offen offset:1024 lds
    v_add_u32 v247, 128, v245
    v_bfi_b32 v245, s40, v247, v245
    v_bfi_b32 v246, s40, v247, v246
    s_waitcnt lgkmcnt(6)
    v_pk_fma_f32 v[104:105], v[104:105], v[168:169], v[184:185]
    v_pk_fma_f32 v[106:107], v[106:107], v[170:171], v[186:187]
    v_cvt_pk_bf16_f32 v216, v100, v104
    v_cvt_pk_bf16_f32 v217, v101, v105
    v_cvt_pk_bf16_f32 v218, v102, v106
    s_add_u32 m0, s41, 4096
    s_waitcnt vmcnt(10) lgkmcnt(2)
    buffer_load_dwordx4 v245, s[32:35], s88 offen offset:0 lds
    ds_read_b128 a[80:83], v10 offset:6144
    ds_read_b128 a[84:87], v11 offset:6144
    v_cvt_pk_bf16_f32 v219, v103, v107
    buffer_store_dwordx4 v[216:219], v241, s[4:7], s64 offen offset:0 sc1
    v_pk_fma_f32 v[116:117], v[116:117], v[164:165], v[180:181]
    v_pk_fma_f32 v[118:119], v[118:119], v[166:167], v[182:183]
    v_pk_fma_f32 v[120:121], v[120:121], v[168:169], v[184:185]
    buffer_load_dwordx4 v246, s[32:35], s88 offen offset:1024 lds
    v_pk_fma_f32 v[122:123], v[122:123], v[170:171], v[186:187]
    v_cvt_pk_bf16_f32 v220, v116, v120
    v_cvt_pk_bf16_f32 v221, v117, v121
    v_cvt_pk_bf16_f32 v222, v118, v122
    v_cvt_pk_bf16_f32 v223, v119, v123
    s_add_u32 m0, s41, 6144
    s_waitcnt vmcnt(11) lgkmcnt(0)
    buffer_load_dwordx4 v245, s[32:35], s89 offen offset:0 lds
    ds_read_b128 a[88:91], v10 offset:8192
    ds_read_b128 a[92:95], v11 offset:8192
    buffer_store_dwordx4 v[220:223], v4, s[4:7], s64 offen offset:0 sc1
    v_pk_fma_f32 v[108:109], v[108:109], v[172:173], v[188:189]
    v_pk_fma_f32 v[110:111], v[110:111], v[174:175], v[190:191]
    v_pk_fma_f32 v[112:113], v[112:113], v[176:177], v[192:193]
    v_pk_fma_f32 v[114:115], v[114:115], v[178:179], v[194:195]
    buffer_load_dwordx4 v246, s[32:35], s89 offen offset:1024 lds
    v_cvt_pk_bf16_f32 v216, v108, v112
    v_cvt_pk_bf16_f32 v217, v109, v113
    v_cvt_pk_bf16_f32 v218, v110, v114
    v_cvt_pk_bf16_f32 v219, v111, v115
    buffer_store_dwordx4 v[216:219], v241, s[4:7], s64 offen offset:1024 sc1
    s_add_u32 m0, s41, 8192
    s_waitcnt vmcnt(13) lgkmcnt(0)
    buffer_load_dwordx4 v245, s[32:35], s90 offen offset:0 lds
    ds_read_b128 a[96:99], v10 offset:10240
    ds_read_b128 a[100:103], v11 offset:10240
    v_pk_fma_f32 v[124:125], v[124:125], v[172:173], v[188:189]
    v_pk_fma_f32 v[126:127], v[126:127], v[174:175], v[190:191]
    v_pk_fma_f32 v[128:129], v[128:129], v[176:177], v[192:193]
    v_pk_fma_f32 v[130:131], v[130:131], v[178:179], v[194:195]
    v_cvt_pk_bf16_f32 v220, v124, v128
    buffer_load_dwordx4 v246, s[32:35], s90 offen offset:1024 lds
    v_cvt_pk_bf16_f32 v221, v125, v129
    v_cvt_pk_bf16_f32 v222, v126, v130
    v_cvt_pk_bf16_f32 v223, v127, v131
    buffer_store_dwordx4 v[220:223], v4, s[4:7], s64 offen offset:1024 sc1
    v_mfma_f32_16x16x32_bf16 v[132:135], a[208:211], v[60:63], v[132:135]
    ds_read_b64 v[44:45], v5 offset:16384
    s_add_u32 m0, s41, 10240
    v_mfma_f32_16x16x32_bf16 v[136:139], a[208:211], v[64:67], v[136:139]
    ds_read_b64 v[46:47], v5 offset:16896
    s_waitcnt vmcnt(14) lgkmcnt(2)
    v_mfma_f32_16x16x32_bf16 v[140:143], a[208:211], v[68:71], v[140:143]
    ds_read_b64 v[48:49], v5 offset:36864
    s_mul_i32 s57, s84, 10
    v_mfma_f32_16x16x32_bf16 v[144:147], a[208:211], v[72:75], v[144:147]
    ds_read_b64 v[50:51], v5 offset:37376
    buffer_load_dwordx4 v245, s[32:35], s91 offen offset:0 lds
    v_mfma_f32_16x16x32_bf16 v[148:151], a[212:215], v[60:63], v[148:151]
    ds_read_b64 v[52:53], v6 offset:16384
    v_add_u32 v92, s57, v2
    v_mfma_f32_16x16x32_bf16 v[152:155], a[212:215], v[64:67], v[152:155]
    ds_read_b64 v[54:55], v6 offset:16896
    ds_read_b128 a[104:107], v10 offset:12288
    v_mfma_f32_16x16x32_bf16 v[156:159], a[212:215], v[68:71], v[156:159]
    ds_read_b64 v[56:57], v6 offset:36864
    v_lshrrev_b32 v93, 2, v92
    v_mfma_f32_16x16x32_bf16 v[160:163], a[212:215], v[72:75], v[160:163]
    ds_read_b64 v[58:59], v6 offset:37376
    ds_read_b128 a[108:111], v11 offset:12288
    v_mfma_f32_16x16x32_bf16 v[132:135], a[216:219], v[76:79], v[132:135]
    ds_read_b64 v[60:61], v5 offset:17408
    v_and_b32 v92, 3, v92
    v_mfma_f32_16x16x32_bf16 v[136:139], a[216:219], v[80:83], v[136:139]
    ds_read_b64 v[62:63], v5 offset:17920
    buffer_load_dwordx4 v246, s[32:35], s91 offen offset:1024 lds
    v_mfma_f32_16x16x32_bf16 v[140:143], a[216:219], v[84:87], v[140:143]
    ds_read_b64 v[64:65], v5 offset:37888
    v_add_u32 v247, 128, v245
    v_mfma_f32_16x16x32_bf16 v[144:147], a[216:219], v[88:91], v[144:147]
    ds_read_b64 v[66:67], v5 offset:38400
    v_bfi_b32 v245, s40, v247, v245
    v_bfi_b32 v246, s40, v247, v246
    v_mfma_f32_16x16x32_bf16 v[148:151], a[220:223], v[76:79], v[148:151]
    ds_read_b64 v[68:69], v6 offset:17408
    s_add_u32 m0, s41, 12288
    v_mfma_f32_16x16x32_bf16 v[152:155], a[220:223], v[80:83], v[152:155]
    ds_read_b64 v[70:71], v6 offset:17920
    s_waitcnt vmcnt(14) lgkmcnt(5)
    v_mfma_f32_16x16x32_bf16 v[156:159], a[220:223], v[84:87], v[156:159]
    ds_read_b64 v[72:73], v6 offset:37888
    v_lshlrev_b32 v92, 7, v92
    v_mfma_f32_16x16x32_bf16 v[160:163], a[220:223], v[88:91], v[160:163]
    ds_read_b64 v[74:75], v6 offset:38400
    buffer_load_dwordx4 v245, s[32:35], s88 offen offset:0 lds
    v_mfma_f32_16x16x32_bf16 v[132:135], a[224:227], v[44:47], v[132:135]
    ds_read_b64 v[76:77], v5 offset:18432
    v_lshl_add_u32 v92, v93, 10, v92
    v_mfma_f32_16x16x32_bf16 v[136:139], a[224:227], v[48:51], v[136:139]
    ds_read_b64 v[78:79], v5 offset:18944
    ds_read_b128 a[112:115], v10 offset:0
    v_mfma_f32_16x16x32_bf16 v[140:143], a[224:227], v[52:55], v[140:143]
    ds_read_b64 v[80:81], v5 offset:38912
    v_lshl_add_u32 v92, v1, 3, v92
    v_mfma_f32_16x16x32_bf16 v[144:147], a[224:227], v[56:59], v[144:147]
    ds_read_b64 v[82:83], v5 offset:39424
    ds_read_b128 a[116:119], v11 offset:0
    v_mfma_f32_16x16x32_bf16 v[148:151], a[228:231], v[44:47], v[148:151]
    ds_read_b64 v[84:85], v6 offset:18432
    v_add_u32 v92, s53, v92
    v_mfma_f32_16x16x32_bf16 v[152:155], a[228:231], v[48:51], v[152:155]
    ds_read_b64 v[86:87], v6 offset:18944
    ds_read_b64 v[16:17], v92 offset:0
    v_mfma_f32_16x16x32_bf16 v[156:159], a[228:231], v[52:55], v[156:159]
    ds_read_b64 v[88:89], v6 offset:38912
    v_mfma_f32_16x16x32_bf16 v[160:163], a[228:231], v[56:59], v[160:163]
    ds_read_b64 v[90:91], v6 offset:39424
    ds_read_b64 v[18:19], v92 offset:512
    s_waitcnt lgkmcnt(9)
    v_mfma_f32_16x16x32_bf16 v[132:135], a[232:235], v[60:63], v[132:135]
    ds_read_b64 v[44:45], v5 offset:19456
    v_mfma_f32_16x16x32_bf16 v[136:139], a[232:235], v[64:67], v[136:139]
    ds_read_b64 v[46:47], v5 offset:19968
    ds_read_b64 v[20:21], v92 offset:1024
    v_mfma_f32_16x16x32_bf16 v[140:143], a[232:235], v[68:71], v[140:143]
    ds_read_b64 v[48:49], v5 offset:39936
    v_mfma_f32_16x16x32_bf16 v[144:147], a[232:235], v[72:75], v[144:147]
    ds_read_b64 v[50:51], v5 offset:40448
    ds_read_b64 v[22:23], v92 offset:1536
    v_mfma_f32_16x16x32_bf16 v[148:151], a[236:239], v[60:63], v[148:151]
    ds_read_b64 v[52:53], v6 offset:19456
    v_lshrrev_b32 v92, 1, v2
    v_mfma_f32_16x16x32_bf16 v[152:155], a[236:239], v[64:67], v[152:155]
    ds_read_b64 v[54:55], v6 offset:19968
    buffer_load_dwordx4 v246, s[32:35], s88 offen offset:1024 lds
    v_mfma_f32_16x16x32_bf16 v[156:159], a[236:239], v[68:71], v[156:159]
    ds_read_b64 v[56:57], v6 offset:39936
    s_add_u32 m0, s41, 0
    v_mfma_f32_16x16x32_bf16 v[160:163], a[236:239], v[72:75], v[160:163]
    ds_read_b64 v[58:59], v6 offset:40448
    s_waitcnt vmcnt(14) lgkmcnt(7)
    v_mfma_f32_16x16x32_bf16 v[132:135], a[240:243], v[76:79], v[132:135]
    buffer_load_dwordx4 v245, s[32:35], s89 offen offset:0 lds
    v_mfma_f32_16x16x32_bf16 v[136:139], a[240:243], v[80:83], v[136:139]
    ds_read_b128 a[120:123], v10 offset:2048
    v_mfma_f32_16x16x32_bf16 v[140:143], a[240:243], v[84:87], v[140:143]
    ds_read_b128 a[124:127], v11 offset:2048
    v_mfma_f32_16x16x32_bf16 v[144:147], a[240:243], v[88:91], v[144:147]
    buffer_load_dwordx4 v246, s[32:35], s89 offen offset:1024 lds
    s_add_u32 m0, s41, 2048
    v_mfma_f32_16x16x32_bf16 v[148:151], a[244:247], v[76:79], v[148:151]
    s_waitcnt vmcnt(13) lgkmcnt(0)
    buffer_load_dwordx4 v245, s[32:35], s90 offen offset:0 lds
    v_mfma_f32_16x16x32_bf16 v[152:155], a[244:247], v[80:83], v[152:155]
    ds_read_b128 a[128:131], v10 offset:4096
    v_mfma_f32_16x16x32_bf16 v[156:159], a[244:247], v[84:87], v[156:159]
    ds_read_b128 a[132:135], v11 offset:4096
    v_mfma_f32_16x16x32_bf16 v[160:163], a[244:247], v[88:91], v[160:163]
    v_add3_u32 v92, v92, s57, 8
    v_mfma_f32_16x16x32_bf16 v[132:135], a[248:251], v[44:47], v[132:135]
    buffer_load_dwordx4 v246, s[32:35], s90 offen offset:1024 lds
    s_add_u32 m0, s41, 4096
    v_mfma_f32_16x16x32_bf16 v[136:139], a[248:251], v[48:51], v[136:139]
    s_waitcnt vmcnt(12) lgkmcnt(0)
    buffer_load_dwordx4 v245, s[32:35], s91 offen offset:0 lds
    v_mfma_f32_16x16x32_bf16 v[140:143], a[248:251], v[52:55], v[140:143]
    ds_read_b128 a[136:139], v10 offset:6144
    v_mfma_f32_16x16x32_bf16 v[144:147], a[248:251], v[56:59], v[144:147]
    ds_read_b128 a[140:143], v11 offset:6144
    v_mfma_f32_16x16x32_bf16 v[148:151], a[252:255], v[44:47], v[148:151]
    buffer_load_dwordx4 v246, s[32:35], s91 offen offset:1024 lds
    v_add_u32 v247, 128, v245
    v_mfma_f32_16x16x32_bf16 v[152:155], a[252:255], v[48:51], v[152:155]
    v_bfi_b32 v245, s40, v247, v245
    v_bfi_b32 v246, s40, v247, v246
    v_mfma_f32_16x16x32_bf16 v[156:159], a[252:255], v[52:55], v[156:159]
    v_lshrrev_b32 v93, 2, v92
    v_and_b32 v92, 3, v92
    v_mfma_f32_16x16x32_bf16 v[160:163], a[252:255], v[56:59], v[160:163]
    v_lshlrev_b32 v92, 7, v92
    s_lshl_b32 s64, s84, 5
    s_add_u32 s64, s64, s83
    s_lshl_b32 s64, s64, 5
    s_add_u32 s64, s64, 196608
    s_cmp_lg_u32 s82, 0
    s_cselect_b32 s64, 33554432, s64
    v_mul_u32_u24 v4, 8448, v240
    s_waitcnt vmcnt(10) lgkmcnt(1)
    s_barrier
    s_mov_b64 exec, 15
    buffer_store_dword v13, v4, s[4:7], s64 offen sc1
    s_mov_b64 exec, -1
    v_lshl_add_u32 v92, v93, 10, v92
    v_and_b32 v93, 1, v2
    v_lshl_add_u32 v92, v93, 9, v92
    v_lshl_add_u32 v92, v1, 3, v92
    v_add_u32 v92, s53, v92
    ds_read_b64 v[24:25], v92
    s_lshl_b32 s57, s84, 2
    s_add_u32 s57, s57, s82
    s_lshl_b32 s57, s57, 8
    s_lshr_b32 s58, s83, 3
    s_mul_i32 s58, s58, 8448
    s_add_u32 s57, s57, s58
    s_add_u32 s60, s57, 196608
    v_and_b32 v26, 7, v0
    v_lshlrev_b32 v26, 5, v26
    s_lshl_b32 s57, s82, 14
    s_add_u32 s57, s57, s56
    v_add_u32 v9, s57, v241
    s_mul_i32 s20, s84, 0
    s_add_u32 s21, s20, 2048
    s_and_b32 s21, s21, 0x3fff
    s_add_u32 s22, s21, 2048
    s_and_b32 s22, s22, 0x3fff
    s_add_u32 s23, s22, 2048
    s_and_b32 s23, s23, 0x3fff
    s_add_u32 s24, s23, 2048
    s_and_b32 s24, s24, 0x3fff
    s_add_u32 s25, s24, 2048
    s_and_b32 s25, s25, 0x3fff
    s_add_u32 s26, s25, 2048
    s_and_b32 s26, s26, 0x3fff
    s_add_u32 s27, s26, 2048
    s_and_b32 s27, s27, 0x3fff
    v_lshlrev_b32 v3, 2, v1
    v_add_u32 v3, 81920, v3
    ds_read2_b32 v[164:165], v3 offset0:0 offset1:64
    ds_read2_b32 v[166:167], v3 offset0:16 offset1:80
    ds_read2_b32 v[168:169], v3 offset0:32 offset1:96
    ds_read2_b32 v[170:171], v3 offset0:48 offset1:112
    s_lshl_b32 s64, s82, 10
    s_add_u32 s64, s64, 86528
    v_add_u32_e64 v3, s64, v241
    s_waitcnt lgkmcnt(3)
    v_pk_fma_f32 v[132:133], v[196:197], v[164:165], v[132:133] op_sel:[0,1,0] op_sel_hi:[1,1,1]
    s_add_u32 m0, s41, 6144
    s_nop 0
    buffer_load_dwordx4 v245, s[32:35], s88 offen offset:0 lds
    ds_read_b128 a[144:147], v10 offset:8192
    ds_read_b128 a[148:151], v11 offset:8192
    v_pk_fma_f32 v[134:135], v[198:199], v[164:165], v[134:135] op_sel:[0,1,0] op_sel_hi:[1,1,1]
    v_pk_fma_f32 v[148:149], v[200:201], v[164:165], v[148:149] op_sel:[0,1,0] op_sel_hi:[1,1,1]
    v_pk_fma_f32 v[150:151], v[202:203], v[164:165], v[150:151] op_sel:[0,1,0] op_sel_hi:[1,1,1]
    v_pk_fma_f32 v[132:133], v[132:133], v[164:165], v[204:205] op_sel:[0,0,0] op_sel_hi:[1,0,1]
    v_pk_fma_f32 v[134:135], v[134:135], v[164:165], v[206:207] op_sel:[0,0,0] op_sel_hi:[1,0,1]
    v_pk_fma_f32 v[148:149], v[148:149], v[164:165], v[208:209] op_sel:[0,0,0] op_sel_hi:[1,0,1]
    v_pk_fma_f32 v[150:151], v[150:151], v[164:165], v[210:211] op_sel:[0,0,0] op_sel_hi:[1,0,1]
    v_pk_mul_f32 v[216:217], v[132:133], v[132:133]
    buffer_load_dwordx4 v246, s[32:35], s88 offen offset:1024 lds
    v_pk_mul_f32 v[218:219], v[134:135], v[134:135]
    v_pk_mul_f32 v[220:221], v[148:149], v[148:149]
    v_pk_mul_f32 v[222:223], v[150:151], v[150:151]
    v_pk_fma_f32 v[216:217], v[216:217], s[66:67], s[66:67] op_sel:[0,0,1] op_sel_hi:[1,0,1]
    v_pk_fma_f32 v[218:219], v[218:219], s[66:67], s[66:67] op_sel:[0,0,1] op_sel_hi:[1,0,1]
    v_pk_fma_f32 v[220:221], v[220:221], s[66:67], s[66:67] op_sel:[0,0,1] op_sel_hi:[1,0,1]
    v_pk_fma_f32 v[222:223], v[222:223], s[66:67], s[66:67] op_sel:[0,0,1] op_sel_hi:[1,0,1]
    v_pk_mul_f32 v[216:217], v[216:217], v[132:133]
    s_add_u32 m0, s41, 8192
    s_waitcnt vmcnt(11) lgkmcnt(0)
    buffer_load_dwordx4 v245, s[32:35], s89 offen offset:0 lds
    ds_read_b128 a[152:155], v10 offset:10240
    ds_read_b128 a[156:159], v11 offset:10240
    v_pk_mul_f32 v[218:219], v[218:219], v[134:135]
    v_pk_mul_f32 v[220:221], v[220:221], v[148:149]
    v_pk_mul_f32 v[222:223], v[222:223], v[150:151]
    v_exp_f32 v216, v216
    v_exp_f32 v217, v217
    v_exp_f32 v218, v218
    v_exp_f32 v219, v219
    v_exp_f32 v220, v220
    buffer_load_dwordx4 v246, s[32:35], s89 offen offset:1024 lds
    v_exp_f32 v221, v221
    v_exp_f32 v222, v222
    v_exp_f32 v223, v223
    v_pk_add_f32 v[216:217], v[216:217], s[68:69]
    v_pk_add_f32 v[218:219], v[218:219], s[68:69]
    v_pk_add_f32 v[220:221], v[220:221], s[68:69]
    v_pk_add_f32 v[222:223], v[222:223], s[68:69]
    v_rcp_f32 v216, v216
    s_add_u32 m0, s41, 10240
    s_waitcnt vmcnt(11) lgkmcnt(0)
    buffer_load_dwordx4 v245, s[32:35], s90 offen offset:0 lds
    ds_read_b128 a[160:163], v10 offset:12288
    ds_read_b128 a[164:167], v11 offset:12288
    v_rcp_f32 v217, v217
    v_rcp_f32 v218, v218
    v_rcp_f32 v219, v219
    v_rcp_f32 v220, v220
    v_rcp_f32 v221, v221
    v_rcp_f32 v222, v222
    v_rcp_f32 v223, v223
    v_pk_mul_f32 v[132:133], v[132:133], v[216:217]
    buffer_load_dwordx4 v246, s[32:35], s90 offen offset:1024 lds
    v_pk_mul_f32 v[134:135], v[134:135], v[218:219]
    v_pk_mul_f32 v[148:149], v[148:149], v[220:221]
    v_pk_mul_f32 v[150:151], v[150:151], v[222:223]
    v_cvt_pk_bf16_f32 v180, v132, v148
    v_cvt_pk_bf16_f32 v181, v133, v149
    v_cvt_pk_bf16_f32 v182, v134, v150
    v_cvt_pk_bf16_f32 v183, v135, v151
    ds_write_b128 v3, v[180:183] offset:0
    s_add_u32 m0, s41, 12288
    s_waitcnt vmcnt(11) lgkmcnt(1)
    buffer_load_dwordx4 v245, s[32:35], s91 offen offset:0 lds
    ds_read_b128 a[168:171], v10 offset:0
    ds_read_b128 a[172:175], v11 offset:0
    v_pk_fma_f32 v[136:137], v[196:197], v[166:167], v[136:137] op_sel:[0,1,0] op_sel_hi:[1,1,1]
    v_pk_fma_f32 v[138:139], v[198:199], v[166:167], v[138:139] op_sel:[0,1,0] op_sel_hi:[1,1,1]
    v_pk_fma_f32 v[152:153], v[200:201], v[166:167], v[152:153] op_sel:[0,1,0] op_sel_hi:[1,1,1]
    v_pk_fma_f32 v[154:155], v[202:203], v[166:167], v[154:155] op_sel:[0,1,0] op_sel_hi:[1,1,1]
    v_pk_fma_f32 v[136:137], v[136:137], v[166:167], v[204:205] op_sel:[0,0,0] op_sel_hi:[1,0,1]
    v_pk_fma_f32 v[138:139], v[138:139], v[166:167], v[206:207] op_sel:[0,0,0] op_sel_hi:[1,0,1]
    v_pk_fma_f32 v[152:153], v[152:153], v[166:167], v[208:209] op_sel:[0,0,0] op_sel_hi:[1,0,1]
    v_pk_fma_f32 v[154:155], v[154:155], v[166:167], v[210:211] op_sel:[0,0,0] op_sel_hi:[1,0,1]
    buffer_load_dwordx4 v246, s[32:35], s91 offen offset:1024 lds
    v_add_u32 v247, 128, v245
    v_bfi_b32 v245, s40, v247, v245
    v_bfi_b32 v246, s40, v247, v246
    v_pk_mul_f32 v[216:217], v[136:137], v[136:137]
    v_pk_mul_f32 v[218:219], v[138:139], v[138:139]
    v_pk_mul_f32 v[220:221], v[152:153], v[152:153]
    v_pk_mul_f32 v[222:223], v[154:155], v[154:155]
    v_pk_fma_f32 v[216:217], v[216:217], s[66:67], s[66:67] op_sel:[0,0,1] op_sel_hi:[1,0,1]
    v_pk_fma_f32 v[218:219], v[218:219], s[66:67], s[66:67] op_sel:[0,0,1] op_sel_hi:[1,0,1]
    v_pk_fma_f32 v[220:221], v[220:221], s[66:67], s[66:67] op_sel:[0,0,1] op_sel_hi:[1,0,1]
    v_pk_fma_f32 v[222:223], v[222:223], s[66:67], s[66:67] op_sel:[0,0,1] op_sel_hi:[1,0,1]
    s_add_u32 m0, s41, 0
    s_waitcnt vmcnt(11) lgkmcnt(0)
    buffer_load_dwordx4 v245, s[32:35], s88 offen offset:0 lds
    ds_read_b128 a[176:179], v10 offset:2048
    ds_read_b128 a[180:183], v11 offset:2048
    v_pk_mul_f32 v[216:217], v[216:217], v[136:137]
    v_pk_mul_f32 v[218:219], v[218:219], v[138:139]
    v_pk_mul_f32 v[220:221], v[220:221], v[152:153]
    v_pk_mul_f32 v[222:223], v[222:223], v[154:155]
    v_exp_f32 v216, v216
    v_exp_f32 v217, v217
    v_exp_f32 v218, v218
    v_exp_f32 v219, v219
    buffer_load_dwordx4 v246, s[32:35], s88 offen offset:1024 lds
    v_exp_f32 v220, v220
    v_exp_f32 v221, v221
    v_exp_f32 v222, v222
    v_exp_f32 v223, v223
    v_pk_add_f32 v[216:217], v[216:217], s[68:69]
    v_pk_add_f32 v[218:219], v[218:219], s[68:69]
    v_pk_add_f32 v[220:221], v[220:221], s[68:69]
    v_pk_add_f32 v[222:223], v[222:223], s[68:69]
    s_add_u32 m0, s41, 2048
    s_waitcnt vmcnt(11) lgkmcnt(0)
    buffer_load_dwordx4 v245, s[32:35], s89 offen offset:0 lds
    ds_read_b128 a[184:187], v10 offset:4096
    ds_read_b128 a[188:191], v11 offset:4096
    v_rcp_f32 v216, v216
    v_rcp_f32 v217, v217
    v_rcp_f32 v218, v218
    v_rcp_f32 v219, v219
    v_rcp_f32 v220, v220
    v_rcp_f32 v221, v221
    v_rcp_f32 v222, v222
    v_rcp_f32 v223, v223
    buffer_load_dwordx4 v246, s[32:35], s89 offen offset:1024 lds
    v_pk_mul_f32 v[136:137], v[136:137], v[216:217]
    v_pk_mul_f32 v[138:139], v[138:139], v[218:219]
    v_pk_mul_f32 v[152:153], v[152:153], v[220:221]
    v_pk_mul_f32 v[154:155], v[154:155], v[222:223]
    v_cvt_pk_bf16_f32 v184, v136, v152
    v_cvt_pk_bf16_f32 v185, v137, v153
    v_cvt_pk_bf16_f32 v186, v138, v154
    v_cvt_pk_bf16_f32 v187, v139, v155
    s_add_u32 m0, s41, 4096
    s_waitcnt vmcnt(10) lgkmcnt(0)
    buffer_load_dwordx4 v245, s[32:35], s90 offen offset:0 lds
    ds_read_b128 a[192:195], v10 offset:6144
    ds_read_b128 a[196:199], v11 offset:6144
    ds_write_b128 v3, v[184:187] offset:4096
    buffer_load_dword v27, v26, s[4:7], s60 offen sc1
    v_pk_fma_f32 v[140:141], v[196:197], v[168:169], v[140:141] op_sel:[0,1,0] op_sel_hi:[1,1,1]
    v_pk_fma_f32 v[142:143], v[198:199], v[168:169], v[142:143] op_sel:[0,1,0] op_sel_hi:[1,1,1]
    v_pk_fma_f32 v[156:157], v[200:201], v[168:169], v[156:157] op_sel:[0,1,0] op_sel_hi:[1,1,1]
    v_pk_fma_f32 v[158:159], v[202:203], v[168:169], v[158:159] op_sel:[0,1,0] op_sel_hi:[1,1,1]
    v_pk_fma_f32 v[140:141], v[140:141], v[168:169], v[204:205] op_sel:[0,0,0] op_sel_hi:[1,0,1]
    v_pk_fma_f32 v[142:143], v[142:143], v[168:169], v[206:207] op_sel:[0,0,0] op_sel_hi:[1,0,1]
    buffer_load_dwordx4 v246, s[32:35], s90 offen offset:1024 lds
    v_pk_fma_f32 v[156:157], v[156:157], v[168:169], v[208:209] op_sel:[0,0,0] op_sel_hi:[1,0,1]
    v_pk_fma_f32 v[158:159], v[158:159], v[168:169], v[210:211] op_sel:[0,0,0] op_sel_hi:[1,0,1]
    v_pk_mul_f32 v[216:217], v[140:141], v[140:141]
    v_pk_mul_f32 v[218:219], v[142:143], v[142:143]
    v_pk_mul_f32 v[220:221], v[156:157], v[156:157]
    v_pk_mul_f32 v[222:223], v[158:159], v[158:159]
    v_pk_fma_f32 v[216:217], v[216:217], s[66:67], s[66:67] op_sel:[0,0,1] op_sel_hi:[1,0,1]
    v_pk_fma_f32 v[218:219], v[218:219], s[66:67], s[66:67] op_sel:[0,0,1] op_sel_hi:[1,0,1]
    s_add_u32 m0, s41, 6144
    s_waitcnt vmcnt(11) lgkmcnt(1)
    buffer_load_dwordx4 v245, s[32:35], s91 offen offset:0 lds
    ds_read_b128 a[200:203], v10 offset:8192
    ds_read_b128 a[204:207], v11 offset:8192
    v_pk_fma_f32 v[220:221], v[220:221], s[66:67], s[66:67] op_sel:[0,0,1] op_sel_hi:[1,0,1]
    v_pk_fma_f32 v[222:223], v[222:223], s[66:67], s[66:67] op_sel:[0,0,1] op_sel_hi:[1,0,1]
    v_pk_mul_f32 v[216:217], v[216:217], v[140:141]
    v_pk_mul_f32 v[218:219], v[218:219], v[142:143]
    v_pk_mul_f32 v[220:221], v[220:221], v[156:157]
    v_pk_mul_f32 v[222:223], v[222:223], v[158:159]
    v_exp_f32 v216, v216
    v_exp_f32 v217, v217
    buffer_load_dwordx4 v246, s[32:35], s91 offen offset:1024 lds
    v_exp_f32 v218, v218
    v_exp_f32 v219, v219
    v_exp_f32 v220, v220
    v_exp_f32 v221, v221
    v_exp_f32 v222, v222
    v_exp_f32 v223, v223
    v_pk_add_f32 v[216:217], v[216:217], s[68:69]
    v_pk_add_f32 v[218:219], v[218:219], s[68:69]
    s_waitcnt vmcnt(11) lgkmcnt(2)
    ds_read_b128 a[208:211], v10 offset:10240
    ds_read_b128 a[212:215], v11 offset:10240
    v_pk_add_f32 v[220:221], v[220:221], s[68:69]
    v_pk_add_f32 v[222:223], v[222:223], s[68:69]
    v_rcp_f32 v216, v216
    v_rcp_f32 v217, v217
    v_rcp_f32 v218, v218
    v_rcp_f32 v219, v219
    v_rcp_f32 v220, v220
    v_rcp_f32 v221, v221
    s_waitcnt vmcnt(9) lgkmcnt(2)
    ds_read_b128 a[216:219], v10 offset:12288
    ds_read_b128 a[220:223], v11 offset:12288
    v_rcp_f32 v222, v222
    v_rcp_f32 v223, v223
    v_pk_mul_f32 v[140:141], v[140:141], v[216:217]
    v_pk_mul_f32 v[142:143], v[142:143], v[218:219]
    v_pk_mul_f32 v[156:157], v[156:157], v[220:221]
    v_pk_mul_f32 v[158:159], v[158:159], v[222:223]
    v_cvt_pk_bf16_f32 v188, v140, v156
    v_cvt_pk_bf16_f32 v189, v141, v157
    s_waitcnt vmcnt(7)
    ds_read_b128 a[224:227], v10 offset:0
    ds_read_b128 a[228:231], v11 offset:0
    v_cvt_pk_bf16_f32 v190, v142, v158
    v_cvt_pk_bf16_f32 v191, v143, v159
    ds_write_b128 v3, v[188:191] offset:8192
    v_pk_fma_f32 v[144:145], v[196:197], v[170:171], v[144:145] op_sel:[0,1,0] op_sel_hi:[1,1,1]
    v_pk_fma_f32 v[146:147], v[198:199], v[170:171], v[146:147] op_sel:[0,1,0] op_sel_hi:[1,1,1]
    v_pk_fma_f32 v[160:161], v[200:201], v[170:171], v[160:161] op_sel:[0,1,0] op_sel_hi:[1,1,1]
    v_pk_fma_f32 v[162:163], v[202:203], v[170:171], v[162:163] op_sel:[0,1,0] op_sel_hi:[1,1,1]
    v_pk_fma_f32 v[144:145], v[144:145], v[170:171], v[204:205] op_sel:[0,0,0] op_sel_hi:[1,0,1]
    s_mov_b32 s49, 65536
    s_waitcnt vmcnt(3)
    v_cmp_ne_u32 vcc, s48, v27
    s_nop 0
    s_cbranch_vccz L_adaL_got_31
L_adaL_poll_30:
    buffer_load_dword v27, v26, s[4:7], s60 offen sc1
    s_waitcnt vmcnt(0)
    s_sub_u32 s49, s49, 1
    s_cbranch_scc1 L_adaL_got_31
    v_cmp_ne_u32 vcc, s48, v27
    s_nop 0
    s_cbranch_vccnz L_adaL_poll_30
L_adaL_got_31:
    buffer_load_dwordx4 v[44:47], v9, s[4:7], s20 offen offset:0 sc1
    ds_read_b128 a[232:235], v10 offset:2048
    ds_read_b128 a[236:239], v11 offset:2048
    v_pk_fma_f32 v[146:147], v[146:147], v[170:171], v[206:207] op_sel:[0,0,0] op_sel_hi:[1,0,1]
    v_pk_fma_f32 v[160:161], v[160:161], v[170:171], v[208:209] op_sel:[0,0,0] op_sel_hi:[1,0,1]
    v_pk_fma_f32 v[162:163], v[162:163], v[170:171], v[210:211] op_sel:[0,0,0] op_sel_hi:[1,0,1]
    v_pk_mul_f32 v[216:217], v[144:145], v[144:145]
    v_pk_mul_f32 v[218:219], v[146:147], v[146:147]
    v_pk_mul_f32 v[220:221], v[160:161], v[160:161]
    v_pk_mul_f32 v[222:223], v[162:163], v[162:163]
    v_pk_fma_f32 v[216:217], v[216:217], s[66:67], s[66:67] op_sel:[0,0,1] op_sel_hi:[1,0,1]
    buffer_load_dwordx4 v[48:51], v9, s[4:7], s20 offen offset:1024 sc1
    s_waitcnt vmcnt(4) lgkmcnt(5)
    ds_read_b128 a[240:243], v10 offset:4096
    ds_read_b128 a[244:247], v11 offset:4096
    v_pk_fma_f32 v[218:219], v[218:219], s[66:67], s[66:67] op_sel:[0,0,1] op_sel_hi:[1,0,1]
    v_pk_fma_f32 v[220:221], v[220:221], s[66:67], s[66:67] op_sel:[0,0,1] op_sel_hi:[1,0,1]
    v_pk_fma_f32 v[222:223], v[222:223], s[66:67], s[66:67] op_sel:[0,0,1] op_sel_hi:[1,0,1]
    v_pk_mul_f32 v[216:217], v[216:217], v[144:145]
    v_pk_mul_f32 v[218:219], v[218:219], v[146:147]
    v_pk_mul_f32 v[220:221], v[220:221], v[160:161]
    v_pk_mul_f32 v[222:223], v[222:223], v[162:163]
    v_exp_f32 v216, v216
    buffer_load_dwordx4 v[52:55], v9, s[4:7], s21 offen offset:0 sc1
    s_waitcnt vmcnt(3) lgkmcnt(5)
    ds_read_b128 a[248:251], v10 offset:6144
    ds_read_b128 a[252:255], v11 offset:6144
    v_exp_f32 v217, v217
    v_exp_f32 v218, v218
    v_exp_f32 v219, v219
    v_exp_f32 v220, v220
    v_exp_f32 v221, v221
    v_exp_f32 v222, v222
    v_exp_f32 v223, v223
    v_pk_add_f32 v[216:217], v[216:217], s[68:69]
    buffer_load_dwordx4 v[56:59], v9, s[4:7], s21 offen offset:1024 sc1
    v_pk_add_f32 v[218:219], v[218:219], s[68:69]
    v_pk_add_f32 v[220:221], v[220:221], s[68:69]
    v_pk_add_f32 v[222:223], v[222:223], s[68:69]
    v_rcp_f32 v216, v216
    v_rcp_f32 v217, v217
    v_rcp_f32 v218, v218
    v_rcp_f32 v219, v219
    v_rcp_f32 v220, v220
    buffer_load_dwordx4 v[60:63], v9, s[4:7], s22 offen offset:0 sc1
    v_rcp_f32 v221, v221
    v_rcp_f32 v222, v222
    v_rcp_f32_e64 v223, v223
    v_pk_mul_f32 v[144:145], v[144:145], v[216:217]
    v_pk_mul_f32 v[146:147], v[146:147], v[218:219]
    v_pk_mul_f32 v[160:161], v[160:161], v[220:221]
    v_pk_mul_f32 v[162:163], v[162:163], v[222:223]
    v_cvt_pk_bf16_f32 v192, v144, v160
    buffer_load_dwordx4 v[64:67], v9, s[4:7], s22 offen offset:1024 sc1
    v_cvt_pk_bf16_f32 v193, v145, v161
    v_cvt_pk_bf16_f32 v194, v146, v162
    v_cvt_pk_bf16_f32 v195, v147, v163
    ds_write_b128 v3, v[192:195] offset:12288
    buffer_load_dwordx4 v[68:71], v9, s[4:7], s23 offen offset:0 sc1
    buffer_load_dwordx4 v[72:75], v9, s[4:7], s23 offen offset:1024 sc1
    buffer_load_dwordx4 v[76:79], v9, s[4:7], s24 offen offset:0 sc1
    buffer_load_dwordx4 v[80:83], v9, s[4:7], s24 offen offset:1024 sc1
    buffer_load_dwordx4 v[84:87], v9, s[4:7], s25 offen offset:0 sc1
    buffer_load_dwordx4 v[88:91], v9, s[4:7], s25 offen offset:1024 sc1
    buffer_load_dwordx4 v[92:95], v9, s[4:7], s26 offen offset:0 sc1
    buffer_load_dwordx4 v[96:99], v9, s[4:7], s26 offen offset:1024 sc1
    buffer_load_dwordx4 v[100:103], v9, s[4:7], s27 offen offset:0 sc1
    buffer_load_dwordx4 v[104:107], v9, s[4:7], s27 offen offset:1024 sc1
    v_add_u32 v9, 65536, v9
L_adaL_w3back_33:
    s_waitcnt lgkmcnt(0)
    s_barrier
    s_waitcnt vmcnt(15)
    v_mfma_f32_16x16x32_bf16 v[144:147], v[44:47], a[0:3], 0
    s_lshl_b32 s64, s82, 12
    v_add_u32 v14, s64, v241
    v_add_u32 v3, 86528, v14
    v_mfma_f32_16x16x32_bf16 v[148:151], v[44:47], a[8:11], 0
    ds_read_b128 v[28:31], v3 offset:0
    v_mfma_f32_16x16x32_bf16 v[152:155], v[44:47], a[16:19], 0
    ds_read_b128 v[32:35], v3 offset:1024
    v_mfma_f32_16x16x32_bf16 v[156:159], v[44:47], a[24:27], 0
    buffer_load_dwordx4 v[44:47], v9, s[4:7], s20 offen offset:0 sc1
    s_waitcnt vmcnt(15)
    v_mfma_f32_16x16x32_bf16 v[144:147], v[48:51], a[4:7], v[144:147]
    ds_read_b128 v[36:39], v3 offset:2048
    v_mfma_f32_16x16x32_bf16 v[148:151], v[48:51], a[12:15], v[148:151]
    ds_read_b128 v[40:43], v3 offset:3072
    s_add_u32 s64, s82, 1
    v_mfma_f32_16x16x32_bf16 v[152:155], v[48:51], a[20:23], v[152:155]
    s_and_b32 s64, s64, 3
    s_lshl_b32 s64, s64, 12
    v_add_u32 v15, s64, v241
    v_mfma_f32_16x16x32_bf16 v[156:159], v[48:51], a[28:31], v[156:159]
    buffer_load_dwordx4 v[48:51], v9, s[4:7], s20 offen offset:1024 sc1
    s_waitcnt vmcnt(15) lgkmcnt(3)
    v_mfma_f32_16x16x32_bf16 v[144:147], v[52:55], a[32:35], v[144:147]
    s_add_u32 s64, s82, 2
    s_and_b32 s64, s64, 3
    s_lshl_b32 s64, s64, 12
    v_mfma_f32_16x16x32_bf16 v[148:151], v[52:55], a[40:43], v[148:151]
    v_add_u32 v6, s64, v241
    s_add_u32 s64, s82, 3
    v_mfma_f32_16x16x32_bf16 v[152:155], v[52:55], a[48:51], v[152:155]
    s_and_b32 s64, s64, 3
    s_lshl_b32 s64, s64, 12
    v_add_u32 v8, s64, v241
    v_mfma_f32_16x16x32_bf16 v[156:159], v[52:55], a[56:59], v[156:159]
    buffer_load_dwordx4 v[52:55], v9, s[4:7], s21 offen offset:0 sc1
    s_waitcnt vmcnt(15) lgkmcnt(0)
    v_mfma_f32_16x16x32_bf16 v[144:147], v[56:59], a[36:39], v[144:147]
    s_lshl_b32 s62, s83, 6
    s_lshr_b32 s63, s82, 1
    s_lshl_b32 s63, s63, 5
    v_mfma_f32_16x16x32_bf16 v[148:151], v[56:59], a[44:47], v[148:151]
    s_add_u32 s62, s62, s63
    s_and_b32 s63, s82, 1
    s_add_u32 s52, s62, s63
    v_mfma_f32_16x16x32_bf16 v[152:155], v[56:59], a[52:55], v[152:155]
    s_lshl_b32 s62, s52, 1
    buffer_load_ushort v12, v12, s[12:15], s62 offen
    v_mfma_f32_16x16x32_bf16 v[156:159], v[56:59], a[60:63], v[156:159]
    buffer_load_dwordx4 v[56:59], v9, s[4:7], s21 offen offset:1024 sc1
    s_waitcnt vmcnt(16)
    v_mfma_f32_16x16x32_bf16 v[144:147], v[60:63], a[64:67], v[144:147]
    s_lshl_b32 s62, s83, 2
    s_add_u32 s62, s62, s82
    s_mul_i32 s55, s62, 768
    v_mfma_f32_16x16x32_bf16 v[148:151], v[60:63], a[72:75], v[148:151]
    s_add_u32 s55, s55, 24117248
    s_mul_i32 s62, s62, 28672
    s_add_u32 s85, s62, 20447232
    v_mfma_f32_16x16x32_bf16 v[152:155], v[60:63], a[80:83], v[152:155]
    s_lshl_b32 s57, s84, 11
    s_add_u32 s57, s57, s85
    s_lshl_b32 s70, s84, 10
    v_mfma_f32_16x16x32_bf16 v[156:159], v[60:63], a[88:91], v[156:159]
    buffer_load_dwordx4 v[60:63], v9, s[4:7], s22 offen offset:0 sc1
    s_waitcnt vmcnt(16)
    v_mfma_f32_16x16x32_bf16 v[144:147], v[64:67], a[68:71], v[144:147]
    s_add_u32 s70, s70, s85
    s_add_u32 s70, s70, 16384
    s_lshl_b32 s58, s84, 9
    v_mfma_f32_16x16x32_bf16 v[148:151], v[64:67], a[76:79], v[148:151]
    s_add_u32 s58, s58, s85
    s_add_u32 s58, s58, 24576
    s_mul_i32 s53, s82, 5120
    v_mfma_f32_16x16x32_bf16 v[152:155], v[64:67], a[84:87], v[152:155]
    s_mul_i32 s59, s84, 143360
    s_add_u32 s59, s59, s53
    s_add_u32 s59, s59, 11206656
    v_mfma_f32_16x16x32_bf16 v[156:159], v[64:67], a[92:95], v[156:159]
    buffer_load_dwordx4 v[64:67], v9, s[4:7], s22 offen offset:1024 sc1
    s_waitcnt vmcnt(16)
    v_mfma_f32_16x16x32_bf16 v[144:147], v[68:71], a[96:99], v[144:147]
    s_lshl_b32 s71, s84, 5
    s_add_u32 s71, s71, s55
    v_mul_u32_u24 v133, 98560, v240
    v_mfma_f32_16x16x32_bf16 v[148:151], v[68:71], a[104:107], v[148:151]
    s_lshr_b32 s62, s84, 2
    s_mul_i32 s62, s62, 98560
    s_add_u32 s55, s55, s62
    v_mfma_f32_16x16x32_bf16 v[152:155], v[68:71], a[112:115], v[152:155]
    v_add_u32 v128, 20480, v241
    v_add_u32 v129, 81920, v241
    v_mfma_f32_16x16x32_bf16 v[156:159], v[68:71], a[120:123], v[156:159]
    buffer_load_dwordx4 v[68:71], v9, s[4:7], s23 offen offset:0 sc1
    s_waitcnt vmcnt(16)
    v_mfma_f32_16x16x32_bf16 v[144:147], v[72:75], a[100:103], v[144:147]
    v_add_u32 v130, 143360, v241
    s_lshl_b32 s63, s82, 12
    v_mfma_f32_16x16x32_bf16 v[148:151], v[72:75], a[108:111], v[148:151]
    v_add_u32 v131, 0, v240
    v_mul_u32_u24 v132, 205, v131
    v_mfma_f32_16x16x32_bf16 v[152:155], v[72:75], a[116:119], v[152:155]
    v_lshrrev_b32 v132, 11, v132
    v_add_u32 v134, v131, v132
    v_mfma_f32_16x16x32_bf16 v[156:159], v[72:75], a[124:127], v[156:159]
    buffer_load_dwordx4 v[72:75], v9, s[4:7], s23 offen offset:1024 sc1
    s_waitcnt vmcnt(16)
    v_mfma_f32_16x16x32_bf16 v[144:147], v[76:79], a[128:131], v[144:147]
    v_lshl_add_u32 v134, v134, 4, s63
    v_mul_u32_u24 v132, 150, v132
    v_mfma_f32_16x16x32_bf16 v[148:151], v[76:79], a[136:139], v[148:151]
    v_add_lshl_u32 v138, v131, v132, 4
    v_add_u32 v131, 64, v240
    v_mfma_f32_16x16x32_bf16 v[152:155], v[76:79], a[144:147], v[152:155]
    v_mul_u32_u24 v132, 205, v131
    v_lshrrev_b32 v132, 11, v132
    v_mfma_f32_16x16x32_bf16 v[156:159], v[76:79], a[152:155], v[156:159]
    buffer_load_dwordx4 v[76:79], v9, s[4:7], s24 offen offset:0 sc1
    s_waitcnt vmcnt(16)
    v_mfma_f32_16x16x32_bf16 v[144:147], v[80:83], a[132:135], v[144:147]
    v_add_u32 v135, v131, v132
    v_lshl_add_u32 v135, v135, 4, s63
    v_mfma_f32_16x16x32_bf16 v[148:151], v[80:83], a[140:143], v[148:151]
    v_mul_u32_u24 v132, 150, v132
    v_add_lshl_u32 v139, v131, v132, 4
    v_mfma_f32_16x16x32_bf16 v[152:155], v[80:83], a[148:151], v[152:155]
    v_add_u32 v131, 128, v240
    v_mul_u32_u24 v132, 205, v131
    v_mfma_f32_16x16x32_bf16 v[156:159], v[80:83], a[156:159], v[156:159]
    buffer_load_dwordx4 v[80:83], v9, s[4:7], s24 offen offset:1024 sc1
    s_waitcnt vmcnt(16)
    v_mfma_f32_16x16x32_bf16 v[144:147], v[84:87], a[160:163], v[144:147]
    v_lshrrev_b32 v132, 11, v132
    v_add_u32 v136, v131, v132
    v_mfma_f32_16x16x32_bf16 v[148:151], v[84:87], a[168:171], v[148:151]
    v_lshl_add_u32 v136, v136, 4, s63
    v_mul_u32_u24 v132, 150, v132
    v_mfma_f32_16x16x32_bf16 v[152:155], v[84:87], a[176:179], v[152:155]
    v_add_lshl_u32 v140, v131, v132, 4
    v_lshlrev_b32 v131, 26, v240
    v_mfma_f32_16x16x32_bf16 v[156:159], v[84:87], a[184:187], v[156:159]
    buffer_load_dwordx4 v[84:87], v9, s[4:7], s25 offen offset:0 sc1
    s_waitcnt vmcnt(16)
    v_mfma_f32_16x16x32_bf16 v[144:147], v[88:91], a[164:167], v[144:147]
    v_and_b32 v131, 2147483648, v131
    v_or_b32 v140, v131, v140
    v_mfma_f32_16x16x32_bf16 v[148:151], v[88:91], a[172:175], v[148:151]
    v_mul_u32_u24 v131, 176, v1
    v_add_u32 v131, s63, v131
    v_mfma_f32_16x16x32_bf16 v[152:155], v[88:91], a[180:183], v[152:155]
    s_mul_i32 s72, s52, 1280
    s_mul_i32 s63, s84, 160
    s_add_u32 s72, s72, s63
    v_mfma_f32_16x16x32_bf16 v[156:159], v[88:91], a[188:191], v[156:159]
    buffer_load_dwordx4 v[88:91], v9, s[4:7], s25 offen offset:1024 sc1
    s_waitcnt vmcnt(16)
    v_mfma_f32_16x16x32_bf16 v[144:147], v[92:95], a[192:195], v[144:147]
    v_lshl_add_u32 v132, v2, 3, v131
    v_lshl_add_u32 v131, v2, 4, v131
    v_mfma_f32_16x16x32_bf16 v[148:151], v[92:95], a[200:203], v[148:151]
    v_mfma_f32_16x16x32_bf16 v[152:155], v[92:95], a[208:211], v[152:155]
    v_mfma_f32_16x16x32_bf16 v[156:159], v[92:95], a[216:219], v[156:159]
    buffer_load_dwordx4 v[92:95], v9, s[4:7], s26 offen offset:0 sc1
    s_waitcnt vmcnt(16)
    v_mfma_f32_16x16x32_bf16 v[144:147], v[96:99], a[196:199], v[144:147]
    v_mfma_f32_16x16x32_bf16 v[148:151], v[96:99], a[204:207], v[148:151]
    v_mfma_f32_16x16x32_bf16 v[152:155], v[96:99], a[212:215], v[152:155]
    v_mfma_f32_16x16x32_bf16 v[156:159], v[96:99], a[220:223], v[156:159]
    buffer_load_dwordx4 v[96:99], v9, s[4:7], s26 offen offset:1024 sc1
    s_waitcnt vmcnt(16)
    v_mfma_f32_16x16x32_bf16 v[144:147], v[100:103], a[224:227], v[144:147]
    v_mfma_f32_16x16x32_bf16 v[148:151], v[100:103], a[232:235], v[148:151]
    v_mfma_f32_16x16x32_bf16 v[152:155], v[100:103], a[240:243], v[152:155]
    v_mfma_f32_16x16x32_bf16 v[156:159], v[100:103], a[248:251], v[156:159]
    buffer_load_dwordx4 v[100:103], v9, s[4:7], s27 offen offset:0 sc1
    s_waitcnt vmcnt(16)
    v_mfma_f32_16x16x32_bf16 v[144:147], v[104:107], a[228:231], v[144:147]
    v_mfma_f32_16x16x32_bf16 v[148:151], v[104:107], a[236:239], v[148:151]
    v_mfma_f32_16x16x32_bf16 v[152:155], v[104:107], a[244:247], v[152:155]
    v_mfma_f32_16x16x32_bf16 v[156:159], v[104:107], a[252:255], v[156:159]
    buffer_load_dwordx4 v[104:107], v9, s[4:7], s27 offen offset:1024 sc1
    v_add_u32 v9, 65536, v9
    s_waitcnt vmcnt(16)
    v_mfma_f32_16x16x32_bf16 v[160:163], v[44:47], a[0:3], 0
    v_mfma_f32_16x16x32_bf16 v[164:167], v[44:47], a[8:11], 0
    v_mfma_f32_16x16x32_bf16 v[168:171], v[44:47], a[16:19], 0
    v_mfma_f32_16x16x32_bf16 v[172:175], v[44:47], a[24:27], 0
    buffer_load_dwordx4 v[44:47], v9, s[4:7], s20 offen offset:0 sc1
    s_waitcnt vmcnt(16)
    v_mfma_f32_16x16x32_bf16 v[160:163], v[48:51], a[4:7], v[160:163]
    v_mfma_f32_16x16x32_bf16 v[164:167], v[48:51], a[12:15], v[164:167]
    v_mfma_f32_16x16x32_bf16 v[168:171], v[48:51], a[20:23], v[168:171]
    v_mfma_f32_16x16x32_bf16 v[172:175], v[48:51], a[28:31], v[172:175]
    buffer_load_dwordx4 v[48:51], v9, s[4:7], s20 offen offset:1024 sc1
    s_waitcnt vmcnt(16)
    v_mfma_f32_16x16x32_bf16 v[160:163], v[52:55], a[32:35], v[160:163]
    ds_write_b128 v15, v[148:151] offset:1024
    v_mfma_f32_16x16x32_bf16 v[164:167], v[52:55], a[40:43], v[164:167]
    ds_write_b128 v6, v[152:155] offset:2048
    v_mfma_f32_16x16x32_bf16 v[168:171], v[52:55], a[48:51], v[168:171]
    ds_write_b128 v8, v[156:159] offset:3072
    v_mfma_f32_16x16x32_bf16 v[172:175], v[52:55], a[56:59], v[172:175]
    buffer_load_dwordx4 v[52:55], v9, s[4:7], s21 offen offset:0 sc1
    s_waitcnt vmcnt(15)
    v_mfma_f32_16x16x32_bf16 v[160:163], v[56:59], a[36:39], v[160:163]
    v_mfma_f32_16x16x32_bf16 v[164:167], v[56:59], a[44:47], v[164:167]
    v_mfma_f32_16x16x32_bf16 v[168:171], v[56:59], a[52:55], v[168:171]
    v_mfma_f32_16x16x32_bf16 v[172:175], v[56:59], a[60:63], v[172:175]
    buffer_load_dwordx4 v[56:59], v9, s[4:7], s21 offen offset:1024 sc1
    s_waitcnt vmcnt(15)
    v_mfma_f32_16x16x32_bf16 v[160:163], v[60:63], a[64:67], v[160:163]
    v_mfma_f32_16x16x32_bf16 v[164:167], v[60:63], a[72:75], v[164:167]
    v_mfma_f32_16x16x32_bf16 v[168:171], v[60:63], a[80:83], v[168:171]
    v_mfma_f32_16x16x32_bf16 v[172:175], v[60:63], a[88:91], v[172:175]
    buffer_load_dwordx4 v[60:63], v9, s[4:7], s22 offen offset:0 sc1
    s_waitcnt vmcnt(15) lgkmcnt(0)
    v_mfma_f32_16x16x32_bf16 v[160:163], v[64:67], a[68:71], v[160:163]
    s_barrier
    v_mfma_f32_16x16x32_bf16 v[164:167], v[64:67], a[76:79], v[164:167]
    ds_read_b128 v[180:183], v14 offset:1024
    v_mfma_f32_16x16x32_bf16 v[168:171], v[64:67], a[84:87], v[168:171]
    ds_read_b128 v[184:187], v14 offset:2048
    v_mfma_f32_16x16x32_bf16 v[172:175], v[64:67], a[92:95], v[172:175]
    buffer_load_dwordx4 v[64:67], v9, s[4:7], s22 offen offset:1024 sc1
    s_waitcnt vmcnt(15)
    v_mfma_f32_16x16x32_bf16 v[160:163], v[68:71], a[96:99], v[160:163]
    ds_read_b128 v[188:191], v14 offset:3072
    v_mfma_f32_16x16x32_bf16 v[164:167], v[68:71], a[104:107], v[164:167]
    v_mfma_f32_16x16x32_bf16 v[168:171], v[68:71], a[112:115], v[168:171]
    v_mfma_f32_16x16x32_bf16 v[172:175], v[68:71], a[120:123], v[172:175]
    buffer_load_dwordx4 v[68:71], v9, s[4:7], s23 offen offset:0 sc1
    s_waitcnt vmcnt(15) lgkmcnt(2)
    v_mfma_f32_16x16x32_bf16 v[160:163], v[72:75], a[100:103], v[160:163]
    v_mfma_f32_16x16x32_bf16 v[164:167], v[72:75], a[108:111], v[164:167]
    v_mfma_f32_16x16x32_bf16 v[168:171], v[72:75], a[116:119], v[168:171]
    v_mfma_f32_16x16x32_bf16 v[172:175], v[72:75], a[124:127], v[172:175]
    buffer_load_dwordx4 v[72:75], v9, s[4:7], s23 offen offset:1024 sc1
    s_waitcnt vmcnt(15) lgkmcnt(0)
    v_mfma_f32_16x16x32_bf16 v[160:163], v[76:79], a[128:131], v[160:163]
    v_lshlrev_b32 v12, 16, v12
    v_lshlrev_b32 v200, 16, v28
    v_mfma_f32_16x16x32_bf16 v[164:167], v[76:79], a[136:139], v[164:167]
    v_lshlrev_b32 v201, 16, v29
    v_lshlrev_b32 v202, 16, v30
    v_mfma_f32_16x16x32_bf16 v[168:171], v[76:79], a[144:147], v[168:171]
    v_lshlrev_b32 v203, 16, v31
    v_add_f32 v176, v144, v12
    v_mfma_f32_16x16x32_bf16 v[172:175], v[76:79], a[152:155], v[172:175]
    buffer_load_dwordx4 v[76:79], v9, s[4:7], s24 offen offset:0 sc1
    s_waitcnt vmcnt(15)
    v_mfma_f32_16x16x32_bf16 v[160:163], v[80:83], a[132:135], v[160:163]
    v_add_f32 v177, v145, v12
    v_add_f32 v178, v146, v12
    v_mfma_f32_16x16x32_bf16 v[164:167], v[80:83], a[140:143], v[164:167]
    v_add_f32 v179, v147, v12
    v_add_f32 v176, v176, v180
    v_mfma_f32_16x16x32_bf16 v[168:171], v[80:83], a[148:151], v[168:171]
    v_add_f32 v177, v177, v181
    v_add_f32 v178, v178, v182
    v_mfma_f32_16x16x32_bf16 v[172:175], v[80:83], a[156:159], v[172:175]
    buffer_load_dwordx4 v[80:83], v9, s[4:7], s24 offen offset:1024 sc1
    s_waitcnt vmcnt(15)
    v_mfma_f32_16x16x32_bf16 v[160:163], v[84:87], a[160:163], v[160:163]
    v_add_f32 v179, v179, v183
    v_add_f32 v184, v184, v188
    v_mfma_f32_16x16x32_bf16 v[164:167], v[84:87], a[168:171], v[164:167]
    v_add_f32 v185, v185, v189
    v_add_f32 v186, v186, v190
    v_mfma_f32_16x16x32_bf16 v[168:171], v[84:87], a[176:179], v[168:171]
    v_add_f32 v187, v187, v191
    v_add_f32 v176, v176, v184
    v_mfma_f32_16x16x32_bf16 v[172:175], v[84:87], a[184:187], v[172:175]
    buffer_load_dwordx4 v[84:87], v9, s[4:7], s25 offen offset:0 sc1
    s_waitcnt vmcnt(15)
    v_mfma_f32_16x16x32_bf16 v[160:163], v[88:91], a[164:167], v[160:163]
    v_add_f32 v177, v177, v185
    v_add_f32 v178, v178, v186
    v_mfma_f32_16x16x32_bf16 v[164:167], v[88:91], a[172:175], v[164:167]
    v_add_f32 v179, v179, v187
    v_mul_f32 v192, v176, v200
    v_mfma_f32_16x16x32_bf16 v[168:171], v[88:91], a[180:183], v[168:171]
    v_mul_f32 v193, v177, v201
    v_mul_f32 v194, v178, v202
    v_mfma_f32_16x16x32_bf16 v[172:175], v[88:91], a[188:191], v[172:175]
    buffer_load_dwordx4 v[88:91], v9, s[4:7], s25 offen offset:1024 sc1
    s_waitcnt vmcnt(15)
    v_mfma_f32_16x16x32_bf16 v[160:163], v[92:95], a[192:195], v[160:163]
    v_mul_f32 v195, v179, v203
    v_mfma_f32_16x16x32_bf16 v[164:167], v[92:95], a[200:203], v[164:167]
    v_mfma_f32_16x16x32_bf16 v[168:171], v[92:95], a[208:211], v[168:171]
    v_mfma_f32_16x16x32_bf16 v[172:175], v[92:95], a[216:219], v[172:175]
    buffer_load_dwordx4 v[92:95], v9, s[4:7], s26 offen offset:0 sc1
    s_waitcnt vmcnt(15)
    v_mfma_f32_16x16x32_bf16 v[160:163], v[96:99], a[196:199], v[160:163]
    v_mfma_f32_16x16x32_bf16 v[164:167], v[96:99], a[204:207], v[164:167]
    v_mfma_f32_16x16x32_bf16 v[168:171], v[96:99], a[212:215], v[168:171]
    v_mfma_f32_16x16x32_bf16 v[172:175], v[96:99], a[220:223], v[172:175]
    buffer_load_dwordx4 v[96:99], v9, s[4:7], s26 offen offset:1024 sc1
    s_waitcnt vmcnt(15)
    v_mfma_f32_16x16x32_bf16 v[160:163], v[100:103], a[224:227], v[160:163]
    v_mfma_f32_16x16x32_bf16 v[164:167], v[100:103], a[232:235], v[164:167]
    v_mfma_f32_16x16x32_bf16 v[168:171], v[100:103], a[240:243], v[168:171]
    v_mfma_f32_16x16x32_bf16 v[172:175], v[100:103], a[248:251], v[172:175]
    buffer_load_dwordx4 v[100:103], v9, s[4:7], s27 offen offset:0 sc1
    s_waitcnt vmcnt(15)
    v_mfma_f32_16x16x32_bf16 v[160:163], v[104:107], a[228:231], v[160:163]
    v_mfma_f32_16x16x32_bf16 v[164:167], v[104:107], a[236:239], v[164:167]
    v_mfma_f32_16x16x32_bf16 v[168:171], v[104:107], a[244:247], v[168:171]
    v_mfma_f32_16x16x32_bf16 v[172:175], v[104:107], a[252:255], v[172:175]
    buffer_load_dwordx4 v[104:107], v9, s[4:7], s27 offen offset:1024 sc1
    v_add_u32 v9, 65536, v9
    s_waitcnt vmcnt(15)
    v_mfma_f32_16x16x32_bf16 v[144:147], v[44:47], a[0:3], 0
    v_mfma_f32_16x16x32_bf16 v[148:151], v[44:47], a[8:11], 0
    v_mfma_f32_16x16x32_bf16 v[152:155], v[44:47], a[16:19], 0
    v_mfma_f32_16x16x32_bf16 v[156:159], v[44:47], a[24:27], 0
    buffer_load_dwordx4 v[44:47], v9, s[4:7], s20 offen offset:0 sc1
    s_waitcnt vmcnt(15)
    v_mfma_f32_16x16x32_bf16 v[144:147], v[48:51], a[4:7], v[144:147]
    v_mfma_f32_16x16x32_bf16 v[148:151], v[48:51], a[12:15], v[148:151]
    v_mfma_f32_16x16x32_bf16 v[152:155], v[48:51], a[20:23], v[152:155]
    v_mfma_f32_16x16x32_bf16 v[156:159], v[48:51], a[28:31], v[156:159]
    buffer_load_dwordx4 v[48:51], v9, s[4:7], s20 offen offset:1024 sc1
    s_waitcnt vmcnt(15)
    v_mfma_f32_16x16x32_bf16 v[144:147], v[52:55], a[32:35], v[144:147]
    ds_write_b128 v15, v[164:167] offset:17408
    v_mfma_f32_16x16x32_bf16 v[148:151], v[52:55], a[40:43], v[148:151]
    ds_write_b128 v6, v[168:171] offset:18432
    v_mfma_f32_16x16x32_bf16 v[152:155], v[52:55], a[48:51], v[152:155]
    ds_write_b128 v8, v[172:175] offset:19456
    v_mfma_f32_16x16x32_bf16 v[156:159], v[52:55], a[56:59], v[156:159]
    buffer_load_dwordx4 v[52:55], v9, s[4:7], s21 offen offset:0 sc1
    s_waitcnt vmcnt(15)
    v_mfma_f32_16x16x32_bf16 v[144:147], v[56:59], a[36:39], v[144:147]
    v_mfma_f32_16x16x32_bf16 v[148:151], v[56:59], a[44:47], v[148:151]
    v_mfma_f32_16x16x32_bf16 v[152:155], v[56:59], a[52:55], v[152:155]
    v_mfma_f32_16x16x32_bf16 v[156:159], v[56:59], a[60:63], v[156:159]
    buffer_load_dwordx4 v[56:59], v9, s[4:7], s21 offen offset:1024 sc1
    s_waitcnt vmcnt(15)
    v_mfma_f32_16x16x32_bf16 v[144:147], v[60:63], a[64:67], v[144:147]
    v_mfma_f32_16x16x32_bf16 v[148:151], v[60:63], a[72:75], v[148:151]
    v_mfma_f32_16x16x32_bf16 v[152:155], v[60:63], a[80:83], v[152:155]
    v_mfma_f32_16x16x32_bf16 v[156:159], v[60:63], a[88:91], v[156:159]
    buffer_load_dwordx4 v[60:63], v9, s[4:7], s22 offen offset:0 sc1
    s_waitcnt vmcnt(15) lgkmcnt(0)
    v_mfma_f32_16x16x32_bf16 v[144:147], v[64:67], a[68:71], v[144:147]
    s_barrier
    v_mfma_f32_16x16x32_bf16 v[148:151], v[64:67], a[76:79], v[148:151]
    ds_read_b128 v[180:183], v14 offset:17408
    v_mfma_f32_16x16x32_bf16 v[152:155], v[64:67], a[84:87], v[152:155]
    ds_read_b128 v[184:187], v14 offset:18432
    v_mfma_f32_16x16x32_bf16 v[156:159], v[64:67], a[92:95], v[156:159]
    buffer_load_dwordx4 v[64:67], v9, s[4:7], s22 offen offset:1024 sc1
    s_waitcnt vmcnt(15)
    v_mfma_f32_16x16x32_bf16 v[144:147], v[68:71], a[96:99], v[144:147]
    ds_read_b128 v[188:191], v14 offset:19456
    v_mfma_f32_16x16x32_bf16 v[148:151], v[68:71], a[104:107], v[148:151]
    v_mfma_f32_16x16x32_bf16 v[152:155], v[68:71], a[112:115], v[152:155]
    v_mfma_f32_16x16x32_bf16 v[156:159], v[68:71], a[120:123], v[156:159]
    buffer_load_dwordx4 v[68:71], v9, s[4:7], s23 offen offset:0 sc1
    s_waitcnt vmcnt(15) lgkmcnt(2)
    v_mfma_f32_16x16x32_bf16 v[144:147], v[72:75], a[100:103], v[144:147]
    v_mfma_f32_16x16x32_bf16 v[148:151], v[72:75], a[108:111], v[148:151]
    v_mfma_f32_16x16x32_bf16 v[152:155], v[72:75], a[116:119], v[152:155]
    v_mfma_f32_16x16x32_bf16 v[156:159], v[72:75], a[124:127], v[156:159]
    buffer_load_dwordx4 v[72:75], v9, s[4:7], s23 offen offset:1024 sc1
    s_waitcnt vmcnt(15) lgkmcnt(0)
    v_mfma_f32_16x16x32_bf16 v[144:147], v[76:79], a[128:131], v[144:147]
    v_and_b32 v200, s3, v28
    v_and_b32 v201, s3, v29
    v_mfma_f32_16x16x32_bf16 v[148:151], v[76:79], a[136:139], v[148:151]
    v_and_b32 v202, s3, v30
    v_and_b32 v203, s3, v31
    v_mfma_f32_16x16x32_bf16 v[152:155], v[76:79], a[144:147], v[152:155]
    v_add_f32 v176, v160, v12
    v_add_f32 v177, v161, v12
    v_mfma_f32_16x16x32_bf16 v[156:159], v[76:79], a[152:155], v[156:159]
    buffer_load_dwordx4 v[76:79], v9, s[4:7], s24 offen offset:0 sc1
    s_waitcnt vmcnt(15)
    v_mfma_f32_16x16x32_bf16 v[144:147], v[80:83], a[132:135], v[144:147]
    v_add_f32 v178, v162, v12
    v_add_f32 v179, v163, v12
    v_mfma_f32_16x16x32_bf16 v[148:151], v[80:83], a[140:143], v[148:151]
    v_add_f32 v176, v176, v180
    v_add_f32 v177, v177, v181
    v_mfma_f32_16x16x32_bf16 v[152:155], v[80:83], a[148:151], v[152:155]
    v_add_f32 v178, v178, v182
    v_add_f32 v179, v179, v183
    v_mfma_f32_16x16x32_bf16 v[156:159], v[80:83], a[156:159], v[156:159]
    buffer_load_dwordx4 v[80:83], v9, s[4:7], s24 offen offset:1024 sc1
    s_waitcnt vmcnt(15)
    v_mfma_f32_16x16x32_bf16 v[144:147], v[84:87], a[160:163], v[144:147]
    v_add_f32 v184, v184, v188
    v_add_f32 v185, v185, v189
    v_mfma_f32_16x16x32_bf16 v[148:151], v[84:87], a[168:171], v[148:151]
    v_add_f32 v186, v186, v190
    v_add_f32 v187, v187, v191
    v_mfma_f32_16x16x32_bf16 v[152:155], v[84:87], a[176:179], v[152:155]
    v_add_f32 v176, v176, v184
    v_add_f32 v177, v177, v185
    v_mfma_f32_16x16x32_bf16 v[156:159], v[84:87], a[184:187], v[156:159]
    buffer_load_dwordx4 v[84:87], v9, s[4:7], s25 offen offset:0 sc1
    s_waitcnt vmcnt(15)
    v_mfma_f32_16x16x32_bf16 v[144:147], v[88:91], a[164:167], v[144:147]
    v_add_f32 v178, v178, v186
    v_add_f32 v179, v179, v187
    v_mfma_f32_16x16x32_bf16 v[148:151], v[88:91], a[172:175], v[148:151]
    v_mul_f32 v196, v176, v200
    v_mul_f32 v197, v177, v201
    v_mfma_f32_16x16x32_bf16 v[152:155], v[88:91], a[180:183], v[152:155]
    v_mul_f32 v198, v178, v202
    v_mul_f32 v199, v179, v203
    v_mfma_f32_16x16x32_bf16 v[156:159], v[88:91], a[188:191], v[156:159]
    buffer_load_dwordx4 v[88:91], v9, s[4:7], s25 offen offset:1024 sc1
    s_waitcnt vmcnt(15)
    v_mfma_f32_16x16x32_bf16 v[144:147], v[92:95], a[192:195], v[144:147]
    v_cvt_pk_bf16_f32 v28, v192, v196
    v_cvt_pk_bf16_f32 v29, v193, v197
    v_mfma_f32_16x16x32_bf16 v[148:151], v[92:95], a[200:203], v[148:151]
    v_cvt_pk_bf16_f32 v30, v194, v198
    v_cvt_pk_bf16_f32 v31, v195, v199
    v_mfma_f32_16x16x32_bf16 v[152:155], v[92:95], a[208:211], v[152:155]
    buffer_store_dwordx4 v[28:31], v241, s[4:7], s57 offen offset:0 sc1
    v_mfma_f32_16x16x32_bf16 v[156:159], v[92:95], a[216:219], v[156:159]
    buffer_load_dwordx4 v[92:95], v9, s[4:7], s26 offen offset:0 sc1
    s_waitcnt vmcnt(16)
    v_mfma_f32_16x16x32_bf16 v[144:147], v[96:99], a[196:199], v[144:147]
    v_mfma_f32_16x16x32_bf16 v[148:151], v[96:99], a[204:207], v[148:151]
    v_mfma_f32_16x16x32_bf16 v[152:155], v[96:99], a[212:215], v[152:155]
    v_mfma_f32_16x16x32_bf16 v[156:159], v[96:99], a[220:223], v[156:159]
    buffer_load_dwordx4 v[96:99], v9, s[4:7], s26 offen offset:1024 sc1
    s_waitcnt vmcnt(16)
    v_mfma_f32_16x16x32_bf16 v[144:147], v[100:103], a[224:227], v[144:147]
    v_mfma_f32_16x16x32_bf16 v[148:151], v[100:103], a[232:235], v[148:151]
    v_mfma_f32_16x16x32_bf16 v[152:155], v[100:103], a[240:243], v[152:155]
    v_mfma_f32_16x16x32_bf16 v[156:159], v[100:103], a[248:251], v[156:159]
    buffer_load_dwordx4 v[100:103], v9, s[4:7], s27 offen offset:0 sc1
    s_waitcnt vmcnt(16)
    v_mfma_f32_16x16x32_bf16 v[144:147], v[104:107], a[228:231], v[144:147]
    v_mfma_f32_16x16x32_bf16 v[148:151], v[104:107], a[236:239], v[148:151]
    v_mfma_f32_16x16x32_bf16 v[152:155], v[104:107], a[244:247], v[152:155]
    v_mfma_f32_16x16x32_bf16 v[156:159], v[104:107], a[252:255], v[156:159]
    buffer_load_dwordx4 v[104:107], v9, s[4:7], s27 offen offset:1024 sc1
    v_add_u32 v9, 65536, v9
    s_waitcnt vmcnt(16)
    v_mfma_f32_16x16x32_bf16 v[160:163], v[44:47], a[0:3], 0
    v_mfma_f32_16x16x32_bf16 v[164:167], v[44:47], a[8:11], 0
    v_mfma_f32_16x16x32_bf16 v[168:171], v[44:47], a[16:19], 0
    v_mfma_f32_16x16x32_bf16 v[172:175], v[44:47], a[24:27], 0
    buffer_load_dwordx4 v[44:47], v9, s[4:7], s20 offen offset:0 sc1
    s_waitcnt vmcnt(16)
    v_mfma_f32_16x16x32_bf16 v[160:163], v[48:51], a[4:7], v[160:163]
    v_mfma_f32_16x16x32_bf16 v[164:167], v[48:51], a[12:15], v[164:167]
    v_mfma_f32_16x16x32_bf16 v[168:171], v[48:51], a[20:23], v[168:171]
    v_mfma_f32_16x16x32_bf16 v[172:175], v[48:51], a[28:31], v[172:175]
    buffer_load_dwordx4 v[48:51], v9, s[4:7], s20 offen offset:1024 sc1
    s_waitcnt vmcnt(16)
    v_mfma_f32_16x16x32_bf16 v[160:163], v[52:55], a[32:35], v[160:163]
    ds_write_b128 v15, v[148:151] offset:1024
    v_mfma_f32_16x16x32_bf16 v[164:167], v[52:55], a[40:43], v[164:167]
    ds_write_b128 v6, v[152:155] offset:2048
    v_mfma_f32_16x16x32_bf16 v[168:171], v[52:55], a[48:51], v[168:171]
    ds_write_b128 v8, v[156:159] offset:3072
    v_mfma_f32_16x16x32_bf16 v[172:175], v[52:55], a[56:59], v[172:175]
    buffer_load_dwordx4 v[52:55], v9, s[4:7], s21 offen offset:0 sc1
    s_waitcnt vmcnt(16)
    v_mfma_f32_16x16x32_bf16 v[160:163], v[56:59], a[36:39], v[160:163]
    v_mfma_f32_16x16x32_bf16 v[164:167], v[56:59], a[44:47], v[164:167]
    v_mfma_f32_16x16x32_bf16 v[168:171], v[56:59], a[52:55], v[168:171]
    v_mfma_f32_16x16x32_bf16 v[172:175], v[56:59], a[60:63], v[172:175]
    buffer_load_dwordx4 v[56:59], v9, s[4:7], s21 offen offset:1024 sc1
    s_waitcnt vmcnt(16)
    v_mfma_f32_16x16x32_bf16 v[160:163], v[60:63], a[64:67], v[160:163]
    v_mfma_f32_16x16x32_bf16 v[164:167], v[60:63], a[72:75], v[164:167]
    v_mfma_f32_16x16x32_bf16 v[168:171], v[60:63], a[80:83], v[168:171]
    v_mfma_f32_16x16x32_bf16 v[172:175], v[60:63], a[88:91], v[172:175]
    buffer_load_dwordx4 v[60:63], v9, s[4:7], s22 offen offset:0 sc1
    s_waitcnt vmcnt(16) lgkmcnt(0)
    v_mfma_f32_16x16x32_bf16 v[160:163], v[64:67], a[68:71], v[160:163]
    s_barrier
    v_mfma_f32_16x16x32_bf16 v[164:167], v[64:67], a[76:79], v[164:167]
    ds_read_b128 v[180:183], v14 offset:1024
    v_mfma_f32_16x16x32_bf16 v[168:171], v[64:67], a[84:87], v[168:171]
    ds_read_b128 v[184:187], v14 offset:2048
    v_mfma_f32_16x16x32_bf16 v[172:175], v[64:67], a[92:95], v[172:175]
    buffer_load_dwordx4 v[64:67], v9, s[4:7], s22 offen offset:1024 sc1
    s_waitcnt vmcnt(16)
    v_mfma_f32_16x16x32_bf16 v[160:163], v[68:71], a[96:99], v[160:163]
    ds_read_b128 v[188:191], v14 offset:3072
    v_mfma_f32_16x16x32_bf16 v[164:167], v[68:71], a[104:107], v[164:167]
    v_mfma_f32_16x16x32_bf16 v[168:171], v[68:71], a[112:115], v[168:171]
    v_mfma_f32_16x16x32_bf16 v[172:175], v[68:71], a[120:123], v[172:175]
    buffer_load_dwordx4 v[68:71], v9, s[4:7], s23 offen offset:0 sc1
    s_waitcnt vmcnt(16) lgkmcnt(2)
    v_mfma_f32_16x16x32_bf16 v[160:163], v[72:75], a[100:103], v[160:163]
    v_mfma_f32_16x16x32_bf16 v[164:167], v[72:75], a[108:111], v[164:167]
    v_mfma_f32_16x16x32_bf16 v[168:171], v[72:75], a[116:119], v[168:171]
    v_mfma_f32_16x16x32_bf16 v[172:175], v[72:75], a[124:127], v[172:175]
    buffer_load_dwordx4 v[72:75], v9, s[4:7], s23 offen offset:1024 sc1
    s_waitcnt vmcnt(16) lgkmcnt(0)
    v_mfma_f32_16x16x32_bf16 v[160:163], v[76:79], a[128:131], v[160:163]
    v_lshlrev_b32 v200, 16, v32
    v_lshlrev_b32 v201, 16, v33
    v_mfma_f32_16x16x32_bf16 v[164:167], v[76:79], a[136:139], v[164:167]
    v_lshlrev_b32 v202, 16, v34
    v_lshlrev_b32 v203, 16, v35
    v_mfma_f32_16x16x32_bf16 v[168:171], v[76:79], a[144:147], v[168:171]
    v_add_f32 v176, v144, v12
    v_add_f32 v177, v145, v12
    v_mfma_f32_16x16x32_bf16 v[172:175], v[76:79], a[152:155], v[172:175]
    buffer_load_dwordx4 v[76:79], v9, s[4:7], s24 offen offset:0 sc1
    s_waitcnt vmcnt(16)
    v_mfma_f32_16x16x32_bf16 v[160:163], v[80:83], a[132:135], v[160:163]
    v_add_f32 v178, v146, v12
    v_add_f32 v179, v147, v12
    v_mfma_f32_16x16x32_bf16 v[164:167], v[80:83], a[140:143], v[164:167]
    v_add_f32 v176, v176, v180
    v_add_f32 v177, v177, v181
    v_mfma_f32_16x16x32_bf16 v[168:171], v[80:83], a[148:151], v[168:171]
    v_add_f32 v178, v178, v182
    v_add_f32 v179, v179, v183
    v_mfma_f32_16x16x32_bf16 v[172:175], v[80:83], a[156:159], v[172:175]
    buffer_load_dwordx4 v[80:83], v9, s[4:7], s24 offen offset:1024 sc1
    s_waitcnt vmcnt(16)
    v_mfma_f32_16x16x32_bf16 v[160:163], v[84:87], a[160:163], v[160:163]
    v_add_f32 v184, v184, v188
    v_add_f32 v185, v185, v189
    v_mfma_f32_16x16x32_bf16 v[164:167], v[84:87], a[168:171], v[164:167]
    v_add_f32 v186, v186, v190
    v_add_f32 v187, v187, v191
    v_mfma_f32_16x16x32_bf16 v[168:171], v[84:87], a[176:179], v[168:171]
    v_add_f32 v176, v176, v184
    v_add_f32 v177, v177, v185
    v_mfma_f32_16x16x32_bf16 v[172:175], v[84:87], a[184:187], v[172:175]
    buffer_load_dwordx4 v[84:87], v9, s[4:7], s25 offen offset:0 sc1
    s_waitcnt vmcnt(16)
    v_mfma_f32_16x16x32_bf16 v[160:163], v[88:91], a[164:167], v[160:163]
    v_add_f32 v178, v178, v186
    v_add_f32 v179, v179, v187
    v_mfma_f32_16x16x32_bf16 v[164:167], v[88:91], a[172:175], v[164:167]
    v_mul_f32 v192, v176, v200
    v_mul_f32 v193, v177, v201
    v_mfma_f32_16x16x32_bf16 v[168:171], v[88:91], a[180:183], v[168:171]
    v_mul_f32 v194, v178, v202
    v_mul_f32 v195, v179, v203
    v_mfma_f32_16x16x32_bf16 v[172:175], v[88:91], a[188:191], v[172:175]
    buffer_load_dwordx4 v[88:91], v9, s[4:7], s25 offen offset:1024 sc1
    s_waitcnt vmcnt(15)
    v_mfma_f32_16x16x32_bf16 v[160:163], v[92:95], a[192:195], v[160:163]
    v_mfma_f32_16x16x32_bf16 v[164:167], v[92:95], a[200:203], v[164:167]
    v_mfma_f32_16x16x32_bf16 v[168:171], v[92:95], a[208:211], v[168:171]
    v_mfma_f32_16x16x32_bf16 v[172:175], v[92:95], a[216:219], v[172:175]
    buffer_load_dwordx4 v[92:95], v9, s[4:7], s26 offen offset:0 sc1
    s_waitcnt vmcnt(15)
    v_mfma_f32_16x16x32_bf16 v[160:163], v[96:99], a[196:199], v[160:163]
    v_mfma_f32_16x16x32_bf16 v[164:167], v[96:99], a[204:207], v[164:167]
    v_mfma_f32_16x16x32_bf16 v[168:171], v[96:99], a[212:215], v[168:171]
    v_mfma_f32_16x16x32_bf16 v[172:175], v[96:99], a[220:223], v[172:175]
    buffer_load_dwordx4 v[96:99], v9, s[4:7], s26 offen offset:1024 sc1
    s_waitcnt vmcnt(15)
    v_mfma_f32_16x16x32_bf16 v[160:163], v[100:103], a[224:227], v[160:163]
    v_mfma_f32_16x16x32_bf16 v[164:167], v[100:103], a[232:235], v[164:167]
    v_mfma_f32_16x16x32_bf16 v[168:171], v[100:103], a[240:243], v[168:171]
    v_mfma_f32_16x16x32_bf16 v[172:175], v[100:103], a[248:251], v[172:175]
    buffer_load_dwordx4 v[100:103], v9, s[4:7], s27 offen offset:0 sc1
    s_waitcnt vmcnt(15)
    v_mfma_f32_16x16x32_bf16 v[160:163], v[104:107], a[228:231], v[160:163]
    v_mfma_f32_16x16x32_bf16 v[164:167], v[104:107], a[236:239], v[164:167]
    v_mfma_f32_16x16x32_bf16 v[168:171], v[104:107], a[244:247], v[168:171]
    v_mfma_f32_16x16x32_bf16 v[172:175], v[104:107], a[252:255], v[172:175]
    buffer_load_dwordx4 v[104:107], v9, s[4:7], s27 offen offset:1024 sc1
    v_add_u32 v9, 65536, v9
    s_waitcnt vmcnt(15)
    v_mfma_f32_16x16x32_bf16 v[144:147], v[44:47], a[0:3], 0
    v_mfma_f32_16x16x32_bf16 v[148:151], v[44:47], a[8:11], 0
    v_mfma_f32_16x16x32_bf16 v[152:155], v[44:47], a[16:19], 0
    v_mfma_f32_16x16x32_bf16 v[156:159], v[44:47], a[24:27], 0
    buffer_load_dwordx4 v[44:47], v9, s[4:7], s20 offen offset:0 sc1
    s_waitcnt vmcnt(15)
    v_mfma_f32_16x16x32_bf16 v[144:147], v[48:51], a[4:7], v[144:147]
    v_mfma_f32_16x16x32_bf16 v[148:151], v[48:51], a[12:15], v[148:151]
    v_mfma_f32_16x16x32_bf16 v[152:155], v[48:51], a[20:23], v[152:155]
    v_mfma_f32_16x16x32_bf16 v[156:159], v[48:51], a[28:31], v[156:159]
    buffer_load_dwordx4 v[48:51], v9, s[4:7], s20 offen offset:1024 sc1
    s_waitcnt vmcnt(15)
    v_mfma_f32_16x16x32_bf16 v[144:147], v[52:55], a[32:35], v[144:147]
    ds_write_b128 v15, v[164:167] offset:17408
    v_mfma_f32_16x16x32_bf16 v[148:151], v[52:55], a[40:43], v[148:151]
    ds_write_b128 v6, v[168:171] offset:18432
    v_mfma_f32_16x16x32_bf16 v[152:155], v[52:55], a[48:51], v[152:155]
    ds_write_b128 v8, v[172:175] offset:19456
    v_mfma_f32_16x16x32_bf16 v[156:159], v[52:55], a[56:59], v[156:159]
    buffer_load_dwordx4 v[52:55], v9, s[4:7], s21 offen offset:0 sc1
    s_waitcnt vmcnt(15)
    v_mfma_f32_16x16x32_bf16 v[144:147], v[56:59], a[36:39], v[144:147]
    v_mfma_f32_16x16x32_bf16 v[148:151], v[56:59], a[44:47], v[148:151]
    v_mfma_f32_16x16x32_bf16 v[152:155], v[56:59], a[52:55], v[152:155]
    v_mfma_f32_16x16x32_bf16 v[156:159], v[56:59], a[60:63], v[156:159]
    buffer_load_dwordx4 v[56:59], v9, s[4:7], s21 offen offset:1024 sc1
    s_waitcnt vmcnt(15)
    v_mfma_f32_16x16x32_bf16 v[144:147], v[60:63], a[64:67], v[144:147]
    v_mfma_f32_16x16x32_bf16 v[148:151], v[60:63], a[72:75], v[148:151]
    v_mfma_f32_16x16x32_bf16 v[152:155], v[60:63], a[80:83], v[152:155]
    v_mfma_f32_16x16x32_bf16 v[156:159], v[60:63], a[88:91], v[156:159]
    buffer_load_dwordx4 v[60:63], v9, s[4:7], s22 offen offset:0 sc1
    s_waitcnt vmcnt(15) lgkmcnt(0)
    v_mfma_f32_16x16x32_bf16 v[144:147], v[64:67], a[68:71], v[144:147]
    s_barrier
    v_mfma_f32_16x16x32_bf16 v[148:151], v[64:67], a[76:79], v[148:151]
    ds_read_b128 v[180:183], v14 offset:17408
    v_mfma_f32_16x16x32_bf16 v[152:155], v[64:67], a[84:87], v[152:155]
    ds_read_b128 v[184:187], v14 offset:18432
    v_mfma_f32_16x16x32_bf16 v[156:159], v[64:67], a[92:95], v[156:159]
    buffer_load_dwordx4 v[64:67], v9, s[4:7], s22 offen offset:1024 sc1
    s_waitcnt vmcnt(15)
    v_mfma_f32_16x16x32_bf16 v[144:147], v[68:71], a[96:99], v[144:147]
    ds_read_b128 v[188:191], v14 offset:19456
    v_mfma_f32_16x16x32_bf16 v[148:151], v[68:71], a[104:107], v[148:151]
    v_mfma_f32_16x16x32_bf16 v[152:155], v[68:71], a[112:115], v[152:155]
    v_mfma_f32_16x16x32_bf16 v[156:159], v[68:71], a[120:123], v[156:159]
    buffer_load_dwordx4 v[68:71], v9, s[4:7], s23 offen offset:0 sc1
    s_waitcnt vmcnt(15) lgkmcnt(2)
    v_mfma_f32_16x16x32_bf16 v[144:147], v[72:75], a[100:103], v[144:147]
    v_mfma_f32_16x16x32_bf16 v[148:151], v[72:75], a[108:111], v[148:151]
    v_mfma_f32_16x16x32_bf16 v[152:155], v[72:75], a[116:119], v[152:155]
    v_mfma_f32_16x16x32_bf16 v[156:159], v[72:75], a[124:127], v[156:159]
    buffer_load_dwordx4 v[72:75], v9, s[4:7], s23 offen offset:1024 sc1
    s_waitcnt vmcnt(15) lgkmcnt(0)
    v_mfma_f32_16x16x32_bf16 v[144:147], v[76:79], a[128:131], v[144:147]
    v_and_b32 v200, s3, v32
    v_and_b32 v201, s3, v33
    v_mfma_f32_16x16x32_bf16 v[148:151], v[76:79], a[136:139], v[148:151]
    v_and_b32 v202, s3, v34
    v_and_b32 v203, s3, v35
    v_mfma_f32_16x16x32_bf16 v[152:155], v[76:79], a[144:147], v[152:155]
    v_add_f32 v176, v160, v12
    v_add_f32 v177, v161, v12
    v_mfma_f32_16x16x32_bf16 v[156:159], v[76:79], a[152:155], v[156:159]
    buffer_load_dwordx4 v[76:79], v9, s[4:7], s24 offen offset:0 sc1
    s_waitcnt vmcnt(15)
    v_mfma_f32_16x16x32_bf16 v[144:147], v[80:83], a[132:135], v[144:147]
    v_add_f32 v178, v162, v12
    v_add_f32 v179, v163, v12
    v_mfma_f32_16x16x32_bf16 v[148:151], v[80:83], a[140:143], v[148:151]
    v_add_f32 v176, v176, v180
    v_add_f32 v177, v177, v181
    v_mfma_f32_16x16x32_bf16 v[152:155], v[80:83], a[148:151], v[152:155]
    v_add_f32 v178, v178, v182
    v_add_f32 v179, v179, v183
    v_mfma_f32_16x16x32_bf16 v[156:159], v[80:83], a[156:159], v[156:159]
    buffer_load_dwordx4 v[80:83], v9, s[4:7], s24 offen offset:1024 sc1
    s_waitcnt vmcnt(15)
    v_mfma_f32_16x16x32_bf16 v[144:147], v[84:87], a[160:163], v[144:147]
    v_add_f32 v184, v184, v188
    v_add_f32 v185, v185, v189
    v_mfma_f32_16x16x32_bf16 v[148:151], v[84:87], a[168:171], v[148:151]
    v_add_f32 v186, v186, v190
    v_add_f32 v187, v187, v191
    v_mfma_f32_16x16x32_bf16 v[152:155], v[84:87], a[176:179], v[152:155]
    v_add_f32 v176, v176, v184
    v_add_f32 v177, v177, v185
    v_mfma_f32_16x16x32_bf16 v[156:159], v[84:87], a[184:187], v[156:159]
    buffer_load_dwordx4 v[84:87], v9, s[4:7], s25 offen offset:0 sc1
    s_waitcnt vmcnt(15)
    v_mfma_f32_16x16x32_bf16 v[144:147], v[88:91], a[164:167], v[144:147]
    v_add_f32 v178, v178, v186
    v_add_f32 v179, v179, v187
    v_mfma_f32_16x16x32_bf16 v[148:151], v[88:91], a[172:175], v[148:151]
    v_mul_f32 v196, v176, v200
    v_mul_f32 v197, v177, v201
    v_mfma_f32_16x16x32_bf16 v[152:155], v[88:91], a[180:183], v[152:155]
    v_mul_f32 v198, v178, v202
    v_mul_f32 v199, v179, v203
    v_mfma_f32_16x16x32_bf16 v[156:159], v[88:91], a[188:191], v[156:159]
    buffer_load_dwordx4 v[88:91], v9, s[4:7], s25 offen offset:1024 sc1
    s_waitcnt vmcnt(15)
    v_mfma_f32_16x16x32_bf16 v[144:147], v[92:95], a[192:195], v[144:147]
    v_cvt_pk_bf16_f32 v32, v192, v196
    v_cvt_pk_bf16_f32 v33, v193, v197
    v_mfma_f32_16x16x32_bf16 v[148:151], v[92:95], a[200:203], v[148:151]
    v_cvt_pk_bf16_f32 v34, v194, v198
    v_cvt_pk_bf16_f32 v35, v195, v199
    v_mfma_f32_16x16x32_bf16 v[152:155], v[92:95], a[208:211], v[152:155]
    buffer_store_dwordx4 v[32:35], v241, s[4:7], s57 offen offset:1024 sc1
    v_mfma_f32_16x16x32_bf16 v[156:159], v[92:95], a[216:219], v[156:159]
    buffer_load_dwordx4 v[92:95], v9, s[4:7], s26 offen offset:0 sc1
    s_waitcnt vmcnt(16)
    v_mfma_f32_16x16x32_bf16 v[144:147], v[96:99], a[196:199], v[144:147]
    v_mfma_f32_16x16x32_bf16 v[148:151], v[96:99], a[204:207], v[148:151]
    v_mfma_f32_16x16x32_bf16 v[152:155], v[96:99], a[212:215], v[152:155]
    v_mfma_f32_16x16x32_bf16 v[156:159], v[96:99], a[220:223], v[156:159]
    buffer_load_dwordx4 v[96:99], v9, s[4:7], s26 offen offset:1024 sc1
    s_waitcnt vmcnt(16)
    v_mfma_f32_16x16x32_bf16 v[144:147], v[100:103], a[224:227], v[144:147]
    v_mfma_f32_16x16x32_bf16 v[148:151], v[100:103], a[232:235], v[148:151]
    v_mfma_f32_16x16x32_bf16 v[152:155], v[100:103], a[240:243], v[152:155]
    v_mfma_f32_16x16x32_bf16 v[156:159], v[100:103], a[248:251], v[156:159]
    buffer_load_dwordx4 v[100:103], v9, s[4:7], s27 offen offset:0 sc1
    s_waitcnt vmcnt(16)
    v_mfma_f32_16x16x32_bf16 v[144:147], v[104:107], a[228:231], v[144:147]
    v_mfma_f32_16x16x32_bf16 v[148:151], v[104:107], a[236:239], v[148:151]
    v_mfma_f32_16x16x32_bf16 v[152:155], v[104:107], a[244:247], v[152:155]
    v_mfma_f32_16x16x32_bf16 v[156:159], v[104:107], a[252:255], v[156:159]
    buffer_load_dwordx4 v[104:107], v9, s[4:7], s27 offen offset:1024 sc1
    v_add_u32 v9, 65536, v9
    s_waitcnt vmcnt(16)
    v_mfma_f32_16x16x32_bf16 v[160:163], v[44:47], a[0:3], 0
    v_mfma_f32_16x16x32_bf16 v[164:167], v[44:47], a[8:11], 0
    v_mfma_f32_16x16x32_bf16 v[168:171], v[44:47], a[16:19], 0
    v_mfma_f32_16x16x32_bf16 v[172:175], v[44:47], a[24:27], 0
    buffer_load_dwordx4 v[44:47], v9, s[4:7], s20 offen offset:0 sc1
    s_waitcnt vmcnt(16)
    v_mfma_f32_16x16x32_bf16 v[160:163], v[48:51], a[4:7], v[160:163]
    v_mfma_f32_16x16x32_bf16 v[164:167], v[48:51], a[12:15], v[164:167]
    v_mfma_f32_16x16x32_bf16 v[168:171], v[48:51], a[20:23], v[168:171]
    v_mfma_f32_16x16x32_bf16 v[172:175], v[48:51], a[28:31], v[172:175]
    buffer_load_dwordx4 v[48:51], v9, s[4:7], s20 offen offset:1024 sc1
    s_waitcnt vmcnt(16)
    v_mfma_f32_16x16x32_bf16 v[160:163], v[52:55], a[32:35], v[160:163]
    ds_write_b128 v15, v[148:151] offset:1024
    v_mfma_f32_16x16x32_bf16 v[164:167], v[52:55], a[40:43], v[164:167]
    ds_write_b128 v6, v[152:155] offset:2048
    v_mfma_f32_16x16x32_bf16 v[168:171], v[52:55], a[48:51], v[168:171]
    ds_write_b128 v8, v[156:159] offset:3072
    v_mfma_f32_16x16x32_bf16 v[172:175], v[52:55], a[56:59], v[172:175]
    buffer_load_dwordx4 v[52:55], v9, s[4:7], s21 offen offset:0 sc1
    s_waitcnt vmcnt(16)
    v_mfma_f32_16x16x32_bf16 v[160:163], v[56:59], a[36:39], v[160:163]
    v_mfma_f32_16x16x32_bf16 v[164:167], v[56:59], a[44:47], v[164:167]
    v_mfma_f32_16x16x32_bf16 v[168:171], v[56:59], a[52:55], v[168:171]
    v_mfma_f32_16x16x32_bf16 v[172:175], v[56:59], a[60:63], v[172:175]
    buffer_load_dwordx4 v[56:59], v9, s[4:7], s21 offen offset:1024 sc1
    s_waitcnt vmcnt(8)
    s_mov_b64 exec, 3
    buffer_store_dword v13, v133, s[4:7], s71 offen sc1
    s_mov_b64 exec, -1
    s_add_u32 s71, s71, 256
    v_mfma_f32_16x16x32_bf16 v[160:163], v[60:63], a[64:67], v[160:163]
    v_mfma_f32_16x16x32_bf16 v[164:167], v[60:63], a[72:75], v[164:167]
    v_mfma_f32_16x16x32_bf16 v[168:171], v[60:63], a[80:83], v[168:171]
    v_mfma_f32_16x16x32_bf16 v[172:175], v[60:63], a[88:91], v[172:175]
    buffer_load_dwordx4 v[60:63], v9, s[4:7], s22 offen offset:0 sc1
    v_mfma_f32_16x16x32_bf16 v[160:163], v[64:67], a[68:71], v[160:163]
    s_waitcnt lgkmcnt(0)
    s_barrier
    v_mfma_f32_16x16x32_bf16 v[164:167], v[64:67], a[76:79], v[164:167]
    ds_read_b128 v[180:183], v14 offset:1024
    v_mfma_f32_16x16x32_bf16 v[168:171], v[64:67], a[84:87], v[168:171]
    ds_read_b128 v[184:187], v14 offset:2048
    v_mfma_f32_16x16x32_bf16 v[172:175], v[64:67], a[92:95], v[172:175]
    buffer_load_dwordx4 v[64:67], v9, s[4:7], s22 offen offset:1024 sc1
    v_mfma_f32_16x16x32_bf16 v[160:163], v[68:71], a[96:99], v[160:163]
    ds_read_b128 v[188:191], v14 offset:3072
    v_mfma_f32_16x16x32_bf16 v[164:167], v[68:71], a[104:107], v[164:167]
    v_mfma_f32_16x16x32_bf16 v[168:171], v[68:71], a[112:115], v[168:171]
    v_mfma_f32_16x16x32_bf16 v[172:175], v[68:71], a[120:123], v[172:175]
    buffer_load_dwordx4 v[68:71], v9, s[4:7], s23 offen offset:0 sc1
    v_mfma_f32_16x16x32_bf16 v[160:163], v[72:75], a[100:103], v[160:163]
    v_mfma_f32_16x16x32_bf16 v[164:167], v[72:75], a[108:111], v[164:167]
    v_mfma_f32_16x16x32_bf16 v[168:171], v[72:75], a[116:119], v[168:171]
    v_mfma_f32_16x16x32_bf16 v[172:175], v[72:75], a[124:127], v[172:175]
    buffer_load_dwordx4 v[72:75], v9, s[4:7], s23 offen offset:1024 sc1
    v_mfma_f32_16x16x32_bf16 v[160:163], v[76:79], a[128:131], v[160:163]
    v_lshlrev_b32 v200, 16, v36
    v_lshlrev_b32 v201, 16, v37
    v_mfma_f32_16x16x32_bf16 v[164:167], v[76:79], a[136:139], v[164:167]
    v_lshlrev_b32 v202, 16, v38
    v_lshlrev_b32 v203, 16, v39
    v_mfma_f32_16x16x32_bf16 v[168:171], v[76:79], a[144:147], v[168:171]
    v_add_f32 v176, v144, v12
    v_add_f32 v177, v145, v12
    v_mfma_f32_16x16x32_bf16 v[172:175], v[76:79], a[152:155], v[172:175]
    buffer_load_dwordx4 v[76:79], v9, s[4:7], s24 offen offset:0 sc1
    v_mfma_f32_16x16x32_bf16 v[160:163], v[80:83], a[132:135], v[160:163]
    v_add_f32 v178, v146, v12
    v_add_f32 v179, v147, v12
    v_mfma_f32_16x16x32_bf16 v[164:167], v[80:83], a[140:143], v[164:167]
    s_waitcnt lgkmcnt(0)
    v_add_f32 v176, v176, v180
    v_add_f32 v177, v177, v181
    v_mfma_f32_16x16x32_bf16 v[168:171], v[80:83], a[148:151], v[168:171]
    v_add_f32 v178, v178, v182
    v_add_f32 v179, v179, v183
    v_mfma_f32_16x16x32_bf16 v[172:175], v[80:83], a[156:159], v[172:175]
    buffer_load_dwordx4 v[80:83], v9, s[4:7], s24 offen offset:1024 sc1
    v_mfma_f32_16x16x32_bf16 v[160:163], v[84:87], a[160:163], v[160:163]
    v_add_f32 v184, v184, v188
    v_add_f32 v185, v185, v189
    v_mfma_f32_16x16x32_bf16 v[164:167], v[84:87], a[168:171], v[164:167]
    v_add_f32 v186, v186, v190
    v_add_f32 v187, v187, v191
    v_mfma_f32_16x16x32_bf16 v[168:171], v[84:87], a[176:179], v[168:171]
    v_add_f32 v176, v176, v184
    v_add_f32 v177, v177, v185
    v_mfma_f32_16x16x32_bf16 v[172:175], v[84:87], a[184:187], v[172:175]
    buffer_load_dwordx4 v[84:87], v9, s[4:7], s25 offen offset:0 sc1
    v_mfma_f32_16x16x32_bf16 v[160:163], v[88:91], a[164:167], v[160:163]
    v_add_f32 v178, v178, v186
    v_add_f32 v179, v179, v187
    v_mfma_f32_16x16x32_bf16 v[164:167], v[88:91], a[172:175], v[164:167]
    v_mul_f32 v192, v176, v200
    v_mul_f32 v193, v177, v201
    v_mfma_f32_16x16x32_bf16 v[168:171], v[88:91], a[180:183], v[168:171]
    v_mul_f32 v194, v178, v202
    v_mul_f32 v195, v179, v203
    v_mfma_f32_16x16x32_bf16 v[172:175], v[88:91], a[188:191], v[172:175]
    buffer_load_dwordx4 v[88:91], v9, s[4:7], s25 offen offset:1024 sc1
    s_waitcnt vmcnt(16)
    v_mfma_f32_16x16x32_bf16 v[160:163], v[92:95], a[192:195], v[160:163]
    v_mfma_f32_16x16x32_bf16 v[164:167], v[92:95], a[200:203], v[164:167]
    v_mfma_f32_16x16x32_bf16 v[168:171], v[92:95], a[208:211], v[168:171]
    v_mfma_f32_16x16x32_bf16 v[172:175], v[92:95], a[216:219], v[172:175]
    buffer_load_dwordx4 v[92:95], v9, s[4:7], s26 offen offset:0 sc1
    s_waitcnt vmcnt(16)
    v_mfma_f32_16x16x32_bf16 v[160:163], v[96:99], a[196:199], v[160:163]
    v_mfma_f32_16x16x32_bf16 v[164:167], v[96:99], a[204:207], v[164:167]
    v_mfma_f32_16x16x32_bf16 v[168:171], v[96:99], a[212:215], v[168:171]
    v_mfma_f32_16x16x32_bf16 v[172:175], v[96:99], a[220:223], v[172:175]
    buffer_load_dwordx4 v[96:99], v9, s[4:7], s26 offen offset:1024 sc1
    s_waitcnt vmcnt(16)
    v_mfma_f32_16x16x32_bf16 v[160:163], v[100:103], a[224:227], v[160:163]
    v_mfma_f32_16x16x32_bf16 v[164:167], v[100:103], a[232:235], v[164:167]
    v_mfma_f32_16x16x32_bf16 v[168:171], v[100:103], a[240:243], v[168:171]
    v_mfma_f32_16x16x32_bf16 v[172:175], v[100:103], a[248:251], v[172:175]
    buffer_load_dwordx4 v[100:103], v9, s[4:7], s27 offen offset:0 sc1
    s_waitcnt vmcnt(16)
    v_mfma_f32_16x16x32_bf16 v[160:163], v[104:107], a[228:231], v[160:163]
    v_mfma_f32_16x16x32_bf16 v[164:167], v[104:107], a[236:239], v[164:167]
    v_mfma_f32_16x16x32_bf16 v[168:171], v[104:107], a[244:247], v[168:171]
    v_mfma_f32_16x16x32_bf16 v[172:175], v[104:107], a[252:255], v[172:175]
    buffer_load_dwordx4 v[104:107], v9, s[4:7], s27 offen offset:1024 sc1
    v_add_u32 v9, 65536, v9
    s_waitcnt vmcnt(16)
    v_mfma_f32_16x16x32_bf16 v[144:147], v[44:47], a[0:3], 0
    v_mfma_f32_16x16x32_bf16 v[148:151], v[44:47], a[8:11], 0
    v_mfma_f32_16x16x32_bf16 v[152:155], v[44:47], a[16:19], 0
    v_mfma_f32_16x16x32_bf16 v[156:159], v[44:47], a[24:27], 0
    s_add_u32 m0, s53, 40960
    s_nop 0
    buffer_load_dwordx4 v241, s[4:7], s59 offen offset:0 sc1 lds
    s_waitcnt vmcnt(16)
    v_mfma_f32_16x16x32_bf16 v[144:147], v[48:51], a[4:7], v[144:147]
    v_mfma_f32_16x16x32_bf16 v[148:151], v[48:51], a[12:15], v[148:151]
    v_mfma_f32_16x16x32_bf16 v[152:155], v[48:51], a[20:23], v[152:155]
    v_mfma_f32_16x16x32_bf16 v[156:159], v[48:51], a[28:31], v[156:159]
    buffer_load_dwordx4 v241, s[4:7], s59 offen offset:1024 sc1 lds
    buffer_load_dword v27, v26, s[4:7], s55 offen sc1
    s_waitcnt vmcnt(17)
    v_mfma_f32_16x16x32_bf16 v[144:147], v[52:55], a[32:35], v[144:147]
    ds_write_b128 v15, v[164:167] offset:17408
    v_mfma_f32_16x16x32_bf16 v[148:151], v[52:55], a[40:43], v[148:151]
    ds_write_b128 v6, v[168:171] offset:18432
    v_mfma_f32_16x16x32_bf16 v[152:155], v[52:55], a[48:51], v[152:155]
    ds_write_b128 v8, v[172:175] offset:19456
    v_mfma_f32_16x16x32_bf16 v[156:159], v[52:55], a[56:59], v[156:159]
    buffer_load_dwordx4 v241, s[4:7], s59 offen offset:2048 sc1 lds
    s_waitcnt vmcnt(17)
    v_mfma_f32_16x16x32_bf16 v[144:147], v[56:59], a[36:39], v[144:147]
    v_mfma_f32_16x16x32_bf16 v[148:151], v[56:59], a[44:47], v[148:151]
    v_mfma_f32_16x16x32_bf16 v[152:155], v[56:59], a[52:55], v[152:155]
    v_mfma_f32_16x16x32_bf16 v[156:159], v[56:59], a[60:63], v[156:159]
    buffer_load_dwordx4 v241, s[4:7], s59 offen offset:3072 sc1 lds
    s_add_u32 s59, s59, 4096
    s_waitcnt vmcnt(16)
    v_mfma_f32_16x16x32_bf16 v[144:147], v[60:63], a[64:67], v[144:147]
    v_mfma_f32_16x16x32_bf16 v[148:151], v[60:63], a[72:75], v[148:151]
    v_mfma_f32_16x16x32_bf16 v[152:155], v[60:63], a[80:83], v[152:155]
    v_mfma_f32_16x16x32_bf16 v[156:159], v[60:63], a[88:91], v[156:159]
    s_add_u32 m0, s53, 45056
    s_nop 0
    buffer_load_dwordx4 v241, s[4:7], s59 offen offset:0 sc1 lds
    s_add_u32 s59, s59, 16384
    s_waitcnt vmcnt(16) lgkmcnt(0)
    v_mfma_f32_16x16x32_bf16 v[144:147], v[64:67], a[68:71], v[144:147]
    s_barrier
    v_mfma_f32_16x16x32_bf16 v[148:151], v[64:67], a[76:79], v[148:151]
    ds_read_b128 v[180:183], v14 offset:17408
    v_mfma_f32_16x16x32_bf16 v[152:155], v[64:67], a[84:87], v[152:155]
    ds_read_b128 v[184:187], v14 offset:18432
    v_mfma_f32_16x16x32_bf16 v[156:159], v[64:67], a[92:95], v[156:159]
    s_add_u32 m0, s53, 61440
    s_nop 0
    buffer_load_dwordx4 v241, s[4:7], s59 offen offset:0 sc1 lds
    s_waitcnt vmcnt(16)
    v_mfma_f32_16x16x32_bf16 v[144:147], v[68:71], a[96:99], v[144:147]
    ds_read_b128 v[188:191], v14 offset:19456
    v_mfma_f32_16x16x32_bf16 v[148:151], v[68:71], a[104:107], v[148:151]
    v_mfma_f32_16x16x32_bf16 v[152:155], v[68:71], a[112:115], v[152:155]
    v_mfma_f32_16x16x32_bf16 v[156:159], v[68:71], a[120:123], v[156:159]
    buffer_load_dwordx4 v241, s[4:7], s59 offen offset:1024 sc1 lds
    s_waitcnt vmcnt(16) lgkmcnt(2)
    v_mfma_f32_16x16x32_bf16 v[144:147], v[72:75], a[100:103], v[144:147]
    v_mfma_f32_16x16x32_bf16 v[148:151], v[72:75], a[108:111], v[148:151]
    v_mfma_f32_16x16x32_bf16 v[152:155], v[72:75], a[116:119], v[152:155]
    v_mfma_f32_16x16x32_bf16 v[156:159], v[72:75], a[124:127], v[156:159]
    buffer_load_dwordx4 v241, s[4:7], s59 offen offset:2048 sc1 lds
    s_waitcnt vmcnt(16) lgkmcnt(0)
    v_mfma_f32_16x16x32_bf16 v[144:147], v[76:79], a[128:131], v[144:147]
    v_and_b32 v200, s3, v36
    v_and_b32 v201, s3, v37
    v_mfma_f32_16x16x32_bf16 v[148:151], v[76:79], a[136:139], v[148:151]
    v_and_b32 v202, s3, v38
    v_and_b32 v203, s3, v39
    v_mfma_f32_16x16x32_bf16 v[152:155], v[76:79], a[144:147], v[152:155]
    v_add_f32 v176, v160, v12
    v_add_f32 v177, v161, v12
    v_mfma_f32_16x16x32_bf16 v[156:159], v[76:79], a[152:155], v[156:159]
    buffer_load_dwordx4 v241, s[4:7], s59 offen offset:3072 sc1 lds
    s_add_u32 s59, s59, 4096
    s_waitcnt vmcnt(16)
    v_mfma_f32_16x16x32_bf16 v[144:147], v[80:83], a[132:135], v[144:147]
    v_add_f32 v178, v162, v12
    v_add_f32 v179, v163, v12
    v_mfma_f32_16x16x32_bf16 v[148:151], v[80:83], a[140:143], v[148:151]
    v_add_f32 v176, v176, v180
    v_add_f32 v177, v177, v181
    v_mfma_f32_16x16x32_bf16 v[152:155], v[80:83], a[148:151], v[152:155]
    v_add_f32 v178, v178, v182
    v_add_f32 v179, v179, v183
    v_mfma_f32_16x16x32_bf16 v[156:159], v[80:83], a[156:159], v[156:159]
    s_add_u32 m0, s53, 65536
    s_nop 0
    buffer_load_dwordx4 v241, s[4:7], s59 offen offset:0 sc1 lds
    s_add_u32 s59, s59, 16384
    s_waitcnt vmcnt(16)
    v_mfma_f32_16x16x32_bf16 v[144:147], v[84:87], a[160:163], v[144:147]
    v_add_f32 v184, v184, v188
    v_add_f32 v185, v185, v189
    v_mfma_f32_16x16x32_bf16 v[148:151], v[84:87], a[168:171], v[148:151]
    v_add_f32 v186, v186, v190
    v_add_f32 v187, v187, v191
    v_mfma_f32_16x16x32_bf16 v[152:155], v[84:87], a[176:179], v[152:155]
    v_add_f32 v176, v176, v184
    v_add_f32 v177, v177, v185
    v_mfma_f32_16x16x32_bf16 v[156:159], v[84:87], a[184:187], v[156:159]
    s_waitcnt vmcnt(8)
    v_cmp_ne_u32 vcc, s48, v27
    s_nop 0
    s_cbranch_vccnz L_adaL_slow_34
L_adaL_got_36:
    s_add_u32 s55, s55, 256
    buffer_load_dwordx4 a[0:3], v241, s[4:7], s85 offen offset:0 sc1
    v_mfma_f32_16x16x32_bf16 v[144:147], v[88:91], a[164:167], v[144:147]
    v_add_f32 v178, v178, v186
    v_add_f32 v179, v179, v187
    v_mfma_f32_16x16x32_bf16 v[148:151], v[88:91], a[172:175], v[148:151]
    v_mul_f32 v196, v176, v200
    v_mul_f32 v197, v177, v201
    v_mfma_f32_16x16x32_bf16 v[152:155], v[88:91], a[180:183], v[152:155]
    v_mul_f32 v198, v178, v202
    v_mul_f32 v199, v179, v203
    v_mfma_f32_16x16x32_bf16 v[156:159], v[88:91], a[188:191], v[156:159]
    buffer_load_dwordx4 a[4:7], v241, s[4:7], s85 offen offset:1024 sc1
    v_mfma_f32_16x16x32_bf16 v[144:147], v[92:95], a[192:195], v[144:147]
    v_cvt_pk_bf16_f32 v36, v192, v196
    v_cvt_pk_bf16_f32 v37, v193, v197
    v_mfma_f32_16x16x32_bf16 v[148:151], v[92:95], a[200:203], v[148:151]
    v_cvt_pk_bf16_f32 v38, v194, v198
    v_cvt_pk_bf16_f32 v39, v195, v199
    v_mfma_f32_16x16x32_bf16 v[152:155], v[92:95], a[208:211], v[152:155]
    buffer_store_dwordx4 v[36:39], v241, s[4:7], s70 offen sc1
    v_mfma_f32_16x16x32_bf16 v[156:159], v[92:95], a[216:219], v[156:159]
    buffer_load_dwordx4 a[8:11], v241, s[4:7], s85 offen offset:2048 sc1
    v_mfma_f32_16x16x32_bf16 v[144:147], v[96:99], a[196:199], v[144:147]
    v_mfma_f32_16x16x32_bf16 v[148:151], v[96:99], a[204:207], v[148:151]
    v_mfma_f32_16x16x32_bf16 v[152:155], v[96:99], a[212:215], v[152:155]
    v_mfma_f32_16x16x32_bf16 v[156:159], v[96:99], a[220:223], v[156:159]
    buffer_load_dwordx4 a[12:15], v241, s[4:7], s85 offen offset:3072 sc1
    s_add_u32 s85, s85, 4096
    v_mfma_f32_16x16x32_bf16 v[144:147], v[100:103], a[224:227], v[144:147]
    v_mfma_f32_16x16x32_bf16 v[148:151], v[100:103], a[232:235], v[148:151]
    v_mfma_f32_16x16x32_bf16 v[152:155], v[100:103], a[240:243], v[152:155]
    v_mfma_f32_16x16x32_bf16 v[156:159], v[100:103], a[248:251], v[156:159]
    buffer_load_dwordx4 a[16:19], v241, s[4:7], s85 offen offset:0 sc1
    v_mfma_f32_16x16x32_bf16 v[144:147], v[104:107], a[228:231], v[144:147]
    v_mfma_f32_16x16x32_bf16 v[148:151], v[104:107], a[236:239], v[148:151]
    v_mfma_f32_16x16x32_bf16 v[152:155], v[104:107], a[244:247], v[152:155]
    v_mfma_f32_16x16x32_bf16 v[156:159], v[104:107], a[252:255], v[156:159]
    buffer_load_dwordx4 a[20:23], v241, s[4:7], s85 offen offset:1024 sc1
    s_nop 4
    ds_write_b128 v15, v[148:151] offset:1024
    ds_write_b128 v6, v[152:155] offset:2048
    ds_write_b128 v8, v[156:159] offset:3072
    buffer_load_dwordx4 a[24:27], v241, s[4:7], s85 offen offset:2048 sc1
    buffer_load_dwordx4 a[28:31], v241, s[4:7], s85 offen offset:3072 sc1
    s_add_u32 s85, s85, 4096
    s_waitcnt vmcnt(9)
    s_waitcnt lgkmcnt(0)
    s_barrier
    ds_read_b128 v[180:183], v14 offset:1024
    ds_read_b128 v[184:187], v14 offset:2048
    ds_read_b128 v[188:191], v14 offset:3072
    s_add_u32 m0, s53, 81920
    s_nop 0
    buffer_load_dwordx4 v241, s[4:7], s59 offen offset:0 sc1 lds
    buffer_load_dwordx4 v241, s[4:7], s59 offen offset:1024 sc1 lds
    ds_read_b128 v[64:67], v128 offset:20480
    ds_read_b128 v[68:71], v128 offset:21504
    ds_read_b128 v[72:75], v128 offset:22528
    ds_read_b128 v[76:79], v128 offset:23552
    ds_read_b128 v[80:83], v128 offset:24576
    ds_read_b128 v[84:87], v128 offset:25600
    ds_read_b128 v[88:91], v128 offset:26624
    ds_read_b128 v[92:95], v128 offset:27648
    v_lshlrev_b32 v200, 16, v40
    v_lshlrev_b32 v201, 16, v41
    v_lshlrev_b32 v202, 16, v42
    v_lshlrev_b32 v203, 16, v43
    v_add_f32 v176, v144, v12
    v_add_f32 v177, v145, v12
    v_add_f32 v178, v146, v12
    v_add_f32 v179, v147, v12
    s_waitcnt lgkmcnt(10)
    v_add_f32 v176, v176, v180
    v_add_f32 v177, v177, v181
    v_add_f32 v178, v178, v182
    v_add_f32 v179, v179, v183
    s_waitcnt lgkmcnt(8)
    v_add_f32 v184, v184, v188
    v_add_f32 v185, v185, v189
    v_add_f32 v186, v186, v190
    v_add_f32 v187, v187, v191
    v_add_f32 v176, v176, v184
    v_add_f32 v177, v177, v185
    v_add_f32 v178, v178, v186
    v_add_f32 v179, v179, v187
    v_mul_f32 v192, v176, v200
    v_mul_f32 v193, v177, v201
    v_mul_f32 v194, v178, v202
    v_mul_f32 v195, v179, v203
    v_cvt_pk_bf16_f32 v204, v192, v193
    v_cvt_pk_bf16_f32 v205, v194, v195
    buffer_store_dwordx2 v[204:205], v5, s[4:7], s58 offen sc1
    s_waitcnt vmcnt(9) lgkmcnt(0)
    s_mov_b64 exec, 3
    buffer_store_dword v13, v133, s[4:7], s71 offen sc1
    s_mov_b64 exec, -1
    s_add_u32 s71, s71, 256
    v_mfma_f32_16x16x32_bf16 v[44:47], v[64:67], a[0:3], 0
    ds_read_b128 v[96:99], v128 offset:28672
    v_mfma_f32_16x16x32_bf16 v[48:51], v[68:71], a[0:3], 0
    ds_read_b128 v[100:103], v128 offset:29696
    buffer_load_dwordx4 v241, s[4:7], s59 offen offset:2048 sc1 lds
    v_mfma_f32_16x16x32_bf16 v[52:55], v[72:75], a[0:3], 0
    ds_read_b128 v[64:67], v128 offset:30720
    v_mfma_f32_16x16x32_bf16 v[56:59], v[76:79], a[0:3], 0
    ds_read_b128 v[68:71], v128 offset:31744
    buffer_load_dwordx4 v241, s[4:7], s59 offen offset:3072 sc1 lds
    s_add_u32 s59, s59, 4096
    v_mfma_f32_16x16x32_bf16 v[60:63], v[80:83], a[0:3], 0
    ds_read_b128 v[72:75], v128 offset:32768
    v_mfma_f32_16x16x32_bf16 v[44:47], v[84:87], a[4:7], v[44:47]
    ds_read_b128 v[76:79], v128 offset:33792
    v_mfma_f32_16x16x32_bf16 v[48:51], v[88:91], a[4:7], v[48:51]
    ds_read_b128 v[80:83], v128 offset:34816
    s_add_u32 m0, s53, 86016
    s_nop 0
    buffer_load_dwordx4 v241, s[4:7], s59 offen offset:0 sc1 lds
    s_add_u32 s59, s59, 16384
    v_mfma_f32_16x16x32_bf16 v[52:55], v[92:95], a[4:7], v[52:55]
    ds_read_b128 v[84:87], v128 offset:35840
    s_waitcnt lgkmcnt(6)
    v_mfma_f32_16x16x32_bf16 v[56:59], v[96:99], a[4:7], v[56:59]
    ds_read_b128 v[88:91], v128 offset:36864
    s_add_u32 m0, s53, 102400
    s_nop 0
    buffer_load_dwordx4 v241, s[4:7], s59 offen offset:0 sc1 lds
    v_mfma_f32_16x16x32_bf16 v[60:63], v[100:103], a[4:7], v[60:63]
    ds_read_b128 v[92:95], v128 offset:37888
    s_waitcnt vmcnt(13) lgkmcnt(6)
    v_mfma_f32_16x16x32_bf16 v[44:47], v[64:67], a[8:11], v[44:47]
    ds_read_b128 v[96:99], v128 offset:38912
    v_mfma_f32_16x16x32_bf16 v[48:51], v[68:71], a[8:11], v[48:51]
    ds_read_b128 v[100:103], v128 offset:39936
    buffer_load_dwordx4 v241, s[4:7], s59 offen offset:1024 sc1 lds
    s_waitcnt lgkmcnt(6)
    v_mfma_f32_16x16x32_bf16 v[52:55], v[72:75], a[8:11], v[52:55]
    ds_read_b128 v[64:67], v128 offset:40960
    v_mfma_f32_16x16x32_bf16 v[56:59], v[76:79], a[8:11], v[56:59]
    ds_read_b128 v[68:71], v128 offset:41984
    buffer_load_dwordx4 v241, s[4:7], s59 offen offset:2048 sc1 lds
    s_waitcnt lgkmcnt(6)
    v_mfma_f32_16x16x32_bf16 v[60:63], v[80:83], a[8:11], v[60:63]
    ds_read_b128 v[72:75], v128 offset:43008
    s_waitcnt vmcnt(14) lgkmcnt(6)
    v_mfma_f32_16x16x32_bf16 v[44:47], v[84:87], a[12:15], v[44:47]
    ds_read_b128 v[76:79], v128 offset:44032
    v_mfma_f32_16x16x32_bf16 v[48:51], v[88:91], a[12:15], v[48:51]
    ds_read_b128 v[80:83], v128 offset:45056
    buffer_load_dwordx4 v241, s[4:7], s59 offen offset:3072 sc1 lds
    s_add_u32 s59, s59, 4096
    s_waitcnt lgkmcnt(6)
    v_mfma_f32_16x16x32_bf16 v[52:55], v[92:95], a[12:15], v[52:55]
    ds_read_b128 v[84:87], v128 offset:46080
    v_mfma_f32_16x16x32_bf16 v[56:59], v[96:99], a[12:15], v[56:59]
    ds_read_b128 v[88:91], v128 offset:47104
    s_add_u32 m0, s53, 106496
    s_nop 0
    buffer_load_dwordx4 v241, s[4:7], s59 offen offset:0 sc1 lds
    s_add_u32 s59, s59, 16384
    s_waitcnt lgkmcnt(6)
    v_mfma_f32_16x16x32_bf16 v[60:63], v[100:103], a[12:15], v[60:63]
    ds_read_b128 v[92:95], v128 offset:48128
    s_waitcnt vmcnt(15) lgkmcnt(6)
    v_mfma_f32_16x16x32_bf16 v[44:47], v[64:67], a[16:19], v[44:47]
    ds_read_b128 v[96:99], v128 offset:49152
    v_mfma_f32_16x16x32_bf16 v[48:51], v[68:71], a[16:19], v[48:51]
    ds_read_b128 v[100:103], v128 offset:50176
    buffer_load_dwordx4 a[32:35], v241, s[4:7], s85 offen offset:0 sc1
    s_waitcnt lgkmcnt(6)
    v_mfma_f32_16x16x32_bf16 v[52:55], v[72:75], a[16:19], v[52:55]
    ds_read_b128 v[64:67], v128 offset:51200
    v_mfma_f32_16x16x32_bf16 v[56:59], v[76:79], a[16:19], v[56:59]
    ds_read_b128 v[68:71], v128 offset:52224
    buffer_load_dwordx4 a[36:39], v241, s[4:7], s85 offen offset:1024 sc1
    s_waitcnt lgkmcnt(6)
    v_mfma_f32_16x16x32_bf16 v[60:63], v[80:83], a[16:19], v[60:63]
    ds_read_b128 v[72:75], v128 offset:53248
    s_waitcnt vmcnt(16) lgkmcnt(6)
    v_mfma_f32_16x16x32_bf16 v[44:47], v[84:87], a[20:23], v[44:47]
    ds_read_b128 v[76:79], v128 offset:54272
    v_mfma_f32_16x16x32_bf16 v[48:51], v[88:91], a[20:23], v[48:51]
    ds_read_b128 v[80:83], v128 offset:55296
    buffer_load_dwordx4 a[40:43], v241, s[4:7], s85 offen offset:2048 sc1
    s_waitcnt lgkmcnt(6)
    v_mfma_f32_16x16x32_bf16 v[52:55], v[92:95], a[20:23], v[52:55]
    ds_read_b128 v[84:87], v128 offset:56320
    v_mfma_f32_16x16x32_bf16 v[56:59], v[96:99], a[20:23], v[56:59]
    ds_read_b128 v[88:91], v128 offset:57344
    buffer_load_dwordx4 a[44:47], v241, s[4:7], s85 offen offset:3072 sc1
    s_add_u32 s85, s85, 4096
    s_waitcnt lgkmcnt(6)
    v_mfma_f32_16x16x32_bf16 v[60:63], v[100:103], a[20:23], v[60:63]
    ds_read_b128 v[92:95], v128 offset:58368
    s_waitcnt vmcnt(13) lgkmcnt(6)
    s_mov_b64 exec, 3
    buffer_store_dword v13, v133, s[4:7], s71 offen sc1
    s_mov_b64 exec, -1
    v_mfma_f32_16x16x32_bf16 v[44:47], v[64:67], a[24:27], v[44:47]
    ds_read_b128 v[96:99], v128 offset:59392
    v_mfma_f32_16x16x32_bf16 v[48:51], v[68:71], a[24:27], v[48:51]
    ds_read_b128 v[100:103], v128 offset:60416
    buffer_load_dwordx4 a[48:51], v241, s[4:7], s85 offen offset:0 sc1
    s_waitcnt vmcnt(6) lgkmcnt(6)
    s_barrier
    v_mfma_f32_16x16x32_bf16 v[52:55], v[72:75], a[24:27], v[52:55]
    ds_read_b128 v[64:67], v129 offset:0
    v_mfma_f32_16x16x32_bf16 v[56:59], v[76:79], a[24:27], v[56:59]
    ds_read_b128 v[68:71], v129 offset:1024
    buffer_load_dwordx4 a[52:55], v241, s[4:7], s85 offen offset:1024 sc1
    s_waitcnt lgkmcnt(6)
    v_mfma_f32_16x16x32_bf16 v[60:63], v[80:83], a[24:27], v[60:63]
    ds_read_b128 v[72:75], v129 offset:2048
    v_mfma_f32_16x16x32_bf16 v[44:47], v[84:87], a[28:31], v[44:47]
    ds_read_b128 v[76:79], v129 offset:3072
    s_waitcnt lgkmcnt(6)
    v_mfma_f32_16x16x32_bf16 v[48:51], v[88:91], a[28:31], v[48:51]
    ds_read_b128 v[80:83], v129 offset:4096
    buffer_load_dwordx4 a[56:59], v241, s[4:7], s85 offen offset:2048 sc1
    v_mfma_f32_16x16x32_bf16 v[52:55], v[92:95], a[28:31], v[52:55]
    ds_read_b128 v[84:87], v129 offset:5120
    s_waitcnt lgkmcnt(6)
    v_mfma_f32_16x16x32_bf16 v[56:59], v[96:99], a[28:31], v[56:59]
    ds_read_b128 v[88:91], v129 offset:6144
    buffer_load_dwordx4 a[60:63], v241, s[4:7], s85 offen offset:3072 sc1
    s_add_u32 s85, s85, 4096
    v_mfma_f32_16x16x32_bf16 v[60:63], v[100:103], a[28:31], v[60:63]
    ds_read_b128 v[92:95], v129 offset:7168
    s_waitcnt vmcnt(8) lgkmcnt(6)
    v_mfma_f32_16x16x32_bf16 v[44:47], v[64:67], a[32:35], v[44:47]
    ds_read_b128 v[96:99], v129 offset:8192
    v_mfma_f32_16x16x32_bf16 v[48:51], v[68:71], a[32:35], v[48:51]
    ds_read_b128 v[100:103], v129 offset:9216
    s_add_u32 m0, s53, 122880
    s_nop 0
    buffer_load_dwordx4 v241, s[4:7], s59 offen offset:0 sc1 lds
    s_waitcnt lgkmcnt(6)
    v_mfma_f32_16x16x32_bf16 v[52:55], v[72:75], a[32:35], v[52:55]
    ds_read_b128 v[64:67], v129 offset:10240
    v_mfma_f32_16x16x32_bf16 v[56:59], v[76:79], a[32:35], v[56:59]
    ds_read_b128 v[68:71], v129 offset:11264
    buffer_load_dwordx4 v241, s[4:7], s59 offen offset:1024 sc1 lds
    s_waitcnt lgkmcnt(6)
    v_mfma_f32_16x16x32_bf16 v[60:63], v[80:83], a[32:35], v[60:63]
    ds_read_b128 v[72:75], v129 offset:12288
    buffer_load_dword v27, v26, s[4:7], s55 offen sc1
    s_waitcnt vmcnt(10) lgkmcnt(6)
    v_mfma_f32_16x16x32_bf16 v[44:47], v[84:87], a[36:39], v[44:47]
    ds_read_b128 v[76:79], v129 offset:13312
    v_mfma_f32_16x16x32_bf16 v[48:51], v[88:91], a[36:39], v[48:51]
    ds_read_b128 v[80:83], v129 offset:14336
    buffer_load_dwordx4 v241, s[4:7], s59 offen offset:2048 sc1 lds
    s_waitcnt lgkmcnt(6)
    v_mfma_f32_16x16x32_bf16 v[52:55], v[92:95], a[36:39], v[52:55]
    ds_read_b128 v[84:87], v129 offset:15360
    v_mfma_f32_16x16x32_bf16 v[56:59], v[96:99], a[36:39], v[56:59]
    ds_read_b128 v[88:91], v129 offset:16384
    buffer_load_dwordx4 v241, s[4:7], s59 offen offset:3072 sc1 lds
    s_add_u32 s59, s59, 4096
    s_waitcnt lgkmcnt(6)
    v_mfma_f32_16x16x32_bf16 v[60:63], v[100:103], a[36:39], v[60:63]
    ds_read_b128 v[92:95], v129 offset:17408
    s_waitcnt vmcnt(11) lgkmcnt(6)
    v_mfma_f32_16x16x32_bf16 v[44:47], v[64:67], a[40:43], v[44:47]
    ds_read_b128 v[96:99], v129 offset:18432
    v_mfma_f32_16x16x32_bf16 v[48:51], v[68:71], a[40:43], v[48:51]
    ds_read_b128 v[100:103], v129 offset:19456
    s_add_u32 m0, s53, 126976
    s_nop 0
    buffer_load_dwordx4 v241, s[4:7], s59 offen offset:0 sc1 lds
    s_add_u32 s59, s59, 16384
    s_waitcnt lgkmcnt(6)
    v_mfma_f32_16x16x32_bf16 v[52:55], v[72:75], a[40:43], v[52:55]
    ds_read_b128 v[64:67], v129 offset:20480
    v_mfma_f32_16x16x32_bf16 v[56:59], v[76:79], a[40:43], v[56:59]
    ds_read_b128 v[68:71], v129 offset:21504
    s_add_u32 m0, s53, 143360
    s_nop 0
    buffer_load_dwordx4 v241, s[4:7], s59 offen offset:0 sc1 lds
    s_waitcnt lgkmcnt(6)
    v_mfma_f32_16x16x32_bf16 v[60:63], v[80:83], a[40:43], v[60:63]
    ds_read_b128 v[72:75], v129 offset:22528
    s_waitcnt vmcnt(12) lgkmcnt(6)
    v_mfma_f32_16x16x32_bf16 v[44:47], v[84:87], a[44:47], v[44:47]
    ds_read_b128 v[76:79], v129 offset:23552
    v_mfma_f32_16x16x32_bf16 v[48:51], v[88:91], a[44:47], v[48:51]
    ds_read_b128 v[80:83], v129 offset:24576
    buffer_load_dwordx4 v241, s[4:7], s59 offen offset:1024 sc1 lds
    s_waitcnt lgkmcnt(6)
    v_mfma_f32_16x16x32_bf16 v[52:55], v[92:95], a[44:47], v[52:55]
    ds_read_b128 v[84:87], v129 offset:25600
    v_mfma_f32_16x16x32_bf16 v[56:59], v[96:99], a[44:47], v[56:59]
    ds_read_b128 v[88:91], v129 offset:26624
    buffer_load_dwordx4 v241, s[4:7], s59 offen offset:2048 sc1 lds
    s_waitcnt lgkmcnt(6)
    v_mfma_f32_16x16x32_bf16 v[60:63], v[100:103], a[44:47], v[60:63]
    ds_read_b128 v[92:95], v129 offset:27648
    buffer_load_dwordx4 v241, s[4:7], s59 offen offset:3072 sc1 lds
    s_add_u32 s59, s59, 4096
    s_add_u32 m0, s53, 147456
    s_nop 0
    buffer_load_dwordx4 v241, s[4:7], s59 offen offset:0 sc1 lds
    s_add_u32 s59, s59, 16384
    s_waitcnt vmcnt(8) lgkmcnt(6)
    v_cmp_ne_u32 vcc, s48, v27
    s_nop 0
    s_cbranch_vccnz L_adaL_slow_37
L_adaL_got_39:
    s_add_u32 s55, s55, 256
    v_mfma_f32_16x16x32_bf16 v[44:47], v[64:67], a[48:51], v[44:47]
    ds_read_b128 v[96:99], v129 offset:28672
    v_mfma_f32_16x16x32_bf16 v[48:51], v[68:71], a[48:51], v[48:51]
    ds_read_b128 v[100:103], v129 offset:29696
    buffer_load_dwordx4 a[64:67], v241, s[4:7], s85 offen offset:0 sc1
    s_waitcnt lgkmcnt(6)
    v_mfma_f32_16x16x32_bf16 v[52:55], v[72:75], a[48:51], v[52:55]
    ds_read_b128 v[64:67], v129 offset:30720
    v_mfma_f32_16x16x32_bf16 v[56:59], v[76:79], a[48:51], v[56:59]
    ds_read_b128 v[68:71], v129 offset:31744
    buffer_load_dwordx4 a[68:71], v241, s[4:7], s85 offen offset:1024 sc1
    s_waitcnt lgkmcnt(6)
    v_mfma_f32_16x16x32_bf16 v[60:63], v[80:83], a[48:51], v[60:63]
    ds_read_b128 v[72:75], v129 offset:32768
    v_mfma_f32_16x16x32_bf16 v[44:47], v[84:87], a[52:55], v[44:47]
    ds_read_b128 v[76:79], v129 offset:33792
    s_waitcnt lgkmcnt(6)
    v_mfma_f32_16x16x32_bf16 v[48:51], v[88:91], a[52:55], v[48:51]
    ds_read_b128 v[80:83], v129 offset:34816
    buffer_load_dwordx4 a[72:75], v241, s[4:7], s85 offen offset:2048 sc1
    v_mfma_f32_16x16x32_bf16 v[52:55], v[92:95], a[52:55], v[52:55]
    ds_read_b128 v[84:87], v129 offset:35840
    s_waitcnt lgkmcnt(6)
    v_mfma_f32_16x16x32_bf16 v[56:59], v[96:99], a[52:55], v[56:59]
    ds_read_b128 v[88:91], v129 offset:36864
    buffer_load_dwordx4 a[76:79], v241, s[4:7], s85 offen offset:3072 sc1
    s_add_u32 s85, s85, 4096
    v_mfma_f32_16x16x32_bf16 v[60:63], v[100:103], a[52:55], v[60:63]
    ds_read_b128 v[92:95], v129 offset:37888
    s_waitcnt lgkmcnt(6)
    v_mfma_f32_16x16x32_bf16 v[44:47], v[64:67], a[56:59], v[44:47]
    ds_read_b128 v[96:99], v129 offset:38912
    v_mfma_f32_16x16x32_bf16 v[48:51], v[68:71], a[56:59], v[48:51]
    ds_read_b128 v[100:103], v129 offset:39936
    buffer_load_dwordx4 a[80:83], v241, s[4:7], s85 offen offset:0 sc1
    s_waitcnt vmcnt(5) lgkmcnt(6)
    s_barrier
    v_mfma_f32_16x16x32_bf16 v[52:55], v[72:75], a[56:59], v[52:55]
    ds_read_b128 v[64:67], v129 offset:40960
    v_mfma_f32_16x16x32_bf16 v[56:59], v[76:79], a[56:59], v[56:59]
    ds_read_b128 v[68:71], v129 offset:41984
    buffer_load_dwordx4 a[84:87], v241, s[4:7], s85 offen offset:1024 sc1
    s_waitcnt lgkmcnt(6)
    v_mfma_f32_16x16x32_bf16 v[60:63], v[80:83], a[56:59], v[60:63]
    ds_read_b128 v[72:75], v129 offset:43008
    buffer_load_dword v27, v26, s[4:7], s55 offen sc1
    v_mfma_f32_16x16x32_bf16 v[44:47], v[84:87], a[60:63], v[44:47]
    ds_read_b128 v[76:79], v129 offset:44032
    s_waitcnt lgkmcnt(6)
    v_mfma_f32_16x16x32_bf16 v[48:51], v[88:91], a[60:63], v[48:51]
    ds_read_b128 v[80:83], v129 offset:45056
    buffer_load_dwordx4 a[88:91], v241, s[4:7], s85 offen offset:2048 sc1
    v_mfma_f32_16x16x32_bf16 v[52:55], v[92:95], a[60:63], v[52:55]
    ds_read_b128 v[84:87], v129 offset:46080
    s_waitcnt lgkmcnt(6)
    v_mfma_f32_16x16x32_bf16 v[56:59], v[96:99], a[60:63], v[56:59]
    ds_read_b128 v[88:91], v129 offset:47104
    buffer_load_dwordx4 a[92:95], v241, s[4:7], s85 offen offset:3072 sc1
    s_add_u32 s85, s85, 4096
    v_mfma_f32_16x16x32_bf16 v[60:63], v[100:103], a[60:63], v[60:63]
    ds_read_b128 v[92:95], v129 offset:48128
    s_waitcnt vmcnt(8) lgkmcnt(6)
    v_mfma_f32_16x16x32_bf16 v[44:47], v[64:67], a[64:67], v[44:47]
    ds_read_b128 v[96:99], v129 offset:49152
    v_lshlrev_b32 v108, 16, v230
    v_mfma_f32_16x16x32_bf16 v[48:51], v[68:71], a[64:67], v[48:51]
    ds_read_b128 v[100:103], v129 offset:50176
    s_add_u32 m0, s53, 20480
    s_nop 0
    buffer_load_dwordx4 v241, s[4:7], s59 offen offset:0 sc1 lds
    s_waitcnt lgkmcnt(6)
    v_mfma_f32_16x16x32_bf16 v[52:55], v[72:75], a[64:67], v[52:55]
    ds_read_b128 v[64:67], v129 offset:51200
    v_and_b32 v109, s3, v230
    v_mfma_f32_16x16x32_bf16 v[56:59], v[76:79], a[64:67], v[56:59]
    ds_read_b128 v[68:71], v129 offset:52224
    buffer_load_dwordx4 v241, s[4:7], s59 offen offset:1024 sc1 lds
    s_waitcnt lgkmcnt(6)
    v_mfma_f32_16x16x32_bf16 v[60:63], v[80:83], a[64:67], v[60:63]
    ds_read_b128 v[72:75], v129 offset:53248
    v_lshlrev_b32 v110, 16, v231
    s_waitcnt vmcnt(9) lgkmcnt(6)
    v_mfma_f32_16x16x32_bf16 v[44:47], v[84:87], a[68:71], v[44:47]
    ds_read_b128 v[76:79], v129 offset:54272
    v_and_b32 v111, s3, v231
    v_mfma_f32_16x16x32_bf16 v[48:51], v[88:91], a[68:71], v[48:51]
    ds_read_b128 v[80:83], v129 offset:55296
    buffer_load_dwordx4 v241, s[4:7], s59 offen offset:2048 sc1 lds
    s_waitcnt lgkmcnt(6)
    v_mfma_f32_16x16x32_bf16 v[52:55], v[92:95], a[68:71], v[52:55]
    ds_read_b128 v[84:87], v129 offset:56320
    v_lshlrev_b32 v112, 16, v232
    v_mfma_f32_16x16x32_bf16 v[56:59], v[96:99], a[68:71], v[56:59]
    ds_read_b128 v[88:91], v129 offset:57344
    buffer_load_dwordx4 v241, s[4:7], s59 offen offset:3072 sc1 lds
    s_add_u32 s59, s59, 4096
    s_waitcnt lgkmcnt(6)
    v_mfma_f32_16x16x32_bf16 v[60:63], v[100:103], a[68:71], v[60:63]
    ds_read_b128 v[92:95], v129 offset:58368
    v_and_b32 v113, s3, v232
    s_waitcnt vmcnt(10) lgkmcnt(5)
    v_mfma_f32_16x16x32_bf16 v[44:47], v[64:67], a[72:75], v[44:47]
    ds_read_b128 v[96:99], v129 offset:59392
    v_lshlrev_b32 v114, 16, v233
    v_mfma_f32_16x16x32_bf16 v[48:51], v[68:71], a[72:75], v[48:51]
    ds_read_b128 v[100:103], v129 offset:60416
    s_add_u32 m0, s53, 24576
    s_nop 0
    buffer_load_dwordx4 v241, s[4:7], s59 offen offset:0 sc1 lds
    s_add_u32 s59, s59, 16384
    v_mfma_f32_16x16x32_bf16 v[52:55], v[72:75], a[72:75], v[52:55]
    ds_read_b128 v[64:67], v130 offset:0
    v_and_b32 v115, s3, v233
    s_waitcnt lgkmcnt(5)
    v_mfma_f32_16x16x32_bf16 v[56:59], v[76:79], a[72:75], v[56:59]
    ds_read_b128 v[68:71], v130 offset:1024
    v_lshlrev_b32 v116, 16, v234
    v_mfma_f32_16x16x32_bf16 v[60:63], v[80:83], a[72:75], v[60:63]
    ds_read_b128 v[72:75], v130 offset:2048
    v_and_b32 v117, s3, v234
    s_waitcnt vmcnt(7) lgkmcnt(5)
    v_cmp_ne_u32 vcc, s48, v27
    s_nop 0
    s_cbranch_vccnz L_adaL_slow_40
L_adaL_got_42:
    s_add_u32 s55, s55, 256
    v_mfma_f32_16x16x32_bf16 v[44:47], v[84:87], a[76:79], v[44:47]
    ds_read_b128 v[76:79], v130 offset:3072
    v_lshlrev_b32 v118, 16, v235
    v_mfma_f32_16x16x32_bf16 v[48:51], v[88:91], a[76:79], v[48:51]
    ds_read_b128 v[80:83], v130 offset:4096
    buffer_load_dwordx2 a[96:97], v5, s[4:7], s85 offen offset:0 sc1
    buffer_load_dwordx2 a[98:99], v5, s[4:7], s85 offen offset:512 sc1
    v_mfma_f32_16x16x32_bf16 v[52:55], v[92:95], a[76:79], v[52:55]
    ds_read_b128 v[84:87], v130 offset:5120
    v_and_b32 v119, s3, v235
    s_waitcnt lgkmcnt(5)
    v_mfma_f32_16x16x32_bf16 v[56:59], v[96:99], a[76:79], v[56:59]
    ds_read_b128 v[88:91], v130 offset:6144
    buffer_load_dwordx2 a[100:101], v5, s[4:7], s85 offen offset:1024 sc1
    buffer_load_dwordx2 a[102:103], v5, s[4:7], s85 offen offset:1536 sc1
    v_mfma_f32_16x16x32_bf16 v[60:63], v[100:103], a[76:79], v[60:63]
    ds_read_b128 v[92:95], v130 offset:7168
    v_lshlrev_b32 v120, 16, v236
    v_mfma_f32_16x16x32_bf16 v[44:47], v[64:67], a[80:83], v[44:47]
    ds_read_b128 v[96:99], v130 offset:8192
    v_and_b32 v121, s3, v236
    s_waitcnt lgkmcnt(5)
    v_mfma_f32_16x16x32_bf16 v[48:51], v[68:71], a[80:83], v[48:51]
    ds_read_b128 v[100:103], v130 offset:9216
    buffer_load_dwordx2 a[104:105], v5, s[4:7], s85 offen offset:2048 sc1
    buffer_load_dwordx2 a[106:107], v5, s[4:7], s85 offen offset:2560 sc1
    v_mfma_f32_16x16x32_bf16 v[52:55], v[72:75], a[80:83], v[52:55]
    ds_read_b128 v[64:67], v130 offset:10240
    v_lshlrev_b32 v122, 16, v237
    v_mfma_f32_16x16x32_bf16 v[56:59], v[76:79], a[80:83], v[56:59]
    ds_read_b128 v[68:71], v130 offset:11264
    buffer_load_dwordx2 a[108:109], v5, s[4:7], s85 offen offset:3072 sc1
    buffer_load_dwordx2 a[110:111], v5, s[4:7], s85 offen offset:3584 sc1
    s_add_u32 s85, s85, 4096
    s_waitcnt lgkmcnt(6)
    v_mfma_f32_16x16x32_bf16 v[60:63], v[80:83], a[80:83], v[60:63]
    ds_read_b128 v[72:75], v130 offset:12288
    v_and_b32 v123, s3, v237
    v_mfma_f32_16x16x32_bf16 v[44:47], v[84:87], a[84:87], v[44:47]
    ds_read_b128 v[76:79], v130 offset:13312
    v_lshlrev_b32 v124, 16, v238
    s_waitcnt lgkmcnt(5)
    v_mfma_f32_16x16x32_bf16 v[48:51], v[88:91], a[84:87], v[48:51]
    ds_read_b128 v[80:83], v130 offset:14336
    v_and_b32 v125, s3, v238
    v_mfma_f32_16x16x32_bf16 v[52:55], v[92:95], a[84:87], v[52:55]
    ds_read_b128 v[84:87], v130 offset:15360
    v_lshlrev_b32 v126, 16, v239
    v_mfma_f32_16x16x32_bf16 v[56:59], v[96:99], a[84:87], v[56:59]
    ds_read_b128 v[88:91], v130 offset:16384
    v_and_b32 v127, s3, v239
    s_waitcnt lgkmcnt(5)
    v_mfma_f32_16x16x32_bf16 v[60:63], v[100:103], a[84:87], v[60:63]
    ds_read_b128 v[92:95], v130 offset:17408
    v_lshlrev_b32 v144, 16, v16
    s_waitcnt vmcnt(14) lgkmcnt(5)
    v_mfma_f32_16x16x32_bf16 v[44:47], v[64:67], a[88:91], v[44:47]
    ds_read_b128 v[96:99], v130 offset:18432
    v_and_b32 v145, s3, v16
    v_mfma_f32_16x16x32_bf16 v[48:51], v[68:71], a[88:91], v[48:51]
    ds_read_b128 v[100:103], v130 offset:19456
    v_lshlrev_b32 v146, 16, v17
    s_waitcnt vmcnt(8) lgkmcnt(5)
    s_barrier
    v_mfma_f32_16x16x32_bf16 v[52:55], v[72:75], a[88:91], v[52:55]
    ds_read_b128 v[64:67], v128 offset:0
    v_and_b32 v147, s3, v17
    v_mfma_f32_16x16x32_bf16 v[56:59], v[76:79], a[88:91], v[56:59]
    ds_read_b128 v[68:71], v128 offset:1024
    v_lshlrev_b32 v148, 16, v18
    v_mfma_f32_16x16x32_bf16 v[60:63], v[80:83], a[88:91], v[60:63]
    ds_read_b128 v[72:75], v128 offset:2048
    v_and_b32 v149, s3, v18
    s_waitcnt lgkmcnt(5)
    v_mfma_f32_16x16x32_bf16 v[44:47], v[84:87], a[92:95], v[44:47]
    ds_read_b128 v[76:79], v128 offset:3072
    v_lshlrev_b32 v150, 16, v19
    v_mfma_f32_16x16x32_bf16 v[48:51], v[88:91], a[92:95], v[48:51]
    ds_read_b128 v[80:83], v128 offset:4096
    v_and_b32 v151, s3, v19
    v_mfma_f32_16x16x32_bf16 v[52:55], v[92:95], a[92:95], v[52:55]
    ds_read_b128 v[84:87], v128 offset:5120
    v_lshlrev_b32 v152, 16, v20
    s_waitcnt lgkmcnt(5)
    v_mfma_f32_16x16x32_bf16 v[56:59], v[96:99], a[92:95], v[56:59]
    ds_read_b128 v[88:91], v128 offset:6144
    v_and_b32 v153, s3, v20
    v_mfma_f32_16x16x32_bf16 v[60:63], v[100:103], a[92:95], v[60:63]
    ds_read_b128 v[92:95], v128 offset:7168
    v_lshlrev_b32 v154, 16, v21
    s_waitcnt vmcnt(6) lgkmcnt(5)
    v_mfma_f32_16x16x32_bf16 v[44:47], v[64:67], a[96:99], v[44:47]
    ds_read_b128 v[96:99], v128 offset:8192
    v_and_b32 v155, s3, v21
    v_mfma_f32_16x16x32_bf16 v[48:51], v[68:71], a[96:99], v[48:51]
    ds_read_b128 v[100:103], v128 offset:9216
    v_lshlrev_b32 v156, 16, v22
    v_mfma_f32_16x16x32_bf16 v[52:55], v[72:75], a[96:99], v[52:55]
    ds_read_b128 v[64:67], v128 offset:10240
    v_and_b32 v157, s3, v22
    s_waitcnt lgkmcnt(5)
    v_mfma_f32_16x16x32_bf16 v[56:59], v[76:79], a[96:99], v[56:59]
    ds_read_b128 v[68:71], v128 offset:11264
    v_lshlrev_b32 v158, 16, v23
    v_mfma_f32_16x16x32_bf16 v[60:63], v[80:83], a[96:99], v[60:63]
    ds_read_b128 v[72:75], v128 offset:12288
    v_and_b32 v159, s3, v23
    s_waitcnt vmcnt(4) lgkmcnt(5)
    v_mfma_f32_16x16x32_bf16 v[44:47], v[84:87], a[100:103], v[44:47]
    ds_read_b128 v[76:79], v128 offset:13312
    v_lshlrev_b32 v160, 16, v24
    v_mfma_f32_16x16x32_bf16 v[48:51], v[88:91], a[100:103], v[48:51]
    ds_read_b128 v[80:83], v128 offset:14336
    v_and_b32 v161, s3, v24
    v_mfma_f32_16x16x32_bf16 v[52:55], v[92:95], a[100:103], v[52:55]
    ds_read_b128 v[84:87], v128 offset:15360
    v_lshlrev_b32 v162, 16, v25
    s_waitcnt lgkmcnt(5)
    v_mfma_f32_16x16x32_bf16 v[56:59], v[96:99], a[100:103], v[56:59]
    ds_read_b128 v[88:91], v128 offset:16384
    v_and_b32 v163, s3, v25
    v_mfma_f32_16x16x32_bf16 v[60:63], v[100:103], a[100:103], v[60:63]
    ds_read_b128 v[92:95], v128 offset:17408
    s_waitcnt vmcnt(2) lgkmcnt(5)
    v_mfma_f32_16x16x32_bf16 v[44:47], v[64:67], a[104:107], v[44:47]
    ds_read_b128 v[96:99], v128 offset:18432
    v_mfma_f32_16x16x32_bf16 v[48:51], v[68:71], a[104:107], v[48:51]
    ds_read_b128 v[100:103], v128 offset:19456
    v_mfma_f32_16x16x32_bf16 v[52:55], v[72:75], a[104:107], v[52:55]
    s_waitcnt lgkmcnt(5)
    v_mfma_f32_16x16x32_bf16 v[56:59], v[76:79], a[104:107], v[56:59]
    v_mfma_f32_16x16x32_bf16 v[60:63], v[80:83], a[104:107], v[60:63]
    s_waitcnt vmcnt(0) lgkmcnt(3)
    v_mfma_f32_16x16x32_bf16 v[44:47], v[84:87], a[108:111], v[44:47]
    v_mfma_f32_16x16x32_bf16 v[48:51], v[88:91], a[108:111], v[48:51]
    s_waitcnt lgkmcnt(1)
    v_mfma_f32_16x16x32_bf16 v[52:55], v[92:95], a[108:111], v[52:55]
    v_mfma_f32_16x16x32_bf16 v[56:59], v[96:99], a[108:111], v[56:59]
    s_waitcnt lgkmcnt(0)
    v_mfma_f32_16x16x32_bf16 v[60:63], v[100:103], a[108:111], v[60:63]
    s_nop 1
    v_fmac_f32 v144, v108, v44
    v_fmac_f32 v145, v109, v48
    v_fmac_f32 v146, v110, v45
    v_fmac_f32 v147, v111, v49
    v_fmac_f32 v148, v112, v46
    v_fmac_f32 v149, v113, v50
    v_fmac_f32 v150, v114, v47
    v_fmac_f32 v151, v115, v51
    v_cvt_pk_bf16_f32 v16, v144, v145
    v_cvt_pk_bf16_f32 v17, v146, v147
    v_cvt_pk_bf16_f32 v18, v148, v149
    v_cvt_pk_bf16_f32 v19, v150, v151
    ds_write_b128 v131, v[16:19] offset:0
    v_fmac_f32 v152, v116, v52
    v_fmac_f32 v153, v117, v56
    v_fmac_f32 v154, v118, v53
    v_fmac_f32 v155, v119, v57
    v_fmac_f32 v156, v120, v54
    v_fmac_f32 v157, v121, v58
    v_fmac_f32 v158, v122, v55
    v_fmac_f32 v159, v123, v59
    v_cvt_pk_bf16_f32 v20, v152, v153
    v_cvt_pk_bf16_f32 v21, v154, v155
    v_cvt_pk_bf16_f32 v22, v156, v157
    v_cvt_pk_bf16_f32 v23, v158, v159
    ds_write_b128 v131, v[20:23] offset:64
    v_fmac_f32 v160, v124, v60
    v_fmac_f32 v161, v125, v61
    v_fmac_f32 v162, v126, v62
    v_fmac_f32 v163, v127, v63
    v_cvt_pk_bf16_f32 v24, v160, v161
    v_cvt_pk_bf16_f32 v25, v162, v163
    ds_write_b64 v132, v[24:25] offset:128
    ds_read_b128 v[64:67], v134
    ds_read_b128 v[68:71], v135
    ds_read_b128 v[72:75], v136
    s_waitcnt lgkmcnt(2)
    buffer_store_dwordx4 v[64:67], v138, s[16:19], s72 offen nt
    s_waitcnt lgkmcnt(1)
    buffer_store_dwordx4 v[68:71], v139, s[16:19], s72 offen nt
    s_waitcnt lgkmcnt(0)
    buffer_store_dwordx4 v[72:75], v140, s[16:19], s72 offen nt
    s_cmp_lg_u32 s2, 252
    s_cbranch_scc1 L_adaL_end_1
    v_mov_b32 v2, 0
    v_mov_b32 v3, 0
    buffer_store_dwordx2 v[2:3], off, s[44:47], 0 sc1
L_adaL_end_1:
    s_endpgm
L_adaL_w3_32:
    buffer_load_dwordx4 a[96:99], v241, s[4:7], s85 offen offset:0 sc1
    v_bfe_u32 v3, v0, 3, 2
    v_bfe_u32 v4, v0, 5, 1
    v_lshl_add_u32 v3, v3, 1, v4
    v_lshlrev_b32 v15, 14, v3
    v_and_b32 v3, 7, v0
    v_lshl_add_u32 v15, v3, 4, v15
    s_lshl_b32 s52, s83, 9
    s_lshl_b32 s62, s82, 7
    buffer_load_dwordx4 a[104:107], v241, s[4:7], s85 offen offset:1024 sc1
    s_add_u32 s52, s52, s62
    s_add_u32 s52, s52, 6291456
    s_mul_i32 s53, s82, 20480
    v_lshlrev_b32 v5, 3, v240
    v_add_u32 v6, 40960, v5
    v_add_u32 v14, s53, v5
    v_lshlrev_b32 v7, 4, v2
    s_mov_b32 s66, 0xbdd2d3e8
    buffer_load_dwordx4 a[112:115], v241, s[4:7], s85 offen offset:2048 sc1
    s_mov_b32 s67, 0xc0135761
    s_mov_b32 s68, 1.0
    s_mov_b32 s69, 1.0
    v_mov_b32 v132, 0x3f803f80
    v_mov_b32 v133, 0x3f803f80
    v_mov_b32 v134, 0x3f803f80
    v_mov_b32 v135, 0x3f803f80
    v_lshlrev_b32 v12, 2, v1
    buffer_load_dwordx4 a[120:123], v241, s[4:7], s85 offen offset:3072 sc1
    s_lshl_b32 s59, s84, 12
    s_add_u32 s59, s59, 24379392
    v_lshlrev_b32 v4, 3, v0
    v_lshlrev_b32_e64 v180, 4, v0
    s_add_u32 s85, s85, 4096
    buffer_load_dwordx4 a[128:131], v241, s[4:7], s85 offen offset:0 sc1
    buffer_load_dwordx4 a[136:139], v241, s[4:7], s85 offen offset:1024 sc1
    buffer_load_dwordx4 a[144:147], v241, s[4:7], s85 offen offset:2048 sc1
    buffer_load_dwordx4 a[152:155], v241, s[4:7], s85 offen offset:3072 sc1
    s_add_u32 s85, s85, 4096
    buffer_load_dwordx4 a[160:163], v241, s[4:7], s85 offen offset:0 sc1
    buffer_load_dwordx4 a[168:171], v241, s[4:7], s85 offen offset:1024 sc1
    buffer_load_dwordx4 a[176:179], v241, s[4:7], s85 offen offset:2048 sc1
    buffer_load_dwordx4 a[184:187], v241, s[4:7], s85 offen offset:3072 sc1
    s_add_u32 s85, s85, 4096
    s_add_u32 s63, s59, 0
    buffer_load_dwordx4 v[100:103], v180, s[4:7], s63 offen sc1
    s_add_u32 s63, s59, 32768
    buffer_load_dwordx4 v[104:107], v180, s[4:7], s63 offen sc1
    s_add_u32 s63, s59, 65536
    buffer_load_dwordx4 v[108:111], v180, s[4:7], s63 offen sc1
    s_add_u32 s63, s59, 98304
    buffer_load_dwordx4 v[112:115], v180, s[4:7], s63 offen sc1
    s_add_u32 s63, s59, 131072
    buffer_load_dwordx4 v[116:119], v180, s[4:7], s63 offen sc1
    s_mul_i32 s62, s84, 640
    s_add_u32 s62, s62, 58368
    v_min_u32 v3, 79, v0
    v_lshl_add_u32 v166, v3, 3, s62
    buffer_load_dwordx2 v[164:165], v166, s[4:7], 0 offen sc1
    buffer_load_dword v27, v26, s[4:7], s60 offen sc1
    v_lshlrev_b32 v3, 2, v3
    v_add_u32 v3, 88576, v3
    v_add_u32 v4, 86528, v4
    s_mul_i32 s63, s82, 14336
    s_add_u32 s63, s63, 102912
    s_sub_u32 s64, s63, s54
    s_mov_b32 s54, s63
    v_add_u32 v10, s64, v10
    v_add_u32_e64 v11, s64, v11
    s_waitcnt vmcnt(1)
    v_min3_u32 v181, v165, v13, v13
    v_min3_u32 v181, v181, v101, v103
    v_min3_u32 v181, v181, v105, v107
    v_min3_u32 v181, v181, v109, v111
    v_min3_u32 v181, v181, v113, v115
    v_min3_u32 v181, v181, v117, v119
    v_max3_u32 v182, v165, v13, v13
    v_max3_u32 v182, v182, v101, v103
    v_max3_u32 v182, v182, v105, v107
    v_max3_u32 v182, v182, v109, v111
    v_max3_u32 v182, v182, v113, v115
    v_max3_u32 v182, v182, v117, v119
    v_cmp_ne_u32 vcc, v181, v182
    s_nop 0
    s_cbranch_vccnz L_adaL_slow_19_w3
L_adaL_got_21_w3:
    v_add_f32 v100, v100, v104
    v_add_f32 v102, v102, v106
    v_add_f32 v100, v100, v108
    v_add_f32 v102, v102, v110
    v_add_f32 v100, v100, v112
    v_add_f32 v102, v102, v114
    v_add_f32 v100, v100, v116
    v_add_f32 v102, v102, v118
    s_mov_b32 s49, 65536
    s_waitcnt vmcnt(0)
    v_cmp_ne_u32 vcc, s48, v27
    s_nop 0
    s_cbranch_vccz L_adaL_got_24_w3
L_adaL_poll_23_w3:
    buffer_load_dword v27, v26, s[4:7], s60 offen sc1
    s_waitcnt vmcnt(0)
    s_sub_u32 s49, s49, 1
    s_cbranch_scc1 L_adaL_got_24_w3
    v_cmp_ne_u32 vcc, s48, v27
    s_nop 0
    s_cbranch_vccnz L_adaL_poll_23_w3
L_adaL_got_24_w3:
    s_barrier
    s_mov_b32 m0, s53
    s_nop 0
    buffer_load_dwordx4 v15, s[4:7], s52 offen sc1 lds
    s_add_u32 m0, m0, 1024
    s_add_u32 s52, s52, 131072
    buffer_load_dwordx4 v15, s[4:7], s52 offen sc1 lds
    s_add_u32 m0, m0, 1024
    s_add_u32 s52, s52, 131072
    buffer_load_dwordx4 v15, s[4:7], s52 offen sc1 lds
    s_add_u32 m0, m0, 1024
    s_add_u32 s52, s52, 131072
    buffer_load_dwordx4 v15, s[4:7], s52 offen sc1 lds
    s_add_u32 m0, m0, 1024
    s_add_u32 s52, s52, 131072
    buffer_load_dwordx4 v15, s[4:7], s52 offen sc1 lds
    s_add_u32 m0, m0, 1024
    s_add_u32 s52, s52, 131072
    buffer_load_dwordx4 v15, s[4:7], s52 offen sc1 lds
    s_add_u32 m0, m0, 1024
    s_add_u32 s52, s52, 131072
    buffer_load_dwordx4 v15, s[4:7], s52 offen sc1 lds
    s_add_u32 m0, m0, 1024
    s_add_u32 s52, s52, 131072
    buffer_load_dwordx4 v15, s[4:7], s52 offen sc1 lds
    s_add_u32 m0, m0, 1024
    s_add_u32 s52, s52, 131072
    buffer_load_dwordx4 v15, s[4:7], s52 offen sc1 lds
    s_add_u32 m0, m0, 1024
    s_add_u32 s52, s52, 131072
    buffer_load_dwordx4 v15, s[4:7], s52 offen sc1 lds
    s_add_u32 m0, m0, 1024
    s_add_u32 s52, s52, 131072
    ds_write2_b32 v4, v100, v102 offset0:0 offset1:1
    ds_write_b32 v3, v164
    s_lshl_b32 s60, s83, 3
    s_add_u32 s60, s60, s84
    s_lshl_b32 s60, s60, 15
    v_lshlrev_b32 v26, 5, v0
    s_waitcnt vmcnt(9)
    ds_read_b64 v[92:93], v14 offset:0
    ds_read_b64 v[94:95], v14 offset:512
    buffer_load_dwordx4 v15, s[4:7], s52 offen sc1 lds
    s_add_u32 m0, m0, 1024
    s_add_u32 s52, s52, 131072
    s_waitcnt lgkmcnt(0)
    v_mfma_f32_16x16x32_bf16 v[136:139], v[92:95], v[92:95], 0
    s_waitcnt vmcnt(9)
    ds_read_b64 v[96:97], v14 offset:1024
    v_mfma_f32_16x16x32_bf16 v[140:143], v[132:135], v[92:95], 0
    ds_read_b64 v[98:99], v14 offset:1536
    buffer_load_dwordx4 v15, s[4:7], s52 offen sc1 lds
    s_add_u32 m0, m0, 1024
    s_add_u32 s52, s52, 131072
    s_waitcnt lgkmcnt(0)
    v_mfma_f32_16x16x32_bf16 v[136:139], v[96:99], v[96:99], v[136:139]
    s_waitcnt vmcnt(9)
    ds_read_b64 v[92:93], v14 offset:2048
    v_mfma_f32_16x16x32_bf16 v[140:143], v[132:135], v[96:99], v[140:143]
    ds_read_b64 v[94:95], v14 offset:2560
    buffer_load_dwordx4 v15, s[4:7], s52 offen sc1 lds
    s_add_u32 m0, m0, 1024
    s_add_u32 s52, s52, 131072
    s_waitcnt lgkmcnt(0)
    v_mfma_f32_16x16x32_bf16 v[136:139], v[92:95], v[92:95], v[136:139]
    s_waitcnt vmcnt(9)
    ds_read_b64 v[96:97], v14 offset:3072
    v_mfma_f32_16x16x32_bf16 v[140:143], v[132:135], v[92:95], v[140:143]
    ds_read_b64 v[98:99], v14 offset:3584
    s_waitcnt lgkmcnt(0)
    s_barrier
    ds_read_b64 v[44:45], v5 offset:0
    ds_read_b64 v[46:47], v5 offset:512
    ds_read_b64 v[48:49], v5 offset:20480
    ds_read_b64 v[50:51], v5 offset:20992
    ds_read_b64 v[52:53], v6 offset:0
    ds_read_b64 v[54:55], v6 offset:512
    ds_read_b64 v[56:57], v6 offset:20480
    ds_read_b64 v[58:59], v6 offset:20992
    ds_read_b64 v[60:61], v5 offset:1024
    ds_read_b64 v[62:63], v5 offset:1536
    ds_read_b64 v[64:65], v5 offset:21504
    ds_read_b64 v[66:67], v5 offset:22016
    ds_read_b64 v[68:69], v6 offset:1024
    ds_read_b64 v[70:71], v6 offset:1536
    ds_read_b64 v[72:73], v6 offset:21504
    ds_read_b64 v[74:75], v6 offset:22016
    v_mfma_f32_16x16x32_bf16 v[136:139], v[96:99], v[96:99], v[136:139]
    s_waitcnt vmcnt(8)
    ds_read_b64 v[92:93], v14 offset:4096
    v_mfma_f32_16x16x32_bf16 v[140:143], v[132:135], v[96:99], v[140:143]
    ds_read_b64 v[94:95], v14 offset:4608
    s_waitcnt lgkmcnt(10)
    v_mfma_f32_16x16x32_bf16 v[100:103], v[44:47], a[96:99], 0
    ds_read2st64_b64 v[76:79], v5 offset0:4 offset1:5
    v_mfma_f32_16x16x32_bf16 v[104:107], v[48:51], a[96:99], 0
    ds_read_b64 v[80:81], v5 offset:22528
    v_mfma_f32_16x16x32_bf16 v[108:111], v[52:55], a[96:99], 0
    ds_read_b64 v[82:83], v5 offset:23040
    v_mfma_f32_16x16x32_bf16 v[112:115], v[56:59], a[96:99], 0
    buffer_load_dwordx4 v15, s[4:7], s52 offen sc1 lds
    s_add_u32 m0, m0, 1024
    s_add_u32 s52, s52, 131072
    v_mov_b32 v116, 0
    v_mov_b32 v117, 0
    v_mov_b32 v118, 0
    v_mov_b32 v119, 0
    ds_read2st64_b64 v[84:87], v5 offset0:84 offset1:85
    v_mov_b32 v120, 0
    v_mov_b32 v121, 0
    v_mov_b32 v122, 0
    v_mov_b32 v123, 0
    ds_read_b64 v[88:89], v6 offset:22528
    v_mov_b32 v124, 0
    v_mov_b32 v125, 0
    v_mov_b32 v126, 0
    v_mov_b32 v127, 0
    ds_read_b64 v[90:91], v6 offset:23040
    v_mov_b32 v128, 0
    v_mov_b32 v129, 0
    v_mov_b32 v130, 0
    v_mov_b32 v131, 0
    buffer_load_dwordx4 v15, s[4:7], s52 offen sc1 lds
    s_add_u32 m0, m0, 1024
    s_add_u32 s52, s52, 131072
    s_waitcnt lgkmcnt(4)
    v_mfma_f32_16x16x32_bf16 v[136:139], v[92:95], v[92:95], v[136:139]
    s_waitcnt vmcnt(9) lgkmcnt(3)
    ds_read_b64 v[96:97], v14 offset:5120
    v_mfma_f32_16x16x32_bf16 v[140:143], v[132:135], v[92:95], v[140:143]
    ds_read_b64 v[98:99], v14 offset:5632
    v_mfma_f32_16x16x32_bf16 v[100:103], v[60:63], a[104:107], v[100:103]
    ds_read2st64_b64 v[44:47], v5 offset0:6 offset1:7
    v_mfma_f32_16x16x32_bf16 v[104:107], v[64:67], a[104:107], v[104:107]
    ds_read_b64 v[48:49], v5 offset:23552
    v_mfma_f32_16x16x32_bf16 v[108:111], v[68:71], a[104:107], v[108:111]
    ds_read_b64 v[50:51], v5 offset:24064
    v_mfma_f32_16x16x32_bf16 v[112:115], v[72:75], a[104:107], v[112:115]
    buffer_load_dwordx4 v15, s[4:7], s52 offen sc1 lds
    s_add_u32 m0, m0, 1024
    s_add_u32 s52, s52, 131072
    ds_read2st64_b64 v[52:55], v5 offset0:86 offset1:87
    ds_read_b64 v[56:57], v6 offset:23552
    ds_read_b64 v[58:59], v6 offset:24064
    buffer_load_dwordx4 v15, s[4:7], s52 offen sc1 lds
    s_add_u32 m0, m0, 1024
    s_add_u32 s52, s52, 131072
    s_waitcnt lgkmcnt(6)
    v_mfma_f32_16x16x32_bf16 v[136:139], v[96:99], v[96:99], v[136:139]
    s_waitcnt vmcnt(10)
    ds_read_b64 v[92:93], v14 offset:6144
    v_mfma_f32_16x16x32_bf16 v[140:143], v[132:135], v[96:99], v[140:143]
    ds_read_b64 v[94:95], v14 offset:6656
    s_waitcnt vmcnt(9)
    s_barrier
    v_mfma_f32_16x16x32_bf16 v[100:103], v[76:79], a[112:115], v[100:103]
    ds_read2st64_b64 v[60:63], v5 offset0:8 offset1:9
    v_mfma_f32_16x16x32_bf16 v[104:107], v[80:83], a[112:115], v[104:107]
    ds_read_b64 v[64:65], v5 offset:24576
    v_mfma_f32_16x16x32_bf16 v[108:111], v[84:87], a[112:115], v[108:111]
    ds_read_b64 v[66:67], v5 offset:25088
    v_mfma_f32_16x16x32_bf16 v[112:115], v[88:91], a[112:115], v[112:115]
    buffer_load_dwordx4 v15, s[4:7], s52 offen sc1 lds
    s_add_u32 m0, m0, 1024
    s_add_u32 s52, s52, 131072
    ds_read2st64_b64 v[68:71], v5 offset0:88 offset1:89
    ds_read_b64 v[72:73], v6 offset:24576
    ds_read_b64 v[74:75], v6 offset:25088
    buffer_load_dwordx4 v15, s[4:7], s52 offen sc1 lds
    s_add_u32 m0, m0, 1024
    s_add_u32 s52, s52, 131072
    s_waitcnt lgkmcnt(6)
    v_mfma_f32_16x16x32_bf16 v[136:139], v[92:95], v[92:95], v[136:139]
    ds_read_b64 v[96:97], v14 offset:7168
    v_mfma_f32_16x16x32_bf16 v[140:143], v[132:135], v[92:95], v[140:143]
    ds_read_b64 v[98:99], v14 offset:7680
    v_mfma_f32_16x16x32_bf16 v[100:103], v[44:47], a[120:123], v[100:103]
    ds_read2st64_b64 v[76:79], v5 offset0:10 offset1:11
    v_mfma_f32_16x16x32_bf16 v[104:107], v[48:51], a[120:123], v[104:107]
    ds_read_b64 v[80:81], v5 offset:25600
    v_mfma_f32_16x16x32_bf16 v[108:111], v[52:55], a[120:123], v[108:111]
    ds_read_b64 v[82:83], v5 offset:26112
    v_mfma_f32_16x16x32_bf16 v[112:115], v[56:59], a[120:123], v[112:115]
    buffer_load_dwordx4 v15, s[4:7], s52 offen sc1 lds
    ds_read2st64_b64 v[84:87], v5 offset0:90 offset1:91
    ds_read_b64 v[88:89], v6 offset:25600
    ds_read_b64 v[90:91], v6 offset:26112
    buffer_load_dwordx4 a[192:195], v241, s[4:7], s85 offen offset:0 sc1
    s_waitcnt lgkmcnt(6)
    v_mfma_f32_16x16x32_bf16 v[136:139], v[96:99], v[96:99], v[136:139]
    s_waitcnt vmcnt(12)
    ds_read_b64 v[92:93], v14 offset:8192
    v_mfma_f32_16x16x32_bf16 v[140:143], v[132:135], v[96:99], v[140:143]
    ds_read_b64 v[94:95], v14 offset:8704
    v_mfma_f32_16x16x32_bf16 v[100:103], v[60:63], a[128:131], v[100:103]
    ds_read2st64_b64 v[44:47], v5 offset0:12 offset1:13
    s_lshl_b32 s62, s82, 7
    v_mfma_f32_16x16x32_bf16 v[104:107], v[64:67], a[128:131], v[104:107]
    ds_read_b64 v[48:49], v5 offset:26624
    s_add_u32 s62, s62, 86528
    v_mfma_f32_16x16x32_bf16 v[108:111], v[68:71], a[128:131], v[108:111]
    ds_read_b64 v[50:51], v5 offset:27136
    v_add_u32 v3, s62, v12
    v_mfma_f32_16x16x32_bf16 v[112:115], v[72:75], a[128:131], v[112:115]
    ds_read2st64_b64 v[52:55], v5 offset0:92 offset1:93
    v_add_u32 v4, s62, v7
    ds_read_b64 v[56:57], v6 offset:26624
    ds_read_b32 v212, v3 offset:1024
    ds_read_b64 v[58:59], v6 offset:27136
    ds_read_b32 v213, v3 offset:1536
    buffer_load_dwordx4 a[200:203], v241, s[4:7], s85 offen offset:1024 sc1
    s_waitcnt lgkmcnt(8)
    v_mfma_f32_16x16x32_bf16 v[136:139], v[92:95], v[92:95], v[136:139]
    s_waitcnt vmcnt(12)
    ds_read_b64 v[96:97], v14 offset:9216
    v_mfma_f32_16x16x32_bf16 v[140:143], v[132:135], v[92:95], v[140:143]
    ds_read_b64 v[98:99], v14 offset:9728
    v_mfma_f32_16x16x32_bf16 v[100:103], v[76:79], a[136:139], v[100:103]
    ds_read2st64_b64 v[60:63], v5 offset0:14 offset1:15
    ds_read_b128 v[196:199], v4 offset:0
    v_mfma_f32_16x16x32_bf16 v[104:107], v[80:83], a[136:139], v[104:107]
    ds_read_b64 v[64:65], v5 offset:27648
    ds_read_b128 v[204:207], v4 offset:512
    v_mfma_f32_16x16x32_bf16 v[108:111], v[84:87], a[136:139], v[108:111]
    ds_read_b64 v[66:67], v5 offset:28160
    ds_read_b32 v214, v3 offset:1088
    v_mfma_f32_16x16x32_bf16 v[112:115], v[88:91], a[136:139], v[112:115]
    ds_read2st64_b64 v[68:71], v5 offset0:94 offset1:95
    ds_read_b32 v215, v3 offset:1600
    ds_read_b64 v[72:73], v6 offset:27648
    ds_read_b128 v[200:203], v4 offset:64
    ds_read_b64 v[74:75], v6 offset:28160
    ds_read_b128 v[208:211], v4 offset:576
    buffer_load_dwordx4 a[208:211], v241, s[4:7], s85 offen offset:2048 sc1
    s_waitcnt lgkmcnt(12)
    v_mfma_f32_16x16x32_bf16 v[136:139], v[96:99], v[96:99], v[136:139]
    s_waitcnt vmcnt(12)
    ds_read_b64 v[92:93], v14 offset:10240
    v_mfma_f32_16x16x32_bf16 v[140:143], v[132:135], v[96:99], v[140:143]
    ds_read_b64 v[94:95], v14 offset:10752
    s_waitcnt vmcnt(11)
    s_barrier
    v_mfma_f32_16x16x32_bf16 v[100:103], v[44:47], a[144:147], v[100:103]
    ds_read2st64_b64 v[76:79], v5 offset0:16 offset1:17
    v_mfma_f32_16x16x32_bf16 v[104:107], v[48:51], a[144:147], v[104:107]
    ds_read_b64 v[80:81], v5 offset:28672
    v_mfma_f32_16x16x32_bf16 v[108:111], v[52:55], a[144:147], v[108:111]
    ds_read_b64 v[82:83], v5 offset:29184
    v_mfma_f32_16x16x32_bf16 v[112:115], v[56:59], a[144:147], v[112:115]
    ds_read2st64_b64 v[84:87], v5 offset0:96 offset1:97
    ds_read_b64 v[88:89], v6 offset:28672
    ds_read_b64 v[90:91], v6 offset:29184
    buffer_load_dwordx4 a[216:219], v241, s[4:7], s85 offen offset:3072 sc1
    s_waitcnt lgkmcnt(6)
    v_mfma_f32_16x16x32_bf16 v[136:139], v[92:95], v[92:95], v[136:139]
    ds_read_b64 v[96:97], v14 offset:11264
    v_mfma_f32_16x16x32_bf16 v[140:143], v[132:135], v[92:95], v[140:143]
    ds_read_b64 v[98:99], v14 offset:11776
    v_mfma_f32_16x16x32_bf16 v[100:103], v[60:63], a[152:155], v[100:103]
    ds_read2st64_b64 v[44:47], v5 offset0:18 offset1:19
    v_mfma_f32_16x16x32_bf16 v[104:107], v[64:67], a[152:155], v[104:107]
    ds_read_b64 v[48:49], v5 offset:29696
    v_mfma_f32_16x16x32_bf16 v[108:111], v[68:71], a[152:155], v[108:111]
    ds_read_b64 v[50:51], v5 offset:30208
    v_mfma_f32_16x16x32_bf16 v[112:115], v[72:75], a[152:155], v[112:115]
    s_add_u32 s85, s85, 4096
    ds_read2st64_b64 v[52:55], v5 offset0:98 offset1:99
    ds_read_b64 v[56:57], v6 offset:29696
    ds_read_b64 v[58:59], v6 offset:30208
    buffer_load_dwordx4 a[224:227], v241, s[4:7], s85 offen offset:0 sc1
    s_waitcnt lgkmcnt(6)
    v_mfma_f32_16x16x32_bf16 v[136:139], v[96:99], v[96:99], v[136:139]
    s_waitcnt vmcnt(12)
    ds_read_b64 v[92:93], v14 offset:12288
    v_mfma_f32_16x16x32_bf16 v[140:143], v[132:135], v[96:99], v[140:143]
    ds_read_b64 v[94:95], v14 offset:12800
    v_mfma_f32_16x16x32_bf16 v[100:103], v[76:79], a[160:163], v[100:103]
    ds_read2st64_b64 v[60:63], v5 offset0:20 offset1:21
    v_mfma_f32_16x16x32_bf16 v[104:107], v[80:83], a[160:163], v[104:107]
    ds_read_b64 v[64:65], v5 offset:30720
    v_mfma_f32_16x16x32_bf16 v[108:111], v[84:87], a[160:163], v[108:111]
    ds_read_b64 v[66:67], v5 offset:31232
    v_mfma_f32_16x16x32_bf16 v[112:115], v[88:91], a[160:163], v[112:115]
    ds_read2st64_b64 v[68:71], v5 offset0:100 offset1:101
    ds_read_b64 v[72:73], v6 offset:30720
    ds_read_b64 v[74:75], v6 offset:31232
    buffer_load_dwordx4 a[232:235], v241, s[4:7], s85 offen offset:1024 sc1
    s_waitcnt lgkmcnt(6)
    v_mfma_f32_16x16x32_bf16 v[136:139], v[92:95], v[92:95], v[136:139]
    s_waitcnt vmcnt(12)
    ds_read_b64 v[96:97], v14 offset:13312
    v_mfma_f32_16x16x32_bf16 v[140:143], v[132:135], v[92:95], v[140:143]
    ds_read_b64 v[98:99], v14 offset:13824
    v_mfma_f32_16x16x32_bf16 v[100:103], v[44:47], a[168:171], v[100:103]
    ds_read2st64_b64 v[76:79], v5 offset0:22 offset1:23
    v_mfma_f32_16x16x32_bf16 v[104:107], v[48:51], a[168:171], v[104:107]
    ds_read_b64 v[80:81], v5 offset:31744
    v_mfma_f32_16x16x32_bf16 v[108:111], v[52:55], a[168:171], v[108:111]
    ds_read_b64 v[82:83], v5 offset:32256
    v_mfma_f32_16x16x32_bf16 v[112:115], v[56:59], a[168:171], v[112:115]
    ds_read2st64_b64 v[84:87], v5 offset0:102 offset1:103
    ds_read_b64 v[88:89], v6 offset:31744
    ds_read_b64 v[90:91], v6 offset:32256
    buffer_load_dwordx4 a[240:243], v241, s[4:7], s85 offen offset:2048 sc1
    s_waitcnt lgkmcnt(6)
    v_mfma_f32_16x16x32_bf16 v[136:139], v[96:99], v[96:99], v[136:139]
    s_waitcnt vmcnt(12)
    ds_read_b64 v[92:93], v14 offset:14336
    v_mfma_f32_16x16x32_bf16 v[140:143], v[132:135], v[96:99], v[140:143]
    ds_read_b64 v[94:95], v14 offset:14848
    s_waitcnt vmcnt(11)
    s_barrier
    v_mfma_f32_16x16x32_bf16 v[100:103], v[60:63], a[176:179], v[100:103]
    ds_read2st64_b64 v[44:47], v5 offset0:24 offset1:25
    v_mfma_f32_16x16x32_bf16 v[104:107], v[64:67], a[176:179], v[104:107]
    ds_read_b64 v[48:49], v5 offset:32768
    v_mfma_f32_16x16x32_bf16 v[108:111], v[68:71], a[176:179], v[108:111]
    ds_read_b64 v[50:51], v5 offset:33280
    v_mfma_f32_16x16x32_bf16 v[112:115], v[72:75], a[176:179], v[112:115]
    ds_read2st64_b64 v[52:55], v5 offset0:104 offset1:105
    ds_read_b64 v[56:57], v6 offset:32768
    ds_read_b64 v[58:59], v6 offset:33280
    buffer_load_dwordx4 a[248:251], v241, s[4:7], s85 offen offset:3072 sc1
    s_waitcnt lgkmcnt(6)
    v_mfma_f32_16x16x32_bf16 v[136:139], v[92:95], v[92:95], v[136:139]
    ds_read_b64 v[96:97], v14 offset:15360
    v_mfma_f32_16x16x32_bf16 v[140:143], v[132:135], v[92:95], v[140:143]
    ds_read_b64 v[98:99], v14 offset:15872
    v_mfma_f32_16x16x32_bf16 v[100:103], v[76:79], a[184:187], v[100:103]
    ds_read2st64_b64 v[60:63], v5 offset0:26 offset1:27
    v_mfma_f32_16x16x32_bf16 v[104:107], v[80:83], a[184:187], v[104:107]
    ds_read_b64 v[64:65], v5 offset:33792
    v_mfma_f32_16x16x32_bf16 v[108:111], v[84:87], a[184:187], v[108:111]
    ds_read_b64 v[66:67], v5 offset:34304
    v_mfma_f32_16x16x32_bf16 v[112:115], v[88:91], a[184:187], v[112:115]
    s_sub_u32 s85, s85, 159744
    ds_read2st64_b64 v[68:71], v5 offset0:106 offset1:107
    ds_read_b64 v[72:73], v6 offset:33792
    ds_read_b64 v[74:75], v6 offset:34304
    buffer_load_dwordx4 a[96:99], v241, s[4:7], s85 offen offset:0 sc1
    s_waitcnt lgkmcnt(6)
    v_mfma_f32_16x16x32_bf16 v[136:139], v[96:99], v[96:99], v[136:139]
    s_waitcnt vmcnt(12)
    ds_read_b64 v[92:93], v14 offset:16384
    v_mfma_f32_16x16x32_bf16 v[140:143], v[132:135], v[96:99], v[140:143]
    ds_read_b64 v[94:95], v14 offset:16896
    s_waitcnt vmcnt(8)
    v_mfma_f32_16x16x32_bf16 v[100:103], v[44:47], a[192:195], v[100:103]
    ds_read2st64_b64 v[76:79], v5 offset0:28 offset1:29
    v_mfma_f32_16x16x32_bf16 v[104:107], v[48:51], a[192:195], v[104:107]
    ds_read_b64 v[80:81], v5 offset:34816
    v_mfma_f32_16x16x32_bf16 v[108:111], v[52:55], a[192:195], v[108:111]
    ds_read_b64 v[82:83], v5 offset:35328
    v_mfma_f32_16x16x32_bf16 v[112:115], v[56:59], a[192:195], v[112:115]
    ds_read2st64_b64 v[84:87], v5 offset0:108 offset1:109
    ds_read_b64 v[88:89], v6 offset:34816
    ds_read_b64 v[90:91], v6 offset:35328
    buffer_load_dwordx4 a[104:107], v241, s[4:7], s85 offen offset:1024 sc1
    s_waitcnt lgkmcnt(6)
    v_mfma_f32_16x16x32_bf16 v[136:139], v[92:95], v[92:95], v[136:139]
    ds_read_b64 v[96:97], v14 offset:17408
    v_mfma_f32_16x16x32_bf16 v[140:143], v[132:135], v[92:95], v[140:143]
    ds_read_b64 v[98:99], v14 offset:17920
    s_waitcnt vmcnt(8)
    v_mfma_f32_16x16x32_bf16 v[100:103], v[60:63], a[200:203], v[100:103]
    ds_read2st64_b64 v[44:47], v5 offset0:30 offset1:31
    v_mfma_f32_16x16x32_bf16 v[104:107], v[64:67], a[200:203], v[104:107]
    ds_read_b64 v[48:49], v5 offset:35840
    v_mfma_f32_16x16x32_bf16 v[108:111], v[68:71], a[200:203], v[108:111]
    ds_read_b64 v[50:51], v5 offset:36352
    v_mfma_f32_16x16x32_bf16 v[112:115], v[72:75], a[200:203], v[112:115]
    ds_read2st64_b64 v[52:55], v5 offset0:110 offset1:111
    ds_read_b64 v[56:57], v6 offset:35840
    ds_read_b64 v[58:59], v6 offset:36352
    buffer_load_dwordx4 a[112:115], v241, s[4:7], s85 offen offset:2048 sc1
    s_waitcnt lgkmcnt(6)
    v_mfma_f32_16x16x32_bf16 v[136:139], v[96:99], v[96:99], v[136:139]
    ds_read_b64 v[92:93], v14 offset:18432
    v_mfma_f32_16x16x32_bf16 v[140:143], v[132:135], v[96:99], v[140:143]
    ds_read_b64 v[94:95], v14 offset:18944
    s_barrier
    s_waitcnt vmcnt(8)
    v_mfma_f32_16x16x32_bf16 v[100:103], v[76:79], a[208:211], v[100:103]
    ds_read2st64_b64 v[60:63], v5 offset0:32 offset1:33
    v_mfma_f32_16x16x32_bf16 v[104:107], v[80:83], a[208:211], v[104:107]
    ds_read_b64 v[64:65], v5 offset:36864
    v_mfma_f32_16x16x32_bf16 v[108:111], v[84:87], a[208:211], v[108:111]
    ds_read_b64 v[66:67], v5 offset:37376
    v_mfma_f32_16x16x32_bf16 v[112:115], v[88:91], a[208:211], v[112:115]
    ds_read2st64_b64 v[68:71], v5 offset0:112 offset1:113
    ds_read_b64 v[72:73], v6 offset:36864
    ds_read_b64 v[74:75], v6 offset:37376
    buffer_load_dwordx4 a[120:123], v241, s[4:7], s85 offen offset:3072 sc1
    s_waitcnt lgkmcnt(6)
    v_mfma_f32_16x16x32_bf16 v[136:139], v[92:95], v[92:95], v[136:139]
    ds_read_b64 v[96:97], v14 offset:19456
    v_mfma_f32_16x16x32_bf16 v[140:143], v[132:135], v[92:95], v[140:143]
    ds_read_b64 v[98:99], v14 offset:19968
    s_waitcnt vmcnt(8)
    v_mfma_f32_16x16x32_bf16 v[100:103], v[44:47], a[216:219], v[100:103]
    ds_read2st64_b64 v[76:79], v5 offset0:34 offset1:35
    v_mfma_f32_16x16x32_bf16 v[104:107], v[48:51], a[216:219], v[104:107]
    ds_read_b64 v[80:81], v5 offset:37888
    v_mfma_f32_16x16x32_bf16 v[108:111], v[52:55], a[216:219], v[108:111]
    ds_read_b64 v[82:83], v5 offset:38400
    v_mfma_f32_16x16x32_bf16 v[112:115], v[56:59], a[216:219], v[112:115]
    s_add_u32 s85, s85, 4096
    ds_read2st64_b64 v[84:87], v5 offset0:114 offset1:115
    ds_read_b64 v[88:89], v6 offset:37888
    ds_read_b64 v[90:91], v6 offset:38400
    buffer_load_dwordx4 a[128:131], v241, s[4:7], s85 offen offset:0 sc1
    s_waitcnt lgkmcnt(6)
    v_mfma_f32_16x16x32_bf16 v[136:139], v[96:99], v[96:99], v[136:139]
    v_mfma_f32_16x16x32_bf16 v[140:143], v[132:135], v[96:99], v[140:143]
    s_waitcnt vmcnt(8)
    v_mfma_f32_16x16x32_bf16 v[100:103], v[60:63], a[224:227], v[100:103]
    ds_read2st64_b64 v[44:47], v5 offset0:36 offset1:37
    v_mfma_f32_16x16x32_bf16 v[104:107], v[64:67], a[224:227], v[104:107]
    ds_read_b64 v[48:49], v5 offset:38912
    v_mfma_f32_16x16x32_bf16 v[108:111], v[68:71], a[224:227], v[108:111]
    ds_read_b64 v[50:51], v5 offset:39424
    v_mfma_f32_16x16x32_bf16 v[112:115], v[72:75], a[224:227], v[112:115]
    ds_read2st64_b64 v[52:55], v5 offset0:116 offset1:117
    ds_read_b64 v[56:57], v6 offset:38912
    ds_read_b64 v[58:59], v6 offset:39424
    buffer_load_dwordx4 a[136:139], v241, s[4:7], s85 offen offset:1024 sc1
    s_waitcnt vmcnt(8) lgkmcnt(6)
    v_mfma_f32_16x16x32_bf16 v[100:103], v[76:79], a[232:235], v[100:103]
    ds_read2st64_b64 v[60:63], v5 offset0:38 offset1:39
    v_and_b32 v3, 3, v0
    v_mfma_f32_16x16x32_bf16 v[104:107], v[80:83], a[232:235], v[104:107]
    ds_read_b64 v[64:65], v5 offset:39936
    v_cmp_eq_u32 vcc, 1, v3
    v_mfma_f32_16x16x32_bf16 v[108:111], v[84:87], a[232:235], v[108:111]
    ds_read_b64 v[66:67], v5 offset:40448
    v_cndmask_b32 v136, v136, v137, vcc
    v_mfma_f32_16x16x32_bf16 v[112:115], v[88:91], a[232:235], v[112:115]
    ds_read2st64_b64 v[68:71], v5 offset0:118 offset1:119
    v_cmp_eq_u32 vcc, 2, v3
    ds_read_b64 v[72:73], v6 offset:39936
    s_nop 0
    v_cndmask_b32 v136, v136, v138, vcc
    ds_read_b64 v[74:75], v6 offset:40448
    v_cmp_eq_u32 vcc, 3, v3
    buffer_load_dwordx4 a[144:147], v241, s[4:7], s85 offen offset:2048 sc1
    s_waitcnt vmcnt(8) lgkmcnt(6)
    v_mfma_f32_16x16x32_bf16 v[100:103], v[44:47], a[240:243], v[100:103]
    ds_read2st64_b64 v[76:79], v5 offset0:0 offset1:1
    v_cndmask_b32 v136, v136, v139, vcc
    v_mfma_f32_16x16x32_bf16 v[104:107], v[48:51], a[240:243], v[104:107]
    ds_read_b64 v[80:81], v5 offset:20480
    v_mul_f32 v140, 0xbacccccd, v140
    v_mfma_f32_16x16x32_bf16 v[108:111], v[52:55], a[240:243], v[108:111]
    ds_read_b64 v[82:83], v5 offset:20992
    v_mul_f32 v136, 0x3acccccd, v136
    v_mfma_f32_16x16x32_bf16 v[112:115], v[56:59], a[240:243], v[112:115]
    ds_read2st64_b64 v[84:87], v5 offset0:80 offset1:81
    v_fma_f32 v136, -v140, v140, v136
    ds_read_b64 v[88:89], v6 offset:20480
    v_max_f32 v136, 0, v136
    ds_read_b64 v[90:91], v6 offset:20992
    v_add_f32 v136, 0x3727c5ac, v136
    buffer_load_dwordx4 a[152:155], v241, s[4:7], s85 offen offset:3072 sc1
    v_rsq_f32 v136, v136
    v_lshrrev_b32 v3, 2, v1
    v_cmp_eq_u32 vcc, v3, v2
    s_lshl_b32 s62, s82, 6
    s_add_u32 s62, s62, 81920
    v_lshl_add_u32 v3, v1, 2, s62
    s_mov_b64 exec, vcc
    ds_write2st64_b32 v3, v136, v140 offset0:0 offset1:1
    s_mov_b64 exec, -1
    s_waitcnt lgkmcnt(0)
    s_barrier
    s_waitcnt vmcnt(8)
    v_mfma_f32_16x16x32_bf16 v[100:103], v[60:63], a[248:251], v[100:103]
    ds_read2st64_b64 v[44:47], v5 offset0:2 offset1:3
    v_add_u32 v3, 81920, v7
    v_mfma_f32_16x16x32_bf16 v[104:107], v[64:67], a[248:251], v[104:107]
    ds_read_b64 v[48:49], v5 offset:21504
    ds_read_b128 v[180:183], v3 offset:256
    v_mfma_f32_16x16x32_bf16 v[108:111], v[68:71], a[248:251], v[108:111]
    ds_read_b64 v[50:51], v5 offset:22016
    ds_read_b128 v[164:167], v3 offset:0
    v_mfma_f32_16x16x32_bf16 v[112:115], v[72:75], a[248:251], v[112:115]
    s_add_u32 s85, s85, 4096
    ds_read2st64_b64 v[52:55], v5 offset0:82 offset1:83
    ds_read_b128 v[184:187], v3 offset:320
    ds_read_b64 v[56:57], v6 offset:21504
    ds_read_b128 v[168:171], v3 offset:64
    ds_read_b64 v[58:59], v6 offset:22016
    ds_read_b128 v[188:191], v3 offset:384
    buffer_load_dwordx4 a[160:163], v241, s[4:7], s85 offen offset:0 sc1
    ds_read_b128 v[172:175], v3 offset:128
    ds_read_b128 v[192:195], v3 offset:448
    ds_read_b128 v[176:179], v3 offset:192
    s_waitcnt lgkmcnt(11)
    v_pk_fma_f32 v[100:101], v[180:181], v[212:213], v[100:101] op_sel:[0,0,0] op_sel_hi:[1,0,1]
    v_pk_fma_f32 v[102:103], v[182:183], v[212:213], v[102:103] op_sel:[0,0,0] op_sel_hi:[1,0,1]
    v_pk_fma_f32 v[116:117], v[180:181], v[214:215], v[116:117] op_sel:[0,0,0] op_sel_hi:[1,0,1]
    v_pk_fma_f32 v[118:119], v[182:183], v[214:215], v[118:119] op_sel:[0,0,0] op_sel_hi:[1,0,1]
    s_waitcnt lgkmcnt(9)
    v_pk_fma_f32 v[100:101], v[100:101], v[164:165], v[212:213] op_sel:[0,0,1] op_sel_hi:[1,1,1]
    v_pk_fma_f32 v[102:103], v[102:103], v[166:167], v[212:213] op_sel:[0,0,1] op_sel_hi:[1,1,1]
    v_pk_fma_f32 v[116:117], v[116:117], v[164:165], v[214:215] op_sel:[0,0,1] op_sel_hi:[1,1,1]
    v_pk_fma_f32 v[118:119], v[118:119], v[166:167], v[214:215] op_sel:[0,0,1] op_sel_hi:[1,1,1]
    v_pk_mul_f32 v[216:217], v[100:101], v[100:101]
    v_pk_mul_f32 v[218:219], v[102:103], v[102:103]
    v_pk_mul_f32 v[220:221], v[116:117], v[116:117]
    v_pk_mul_f32 v[222:223], v[118:119], v[118:119]
    v_pk_fma_f32 v[216:217], v[216:217], s[66:67], s[66:67] op_sel:[0,0,1] op_sel_hi:[1,0,1]
    v_pk_fma_f32 v[218:219], v[218:219], s[66:67], s[66:67] op_sel:[0,0,1] op_sel_hi:[1,0,1]
    v_pk_fma_f32 v[220:221], v[220:221], s[66:67], s[66:67] op_sel:[0,0,1] op_sel_hi:[1,0,1]
    v_pk_fma_f32 v[222:223], v[222:223], s[66:67], s[66:67] op_sel:[0,0,1] op_sel_hi:[1,0,1]
    v_pk_mul_f32 v[216:217], v[216:217], v[100:101]
    v_pk_mul_f32 v[218:219], v[218:219], v[102:103]
    v_pk_mul_f32 v[220:221], v[220:221], v[116:117]
    v_pk_mul_f32 v[222:223], v[222:223], v[118:119]
    v_exp_f32 v216, v216
    v_exp_f32 v217, v217
    buffer_load_dwordx4 a[168:171], v241, s[4:7], s85 offen offset:1024 sc1
    v_exp_f32 v218, v218
    v_exp_f32 v219, v219
    v_exp_f32 v220, v220
    v_exp_f32 v221, v221
    v_exp_f32 v222, v222
    v_exp_f32 v223, v223
    v_pk_add_f32 v[216:217], v[216:217], s[68:69]
    v_pk_add_f32 v[218:219], v[218:219], s[68:69]
    v_pk_add_f32 v[220:221], v[220:221], s[68:69]
    v_pk_add_f32 v[222:223], v[222:223], s[68:69]
    v_rcp_f32 v216, v216
    v_rcp_f32 v217, v217
    v_rcp_f32 v218, v218
    v_rcp_f32 v219, v219
    v_rcp_f32 v220, v220
    v_rcp_f32 v221, v221
    v_rcp_f32 v222, v222
    v_rcp_f32_e64 v223, v223
    v_pk_mul_f32 v[100:101], v[100:101], v[216:217]
    v_pk_mul_f32 v[102:103], v[102:103], v[218:219]
    v_pk_mul_f32 v[116:117], v[116:117], v[220:221]
    v_pk_mul_f32 v[118:119], v[118:119], v[222:223]
    buffer_load_dwordx4 a[176:179], v241, s[4:7], s85 offen offset:2048 sc1
    v_pk_add_f32 v[164:165], v[100:101], v[116:117]
    v_pk_mul_f32 v[180:181], v[100:101], v[100:101]
    v_pk_add_f32 v[166:167], v[102:103], v[118:119]
    v_pk_mul_f32 v[182:183], v[102:103], v[102:103]
    v_pk_fma_f32 v[180:181], v[116:117], v[116:117], v[180:181]
    v_pk_fma_f32 v[182:183], v[118:119], v[118:119], v[182:183]
    s_waitcnt lgkmcnt(0)
    v_pk_fma_f32 v[104:105], v[184:185], v[212:213], v[104:105] op_sel:[0,0,0] op_sel_hi:[1,0,1]
    v_pk_fma_f32 v[106:107], v[186:187], v[212:213], v[106:107] op_sel:[0,0,0] op_sel_hi:[1,0,1]
    v_pk_fma_f32 v[120:121], v[184:185], v[214:215], v[120:121] op_sel:[0,0,0] op_sel_hi:[1,0,1]
    v_pk_fma_f32 v[122:123], v[186:187], v[214:215], v[122:123] op_sel:[0,0,0] op_sel_hi:[1,0,1]
    v_pk_fma_f32 v[104:105], v[104:105], v[168:169], v[212:213] op_sel:[0,0,1] op_sel_hi:[1,1,1]
    v_pk_fma_f32 v[106:107], v[106:107], v[170:171], v[212:213] op_sel:[0,0,1] op_sel_hi:[1,1,1]
    v_pk_fma_f32 v[120:121], v[120:121], v[168:169], v[214:215] op_sel:[0,0,1] op_sel_hi:[1,1,1]
    v_pk_fma_f32 v[122:123], v[122:123], v[170:171], v[214:215] op_sel:[0,0,1] op_sel_hi:[1,1,1]
    v_pk_mul_f32 v[216:217], v[104:105], v[104:105]
    v_pk_mul_f32 v[218:219], v[106:107], v[106:107]
    v_pk_mul_f32 v[220:221], v[120:121], v[120:121]
    v_pk_mul_f32 v[222:223], v[122:123], v[122:123]
    v_pk_fma_f32 v[216:217], v[216:217], s[66:67], s[66:67] op_sel:[0,0,1] op_sel_hi:[1,0,1]
    v_pk_fma_f32 v[218:219], v[218:219], s[66:67], s[66:67] op_sel:[0,0,1] op_sel_hi:[1,0,1]
    v_pk_fma_f32 v[220:221], v[220:221], s[66:67], s[66:67] op_sel:[0,0,1] op_sel_hi:[1,0,1]
    v_pk_fma_f32 v[222:223], v[222:223], s[66:67], s[66:67] op_sel:[0,0,1] op_sel_hi:[1,0,1]
    buffer_load_dwordx4 a[184:187], v241, s[4:7], s85 offen offset:3072 sc1
    v_pk_mul_f32 v[216:217], v[216:217], v[104:105]
    v_pk_mul_f32 v[218:219], v[218:219], v[106:107]
    v_pk_mul_f32 v[220:221], v[220:221], v[120:121]
    v_pk_mul_f32 v[222:223], v[222:223], v[122:123]
    v_exp_f32 v216, v216
    v_exp_f32 v217, v217
    v_exp_f32 v218, v218
    v_exp_f32 v219, v219
    v_exp_f32 v220, v220
    v_exp_f32 v221, v221
    v_exp_f32 v222, v222
    s_add_u32 s85, s85, 4096
    v_exp_f32 v223, v223
    v_pk_add_f32 v[216:217], v[216:217], s[68:69]
    v_pk_add_f32 v[218:219], v[218:219], s[68:69]
    v_pk_add_f32 v[220:221], v[220:221], s[68:69]
    v_pk_add_f32 v[222:223], v[222:223], s[68:69]
    v_rcp_f32 v216, v216
    v_rcp_f32 v217, v217
    v_rcp_f32 v218, v218
    v_rcp_f32 v219, v219
    v_rcp_f32 v220, v220
    v_rcp_f32 v221, v221
    buffer_load_dwordx4 a[192:195], v241, s[4:7], s85 offen offset:0 sc1
    v_rcp_f32 v222, v222
    v_rcp_f32_e64 v223, v223
    v_pk_mul_f32 v[104:105], v[104:105], v[216:217]
    v_pk_mul_f32 v[106:107], v[106:107], v[218:219]
    v_pk_mul_f32 v[120:121], v[120:121], v[220:221]
    v_pk_mul_f32 v[122:123], v[122:123], v[222:223]
    v_pk_add_f32 v[168:169], v[104:105], v[120:121]
    v_pk_mul_f32 v[184:185], v[104:105], v[104:105]
    v_pk_add_f32 v[170:171], v[106:107], v[122:123]
    v_pk_mul_f32 v[186:187], v[106:107], v[106:107]
    v_pk_fma_f32 v[184:185], v[120:121], v[120:121], v[184:185]
    v_pk_fma_f32 v[186:187], v[122:123], v[122:123], v[186:187]
    v_pk_fma_f32 v[108:109], v[188:189], v[212:213], v[108:109] op_sel:[0,0,0] op_sel_hi:[1,0,1]
    v_pk_fma_f32 v[110:111], v[190:191], v[212:213], v[110:111] op_sel:[0,0,0] op_sel_hi:[1,0,1]
    v_pk_fma_f32 v[124:125], v[188:189], v[214:215], v[124:125] op_sel:[0,0,0] op_sel_hi:[1,0,1]
    v_pk_fma_f32 v[126:127], v[190:191], v[214:215], v[126:127] op_sel:[0,0,0] op_sel_hi:[1,0,1]
    v_pk_fma_f32 v[108:109], v[108:109], v[172:173], v[212:213] op_sel:[0,0,1] op_sel_hi:[1,1,1]
    v_pk_fma_f32 v[110:111], v[110:111], v[174:175], v[212:213] op_sel:[0,0,1] op_sel_hi:[1,1,1]
    v_pk_fma_f32 v[124:125], v[124:125], v[172:173], v[214:215] op_sel:[0,0,1] op_sel_hi:[1,1,1]
    v_pk_fma_f32 v[126:127], v[126:127], v[174:175], v[214:215] op_sel:[0,0,1] op_sel_hi:[1,1,1]
    v_pk_mul_f32 v[216:217], v[108:109], v[108:109]
    v_pk_mul_f32 v[218:219], v[110:111], v[110:111]
    buffer_load_dwordx4 a[200:203], v241, s[4:7], s85 offen offset:1024 sc1
    v_pk_mul_f32 v[220:221], v[124:125], v[124:125]
    v_pk_mul_f32 v[222:223], v[126:127], v[126:127]
    v_pk_fma_f32 v[216:217], v[216:217], s[66:67], s[66:67] op_sel:[0,0,1] op_sel_hi:[1,0,1]
    v_pk_fma_f32 v[218:219], v[218:219], s[66:67], s[66:67] op_sel:[0,0,1] op_sel_hi:[1,0,1]
    v_pk_fma_f32 v[220:221], v[220:221], s[66:67], s[66:67] op_sel:[0,0,1] op_sel_hi:[1,0,1]
    v_pk_fma_f32 v[222:223], v[222:223], s[66:67], s[66:67] op_sel:[0,0,1] op_sel_hi:[1,0,1]
    v_pk_mul_f32 v[216:217], v[216:217], v[108:109]
    v_pk_mul_f32 v[218:219], v[218:219], v[110:111]
    v_pk_mul_f32 v[220:221], v[220:221], v[124:125]
    v_pk_mul_f32 v[222:223], v[222:223], v[126:127]
    v_exp_f32 v216, v216
    v_exp_f32 v217, v217
    v_exp_f32 v218, v218
    v_exp_f32 v219, v219
    v_exp_f32 v220, v220
    v_exp_f32 v221, v221
    v_exp_f32 v222, v222
    v_exp_f32 v223, v223
    v_pk_add_f32 v[216:217], v[216:217], s[68:69]
    v_pk_add_f32 v[218:219], v[218:219], s[68:69]
    v_pk_add_f32 v[220:221], v[220:221], s[68:69]
    v_pk_add_f32 v[222:223], v[222:223], s[68:69]
    buffer_load_dwordx4 a[208:211], v241, s[4:7], s85 offen offset:2048 sc1
    v_rcp_f32 v216, v216
    v_rcp_f32 v217, v217
    v_rcp_f32 v218, v218
    v_rcp_f32 v219, v219
    v_rcp_f32 v220, v220
    v_rcp_f32 v221, v221
    v_rcp_f32 v222, v222
    v_rcp_f32 v223, v223
    v_pk_mul_f32 v[108:109], v[108:109], v[216:217]
    v_pk_mul_f32 v[110:111], v[110:111], v[218:219]
    v_pk_mul_f32 v[124:125], v[124:125], v[220:221]
    v_pk_mul_f32 v[126:127], v[126:127], v[222:223]
    v_pk_add_f32 v[172:173], v[108:109], v[124:125]
    v_pk_mul_f32 v[188:189], v[108:109], v[108:109]
    v_pk_add_f32 v[174:175], v[110:111], v[126:127]
    v_pk_mul_f32 v[190:191], v[110:111], v[110:111]
    v_pk_fma_f32 v[188:189], v[124:125], v[124:125], v[188:189]
    v_pk_fma_f32 v[190:191], v[126:127], v[126:127], v[190:191]
    v_pk_fma_f32 v[112:113], v[192:193], v[212:213], v[112:113] op_sel:[0,0,0] op_sel_hi:[1,0,1]
    v_pk_fma_f32 v[114:115], v[194:195], v[212:213], v[114:115] op_sel:[0,0,0] op_sel_hi:[1,0,1]
    v_pk_fma_f32 v[128:129], v[192:193], v[214:215], v[128:129] op_sel:[0,0,0] op_sel_hi:[1,0,1]
    v_pk_fma_f32 v[130:131], v[194:195], v[214:215], v[130:131] op_sel:[0,0,0] op_sel_hi:[1,0,1]
    buffer_load_dwordx4 a[216:219], v241, s[4:7], s85 offen offset:3072 sc1
    v_pk_fma_f32 v[112:113], v[112:113], v[176:177], v[212:213] op_sel:[0,0,1] op_sel_hi:[1,1,1]
    v_pk_fma_f32 v[114:115], v[114:115], v[178:179], v[212:213] op_sel:[0,0,1] op_sel_hi:[1,1,1]
    v_pk_fma_f32 v[128:129], v[128:129], v[176:177], v[214:215] op_sel:[0,0,1] op_sel_hi:[1,1,1]
    v_pk_fma_f32 v[130:131], v[130:131], v[178:179], v[214:215] op_sel:[0,0,1] op_sel_hi:[1,1,1]
    v_pk_mul_f32 v[216:217], v[112:113], v[112:113]
    v_pk_mul_f32 v[218:219], v[114:115], v[114:115]
    v_pk_mul_f32 v[220:221], v[128:129], v[128:129]
    v_pk_mul_f32 v[222:223], v[130:131], v[130:131]
    v_pk_fma_f32 v[216:217], v[216:217], s[66:67], s[66:67] op_sel:[0,0,1] op_sel_hi:[1,0,1]
    v_pk_fma_f32 v[218:219], v[218:219], s[66:67], s[66:67] op_sel:[0,0,1] op_sel_hi:[1,0,1]
    v_pk_fma_f32 v[220:221], v[220:221], s[66:67], s[66:67] op_sel:[0,0,1] op_sel_hi:[1,0,1]
    s_add_u32 s85, s85, 4096
    v_pk_fma_f32 v[222:223], v[222:223], s[66:67], s[66:67] op_sel:[0,0,1] op_sel_hi:[1,0,1]
    v_pk_mul_f32 v[216:217], v[216:217], v[112:113]
    v_pk_mul_f32 v[218:219], v[218:219], v[114:115]
    v_pk_mul_f32 v[220:221], v[220:221], v[128:129]
    v_pk_mul_f32 v[222:223], v[222:223], v[130:131]
    v_exp_f32 v216, v216
    v_exp_f32 v217, v217
    v_exp_f32 v218, v218
    v_exp_f32 v219, v219
    v_exp_f32 v220, v220
    v_exp_f32 v221, v221
    buffer_load_dwordx4 a[224:227], v241, s[4:7], s85 offen offset:0 sc1
    v_exp_f32 v222, v222
    v_exp_f32 v223, v223
    v_pk_add_f32 v[216:217], v[216:217], s[68:69]
    v_pk_add_f32 v[218:219], v[218:219], s[68:69]
    v_pk_add_f32 v[220:221], v[220:221], s[68:69]
    v_pk_add_f32 v[222:223], v[222:223], s[68:69]
    v_rcp_f32 v216, v216
    v_rcp_f32 v217, v217
    v_rcp_f32 v218, v218
    v_rcp_f32 v219, v219
    v_rcp_f32 v220, v220
    v_rcp_f32 v221, v221
    v_rcp_f32 v222, v222
    v_rcp_f32 v223, v223
    v_pk_mul_f32 v[112:113], v[112:113], v[216:217]
    v_pk_mul_f32 v[114:115], v[114:115], v[218:219]
    v_pk_mul_f32 v[128:129], v[128:129], v[220:221]
    v_pk_mul_f32 v[130:131], v[130:131], v[222:223]
    v_pk_add_f32 v[176:177], v[112:113], v[128:129]
    v_pk_mul_f32 v[192:193], v[112:113], v[112:113]
    v_pk_add_f32 v[178:179], v[114:115], v[130:131]
    v_pk_mul_f32 v[194:195], v[114:115], v[114:115]
    buffer_load_dwordx4 a[232:235], v241, s[4:7], s85 offen offset:1024 sc1
    v_pk_fma_f32 v[192:193], v[128:129], v[128:129], v[192:193]
    v_pk_fma_f32 v[194:195], v[130:131], v[130:131], v[194:195]
    v_add_f32_dpp v164, v164, v164 row_ror:8 row_mask:0xf bank_mask:3
    v_add_f32_dpp v165, v165, v165 row_ror:8 row_mask:0xf bank_mask:3
    v_add_f32_dpp v166, v166, v166 row_ror:8 row_mask:0xf bank_mask:3
    v_add_f32_dpp v167, v167, v167 row_ror:8 row_mask:0xf bank_mask:3
    v_add_f32_dpp v168, v168, v168 row_ror:8 row_mask:0xf bank_mask:3
    v_add_f32_dpp v169, v169, v169 row_ror:8 row_mask:0xf bank_mask:3
    v_add_f32_dpp v170, v170, v170 row_ror:8 row_mask:0xf bank_mask:3
    v_add_f32_dpp v171, v171, v171 row_ror:8 row_mask:0xf bank_mask:3
    v_add_f32_dpp v172, v172, v172 row_ror:8 row_mask:0xf bank_mask:3
    v_add_f32_dpp v173, v173, v173 row_ror:8 row_mask:0xf bank_mask:3
    v_add_f32_dpp v174, v174, v174 row_ror:8 row_mask:0xf bank_mask:3
    v_add_f32_dpp v175, v175, v175 row_ror:8 row_mask:0xf bank_mask:3
    v_add_f32_dpp v176, v176, v176 row_ror:8 row_mask:0xf bank_mask:3
    v_add_f32_dpp v177, v177, v177 row_ror:8 row_mask:0xf bank_mask:3
    v_add_f32_dpp v178, v178, v178 row_ror:8 row_mask:0xf bank_mask:3
    v_add_f32_dpp v179, v179, v179 row_ror:8 row_mask:0xf bank_mask:3
    v_add_f32_dpp v164, v180, v180 row_ror:8 row_mask:0xf bank_mask:12
    v_add_f32_dpp v165, v181, v181 row_ror:8 row_mask:0xf bank_mask:12
    v_add_f32_dpp v166, v182, v182 row_ror:8 row_mask:0xf bank_mask:12
    v_add_f32_dpp v167, v183, v183 row_ror:8 row_mask:0xf bank_mask:12
    buffer_load_dwordx4 a[240:243], v241, s[4:7], s85 offen offset:2048 sc1
    v_add_f32_dpp v168, v184, v184 row_ror:8 row_mask:0xf bank_mask:12
    v_add_f32_dpp v169, v185, v185 row_ror:8 row_mask:0xf bank_mask:12
    v_add_f32_dpp v170, v186, v186 row_ror:8 row_mask:0xf bank_mask:12
    v_add_f32_dpp v171, v187, v187 row_ror:8 row_mask:0xf bank_mask:12
    v_add_f32_dpp v172, v188, v188 row_ror:8 row_mask:0xf bank_mask:12
    v_add_f32_dpp v173, v189, v189 row_ror:8 row_mask:0xf bank_mask:12
    v_add_f32_dpp v174, v190, v190 row_ror:8 row_mask:0xf bank_mask:12
    v_add_f32_dpp v175, v191, v191 row_ror:8 row_mask:0xf bank_mask:12
    v_add_f32_dpp v176, v192, v192 row_ror:8 row_mask:0xf bank_mask:12
    v_add_f32_dpp v177, v193, v193 row_ror:8 row_mask:0xf bank_mask:12
    v_add_f32_dpp v178, v194, v194 row_ror:8 row_mask:0xf bank_mask:12
    v_add_f32_dpp v179, v195, v195 row_ror:8 row_mask:0xf bank_mask:12
    v_add_f32_dpp v164, v164, v164 row_half_mirror row_mask:0xf bank_mask:5
    v_add_f32_dpp v165, v165, v165 row_half_mirror row_mask:0xf bank_mask:5
    v_add_f32_dpp v166, v166, v166 row_half_mirror row_mask:0xf bank_mask:5
    v_add_f32_dpp v167, v167, v167 row_half_mirror row_mask:0xf bank_mask:5
    v_add_f32_dpp v168, v168, v168 row_half_mirror row_mask:0xf bank_mask:5
    v_add_f32_dpp v169, v169, v169 row_half_mirror row_mask:0xf bank_mask:5
    v_add_f32_dpp v170, v170, v170 row_half_mirror row_mask:0xf bank_mask:5
    v_add_f32_dpp v171, v171, v171 row_half_mirror row_mask:0xf bank_mask:5
    v_add_f32_dpp v164, v172, v172 row_half_mirror row_mask:0xf bank_mask:10
    v_add_f32_dpp v165, v173, v173 row_half_mirror row_mask:0xf bank_mask:10
    buffer_load_dwordx4 a[248:251], v241, s[4:7], s85 offen offset:3072 sc1
    v_add_f32_dpp v166, v174, v174 row_half_mirror row_mask:0xf bank_mask:10
    v_add_f32_dpp v167, v175, v175 row_half_mirror row_mask:0xf bank_mask:10
    v_add_f32_dpp v168, v176, v176 row_half_mirror row_mask:0xf bank_mask:10
    v_add_f32_dpp v169, v177, v177 row_half_mirror row_mask:0xf bank_mask:10
    v_add_f32_dpp v170, v178, v178 row_half_mirror row_mask:0xf bank_mask:10
    v_add_f32_dpp v171, v179, v179 row_half_mirror row_mask:0xf bank_mask:10
    v_bfe_u32 v3, v0, 2, 2
    v_lshl_add_u32 v3, v3, 7, v7
    v_and_b32_e64 v4, 3, v0
    v_mul_u32_u24 v4, 528, v4
    s_mul_i32 s64, s82, 2112
    s_add_u32 s64, s64, 90624
    v_add3_u32 v3, s64, v3, v4
    ds_write_b128 v3, v[164:167]
    ds_write_b128 v3, v[168:171] offset:64
    s_lshl_b32 s55, s83, 13
    s_add_u32 s55, s55, 524288
    s_waitcnt lgkmcnt(0)
    s_barrier
    s_cmp_lg_u32 s82, 3
    s_cbranch_scc1 L_adaL_nopub_25_w3
    v_lshlrev_b32 v3, 2, v240
    v_add_u32 v3, 90624, v3
    ds_read_b32 v164, v3 offset:0
    ds_read_b32 v165, v3 offset:256
    ds_read_b32 v166, v3 offset:528
    ds_read_b32 v167, v3 offset:784
    ds_read_b32 v168, v3 offset:1056
    ds_read_b32 v169, v3 offset:1312
    ds_read_b32 v170, v3 offset:1584
    ds_read_b32 v171, v3 offset:1840
    ds_read_b32 v172, v3 offset:2112
    ds_read_b32 v173, v3 offset:2368
    ds_read_b32 v174, v3 offset:2640
    ds_read_b32 v175, v3 offset:2896
    ds_read_b32 v176, v3 offset:3168
    ds_read_b32 v177, v3 offset:3424
    ds_read_b32 v178, v3 offset:3696
    ds_read_b32 v179, v3 offset:3952
    ds_read_b32 v180, v3 offset:4224
    ds_read_b32 v181, v3 offset:4480
    ds_read_b32 v182, v3 offset:4752
    ds_read_b32 v183, v3 offset:5008
    ds_read_b32 v184, v3 offset:5280
    ds_read_b32 v185, v3 offset:5536
    ds_read_b32 v186, v3 offset:5808
    ds_read_b32 v187, v3 offset:6064
    ds_read_b32 v188, v3 offset:6336
    ds_read_b32 v189, v3 offset:6592
    ds_read_b32 v190, v3 offset:6864
    ds_read_b32 v191, v3 offset:7120
    ds_read_b32 v192, v3 offset:7392
    ds_read_b32 v193, v3 offset:7648
    ds_read_b32 v194, v3 offset:7920
    ds_read_b32 v195, v3 offset:8176
    s_lshl_b32 s64, s84, 10
    s_add_u32 s64, s64, s55
    s_waitcnt lgkmcnt(15)
    v_pk_add_f32 v[164:165], v[164:165], v[166:167]
    v_pk_add_f32 v[168:169], v[168:169], v[170:171]
    v_pk_add_f32 v[172:173], v[172:173], v[174:175]
    v_pk_add_f32 v[176:177], v[176:177], v[178:179]
    s_waitcnt lgkmcnt(12)
    v_pk_add_f32 v[180:181], v[180:181], v[182:183]
    s_waitcnt lgkmcnt(8)
    v_pk_add_f32 v[184:185], v[184:185], v[186:187]
    s_waitcnt lgkmcnt(4)
    v_pk_add_f32 v[188:189], v[188:189], v[190:191]
    s_waitcnt lgkmcnt(0)
    v_pk_add_f32 v[192:193], v[192:193], v[194:195]
    v_pk_add_f32 v[164:165], v[164:165], v[168:169]
    v_pk_add_f32 v[172:173], v[172:173], v[176:177]
    v_pk_add_f32 v[180:181], v[180:181], v[184:185]
    v_pk_add_f32 v[188:189], v[188:189], v[192:193]
    v_pk_add_f32 v[164:165], v[164:165], v[172:173]
    v_pk_add_f32 v[180:181], v[180:181], v[188:189]
    v_pk_add_f32 v[216:217], v[164:165], v[180:181]
    v_mov_b32 v219, v13
    v_mov_b32 v218, v217
    v_mov_b32 v217, v13
    buffer_store_dwordx4 v[216:219], v241, s[4:7], s64 offen sc1
L_adaL_nopub_25_w3:
    s_waitcnt vmcnt(18)
    v_mfma_f32_16x16x32_bf16 v[132:135], a[96:99], v[76:79], 0
    ds_read2st64_b64 v[60:63], v5 offset0:4 offset1:5
    s_lshl_b32 s64, s82, 8
    v_mfma_f32_16x16x32_bf16 v[136:139], a[96:99], v[80:83], 0
    ds_read_b64 v[64:65], v5 offset:22528
    s_add_u32 s55, s55, s64
    v_mfma_f32_16x16x32_bf16 v[140:143], a[96:99], v[84:87], 0
    ds_read_b64 v[66:67], v5 offset:23040
    v_lshlrev_b32 v172, 4, v1
    v_mfma_f32_16x16x32_bf16 v[144:147], a[96:99], v[88:91], 0
    s_add_u32 s85, s85, 4096
    v_mov_b32 v148, 0
    v_mov_b32 v149, 0
    v_mov_b32 v150, 0
    v_mov_b32 v151, 0
    ds_read2st64_b64 v[68:71], v5 offset0:84 offset1:85
    v_lshl_add_u32 v172, v2, 11, v172
    v_mov_b32 v152, 0
    v_mov_b32 v153, 0
    v_mov_b32 v154, 0
    v_mov_b32 v155, 0
    ds_read_b64 v[72:73], v6 offset:22528
    v_lshlrev_b32 v92, 1, v7
    v_mov_b32 v156, 0
    v_mov_b32 v157, 0
    v_mov_b32 v158, 0
    v_mov_b32 v159, 0
    ds_read_b64 v[74:75], v6 offset:23040
    v_add_u32 v92, 88576, v92
    v_mov_b32 v160, 0
    v_mov_b32 v161, 0
    v_mov_b32 v162, 0
    v_mov_b32 v163, 0
    v_add_u32 v93, 88832, v7
    v_mfma_f32_16x16x32_bf16 v[132:135], a[104:107], v[44:47], v[132:135]
    ds_read_b64 v[76:77], v5 offset:3072
    s_add_u32 m0, s41, 0
    v_mfma_f32_16x16x32_bf16 v[136:139], a[104:107], v[48:51], v[136:139]
    ds_read_b64 v[78:79], v5 offset:3584
    ds_read_b128 v[176:179], v92 offset:0
    v_mfma_f32_16x16x32_bf16 v[140:143], a[104:107], v[52:55], v[140:143]
    ds_read_b64 v[80:81], v5 offset:23552
    v_mfma_f32_16x16x32_bf16 v[144:147], a[104:107], v[56:59], v[144:147]
    ds_read_b64 v[82:83], v5 offset:24064
    ds_read_b128 v[180:183], v92 offset:16
    ds_read_b64 v[84:85], v6 offset:3072
    ds_read_b64 v[86:87], v6 offset:3584
    ds_read_b128 v[184:187], v92 offset:128
    ds_read_b64 v[88:89], v6 offset:23552
    ds_read_b64 v[90:91], v6 offset:24064
    ds_read_b128 v[188:191], v92 offset:144
    s_waitcnt vmcnt(16) lgkmcnt(12)
    v_mfma_f32_16x16x32_bf16 v[132:135], a[112:115], v[60:63], v[132:135]
    ds_read_b64 v[44:45], v5 offset:4096
    v_mfma_f32_16x16x32_bf16 v[136:139], a[112:115], v[64:67], v[136:139]
    ds_read_b64 v[46:47], v5 offset:4608
    ds_read_b128 v[192:195], v93
    v_mfma_f32_16x16x32_bf16 v[140:143], a[112:115], v[68:71], v[140:143]
    ds_read_b64 v[48:49], v5 offset:24576
    s_mov_b32 s57, 0x07060302
    v_mfma_f32_16x16x32_bf16 v[144:147], a[112:115], v[72:75], v[144:147]
    ds_read_b64 v[50:51], v5 offset:25088
    buffer_load_dwordx4 v245, s[32:35], s88 offen offset:0 lds
    ds_read_b64 v[52:53], v6 offset:4096
    s_waitcnt lgkmcnt(15)
    v_perm_b32 v230, v177, v176, s57
    ds_read_b64 v[54:55], v6 offset:4608
    buffer_load_dwordx4 v246, s[32:35], s88 offen offset:1024 lds
    ds_read_b64 v[56:57], v6 offset:24576
    s_add_u32 m0, s41, 2048
    ds_read_b64 v[58:59], v6 offset:25088
    buffer_load_dwordx4 v245, s[32:35], s89 offen offset:0 lds
    s_waitcnt lgkmcnt(10)
    v_mfma_f32_16x16x32_bf16 v[132:135], a[120:123], v[76:79], v[132:135]
    ds_read_b64 v[60:61], v5 offset:5120
    v_perm_b32 v231, v179, v178, s57
    v_mfma_f32_16x16x32_bf16 v[136:139], a[120:123], v[80:83], v[136:139]
    ds_read_b64 v[62:63], v5 offset:5632
    buffer_load_dwordx4 v246, s[32:35], s89 offen offset:1024 lds
    v_mfma_f32_16x16x32_bf16 v[140:143], a[120:123], v[84:87], v[140:143]
    ds_read_b64 v[64:65], v5 offset:25600
    s_add_u32 m0, s41, 4096
    v_mfma_f32_16x16x32_bf16 v[144:147], a[120:123], v[88:91], v[144:147]
    ds_read_b64 v[66:67], v5 offset:26112
    buffer_load_dwordx4 v245, s[32:35], s90 offen offset:0 lds
    ds_read_b64 v[68:69], v6 offset:5120
    v_perm_b32 v232, v181, v180, s57
    ds_read_b64 v[70:71], v6 offset:5632
    buffer_load_dwordx4 v246, s[32:35], s90 offen offset:1024 lds
    ds_read_b64 v[72:73], v6 offset:25600
    s_add_u32 m0, s41, 6144
    ds_read_b64 v[74:75], v6 offset:26112
    buffer_load_dwordx4 v245, s[32:35], s91 offen offset:0 lds
    s_waitcnt vmcnt(21) lgkmcnt(8)
    v_mfma_f32_16x16x32_bf16 v[132:135], a[128:131], v[44:47], v[132:135]
    ds_read_b64 v[76:77], v5 offset:6144
    v_perm_b32 v233, v183, v182, s57
    v_mfma_f32_16x16x32_bf16 v[136:139], a[128:131], v[48:51], v[136:139]
    ds_read_b64 v[78:79], v5 offset:6656
    buffer_load_dwordx4 v246, s[32:35], s91 offen offset:1024 lds
    v_mfma_f32_16x16x32_bf16 v[140:143], a[128:131], v[52:55], v[140:143]
    ds_read_b64 v[80:81], v5 offset:26624
    v_add_u32 v247, 128, v245
    v_mfma_f32_16x16x32_bf16 v[144:147], a[128:131], v[56:59], v[144:147]
    ds_read_b64 v[82:83], v5 offset:27136
    v_bfi_b32 v245, s40, v247, v245
    v_bfi_b32 v246, s40, v247, v246
    ds_read_b64 v[84:85], v6 offset:6144
    s_add_u32 m0, s41, 8192
    ds_read_b64 v[86:87], v6 offset:6656
    buffer_load_dwordx4 v245, s[32:35], s88 offen offset:0 lds
    ds_read_b64 v[88:89], v6 offset:26624
    v_perm_b32 v234, v185, v184, s57
    ds_read_b64 v[90:91], v6 offset:27136
    buffer_load_dwordx4 v246, s[32:35], s88 offen offset:1024 lds
    s_waitcnt lgkmcnt(8)
    v_mfma_f32_16x16x32_bf16 v[132:135], a[136:139], v[60:63], v[132:135]
    ds_read_b64 v[44:45], v5 offset:7168
    s_add_u32 m0, s41, 10240
    v_mfma_f32_16x16x32_bf16 v[136:139], a[136:139], v[64:67], v[136:139]
    ds_read_b64 v[46:47], v5 offset:7680
    buffer_load_dwordx4 v245, s[32:35], s89 offen offset:0 lds
    v_mfma_f32_16x16x32_bf16 v[140:143], a[136:139], v[68:71], v[140:143]
    ds_read_b64 v[48:49], v5 offset:27648
    v_perm_b32 v235, v187, v186, s57
    v_mfma_f32_16x16x32_bf16 v[144:147], a[136:139], v[72:75], v[144:147]
    ds_read_b64 v[50:51], v5 offset:28160
    buffer_load_dwordx4 v246, s[32:35], s89 offen offset:1024 lds
    ds_read_b64 v[52:53], v6 offset:7168
    s_add_u32 m0, s41, 12288
    ds_read_b64 v[54:55], v6 offset:7680
    buffer_load_dwordx4 v245, s[32:35], s90 offen offset:0 lds
    ds_read_b64 v[56:57], v6 offset:27648
    v_perm_b32 v236, v189, v188, s57
    ds_read_b64 v[58:59], v6 offset:28160
    buffer_load_dwordx4 v246, s[32:35], s90 offen offset:1024 lds
    s_waitcnt vmcnt(26) lgkmcnt(8)
    v_mfma_f32_16x16x32_bf16 v[132:135], a[144:147], v[76:79], v[132:135]
    ds_read_b64 v[60:61], v5 offset:8192
    v_perm_b32 v237, v191, v190, s57
    v_mfma_f32_16x16x32_bf16 v[136:139], a[144:147], v[80:83], v[136:139]
    ds_read_b64 v[62:63], v5 offset:8704
    s_waitcnt vmcnt(12)
    ds_read_b128 a[0:3], v10 offset:0
    v_mfma_f32_16x16x32_bf16 v[140:143], a[144:147], v[84:87], v[140:143]
    ds_read_b64 v[64:65], v5 offset:28672
    v_perm_b32 v238, v193, v192, s57
    v_mfma_f32_16x16x32_bf16 v[144:147], a[144:147], v[88:91], v[144:147]
    ds_read_b64 v[66:67], v5 offset:29184
    ds_read_b128 a[4:7], v11 offset:0
    ds_read_b64 v[68:69], v6 offset:8192
    s_add_u32 m0, s41, 0
    ds_read_b64 v[70:71], v6 offset:8704
    s_waitcnt vmcnt(10) lgkmcnt(2)
    ds_read_b64 v[72:73], v6 offset:28672
    v_perm_b32 v239, v195, v194, s57
    ds_read_b64 v[74:75], v6 offset:29184
    buffer_load_dwordx4 v245, s[32:35], s91 offen offset:0 lds
    v_mfma_f32_16x16x32_bf16 v[132:135], a[152:155], v[44:47], v[132:135]
    ds_read_b64 v[76:77], v5 offset:9216
    v_mfma_f32_16x16x32_bf16 v[136:139], a[152:155], v[48:51], v[136:139]
    ds_read_b64 v[78:79], v5 offset:9728
    ds_read_b128 a[8:11], v10 offset:2048
    v_mfma_f32_16x16x32_bf16 v[140:143], a[152:155], v[52:55], v[140:143]
    ds_read_b64 v[80:81], v5 offset:29696
    v_mfma_f32_16x16x32_bf16 v[144:147], a[152:155], v[56:59], v[144:147]
    ds_read_b64 v[82:83], v5 offset:30208
    ds_read_b128 a[12:15], v11 offset:2048
    ds_read_b64 v[84:85], v6 offset:9216
    ds_read_b64 v[86:87], v6 offset:9728
    buffer_load_dwordx4 v246, s[32:35], s91 offen offset:1024 lds
    ds_read_b64 v[88:89], v6 offset:29696
    v_add_u32 v247, 128, v245
    ds_read_b64 v[90:91], v6 offset:30208
    v_bfi_b32 v245, s40, v247, v245
    v_bfi_b32 v246, s40, v247, v246
    s_waitcnt lgkmcnt(10)
    v_mfma_f32_16x16x32_bf16 v[132:135], a[160:163], v[60:63], v[132:135]
    ds_read_b64 v[44:45], v5 offset:10240
    s_add_u32 m0, s41, 2048
    v_mfma_f32_16x16x32_bf16 v[136:139], a[160:163], v[64:67], v[136:139]
    ds_read_b64 v[46:47], v5 offset:10752
    s_waitcnt vmcnt(10) lgkmcnt(6)
    v_mfma_f32_16x16x32_bf16 v[140:143], a[160:163], v[68:71], v[140:143]
    ds_read_b64 v[48:49], v5 offset:30720
    v_mfma_f32_16x16x32_bf16 v[144:147], a[160:163], v[72:75], v[144:147]
    ds_read_b64 v[50:51], v5 offset:31232
    buffer_load_dwordx4 v245, s[32:35], s88 offen offset:0 lds
    ds_read_b64 v[52:53], v6 offset:10240
    ds_read_b64 v[54:55], v6 offset:10752
    ds_read_b128 a[16:19], v10 offset:4096
    ds_read_b64 v[56:57], v6 offset:30720
    ds_read_b64 v[58:59], v6 offset:31232
    ds_read_b128 a[20:23], v11 offset:4096
    s_waitcnt lgkmcnt(10)
    v_mfma_f32_16x16x32_bf16 v[132:135], a[168:171], v[76:79], v[132:135]
    ds_read_b64 v[60:61], v5 offset:11264
    v_mfma_f32_16x16x32_bf16 v[136:139], a[168:171], v[80:83], v[136:139]
    ds_read_b64 v[62:63], v5 offset:11776
    buffer_load_dwordx4 v246, s[32:35], s88 offen offset:1024 lds
    v_mfma_f32_16x16x32_bf16 v[140:143], a[168:171], v[84:87], v[140:143]
    ds_read_b64 v[64:65], v5 offset:31744
    s_add_u32 m0, s41, 4096
    v_mfma_f32_16x16x32_bf16 v[144:147], a[168:171], v[88:91], v[144:147]
    ds_read_b64 v[66:67], v5 offset:32256
    s_waitcnt vmcnt(10) lgkmcnt(4)
    ds_read_b64 v[68:69], v6 offset:11264
    ds_read_b64 v[70:71], v6 offset:11776
    buffer_load_dwordx4 v245, s[32:35], s89 offen offset:0 lds
    ds_read_b64 v[72:73], v6 offset:31744
    ds_read_b64 v[74:75], v6 offset:32256
    ds_read_b128 a[24:27], v10 offset:6144
    v_mfma_f32_16x16x32_bf16 v[132:135], a[176:179], v[44:47], v[132:135]
    ds_read_b64 v[76:77], v5 offset:12288
    v_mfma_f32_16x16x32_bf16 v[136:139], a[176:179], v[48:51], v[136:139]
    ds_read_b64 v[78:79], v5 offset:12800
    ds_read_b128 a[28:31], v11 offset:6144
    v_mfma_f32_16x16x32_bf16 v[140:143], a[176:179], v[52:55], v[140:143]
    ds_read_b64 v[80:81], v5 offset:32768
    v_mfma_f32_16x16x32_bf16 v[144:147], a[176:179], v[56:59], v[144:147]
    ds_read_b64 v[82:83], v5 offset:33280
    buffer_load_dwordx4 v246, s[32:35], s89 offen offset:1024 lds
    ds_read_b64 v[84:85], v6 offset:12288
    s_add_u32 m0, s41, 6144
    ds_read_b64 v[86:87], v6 offset:12800
    s_waitcnt vmcnt(10) lgkmcnt(4)
    ds_read_b64 v[88:89], v6 offset:32768
    ds_read_b64 v[90:91], v6 offset:33280
    buffer_load_dwordx4 v245, s[32:35], s90 offen offset:0 lds
    v_mfma_f32_16x16x32_bf16 v[132:135], a[184:187], v[60:63], v[132:135]
    ds_read_b64 v[44:45], v5 offset:13312
    v_mfma_f32_16x16x32_bf16 v[136:139], a[184:187], v[64:67], v[136:139]
    ds_read_b64 v[46:47], v5 offset:13824
    ds_read_b128 a[32:35], v10 offset:8192
    v_mfma_f32_16x16x32_bf16 v[140:143], a[184:187], v[68:71], v[140:143]
    ds_read_b64 v[48:49], v5 offset:33792
    v_mfma_f32_16x16x32_bf16 v[144:147], a[184:187], v[72:75], v[144:147]
    ds_read_b64 v[50:51], v5 offset:34304
    ds_read_b128 a[36:39], v11 offset:8192
    ds_read_b64 v[52:53], v6 offset:13312
    ds_read_b64 v[54:55], v6 offset:13824
    buffer_load_dwordx4 v[164:167], v172, s[4:7], s55 offen offset:0 sc1
    ds_read_b64 v[56:57], v6 offset:33792
    ds_read_b64 v[58:59], v6 offset:34304
    buffer_load_dwordx4 v[168:171], v172, s[4:7], s55 offen offset:1024 sc1
    s_waitcnt lgkmcnt(10)
    v_mfma_f32_16x16x32_bf16 v[132:135], a[192:195], v[76:79], v[132:135]
    ds_read_b64 v[60:61], v5 offset:14336
    v_mfma_f32_16x16x32_bf16 v[136:139], a[192:195], v[80:83], v[136:139]
    ds_read_b64 v[62:63], v5 offset:14848
    buffer_load_dwordx4 v246, s[32:35], s90 offen offset:1024 lds
    v_mfma_f32_16x16x32_bf16 v[140:143], a[192:195], v[84:87], v[140:143]
    ds_read_b64 v[64:65], v5 offset:34816
    s_add_u32 m0, s41, 8192
    v_mfma_f32_16x16x32_bf16 v[144:147], a[192:195], v[88:91], v[144:147]
    ds_read_b64 v[66:67], v5 offset:35328
    s_waitcnt vmcnt(12) lgkmcnt(8)
    ds_read_b64 v[68:69], v6 offset:14336
    ds_read_b64 v[70:71], v6 offset:14848
    buffer_load_dwordx4 v245, s[32:35], s91 offen offset:0 lds
    ds_read_b64 v[72:73], v6 offset:34816
    ds_read_b64 v[74:75], v6 offset:35328
    ds_read_b128 a[40:43], v10 offset:10240
    s_waitcnt lgkmcnt(9)
    v_mfma_f32_16x16x32_bf16 v[132:135], a[200:203], v[44:47], v[132:135]
    ds_read_b64 v[76:77], v5 offset:15360
    v_mfma_f32_16x16x32_bf16 v[136:139], a[200:203], v[48:51], v[136:139]
    ds_read_b64 v[78:79], v5 offset:15872
    ds_read_b128 a[44:47], v11 offset:10240
    v_mfma_f32_16x16x32_bf16 v[140:143], a[200:203], v[52:55], v[140:143]
    ds_read_b64 v[80:81], v5 offset:35840
    v_mfma_f32_16x16x32_bf16 v[144:147], a[200:203], v[56:59], v[144:147]
    ds_read_b64 v[82:83], v5 offset:36352
    buffer_load_dwordx4 v246, s[32:35], s91 offen offset:1024 lds
    ds_read_b64 v[84:85], v6 offset:15360
    v_add_u32 v247, 128, v245
    ds_read_b64 v[86:87], v6 offset:15872
    v_bfi_b32 v245, s40, v247, v245
    v_bfi_b32 v246, s40, v247, v246
    ds_read_b64 v[88:89], v6 offset:35840
    s_add_u32 m0, s41, 10240
    ds_read_b64 v[90:91], v6 offset:36352
    s_waitcnt vmcnt(12) lgkmcnt(6)
    buffer_load_dwordx4 v245, s[32:35], s88 offen offset:0 lds
    ds_read_b128 a[48:51], v10 offset:12288
    ds_read_b128 a[52:55], v11 offset:12288
    s_waitcnt vmcnt(5)
    v_min3_u32 v3, v165, v167, v13
    s_waitcnt vmcnt(4)
    v_min3_u32 v3, v3, v169, v171
    v_max3_u32 v4, v165, v167, v13
    v_max3_u32 v4, v4, v169, v171
    v_cmp_ne_u32 vcc, v3, v4
    s_nop 0
    s_cbranch_vccnz L_adaL_slow_26_w3
L_adaL_got_28_w3:
    v_add_f32 v164, v164, v168
    v_add_f32 v166, v166, v170
    v_mov_b32 v165, v164
    v_mov_b32 v167, v166
    s_nop 0
    v_permlane16_swap_b32 v164, v165
    buffer_load_dwordx4 v246, s[32:35], s88 offen offset:1024 lds
    v_permlane16_swap_b32 v166, v167
    v_add_f32 v164, v164, v165
    v_add_f32 v166, v166, v167
    v_mov_b32 v165, v164
    v_mov_b32 v167, v166
    s_add_u32 m0, s41, 12288
    s_waitcnt lgkmcnt(0)
    buffer_load_dwordx4 v245, s[32:35], s89 offen offset:0 lds
    ds_read_b128 a[56:59], v10 offset:0
    ds_read_b128 a[60:63], v11 offset:0
    v_permlane32_swap_b32 v164, v165
    v_permlane32_swap_b32 v166, v167
    v_add_f32 v164, v164, v165
    v_add_f32 v166, v166, v167
    v_mul_f32 v216, 0xba97b426, v164
    buffer_load_dwordx4 v246, s[32:35], s89 offen offset:1024 lds
    v_mul_f32 v217, 0x3a97b426, v166
    v_fma_f32 v217, -v216, v216, v217
    v_max_f32 v217, 0, v217
    v_add_f32 v217, 0x3727c5ac, v217
    v_rsq_f32 v217, v217
    s_add_u32 m0, s41, 0
    s_waitcnt lgkmcnt(0)
    buffer_load_dwordx4 v245, s[32:35], s90 offen offset:0 lds
    ds_read_b128 a[64:67], v10 offset:2048
    ds_read_b128 a[68:71], v11 offset:2048
    s_lshl_b32 s64, s82, 6
    s_add_u32 s64, s64, 82432
    v_add_u32 v3, s64, v12
    v_mul_f32 v216, v216, v217
    ds_write2st64_b32 v3, v217, v216 offset0:0 offset1:1
    v_add_u32 v3, 82432, v7
    s_waitcnt lgkmcnt(0)
    s_barrier
    ds_read_b128 v[164:167], v3 offset:0
    buffer_load_dwordx4 v246, s[32:35], s90 offen offset:1024 lds
    ds_read_b128 v[180:183], v3 offset:256
    ds_read_b128 v[168:171], v3 offset:64
    ds_read_b128 v[184:187], v3 offset:320
    ds_read_b128 v[172:175], v3 offset:128
    ds_read_b128 v[188:191], v3 offset:384
    s_add_u32 m0, s41, 2048
    s_nop 0
    buffer_load_dwordx4 v245, s[32:35], s91 offen offset:0 lds
    ds_read_b128 a[72:75], v10 offset:4096
    ds_read_b128 a[76:79], v11 offset:4096
    ds_read_b128 v[176:179], v3 offset:192
    ds_read_b128 v[192:195], v3 offset:448
    s_mul_i32 s56, s84, 458752
    s_add_u32 s56, s56, 12582912
    s_lshl_b32 s64, s82, 17
    s_add_u32 s64, s64, s56
    s_lshl_b32 s65, s83, 11
    s_add_u32 s64, s64, s65
    v_add_u32 v4, 45056, v242
    s_waitcnt lgkmcnt(8)
    v_pk_fma_f32 v[100:101], v[100:101], v[164:165], v[180:181]
    v_pk_fma_f32 v[102:103], v[102:103], v[166:167], v[182:183]
    buffer_load_dwordx4 v246, s[32:35], s91 offen offset:1024 lds
    v_add_u32 v247, 128, v245
    v_bfi_b32 v245, s40, v247, v245
    v_bfi_b32 v246, s40, v247, v246
    s_waitcnt lgkmcnt(6)
    v_pk_fma_f32 v[104:105], v[104:105], v[168:169], v[184:185]
    v_pk_fma_f32 v[106:107], v[106:107], v[170:171], v[186:187]
    v_cvt_pk_bf16_f32 v216, v100, v104
    v_cvt_pk_bf16_f32 v217, v101, v105
    v_cvt_pk_bf16_f32 v218, v102, v106
    s_add_u32 m0, s41, 4096
    s_waitcnt vmcnt(10) lgkmcnt(2)
    buffer_load_dwordx4 v245, s[32:35], s88 offen offset:0 lds
    ds_read_b128 a[80:83], v10 offset:6144
    ds_read_b128 a[84:87], v11 offset:6144
    v_cvt_pk_bf16_f32 v219, v103, v107
    buffer_store_dwordx4 v[216:219], v241, s[4:7], s64 offen offset:0 sc1
    v_pk_fma_f32 v[116:117], v[116:117], v[164:165], v[180:181]
    v_pk_fma_f32 v[118:119], v[118:119], v[166:167], v[182:183]
    v_pk_fma_f32 v[120:121], v[120:121], v[168:169], v[184:185]
    buffer_load_dwordx4 v246, s[32:35], s88 offen offset:1024 lds
    v_pk_fma_f32 v[122:123], v[122:123], v[170:171], v[186:187]
    v_cvt_pk_bf16_f32 v220, v116, v120
    v_cvt_pk_bf16_f32 v221, v117, v121
    v_cvt_pk_bf16_f32 v222, v118, v122
    v_cvt_pk_bf16_f32 v223, v119, v123
    s_add_u32 m0, s41, 6144
    s_waitcnt vmcnt(11) lgkmcnt(0)
    buffer_load_dwordx4 v245, s[32:35], s89 offen offset:0 lds
    ds_read_b128 a[88:91], v10 offset:8192
    ds_read_b128 a[92:95], v11 offset:8192
    v_pk_fma_f32 v[108:109], v[108:109], v[172:173], v[188:189]
    v_pk_fma_f32 v[110:111], v[110:111], v[174:175], v[190:191]
    v_pk_fma_f32 v[112:113], v[112:113], v[176:177], v[192:193]
    v_pk_fma_f32 v[114:115], v[114:115], v[178:179], v[194:195]
    buffer_load_dwordx4 v246, s[32:35], s89 offen offset:1024 lds
    v_cvt_pk_bf16_f32 v216, v108, v112
    v_cvt_pk_bf16_f32 v217, v109, v113
    v_cvt_pk_bf16_f32 v218, v110, v114
    v_cvt_pk_bf16_f32 v219, v111, v115
    buffer_store_dwordx4 v[216:219], v241, s[4:7], s64 offen offset:1024 sc1
    s_add_u32 m0, s41, 8192
    s_waitcnt vmcnt(12) lgkmcnt(0)
    buffer_load_dwordx4 v245, s[32:35], s90 offen offset:0 lds
    ds_read_b128 a[96:99], v10 offset:10240
    ds_read_b128 a[100:103], v11 offset:10240
    v_pk_fma_f32 v[124:125], v[124:125], v[172:173], v[188:189]
    v_pk_fma_f32 v[126:127], v[126:127], v[174:175], v[190:191]
    v_pk_fma_f32 v[128:129], v[128:129], v[176:177], v[192:193]
    v_pk_fma_f32 v[130:131], v[130:131], v[178:179], v[194:195]
    v_cvt_pk_bf16_f32 v220, v124, v128
    buffer_load_dwordx4 v246, s[32:35], s90 offen offset:1024 lds
    v_cvt_pk_bf16_f32 v221, v125, v129
    v_cvt_pk_bf16_f32 v222, v126, v130
    v_cvt_pk_bf16_f32 v223, v127, v131
    v_mfma_f32_16x16x32_bf16 v[132:135], a[208:211], v[60:63], v[132:135]
    ds_read_b64 v[44:45], v5 offset:16384
    s_add_u32 m0, s41, 10240
    v_mfma_f32_16x16x32_bf16 v[136:139], a[208:211], v[64:67], v[136:139]
    ds_read_b64 v[46:47], v5 offset:16896
    s_waitcnt vmcnt(12) lgkmcnt(2)
    v_mfma_f32_16x16x32_bf16 v[140:143], a[208:211], v[68:71], v[140:143]
    ds_read_b64 v[48:49], v5 offset:36864
    s_mul_i32 s57, s84, 10
    v_mfma_f32_16x16x32_bf16 v[144:147], a[208:211], v[72:75], v[144:147]
    ds_read_b64 v[50:51], v5 offset:37376
    buffer_load_dwordx4 v245, s[32:35], s91 offen offset:0 lds
    ds_read_b64 v[52:53], v6 offset:16384
    v_add_u32 v92, s57, v2
    ds_read_b64 v[54:55], v6 offset:16896
    ds_read_b128 a[104:107], v10 offset:12288
    ds_read_b64 v[56:57], v6 offset:36864
    v_lshrrev_b32 v93, 2, v92
    ds_read_b64 v[58:59], v6 offset:37376
    ds_read_b128 a[108:111], v11 offset:12288
    v_mfma_f32_16x16x32_bf16 v[132:135], a[216:219], v[76:79], v[132:135]
    ds_read_b64 v[60:61], v5 offset:17408
    v_and_b32_e64 v92, 3, v92
    v_mfma_f32_16x16x32_bf16 v[136:139], a[216:219], v[80:83], v[136:139]
    ds_read_b64 v[62:63], v5 offset:17920
    buffer_load_dwordx4 v246, s[32:35], s91 offen offset:1024 lds
    v_mfma_f32_16x16x32_bf16 v[140:143], a[216:219], v[84:87], v[140:143]
    ds_read_b64 v[64:65], v5 offset:37888
    v_add_u32 v247, 128, v245
    v_mfma_f32_16x16x32_bf16 v[144:147], a[216:219], v[88:91], v[144:147]
    ds_read_b64 v[66:67], v5 offset:38400
    v_bfi_b32 v245, s40, v247, v245
    v_bfi_b32 v246, s40, v247, v246
    ds_read_b64 v[68:69], v6 offset:17408
    s_add_u32 m0, s41, 12288
    ds_read_b64 v[70:71], v6 offset:17920
    s_waitcnt vmcnt(12) lgkmcnt(6)
    ds_read_b64 v[72:73], v6 offset:37888
    v_lshlrev_b32 v92, 7, v92
    ds_read_b64 v[74:75], v6 offset:38400
    buffer_load_dwordx4 v245, s[32:35], s88 offen offset:0 lds
    v_mfma_f32_16x16x32_bf16 v[132:135], a[224:227], v[44:47], v[132:135]
    ds_read_b64 v[76:77], v5 offset:18432
    v_lshl_add_u32 v92, v93, 10, v92
    v_mfma_f32_16x16x32_bf16 v[136:139], a[224:227], v[48:51], v[136:139]
    ds_read_b64 v[78:79], v5 offset:18944
    ds_read_b128 a[112:115], v10 offset:0
    v_mfma_f32_16x16x32_bf16 v[140:143], a[224:227], v[52:55], v[140:143]
    ds_read_b64 v[80:81], v5 offset:38912
    v_lshl_add_u32 v92, v1, 3, v92
    v_mfma_f32_16x16x32_bf16 v[144:147], a[224:227], v[56:59], v[144:147]
    ds_read_b64 v[82:83], v5 offset:39424
    ds_read_b128 a[116:119], v11 offset:0
    ds_read_b64 v[84:85], v6 offset:18432
    v_add_u32 v92, s53, v92
    ds_read_b64 v[86:87], v6 offset:18944
    ds_read_b64 v[16:17], v92 offset:0
    ds_read_b64 v[88:89], v6 offset:38912
    ds_read_b64 v[90:91], v6 offset:39424
    ds_read_b64 v[18:19], v92 offset:512
    s_waitcnt lgkmcnt(12)
    v_mfma_f32_16x16x32_bf16 v[132:135], a[232:235], v[60:63], v[132:135]
    ds_read_b64 v[44:45], v5 offset:19456
    v_mfma_f32_16x16x32_bf16 v[136:139], a[232:235], v[64:67], v[136:139]
    ds_read_b64 v[46:47], v5 offset:19968
    ds_read_b64 v[20:21], v92 offset:1024
    v_mfma_f32_16x16x32_bf16 v[140:143], a[232:235], v[68:71], v[140:143]
    ds_read_b64 v[48:49], v5 offset:39936
    v_mfma_f32_16x16x32_bf16 v[144:147], a[232:235], v[72:75], v[144:147]
    ds_read_b64 v[50:51], v5 offset:40448
    ds_read_b64 v[22:23], v92 offset:1536
    ds_read_b64 v[52:53], v6 offset:19456
    v_lshrrev_b32 v92, 1, v2
    ds_read_b64 v[54:55], v6 offset:19968
    buffer_load_dwordx4 v246, s[32:35], s88 offen offset:1024 lds
    ds_read_b64 v[56:57], v6 offset:39936
    s_add_u32 m0, s41, 0
    ds_read_b64 v[58:59], v6 offset:40448
    s_waitcnt vmcnt(12) lgkmcnt(15)
    s_waitcnt lgkmcnt(11)
    v_mfma_f32_16x16x32_bf16 v[132:135], a[240:243], v[76:79], v[132:135]
    buffer_load_dwordx4 v245, s[32:35], s89 offen offset:0 lds
    v_mfma_f32_16x16x32_bf16 v[136:139], a[240:243], v[80:83], v[136:139]
    ds_read_b128 a[120:123], v10 offset:2048
    v_mfma_f32_16x16x32_bf16 v[140:143], a[240:243], v[84:87], v[140:143]
    ds_read_b128 a[124:127], v11 offset:2048
    v_mfma_f32_16x16x32_bf16 v[144:147], a[240:243], v[88:91], v[144:147]
    buffer_load_dwordx4 v246, s[32:35], s89 offen offset:1024 lds
    s_add_u32 m0, s41, 2048
    s_waitcnt vmcnt(11) lgkmcnt(0)
    buffer_load_dwordx4 v245, s[32:35], s90 offen offset:0 lds
    ds_read_b128 a[128:131], v10 offset:4096
    ds_read_b128 a[132:135], v11 offset:4096
    v_add3_u32 v92, v92, s57, 8
    v_mfma_f32_16x16x32_bf16 v[132:135], a[248:251], v[44:47], v[132:135]
    buffer_load_dwordx4 v246, s[32:35], s90 offen offset:1024 lds
    s_add_u32 m0, s41, 4096
    v_mfma_f32_16x16x32_bf16 v[136:139], a[248:251], v[48:51], v[136:139]
    s_waitcnt vmcnt(11) lgkmcnt(0)
    buffer_load_dwordx4 v245, s[32:35], s91 offen offset:0 lds
    v_mfma_f32_16x16x32_bf16 v[140:143], a[248:251], v[52:55], v[140:143]
    ds_read_b128 a[136:139], v10 offset:6144
    v_mfma_f32_16x16x32_bf16 v[144:147], a[248:251], v[56:59], v[144:147]
    ds_read_b128 a[140:143], v11 offset:6144
    buffer_load_dwordx4 v246, s[32:35], s91 offen offset:1024 lds
    v_add_u32 v247, 128, v245
    v_bfi_b32 v245, s40, v247, v245
    v_bfi_b32 v246, s40, v247, v246
    v_lshrrev_b32 v93, 2, v92
    v_and_b32 v92, 3, v92
    v_lshlrev_b32 v92, 7, v92
    s_lshl_b32 s64, s84, 5
    s_add_u32 s64, s64, s83
    s_lshl_b32 s64, s64, 5
    s_add_u32 s64, s64, 196608
    s_cmp_lg_u32 s82, 0
    s_cselect_b32 s64, 33554432, s64
    v_mul_u32_u24 v4, 8448, v240
    s_waitcnt vmcnt(12)
    s_barrier
    s_mov_b64 exec, 15
    buffer_store_dword v13, v4, s[4:7], s64 offen sc1
    s_mov_b64 exec, -1
    v_lshl_add_u32 v92, v93, 10, v92
    v_and_b32 v93, 1, v2
    v_lshl_add_u32 v92, v93, 9, v92
    v_lshl_add_u32 v92, v1, 3, v92
    v_add_u32 v92, s53, v92
    ds_read_b64 v[24:25], v92
    s_lshl_b32 s57, s84, 2
    s_add_u32 s57, s57, s82
    s_lshl_b32 s57, s57, 8
    s_lshr_b32 s58, s83, 3
    s_mul_i32 s58, s58, 8448
    s_add_u32 s57, s57, s58
    s_add_u32 s60, s57, 196608
    v_and_b32 v26, 7, v0
    v_lshlrev_b32 v26, 5, v26
    s_lshl_b32 s57, s82, 14
    s_add_u32 s57, s57, s56
    v_add_u32 v9, s57, v241
    s_mul_i32 s20, s84, 0
    s_add_u32 s21, s20, 2048
    s_and_b32 s21, s21, 0x3fff
    s_add_u32 s22, s21, 2048
    s_and_b32 s22, s22, 0x3fff
    s_add_u32 s23, s22, 2048
    s_and_b32 s23, s23, 0x3fff
    s_add_u32 s24, s23, 2048
    s_and_b32 s24, s24, 0x3fff
    s_add_u32 s25, s24, 2048
    s_and_b32 s25, s25, 0x3fff
    s_add_u32 s26, s25, 2048
    s_and_b32 s26, s26, 0x3fff
    s_add_u32 s27, s26, 2048
    s_and_b32 s27, s27, 0x3fff
    v_lshlrev_b32 v3, 2, v1
    v_add_u32 v3, 81920, v3
    ds_read2_b32 v[164:165], v3 offset0:0 offset1:64
    ds_read2_b32 v[166:167], v3 offset0:16 offset1:80
    ds_read2_b32 v[168:169], v3 offset0:32 offset1:96
    ds_read2_b32 v[170:171], v3 offset0:48 offset1:112
    s_lshl_b32 s64, s82, 10
    s_add_u32 s64, s64, 86528
    v_add_u32_e64 v3, s64, v241
    s_waitcnt lgkmcnt(3)
    v_pk_fma_f32 v[132:133], v[196:197], v[164:165], v[132:133] op_sel:[0,1,0] op_sel_hi:[1,1,1]
    s_add_u32 m0, s41, 6144
    s_waitcnt vmcnt(11)
    buffer_load_dwordx4 v245, s[32:35], s88 offen offset:0 lds
    ds_read_b128 a[144:147], v10 offset:8192
    ds_read_b128 a[148:151], v11 offset:8192
    v_pk_fma_f32 v[134:135], v[198:199], v[164:165], v[134:135] op_sel:[0,1,0] op_sel_hi:[1,1,1]
    v_pk_fma_f32 v[148:149], v[200:201], v[164:165], v[148:149] op_sel:[0,1,0] op_sel_hi:[1,1,1]
    v_pk_fma_f32 v[150:151], v[202:203], v[164:165], v[150:151] op_sel:[0,1,0] op_sel_hi:[1,1,1]
    v_pk_fma_f32 v[132:133], v[132:133], v[164:165], v[204:205] op_sel:[0,0,0] op_sel_hi:[1,0,1]
    v_pk_fma_f32 v[134:135], v[134:135], v[164:165], v[206:207] op_sel:[0,0,0] op_sel_hi:[1,0,1]
    v_pk_fma_f32 v[148:149], v[148:149], v[164:165], v[208:209] op_sel:[0,0,0] op_sel_hi:[1,0,1]
    v_pk_fma_f32 v[150:151], v[150:151], v[164:165], v[210:211] op_sel:[0,0,0] op_sel_hi:[1,0,1]
    v_pk_mul_f32 v[216:217], v[132:133], v[132:133]
    buffer_load_dwordx4 v246, s[32:35], s88 offen offset:1024 lds
    v_pk_mul_f32 v[218:219], v[134:135], v[134:135]
    v_pk_mul_f32 v[220:221], v[148:149], v[148:149]
    v_pk_mul_f32 v[222:223], v[150:151], v[150:151]
    v_pk_fma_f32 v[216:217], v[216:217], s[66:67], s[66:67] op_sel:[0,0,1] op_sel_hi:[1,0,1]
    v_pk_fma_f32 v[218:219], v[218:219], s[66:67], s[66:67] op_sel:[0,0,1] op_sel_hi:[1,0,1]
    v_pk_fma_f32 v[220:221], v[220:221], s[66:67], s[66:67] op_sel:[0,0,1] op_sel_hi:[1,0,1]
    v_pk_fma_f32 v[222:223], v[222:223], s[66:67], s[66:67] op_sel:[0,0,1] op_sel_hi:[1,0,1]
    v_pk_mul_f32 v[216:217], v[216:217], v[132:133]
    s_add_u32 m0, s41, 8192
    s_waitcnt vmcnt(11) lgkmcnt(0)
    buffer_load_dwordx4 v245, s[32:35], s89 offen offset:0 lds
    ds_read_b128 a[152:155], v10 offset:10240
    ds_read_b128 a[156:159], v11 offset:10240
    v_pk_mul_f32 v[218:219], v[218:219], v[134:135]
    v_pk_mul_f32 v[220:221], v[220:221], v[148:149]
    v_pk_mul_f32 v[222:223], v[222:223], v[150:151]
    v_exp_f32 v216, v216
    v_exp_f32 v217, v217
    v_exp_f32 v218, v218
    v_exp_f32 v219, v219
    v_exp_f32 v220, v220
    buffer_load_dwordx4 v246, s[32:35], s89 offen offset:1024 lds
    v_exp_f32 v221, v221
    v_exp_f32 v222, v222
    v_exp_f32 v223, v223
    v_pk_add_f32 v[216:217], v[216:217], s[68:69]
    v_pk_add_f32 v[218:219], v[218:219], s[68:69]
    v_pk_add_f32 v[220:221], v[220:221], s[68:69]
    v_pk_add_f32 v[222:223], v[222:223], s[68:69]
    v_rcp_f32 v216, v216
    s_add_u32 m0, s41, 10240
    s_waitcnt vmcnt(11) lgkmcnt(0)
    buffer_load_dwordx4 v245, s[32:35], s90 offen offset:0 lds
    ds_read_b128 a[160:163], v10 offset:12288
    ds_read_b128 a[164:167], v11 offset:12288
    v_rcp_f32 v217, v217
    v_rcp_f32 v218, v218
    v_rcp_f32 v219, v219
    v_rcp_f32 v220, v220
    v_rcp_f32 v221, v221
    v_rcp_f32 v222, v222
    v_rcp_f32 v223, v223
    v_pk_mul_f32 v[132:133], v[132:133], v[216:217]
    buffer_load_dwordx4 v246, s[32:35], s90 offen offset:1024 lds
    v_pk_mul_f32 v[134:135], v[134:135], v[218:219]
    v_pk_mul_f32 v[148:149], v[148:149], v[220:221]
    v_pk_mul_f32 v[150:151], v[150:151], v[222:223]
    v_cvt_pk_bf16_f32 v180, v132, v148
    v_cvt_pk_bf16_f32 v181, v133, v149
    v_cvt_pk_bf16_f32 v182, v134, v150
    v_cvt_pk_bf16_f32 v183, v135, v151
    ds_write_b128 v3, v[180:183] offset:0
    s_add_u32 m0, s41, 12288
    s_waitcnt vmcnt(11) lgkmcnt(1)
    buffer_load_dwordx4 v245, s[32:35], s91 offen offset:0 lds
    ds_read_b128 a[168:171], v10 offset:0
    ds_read_b128 a[172:175], v11 offset:0
    v_pk_fma_f32 v[136:137], v[196:197], v[166:167], v[136:137] op_sel:[0,1,0] op_sel_hi:[1,1,1]
    v_pk_fma_f32 v[138:139], v[198:199], v[166:167], v[138:139] op_sel:[0,1,0] op_sel_hi:[1,1,1]
    v_pk_fma_f32 v[152:153], v[200:201], v[166:167], v[152:153] op_sel:[0,1,0] op_sel_hi:[1,1,1]
    v_pk_fma_f32 v[154:155], v[202:203], v[166:167], v[154:155] op_sel:[0,1,0] op_sel_hi:[1,1,1]
    v_pk_fma_f32 v[136:137], v[136:137], v[166:167], v[204:205] op_sel:[0,0,0] op_sel_hi:[1,0,1]
    v_pk_fma_f32 v[138:139], v[138:139], v[166:167], v[206:207] op_sel:[0,0,0] op_sel_hi:[1,0,1]
    v_pk_fma_f32 v[152:153], v[152:153], v[166:167], v[208:209] op_sel:[0,0,0] op_sel_hi:[1,0,1]
    v_pk_fma_f32 v[154:155], v[154:155], v[166:167], v[210:211] op_sel:[0,0,0] op_sel_hi:[1,0,1]
    buffer_load_dwordx4 v246, s[32:35], s91 offen offset:1024 lds
    v_add_u32 v247, 128, v245
    v_bfi_b32 v245, s40, v247, v245
    v_bfi_b32 v246, s40, v247, v246
    v_pk_mul_f32 v[216:217], v[136:137], v[136:137]
    v_pk_mul_f32 v[218:219], v[138:139], v[138:139]
    v_pk_mul_f32 v[220:221], v[152:153], v[152:153]
    v_pk_mul_f32 v[222:223], v[154:155], v[154:155]
    v_pk_fma_f32 v[216:217], v[216:217], s[66:67], s[66:67] op_sel:[0,0,1] op_sel_hi:[1,0,1]
    v_pk_fma_f32 v[218:219], v[218:219], s[66:67], s[66:67] op_sel:[0,0,1] op_sel_hi:[1,0,1]
    v_pk_fma_f32 v[220:221], v[220:221], s[66:67], s[66:67] op_sel:[0,0,1] op_sel_hi:[1,0,1]
    v_pk_fma_f32 v[222:223], v[222:223], s[66:67], s[66:67] op_sel:[0,0,1] op_sel_hi:[1,0,1]
    s_add_u32 m0, s41, 0
    s_waitcnt vmcnt(11) lgkmcnt(0)
    buffer_load_dwordx4 v245, s[32:35], s88 offen offset:0 lds
    ds_read_b128 a[176:179], v10 offset:2048
    ds_read_b128 a[180:183], v11 offset:2048
    v_pk_mul_f32 v[216:217], v[216:217], v[136:137]
    v_pk_mul_f32 v[218:219], v[218:219], v[138:139]
    v_pk_mul_f32 v[220:221], v[220:221], v[152:153]
    v_pk_mul_f32 v[222:223], v[222:223], v[154:155]
    v_exp_f32 v216, v216
    v_exp_f32 v217, v217
    v_exp_f32 v218, v218
    v_exp_f32 v219, v219
    buffer_load_dwordx4 v246, s[32:35], s88 offen offset:1024 lds
    v_exp_f32 v220, v220
    v_exp_f32 v221, v221
    v_exp_f32 v222, v222
    v_exp_f32 v223, v223
    v_pk_add_f32 v[216:217], v[216:217], s[68:69]
    v_pk_add_f32 v[218:219], v[218:219], s[68:69]
    v_pk_add_f32 v[220:221], v[220:221], s[68:69]
    v_pk_add_f32 v[222:223], v[222:223], s[68:69]
    s_add_u32 m0, s41, 2048
    s_waitcnt vmcnt(11) lgkmcnt(0)
    buffer_load_dwordx4 v245, s[32:35], s89 offen offset:0 lds
    ds_read_b128 a[184:187], v10 offset:4096
    ds_read_b128 a[188:191], v11 offset:4096
    v_rcp_f32 v216, v216
    v_rcp_f32 v217, v217
    v_rcp_f32 v218, v218
    v_rcp_f32 v219, v219
    v_rcp_f32 v220, v220
    v_rcp_f32 v221, v221
    v_rcp_f32 v222, v222
    v_rcp_f32 v223, v223
    buffer_load_dwordx4 v246, s[32:35], s89 offen offset:1024 lds
    v_pk_mul_f32 v[136:137], v[136:137], v[216:217]
    v_pk_mul_f32 v[138:139], v[138:139], v[218:219]
    v_pk_mul_f32 v[152:153], v[152:153], v[220:221]
    v_pk_mul_f32 v[154:155], v[154:155], v[222:223]
    v_cvt_pk_bf16_f32 v184, v136, v152
    v_cvt_pk_bf16_f32 v185, v137, v153
    v_cvt_pk_bf16_f32 v186, v138, v154
    v_cvt_pk_bf16_f32 v187, v139, v155
    s_add_u32 m0, s41, 4096
    s_waitcnt vmcnt(10) lgkmcnt(0)
    buffer_load_dwordx4 v245, s[32:35], s90 offen offset:0 lds
    ds_read_b128 a[192:195], v10 offset:6144
    ds_read_b128 a[196:199], v11 offset:6144
    ds_write_b128 v3, v[184:187] offset:4096
    buffer_load_dword v27, v26, s[4:7], s60 offen sc1
    v_pk_fma_f32 v[140:141], v[196:197], v[168:169], v[140:141] op_sel:[0,1,0] op_sel_hi:[1,1,1]
    v_pk_fma_f32 v[142:143], v[198:199], v[168:169], v[142:143] op_sel:[0,1,0] op_sel_hi:[1,1,1]
    v_pk_fma_f32 v[156:157], v[200:201], v[168:169], v[156:157] op_sel:[0,1,0] op_sel_hi:[1,1,1]
    v_pk_fma_f32 v[158:159], v[202:203], v[168:169], v[158:159] op_sel:[0,1,0] op_sel_hi:[1,1,1]
    v_pk_fma_f32 v[140:141], v[140:141], v[168:169], v[204:205] op_sel:[0,0,0] op_sel_hi:[1,0,1]
    v_pk_fma_f32 v[142:143], v[142:143], v[168:169], v[206:207] op_sel:[0,0,0] op_sel_hi:[1,0,1]
    buffer_load_dwordx4 v246, s[32:35], s90 offen offset:1024 lds
    v_pk_fma_f32 v[156:157], v[156:157], v[168:169], v[208:209] op_sel:[0,0,0] op_sel_hi:[1,0,1]
    v_pk_fma_f32 v[158:159], v[158:159], v[168:169], v[210:211] op_sel:[0,0,0] op_sel_hi:[1,0,1]
    v_pk_mul_f32 v[216:217], v[140:141], v[140:141]
    v_pk_mul_f32 v[218:219], v[142:143], v[142:143]
    v_pk_mul_f32 v[220:221], v[156:157], v[156:157]
    v_pk_mul_f32 v[222:223], v[158:159], v[158:159]
    v_pk_fma_f32 v[216:217], v[216:217], s[66:67], s[66:67] op_sel:[0,0,1] op_sel_hi:[1,0,1]
    v_pk_fma_f32 v[218:219], v[218:219], s[66:67], s[66:67] op_sel:[0,0,1] op_sel_hi:[1,0,1]
    s_add_u32 m0, s41, 6144
    s_waitcnt vmcnt(11) lgkmcnt(1)
    buffer_load_dwordx4 v245, s[32:35], s91 offen offset:0 lds
    ds_read_b128 a[200:203], v10 offset:8192
    ds_read_b128 a[204:207], v11 offset:8192
    v_pk_fma_f32 v[220:221], v[220:221], s[66:67], s[66:67] op_sel:[0,0,1] op_sel_hi:[1,0,1]
    v_pk_fma_f32 v[222:223], v[222:223], s[66:67], s[66:67] op_sel:[0,0,1] op_sel_hi:[1,0,1]
    v_pk_mul_f32 v[216:217], v[216:217], v[140:141]
    v_pk_mul_f32 v[218:219], v[218:219], v[142:143]
    v_pk_mul_f32 v[220:221], v[220:221], v[156:157]
    v_pk_mul_f32 v[222:223], v[222:223], v[158:159]
    v_exp_f32 v216, v216
    v_exp_f32 v217, v217
    buffer_load_dwordx4 v246, s[32:35], s91 offen offset:1024 lds
    v_exp_f32 v218, v218
    v_exp_f32 v219, v219
    v_exp_f32 v220, v220
    v_exp_f32 v221, v221
    v_exp_f32 v222, v222
    v_exp_f32 v223, v223
    v_pk_add_f32 v[216:217], v[216:217], s[68:69]
    v_pk_add_f32 v[218:219], v[218:219], s[68:69]
    s_waitcnt vmcnt(11) lgkmcnt(2)
    ds_read_b128 a[208:211], v10 offset:10240
    ds_read_b128 a[212:215], v11 offset:10240
    v_pk_add_f32 v[220:221], v[220:221], s[68:69]
    v_pk_add_f32 v[222:223], v[222:223], s[68:69]
    v_rcp_f32 v216, v216
    v_rcp_f32 v217, v217
    v_rcp_f32 v218, v218
    v_rcp_f32 v219, v219
    v_rcp_f32 v220, v220
    v_rcp_f32 v221, v221
    s_waitcnt vmcnt(9) lgkmcnt(2)
    ds_read_b128 a[216:219], v10 offset:12288
    ds_read_b128 a[220:223], v11 offset:12288
    v_rcp_f32 v222, v222
    v_rcp_f32 v223, v223
    v_pk_mul_f32 v[140:141], v[140:141], v[216:217]
    v_pk_mul_f32 v[142:143], v[142:143], v[218:219]
    v_pk_mul_f32 v[156:157], v[156:157], v[220:221]
    v_pk_mul_f32 v[158:159], v[158:159], v[222:223]
    v_cvt_pk_bf16_f32 v188, v140, v156
    v_cvt_pk_bf16_f32 v189, v141, v157
    s_waitcnt vmcnt(7)
    ds_read_b128 a[224:227], v10 offset:0
    ds_read_b128 a[228:231], v11 offset:0
    v_cvt_pk_bf16_f32 v190, v142, v158
    v_cvt_pk_bf16_f32 v191, v143, v159
    ds_write_b128 v3, v[188:191] offset:8192
    v_pk_fma_f32 v[144:145], v[196:197], v[170:171], v[144:145] op_sel:[0,1,0] op_sel_hi:[1,1,1]
    v_pk_fma_f32 v[146:147], v[198:199], v[170:171], v[146:147] op_sel:[0,1,0] op_sel_hi:[1,1,1]
    v_pk_fma_f32 v[160:161], v[200:201], v[170:171], v[160:161] op_sel:[0,1,0] op_sel_hi:[1,1,1]
    v_pk_fma_f32 v[162:163], v[202:203], v[170:171], v[162:163] op_sel:[0,1,0] op_sel_hi:[1,1,1]
    v_pk_fma_f32 v[144:145], v[144:145], v[170:171], v[204:205] op_sel:[0,0,0] op_sel_hi:[1,0,1]
    s_mov_b32 s49, 65536
    s_waitcnt vmcnt(3)
    v_cmp_ne_u32 vcc, s48, v27
    s_nop 0
    s_cbranch_vccz L_adaL_got_31_w3
L_adaL_poll_30_w3:
    buffer_load_dword v27, v26, s[4:7], s60 offen sc1
    s_waitcnt vmcnt(0)
    s_sub_u32 s49, s49, 1
    s_cbranch_scc1 L_adaL_got_31_w3
    v_cmp_ne_u32 vcc, s48, v27
    s_nop 0
    s_cbranch_vccnz L_adaL_poll_30_w3
L_adaL_got_31_w3:
    buffer_load_dwordx4 v[44:47], v9, s[4:7], s20 offen offset:0 sc1
    ds_read_b128 a[232:235], v10 offset:2048
    ds_read_b128 a[236:239], v11 offset:2048
    v_pk_fma_f32 v[146:147], v[146:147], v[170:171], v[206:207] op_sel:[0,0,0] op_sel_hi:[1,0,1]
    v_pk_fma_f32 v[160:161], v[160:161], v[170:171], v[208:209] op_sel:[0,0,0] op_sel_hi:[1,0,1]
    v_pk_fma_f32 v[162:163], v[162:163], v[170:171], v[210:211] op_sel:[0,0,0] op_sel_hi:[1,0,1]
    v_pk_mul_f32 v[216:217], v[144:145], v[144:145]
    v_pk_mul_f32 v[218:219], v[146:147], v[146:147]
    v_pk_mul_f32 v[220:221], v[160:161], v[160:161]
    v_pk_mul_f32 v[222:223], v[162:163], v[162:163]
    v_pk_fma_f32 v[216:217], v[216:217], s[66:67], s[66:67] op_sel:[0,0,1] op_sel_hi:[1,0,1]
    buffer_load_dwordx4 v[48:51], v9, s[4:7], s20 offen offset:1024 sc1
    s_waitcnt vmcnt(4) lgkmcnt(5)
    ds_read_b128 a[240:243], v10 offset:4096
    ds_read_b128 a[244:247], v11 offset:4096
    v_pk_fma_f32 v[218:219], v[218:219], s[66:67], s[66:67] op_sel:[0,0,1] op_sel_hi:[1,0,1]
    v_pk_fma_f32 v[220:221], v[220:221], s[66:67], s[66:67] op_sel:[0,0,1] op_sel_hi:[1,0,1]
    v_pk_fma_f32 v[222:223], v[222:223], s[66:67], s[66:67] op_sel:[0,0,1] op_sel_hi:[1,0,1]
    v_pk_mul_f32 v[216:217], v[216:217], v[144:145]
    v_pk_mul_f32 v[218:219], v[218:219], v[146:147]
    v_pk_mul_f32 v[220:221], v[220:221], v[160:161]
    v_pk_mul_f32 v[222:223], v[222:223], v[162:163]
    v_exp_f32 v216, v216
    buffer_load_dwordx4 v[52:55], v9, s[4:7], s21 offen offset:0 sc1
    s_waitcnt vmcnt(3) lgkmcnt(5)
    ds_read_b128 a[248:251], v10 offset:6144
    ds_read_b128 a[252:255], v11 offset:6144
    v_exp_f32 v217, v217
    v_exp_f32 v218, v218
    v_exp_f32 v219, v219
    v_exp_f32 v220, v220
    v_exp_f32 v221, v221
    v_exp_f32 v222, v222
    v_exp_f32 v223, v223
    v_pk_add_f32 v[216:217], v[216:217], s[68:69]
    buffer_load_dwordx4 v[56:59], v9, s[4:7], s21 offen offset:1024 sc1
    v_pk_add_f32 v[218:219], v[218:219], s[68:69]
    v_pk_add_f32 v[220:221], v[220:221], s[68:69]
    v_pk_add_f32 v[222:223], v[222:223], s[68:69]
    v_rcp_f32 v216, v216
    v_rcp_f32 v217, v217
    v_rcp_f32 v218, v218
    v_rcp_f32 v219, v219
    v_rcp_f32 v220, v220
    buffer_load_dwordx4 v[60:63], v9, s[4:7], s22 offen offset:0 sc1
    v_rcp_f32 v221, v221
    v_rcp_f32 v222, v222
    v_rcp_f32_e64 v223, v223
    v_pk_mul_f32 v[144:145], v[144:145], v[216:217]
    v_pk_mul_f32 v[146:147], v[146:147], v[218:219]
    v_pk_mul_f32 v[160:161], v[160:161], v[220:221]
    v_pk_mul_f32 v[162:163], v[162:163], v[222:223]
    v_cvt_pk_bf16_f32 v192, v144, v160
    buffer_load_dwordx4 v[64:67], v9, s[4:7], s22 offen offset:1024 sc1
    v_cvt_pk_bf16_f32 v193, v145, v161
    v_cvt_pk_bf16_f32 v194, v146, v162
    v_cvt_pk_bf16_f32 v195, v147, v163
    ds_write_b128 v3, v[192:195] offset:12288
    buffer_load_dwordx4 v[68:71], v9, s[4:7], s23 offen offset:0 sc1
    buffer_load_dwordx4 v[72:75], v9, s[4:7], s23 offen offset:1024 sc1
    buffer_load_dwordx4 v[76:79], v9, s[4:7], s24 offen offset:0 sc1
    buffer_load_dwordx4 v[80:83], v9, s[4:7], s24 offen offset:1024 sc1
    buffer_load_dwordx4 v[84:87], v9, s[4:7], s25 offen offset:0 sc1
    buffer_load_dwordx4 v[88:91], v9, s[4:7], s25 offen offset:1024 sc1
    buffer_load_dwordx4 v[92:95], v9, s[4:7], s26 offen offset:0 sc1
    buffer_load_dwordx4 v[96:99], v9, s[4:7], s26 offen offset:1024 sc1
    buffer_load_dwordx4 v[100:103], v9, s[4:7], s27 offen offset:0 sc1
    buffer_load_dwordx4 v[104:107], v9, s[4:7], s27 offen offset:1024 sc1
    v_add_u32 v9, 65536, v9
    s_branch L_adaL_w3back_33
L_adaL_slow_19_w3:
    s_mov_b32 s49, 65536
L_adaL_poll_20_w3:
    s_add_u32 s63, s59, 0
    buffer_load_dwordx4 v[100:103], v180, s[4:7], s63 offen sc1
    s_add_u32 s63, s59, 32768
    buffer_load_dwordx4 v[104:107], v180, s[4:7], s63 offen sc1
    s_add_u32 s63, s59, 65536
    buffer_load_dwordx4 v[108:111], v180, s[4:7], s63 offen sc1
    s_add_u32 s63, s59, 98304
    buffer_load_dwordx4 v[112:115], v180, s[4:7], s63 offen sc1
    s_add_u32 s63, s59, 131072
    buffer_load_dwordx4 v[116:119], v180, s[4:7], s63 offen sc1
    buffer_load_dwordx2 v[164:165], v166, s[4:7], 0 offen sc1
    s_waitcnt vmcnt(0)
    s_sub_u32 s49, s49, 1
    s_cbranch_scc1 L_adaL_got_21_w3
    v_min3_u32 v181, v165, v13, v13
    v_min3_u32 v181, v181, v101, v103
    v_min3_u32 v181, v181, v105, v107
    v_min3_u32 v181, v181, v109, v111
    v_min3_u32 v181, v181, v113, v115
    v_min3_u32 v181, v181, v117, v119
    v_max3_u32 v182, v165, v13, v13
    v_max3_u32 v182, v182, v101, v103
    v_max3_u32 v182, v182, v105, v107
    v_max3_u32 v182, v182, v109, v111
    v_max3_u32 v182, v182, v113, v115
    v_max3_u32 v182, v182, v117, v119
    v_cmp_ne_u32 vcc, v181, v182
    s_nop 0
    s_cbranch_vccnz L_adaL_poll_20_w3
    s_branch L_adaL_got_21_w3
L_adaL_slow_26_w3:
    s_mov_b32 s49, 65536
L_adaL_poll_27_w3:
    buffer_load_dwordx4 v[164:167], v172, s[4:7], s55 offen offset:0 sc1
    buffer_load_dwordx4 v[168:171], v172, s[4:7], s55 offen offset:1024 sc1
    s_waitcnt vmcnt(0)
    s_sub_u32 s49, s49, 1
    s_cbranch_scc1 L_adaL_got_28_w3
    v_min3_u32 v3, v165, v167, v13
    v_min3_u32 v3, v3, v169, v171
    v_max3_u32 v4, v165, v167, v13
    v_max3_u32 v4, v4, v169, v171
    v_cmp_ne_u32 vcc, v3, v4
    s_nop 0
    s_cbranch_vccnz L_adaL_poll_27_w3
    s_branch L_adaL_got_28_w3
L_adaL_aux_2:
    s_sub_u32 s42, s2, 160
    v_lshrrev_b32 v1, 6, v0
    s_nop 0
    v_readfirstlane_b32 s39, v1
    s_cmp_lg_u32 s2, 252
    s_cbranch_scc1 L_adaL_notag_44
    s_memrealtime s[50:51]
    s_waitcnt lgkmcnt(0)
    s_or_b32 s48, s50, 1
    v_mov_b32 v232, s48
    v_mov_b32 v233, s48
    v_cmp_eq_u32 vcc, 0, v0
    s_nop 0
    s_and_b64 exec, exec, vcc
    buffer_store_dwordx2 v[232:233], off, s[44:47], 0 sc1
    s_mov_b64 exec, -1
L_adaL_notag_44:
    s_getpc_b64 s[40:41]
L_adaL_pc_49:
    s_sub_u32 s40, s40, L_adaL_pc_49-adaLN_cond__ssm_conv_h3__mixer_gmlp__prompt_kernel
    s_subb_u32 s41, s41, 0
    s_lshr_b32 s8, s42, 3
    s_mul_i32 s8, s8, 5120
    v_min_u32 v1, 39, v0
    v_lshl_add_u32 v1, v1, 7, s8
    v_min_u32 v1, code_end-adaLN_cond__ssm_conv_h3__mixer_gmlp__prompt_kernel-4, v1
    global_load_dword v230, v1, s[40:41]
    s_lshr_b32 s8, s42, 3
    s_and_b32 s9, s42, 7
    s_lshr_b32 s10, s9, 2
    s_add_u32 s10, s10, 8
    s_and_b32 s11, s9, 3
    s_lshl_b32 s11, s11, 1
    s_add_u32 s11, s11, s8
    s_sub_u32 s11, s11, 8
    s_cmp_lt_u32 s8, 8
    s_cselect_b32 s9, s9, s10
    s_cselect_b32 s8, s8, s11
    s_lshr_b32 s10, s9, 1
    s_lshl_b32 s10, s10, 4
    s_and_b32 s9, s9, 1
    s_lshl_b32 s8, s8, 1
    s_add_u32 s8, s8, s9
    s_add_u32 s42, s8, s10
    s_load_dwordx2 s[20:21], s[0:1], 56
    s_mov_b32 s22, 2211840
    s_mov_b32 s23, 0x20000
    v_lshrrev_b32 v137, 6, v0
    s_nop 0
    v_readfirstlane_b32 s24, v137
    s_lshr_b32 s25, s42, 4
    s_and_b32 s26, s42, 15
    s_lshl_b32 s30, s25, 2
    s_add_u32 s30, s30, s24
    s_lshr_b32 s28, s26, 1
    s_mul_i32 s28, s28, 216
    s_and_b32 s29, s26, 1
    s_mul_i32 s29, s29, 1728
    s_add_u32 s28, s28, s29
    s_mul_i32 s29, s30, 110592
    s_add_u32 s28, s28, s29
    v_and_b32 v136, 63, v0
    v_lshlrev_b32 v138, 2, v136
    v_mov_b32 v137, 2147483648
    v_cmp_gt_u32 vcc, 54, v136
    s_nop 1
    v_cndmask_b32 v138, v137, v138, vcc
    s_cmp_ge_u32 s2, 220
    s_cbranch_scc1 L_adaL_stats_43
    s_load_dwordx2 s[8:9], s[0:1], 96
    s_mov_b32 s10, 4915200
    s_mov_b32 s11, 0x20000
    s_load_dwordx2 s[12:13], s[0:1], 88
    s_mov_b32 s14, 1280
    s_mov_b32 s15, 0x20000
    s_sub_u32 s16, s2, 160
    v_and_b32 v1, 7, v0
    v_lshrrev_b32_e64 v2, 3, v0
    v_mul_u32_u24 v4, 40, v2
    v_mul_u32_u24 v3, 153600, v2
    v_lshl_add_u32 v3, v1, 4, v3
    s_lshl_b32 s17, s16, 7
    s_waitcnt lgkmcnt(0)
    buffer_load_dwordx4 v[6:9], v4, s[12:15], 0 offen
    buffer_load_dwordx4 v[10:13], v4, s[12:15], 0 offen offset:16
    buffer_load_dwordx2 v[14:15], v4, s[12:15], 0 offen offset:32
    buffer_load_dwordx4 v[16:19], v3, s[8:11], s17 offen nt
    s_add_u32 s17, s17, 7680
    buffer_load_dwordx4 v[20:23], v3, s[8:11], s17 offen nt
    s_add_u32 s17, s17, 7680
    buffer_load_dwordx4 v[24:27], v3, s[8:11], s17 offen nt
    s_add_u32 s17, s17, 7680
    buffer_load_dwordx4 v[28:31], v3, s[8:11], s17 offen nt
    s_add_u32 s17, s17, 7680
    buffer_load_dwordx4 v[32:35], v3, s[8:11], s17 offen nt
    s_add_u32 s17, s17, 7680
    buffer_load_dwordx4 v[36:39], v3, s[8:11], s17 offen nt
    s_add_u32 s17, s17, 7680
    buffer_load_dwordx4 v[40:43], v3, s[8:11], s17 offen nt
    s_add_u32 s17, s17, 7680
    buffer_load_dwordx4 v[44:47], v3, s[8:11], s17 offen nt
    s_add_u32 s17, s17, 7680
    buffer_load_dwordx4 v[48:51], v3, s[8:11], s17 offen nt
    s_add_u32 s17, s17, 7680
    buffer_load_dwordx4 v[52:55], v3, s[8:11], s17 offen nt
    s_add_u32 s17, s17, 7680
    buffer_load_dwordx4 v[56:59], v3, s[8:11], s17 offen nt
    s_add_u32 s17, s17, 7680
    buffer_load_dwordx4 v[60:63], v3, s[8:11], s17 offen nt
    s_add_u32 s17, s17, 7680
    buffer_load_dwordx4 v[64:67], v3, s[8:11], s17 offen nt
    s_add_u32 s17, s17, 7680
    buffer_load_dwordx4 v[68:71], v3, s[8:11], s17 offen nt
    s_add_u32 s17, s17, 7680
    buffer_load_dwordx4 v[72:75], v3, s[8:11], s17 offen nt
    s_add_u32 s17, s17, 7680
    buffer_load_dwordx4 v[76:79], v3, s[8:11], s17 offen nt
    s_add_u32 s17, s17, 7680
    buffer_load_dwordx4 v[80:83], v3, s[8:11], s17 offen nt
    s_add_u32 s17, s17, 7680
    buffer_load_dwordx4 v[84:87], v3, s[8:11], s17 offen nt
    s_add_u32 s17, s17, 7680
    buffer_load_dwordx4 v[88:91], v3, s[8:11], s17 offen nt
    s_add_u32 s17, s17, 7680
    buffer_load_dwordx4 v[92:95], v3, s[8:11], s17 offen nt
    s_mov_b32 s18, 0xbfb8aa3b
    s_waitcnt vmcnt(22)
    v_lshlrev_b32 v124, 16, v6
    v_and_b32 v125, s3, v6
    v_mul_f32 v126, s18, v124
    v_mul_f32 v127, s18, v125
    v_exp_f32 v126, v126
    v_exp_f32 v127, v127
    v_add_f32 v126, 1.0, v126
    v_add_f32 v127, 1.0, v127
    v_rcp_f32 v126, v126
    v_rcp_f32 v127, v127
    v_mul_f32 v124, v124, v126
    v_mul_f32 v125, v125, v127
    v_cvt_pk_bf16_f32 v124, v124, v125
    v_lshlrev_b32 v96, 16, v124
    v_and_b32 v97, s3, v124
    v_lshlrev_b32 v124, 16, v7
    v_and_b32 v125, s3, v7
    v_mul_f32 v126, s18, v124
    v_mul_f32 v127, s18, v125
    v_exp_f32 v126, v126
    v_exp_f32 v127, v127
    v_add_f32 v126, 1.0, v126
    v_add_f32 v127, 1.0, v127
    v_rcp_f32 v126, v126
    v_rcp_f32 v127, v127
    v_mul_f32 v124, v124, v126
    v_mul_f32 v125, v125, v127
    v_cvt_pk_bf16_f32 v124, v124, v125
    v_lshlrev_b32 v98, 16, v124
    v_and_b32 v99, s3, v124
    v_lshlrev_b32 v124, 16, v8
    v_and_b32 v125, s3, v8
    v_mul_f32 v126, s18, v124
    v_mul_f32 v127, s18, v125
    v_exp_f32 v126, v126
    v_exp_f32 v127, v127
    v_add_f32 v126, 1.0, v126
    v_add_f32 v127, 1.0, v127
    v_rcp_f32 v126, v126
    v_rcp_f32 v127, v127
    v_mul_f32 v124, v124, v126
    v_mul_f32 v125, v125, v127
    v_cvt_pk_bf16_f32 v124, v124, v125
    v_lshlrev_b32 v100, 16, v124
    v_and_b32 v101, s3, v124
    v_lshlrev_b32 v124, 16, v9
    v_and_b32 v125, s3, v9
    v_mul_f32 v126, s18, v124
    v_mul_f32 v127, s18, v125
    v_exp_f32 v126, v126
    v_exp_f32 v127, v127
    v_add_f32 v126, 1.0, v126
    v_add_f32 v127, 1.0, v127
    v_rcp_f32 v126, v126
    v_rcp_f32 v127, v127
    v_mul_f32 v124, v124, v126
    v_mul_f32 v125, v125, v127
    v_cvt_pk_bf16_f32 v124, v124, v125
    v_lshlrev_b32 v102, 16, v124
    v_and_b32 v103, s3, v124
    s_waitcnt vmcnt(21)
    v_lshlrev_b32 v124, 16, v10
    v_and_b32 v125, s3, v10
    v_mul_f32 v126, s18, v124
    v_mul_f32 v127, s18, v125
    v_exp_f32 v126, v126
    v_exp_f32 v127, v127
    v_add_f32 v126, 1.0, v126
    v_add_f32 v127, 1.0, v127
    v_rcp_f32 v126, v126
    v_rcp_f32 v127, v127
    v_mul_f32 v124, v124, v126
    v_mul_f32 v125, v125, v127
    v_cvt_pk_bf16_f32 v124, v124, v125
    v_lshlrev_b32 v104, 16, v124
    v_and_b32 v105, s3, v124
    v_lshlrev_b32 v124, 16, v11
    v_and_b32 v125, s3, v11
    v_mul_f32 v126, s18, v124
    v_mul_f32 v127, s18, v125
    v_exp_f32 v126, v126
    v_exp_f32 v127, v127
    v_add_f32 v126, 1.0, v126
    v_add_f32 v127, 1.0, v127
    v_rcp_f32 v126, v126
    v_rcp_f32 v127, v127
    v_mul_f32 v124, v124, v126
    v_mul_f32 v125, v125, v127
    v_cvt_pk_bf16_f32 v124, v124, v125
    v_lshlrev_b32 v106, 16, v124
    v_and_b32 v107, s3, v124
    v_lshlrev_b32 v124, 16, v12
    v_and_b32 v125, s3, v12
    v_mul_f32 v126, s18, v124
    v_mul_f32 v127, s18, v125
    v_exp_f32 v126, v126
    v_exp_f32 v127, v127
    v_add_f32 v126, 1.0, v126
    v_add_f32 v127, 1.0, v127
    v_rcp_f32 v126, v126
    v_rcp_f32 v127, v127
    v_mul_f32 v124, v124, v126
    v_mul_f32 v125, v125, v127
    v_cvt_pk_bf16_f32 v124, v124, v125
    v_lshlrev_b32 v108, 16, v124
    v_and_b32 v109, s3, v124
    v_lshlrev_b32 v124, 16, v13
    v_and_b32 v125, s3, v13
    v_mul_f32 v126, s18, v124
    v_mul_f32 v127, s18, v125
    v_exp_f32 v126, v126
    v_exp_f32 v127, v127
    v_add_f32 v126, 1.0, v126
    v_add_f32 v127, 1.0, v127
    v_rcp_f32 v126, v126
    v_rcp_f32 v127, v127
    v_mul_f32 v124, v124, v126
    v_mul_f32 v125, v125, v127
    v_cvt_pk_bf16_f32 v124, v124, v125
    v_lshlrev_b32 v110, 16, v124
    v_and_b32 v111, s3, v124
    s_waitcnt vmcnt(20)
    v_lshlrev_b32 v124, 16, v14
    v_and_b32 v125, s3, v14
    v_mul_f32 v126, s18, v124
    v_mul_f32 v127, s18, v125
    v_exp_f32 v126, v126
    v_exp_f32 v127, v127
    v_add_f32 v126, 1.0, v126
    v_add_f32 v127, 1.0, v127
    v_rcp_f32 v126, v126
    v_rcp_f32 v127, v127
    v_mul_f32 v124, v124, v126
    v_mul_f32 v125, v125, v127
    v_cvt_pk_bf16_f32 v124, v124, v125
    v_lshlrev_b32 v112, 16, v124
    v_and_b32 v113, s3, v124
    v_lshlrev_b32 v124, 16, v15
    v_and_b32 v125, s3, v15
    v_mul_f32 v126, s18, v124
    v_mul_f32 v127, s18, v125
    v_exp_f32 v126, v126
    v_exp_f32 v127, v127
    v_add_f32 v126, 1.0, v126
    v_add_f32 v127, 1.0, v127
    v_rcp_f32 v126, v126
    v_rcp_f32 v127, v127
    v_mul_f32 v124, v124, v126
    v_mul_f32 v125, v125, v127
    v_cvt_pk_bf16_f32 v124, v124, v125
    v_lshlrev_b32 v114, 16, v124
    v_and_b32 v115, s3, v124
    buffer_load_dwordx2 v[232:233], off, s[44:47], 0 sc1
    s_waitcnt vmcnt(20)
    v_lshlrev_b32 v124, 16, v16
    v_and_b32 v125, s3, v16
    v_lshlrev_b32 v126, 16, v17
    v_and_b32 v127, s3, v17
    v_lshlrev_b32 v128, 16, v18
    v_and_b32 v129, s3, v18
    v_lshlrev_b32 v130, 16, v19
    v_and_b32 v131, s3, v19
    v_pk_mul_f32 v[116:117], v[124:125], v[96:97] op_sel:[0,0] op_sel_hi:[1,0]
    v_pk_mul_f32 v[118:119], v[126:127], v[96:97] op_sel:[0,0] op_sel_hi:[1,0]
    v_pk_mul_f32 v[120:121], v[128:129], v[96:97] op_sel:[0,0] op_sel_hi:[1,0]
    v_pk_mul_f32 v[122:123], v[130:131], v[96:97] op_sel:[0,0] op_sel_hi:[1,0]
    buffer_load_dword v142, v138, s[20:23], s28 offen offset:0
    buffer_load_dword v143, v138, s[20:23], s28 offen offset:3456
    s_add_u32 s28, s28, 6912
    s_waitcnt vmcnt(21)
    v_lshlrev_b32 v124, 16, v20
    v_and_b32 v125, s3, v20
    v_lshlrev_b32 v126, 16, v21
    v_and_b32 v127, s3, v21
    v_lshlrev_b32 v128, 16, v22
    v_and_b32 v129, s3, v22
    v_lshlrev_b32 v130, 16, v23
    v_and_b32_e64 v131, s3, v23
    v_pk_fma_f32 v[116:117], v[124:125], v[96:97], v[116:117] op_sel:[0,1,0] op_sel_hi:[1,1,1]
    v_pk_fma_f32 v[118:119], v[126:127], v[96:97], v[118:119] op_sel:[0,1,0] op_sel_hi:[1,1,1]
    v_pk_fma_f32 v[120:121], v[128:129], v[96:97], v[120:121] op_sel:[0,1,0] op_sel_hi:[1,1,1]
    v_pk_fma_f32 v[122:123], v[130:131], v[96:97], v[122:123] op_sel:[0,1,0] op_sel_hi:[1,1,1]
    buffer_load_dword v144, v138, s[20:23], s28 offen offset:0
    buffer_load_dword v145, v138, s[20:23], s28 offen offset:3456
    s_add_u32 s28, s28, 6912
    s_waitcnt vmcnt(22)
    v_lshlrev_b32 v124, 16, v24
    v_and_b32 v125, s3, v24
    v_lshlrev_b32 v126, 16, v25
    v_and_b32 v127, s3, v25
    v_lshlrev_b32 v128, 16, v26
    v_and_b32 v129, s3, v26
    v_lshlrev_b32 v130, 16, v27
    v_and_b32_e64 v131, s3, v27
    v_pk_fma_f32 v[116:117], v[124:125], v[98:99], v[116:117] op_sel:[0,0,0] op_sel_hi:[1,0,1]
    v_pk_fma_f32 v[118:119], v[126:127], v[98:99], v[118:119] op_sel:[0,0,0] op_sel_hi:[1,0,1]
    v_pk_fma_f32 v[120:121], v[128:129], v[98:99], v[120:121] op_sel:[0,0,0] op_sel_hi:[1,0,1]
    v_pk_fma_f32 v[122:123], v[130:131], v[98:99], v[122:123] op_sel:[0,0,0] op_sel_hi:[1,0,1]
    buffer_load_dword v146, v138, s[20:23], s28 offen offset:0
    buffer_load_dword v147, v138, s[20:23], s28 offen offset:3456
    s_add_u32 s28, s28, 6912
    s_waitcnt vmcnt(23)
    v_lshlrev_b32 v124, 16, v28
    v_and_b32 v125, s3, v28
    v_lshlrev_b32 v126, 16, v29
    v_and_b32 v127, s3, v29
    v_lshlrev_b32 v128, 16, v30
    v_and_b32 v129, s3, v30
    v_lshlrev_b32 v130, 16, v31
    v_and_b32_e64 v131, s3, v31
    v_pk_fma_f32 v[116:117], v[124:125], v[98:99], v[116:117] op_sel:[0,1,0] op_sel_hi:[1,1,1]
    v_pk_fma_f32 v[118:119], v[126:127], v[98:99], v[118:119] op_sel:[0,1,0] op_sel_hi:[1,1,1]
    v_pk_fma_f32 v[120:121], v[128:129], v[98:99], v[120:121] op_sel:[0,1,0] op_sel_hi:[1,1,1]
    v_pk_fma_f32 v[122:123], v[130:131], v[98:99], v[122:123] op_sel:[0,1,0] op_sel_hi:[1,1,1]
    buffer_load_dword v148, v138, s[20:23], s28 offen offset:0
    buffer_load_dword v149, v138, s[20:23], s28 offen offset:3456
    s_add_u32 s28, s28, 6912
    s_waitcnt vmcnt(24)
    v_lshlrev_b32 v124, 16, v32
    v_and_b32 v125, s3, v32
    v_lshlrev_b32 v126, 16, v33
    v_and_b32 v127, s3, v33
    v_lshlrev_b32 v128, 16, v34
    v_and_b32 v129, s3, v34
    v_lshlrev_b32 v130, 16, v35
    v_and_b32_e64 v131, s3, v35
    v_pk_fma_f32 v[116:117], v[124:125], v[100:101], v[116:117] op_sel:[0,0,0] op_sel_hi:[1,0,1]
    v_pk_fma_f32 v[118:119], v[126:127], v[100:101], v[118:119] op_sel:[0,0,0] op_sel_hi:[1,0,1]
    v_pk_fma_f32 v[120:121], v[128:129], v[100:101], v[120:121] op_sel:[0,0,0] op_sel_hi:[1,0,1]
    v_pk_fma_f32 v[122:123], v[130:131], v[100:101], v[122:123] op_sel:[0,0,0] op_sel_hi:[1,0,1]
    buffer_load_dword v150, v138, s[20:23], s28 offen offset:0
    buffer_load_dword v151, v138, s[20:23], s28 offen offset:3456
    s_add_u32 s28, s28, 6912
    s_waitcnt vmcnt(25)
    v_lshlrev_b32 v124, 16, v36
    v_and_b32 v125, s3, v36
    v_lshlrev_b32 v126, 16, v37
    v_and_b32 v127, s3, v37
    v_lshlrev_b32 v128, 16, v38
    v_and_b32 v129, s3, v38
    v_lshlrev_b32 v130, 16, v39
    v_and_b32_e64 v131, s3, v39
    v_pk_fma_f32 v[116:117], v[124:125], v[100:101], v[116:117] op_sel:[0,1,0] op_sel_hi:[1,1,1]
    v_pk_fma_f32 v[118:119], v[126:127], v[100:101], v[118:119] op_sel:[0,1,0] op_sel_hi:[1,1,1]
    v_pk_fma_f32 v[120:121], v[128:129], v[100:101], v[120:121] op_sel:[0,1,0] op_sel_hi:[1,1,1]
    v_pk_fma_f32 v[122:123], v[130:131], v[100:101], v[122:123] op_sel:[0,1,0] op_sel_hi:[1,1,1]
    buffer_load_dword v152, v138, s[20:23], s28 offen offset:0
    buffer_load_dword v153, v138, s[20:23], s28 offen offset:3456
    s_add_u32 s28, s28, 6912
    s_waitcnt vmcnt(26)
    v_lshlrev_b32 v124, 16, v40
    v_and_b32 v125, s3, v40
    v_lshlrev_b32 v126, 16, v41
    v_and_b32 v127, s3, v41
    v_lshlrev_b32 v128, 16, v42
    v_and_b32 v129, s3, v42
    v_lshlrev_b32 v130, 16, v43
    v_and_b32_e64 v131, s3, v43
    v_pk_fma_f32 v[116:117], v[124:125], v[102:103], v[116:117] op_sel:[0,0,0] op_sel_hi:[1,0,1]
    v_pk_fma_f32 v[118:119], v[126:127], v[102:103], v[118:119] op_sel:[0,0,0] op_sel_hi:[1,0,1]
    v_pk_fma_f32 v[120:121], v[128:129], v[102:103], v[120:121] op_sel:[0,0,0] op_sel_hi:[1,0,1]
    v_pk_fma_f32 v[122:123], v[130:131], v[102:103], v[122:123] op_sel:[0,0,0] op_sel_hi:[1,0,1]
    buffer_load_dword v154, v138, s[20:23], s28 offen offset:0
    buffer_load_dword v155, v138, s[20:23], s28 offen offset:3456
    s_add_u32 s28, s28, 6912
    s_waitcnt vmcnt(27)
    v_lshlrev_b32 v124, 16, v44
    v_and_b32 v125, s3, v44
    v_lshlrev_b32 v126, 16, v45
    v_and_b32 v127, s3, v45
    v_lshlrev_b32 v128, 16, v46
    v_and_b32 v129, s3, v46
    v_lshlrev_b32 v130, 16, v47
    v_and_b32_e64 v131, s3, v47
    v_pk_fma_f32 v[116:117], v[124:125], v[102:103], v[116:117] op_sel:[0,1,0] op_sel_hi:[1,1,1]
    v_pk_fma_f32 v[118:119], v[126:127], v[102:103], v[118:119] op_sel:[0,1,0] op_sel_hi:[1,1,1]
    v_pk_fma_f32 v[120:121], v[128:129], v[102:103], v[120:121] op_sel:[0,1,0] op_sel_hi:[1,1,1]
    v_pk_fma_f32 v[122:123], v[130:131], v[102:103], v[122:123] op_sel:[0,1,0] op_sel_hi:[1,1,1]
    buffer_load_dword v156, v138, s[20:23], s28 offen offset:0
    buffer_load_dword v157, v138, s[20:23], s28 offen offset:3456
    s_add_u32 s28, s28, 6912
    s_waitcnt vmcnt(28)
    v_lshlrev_b32 v124, 16, v48
    v_and_b32 v125, s3, v48
    v_lshlrev_b32 v126, 16, v49
    v_and_b32 v127, s3, v49
    v_lshlrev_b32 v128, 16, v50
    v_and_b32 v129, s3, v50
    v_lshlrev_b32 v130, 16, v51
    v_and_b32_e64 v131, s3, v51
    v_pk_fma_f32 v[116:117], v[124:125], v[104:105], v[116:117] op_sel:[0,0,0] op_sel_hi:[1,0,1]
    v_pk_fma_f32 v[118:119], v[126:127], v[104:105], v[118:119] op_sel:[0,0,0] op_sel_hi:[1,0,1]
    v_pk_fma_f32 v[120:121], v[128:129], v[104:105], v[120:121] op_sel:[0,0,0] op_sel_hi:[1,0,1]
    v_pk_fma_f32 v[122:123], v[130:131], v[104:105], v[122:123] op_sel:[0,0,0] op_sel_hi:[1,0,1]
    buffer_load_dword v158, v138, s[20:23], s28 offen offset:0
    buffer_load_dword v159, v138, s[20:23], s28 offen offset:3456
    s_add_u32 s28, s28, 6912
    s_waitcnt vmcnt(29)
    v_lshlrev_b32 v124, 16, v52
    v_and_b32 v125, s3, v52
    v_lshlrev_b32 v126, 16, v53
    v_and_b32 v127, s3, v53
    v_lshlrev_b32 v128, 16, v54
    v_and_b32 v129, s3, v54
    v_lshlrev_b32 v130, 16, v55
    v_and_b32_e64 v131, s3, v55
    v_pk_fma_f32 v[116:117], v[124:125], v[104:105], v[116:117] op_sel:[0,1,0] op_sel_hi:[1,1,1]
    v_pk_fma_f32 v[118:119], v[126:127], v[104:105], v[118:119] op_sel:[0,1,0] op_sel_hi:[1,1,1]
    v_pk_fma_f32 v[120:121], v[128:129], v[104:105], v[120:121] op_sel:[0,1,0] op_sel_hi:[1,1,1]
    v_pk_fma_f32 v[122:123], v[130:131], v[104:105], v[122:123] op_sel:[0,1,0] op_sel_hi:[1,1,1]
    buffer_load_dword v160, v138, s[20:23], s28 offen offset:0
    buffer_load_dword v161, v138, s[20:23], s28 offen offset:3456
    s_add_u32 s28, s28, 6912
    s_waitcnt vmcnt(30)
    v_lshlrev_b32 v124, 16, v56
    v_and_b32 v125, s3, v56
    v_lshlrev_b32 v126, 16, v57
    v_and_b32 v127, s3, v57
    v_lshlrev_b32 v128, 16, v58
    v_and_b32 v129, s3, v58
    v_lshlrev_b32 v130, 16, v59
    v_and_b32_e64 v131, s3, v59
    v_pk_fma_f32 v[116:117], v[124:125], v[106:107], v[116:117] op_sel:[0,0,0] op_sel_hi:[1,0,1]
    v_pk_fma_f32 v[118:119], v[126:127], v[106:107], v[118:119] op_sel:[0,0,0] op_sel_hi:[1,0,1]
    v_pk_fma_f32 v[120:121], v[128:129], v[106:107], v[120:121] op_sel:[0,0,0] op_sel_hi:[1,0,1]
    v_pk_fma_f32 v[122:123], v[130:131], v[106:107], v[122:123] op_sel:[0,0,0] op_sel_hi:[1,0,1]
    buffer_load_dword v162, v138, s[20:23], s28 offen offset:0
    buffer_load_dword v163, v138, s[20:23], s28 offen offset:3456
    s_add_u32 s28, s28, 6912
    s_waitcnt vmcnt(31)
    v_lshlrev_b32 v124, 16, v60
    v_and_b32 v125, s3, v60
    v_lshlrev_b32 v126, 16, v61
    v_and_b32 v127, s3, v61
    v_lshlrev_b32 v128, 16, v62
    v_and_b32 v129, s3, v62
    v_lshlrev_b32 v130, 16, v63
    v_and_b32_e64 v131, s3, v63
    v_pk_fma_f32 v[116:117], v[124:125], v[106:107], v[116:117] op_sel:[0,1,0] op_sel_hi:[1,1,1]
    v_pk_fma_f32 v[118:119], v[126:127], v[106:107], v[118:119] op_sel:[0,1,0] op_sel_hi:[1,1,1]
    v_pk_fma_f32 v[120:121], v[128:129], v[106:107], v[120:121] op_sel:[0,1,0] op_sel_hi:[1,1,1]
    v_pk_fma_f32 v[122:123], v[130:131], v[106:107], v[122:123] op_sel:[0,1,0] op_sel_hi:[1,1,1]
    buffer_load_dword v164, v138, s[20:23], s28 offen offset:0
    buffer_load_dword v165, v138, s[20:23], s28 offen offset:3456
    s_add_u32 s28, s28, 6912
    s_waitcnt vmcnt(32)
    v_lshlrev_b32 v124, 16, v64
    v_and_b32 v125, s3, v64
    v_lshlrev_b32 v126, 16, v65
    v_and_b32 v127, s3, v65
    v_lshlrev_b32 v128, 16, v66
    v_and_b32 v129, s3, v66
    v_lshlrev_b32 v130, 16, v67
    v_and_b32_e64 v131, s3, v67
    v_pk_fma_f32 v[116:117], v[124:125], v[108:109], v[116:117] op_sel:[0,0,0] op_sel_hi:[1,0,1]
    v_pk_fma_f32 v[118:119], v[126:127], v[108:109], v[118:119] op_sel:[0,0,0] op_sel_hi:[1,0,1]
    v_pk_fma_f32 v[120:121], v[128:129], v[108:109], v[120:121] op_sel:[0,0,0] op_sel_hi:[1,0,1]
    v_pk_fma_f32 v[122:123], v[130:131], v[108:109], v[122:123] op_sel:[0,0,0] op_sel_hi:[1,0,1]
    buffer_load_dword v166, v138, s[20:23], s28 offen offset:0
    buffer_load_dword v167, v138, s[20:23], s28 offen offset:3456
    s_add_u32 s28, s28, 6912
    s_waitcnt vmcnt(33)
    v_lshlrev_b32 v124, 16, v68
    v_and_b32 v125, s3, v68
    v_lshlrev_b32 v126, 16, v69
    v_and_b32 v127, s3, v69
    v_lshlrev_b32 v128, 16, v70
    v_and_b32 v129, s3, v70
    v_lshlrev_b32 v130, 16, v71
    v_and_b32_e64 v131, s3, v71
    v_pk_fma_f32 v[116:117], v[124:125], v[108:109], v[116:117] op_sel:[0,1,0] op_sel_hi:[1,1,1]
    v_pk_fma_f32 v[118:119], v[126:127], v[108:109], v[118:119] op_sel:[0,1,0] op_sel_hi:[1,1,1]
    v_pk_fma_f32 v[120:121], v[128:129], v[108:109], v[120:121] op_sel:[0,1,0] op_sel_hi:[1,1,1]
    v_pk_fma_f32 v[122:123], v[130:131], v[108:109], v[122:123] op_sel:[0,1,0] op_sel_hi:[1,1,1]
    buffer_load_dword v168, v138, s[20:23], s28 offen offset:0
    buffer_load_dword v169, v138, s[20:23], s28 offen offset:3456
    s_add_u32 s28, s28, 6912
    s_waitcnt vmcnt(34)
    v_lshlrev_b32 v124, 16, v72
    v_and_b32 v125, s3, v72
    v_lshlrev_b32 v126, 16, v73
    v_and_b32 v127, s3, v73
    v_lshlrev_b32 v128, 16, v74
    v_and_b32 v129, s3, v74
    v_lshlrev_b32 v130, 16, v75
    v_and_b32_e64 v131, s3, v75
    v_pk_fma_f32 v[116:117], v[124:125], v[110:111], v[116:117] op_sel:[0,0,0] op_sel_hi:[1,0,1]
    v_pk_fma_f32 v[118:119], v[126:127], v[110:111], v[118:119] op_sel:[0,0,0] op_sel_hi:[1,0,1]
    v_pk_fma_f32 v[120:121], v[128:129], v[110:111], v[120:121] op_sel:[0,0,0] op_sel_hi:[1,0,1]
    v_pk_fma_f32 v[122:123], v[130:131], v[110:111], v[122:123] op_sel:[0,0,0] op_sel_hi:[1,0,1]
    buffer_load_dword v170, v138, s[20:23], s28 offen offset:0
    buffer_load_dword v171, v138, s[20:23], s28 offen offset:3456
    s_add_u32 s28, s28, 6912
    s_waitcnt vmcnt(35)
    v_lshlrev_b32 v124, 16, v76
    v_and_b32 v125, s3, v76
    v_lshlrev_b32 v126, 16, v77
    v_and_b32 v127, s3, v77
    v_lshlrev_b32 v128, 16, v78
    v_and_b32 v129, s3, v78
    v_lshlrev_b32 v130, 16, v79
    v_and_b32_e64 v131, s3, v79
    v_pk_fma_f32 v[116:117], v[124:125], v[110:111], v[116:117] op_sel:[0,1,0] op_sel_hi:[1,1,1]
    v_pk_fma_f32 v[118:119], v[126:127], v[110:111], v[118:119] op_sel:[0,1,0] op_sel_hi:[1,1,1]
    v_pk_fma_f32 v[120:121], v[128:129], v[110:111], v[120:121] op_sel:[0,1,0] op_sel_hi:[1,1,1]
    v_pk_fma_f32 v[122:123], v[130:131], v[110:111], v[122:123] op_sel:[0,1,0] op_sel_hi:[1,1,1]
    buffer_load_dword v172, v138, s[20:23], s28 offen offset:0
    buffer_load_dword v173, v138, s[20:23], s28 offen offset:3456
    s_waitcnt vmcnt(36)
    v_lshlrev_b32 v124, 16, v80
    v_and_b32 v125, s3, v80
    v_lshlrev_b32 v126, 16, v81
    v_and_b32 v127, s3, v81
    v_lshlrev_b32 v128, 16, v82
    v_and_b32 v129, s3, v82
    v_lshlrev_b32 v130, 16, v83
    v_and_b32 v131, s3, v83
    v_pk_fma_f32 v[116:117], v[124:125], v[112:113], v[116:117] op_sel:[0,0,0] op_sel_hi:[1,0,1]
    v_pk_fma_f32 v[118:119], v[126:127], v[112:113], v[118:119] op_sel:[0,0,0] op_sel_hi:[1,0,1]
    v_pk_fma_f32 v[120:121], v[128:129], v[112:113], v[120:121] op_sel:[0,0,0] op_sel_hi:[1,0,1]
    v_pk_fma_f32 v[122:123], v[130:131], v[112:113], v[122:123] op_sel:[0,0,0] op_sel_hi:[1,0,1]
    s_waitcnt vmcnt(35)
    v_lshlrev_b32 v124, 16, v84
    v_and_b32 v125, s3, v84
    v_lshlrev_b32 v126, 16, v85
    v_and_b32 v127, s3, v85
    v_lshlrev_b32 v128, 16, v86
    v_and_b32 v129, s3, v86
    v_lshlrev_b32 v130, 16, v87
    v_and_b32 v131, s3, v87
    v_pk_fma_f32 v[116:117], v[124:125], v[112:113], v[116:117] op_sel:[0,1,0] op_sel_hi:[1,1,1]
    v_pk_fma_f32 v[118:119], v[126:127], v[112:113], v[118:119] op_sel:[0,1,0] op_sel_hi:[1,1,1]
    v_pk_fma_f32 v[120:121], v[128:129], v[112:113], v[120:121] op_sel:[0,1,0] op_sel_hi:[1,1,1]
    v_pk_fma_f32 v[122:123], v[130:131], v[112:113], v[122:123] op_sel:[0,1,0] op_sel_hi:[1,1,1]
    s_waitcnt vmcnt(34)
    v_lshlrev_b32 v124, 16, v88
    v_and_b32 v125, s3, v88
    v_lshlrev_b32 v126, 16, v89
    v_and_b32 v127, s3, v89
    v_lshlrev_b32 v128, 16, v90
    v_and_b32 v129, s3, v90
    v_lshlrev_b32 v130, 16, v91
    v_and_b32 v131, s3, v91
    v_pk_fma_f32 v[116:117], v[124:125], v[114:115], v[116:117] op_sel:[0,0,0] op_sel_hi:[1,0,1]
    v_pk_fma_f32 v[118:119], v[126:127], v[114:115], v[118:119] op_sel:[0,0,0] op_sel_hi:[1,0,1]
    v_pk_fma_f32 v[120:121], v[128:129], v[114:115], v[120:121] op_sel:[0,0,0] op_sel_hi:[1,0,1]
    v_pk_fma_f32 v[122:123], v[130:131], v[114:115], v[122:123] op_sel:[0,0,0] op_sel_hi:[1,0,1]
    s_waitcnt vmcnt(33)
    v_lshlrev_b32 v124, 16, v92
    v_and_b32 v125, s3, v92
    v_lshlrev_b32 v126, 16, v93
    v_and_b32 v127, s3, v93
    v_lshlrev_b32 v128, 16, v94
    v_and_b32 v129, s3, v94
    v_lshlrev_b32 v130, 16, v95
    v_and_b32 v131, s3, v95
    v_pk_fma_f32 v[116:117], v[124:125], v[114:115], v[116:117] op_sel:[0,1,0] op_sel_hi:[1,1,1]
    v_pk_fma_f32 v[118:119], v[126:127], v[114:115], v[118:119] op_sel:[0,1,0] op_sel_hi:[1,1,1]
    v_pk_fma_f32 v[120:121], v[128:129], v[114:115], v[120:121] op_sel:[0,1,0] op_sel_hi:[1,1,1]
    v_pk_fma_f32 v[122:123], v[130:131], v[114:115], v[122:123] op_sel:[0,1,0] op_sel_hi:[1,1,1]
    v_lshlrev_b32 v5, 5, v0
    ds_write_b128 v5, v[116:119]
    ds_write_b128 v5, v[120:123] offset:16
    s_waitcnt lgkmcnt(0)
    s_barrier
    v_lshrrev_b32 v5, 6, v0
    s_nop 0
    v_readfirstlane_b32 s17, v5
    s_nop 0
    s_cmp_lg_u32 s17, 0
    s_cbranch_scc1 L_adaL_gemv_done_50
    v_lshlrev_b32 v5, 2, v0
    ds_read2st64_b32 v[16:17], v5 offset0:0 offset1:1
    ds_read2st64_b32 v[20:21], v5 offset0:2 offset1:3
    ds_read2st64_b32 v[24:25], v5 offset0:4 offset1:5
    ds_read2st64_b32 v[28:29], v5 offset0:6 offset1:7
    ds_read2st64_b32 v[32:33], v5 offset0:8 offset1:9
    ds_read2st64_b32 v[36:37], v5 offset0:10 offset1:11
    ds_read2st64_b32 v[40:41], v5 offset0:12 offset1:13
    ds_read2st64_b32 v[44:45], v5 offset0:14 offset1:15
    ds_read2st64_b32 v[48:49], v5 offset0:16 offset1:17
    ds_read2st64_b32 v[52:53], v5 offset0:18 offset1:19
    ds_read2st64_b32 v[56:57], v5 offset0:20 offset1:21
    ds_read2st64_b32 v[60:61], v5 offset0:22 offset1:23
    ds_read2st64_b32 v[64:65], v5 offset0:24 offset1:25
    ds_read2st64_b32 v[68:69], v5 offset0:26 offset1:27
    ds_read2st64_b32 v[72:73], v5 offset0:28 offset1:29
    ds_read2st64_b32 v[76:77], v5 offset0:30 offset1:31
    s_waitcnt lgkmcnt(14)
    v_pk_add_f32 v[16:17], v[16:17], v[20:21]
    s_waitcnt lgkmcnt(13)
    v_pk_add_f32 v[16:17], v[16:17], v[24:25]
    s_waitcnt lgkmcnt(12)
    v_pk_add_f32 v[16:17], v[16:17], v[28:29]
    s_waitcnt lgkmcnt(11)
    v_pk_add_f32 v[16:17], v[16:17], v[32:33]
    s_waitcnt lgkmcnt(10)
    v_pk_add_f32 v[16:17], v[16:17], v[36:37]
    s_waitcnt lgkmcnt(9)
    v_pk_add_f32 v[16:17], v[16:17], v[40:41]
    s_waitcnt lgkmcnt(8)
    v_pk_add_f32 v[16:17], v[16:17], v[44:45]
    s_waitcnt lgkmcnt(7)
    v_pk_add_f32 v[16:17], v[16:17], v[48:49]
    s_waitcnt lgkmcnt(6)
    v_pk_add_f32 v[16:17], v[16:17], v[52:53]
    s_waitcnt lgkmcnt(5)
    v_pk_add_f32 v[16:17], v[16:17], v[56:57]
    s_waitcnt lgkmcnt(4)
    v_pk_add_f32 v[16:17], v[16:17], v[60:61]
    s_waitcnt lgkmcnt(3)
    v_pk_add_f32 v[16:17], v[16:17], v[64:65]
    s_waitcnt lgkmcnt(2)
    v_pk_add_f32 v[16:17], v[16:17], v[68:69]
    s_waitcnt lgkmcnt(1)
    v_pk_add_f32 v[16:17], v[16:17], v[72:73]
    s_waitcnt lgkmcnt(0)
    v_pk_add_f32 v[16:17], v[16:17], v[76:77]
    v_add_f32 v124, v16, v17
    v_cvt_pk_bf16_f32 v124, v124, v124
    v_lshlrev_b32 v124, 16, v124
    s_cmp_ge_u32 s16, 30
    s_cselect_b32 s17, 30, 0
    s_sub_u32 s17, s16, s17
    s_sub_u32 s17, s17, 10
    s_cmp_lt_u32 s17, 10
    s_cselect_b32 s17, 1.0, 0
    v_add_f32 v124, s17, v124
    v_cvt_pk_bf16_f32 v124, v124, v124
    v_lshlrev_b32 v124, 16, v124
    s_waitcnt vmcnt(32)
    v_readfirstlane_b32 s48, v232
    s_nop 0
    s_cmp_eq_u32 s48, 0
    s_cbranch_scc1 L_adaL_slow_51
L_adaL_got_53:
    v_mov_b32 v232, v124
    v_lshlrev_b32 v5, 3, v0
    s_lshl_b32 s17, s16, 9
    s_add_u32 s17, s17, 32768
    buffer_store_dwordx2 v[232:233], v5, s[4:7], s17 offen sc1
    v_mov_b32 v232, v233
L_adaL_gemv_done_50:
    s_branch L_adaL_join_45
L_adaL_stats_43:
    s_cmp_ge_u32 s2, 252
    s_cbranch_scc1 L_adaL_reset_46
    s_load_dwordx2 s[8:9], s[0:1], 0
    s_mov_b32 s10, 2621440
    s_mov_b32 s11, 0x20000
    s_sub_u32 s12, s2, 220
    s_bfe_u32 s13, s12, 0x10003
    s_and_b32 s12, s12, 16
    s_add_u32 s12, s12, s13
    s_and_b32 s13, s2, 7
    s_lshl_b32 s13, s13, 1
    s_add_u32 s12, s12, s13
    s_mul_i32 s13, s12, 81920
    s_add_u32 s14, s13, 5120
    s_add_u32 s15, s13, 10240
    s_add_u32 s16, s13, 15360
    s_mov_b32 s17, 0x3f803f80
    v_lshrrev_b32 v2, 6, v0
    v_bfe_u32 v4, v0, 4, 2
    v_lshl_add_u32 v1, v2, 4, v4
    v_mul_u32_u24 v1, 1280, v1
    v_and_b32 v3, 15, v0
    v_lshl_add_u32 v1, v3, 4, v1
    s_waitcnt lgkmcnt(0)
    buffer_load_dwordx4 v[6:9], v1, s[8:11], s13 offen offset:0
    buffer_load_dwordx4 v[10:13], v1, s[8:11], s13 offen offset:256
    buffer_load_dwordx4 v[14:17], v1, s[8:11], s13 offen offset:512
    buffer_load_dwordx4 v[18:21], v1, s[8:11], s13 offen offset:768
    buffer_load_dwordx4 v[22:25], v1, s[8:11], s13 offen offset:1024
    buffer_load_dwordx4 v[26:29], v1, s[8:11], s14 offen offset:0
    buffer_load_dwordx4 v[30:33], v1, s[8:11], s14 offen offset:256
    buffer_load_dwordx4 v[34:37], v1, s[8:11], s14 offen offset:512
    buffer_load_dwordx4 v[38:41], v1, s[8:11], s14 offen offset:768
    buffer_load_dwordx4 v[42:45], v1, s[8:11], s14 offen offset:1024
    buffer_load_dwordx4 v[46:49], v1, s[8:11], s15 offen offset:0
    buffer_load_dwordx4 v[50:53], v1, s[8:11], s15 offen offset:256
    buffer_load_dwordx4 v[54:57], v1, s[8:11], s15 offen offset:512
    buffer_load_dwordx4 v[58:61], v1, s[8:11], s15 offen offset:768
    buffer_load_dwordx4 v[62:65], v1, s[8:11], s15 offen offset:1024
    buffer_load_dwordx4 v[66:69], v1, s[8:11], s16 offen offset:0
    buffer_load_dwordx4 v[70:73], v1, s[8:11], s16 offen offset:256
    buffer_load_dwordx4 v[74:77], v1, s[8:11], s16 offen offset:512
    buffer_load_dwordx4 v[78:81], v1, s[8:11], s16 offen offset:768
    buffer_load_dwordx4 v[82:85], v1, s[8:11], s16 offen offset:1024
    buffer_load_dwordx2 v[232:233], off, s[44:47], 0 sc1
    v_cmp_eq_u32 vcc, 0, v3
    v_lshrrev_b32 v3, 1, v2
    v_lshlrev_b32 v3, 8, v3
    v_and_b32 v2, 1, v2
    v_lshl_add_u32 v3, v2, 6, v3
    v_and_b32 v2, 1, v4
    v_lshl_add_u32 v3, v2, 7, v3
    v_lshrrev_b32 v2, 1, v4
    v_lshl_add_u32 v3, v2, 2, v3
    s_lshl_b32 s13, s12, 9
    s_add_u32 s13, s13, 16384
    v_mov_b32 v86, 0
    v_mov_b32 v90, 0
    v_mov_b32 v87, 0
    v_mov_b32 v91, 0
    v_mov_b32 v88, 0
    v_mov_b32 v92, 0
    v_mov_b32 v89, 0
    v_mov_b32 v93, 0
    s_waitcnt vmcnt(20)
    v_dot2c_f32_bf16 v86, s17, v6
    v_dot2c_f32_bf16 v90, v6, v6
    v_dot2c_f32_bf16 v86, s17, v7
    v_dot2c_f32_bf16 v90, v7, v7
    v_dot2c_f32_bf16 v86, s17, v8
    v_dot2c_f32_bf16 v90, v8, v8
    v_dot2c_f32_bf16 v86, s17, v9
    v_dot2c_f32_bf16 v90, v9, v9
    s_waitcnt vmcnt(19)
    v_dot2c_f32_bf16 v86, s17, v10
    v_dot2c_f32_bf16 v90, v10, v10
    v_dot2c_f32_bf16 v86, s17, v11
    v_dot2c_f32_bf16 v90, v11, v11
    v_dot2c_f32_bf16 v86, s17, v12
    v_dot2c_f32_bf16 v90, v12, v12
    v_dot2c_f32_bf16 v86, s17, v13
    v_dot2c_f32_bf16 v90, v13, v13
    s_waitcnt vmcnt(18)
    v_dot2c_f32_bf16 v86, s17, v14
    v_dot2c_f32_bf16 v90, v14, v14
    v_dot2c_f32_bf16 v86, s17, v15
    v_dot2c_f32_bf16 v90, v15, v15
    v_dot2c_f32_bf16 v86, s17, v16
    v_dot2c_f32_bf16 v90, v16, v16
    v_dot2c_f32_bf16 v86, s17, v17
    v_dot2c_f32_bf16 v90, v17, v17
    s_waitcnt vmcnt(17)
    v_dot2c_f32_bf16 v86, s17, v18
    v_dot2c_f32_bf16 v90, v18, v18
    v_dot2c_f32_bf16 v86, s17, v19
    v_dot2c_f32_bf16 v90, v19, v19
    v_dot2c_f32_bf16 v86, s17, v20
    v_dot2c_f32_bf16 v90, v20, v20
    v_dot2c_f32_bf16 v86, s17, v21
    v_dot2c_f32_bf16 v90, v21, v21
    s_waitcnt vmcnt(16)
    v_dot2c_f32_bf16 v86, s17, v22
    v_dot2c_f32_bf16 v90, v22, v22
    v_dot2c_f32_bf16 v86, s17, v23
    v_dot2c_f32_bf16 v90, v23, v23
    v_dot2c_f32_bf16 v86, s17, v24
    v_dot2c_f32_bf16 v90, v24, v24
    v_dot2c_f32_bf16 v86, s17, v25
    v_dot2c_f32_bf16 v90, v25, v25
    s_waitcnt vmcnt(15)
    v_dot2c_f32_bf16 v87, s17, v26
    v_dot2c_f32_bf16 v91, v26, v26
    v_dot2c_f32_bf16 v87, s17, v27
    v_dot2c_f32_bf16 v91, v27, v27
    v_dot2c_f32_bf16 v87, s17, v28
    v_dot2c_f32_bf16 v91, v28, v28
    v_dot2c_f32_bf16 v87, s17, v29
    v_dot2c_f32_bf16 v91, v29, v29
    s_waitcnt vmcnt(14)
    v_dot2c_f32_bf16 v87, s17, v30
    v_dot2c_f32_bf16 v91, v30, v30
    v_dot2c_f32_bf16 v87, s17, v31
    v_dot2c_f32_bf16 v91, v31, v31
    v_dot2c_f32_bf16 v87, s17, v32
    v_dot2c_f32_bf16 v91, v32, v32
    v_dot2c_f32_bf16 v87, s17, v33
    v_dot2c_f32_bf16 v91, v33, v33
    s_waitcnt vmcnt(13)
    v_dot2c_f32_bf16 v87, s17, v34
    v_dot2c_f32_bf16 v91, v34, v34
    v_dot2c_f32_bf16 v87, s17, v35
    v_dot2c_f32_bf16 v91, v35, v35
    v_dot2c_f32_bf16 v87, s17, v36
    v_dot2c_f32_bf16 v91, v36, v36
    v_dot2c_f32_bf16 v87, s17, v37
    v_dot2c_f32_bf16 v91, v37, v37
    s_waitcnt vmcnt(12)
    v_dot2c_f32_bf16 v87, s17, v38
    v_dot2c_f32_bf16 v91, v38, v38
    v_dot2c_f32_bf16 v87, s17, v39
    v_dot2c_f32_bf16 v91, v39, v39
    v_dot2c_f32_bf16 v87, s17, v40
    v_dot2c_f32_bf16 v91, v40, v40
    v_dot2c_f32_bf16 v87, s17, v41
    v_dot2c_f32_bf16 v91, v41, v41
    s_waitcnt vmcnt(11)
    v_dot2c_f32_bf16 v87, s17, v42
    v_dot2c_f32_bf16 v91, v42, v42
    v_dot2c_f32_bf16 v87, s17, v43
    v_dot2c_f32_bf16 v91, v43, v43
    v_dot2c_f32_bf16 v87, s17, v44
    v_dot2c_f32_bf16 v91, v44, v44
    v_dot2c_f32_bf16 v87, s17, v45
    v_dot2c_f32_bf16 v91, v45, v45
    s_waitcnt vmcnt(10)
    v_dot2c_f32_bf16 v88, s17, v46
    v_dot2c_f32_bf16 v92, v46, v46
    v_dot2c_f32_bf16 v88, s17, v47
    v_dot2c_f32_bf16 v92, v47, v47
    v_dot2c_f32_bf16 v88, s17, v48
    v_dot2c_f32_bf16 v92, v48, v48
    v_dot2c_f32_bf16 v88, s17, v49
    v_dot2c_f32_bf16 v92, v49, v49
    s_waitcnt vmcnt(9)
    v_dot2c_f32_bf16 v88, s17, v50
    v_dot2c_f32_bf16 v92, v50, v50
    v_dot2c_f32_bf16 v88, s17, v51
    v_dot2c_f32_bf16 v92, v51, v51
    v_dot2c_f32_bf16 v88, s17, v52
    v_dot2c_f32_bf16 v92, v52, v52
    v_dot2c_f32_bf16 v88, s17, v53
    v_dot2c_f32_bf16 v92, v53, v53
    s_waitcnt vmcnt(8)
    v_dot2c_f32_bf16 v88, s17, v54
    v_dot2c_f32_bf16 v92, v54, v54
    v_dot2c_f32_bf16 v88, s17, v55
    v_dot2c_f32_bf16 v92, v55, v55
    v_dot2c_f32_bf16 v88, s17, v56
    v_dot2c_f32_bf16 v92, v56, v56
    v_dot2c_f32_bf16 v88, s17, v57
    v_dot2c_f32_bf16 v92, v57, v57
    s_waitcnt vmcnt(7)
    v_dot2c_f32_bf16 v88, s17, v58
    v_dot2c_f32_bf16 v92, v58, v58
    v_dot2c_f32_bf16 v88, s17, v59
    v_dot2c_f32_bf16 v92, v59, v59
    v_dot2c_f32_bf16 v88, s17, v60
    v_dot2c_f32_bf16 v92, v60, v60
    v_dot2c_f32_bf16 v88, s17, v61
    v_dot2c_f32_bf16 v92, v61, v61
    s_waitcnt vmcnt(6)
    v_dot2c_f32_bf16 v88, s17, v62
    v_dot2c_f32_bf16 v92, v62, v62
    v_dot2c_f32_bf16 v88, s17, v63
    v_dot2c_f32_bf16 v92, v63, v63
    v_dot2c_f32_bf16 v88, s17, v64
    v_dot2c_f32_bf16 v92, v64, v64
    v_dot2c_f32_bf16 v88, s17, v65
    v_dot2c_f32_bf16 v92, v65, v65
    s_waitcnt vmcnt(5)
    v_dot2c_f32_bf16 v89, s17, v66
    v_dot2c_f32_bf16 v93, v66, v66
    v_dot2c_f32_bf16 v89, s17, v67
    v_dot2c_f32_bf16 v93, v67, v67
    v_dot2c_f32_bf16 v89, s17, v68
    v_dot2c_f32_bf16 v93, v68, v68
    v_dot2c_f32_bf16 v89, s17, v69
    v_dot2c_f32_bf16 v93, v69, v69
    s_waitcnt vmcnt(4)
    v_dot2c_f32_bf16 v89, s17, v70
    v_dot2c_f32_bf16 v93, v70, v70
    v_dot2c_f32_bf16 v89, s17, v71
    v_dot2c_f32_bf16 v93, v71, v71
    v_dot2c_f32_bf16 v89, s17, v72
    v_dot2c_f32_bf16 v93, v72, v72
    v_dot2c_f32_bf16 v89, s17, v73
    v_dot2c_f32_bf16 v93, v73, v73
    s_waitcnt vmcnt(3)
    v_dot2c_f32_bf16 v89, s17, v74
    v_dot2c_f32_bf16 v93, v74, v74
    v_dot2c_f32_bf16 v89, s17, v75
    v_dot2c_f32_bf16 v93, v75, v75
    v_dot2c_f32_bf16 v89, s17, v76
    v_dot2c_f32_bf16 v93, v76, v76
    v_dot2c_f32_bf16 v89, s17, v77
    v_dot2c_f32_bf16 v93, v77, v77
    s_waitcnt vmcnt(2)
    v_dot2c_f32_bf16 v89, s17, v78
    v_dot2c_f32_bf16 v93, v78, v78
    v_dot2c_f32_bf16 v89, s17, v79
    v_dot2c_f32_bf16 v93, v79, v79
    v_dot2c_f32_bf16 v89, s17, v80
    v_dot2c_f32_bf16 v93, v80, v80
    v_dot2c_f32_bf16 v89, s17, v81
    v_dot2c_f32_bf16 v93, v81, v81
    s_waitcnt vmcnt(1)
    v_dot2c_f32_bf16 v89, s17, v82
    v_dot2c_f32_bf16 v93, v82, v82
    v_dot2c_f32_bf16 v89, s17, v83
    v_dot2c_f32_bf16 v93, v83, v83
    v_dot2c_f32_bf16 v89, s17, v84
    v_dot2c_f32_bf16 v93, v84, v84
    v_dot2c_f32_bf16 v89, s17, v85
    v_dot2c_f32_bf16 v93, v85, v85
    v_add_f32_dpp v86, v86, v86 row_ror:8 row_mask:0xf bank_mask:0xf
    v_add_f32_dpp v90, v90, v90 row_ror:8 row_mask:0xf bank_mask:0xf
    v_add_f32_dpp v87, v87, v87 row_ror:8 row_mask:0xf bank_mask:0xf
    v_add_f32_dpp v91, v91, v91 row_ror:8 row_mask:0xf bank_mask:0xf
    v_add_f32_dpp v88, v88, v88 row_ror:8 row_mask:0xf bank_mask:0xf
    v_add_f32_dpp v92, v92, v92 row_ror:8 row_mask:0xf bank_mask:0xf
    v_add_f32_dpp v89, v89, v89 row_ror:8 row_mask:0xf bank_mask:0xf
    v_add_f32_dpp v93, v93, v93 row_ror:8 row_mask:0xf bank_mask:0xf
    v_add_f32_dpp v86, v86, v86 row_ror:4 row_mask:0xf bank_mask:0xf
    v_add_f32_dpp v90, v90, v90 row_ror:4 row_mask:0xf bank_mask:0xf
    v_add_f32_dpp v87, v87, v87 row_ror:4 row_mask:0xf bank_mask:0xf
    v_add_f32_dpp v91, v91, v91 row_ror:4 row_mask:0xf bank_mask:0xf
    v_add_f32_dpp v88, v88, v88 row_ror:4 row_mask:0xf bank_mask:0xf
    v_add_f32_dpp v92, v92, v92 row_ror:4 row_mask:0xf bank_mask:0xf
    v_add_f32_dpp v89, v89, v89 row_ror:4 row_mask:0xf bank_mask:0xf
    v_add_f32_dpp v93, v93, v93 row_ror:4 row_mask:0xf bank_mask:0xf
    v_add_f32_dpp v86, v86, v86 row_ror:2 row_mask:0xf bank_mask:0xf
    v_add_f32_dpp v90, v90, v90 row_ror:2 row_mask:0xf bank_mask:0xf
    v_add_f32_dpp v87, v87, v87 row_ror:2 row_mask:0xf bank_mask:0xf
    v_add_f32_dpp v91, v91, v91 row_ror:2 row_mask:0xf bank_mask:0xf
    v_add_f32_dpp v88, v88, v88 row_ror:2 row_mask:0xf bank_mask:0xf
    v_add_f32_dpp v92, v92, v92 row_ror:2 row_mask:0xf bank_mask:0xf
    v_add_f32_dpp v89, v89, v89 row_ror:2 row_mask:0xf bank_mask:0xf
    v_add_f32_dpp v93, v93, v93 row_ror:2 row_mask:0xf bank_mask:0xf
    v_add_f32_dpp v86, v86, v86 row_ror:1 row_mask:0xf bank_mask:0xf
    v_add_f32_dpp v90, v90, v90 row_ror:1 row_mask:0xf bank_mask:0xf
    v_add_f32_dpp v87, v87, v87 row_ror:1 row_mask:0xf bank_mask:0xf
    v_add_f32_dpp v91, v91, v91 row_ror:1 row_mask:0xf bank_mask:0xf
    v_add_f32_dpp v88, v88, v88 row_ror:1 row_mask:0xf bank_mask:0xf
    v_add_f32_dpp v92, v92, v92 row_ror:1 row_mask:0xf bank_mask:0xf
    v_add_f32_dpp v89, v89, v89 row_ror:1 row_mask:0xf bank_mask:0xf
    v_add_f32_dpp v93, v93, v93 row_ror:1 row_mask:0xf bank_mask:0xf
    v_mul_f32 v86, 0x3acccccd, v86
    v_mul_f32 v90, 0x3acccccd, v90
    v_mul_f32 v87, 0x3acccccd, v87
    v_mul_f32 v91, 0x3acccccd, v91
    v_mul_f32 v88, 0x3acccccd, v88
    v_mul_f32 v92, 0x3acccccd, v92
    v_mul_f32 v89, 0x3acccccd, v89
    v_mul_f32 v93, 0x3acccccd, v93
    v_fma_f32 v90, -v86, v86, v90
    v_max_f32 v90, 0, v90
    v_add_f32 v90, 0x3727c5ac, v90
    v_rsq_f32 v90, v90
    v_fma_f32 v91, -v87, v87, v91
    v_max_f32 v91, 0, v91
    v_add_f32 v91, 0x3727c5ac, v91
    v_rsq_f32 v91, v91
    v_fma_f32 v92, -v88, v88, v92
    v_max_f32 v92, 0, v92
    v_add_f32 v92, 0x3727c5ac, v92
    v_rsq_f32 v92, v92
    v_fma_f32 v93, -v89, v89, v93
    v_max_f32 v93, 0, v93
    v_add_f32 v93, 0x3727c5ac, v93
    v_rsq_f32 v93, v93
    v_mul_f32 v94, -v86, v90
    v_mul_f32 v95, -v87, v91
    v_mul_f32 v96, -v88, v92
    v_mul_f32 v97, -v89, v93
    s_and_b64 exec, exec, vcc
    ds_write2_b32 v3, v90, v94 offset0:0 offset1:2
    ds_write2_b32 v3, v91, v95 offset0:4 offset1:6
    ds_write2_b32 v3, v92, v96 offset0:8 offset1:10
    ds_write2_b32 v3, v93, v97 offset0:12 offset1:14
    s_mov_b64 exec, -1
    v_lshlrev_b32 v3, 3, v0
    v_cmp_gt_u32 vcc, 64, v0
    v_mov_b32 v2, 2147483648
    s_nop 0
    v_cndmask_b32 v1, v2, v3, vcc
    s_waitcnt lgkmcnt(0)
    s_barrier
    ds_read_b64 v[94:95], v3
    s_waitcnt lgkmcnt(0)
    buffer_store_dwordx2 v[94:95], v1, s[4:7], s13 offen sc1
    s_cmp_lg_u32 s39, 0
    s_cbranch_scc1 L_adaL_nopost_54
    s_waitcnt vmcnt(1)
    v_readfirstlane_b32 s48, v232
    s_nop 0
    s_cmp_eq_u32 s48, 0
    s_cbranch_scc1 L_adaL_slow_55
L_adaL_got_57:
    s_lshl_b32 s43, s2, 3
    s_add_u32 s43, s43, 178464
    v_lshlrev_b32_e64 v1, 8, v0
    s_waitcnt vmcnt(0)
    s_mov_b64 exec, 255
    buffer_store_dwordx2 v[232:233], v1, s[4:7], s43 offen sc1
    s_mov_b64 exec, -1
L_adaL_nopost_54:
    s_barrier
    s_cmp_ge_u32 s2, 240
    s_cbranch_scc1 L_adaL_reset_46
    buffer_load_dword v142, v138, s[20:23], s28 offen offset:0
    buffer_load_dword v143, v138, s[20:23], s28 offen offset:3456
    s_add_u32 s28, s28, 6912
    buffer_load_dword v144, v138, s[20:23], s28 offen offset:0
    buffer_load_dword v145, v138, s[20:23], s28 offen offset:3456
    s_add_u32 s28, s28, 6912
    buffer_load_dword v146, v138, s[20:23], s28 offen offset:0
    buffer_load_dword v147, v138, s[20:23], s28 offen offset:3456
    s_add_u32 s28, s28, 6912
    buffer_load_dword v148, v138, s[20:23], s28 offen offset:0
    buffer_load_dword v149, v138, s[20:23], s28 offen offset:3456
    s_add_u32 s28, s28, 6912
    buffer_load_dword v150, v138, s[20:23], s28 offen offset:0
    buffer_load_dword v151, v138, s[20:23], s28 offen offset:3456
    s_add_u32 s28, s28, 6912
    buffer_load_dword v152, v138, s[20:23], s28 offen offset:0
    buffer_load_dword v153, v138, s[20:23], s28 offen offset:3456
    s_add_u32 s28, s28, 6912
    buffer_load_dword v154, v138, s[20:23], s28 offen offset:0
    buffer_load_dword v155, v138, s[20:23], s28 offen offset:3456
    s_add_u32 s28, s28, 6912
    buffer_load_dword v156, v138, s[20:23], s28 offen offset:0
    buffer_load_dword v157, v138, s[20:23], s28 offen offset:3456
    s_add_u32 s28, s28, 6912
    buffer_load_dword v158, v138, s[20:23], s28 offen offset:0
    buffer_load_dword v159, v138, s[20:23], s28 offen offset:3456
    s_add_u32 s28, s28, 6912
    buffer_load_dword v160, v138, s[20:23], s28 offen offset:0
    buffer_load_dword v161, v138, s[20:23], s28 offen offset:3456
    s_add_u32 s28, s28, 6912
    buffer_load_dword v162, v138, s[20:23], s28 offen offset:0
    buffer_load_dword v163, v138, s[20:23], s28 offen offset:3456
    s_add_u32 s28, s28, 6912
    buffer_load_dword v164, v138, s[20:23], s28 offen offset:0
    buffer_load_dword v165, v138, s[20:23], s28 offen offset:3456
    s_add_u32 s28, s28, 6912
    buffer_load_dword v166, v138, s[20:23], s28 offen offset:0
    buffer_load_dword v167, v138, s[20:23], s28 offen offset:3456
    s_add_u32 s28, s28, 6912
    buffer_load_dword v168, v138, s[20:23], s28 offen offset:0
    buffer_load_dword v169, v138, s[20:23], s28 offen offset:3456
    s_add_u32 s28, s28, 6912
    buffer_load_dword v170, v138, s[20:23], s28 offen offset:0
    buffer_load_dword v171, v138, s[20:23], s28 offen offset:3456
    s_add_u32 s28, s28, 6912
    buffer_load_dword v172, v138, s[20:23], s28 offen offset:0
    buffer_load_dword v173, v138, s[20:23], s28 offen offset:3456
L_adaL_join_45:
    s_waitcnt vmcnt(32)
    v_readfirstlane_b32 s48, v232
    s_nop 0
    s_cmp_eq_u32 s48, 0
    s_cbranch_scc1 L_adaL_slow_58
L_adaL_got_60:
    s_lshl_b32 s28, s30, 8
    s_add_u32 s28, s28, 48128
    v_lshrrev_b32 v236, 5, v136
    v_mul_u32_u24 v236, 4864, v236
    v_lshl_add_u32 v236, v136, 3, v236
    v_add_u32 v236, s28, v236
    buffer_load_dwordx2 v[234:235], v236, s[4:7], 0 offen sc1
    s_lshr_b32 s43, s26, 1
    s_mul_i32 s43, s43, 6
    s_add_u32 s43, s43, s25
    s_lshl_b32 s43, s43, 1
    s_and_b32 s8, s26, 1
    s_add_u32 s43, s43, s8
    s_lshl_b32 s43, s43, 5
    s_add_u32 s43, s43, 65536
    s_cmp_lg_u32 s39, 0
    s_cselect_b32 s43, 33554432, s43
    v_mul_u32_u24 v237, 3840, v0
    s_mov_b32 s27, 0x3f803f80
    v_lshrrev_b32 v139, 4, v136
    v_lshlrev_b32 v1, 5, v139
    v_mul_u32_u24 v139, 40960, v139
    v_and_b32 v140, 15, v136
    v_lshl_add_u32 v139, v140, 4, v139
    v_add_u32 v1, v1, v140
    v_cmp_le_u32 vcc, 48, v136
    v_and_b32 v140, 8, v136
    s_nop 0
    v_cndmask_b32 v140, 0, v140, vcc
    v_add_u32 v1, v1, v140
    v_mov_b32 v137, 20480
    v_mov_b32 v140, 128
    v_cndmask_b32 v137, v137, v140, vcc
    v_cndmask_b32 v2, 16, 8, vcc
    v_add_u32 v2, v2, v1
    v_cmp_gt_u32 vcc, 56, v136
    v_mov_b32 v140, 2147483648
    s_nop 0
    v_cndmask_b32 v139, v140, v139, vcc
    v_add_u32 v140, v137, v139
    s_mul_i32 s28, s26, 143360
    s_lshl_b32 s29, s30, 10
    s_add_u32 s28, s28, s29
    s_add_u32 s28, s28, 8912896
    v_mov_b32 v4, 0
    v_mov_b32 v5, 0
    v_mov_b32 v6, 0
    v_mov_b32 v7, 0
    s_waitcnt vmcnt(32)
    v_lshlrev_b32 v8, 16, v142
    v_and_b32 v40, s3, v142
    s_waitcnt vmcnt(31)
    v_lshlrev_b32 v9, 16, v143
    v_and_b32 v41, s3, v143
    s_waitcnt vmcnt(30)
    v_lshlrev_b32 v10, 16, v144
    v_and_b32 v42, s3, v144
    s_waitcnt vmcnt(29)
    v_lshlrev_b32 v11, 16, v145
    v_and_b32 v43, s3, v145
    s_waitcnt vmcnt(28)
    v_lshlrev_b32 v12, 16, v146
    v_and_b32 v44, s3, v146
    s_waitcnt vmcnt(27)
    v_lshlrev_b32 v13, 16, v147
    v_and_b32 v45, s3, v147
    s_waitcnt vmcnt(26)
    v_lshlrev_b32 v14, 16, v148
    v_and_b32 v46, s3, v148
    s_waitcnt vmcnt(25)
    v_lshlrev_b32 v15, 16, v149
    v_and_b32 v47, s3, v149
    s_waitcnt vmcnt(24)
    v_lshlrev_b32 v16, 16, v150
    v_and_b32 v48, s3, v150
    s_waitcnt vmcnt(23)
    v_lshlrev_b32 v17, 16, v151
    v_and_b32 v49, s3, v151
    s_waitcnt vmcnt(22)
    v_lshlrev_b32 v18, 16, v152
    v_and_b32 v50, s3, v152
    s_waitcnt vmcnt(21)
    v_lshlrev_b32 v19, 16, v153
    v_and_b32 v51, s3, v153
    s_waitcnt vmcnt(20)
    v_lshlrev_b32 v20, 16, v154
    v_and_b32 v52, s3, v154
    s_waitcnt vmcnt(19)
    v_lshlrev_b32 v21, 16, v155
    v_and_b32 v53, s3, v155
    s_waitcnt vmcnt(18)
    v_lshlrev_b32 v22, 16, v156
    v_and_b32 v54, s3, v156
    s_waitcnt vmcnt(17)
    v_lshlrev_b32 v23, 16, v157
    v_and_b32 v55, s3, v157
    s_waitcnt vmcnt(16)
    v_lshlrev_b32 v24, 16, v158
    v_and_b32 v56, s3, v158
    s_waitcnt vmcnt(15)
    v_lshlrev_b32 v25, 16, v159
    v_and_b32 v57, s3, v159
    s_waitcnt vmcnt(14)
    v_lshlrev_b32 v26, 16, v160
    v_and_b32 v58, s3, v160
    s_waitcnt vmcnt(13)
    v_lshlrev_b32 v27, 16, v161
    v_and_b32 v59, s3, v161
    s_waitcnt vmcnt(12)
    v_lshlrev_b32 v28, 16, v162
    v_and_b32 v60, s3, v162
    s_waitcnt vmcnt(11)
    v_lshlrev_b32 v29, 16, v163
    v_and_b32 v61, s3, v163
    s_waitcnt vmcnt(10)
    v_lshlrev_b32 v30, 16, v164
    v_and_b32 v62, s3, v164
    s_waitcnt vmcnt(9)
    v_lshlrev_b32 v31, 16, v165
    v_and_b32 v63, s3, v165
    s_waitcnt vmcnt(8)
    v_lshlrev_b32 v32, 16, v166
    v_and_b32 v64, s3, v166
    s_waitcnt vmcnt(7)
    v_lshlrev_b32 v33, 16, v167
    v_and_b32 v65, s3, v167
    s_waitcnt vmcnt(6)
    v_lshlrev_b32 v34, 16, v168
    v_and_b32 v66, s3, v168
    s_waitcnt vmcnt(5)
    v_lshlrev_b32 v35, 16, v169
    v_and_b32 v67, s3, v169
    s_waitcnt vmcnt(4)
    v_lshlrev_b32 v36, 16, v170
    v_and_b32 v68, s3, v170
    s_waitcnt vmcnt(3)
    v_lshlrev_b32 v37, 16, v171
    v_and_b32 v69, s3, v171
    s_waitcnt vmcnt(2)
    v_lshlrev_b32 v38, 16, v172
    v_and_b32 v70, s3, v172
    s_waitcnt vmcnt(1)
    v_lshlrev_b32 v39, 16, v173
    v_and_b32 v71, s3, v173
    s_mov_b32 s49, 65536
    s_waitcnt vmcnt(0)
    v_cmp_ne_u32 vcc, s48, v235
    s_nop 0
    s_cbranch_vccz L_adaL_got_63
L_adaL_poll_62:
    buffer_load_dwordx2 v[234:235], v236, s[4:7], 0 offen sc1
    s_waitcnt vmcnt(0)
    s_sub_u32 s49, s49, 1
    s_cbranch_scc1 L_adaL_got_63
    v_cmp_ne_u32 vcc, s48, v235
    s_nop 0
    s_cbranch_vccnz L_adaL_poll_62
L_adaL_got_63:
    v_readlane_b32 s52, v234, 32
    v_readlane_b32 s53, v234, 33
    v_readlane_b32 s54, v234, 34
    v_readlane_b32 s55, v234, 35
    v_readlane_b32 s56, v234, 36
    v_readlane_b32 s57, v234, 37
    v_readlane_b32 s58, v234, 38
    v_readlane_b32 s59, v234, 39
    v_pk_mul_f32 v[72:73], v[8:9], s[52:53]
    v_pk_mul_f32 v[80:81], v[40:41], s[52:53]
    v_pk_mul_f32 v[74:75], v[10:11], s[54:55]
    v_pk_mul_f32 v[82:83], v[42:43], s[54:55]
    v_pk_mul_f32 v[76:77], v[12:13], s[56:57]
    v_pk_mul_f32 v[84:85], v[44:45], s[56:57]
    v_pk_mul_f32 v[78:79], v[14:15], s[58:59]
    v_pk_mul_f32 v[86:87], v[46:47], s[58:59]
    v_cvt_pk_bf16_f32 v142, v72, v73
    v_cvt_pk_bf16_f32 v146, v80, v81
    v_cvt_pk_bf16_f32 v143, v74, v75
    v_cvt_pk_bf16_f32 v147, v82, v83
    v_cvt_pk_bf16_f32 v144, v76, v77
    v_cvt_pk_bf16_f32 v148, v84, v85
    v_cvt_pk_bf16_f32 v145, v78, v79
    v_cvt_pk_bf16_f32 v149, v86, v87
    buffer_store_dwordx4 v[142:145], v139, s[4:7], s28 offen offset:0 sc1
    buffer_store_dwordx4 v[146:149], v140, s[4:7], s28 offen offset:0 sc1
    v_readlane_b32 s60, v234, 40
    v_readlane_b32 s61, v234, 41
    v_readlane_b32 s62, v234, 42
    v_readlane_b32 s63, v234, 43
    v_readlane_b32 s64, v234, 44
    v_readlane_b32 s65, v234, 45
    v_readlane_b32 s66, v234, 46
    v_readlane_b32 s67, v234, 47
    v_pk_mul_f32 v[72:73], v[16:17], s[60:61]
    v_pk_mul_f32 v[80:81], v[48:49], s[60:61]
    v_pk_mul_f32 v[74:75], v[18:19], s[62:63]
    v_pk_mul_f32 v[82:83], v[50:51], s[62:63]
    v_pk_mul_f32 v[76:77], v[20:21], s[64:65]
    v_pk_mul_f32 v[84:85], v[52:53], s[64:65]
    v_pk_mul_f32 v[78:79], v[22:23], s[66:67]
    v_pk_mul_f32 v[86:87], v[54:55], s[66:67]
    v_cvt_pk_bf16_f32 v150, v72, v73
    v_cvt_pk_bf16_f32 v154, v80, v81
    v_cvt_pk_bf16_f32 v151, v74, v75
    v_cvt_pk_bf16_f32 v155, v82, v83
    v_cvt_pk_bf16_f32 v152, v76, v77
    v_cvt_pk_bf16_f32 v156, v84, v85
    v_cvt_pk_bf16_f32 v153, v78, v79
    v_cvt_pk_bf16_f32 v157, v86, v87
    buffer_store_dwordx4 v[150:153], v139, s[4:7], s28 offen offset:256 sc1
    buffer_store_dwordx4 v[154:157], v140, s[4:7], s28 offen offset:256 sc1
    v_readlane_b32 s68, v234, 48
    v_readlane_b32 s69, v234, 49
    v_readlane_b32 s70, v234, 50
    v_readlane_b32 s71, v234, 51
    v_readlane_b32 s72, v234, 52
    v_readlane_b32 s73, v234, 53
    v_readlane_b32 s74, v234, 54
    v_readlane_b32 s75, v234, 55
    v_pk_mul_f32 v[72:73], v[24:25], s[68:69]
    v_pk_mul_f32 v[80:81], v[56:57], s[68:69]
    v_pk_mul_f32 v[74:75], v[26:27], s[70:71]
    v_pk_mul_f32 v[82:83], v[58:59], s[70:71]
    v_pk_mul_f32 v[76:77], v[28:29], s[72:73]
    v_pk_mul_f32 v[84:85], v[60:61], s[72:73]
    v_pk_mul_f32 v[78:79], v[30:31], s[74:75]
    v_pk_mul_f32 v[86:87], v[62:63], s[74:75]
    v_cvt_pk_bf16_f32 v158, v72, v73
    v_cvt_pk_bf16_f32 v162, v80, v81
    v_cvt_pk_bf16_f32 v159, v74, v75
    v_cvt_pk_bf16_f32 v163, v82, v83
    v_cvt_pk_bf16_f32 v160, v76, v77
    v_cvt_pk_bf16_f32 v164, v84, v85
    v_cvt_pk_bf16_f32 v161, v78, v79
    v_cvt_pk_bf16_f32 v165, v86, v87
    buffer_store_dwordx4 v[158:161], v139, s[4:7], s28 offen offset:512 sc1
    buffer_store_dwordx4 v[162:165], v140, s[4:7], s28 offen offset:512 sc1
    v_readlane_b32 s76, v234, 56
    v_readlane_b32 s77, v234, 57
    v_readlane_b32 s78, v234, 58
    v_readlane_b32 s79, v234, 59
    v_readlane_b32 s80, v234, 60
    v_readlane_b32 s81, v234, 61
    v_readlane_b32 s82, v234, 62
    v_readlane_b32 s83, v234, 63
    v_pk_mul_f32 v[72:73], v[32:33], s[76:77]
    v_pk_mul_f32 v[80:81], v[64:65], s[76:77]
    v_pk_mul_f32 v[74:75], v[34:35], s[78:79]
    v_pk_mul_f32 v[82:83], v[66:67], s[78:79]
    v_pk_mul_f32 v[76:77], v[36:37], s[80:81]
    v_pk_mul_f32 v[84:85], v[68:69], s[80:81]
    v_pk_mul_f32 v[78:79], v[38:39], s[82:83]
    v_pk_mul_f32 v[86:87], v[70:71], s[82:83]
    v_cvt_pk_bf16_f32 v166, v72, v73
    v_cvt_pk_bf16_f32 v170, v80, v81
    v_cvt_pk_bf16_f32 v167, v74, v75
    v_cvt_pk_bf16_f32 v171, v82, v83
    v_cvt_pk_bf16_f32 v168, v76, v77
    v_cvt_pk_bf16_f32 v172, v84, v85
    v_cvt_pk_bf16_f32 v169, v78, v79
    v_cvt_pk_bf16_f32 v173, v86, v87
    buffer_store_dwordx4 v[166:169], v139, s[4:7], s28 offen offset:768 sc1
    buffer_store_dwordx4 v[170:173], v140, s[4:7], s28 offen offset:768 sc1
    v_readlane_b32 s52, v234, 0
    v_readlane_b32 s53, v234, 1
    v_readlane_b32 s54, v234, 2
    v_readlane_b32 s55, v234, 3
    v_readlane_b32 s56, v234, 4
    v_readlane_b32 s57, v234, 5
    v_readlane_b32 s58, v234, 6
    v_readlane_b32 s59, v234, 7
    v_readlane_b32 s60, v234, 8
    v_readlane_b32 s61, v234, 9
    v_readlane_b32 s62, v234, 10
    v_readlane_b32 s63, v234, 11
    v_readlane_b32 s64, v234, 12
    v_readlane_b32 s65, v234, 13
    v_readlane_b32 s66, v234, 14
    v_readlane_b32 s67, v234, 15
    v_readlane_b32 s68, v234, 16
    v_readlane_b32 s69, v234, 17
    v_readlane_b32 s70, v234, 18
    v_readlane_b32 s71, v234, 19
    v_readlane_b32 s72, v234, 20
    v_readlane_b32 s73, v234, 21
    v_readlane_b32 s74, v234, 22
    v_readlane_b32 s75, v234, 23
    v_readlane_b32 s76, v234, 24
    v_readlane_b32 s77, v234, 25
    v_readlane_b32 s78, v234, 26
    v_readlane_b32 s79, v234, 27
    v_readlane_b32 s80, v234, 28
    v_readlane_b32 s81, v234, 29
    v_readlane_b32 s82, v234, 30
    v_readlane_b32 s83, v234, 31
    v_fmac_f32 v6, s52, v8
    v_fmac_f32 v7, s52, v40
    v_fmac_f32 v6, s53, v9
    v_fmac_f32 v7, s53, v41
    v_fmac_f32 v6, s54, v10
    v_fmac_f32 v7, s54, v42
    v_fmac_f32 v6, s55, v11
    v_fmac_f32 v7, s55, v43
    v_fmac_f32 v6, s56, v12
    v_fmac_f32 v7, s56, v44
    v_fmac_f32 v6, s57, v13
    v_fmac_f32 v7, s57, v45
    v_fmac_f32 v6, s58, v14
    v_fmac_f32 v7, s58, v46
    v_fmac_f32 v6, s59, v15
    v_fmac_f32 v7, s59, v47
    v_fmac_f32 v6, s60, v16
    v_fmac_f32 v7, s60, v48
    v_fmac_f32 v6, s61, v17
    v_fmac_f32 v7, s61, v49
    v_fmac_f32 v6, s62, v18
    v_fmac_f32 v7, s62, v50
    v_fmac_f32 v6, s63, v19
    v_fmac_f32 v7, s63, v51
    v_fmac_f32 v6, s64, v20
    v_fmac_f32 v7, s64, v52
    v_fmac_f32 v6, s65, v21
    v_fmac_f32 v7, s65, v53
    v_fmac_f32 v6, s66, v22
    v_fmac_f32 v7, s66, v54
    v_fmac_f32 v6, s67, v23
    v_fmac_f32 v7, s67, v55
    v_fmac_f32 v6, s68, v24
    v_fmac_f32 v7, s68, v56
    v_fmac_f32 v6, s69, v25
    v_fmac_f32 v7, s69, v57
    v_fmac_f32 v6, s70, v26
    v_fmac_f32 v7, s70, v58
    v_fmac_f32 v6, s71, v27
    v_fmac_f32 v7, s71, v59
    v_fmac_f32 v6, s72, v28
    v_fmac_f32 v7, s72, v60
    v_fmac_f32 v6, s73, v29
    v_fmac_f32 v7, s73, v61
    v_fmac_f32 v6, s74, v30
    v_fmac_f32 v7, s74, v62
    v_fmac_f32 v6, s75, v31
    v_fmac_f32 v7, s75, v63
    v_fmac_f32 v6, s76, v32
    v_fmac_f32 v7, s76, v64
    v_fmac_f32 v6, s77, v33
    v_fmac_f32 v7, s77, v65
    v_fmac_f32 v6, s78, v34
    v_fmac_f32 v7, s78, v66
    v_fmac_f32 v6, s79, v35
    v_fmac_f32 v7, s79, v67
    v_fmac_f32 v6, s80, v36
    v_fmac_f32 v7, s80, v68
    v_fmac_f32 v6, s81, v37
    v_fmac_f32 v7, s81, v69
    v_fmac_f32 v6, s82, v38
    v_fmac_f32 v7, s82, v70
    v_fmac_f32 v6, s83, v39
    v_fmac_f32 v7, s83, v71
    v_dot2c_f32_bf16 v4, s27, v142
    v_dot2c_f32_bf16 v5, s27, v146
    v_dot2c_f32_bf16 v4, s27, v143
    v_dot2c_f32_bf16 v5, s27, v147
    v_dot2c_f32_bf16 v4, s27, v144
    v_dot2c_f32_bf16 v5, s27, v148
    v_dot2c_f32_bf16 v4, s27, v145
    v_dot2c_f32_bf16 v5, s27, v149
    v_dot2c_f32_bf16 v4, s27, v150
    v_dot2c_f32_bf16 v5, s27, v154
    v_dot2c_f32_bf16 v4, s27, v151
    v_dot2c_f32_bf16 v5, s27, v155
    v_dot2c_f32_bf16 v4, s27, v152
    v_dot2c_f32_bf16 v5, s27, v156
    v_dot2c_f32_bf16 v4, s27, v153
    v_dot2c_f32_bf16 v5, s27, v157
    v_dot2c_f32_bf16 v4, s27, v158
    v_dot2c_f32_bf16 v5, s27, v162
    v_dot2c_f32_bf16 v4, s27, v159
    v_dot2c_f32_bf16 v5, s27, v163
    v_dot2c_f32_bf16 v4, s27, v160
    v_dot2c_f32_bf16 v5, s27, v164
    v_dot2c_f32_bf16 v4, s27, v161
    v_dot2c_f32_bf16 v5, s27, v165
    v_dot2c_f32_bf16 v4, s27, v166
    v_dot2c_f32_bf16 v5, s27, v170
    v_dot2c_f32_bf16 v4, s27, v167
    v_dot2c_f32_bf16 v5, s27, v171
    v_dot2c_f32_bf16 v4, s27, v168
    v_dot2c_f32_bf16 v5, s27, v172
    v_dot2c_f32_bf16 v4, s27, v169
    v_dot2c_f32_bf16 v5, s27, v173
    s_lshl_b32 s28, s24, 10
    s_add_u32 s28, s28, 8192
    v_lshl_add_u32 v1, v1, 2, s28
    v_lshl_add_u32 v2, v2, 2, s28
    ds_write2st64_b32 v1, v4, v6 offset0:0 offset1:2
    ds_write2st64_b32 v2, v5, v7 offset0:0 offset1:2
    v_lshlrev_b32 v137, 2, v0
    s_waitcnt vmcnt(0) lgkmcnt(0)
    s_barrier
    ds_read2st64_b32 v[8:9], v137 offset0:32 offset1:36
    ds_read2st64_b32 v[10:11], v137 offset0:40 offset1:44
    s_lshl_b32 s28, s42, 11
    s_add_u32 s28, s28, 24379392
    v_lshlrev_b32 v137, 3, v0
    s_mov_b64 exec, 255
    buffer_store_dword v232, v237, s[4:7], s43 offen sc1
    s_mov_b64 exec, -1
    s_waitcnt lgkmcnt(0)
    v_pk_add_f32 v[8:9], v[8:9], v[10:11]
    v_add_f32 v8, v8, v9
    v_mov_b32 v9, v232
    buffer_store_dwordx2 v[8:9], v137, s[4:7], s28 offen sc1
    s_branch L_adaL_nopub_48
L_adaL_reset_46:
    s_waitcnt lgkmcnt(0)
    buffer_load_dwordx2 v[232:233], off, s[44:47], 0 sc1
    s_waitcnt vmcnt(0)
    v_readfirstlane_b32 s48, v232
    s_nop 0
    s_cmp_eq_u32 s48, 0
    s_cbranch_scc1 L_adaL_slow_64
L_adaL_got_66:
L_adaL_nopub_48:
    s_barrier
    v_lshrrev_b32 v240, 6, v0
    s_nop 0
    v_readfirstlane_b32 s82, v240
    s_bfe_u32 s87, s2, 0x30003
    s_and_b32 s83, s2, 6
    s_lshl_b32 s83, s83, 2
    s_add_u32 s83, s83, s87
    s_lshr_b32 s87, s2, 6
    s_and_b32 s84, s2, 1
    s_lshl_b32 s84, s84, 2
    s_add_u32 s84, s84, s87
    v_and_b32 v240, 63, v0
    v_lshlrev_b32 v241, 4, v240
    s_add_u32 s87, s82, 1
    s_lshl_b32 s87, s87, 29
    s_and_b32 s87, s87, 2147483648
    s_or_b32 s87, s87, 20480
    v_add_u32 v242, s87, v241
    s_mul_i32 s85, s84, 286720
    s_mul_i32 s87, s82, 40960
    s_add_u32 s85, s85, s87
    s_add_u32 s85, s85, 9056256
    s_and_b32 s86, s2, 7
    s_mul_i32 s86, s86, 3840
    s_mul_i32 s87, s84, 384
    s_add_u32 s86, s86, s87
    s_add_u32 s86, s86, 65536
    v_min_u32 v243, 9, v240
    v_lshlrev_b32 v243, 5, v243
    v_lshrrev_b32 v246, 3, v240
    v_lshlrev_b32 v245, 13, v246
    v_lshrrev_b32 v246, 4, v240
    v_and_b32 v247, 7, v0
    v_xor_b32 v246, v246, v247
    v_lshl_add_u32 v245, v246, 4, v245
    s_mul_i32 s87, s84, 0
    v_add_u32 v245, s87, v245
    v_xor_b32 v246, 64, v245
    v_add_u32 v246, 64512, v246
    s_lshl_b32 s88, s83, 18
    s_lshl_b32 s87, s82, 10
    s_add_u32 s88, s88, s87
    s_add_u32 s87, s82, 3
    s_and_b32 s40, s87, 1
    s_and_b32 s87, s87, 2
    s_lshl_b32 s87, s87, 4
    s_add_u32 s87, s87, s40
    s_lshl_b32 s87, s87, 12
    s_add_u32 s91, s88, s87
    s_add_u32 s87, s82, 2
    s_and_b32 s40, s87, 1
    s_and_b32 s87, s87, 2
    s_lshl_b32 s87, s87, 4
    s_add_u32 s87, s87, s40
    s_lshl_b32 s87, s87, 12
    s_add_u32 s90, s88, s87
    s_add_u32 s87, s82, 1
    s_and_b32 s40, s87, 1
    s_and_b32 s87, s87, 2
    s_lshl_b32 s87, s87, 4
    s_add_u32 s87, s87, s40
    s_lshl_b32 s87, s87, 12
    s_add_u32 s89, s88, s87
    s_add_u32 s87, s82, 0
    s_and_b32 s40, s87, 1
    s_and_b32 s87, s87, 2
    s_lshl_b32 s87, s87, 4
    s_add_u32 s87, s87, s40
    s_lshl_b32 s87, s87, 12
    s_add_u32 s88, s88, s87
    s_movk_i32 s40, 0x380
    s_mul_i32 s41, s82, 14336
    s_add_u32 s41, s41, 102912
    s_lshr_b32 s10, s2, 3
    s_sub_u32 s10, s10, 20
    s_mov_b32 s8, 5
    s_mul_i32 s9, s10, 5
    s_bfe_u32 s11, s2, 0x10002
    s_sub_u32 s11, 8, s11
    s_mul_i32 s12, s11, 1
    s_mul_i32 s13, s10, 4
    s_add_u32 s13, s13, s12
    s_cmp_ge_u32 s2, 220
    s_cselect_b32 s8, 4, s8
    s_cselect_b32 s9, s13, s9
    s_cmp_eq_u32 s10, 10
    s_cselect_b32 s8, 8, s8
    s_add_u32 s12, s12, 48
    s_sub_u32 s13, 64, s12
    s_max_i32 s13, s13, 0
    s_cmp_eq_u32 s10, 11
    s_cselect_b32 s8, s13, s8
    s_cselect_b32 s9, s12, s9
    s_lshl_b32 s9, s9, 14
    s_and_b32 s10, s2, 7
    s_lshl_b32 s10, s10, 20
    s_add_u32 s9, s9, s10
    v_lshlrev_b32 v1, 4, v0
    s_cmp_eq_u32 s8, 0
    s_cbranch_scc1 L_adaL_nopull_68
L_adaL_pull_67:
    buffer_load_dwordx4 v[2:5], v1, s[32:35], s9 offen
    s_add_u32 s9, s9, 4096
    buffer_load_dwordx4 v[2:5], v1, s[32:35], s9 offen
    s_add_u32 s9, s9, 4096
    buffer_load_dwordx4 v[2:5], v1, s[32:35], s9 offen
    s_add_u32 s9, s9, 4096
    buffer_load_dwordx4 v[2:5], v1, s[32:35], s9 offen
    s_add_u32 s9, s9, 4096
    s_sub_u32 s8, s8, 1
    s_cmp_lg_u32 s8, 0
    s_cbranch_scc1 L_adaL_pull_67
L_adaL_nopull_68:
    s_lshr_b32 s8, s2, 3
    s_sub_u32 s8, s8, 20
    s_and_b32 s9, s2, 1
    v_lshlrev_b32 v1, 7, v0
    buffer_load_dword v244, v243, s[4:7], s86 offen sc1
    s_branch L_adaL_join_3
L_adaL_slow_4:
    s_mov_b32 s49, 65536
L_adaL_poll_5:
    buffer_load_dwordx2 v[12:13], off, s[44:47], 0 sc1
    s_waitcnt vmcnt(0)
    s_sub_u32 s49, s49, 1
    s_cbranch_scc1 L_adaL_got_6
    v_readfirstlane_b32 s48, v12
    s_nop 0
    s_cmp_eq_u32 s48, 0
    s_cbranch_scc1 L_adaL_poll_5
    s_branch L_adaL_got_6
L_adaL_slow_10:
    s_mov_b32 s49, 65536
L_adaL_poll_11:
    buffer_load_dwordx2 v[14:15], v10, s[4:7], 0 offen sc1
    buffer_load_dword v16, v24, s[4:7], s58 offen sc1
    s_waitcnt vmcnt(0)
    s_sub_u32 s49, s49, 1
    s_cbranch_scc1 L_adaL_got_12
    v_cmp_ne_u32 vcc, s48, v15
    v_cmp_ne_u32 s[50:51], s48, v16
    s_nop 0
    s_or_b64 vcc, vcc, s[50:51]
    s_cbranch_vccnz L_adaL_poll_11
    s_branch L_adaL_got_12
L_adaL_slow_13:
    s_mov_b32 s49, 65536
L_adaL_poll_14:
    buffer_load_dwordx2 v[14:15], v25, s[4:7], 0 offen sc1
    s_waitcnt vmcnt(0)
    s_sub_u32 s49, s49, 1
    s_cbranch_scc1 L_adaL_got_15
    v_cmp_ne_u32 vcc, s48, v15
    s_nop 0
    s_cbranch_vccnz L_adaL_poll_14
    s_branch L_adaL_got_15
L_adaL_slow_16:
    s_mov_b32 s49, 65536
L_adaL_poll_17:
    buffer_load_dword v244, v243, s[4:7], s86 offen sc1
    s_waitcnt vmcnt(0)
    s_sub_u32 s49, s49, 1
    s_cbranch_scc1 L_adaL_got_18
    v_cmp_ne_u32 vcc, s48, v244
    s_nop 0
    s_cbranch_vccnz L_adaL_poll_17
    s_branch L_adaL_got_18
L_adaL_slow_19:
    s_mov_b32 s49, 65536
L_adaL_poll_20:
    s_add_u32 s63, s59, 0
    buffer_load_dwordx4 v[100:103], v180, s[4:7], s63 offen sc1
    s_add_u32 s63, s59, 32768
    buffer_load_dwordx4 v[104:107], v180, s[4:7], s63 offen sc1
    s_add_u32 s63, s59, 65536
    buffer_load_dwordx4 v[108:111], v180, s[4:7], s63 offen sc1
    s_add_u32 s63, s59, 98304
    buffer_load_dwordx4 v[112:115], v180, s[4:7], s63 offen sc1
    s_add_u32 s63, s59, 131072
    buffer_load_dwordx4 v[116:119], v180, s[4:7], s63 offen sc1
    buffer_load_dwordx2 v[164:165], v166, s[4:7], 0 offen sc1
    s_waitcnt vmcnt(0)
    s_sub_u32 s49, s49, 1
    s_cbranch_scc1 L_adaL_got_21
    v_min3_u32 v181, v165, v13, v13
    v_min3_u32 v181, v181, v101, v103
    v_min3_u32 v181, v181, v105, v107
    v_min3_u32 v181, v181, v109, v111
    v_min3_u32 v181, v181, v113, v115
    v_min3_u32 v181, v181, v117, v119
    v_max3_u32 v182, v165, v13, v13
    v_max3_u32 v182, v182, v101, v103
    v_max3_u32 v182, v182, v105, v107
    v_max3_u32 v182, v182, v109, v111
    v_max3_u32 v182, v182, v113, v115
    v_max3_u32 v182, v182, v117, v119
    v_cmp_ne_u32 vcc, v181, v182
    s_nop 0
    s_cbranch_vccnz L_adaL_poll_20
    s_branch L_adaL_got_21
L_adaL_slow_26:
    s_mov_b32 s49, 65536
L_adaL_poll_27:
    buffer_load_dwordx4 v[164:167], v172, s[4:7], s55 offen offset:0 sc1
    buffer_load_dwordx4 v[168:171], v172, s[4:7], s55 offen offset:1024 sc1
    s_waitcnt vmcnt(0)
    s_sub_u32 s49, s49, 1
    s_cbranch_scc1 L_adaL_got_28
    v_min3_u32 v3, v165, v167, v13
    v_min3_u32 v3, v3, v169, v171
    v_max3_u32 v4, v165, v167, v13
    v_max3_u32 v4, v4, v169, v171
    v_cmp_ne_u32 vcc, v3, v4
    s_nop 0
    s_cbranch_vccnz L_adaL_poll_27
    s_branch L_adaL_got_28
L_adaL_slow_34:
    s_mov_b32 s49, 65536
L_adaL_poll_35:
    buffer_load_dword v27, v26, s[4:7], s55 offen sc1
    s_waitcnt vmcnt(0)
    s_sub_u32 s49, s49, 1
    s_cbranch_scc1 L_adaL_got_36
    v_cmp_ne_u32 vcc, s48, v27
    s_nop 0
    s_cbranch_vccnz L_adaL_poll_35
    s_branch L_adaL_got_36
L_adaL_slow_37:
    s_mov_b32 s49, 65536
L_adaL_poll_38:
    buffer_load_dword v27, v26, s[4:7], s55 offen sc1
    s_waitcnt vmcnt(0)
    s_sub_u32 s49, s49, 1
    s_cbranch_scc1 L_adaL_got_39
    v_cmp_ne_u32 vcc, s48, v27
    s_nop 0
    s_cbranch_vccnz L_adaL_poll_38
    s_branch L_adaL_got_39
L_adaL_slow_40:
    s_mov_b32 s49, 65536
L_adaL_poll_41:
    buffer_load_dword v27, v26, s[4:7], s55 offen sc1
    s_waitcnt vmcnt(0)
    s_sub_u32 s49, s49, 1
    s_cbranch_scc1 L_adaL_got_42
    v_cmp_ne_u32 vcc, s48, v27
    s_nop 0
    s_cbranch_vccnz L_adaL_poll_41
    s_branch L_adaL_got_42
L_adaL_slow_51:
    s_mov_b32 s49, 65536
L_adaL_poll_52:
    buffer_load_dwordx2 v[232:233], off, s[44:47], 0 sc1
    s_waitcnt vmcnt(0)
    s_sub_u32 s49, s49, 1
    s_cbranch_scc1 L_adaL_got_53
    v_readfirstlane_b32 s48, v232
    s_nop 0
    s_cmp_eq_u32 s48, 0
    s_cbranch_scc1 L_adaL_poll_52
    s_branch L_adaL_got_53
L_adaL_slow_55:
    s_mov_b32 s49, 65536
L_adaL_poll_56:
    buffer_load_dwordx2 v[232:233], off, s[44:47], 0 sc1
    s_waitcnt vmcnt(0)
    s_sub_u32 s49, s49, 1
    s_cbranch_scc1 L_adaL_got_57
    v_readfirstlane_b32 s48, v232
    s_nop 0
    s_cmp_eq_u32 s48, 0
    s_cbranch_scc1 L_adaL_poll_56
    s_branch L_adaL_got_57
L_adaL_slow_58:
    s_mov_b32 s49, 65536
L_adaL_poll_59:
    buffer_load_dwordx2 v[232:233], off, s[44:47], 0 sc1
    s_waitcnt vmcnt(0)
    s_sub_u32 s49, s49, 1
    s_cbranch_scc1 L_adaL_got_60
    v_readfirstlane_b32 s48, v232
    s_nop 0
    s_cmp_eq_u32 s48, 0
    s_cbranch_scc1 L_adaL_poll_59
    s_branch L_adaL_got_60
L_adaL_slow_64:
    s_mov_b32 s49, 65536
L_adaL_poll_65:
    buffer_load_dwordx2 v[232:233], off, s[44:47], 0 sc1
    s_waitcnt vmcnt(0)
    s_sub_u32 s49, s49, 1
    s_cbranch_scc1 L_adaL_got_66
    v_readfirstlane_b32 s48, v232
    s_nop 0
    s_cmp_eq_u32 s48, 0
    s_cbranch_scc1 L_adaL_poll_65
    s_branch L_adaL_got_66
code_end:
    s_endpgm
.section .rodata,"a"
.p2align 6
.amdhsa_kernel adaLN_cond__ssm_conv_h3__mixer_gmlp__prompt_kernel
  .amdhsa_next_free_vgpr 504
  .amdhsa_next_free_sgpr 92
  .amdhsa_accum_offset 248
  .amdhsa_group_segment_fixed_size 0
  .amdhsa_kernarg_size 128
  .amdhsa_user_sgpr_count 2
  .amdhsa_user_sgpr_kernarg_segment_ptr 1
  .amdhsa_system_sgpr_workgroup_id_x 1
  .amdhsa_float_denorm_mode_32 3
.end_amdhsa_kernel
```
